```python
import torch

def _softmax(x, axis=-1):
    return torch.softmax(x, dim=axis)

def _gelu(x):
    return torch.nn.functional.gelu(x, approximate='tanh')

def _silu(x):
    return torch.nn.functional.silu(x)

def _sigmoid(x):
    return torch.sigmoid(x)

def _layernorm(x, axis=-1, eps=1e-05):
    m = x.mean(dim=axis, keepdim=True)
    v = x.var(dim=axis, keepdim=True, unbiased=False)
    return (x - m) / torch.sqrt(v + eps)

def _scatter_add(tgt, idx, src, axis=0):
    return tgt.clone().index_add_(axis, idx, src)

def _segment_sum(src, seg, n):
    out = torch.zeros((n,) + src.shape[1:], dtype=src.dtype)
    return out.index_add_(0, seg, src)

def _pad(x, pw):
    flat = tuple((v for pair in reversed(pw) for v in pair))
    return torch.nn.functional.pad(x, flat)
kernel_name = 'concat_heads__memory_aug_recurrent_mem_tr__sliding_local_dilated__prompt'

def setup_inputs():

    _w = lambda a: (lambda t: t.to(torch.bfloat16) if t.is_floating_point() else t)(torch.as_tensor(a))

    def _A_setup():
        B, S, Dm = (1, 2048, 1024)
        H, Dh = (32, 128)
        M, seg = (8, 32)
        seg = min(seg, S)
        S = S // seg * seg
        return {'x': _w((lambda *s: torch.randn(*s, dtype=torch.bfloat16) * 0.05)(B, S, Dm)), 'mem0': _w((lambda *s: torch.randn(*s, dtype=torch.bfloat16) * 1.6)(B, M, Dm)), 'Wq': _w((lambda *s: torch.randn(*s, dtype=torch.bfloat16) * 0.8)(Dm, H, Dh) * Dm ** (-0.5)), 'Wk': _w((lambda *s: torch.randn(*s, dtype=torch.bfloat16) * 0.8)(Dm, H, Dh) * Dm ** (-0.5)), 'Wv': _w((lambda *s: torch.randn(*s, dtype=torch.bfloat16) * 1.6)(Dm, H, Dh) * Dm ** (-0.5)), 'Wo': _w((lambda *s: torch.randn(*s, dtype=torch.bfloat16) * 1.6)(H, Dh, Dm) * (H * Dh) ** (-0.5)), 'seg_len': seg}
    _A_in = _A_setup()

    def _B_setup():
        B, S, D = (1, 2048, 1024)
        return {'x': _w((lambda *s: torch.randn(*s, dtype=torch.bfloat16) * 0.2)(B, S, D)), 'wqkv': _w((lambda *s: torch.randn(*s, dtype=torch.bfloat16) * 0.2)(D, 3 * D)), 'wo': _w((lambda *s: torch.randn(*s, dtype=torch.bfloat16) * 0.05)(D, D))}
    _B_in = _B_setup()
    return {'A_x': _A_in['x'], 'A_mem0': _A_in['mem0'], 'A_Wq': _A_in['Wq'], 'A_Wk': _A_in['Wk'], 'A_Wv': _A_in['Wv'], 'A_Wo': _A_in['Wo'], 'A_seg_len': _A_in['seg_len'], 'B_x': _B_in['x'], 'B_wqkv': _B_in['wqkv'], 'B_wo': _B_in['wo']}

def reference(A_x, A_mem0, A_Wq, A_Wk, A_Wv, A_Wo, A_seg_len, B_x, B_wqkv, B_wo):

    def _A_ref(x, mem0, Wq, Wk, Wv, Wo, seg_len):
        B, S, Dm = x.shape
        H, Dh = (Wq.shape[1], Wq.shape[2])
        M = mem0.shape[1]
        scale = Dh ** (-0.5)
        n_seg = S // seg_len
        L = M + seg_len
        idx = torch.arange(L)
        mask = (idx[:, None] < M) | (idx[:, None] >= idx[None, :])
        mem = mem0
        outs = []
        for s in range(n_seg):
            xs = x[:, s * seg_len:(s + 1) * seg_len, :].clone()
            h = torch.concatenate([mem, xs], axis=1)
            q = torch.einsum('btd,dhe->bhte', h, Wq)
            k = torch.einsum('btd,dhe->bhte', h, Wk)
            v = torch.einsum('btd,dhe->bhte', h, Wv)
            scores = torch.einsum('bhqe,bhke->bhqk', q, k) * scale
            scores = torch.where(mask[None, None], scores, -1000000000.0)
            p = _softmax(scores, axis=-1)
            o = torch.einsum('bhqk,bhke->bhqe', p, v)
            o = torch.einsum('bhte,hed->btd', o, Wo)
            mem = o[:, :M, :].clone()
            outs.append(o[:, M:, :])
        return torch.concatenate(outs, axis=1)

    def _B_ref(x, wqkv, wo):
        B, S, D = x.shape
        H = 32
        Dh = D // H
        W, dil = (8, 2)
        qkv = (lambda x, *d: x.permute(*d))((x @ wqkv).reshape(B, S, 3, H, Dh), 2, 0, 3, 1, 4)
        q, k, v = (qkv[0], qkv[1], qkv[2])
        scale = Dh ** (-0.5)
        pos = torch.arange(S)
        off = torch.arange(W) * dil
        idx = pos[:, None] - off[None, :]
        mask = idx >= 0
        idx_c = torch.where(mask, idx, 0).reshape(-1)
        kg = k[:, :, idx_c, :].reshape(B, H, S, W, Dh)
        vg = v[:, :, idx_c, :].reshape(B, H, S, W, Dh)
        logits = torch.einsum('bhsd,bhswd->bhsw', q, kg) * scale
        logits = torch.where(mask[None, None, :, :], logits, -1000000000.0)
        attn = _softmax(logits, axis=-1)
        o = torch.einsum('bhsw,bhswd->bhsd', attn, vg)
        return (lambda x, *d: x.permute(*d))(o, 0, 2, 1, 3).reshape(B, S, D) @ wo
    a = _A_ref(A_x, A_mem0, A_Wq, A_Wk, A_Wv, A_Wo, A_seg_len)
    b = _B_ref(B_x, B_wqkv, B_wo)
    return torch.concatenate([a, b], axis=-1)
```

```asm
; @launch grid=(256,1,1) block=(256,1,1) lds=163840
.amdgcn_target "amdgcn-amd-amdhsa--gfx950"
.text
.globl concat_heads__memory_aug_recurrent_mem_tr__sliding_local_dilated__prompt_kernel
.p2align 8
.type concat_heads__memory_aug_recurrent_mem_tr__sliding_local_dilated__prompt_kernel,@function
concat_heads__memory_aug_recurrent_mem_tr__sliding_local_dilated__prompt_kernel:
    s_cmp_ge_u32 s2, 256
    s_cbranch_scc1 L_end
    s_and_b32 s3, s2, 3
    s_lshl_b32 s3, s3, 5
    s_lshr_b32 s28, s2, 3
    s_add_u32 s28, s28, s3
    s_bitcmp1_b32 s2, 2
    s_cbranch_scc1 L_gem
    s_load_dwordx2 s[72:73], s[0:1], 8
    s_load_dwordx4 s[76:79], s[0:1], 16
    s_load_dwordx4 s[80:83], s[0:1], 32
    s_load_dwordx2 s[90:91], s[0:1], 96
    s_load_dwordx2 s[92:93], s[0:1], 88
    v_and_b32 v1, 63, v0
    v_lshrrev_b32 v2, 6, v0
    s_nop 0
    v_readfirstlane_b32 s31, v2
    s_lshr_b32 s29, s28, 2
    s_and_b32 s30, s28, 3
    s_mov_b32 s41, 0
    s_waitcnt lgkmcnt(0)
    s_mov_b32 s24, s72
    s_and_b32 s25, s73, 0xffff
    s_mov_b32 s26, 16384
    s_mov_b32 s27, 0x00020000
    s_mov_b32 s8, s76
    s_and_b32 s9, s77, 0xffff
    s_mov_b32 s10, 8388608
    s_mov_b32 s11, 0x00020000
    s_mov_b32 s12, s78
    s_and_b32 s13, s79, 0xffff
    s_mov_b32 s14, 8388608
    s_mov_b32 s15, 0x00020000
    s_mov_b32 s16, s80
    s_and_b32 s17, s81, 0xffff
    s_mov_b32 s18, 8388608
    s_mov_b32 s19, 0x00020000
    s_mov_b32 s20, s82
    s_and_b32 s21, s83, 0xffff
    s_mov_b32 s22, 8388608
    s_mov_b32 s23, 0x00020000
    s_mov_b32 s4, s90
    s_and_b32 s5, s91, 0xffff
    s_mov_b32 s6, 268435456
    s_mov_b32 s7, 0x00020000
    s_sub_u32 s49, 0, s90
    s_and_b32 s49, s49, 2097151
    s_add_u32 s49, s49, 117440512
    s_cmp_lg_u32 s31, 3
    s_cbranch_scc1 rec_cal_1
    s_cmp_ge_u32 s28, 9
    s_cbranch_scc1 rec_cal_1
    s_lshl_b32 s38, s28, 21
    s_add_u32 s38, s38, s49
    s_add_u32 s38, s38, 245760
    s_add_u32 s39, s38, 8192
    s_mov_b32 s72, -1
    s_mov_b32 s73, -1
    s_memtime s[76:77]
    s_waitcnt lgkmcnt(0)
    s_load_dword s80, s[90:91], s38 glc
    s_waitcnt lgkmcnt(0)
    s_memtime s[78:79]
    s_waitcnt lgkmcnt(0)
    s_sub_u32 s78, s78, s76
    s_min_u32 s72, s72, s78
    s_memtime s[76:77]
    s_waitcnt lgkmcnt(0)
    s_load_dword s80, s[90:91], s39 glc
    s_waitcnt lgkmcnt(0)
    s_memtime s[78:79]
    s_waitcnt lgkmcnt(0)
    s_sub_u32 s78, s78, s76
    s_min_u32 s73, s73, s78
    s_memtime s[76:77]
    s_waitcnt lgkmcnt(0)
    s_load_dword s80, s[90:91], s38 glc
    s_waitcnt lgkmcnt(0)
    s_memtime s[78:79]
    s_waitcnt lgkmcnt(0)
    s_sub_u32 s78, s78, s76
    s_min_u32 s72, s72, s78
    s_memtime s[76:77]
    s_waitcnt lgkmcnt(0)
    s_load_dword s80, s[90:91], s39 glc
    s_waitcnt lgkmcnt(0)
    s_memtime s[78:79]
    s_waitcnt lgkmcnt(0)
    s_sub_u32 s78, s78, s76
    s_min_u32 s73, s73, s78
    s_memtime s[76:77]
    s_waitcnt lgkmcnt(0)
    s_load_dword s80, s[90:91], s38 glc
    s_waitcnt lgkmcnt(0)
    s_memtime s[78:79]
    s_waitcnt lgkmcnt(0)
    s_sub_u32 s78, s78, s76
    s_min_u32 s72, s72, s78
    s_memtime s[76:77]
    s_waitcnt lgkmcnt(0)
    s_load_dword s80, s[90:91], s39 glc
    s_waitcnt lgkmcnt(0)
    s_memtime s[78:79]
    s_waitcnt lgkmcnt(0)
    s_sub_u32 s78, s78, s76
    s_min_u32 s73, s73, s78
    s_memtime s[76:77]
    s_waitcnt lgkmcnt(0)
    s_load_dword s80, s[90:91], s38 glc
    s_waitcnt lgkmcnt(0)
    s_memtime s[78:79]
    s_waitcnt lgkmcnt(0)
    s_sub_u32 s78, s78, s76
    s_min_u32 s72, s72, s78
    s_memtime s[76:77]
    s_waitcnt lgkmcnt(0)
    s_load_dword s80, s[90:91], s39 glc
    s_waitcnt lgkmcnt(0)
    s_memtime s[78:79]
    s_waitcnt lgkmcnt(0)
    s_sub_u32 s78, s78, s76
    s_min_u32 s73, s73, s78
    s_memtime s[76:77]
    s_waitcnt lgkmcnt(0)
    s_load_dword s80, s[90:91], s38 glc
    s_waitcnt lgkmcnt(0)
    s_memtime s[78:79]
    s_waitcnt lgkmcnt(0)
    s_sub_u32 s78, s78, s76
    s_min_u32 s72, s72, s78
    s_memtime s[76:77]
    s_waitcnt lgkmcnt(0)
    s_load_dword s80, s[90:91], s39 glc
    s_waitcnt lgkmcnt(0)
    s_memtime s[78:79]
    s_waitcnt lgkmcnt(0)
    s_sub_u32 s78, s78, s76
    s_min_u32 s73, s73, s78
    s_cmp_lt_u32 s73, s72
    s_cselect_b32 s38, 2, 1
    v_mov_b32 v2, s38
    s_lshl_b32 s39, s28, 2
    s_add_u32 s39, s39, 64
    v_mov_b32 v3, s39
    s_mov_b64 exec, 1
    global_store_dword v3, v2, s[92:93] sc1
    s_mov_b64 exec, -1
    s_waitcnt vmcnt(0)
rec_cal_1:
    s_lshl_b32 s38, s31, 21
    s_lshl_b32 s40, s28, 6
    s_add_u32 s38, s38, s40
    v_lshrrev_b32 v184, 2, v1
    v_lshlrev_b32 v184, 13, v184
    v_and_b32 v4, 3, v1
    v_lshl_add_u32 v184, v4, 4, v184
    v_add_u32 v184, s38, v184
    s_lshl_b32 s38, s31, 21
    s_lshr_b32 s40, s28, 1
    s_lshl_b32 s40, s40, 5
    s_add_u32 s38, s38, s40
    v_lshrrev_b32 v185, 1, v1
    v_lshlrev_b32 v185, 11, v185
    v_and_b32 v4, 1, v1
    v_lshl_add_u32 v185, v4, 4, v185
    v_add_u32 v185, s38, v185
    s_lshl_b32 s39, s31, 15
    v_lshrrev_b32 v186, 4, v1
    v_lshlrev_b32 v186, 9, v186
    v_bfe_u32 v4, v1, 2, 2
    v_lshl_add_u32 v186, v4, 6, v186
    v_and_b32 v4, 3, v1
    v_lshl_add_u32 v186, v4, 3, v186
    v_add_u32 v186, s39, v186
    v_lshrrev_b32 v187, 4, v1
    v_lshlrev_b32 v187, 8, v187
    v_bfe_u32 v4, v1, 2, 2
    v_lshl_add_u32 v187, v4, 5, v187
    v_and_b32 v4, 3, v1
    v_lshl_add_u32 v187, v4, 3, v187
    v_add_u32 v187, s39, v187
    s_add_u32 m0, s39, 0
    s_mov_b32 s38, 0
    buffer_load_dwordx4 v184, s[8:11], s38 offen lds
    s_add_u32 m0, s39, 1024
    s_mov_b32 s38, 131072
    buffer_load_dwordx4 v184, s[8:11], s38 offen lds
    s_add_u32 m0, s39, 2048
    s_mov_b32 s38, 0
    buffer_load_dwordx4 v184, s[12:15], s38 offen lds
    s_add_u32 m0, s39, 3072
    s_mov_b32 s38, 131072
    buffer_load_dwordx4 v184, s[12:15], s38 offen lds
    s_add_u32 m0, s39, 4096
    s_mov_b32 s38, 0
    buffer_load_dwordx4 v184, s[16:19], s38 offen lds
    s_add_u32 m0, s39, 5120
    s_mov_b32 s38, 131072
    buffer_load_dwordx4 v184, s[16:19], s38 offen lds
    s_add_u32 m0, s39, 6144
    s_mov_b32 s38, 262144
    buffer_load_dwordx4 v184, s[8:11], s38 offen lds
    s_add_u32 m0, s39, 7168
    s_mov_b32 s38, 393216
    buffer_load_dwordx4 v184, s[8:11], s38 offen lds
    s_add_u32 m0, s39, 8192
    s_mov_b32 s38, 262144
    buffer_load_dwordx4 v184, s[12:15], s38 offen lds
    s_add_u32 m0, s39, 9216
    s_mov_b32 s38, 393216
    buffer_load_dwordx4 v184, s[12:15], s38 offen lds
    s_add_u32 m0, s39, 10240
    s_mov_b32 s38, 262144
    buffer_load_dwordx4 v184, s[16:19], s38 offen lds
    s_add_u32 m0, s39, 11264
    s_mov_b32 s38, 393216
    buffer_load_dwordx4 v184, s[16:19], s38 offen lds
    s_add_u32 m0, s39, 12288
    s_mov_b32 s38, 524288
    buffer_load_dwordx4 v184, s[8:11], s38 offen lds
    s_add_u32 m0, s39, 13312
    s_mov_b32 s38, 655360
    buffer_load_dwordx4 v184, s[8:11], s38 offen lds
    s_add_u32 m0, s39, 14336
    s_mov_b32 s38, 524288
    buffer_load_dwordx4 v184, s[12:15], s38 offen lds
    s_add_u32 m0, s39, 15360
    s_mov_b32 s38, 655360
    buffer_load_dwordx4 v184, s[12:15], s38 offen lds
    s_add_u32 m0, s39, 16384
    s_mov_b32 s38, 524288
    buffer_load_dwordx4 v184, s[16:19], s38 offen lds
    s_add_u32 m0, s39, 17408
    s_mov_b32 s38, 655360
    buffer_load_dwordx4 v184, s[16:19], s38 offen lds
    s_add_u32 m0, s39, 18432
    s_mov_b32 s38, 786432
    buffer_load_dwordx4 v184, s[8:11], s38 offen lds
    s_add_u32 m0, s39, 19456
    s_mov_b32 s38, 917504
    buffer_load_dwordx4 v184, s[8:11], s38 offen lds
    s_add_u32 m0, s39, 20480
    s_mov_b32 s38, 786432
    buffer_load_dwordx4 v184, s[12:15], s38 offen lds
    s_add_u32 m0, s39, 21504
    s_mov_b32 s38, 917504
    buffer_load_dwordx4 v184, s[12:15], s38 offen lds
    s_add_u32 m0, s39, 22528
    s_mov_b32 s38, 786432
    buffer_load_dwordx4 v184, s[16:19], s38 offen lds
    s_add_u32 m0, s39, 23552
    s_mov_b32 s38, 917504
    buffer_load_dwordx4 v184, s[16:19], s38 offen lds
    s_add_u32 m0, s39, 24576
    s_mov_b32 s38, 1048576
    buffer_load_dwordx4 v184, s[8:11], s38 offen lds
    s_add_u32 m0, s39, 25600
    s_mov_b32 s38, 1179648
    buffer_load_dwordx4 v184, s[8:11], s38 offen lds
    s_add_u32 m0, s39, 26624
    s_mov_b32 s38, 1048576
    buffer_load_dwordx4 v184, s[12:15], s38 offen lds
    s_add_u32 m0, s39, 27648
    s_mov_b32 s38, 1179648
    buffer_load_dwordx4 v184, s[12:15], s38 offen lds
    s_add_u32 m0, s39, 28672
    s_mov_b32 s38, 1048576
    buffer_load_dwordx4 v184, s[16:19], s38 offen lds
    s_add_u32 m0, s39, 29696
    s_mov_b32 s38, 1179648
    buffer_load_dwordx4 v184, s[16:19], s38 offen lds
    s_add_u32 m0, s39, 30720
    s_mov_b32 s38, 1310720
    buffer_load_dwordx4 v184, s[8:11], s38 offen lds
    s_add_u32 m0, s39, 31744
    s_mov_b32 s38, 1441792
    buffer_load_dwordx4 v184, s[8:11], s38 offen lds
    s_waitcnt vmcnt(30)
    ds_read_b64_tr_b16 a[0:1], v186 offset:0
    ds_read_b64_tr_b16 a[2:3], v186 offset:256
    ds_read_b64_tr_b16 a[8:9], v186 offset:32
    ds_read_b64_tr_b16 a[10:11], v186 offset:288
    s_waitcnt vmcnt(28)
    ds_read_b64_tr_b16 a[16:17], v186 offset:2048
    ds_read_b64_tr_b16 a[18:19], v186 offset:2304
    ds_read_b64_tr_b16 a[24:25], v186 offset:2080
    ds_read_b64_tr_b16 a[26:27], v186 offset:2336
    s_waitcnt lgkmcnt(4)
    s_add_u32 m0, s39, 0
    s_mov_b32 s38, 1310720
    buffer_load_dwordx4 v184, s[12:15], s38 offen lds
    s_add_u32 m0, s39, 1024
    s_mov_b32 s38, 1441792
    buffer_load_dwordx4 v184, s[12:15], s38 offen lds
    s_waitcnt vmcnt(28)
    ds_read_b64_tr_b16 a[32:33], v186 offset:4096
    ds_read_b64_tr_b16 a[34:35], v186 offset:4352
    ds_read_b64_tr_b16 a[40:41], v186 offset:4128
    ds_read_b64_tr_b16 a[42:43], v186 offset:4384
    s_waitcnt lgkmcnt(4)
    s_add_u32 m0, s39, 2048
    s_mov_b32 s38, 1310720
    buffer_load_dwordx4 v184, s[16:19], s38 offen lds
    s_add_u32 m0, s39, 3072
    s_mov_b32 s38, 1441792
    buffer_load_dwordx4 v184, s[16:19], s38 offen lds
    s_waitcnt vmcnt(28)
    ds_read_b64_tr_b16 a[4:5], v186 offset:6144
    ds_read_b64_tr_b16 a[6:7], v186 offset:6400
    ds_read_b64_tr_b16 a[12:13], v186 offset:6176
    ds_read_b64_tr_b16 a[14:15], v186 offset:6432
    s_waitcnt lgkmcnt(4)
    s_add_u32 m0, s39, 4096
    s_mov_b32 s38, 1572864
    buffer_load_dwordx4 v184, s[8:11], s38 offen lds
    s_add_u32 m0, s39, 5120
    s_mov_b32 s38, 1703936
    buffer_load_dwordx4 v184, s[8:11], s38 offen lds
    s_waitcnt vmcnt(28)
    ds_read_b64_tr_b16 a[20:21], v186 offset:8192
    ds_read_b64_tr_b16 a[22:23], v186 offset:8448
    ds_read_b64_tr_b16 a[28:29], v186 offset:8224
    ds_read_b64_tr_b16 a[30:31], v186 offset:8480
    s_waitcnt lgkmcnt(4)
    s_add_u32 m0, s39, 6144
    s_mov_b32 s38, 1572864
    buffer_load_dwordx4 v184, s[12:15], s38 offen lds
    s_add_u32 m0, s39, 7168
    s_mov_b32 s38, 1703936
    buffer_load_dwordx4 v184, s[12:15], s38 offen lds
    s_waitcnt vmcnt(28)
    ds_read_b64_tr_b16 a[36:37], v186 offset:10240
    ds_read_b64_tr_b16 a[38:39], v186 offset:10496
    ds_read_b64_tr_b16 a[44:45], v186 offset:10272
    ds_read_b64_tr_b16 a[46:47], v186 offset:10528
    s_waitcnt lgkmcnt(4)
    s_add_u32 m0, s39, 8192
    s_mov_b32 s38, 1572864
    buffer_load_dwordx4 v184, s[16:19], s38 offen lds
    s_add_u32 m0, s39, 9216
    s_mov_b32 s38, 1703936
    buffer_load_dwordx4 v184, s[16:19], s38 offen lds
    s_waitcnt vmcnt(28)
    ds_read_b64_tr_b16 a[48:49], v186 offset:12288
    ds_read_b64_tr_b16 a[50:51], v186 offset:12544
    ds_read_b64_tr_b16 a[56:57], v186 offset:12320
    ds_read_b64_tr_b16 a[58:59], v186 offset:12576
    s_waitcnt lgkmcnt(4)
    s_add_u32 m0, s39, 10240
    s_mov_b32 s38, 1835008
    buffer_load_dwordx4 v184, s[8:11], s38 offen lds
    s_add_u32 m0, s39, 11264
    s_mov_b32 s38, 1966080
    buffer_load_dwordx4 v184, s[8:11], s38 offen lds
    s_waitcnt vmcnt(28)
    ds_read_b64_tr_b16 a[64:65], v186 offset:14336
    ds_read_b64_tr_b16 a[66:67], v186 offset:14592
    ds_read_b64_tr_b16 a[72:73], v186 offset:14368
    ds_read_b64_tr_b16 a[74:75], v186 offset:14624
    s_waitcnt lgkmcnt(4)
    s_add_u32 m0, s39, 12288
    s_mov_b32 s38, 1835008
    buffer_load_dwordx4 v184, s[12:15], s38 offen lds
    s_add_u32 m0, s39, 13312
    s_mov_b32 s38, 1966080
    buffer_load_dwordx4 v184, s[12:15], s38 offen lds
    s_waitcnt vmcnt(28)
    ds_read_b64_tr_b16 a[80:81], v186 offset:16384
    ds_read_b64_tr_b16 a[82:83], v186 offset:16640
    ds_read_b64_tr_b16 a[88:89], v186 offset:16416
    ds_read_b64_tr_b16 a[90:91], v186 offset:16672
    s_waitcnt lgkmcnt(4)
    s_add_u32 m0, s39, 14336
    s_mov_b32 s38, 1835008
    buffer_load_dwordx4 v184, s[16:19], s38 offen lds
    s_add_u32 m0, s39, 15360
    s_mov_b32 s38, 1966080
    buffer_load_dwordx4 v184, s[16:19], s38 offen lds
    s_waitcnt vmcnt(28)
    ds_read_b64_tr_b16 a[52:53], v186 offset:18432
    ds_read_b64_tr_b16 a[54:55], v186 offset:18688
    ds_read_b64_tr_b16 a[60:61], v186 offset:18464
    ds_read_b64_tr_b16 a[62:63], v186 offset:18720
    s_waitcnt lgkmcnt(4)
    s_add_u32 m0, s39, 16384
    s_mov_b32 s38, 0
    buffer_load_dwordx4 v185, s[20:23], s38 offen lds
    s_add_u32 m0, s39, 17408
    s_mov_b32 s38, 65536
    buffer_load_dwordx4 v185, s[20:23], s38 offen lds
    s_waitcnt vmcnt(28)
    ds_read_b64_tr_b16 a[68:69], v186 offset:20480
    ds_read_b64_tr_b16 a[70:71], v186 offset:20736
    ds_read_b64_tr_b16 a[76:77], v186 offset:20512
    ds_read_b64_tr_b16 a[78:79], v186 offset:20768
    s_waitcnt lgkmcnt(4)
    s_add_u32 m0, s39, 18432
    s_mov_b32 s38, 131072
    buffer_load_dwordx4 v185, s[20:23], s38 offen lds
    s_add_u32 m0, s39, 19456
    s_mov_b32 s38, 196608
    buffer_load_dwordx4 v185, s[20:23], s38 offen lds
    s_waitcnt vmcnt(28)
    ds_read_b64_tr_b16 a[84:85], v186 offset:22528
    ds_read_b64_tr_b16 a[86:87], v186 offset:22784
    ds_read_b64_tr_b16 a[92:93], v186 offset:22560
    ds_read_b64_tr_b16 a[94:95], v186 offset:22816
    s_waitcnt lgkmcnt(4)
    s_add_u32 m0, s39, 20480
    s_mov_b32 s38, 262144
    buffer_load_dwordx4 v185, s[20:23], s38 offen lds
    s_add_u32 m0, s39, 21504
    s_mov_b32 s38, 327680
    buffer_load_dwordx4 v185, s[20:23], s38 offen lds
    s_waitcnt vmcnt(28)
    ds_read_b64_tr_b16 a[96:97], v186 offset:24576
    ds_read_b64_tr_b16 a[98:99], v186 offset:24832
    ds_read_b64_tr_b16 a[104:105], v186 offset:24608
    ds_read_b64_tr_b16 a[106:107], v186 offset:24864
    s_waitcnt lgkmcnt(4)
    s_add_u32 m0, s39, 22528
    s_mov_b32 s38, 393216
    buffer_load_dwordx4 v185, s[20:23], s38 offen lds
    s_add_u32 m0, s39, 23552
    s_mov_b32 s38, 458752
    buffer_load_dwordx4 v185, s[20:23], s38 offen lds
    s_waitcnt vmcnt(28)
    ds_read_b64_tr_b16 a[112:113], v186 offset:26624
    ds_read_b64_tr_b16 a[114:115], v186 offset:26880
    ds_read_b64_tr_b16 a[120:121], v186 offset:26656
    ds_read_b64_tr_b16 a[122:123], v186 offset:26912
    s_waitcnt lgkmcnt(4)
    s_add_u32 m0, s39, 24576
    s_mov_b32 s38, 524288
    buffer_load_dwordx4 v185, s[20:23], s38 offen lds
    s_add_u32 m0, s39, 25600
    s_mov_b32 s38, 589824
    buffer_load_dwordx4 v185, s[20:23], s38 offen lds
    s_waitcnt vmcnt(28)
    ds_read_b64_tr_b16 a[128:129], v186 offset:28672
    ds_read_b64_tr_b16 a[130:131], v186 offset:28928
    ds_read_b64_tr_b16 a[136:137], v186 offset:28704
    ds_read_b64_tr_b16 a[138:139], v186 offset:28960
    s_waitcnt lgkmcnt(4)
    s_add_u32 m0, s39, 26624
    s_mov_b32 s38, 655360
    buffer_load_dwordx4 v185, s[20:23], s38 offen lds
    s_add_u32 m0, s39, 27648
    s_mov_b32 s38, 720896
    buffer_load_dwordx4 v185, s[20:23], s38 offen lds
    s_waitcnt vmcnt(28)
    ds_read_b64_tr_b16 a[100:101], v186 offset:30720
    ds_read_b64_tr_b16 a[102:103], v186 offset:30976
    ds_read_b64_tr_b16 a[108:109], v186 offset:30752
    ds_read_b64_tr_b16 a[110:111], v186 offset:31008
    s_waitcnt lgkmcnt(4)
    s_add_u32 m0, s39, 28672
    s_mov_b32 s38, 786432
    buffer_load_dwordx4 v185, s[20:23], s38 offen lds
    s_add_u32 m0, s39, 29696
    s_mov_b32 s38, 851968
    buffer_load_dwordx4 v185, s[20:23], s38 offen lds
    s_waitcnt vmcnt(28)
    ds_read_b64_tr_b16 a[116:117], v186 offset:0
    ds_read_b64_tr_b16 a[118:119], v186 offset:256
    ds_read_b64_tr_b16 a[124:125], v186 offset:32
    ds_read_b64_tr_b16 a[126:127], v186 offset:288
    s_waitcnt lgkmcnt(4)
    s_add_u32 m0, s39, 30720
    s_mov_b32 s38, 917504
    buffer_load_dwordx4 v185, s[20:23], s38 offen lds
    s_add_u32 m0, s39, 31744
    s_mov_b32 s38, 983040
    buffer_load_dwordx4 v185, s[20:23], s38 offen lds
    s_waitcnt vmcnt(28)
    ds_read_b64_tr_b16 a[132:133], v186 offset:2048
    ds_read_b64_tr_b16 a[134:135], v186 offset:2304
    ds_read_b64_tr_b16 a[140:141], v186 offset:2080
    ds_read_b64_tr_b16 a[142:143], v186 offset:2336
    s_waitcnt lgkmcnt(4)
    s_add_u32 m0, s39, 0
    s_mov_b32 s38, 1048576
    buffer_load_dwordx4 v185, s[20:23], s38 offen lds
    s_add_u32 m0, s39, 1024
    s_mov_b32 s38, 1114112
    buffer_load_dwordx4 v185, s[20:23], s38 offen lds
    s_waitcnt vmcnt(28)
    ds_read_b64_tr_b16 a[144:145], v186 offset:4096
    ds_read_b64_tr_b16 a[146:147], v186 offset:4352
    ds_read_b64_tr_b16 a[152:153], v186 offset:4128
    ds_read_b64_tr_b16 a[154:155], v186 offset:4384
    s_waitcnt lgkmcnt(4)
    s_add_u32 m0, s39, 2048
    s_mov_b32 s38, 1179648
    buffer_load_dwordx4 v185, s[20:23], s38 offen lds
    s_add_u32 m0, s39, 3072
    s_mov_b32 s38, 1245184
    buffer_load_dwordx4 v185, s[20:23], s38 offen lds
    s_waitcnt vmcnt(28)
    ds_read_b64_tr_b16 a[160:161], v186 offset:6144
    ds_read_b64_tr_b16 a[162:163], v186 offset:6400
    ds_read_b64_tr_b16 a[168:169], v186 offset:6176
    ds_read_b64_tr_b16 a[170:171], v186 offset:6432
    s_waitcnt lgkmcnt(4)
    s_add_u32 m0, s39, 4096
    s_mov_b32 s38, 1310720
    buffer_load_dwordx4 v185, s[20:23], s38 offen lds
    s_add_u32 m0, s39, 5120
    s_mov_b32 s38, 1376256
    buffer_load_dwordx4 v185, s[20:23], s38 offen lds
    s_waitcnt vmcnt(28)
    ds_read_b64_tr_b16 a[176:177], v186 offset:8192
    ds_read_b64_tr_b16 a[178:179], v186 offset:8448
    ds_read_b64_tr_b16 a[184:185], v186 offset:8224
    ds_read_b64_tr_b16 a[186:187], v186 offset:8480
    s_waitcnt lgkmcnt(4)
    s_add_u32 m0, s39, 6144
    s_mov_b32 s38, 1441792
    buffer_load_dwordx4 v185, s[20:23], s38 offen lds
    s_add_u32 m0, s39, 7168
    s_mov_b32 s38, 1507328
    buffer_load_dwordx4 v185, s[20:23], s38 offen lds
    s_waitcnt vmcnt(28)
    ds_read_b64_tr_b16 a[148:149], v186 offset:10240
    ds_read_b64_tr_b16 a[150:151], v186 offset:10496
    ds_read_b64_tr_b16 a[156:157], v186 offset:10272
    ds_read_b64_tr_b16 a[158:159], v186 offset:10528
    s_waitcnt lgkmcnt(4)
    s_add_u32 m0, s39, 8192
    s_mov_b32 s38, 1572864
    buffer_load_dwordx4 v185, s[20:23], s38 offen lds
    s_add_u32 m0, s39, 9216
    s_mov_b32 s38, 1638400
    buffer_load_dwordx4 v185, s[20:23], s38 offen lds
    s_waitcnt vmcnt(28)
    ds_read_b64_tr_b16 a[164:165], v186 offset:12288
    ds_read_b64_tr_b16 a[166:167], v186 offset:12544
    ds_read_b64_tr_b16 a[172:173], v186 offset:12320
    ds_read_b64_tr_b16 a[174:175], v186 offset:12576
    s_waitcnt lgkmcnt(4)
    s_add_u32 m0, s39, 10240
    s_mov_b32 s38, 1703936
    buffer_load_dwordx4 v185, s[20:23], s38 offen lds
    s_add_u32 m0, s39, 11264
    s_mov_b32 s38, 1769472
    buffer_load_dwordx4 v185, s[20:23], s38 offen lds
    s_waitcnt vmcnt(28)
    ds_read_b64_tr_b16 a[180:181], v186 offset:14336
    ds_read_b64_tr_b16 a[182:183], v186 offset:14592
    ds_read_b64_tr_b16 a[188:189], v186 offset:14368
    ds_read_b64_tr_b16 a[190:191], v186 offset:14624
    s_waitcnt lgkmcnt(4)
    s_add_u32 m0, s39, 12288
    s_mov_b32 s38, 1835008
    buffer_load_dwordx4 v185, s[20:23], s38 offen lds
    s_add_u32 m0, s39, 13312
    s_mov_b32 s38, 1900544
    buffer_load_dwordx4 v185, s[20:23], s38 offen lds
    s_waitcnt vmcnt(28)
    ds_read_b64_tr_b16 a[192:193], v187 offset:16384
    ds_read_b64_tr_b16 a[194:195], v187 offset:16512
    ds_read_b64_tr_b16 a[196:197], v187 offset:17408
    ds_read_b64_tr_b16 a[198:199], v187 offset:17536
    s_waitcnt lgkmcnt(4)
    s_add_u32 m0, s39, 14336
    s_mov_b32 s38, 1966080
    buffer_load_dwordx4 v185, s[20:23], s38 offen lds
    s_add_u32 m0, s39, 15360
    s_mov_b32 s38, 2031616
    buffer_load_dwordx4 v185, s[20:23], s38 offen lds
    s_waitcnt vmcnt(28)
    ds_read_b64_tr_b16 a[200:201], v187 offset:18432
    ds_read_b64_tr_b16 a[202:203], v187 offset:18560
    ds_read_b64_tr_b16 a[204:205], v187 offset:19456
    ds_read_b64_tr_b16 a[206:207], v187 offset:19584
    s_waitcnt vmcnt(26)
    ds_read_b64_tr_b16 a[208:209], v187 offset:20480
    ds_read_b64_tr_b16 a[210:211], v187 offset:20608
    ds_read_b64_tr_b16 a[212:213], v187 offset:21504
    ds_read_b64_tr_b16 a[214:215], v187 offset:21632
    s_waitcnt vmcnt(24)
    ds_read_b64_tr_b16 a[216:217], v187 offset:22528
    ds_read_b64_tr_b16 a[218:219], v187 offset:22656
    ds_read_b64_tr_b16 a[220:221], v187 offset:23552
    ds_read_b64_tr_b16 a[222:223], v187 offset:23680
    s_waitcnt vmcnt(22)
    ds_read_b64_tr_b16 a[224:225], v187 offset:24576
    ds_read_b64_tr_b16 a[226:227], v187 offset:24704
    ds_read_b64_tr_b16 a[228:229], v187 offset:25600
    ds_read_b64_tr_b16 a[230:231], v187 offset:25728
    s_waitcnt vmcnt(20)
    ds_read_b64_tr_b16 a[232:233], v187 offset:26624
    ds_read_b64_tr_b16 a[234:235], v187 offset:26752
    ds_read_b64_tr_b16 a[236:237], v187 offset:27648
    ds_read_b64_tr_b16 a[238:239], v187 offset:27776
    s_waitcnt vmcnt(18)
    ds_read_b64_tr_b16 a[240:241], v187 offset:28672
    ds_read_b64_tr_b16 a[242:243], v187 offset:28800
    ds_read_b64_tr_b16 a[244:245], v187 offset:29696
    ds_read_b64_tr_b16 a[246:247], v187 offset:29824
    s_waitcnt vmcnt(16)
    ds_read_b64_tr_b16 a[248:249], v187 offset:30720
    ds_read_b64_tr_b16 a[250:251], v187 offset:30848
    ds_read_b64_tr_b16 a[252:253], v187 offset:31744
    ds_read_b64_tr_b16 a[254:255], v187 offset:31872
    s_waitcnt vmcnt(14)
    ds_read_b64_tr_b16 v[192:193], v187 offset:0
    ds_read_b64_tr_b16 v[194:195], v187 offset:128
    ds_read_b64_tr_b16 v[196:197], v187 offset:1024
    ds_read_b64_tr_b16 v[198:199], v187 offset:1152
    s_waitcnt vmcnt(12)
    ds_read_b64_tr_b16 v[200:201], v187 offset:2048
    ds_read_b64_tr_b16 v[202:203], v187 offset:2176
    ds_read_b64_tr_b16 v[204:205], v187 offset:3072
    ds_read_b64_tr_b16 v[206:207], v187 offset:3200
    s_waitcnt vmcnt(10)
    ds_read_b64_tr_b16 v[208:209], v187 offset:4096
    ds_read_b64_tr_b16 v[210:211], v187 offset:4224
    ds_read_b64_tr_b16 v[212:213], v187 offset:5120
    ds_read_b64_tr_b16 v[214:215], v187 offset:5248
    s_waitcnt vmcnt(8)
    ds_read_b64_tr_b16 v[216:217], v187 offset:6144
    ds_read_b64_tr_b16 v[218:219], v187 offset:6272
    ds_read_b64_tr_b16 v[220:221], v187 offset:7168
    ds_read_b64_tr_b16 v[222:223], v187 offset:7296
    s_waitcnt vmcnt(6)
    ds_read_b64_tr_b16 v[224:225], v187 offset:8192
    ds_read_b64_tr_b16 v[226:227], v187 offset:8320
    ds_read_b64_tr_b16 v[228:229], v187 offset:9216
    ds_read_b64_tr_b16 v[230:231], v187 offset:9344
    s_waitcnt vmcnt(4)
    ds_read_b64_tr_b16 v[232:233], v187 offset:10240
    ds_read_b64_tr_b16 v[234:235], v187 offset:10368
    ds_read_b64_tr_b16 v[236:237], v187 offset:11264
    ds_read_b64_tr_b16 v[238:239], v187 offset:11392
    s_waitcnt vmcnt(2)
    ds_read_b64_tr_b16 v[240:241], v187 offset:12288
    ds_read_b64_tr_b16 v[242:243], v187 offset:12416
    ds_read_b64_tr_b16 v[244:245], v187 offset:13312
    ds_read_b64_tr_b16 v[246:247], v187 offset:13440
    s_waitcnt vmcnt(0)
    ds_read_b64_tr_b16 v[248:249], v187 offset:14336
    ds_read_b64_tr_b16 v[250:251], v187 offset:14464
    ds_read_b64_tr_b16 v[252:253], v187 offset:15360
    ds_read_b64_tr_b16 v[254:255], v187 offset:15488
    s_waitcnt lgkmcnt(0)
    v_bfe_u32 v2, v1, 2, 1
    v_mov_b32 v3, 0xaaaa
    v_mul_u32_u24 v2, v2, v3
    v_add_u32 v5, 0x4444, v2
    v_lshlrev_b32 v16, 4, v1
    s_lshr_b32 s38, s28, 6
    s_lshl_b32 s38, s38, 14
    s_and_b32 s40, s28, 63
    s_lshl_b32 s40, s40, 7
    s_add_u32 s38, s38, s40
    s_add_u32 s38, s38, 131072
    v_lshl_add_u32 v6, v1, 2, s38
    s_lshr_b32 s38, s31, 1
    s_lshl_b32 s38, s38, 14
    s_and_b32 s40, s31, 1
    s_lshl_b32 s40, s40, 12
    s_add_u32 s38, s38, s40
    s_add_u32 s38, s38, 131072
    v_add_u32 v7, s38, v16
    s_and_b32 s38, s28, 1
    s_lshl_b32 s38, s38, 16
    s_lshl_b32 s40, s31, 14
    s_add_u32 s38, s38, s40
    v_add_u32 v12, s38, v16
    v_add_u32 v13, 4096, v12
    v_lshrrev_b32 v2, 5, v1
    v_mul_u32_u24 v2, 640, v2
    v_and_b32 v3, 31, v1
    v_lshl_add_u32 v2, v3, 2, v2
    s_mul_i32 s38, s31, 2560
    v_add_u32 v14, s38, v2
    v_add_u32 v15, 1280, v14
    s_lshl_b32 s38, s31, 10
    s_add_u32 s38, s38, 10240
    v_add_u32 v17, s38, v16
    v_lshrrev_b32 v2, 5, v1
    v_lshlrev_b32 v2, 6, v2
    v_bfe_u32 v4, v1, 4, 1
    v_lshl_add_u32 v2, v4, 4, v2
    v_and_b32 v3, 15, v1
    v_mul_u32_u24 v3, 160, v3
    v_add_u32 v18, v2, v3
    s_lshl_b32 s38, s28, 11
    v_add_u32 v19, s38, v16
    v_bfe_u32 v20, v1, 4, 1
    v_lshlrev_b32 v20, 7, v20
    v_and_b32 v4, 7, v1
    v_lshl_add_u32 v20, v4, 4, v20
    v_add_u32 v20, s38, v20
    s_add_u32 s39, s30, 1
    s_and_b32 s38, s39, 3
    s_lshl_b32 s38, s38, 11
    s_lshl_b32 s40, s29, 13
    s_add_u32 s38, s38, s40
    v_add_u32 v22, s38, v16
    s_add_u32 s39, s30, 2
    s_and_b32 s38, s39, 3
    s_lshl_b32 s38, s38, 11
    s_lshl_b32 s40, s29, 13
    s_add_u32 s38, s38, s40
    v_add_u32 v23, s38, v16
    s_add_u32 s39, s30, 3
    s_and_b32 s38, s39, 3
    s_lshl_b32 s38, s38, 11
    s_lshl_b32 s40, s29, 13
    s_add_u32 s38, s38, s40
    v_add_u32 v24, s38, v16
    s_lshl_b32 s38, s29, 13
    v_lshrrev_b32 v21, 4, v1
    v_lshlrev_b32 v21, 11, v21
    v_and_b32 v4, 15, v1
    v_lshl_add_u32 v21, v4, 4, v21
    v_add_u32 v21, s38, v21
    v_bfe_u32 v25, v1, 3, 1
    v_lshlrev_b32 v25, 8, v25
    v_bfe_u32 v4, v1, 1, 1
    v_lshl_add_u32 v25, v4, 6, v25
    v_bfe_u32 v4, v1, 2, 1
    v_lshl_add_u32 v25, v4, 5, v25
    v_and_b32 v4, 1, v1
    v_lshl_add_u32 v25, v4, 4, v25
    v_lshrrev_b32 v4, 4, v1
    v_lshl_add_u32 v25, v4, 2, v25
    v_add_u32 v25, 10240, v25
    v_add_u32 v26, 128, v25
    s_lshl_b32 s38, s28, 11
    s_and_b32 s40, s31, 1
    s_lshl_b32 s40, s40, 7
    s_add_u32 s38, s38, s40
    s_add_u32 s38, s38, 16777216
    v_bfe_u32 v2, v1, 3, 1
    v_lshlrev_b32 v2, 8, v2
    v_and_b32 v4, 7, v1
    v_lshl_add_u32 v2, v4, 4, v2
    v_bfe_u32 v4, v1, 4, 1
    v_lshl_add_u32 v2, v4, 9, v2
    v_lshrrev_b32 v4, 5, v1
    v_lshl_add_u32 v2, v4, 10, v2
    v_add_u32 v2, s38, v2
    s_add_u32 s38, s38, 16777216
    v_bfe_u32 v3, v1, 3, 1
    v_lshlrev_b32 v3, 8, v3
    v_bfe_u32 v4, v1, 1, 1
    v_lshl_add_u32 v3, v4, 6, v3
    v_bfe_u32 v4, v1, 2, 1
    v_lshl_add_u32 v3, v4, 5, v3
    v_and_b32 v4, 1, v1
    v_lshl_add_u32 v3, v4, 4, v3
    v_bfe_u32 v4, v1, 4, 1
    v_lshl_add_u32 v3, v4, 9, v3
    v_lshrrev_b32 v4, 5, v1
    v_lshl_add_u32 v3, v4, 10, v3
    v_add_u32 v3, s38, v3
    s_cmp_lt_u32 s31, 2
    s_cselect_b64 vcc, -1, 0
    v_cndmask_b32 v30, v3, v2, vcc
    s_lshl_b32 s3, s31, 10
    s_lshr_b32 s38, s29, 3
    s_lshl_b32 s38, s38, 14
    s_and_b32 s40, s29, 7
    s_lshl_b32 s40, s40, 10
    s_add_u32 s38, s38, s40
    s_and_b32 s40, s30, 1
    s_lshl_b32 s40, s40, 9
    s_add_u32 s38, s38, s40
    s_lshr_b32 s40, s30, 1
    s_lshl_b32 s40, s40, 7
    s_add_u32 s38, s38, s40
    v_bfe_u32 v27, v1, 2, 1
    v_lshlrev_b32 v27, 16, v27
    v_lshrrev_b32 v4, 5, v1
    v_lshl_add_u32 v27, v4, 8, v27
    v_bfe_u32 v4, v1, 4, 1
    v_lshl_add_u32 v27, v4, 6, v27
    v_and_b32 v4, 3, v1
    v_lshl_add_u32 v27, v4, 4, v27
    v_add_u32 v27, s38, v27
    s_lshr_b32 s39, s31, 1
    s_lshl_b32 s39, s39, 16
    s_and_b32 s40, s31, 1
    s_lshl_b32 s40, s40, 8
    s_add_u32 s39, s39, s40
    s_add_u32 s39, s39, s38
    v_add_u32 v95, s39, v16
    v_cmp_gt_u32 vcc, 8, v1
    v_mov_b32 v4, 2130706432
    s_nop 0
    v_cndmask_b32 v95, v4, v95, vcc
    s_lshl_b32 s38, s31, 8
    s_add_u32 s38, s38, 14336
    v_lshl_add_u32 v28, v1, 2, s38
    v_and_b32 v29, 15, v1
    v_lshlrev_b32 v29, 4, v29
    v_bfe_u32 v4, v1, 4, 1
    v_lshl_add_u32 v29, v4, 3, v29
    v_add_u32 v29, 14336, v29
    s_mul_i32 s39, s31, 320
    s_lshl_b32 s38, s28, 11
    s_add_u32 s38, s38, s39
    v_add_u32 v94, s38, v16
    v_cmp_gt_u32 vcc, 20, v1
    v_mov_b32 v4, 2130706432
    s_nop 0
    v_cndmask_b32 v94, v4, v94, vcc
    s_mul_i32 s38, s31, 3
    v_min_u32 v2, 2, v1
    v_add_u32 v2, s38, v2
    v_min_u32 v2, 9, v2
    s_lshl_b32 s38, s28, 11
    s_add_u32 s38, s38, 262144
    v_lshl_add_u32 v92, v2, 7, s38
    s_lshl_b32 s38, s28, 9
    v_lshrrev_b32 v93, 4, v1
    v_lshlrev_b32 v93, 7, v93
    v_and_b32 v4, 7, v1
    v_lshl_add_u32 v93, v4, 4, v93
    v_add_u32 v93, s38, v93
    s_mov_b32 vcc_lo, 0xff00ff00
    s_mov_b32 vcc_hi, 0xff00ff00
    s_cmp_eq_u32 s31, 1
    s_cbranch_scc1 rec_ns_2
    s_add_u32 s38, s38, 4194304
    v_add_u32 v93, s38, v16
    s_mov_b32 vcc_lo, -1
    s_mov_b32 vcc_hi, 0
    s_cmp_eq_u32 s31, 2
    s_cbranch_scc1 rec_ns_2
    s_lshr_b32 s38, s28, 6
    s_lshl_b32 s38, s38, 14
    s_and_b32 s40, s28, 63
    s_lshl_b32 s40, s40, 7
    s_add_u32 s38, s38, s40
    s_add_u32 s38, s38, 131072
    v_add_u32 v93, s38, v16
    s_cmp_eq_u32 s31, 3
    s_cselect_b32 vcc_lo, 0xff, 0
rec_ns_2:
    s_nop 0
    v_mov_b32 v4, 2130706432
    v_cndmask_b32 v93, v4, v93, vcc
    v_mov_b32 v32, 0x3f803f80
    v_mov_b32 v33, 0x3f803f80
    v_mov_b32 v34, 0x3f803f80
    v_mov_b32 v35, 0x3f803f80
    v_mov_b32 v8, -1
    v_mov_b32 v9, -1
    v_mov_b32 v10, -1
    v_mov_b32 v11, -1
    v_mov_b32 v144, 0
    v_mov_b32 v145, 0
    v_mov_b32 v146, 0
    v_mov_b32 v147, 0
    v_mov_b32 v180, 0
    v_mov_b32 v181, 0
    v_mov_b32 v182, 0
    v_mov_b32 v183, 0
    v_mov_b32 v161, 0
    v_mov_b32 v162, 0
    v_mov_b32 v163, 0
    v_mov_b32 v138, 0
    v_mov_b32 v139, 0
    v_mov_b32 v140, 0
    v_mov_b32 v141, 0
    v_mov_b32 v142, 0
    v_mov_b32 v143, 0
    s_mov_b32 s42, 0x00ff00ff
    s_mov_b32 s43, 0x00ff00ff
    s_mov_b32 s44, 0
    s_mov_b32 s45, -1
    s_mov_b32 s46, 0
    s_mov_b32 s47, 0x00ff00ff
    s_mov_b32 s50, 0x3e0293ee
    s_mov_b32 s36, 96468992
    s_mov_b32 s37, 0
    s_mov_b32 s32, 0
    s_mov_b32 s51, 16384
    s_mov_b32 s54, 1
    s_add_u32 s38, s31, 1
    v_mov_b32 v134, s38
    s_mov_b32 s72, 0
    s_mov_b32 s73, 0
    s_mov_b32 s74, 0
    s_mov_b32 s75, 0
    s_mov_b32 s76, 0
    s_mov_b32 s77, 0
    s_mov_b32 s78, 0
    s_mov_b32 s79, 0
    s_mov_b32 s80, 0
    s_mov_b32 s81, 0
    s_mov_b32 s82, 0
    s_mov_b32 s83, 0
    s_mov_b32 s84, 0
    s_mov_b32 s85, 0
    s_mov_b32 s86, 0
    s_mov_b32 s87, 0
    s_lshl_b32 s95, s29, 7
    s_lshr_b32 s40, s31, 1
    s_lshl_b32 s40, s40, 2
    s_add_u32 s95, s95, s40
    s_add_u32 s95, s95, 115343364
    s_lshl_b32 s97, s29, 7
    s_add_u32 s97, s97, 115351552
    s_lshl_b32 s38, s30, 2
    s_add_u32 s38, s38, s97
    v_mov_b32 v188, s38
    s_cmp_eq_u32 s31, 2
    s_cselect_b64 vcc, 1, 0
    v_mov_b32 v4, 2130706432
    v_cndmask_b32 v188, v4, v188, vcc
    v_mov_b32 v189, 0
    s_mov_b32 s94, 0
    v_min_u32 v2, 8, v1
    v_lshlrev_b32 v2, 2, v2
rec_par_3:
    global_load_dword v3, v2, s[92:93] offset:64 sc1
    s_add_u32 s41, s41, 1
    s_cmp_ge_u32 s41, 0x80000
    s_cbranch_scc1 rec_pard_4
    s_waitcnt vmcnt(0)
    v_cmp_eq_u32 vcc, 0, v3
    s_cbranch_vccnz rec_par_3
rec_pard_4:
    v_cmp_eq_u32 vcc, 2, v3
    s_and_b32 s48, vcc_lo, 511
    s_and_b32 s33, s48, 1
    s_lshl_b32 s33, s33, 13
    s_add_u32 s33, s33, s49
    s_add_u32 s34, s33, 262144
    s_add_u32 s35, s33, 524288
    s_lshr_b32 s39, s28, 5
    v_subrev_u32 v2, s39, v1
    v_and_b32 v2, 3, v2
    v_mul_u32_u24 v2, 6, v2
    s_add_u32 s38, s28, 5
    v_add_u32 v2, s38, v2
    v_and_b32 v2, 31, v2
    v_lshlrev_b32 v2, 8, v2
    v_lshl_add_u32 v2, v1, 14, v2
    s_lshr_b32 s38, s28, 5
    s_lshl_b32 s38, s38, 4
    s_add_u32 s38, s38, s33
    s_add_u32 s38, s38, 163840
    v_add_u32 v132, s38, v2
    s_mov_b64 vcc, 15
    v_mov_b32 v4, 2130706432
    v_cndmask_b32 v132, v4, v132, vcc
    v_add_u32 v133, 128, v132
    s_cmp_eq_u32 s31, 1
    s_cselect_b64 vcc, 15, 0
    v_mov_b32 v4, 2130706432
    v_cndmask_b32 v133, v4, v133, vcc
    s_lshr_b32 s55, s28, 5
    s_lshl_b32 s55, s55, 14
    s_and_b32 s40, s28, 31
    s_lshl_b32 s40, s40, 8
    s_add_u32 s55, s55, s40
    s_add_u32 s55, s55, s33
    s_add_u32 s55, s55, 163840
    s_cmp_eq_u32 s31, 3
    s_cselect_b32 s88, s35, 88080384
    buffer_store_dwordx4 v[144:147], v95, s[4:7], s33 offen sc1
    buffer_store_dwordx4 v[144:147], v95, s[4:7], s34 offen sc1
    buffer_store_dwordx4 v[8:11], v94, s[4:7], s36 offen sc1
    v_add_u32 v94, 262144, v94
    buffer_store_dwordx4 v[8:11], v94, s[4:7], s36 offen sc1
    v_add_u32 v94, 262144, v94
    buffer_store_dword v189, v188, s[4:7], 0 offen sc1
    s_getreg_b32 s38, hwreg(HW_REG_XCC_ID)
    v_mov_b32 v2, s38
    buffer_store_dword v2, v188, s[4:7], 0 offen offset:16 sc1
    s_cmp_lg_u32 s31, 3
    s_cbranch_scc1 rec_i3_5
    buffer_store_dwordx4 v[144:147], v93, s[4:7], s34 offen sc1
    s_mov_b64 exec, 0xffff
    buffer_store_dwordx4 v[144:147], v16, s[4:7], s55 offen sc1
    s_add_u32 s38, s55, 262144
    buffer_store_dwordx4 v[144:147], v16, s[4:7], s38 offen sc1
    s_mov_b64 exec, -1
rec_i3_5:
    s_cmp_lg_u32 s31, 0
    s_cbranch_scc1 rec_i0_6
    v_bfe_u32 v2, v1, 2, 2
    v_lshlrev_b32 v2, 11, v2
    v_and_b32 v4, 3, v1
    v_lshl_add_u32 v2, v4, 3, v2
    v_bfe_u32 v4, v1, 4, 1
    v_lshl_add_u32 v2, v4, 2, v2
    s_and_b32 s38, s28, 1
    s_lshl_b32 s38, s38, 13
    s_lshr_b32 s40, s28, 1
    s_lshl_b32 s40, s40, 5
    s_add_u32 s38, s38, s40
    s_mov_b32 exec_hi, 0
    buffer_load_dword v3, v2, s[24:27], s38 offen
    s_waitcnt vmcnt(0)
    v_max_u32 v3, 1, v3
    buffer_store_dword v3, v6, s[4:7], s33 offen sc1
    s_mov_b64 exec, -1
rec_i0_6:
    s_waitcnt vmcnt(0)
    s_barrier
    s_cmp_lg_u32 s31, 0
    s_cbranch_scc1 rec_ib_7
    v_mov_b32 v2, 0
    v_mov_b32 v3, 1
    s_mov_b64 exec, 1
    global_atomic_add v2, v3, s[92:93] offset:0 sc1
rec_ibp_8:
    global_load_dword v3, v2, s[92:93] offset:0 sc1
    s_add_u32 s41, s41, 1
    s_cmp_ge_u32 s41, 0x80000
    s_cbranch_scc1 rec_ib_7
    s_waitcnt vmcnt(0)
    v_cmp_gt_u32 vcc, 256, v3
    s_cbranch_vccnz rec_ibp_8
rec_ib_7:
    s_mov_b64 exec, -1
    s_barrier
    s_load_dwordx4 s[72:75], s[90:91], s97 offset:16 glc
    s_waitcnt lgkmcnt(0)
    s_xor_b32 s73, s73, s72
    s_xor_b32 s74, s74, s72
    s_xor_b32 s75, s75, s72
    s_or_b32 s73, s73, s74
    s_or_b32 s96, s73, s75
    s_mov_b32 s72, 0
    s_mov_b32 s73, 0
    s_mov_b32 s74, 0
    s_mov_b32 s75, 0
    s_cmp_gt_u32 s94, 0
    s_cbranch_scc0 rec_kv_9
rec_kvd_10:
    s_add_u32 m0, s51, s3
    s_nop 0
    buffer_load_dwordx4 v30, s[4:7], s37 offen sc1 lds
rec_loop_11:
    buffer_load_dwordx4 v[36:39], v7, s[4:7], s33 offen offset:0 sc1
    v_mov_b32 v68, 0
    v_mov_b32 v69, 0
    v_mov_b32 v70, 0
    v_mov_b32 v71, 0
    v_mov_b32 v72, 0
    v_mov_b32 v73, 0
    buffer_load_dwordx4 v[40:43], v7, s[4:7], s33 offen offset:1024 sc1
    v_mov_b32 v74, 0
    v_mov_b32 v75, 0
    v_mov_b32 v76, 0
    v_mov_b32 v77, 0
    v_mov_b32 v78, 0
    v_mov_b32 v79, 0
    buffer_load_dwordx4 v[44:47], v7, s[4:7], s33 offen offset:2048 sc1
    v_mov_b32 v80, 0
    v_mov_b32 v81, 0
    v_mov_b32 v82, 0
    v_mov_b32 v83, 0
    v_mov_b32 v84, 0
    v_mov_b32 v85, 0
    buffer_load_dwordx4 v[48:51], v7, s[4:7], s33 offen offset:3072 sc1
    v_mov_b32 v86, 0
    v_mov_b32 v87, 0
    v_mov_b32 v88, 0
    v_mov_b32 v89, 0
    v_mov_b32 v90, 0
    v_mov_b32 v91, 0
    s_waitcnt vmcnt(3)
    buffer_store_dwordx4 v[8:11], v94, s[4:7], s36 offen sc1
    v_smfmac_f32_16x16x64_bf16 v[68:71], v[36:39], a[0:7], v5
    v_min3_u32 v31, v36, v37, v38
    v_min_u32 v31, v31, v39
    v_smfmac_f32_16x16x64_bf16 v[72:75], v[36:39], a[8:15], v5
    v_cmp_eq_u32 s[56:57], 0, v31
    v_smfmac_f32_16x16x64_bf16 v[76:79], v[36:39], a[16:23], v5
    v_smfmac_f32_16x16x64_bf16 v[80:83], v[36:39], a[24:31], v5
    s_waitcnt vmcnt(3)
    v_smfmac_f32_16x16x64_bf16 v[68:71], v[40:43], a[48:55], v5
    v_min3_u32 v31, v40, v41, v42
    v_min_u32 v31, v31, v43
    v_smfmac_f32_16x16x64_bf16 v[72:75], v[40:43], a[56:63], v5
    v_cmp_eq_u32 s[58:59], 0, v31
    s_mov_b64 vcc, s[56:57]
    v_smfmac_f32_16x16x64_bf16 v[76:79], v[40:43], a[64:71], v5
    v_smfmac_f32_16x16x64_bf16 v[80:83], v[40:43], a[72:79], v5
    s_waitcnt vmcnt(2)
    v_smfmac_f32_16x16x64_bf16 v[68:71], v[44:47], a[96:103], v5
    v_min3_u32 v31, v44, v45, v46
    v_min_u32 v31, v31, v47
    v_smfmac_f32_16x16x64_bf16 v[72:75], v[44:47], a[104:111], v5
    v_cmp_eq_u32 s[60:61], 0, v31
    s_or_b64 vcc, vcc, s[58:59]
    v_smfmac_f32_16x16x64_bf16 v[76:79], v[44:47], a[112:119], v5
    v_smfmac_f32_16x16x64_bf16 v[80:83], v[44:47], a[120:127], v5
    s_waitcnt vmcnt(1)
    v_smfmac_f32_16x16x64_bf16 v[68:71], v[48:51], a[144:151], v5
    v_min3_u32 v31, v48, v49, v50
    v_min_u32 v31, v31, v51
    v_smfmac_f32_16x16x64_bf16 v[72:75], v[48:51], a[152:159], v5
    v_cmp_eq_u32 s[62:63], 0, v31
    s_or_b64 vcc, vcc, s[60:61]
    v_smfmac_f32_16x16x64_bf16 v[76:79], v[48:51], a[160:167], v5
    v_smfmac_f32_16x16x64_bf16 v[80:83], v[48:51], a[168:175], v5
    s_or_b64 vcc, vcc, s[62:63]
    s_cbranch_scc1 rec_gafix_14
rec_gaok_13:
    v_add_u32 v2, s51, v16
    s_nop 0
    v_permlane16_swap_b32 v68, v72
    v_permlane16_swap_b32 v69, v73
    v_permlane16_swap_b32 v70, v74
    v_permlane16_swap_b32 v71, v75
    v_pk_add_f32 v[68:69], v[68:69], v[72:73]
    v_pk_add_f32 v[70:71], v[70:71], v[74:75]
    ds_write2_b32 v14, v68, v69 offset0:0 offset1:40
    ds_write2_b32 v14, v70, v71 offset0:80 offset1:120
    v_permlane16_swap_b32 v76, v80
    v_permlane16_swap_b32 v77, v81
    v_permlane16_swap_b32 v78, v82
    v_permlane16_swap_b32 v79, v83
    v_pk_add_f32 v[76:77], v[76:77], v[80:81]
    v_pk_add_f32 v[78:79], v[78:79], v[82:83]
    ds_write2_b32 v15, v76, v77 offset0:0 offset1:40
    ds_write2_b32 v15, v78, v79 offset0:80 offset1:120
    s_cmp_lg_u32 s31, 0
    s_cbranch_scc1 rec_w1_16
    s_waitcnt lgkmcnt(0)
    s_barrier
    ds_read_b128 v[100:103], v18 offset:0
    ds_read_b128 v[104:107], v18 offset:32
    ds_read_b128 v[108:111], v18 offset:2560
    ds_read_b128 v[112:115], v18 offset:2592
    ds_read_b128 v[116:119], v18 offset:5120
    ds_read_b128 v[120:123], v18 offset:5152
    ds_read_b128 v[124:127], v18 offset:7680
    ds_read_b128 v[128:131], v18 offset:7712
    ds_read_b128 v[60:63], v2 offset:0
    ds_read_b128 v[64:67], v2 offset:1024
    ds_read_b128 v[52:55], v2 offset:2048
    ds_read_b128 v[56:59], v2 offset:3072
    v_smfmac_f32_16x16x64_bf16 v[84:87], v[36:39], a[32:39], v5
    v_smfmac_f32_16x16x64_bf16 v[88:91], v[36:39], a[40:47], v5
    v_smfmac_f32_16x16x64_bf16 v[84:87], v[40:43], a[80:87], v5
    v_smfmac_f32_16x16x64_bf16 v[88:91], v[40:43], a[88:95], v5
    v_smfmac_f32_16x16x64_bf16 v[84:87], v[44:47], a[128:135], v5
    v_smfmac_f32_16x16x64_bf16 v[88:91], v[44:47], a[136:143], v5
    v_smfmac_f32_16x16x64_bf16 v[84:87], v[48:51], a[176:183], v5
    v_smfmac_f32_16x16x64_bf16 v[88:91], v[48:51], a[184:191], v5
    s_waitcnt lgkmcnt(2)
    v_pk_add_f32 v[100:101], v[100:101], v[108:109]
    v_pk_add_f32 v[102:103], v[102:103], v[110:111]
    v_pk_add_f32 v[104:105], v[104:105], v[112:113]
    v_pk_add_f32 v[106:107], v[106:107], v[114:115]
    v_pk_add_f32 v[116:117], v[116:117], v[124:125]
    v_pk_add_f32 v[118:119], v[118:119], v[126:127]
    v_pk_add_f32 v[120:121], v[120:121], v[128:129]
    v_pk_add_f32 v[122:123], v[122:123], v[130:131]
    v_pk_add_f32 v[100:101], v[100:101], v[116:117]
    v_pk_add_f32 v[102:103], v[102:103], v[118:119]
    v_pk_add_f32 v[104:105], v[104:105], v[120:121]
    v_pk_add_f32 v[106:107], v[106:107], v[122:123]
    v_cvt_pk_bf16_f32 v96, v100, v101
    v_cvt_pk_bf16_f32 v97, v102, v103
    v_cvt_pk_bf16_f32 v98, v104, v105
    v_cvt_pk_bf16_f32 v99, v106, v107
    s_nop 1
    v_mfma_f32_16x16x32_bf16 v[68:71], v[60:63], v[96:99], 0
    v_mfma_f32_16x16x32_bf16 v[72:75], v[64:67], v[96:99], 0
    v_mfma_f32_16x16x32_bf16 v[76:79], v[96:99], v[96:99], 0
    s_cmp_lg_u32 s96, 0
    v_permlane16_swap_b32 v84, v88
    v_permlane16_swap_b32 v85, v89
    v_permlane16_swap_b32 v86, v90
    v_permlane16_swap_b32 v87, v91
    v_pk_add_f32 v[84:85], v[84:85], v[88:89]
    v_pk_add_f32 v[86:87], v[86:87], v[90:91]
    s_cbranch_scc1 rec_slow_17
    s_mov_b64 exec, s[42:43]
    buffer_store_dwordx4 v[68:71], v19, s[4:7], s36 offen
    buffer_store_dwordx4 v[72:75], v19, s[4:7], s36 offen offset:128
    s_mov_b64 exec, s[46:47]
    buffer_store_dwordx4 v[76:79], v20, s[4:7], s36 offen offset:1024
    s_mov_b64 exec, -1
rec_slowr_18:
    ds_write_b128 v17, v[84:87]
    ds_write_b128 v16, v[96:99] offset:15360
    s_waitcnt lgkmcnt(0)
    s_barrier
    ds_read2st64_b32 v[100:101], v25 offset0:0 offset1:2
    ds_read2st64_b32 v[102:103], v26 offset0:0 offset1:2
    ds_read2st64_b32 v[104:105], v25 offset0:4 offset1:6
    ds_read2st64_b32 v[106:107], v26 offset0:4 offset1:6
    ds_read2st64_b32 v[108:109], v25 offset0:8 offset1:10
    ds_read2st64_b32 v[110:111], v26 offset0:8 offset1:10
    ds_read2st64_b32 v[112:113], v25 offset0:12 offset1:14
    ds_read2st64_b32 v[114:115], v26 offset0:12 offset1:14
    s_sleep 1
    buffer_load_dwordx4 v[176:179], v21, s[4:7], s36 offen offset:1024 sc1
    buffer_load_dwordx4 v[164:167], v22, s[4:7], s36 offen sc1
    buffer_load_dwordx4 v[168:171], v23, s[4:7], s36 offen sc1
    buffer_load_dwordx4 v[172:175], v24, s[4:7], s36 offen sc1
    v_mov_b32_dpp v68, v72 row_ror:8 row_mask:0xf bank_mask:0xc
    v_mov_b32_dpp v69, v73 row_ror:8 row_mask:0xf bank_mask:0xc
    v_mov_b32_dpp v70, v74 row_ror:8 row_mask:0xf bank_mask:0xc
    v_mov_b32_dpp v71, v75 row_ror:8 row_mask:0xf bank_mask:0xc
    s_waitcnt lgkmcnt(0)
    v_pk_add_f32 v[100:101], v[100:101], v[104:105]
    v_pk_add_f32 v[102:103], v[102:103], v[106:107]
    v_pk_add_f32 v[108:109], v[108:109], v[112:113]
    v_pk_add_f32 v[110:111], v[110:111], v[114:115]
    v_pk_add_f32 v[100:101], v[100:101], v[108:109]
    v_pk_add_f32 v[102:103], v[102:103], v[110:111]
    v_cvt_pk_bf16_f32 v138, v100, v101
    v_cvt_pk_bf16_f32 v140, v102, v103
    s_cmp_eq_u32 s32, 63
    s_cbranch_scc1 rec_b2_15
rec_gbw_21:
    s_waitcnt vmcnt(3)
    v_max3_u32 v31, v176, v177, v178
    v_max_u32 v31, v31, v179
    v_permlane32_swap_b32 v176, v178
    v_permlane32_swap_b32 v177, v179
    v_pk_add_f32 v[124:125], v[176:177], v[178:179]
    s_waitcnt vmcnt(2)
    v_pk_add_f32 v[120:121], v[68:69], v[164:165]
    v_pk_add_f32 v[122:123], v[70:71], v[166:167]
    v_permlane16_swap_b32 v124, v125
    s_waitcnt vmcnt(1)
    v_pk_add_f32 v[120:121], v[120:121], v[168:169]
    v_pk_add_f32 v[122:123], v[122:123], v[170:171]
    v_add_f32 v124, v124, v125
    s_waitcnt vmcnt(0)
    v_pk_add_f32 v[120:121], v[120:121], v[172:173]
    v_pk_add_f32 v[122:123], v[122:123], v[174:175]
    v_maximum3_f32 v135, v120, v121, v124
    v_maximum3_f32 v135, v135, v122, v123
    v_cmp_u_f32 vcc, v135, v135
    s_nop 0
    v_max_f32_dpp v135, v135, v135 row_ror:8 row_mask:0xf bank_mask:0xf
    v_mov_b32 v136, v135
    s_cbranch_vccnz rec_gbr_19
rec_gbo_20:
    buffer_store_dword v134, v132, s[4:7], 0 offen sc1
    v_permlane16_swap_b32 v135, v136
    v_max_f32 v135, v135, v136
    v_mov_b32 v136, v135
    s_nop 1
    v_permlane32_swap_b32 v135, v136
    v_max_f32 v135, v135, v136
    v_mul_f32 v135, s50, v135
    v_fma_f32 v124, v124, s50, -v135
    v_fma_f32 v120, v120, s50, -v135
    v_fma_f32 v121, v121, s50, -v135
    v_fma_f32 v122, v122, s50, -v135
    v_fma_f32 v123, v123, s50, -v135
    v_exp_f32 v124, v124
    v_exp_f32 v120, v120
    v_exp_f32 v121, v121
    v_exp_f32 v122, v122
    v_exp_f32 v123, v123
    v_mov_b32_dpp v125, v124 row_ror:8 row_mask:0xf bank_mask:0xf
    v_cvt_pk_bf16_f32 v156, v120, v121
    v_cvt_pk_bf16_f32 v157, v122, v123
    v_cvt_pk_bf16_f32 v160, v124, v125
    v_mov_b32_dpp v158, v156 row_ror:8 row_mask:0xf bank_mask:0xf
    v_mov_b32_dpp v159, v157 row_ror:8 row_mask:0xf bank_mask:0xf
    v_mfma_f32_16x16x32_bf16 v[116:119], v[32:35], v[160:163], 0
    s_nop 0
    v_mfma_f32_16x16x32_bf16 v[116:119], v[32:35], v[156:159], v[116:119]
    v_mfma_f32_16x16x32_bf16 v[108:111], v[52:55], v[156:159], 0
    v_mfma_f32_16x16x32_bf16 v[108:111], v[138:141], v[160:163], v[108:111]
    v_mfma_f32_16x16x32_bf16 v[112:115], v[56:59], v[156:159], 0
    v_mfma_f32_16x16x32_bf16 v[112:115], v[140:143], v[160:163], v[112:115]
    s_nop 3
    v_rcp_f32 v135, v116
    s_nop 0
    v_mul_f32 v108, v108, v135
    v_mul_f32 v109, v109, v135
    v_mul_f32 v110, v110, v135
    v_mul_f32 v111, v111, v135
    v_mul_f32 v112, v112, v135
    v_mul_f32 v113, v113, v135
    v_mul_f32 v114, v114, v135
    v_mul_f32 v115, v115, v135
    v_cvt_pk_bf16_f32 v108, v108, v109
    v_cvt_pk_bf16_f32 v109, v110, v111
    v_cvt_pk_bf16_f32 v110, v112, v113
    v_cvt_pk_bf16_f32 v111, v114, v115
    v_max_u32 v108, 1, v108
    v_max_u32 v109, 1, v109
    v_max_u32 v110, 1, v110
    v_max_u32 v111, 1, v111
    s_mov_b64 exec, s[42:43]
    buffer_store_dwordx4 v[108:111], v27, s[4:7], s33 offen sc1
    s_mov_b64 exec, -1
    s_barrier
rec_cs_22:
    buffer_load_dwordx4 v[36:39], v12, s[4:7], s33 offen offset:0 sc1
    v_mov_b32 v68, 0
    buffer_load_dwordx4 v[40:43], v12, s[4:7], s33 offen offset:1024 sc1
    v_mov_b32 v69, 0
    buffer_load_dwordx4 v[44:47], v12, s[4:7], s33 offen offset:2048 sc1
    v_mov_b32 v70, 0
    buffer_load_dwordx4 v[48:51], v12, s[4:7], s33 offen offset:3072 sc1
    v_mov_b32 v71, 0
    buffer_load_dwordx4 v[52:55], v13, s[4:7], s33 offen offset:0 sc1
    v_mov_b32 v72, 0
    buffer_load_dwordx4 v[56:59], v13, s[4:7], s33 offen offset:1024 sc1
    v_mov_b32 v73, 0
    buffer_load_dwordx4 v[60:63], v13, s[4:7], s33 offen offset:2048 sc1
    v_mov_b32 v74, 0
    buffer_load_dwordx4 v[64:67], v13, s[4:7], s33 offen offset:3072 sc1
    v_mov_b32 v75, 0
    s_waitcnt vmcnt(7)
    buffer_store_dwordx4 v[180:183], v93, s[4:7], s88 offen sc1
    buffer_store_dwordx4 v[144:147], v95, s[4:7], s35 offen sc1
    buffer_load_dword v3, v92, s[4:7], s36 offen sc1
    s_add_u32 s38, s32, 1
    s_cmp_gt_u32 s94, s38
    s_cbranch_scc0 rec_kv_25
rec_kvd_26:
    s_xor_b32 s51, s51, 4096
    s_add_u32 m0, s51, s3
    s_add_u32 s37, s37, 262144
    buffer_load_dwordx4 v30, s[4:7], s37 offen sc1 lds
    v_smfmac_f32_16x16x64_bf16 v[68:71], v[36:39], a[192:199], v5
    v_min3_u32 v31, v36, v37, v38
    v_min_u32 v31, v31, v39
    v_smfmac_f32_16x16x64_bf16 v[72:75], v[36:39], a[200:207], v5
    v_cmp_eq_u32 s[56:57], 0, v31
    s_waitcnt vmcnt(10)
    v_smfmac_f32_16x16x64_bf16 v[68:71], v[40:43], a[208:215], v5
    v_min3_u32 v31, v40, v41, v42
    v_min_u32 v31, v31, v43
    v_smfmac_f32_16x16x64_bf16 v[72:75], v[40:43], a[216:223], v5
    v_cmp_eq_u32 s[58:59], 0, v31
    s_mov_b64 vcc, s[56:57]
    s_waitcnt vmcnt(9)
    v_smfmac_f32_16x16x64_bf16 v[68:71], v[44:47], a[224:231], v5
    v_min3_u32 v31, v44, v45, v46
    v_min_u32 v31, v31, v47
    v_smfmac_f32_16x16x64_bf16 v[72:75], v[44:47], a[232:239], v5
    v_cmp_eq_u32 s[60:61], 0, v31
    s_or_b64 vcc, vcc, s[58:59]
    s_waitcnt vmcnt(8)
    v_smfmac_f32_16x16x64_bf16 v[68:71], v[48:51], a[240:247], v5
    v_min3_u32 v31, v48, v49, v50
    v_min_u32 v31, v31, v51
    v_smfmac_f32_16x16x64_bf16 v[72:75], v[48:51], a[248:255], v5
    v_cmp_eq_u32 s[62:63], 0, v31
    s_or_b64 vcc, vcc, s[60:61]
    s_waitcnt vmcnt(7)
    v_smfmac_f32_16x16x64_bf16 v[68:71], v[52:55], v[192:199], v5
    v_min3_u32 v31, v52, v53, v54
    v_min_u32 v31, v31, v55
    v_smfmac_f32_16x16x64_bf16 v[72:75], v[52:55], v[200:207], v5
    v_cmp_eq_u32 s[64:65], 0, v31
    s_or_b64 vcc, vcc, s[62:63]
    s_waitcnt vmcnt(6)
    v_smfmac_f32_16x16x64_bf16 v[68:71], v[56:59], v[208:215], v5
    v_min3_u32 v31, v56, v57, v58
    v_min_u32 v31, v31, v59
    v_smfmac_f32_16x16x64_bf16 v[72:75], v[56:59], v[216:223], v5
    v_cmp_eq_u32 s[66:67], 0, v31
    s_or_b64 vcc, vcc, s[64:65]
    s_waitcnt vmcnt(5)
    v_smfmac_f32_16x16x64_bf16 v[68:71], v[60:63], v[224:231], v5
    v_min3_u32 v31, v60, v61, v62
    v_min_u32 v31, v31, v63
    v_smfmac_f32_16x16x64_bf16 v[72:75], v[60:63], v[232:239], v5
    v_cmp_eq_u32 s[68:69], 0, v31
    s_or_b64 vcc, vcc, s[66:67]
    s_waitcnt vmcnt(4)
    v_smfmac_f32_16x16x64_bf16 v[68:71], v[64:67], v[240:247], v5
    v_min3_u32 v31, v64, v65, v66
    v_min_u32 v31, v31, v67
    v_smfmac_f32_16x16x64_bf16 v[72:75], v[64:67], v[248:255], v5
    v_cmp_eq_u32 s[70:71], 0, v31
    s_or_b64 vcc, vcc, s[68:69]
    s_or_b64 vcc, vcc, s[70:71]
    s_cbranch_scc1 rec_gcfix_24
rec_gcok_23:
    s_add_u32 s32, s32, 1
    s_mov_b32 s33, s34
    s_mov_b32 s34, s35
    s_add_u32 s38, s32, 2
    s_lshr_b32 s39, s38, 3
    s_lshr_b32 s39, s48, s39
    v_cndmask_b32 v68, v68, v72, s[44:45]
    v_cndmask_b32 v69, v69, v73, s[44:45]
    v_cndmask_b32 v70, v70, v74, s[44:45]
    v_cndmask_b32 v71, v71, v75, s[44:45]
    s_nop 0
    v_permlane32_swap_b32 v68, v70
    v_permlane32_swap_b32 v69, v71
    v_pk_add_f32 v[68:69], v[68:69], v[70:71]
    s_nop 1
    v_permlane16_swap_b32 v68, v69
    v_add_f32 v68, v68, v69
    ds_write_b32 v28, v68
    s_and_b32 s35, s39, 1
    s_lshl_b32 s35, s35, 13
    s_lshl_b32 s40, s38, 18
    s_add_u32 s35, s35, s40
    s_add_u32 s35, s35, s49
    s_add_u32 s36, s36, 262144
    s_add_u32 s88, s88, 65536
    s_cmp_eq_u32 s31, 3
    s_cselect_b32 s88, s35, s88
    s_cmp_lg_u32 s31, 0
    s_cbranch_scc1 rec_b4_27
    s_waitcnt lgkmcnt(0)
    s_barrier
    ds_read_b64 v[100:101], v29 offset:0
    ds_read_b64 v[102:103], v29 offset:256
    ds_read_b64 v[104:105], v29 offset:512
    ds_read_b64 v[106:107], v29 offset:768
    v_add_u32 v134, 2, v134
    s_waitcnt lgkmcnt(0)
    v_pk_add_f32 v[100:101], v[100:101], v[102:103]
    v_pk_add_f32 v[104:105], v[104:105], v[106:107]
    v_pk_add_f32 v[100:101], v[100:101], v[104:105]
    v_cvt_pk_bf16_f32 v100, v100, v101
    v_max_u32 v100, 1, v100
    s_nop 1
    v_mov_b32_dpp v101, v100 quad_perm:[1,1,1,1] row_mask:0xf bank_mask:0xf
    v_mov_b32_dpp v102, v100 quad_perm:[2,2,2,2] row_mask:0xf bank_mask:0xf
    v_mov_b32_dpp v103, v100 quad_perm:[3,3,3,3] row_mask:0xf bank_mask:0xf
    s_mov_b64 exec, 0x11111111
    buffer_store_dwordx4 v[100:103], v6, s[4:7], s33 offen sc1
    s_mov_b64 exec, -1
    s_barrier
    s_branch rec_loop_11
rec_b4_27:
    s_waitcnt vmcnt(3) lgkmcnt(0)
    s_barrier
    buffer_store_dword v134, v133, s[4:7], 0 offen sc1
    v_add_u32 v189, 1, v189
    buffer_store_dword v189, v188, s[4:7], 0 offen sc1
    v_add_u32 v134, 2, v134
    s_cmp_lg_u32 s31, 3
    s_cbranch_scc1 rec_b4b_28
    s_add_u32 s40, s55, 128
rec_tk_29:
    s_load_dwordx16 s[72:87], s[90:91], s40 glc
    s_add_u32 s41, s41, 1
    s_cmp_ge_u32 s41, 0x80000
    s_cbranch_scc1 rec_tkd_30
    s_sleep 1
    s_min_u32 s38, s72, s76
    s_min_u32 s39, s80, s84
    s_min_u32 s38, s38, s39
    s_cmp_lt_u32 s38, s54
    s_cbranch_scc1 rec_tk_29
rec_tkd_30:
    s_add_u32 s54, s54, 1
rec_b4b_28:
    s_barrier
    s_branch rec_loop_11
rec_kv_9:
    s_load_dword s94, s[90:91], s95 glc
    s_add_u32 s41, s41, 1
    s_cmp_ge_u32 s41, 0x80000
    s_cbranch_scc1 rec_kvd_10
    s_waitcnt lgkmcnt(0)
    s_cmp_gt_u32 s94, 0
    s_cbranch_scc1 rec_kvd_10
    s_sleep 2
    s_branch rec_kv_9
rec_gafix_14:
    s_cmp_eq_u64 s[56:57], 0
    s_cbranch_scc1 rec_gask_31
    buffer_load_dwordx4 v[100:103], v7, s[4:7], s33 offen offset:0 sc1
rec_gask_31:
    s_cmp_eq_u64 s[58:59], 0
    s_cbranch_scc1 rec_gask_32
    buffer_load_dwordx4 v[104:107], v7, s[4:7], s33 offen offset:1024 sc1
rec_gask_32:
    s_cmp_eq_u64 s[60:61], 0
    s_cbranch_scc1 rec_gask_33
    buffer_load_dwordx4 v[108:111], v7, s[4:7], s33 offen offset:2048 sc1
rec_gask_33:
    s_cmp_eq_u64 s[62:63], 0
    s_cbranch_scc1 rec_gask_34
    buffer_load_dwordx4 v[112:115], v7, s[4:7], s33 offen offset:3072 sc1
rec_gask_34:
rec_galp_35:
    s_add_u32 s41, s41, 1
    s_cmp_ge_u32 s41, 0x80000
    s_cbranch_scc1 rec_gaok_13
    s_mov_b64 vcc, 0
    s_waitcnt vmcnt(0)
    s_cmp_eq_u64 s[56:57], 0
    s_cbranch_scc1 rec_gask_36
    v_min3_u32 v31, v100, v101, v102
    v_min_u32 v31, v31, v103
    v_cmp_eq_u32 s[56:57], 0, v31
    v_xor_b32 v36, v36, v100
    v_xor_b32 v37, v37, v101
    v_xor_b32 v38, v38, v102
    v_xor_b32 v39, v39, v103
    s_nop 1
    v_smfmac_f32_16x16x64_bf16 v[68:71], v[36:39], a[0:7], v5
    v_smfmac_f32_16x16x64_bf16 v[72:75], v[36:39], a[8:15], v5
    v_smfmac_f32_16x16x64_bf16 v[76:79], v[36:39], a[16:23], v5
    v_smfmac_f32_16x16x64_bf16 v[80:83], v[36:39], a[24:31], v5
    v_mov_b32 v36, v100
    v_mov_b32 v37, v101
    v_mov_b32 v38, v102
    v_mov_b32 v39, v103
    s_or_b64 vcc, vcc, s[56:57]
    s_cmp_eq_u64 s[56:57], 0
    s_cbranch_scc1 rec_gask_36
    buffer_load_dwordx4 v[100:103], v7, s[4:7], s33 offen offset:0 sc1
rec_gask_36:
    s_cmp_eq_u64 s[58:59], 0
    s_cbranch_scc1 rec_gask_37
    v_min3_u32 v31, v104, v105, v106
    v_min_u32 v31, v31, v107
    v_cmp_eq_u32 s[58:59], 0, v31
    v_xor_b32 v40, v40, v104
    v_xor_b32 v41, v41, v105
    v_xor_b32 v42, v42, v106
    v_xor_b32 v43, v43, v107
    s_nop 1
    v_smfmac_f32_16x16x64_bf16 v[68:71], v[40:43], a[48:55], v5
    v_smfmac_f32_16x16x64_bf16 v[72:75], v[40:43], a[56:63], v5
    v_smfmac_f32_16x16x64_bf16 v[76:79], v[40:43], a[64:71], v5
    v_smfmac_f32_16x16x64_bf16 v[80:83], v[40:43], a[72:79], v5
    v_mov_b32 v40, v104
    v_mov_b32 v41, v105
    v_mov_b32 v42, v106
    v_mov_b32 v43, v107
    s_or_b64 vcc, vcc, s[58:59]
    s_cmp_eq_u64 s[58:59], 0
    s_cbranch_scc1 rec_gask_37
    buffer_load_dwordx4 v[104:107], v7, s[4:7], s33 offen offset:1024 sc1
rec_gask_37:
    s_cmp_eq_u64 s[60:61], 0
    s_cbranch_scc1 rec_gask_38
    v_min3_u32 v31, v108, v109, v110
    v_min_u32 v31, v31, v111
    v_cmp_eq_u32 s[60:61], 0, v31
    v_xor_b32 v44, v44, v108
    v_xor_b32 v45, v45, v109
    v_xor_b32 v46, v46, v110
    v_xor_b32 v47, v47, v111
    s_nop 1
    v_smfmac_f32_16x16x64_bf16 v[68:71], v[44:47], a[96:103], v5
    v_smfmac_f32_16x16x64_bf16 v[72:75], v[44:47], a[104:111], v5
    v_smfmac_f32_16x16x64_bf16 v[76:79], v[44:47], a[112:119], v5
    v_smfmac_f32_16x16x64_bf16 v[80:83], v[44:47], a[120:127], v5
    v_mov_b32 v44, v108
    v_mov_b32 v45, v109
    v_mov_b32 v46, v110
    v_mov_b32 v47, v111
    s_or_b64 vcc, vcc, s[60:61]
    s_cmp_eq_u64 s[60:61], 0
    s_cbranch_scc1 rec_gask_38
    buffer_load_dwordx4 v[108:111], v7, s[4:7], s33 offen offset:2048 sc1
rec_gask_38:
    s_cmp_eq_u64 s[62:63], 0
    s_cbranch_scc1 rec_gask_39
    v_min3_u32 v31, v112, v113, v114
    v_min_u32 v31, v31, v115
    v_cmp_eq_u32 s[62:63], 0, v31
    v_xor_b32 v48, v48, v112
    v_xor_b32 v49, v49, v113
    v_xor_b32 v50, v50, v114
    v_xor_b32 v51, v51, v115
    s_nop 1
    v_smfmac_f32_16x16x64_bf16 v[68:71], v[48:51], a[144:151], v5
    v_smfmac_f32_16x16x64_bf16 v[72:75], v[48:51], a[152:159], v5
    v_smfmac_f32_16x16x64_bf16 v[76:79], v[48:51], a[160:167], v5
    v_smfmac_f32_16x16x64_bf16 v[80:83], v[48:51], a[168:175], v5
    v_mov_b32 v48, v112
    v_mov_b32 v49, v113
    v_mov_b32 v50, v114
    v_mov_b32 v51, v115
    s_or_b64 vcc, vcc, s[62:63]
    s_cmp_eq_u64 s[62:63], 0
    s_cbranch_scc1 rec_gask_39
    buffer_load_dwordx4 v[112:115], v7, s[4:7], s33 offen offset:3072 sc1
rec_gask_39:
    s_cmp_eq_u64 vcc, 0
    s_cbranch_scc1 rec_gaok_13
    s_branch rec_galp_35
rec_slow_17:
    s_mov_b64 exec, s[42:43]
    buffer_store_dwordx4 v[68:71], v19, s[4:7], s36 offen sc1
    buffer_store_dwordx4 v[72:75], v19, s[4:7], s36 offen offset:128 sc1
    s_mov_b64 exec, s[46:47]
    buffer_store_dwordx4 v[76:79], v20, s[4:7], s36 offen offset:1024 sc1
    s_mov_b64 exec, -1
    s_branch rec_slowr_18
rec_gbr_19:
    v_max3_u32 v31, v31, v164, v165
    v_max3_u32 v31, v31, v166, v167
    v_max3_u32 v31, v31, v168, v169
    v_max3_u32 v31, v31, v170, v171
    v_max3_u32 v31, v31, v172, v173
    v_max3_u32 v31, v31, v174, v175
    buffer_load_dwordx4 v[176:179], v21, s[4:7], s36 offen offset:1024 sc1
    buffer_load_dwordx4 v[164:167], v22, s[4:7], s36 offen sc1
    buffer_load_dwordx4 v[168:171], v23, s[4:7], s36 offen sc1
    buffer_load_dwordx4 v[172:175], v24, s[4:7], s36 offen sc1
    v_cmp_eq_u32 vcc, -1, v31
    s_add_u32 s41, s41, 1
    s_cmp_ge_u32 s41, 0x80000
    s_cbranch_scc1 rec_gbo_20
    s_cbranch_vccnz rec_gbw_21
    s_waitcnt vmcnt(0)
    s_branch rec_gbo_20
rec_w1_16:
    s_waitcnt lgkmcnt(0)
    s_barrier
    v_smfmac_f32_16x16x64_bf16 v[84:87], v[36:39], a[32:39], v5
    v_smfmac_f32_16x16x64_bf16 v[88:91], v[36:39], a[40:47], v5
    v_smfmac_f32_16x16x64_bf16 v[84:87], v[40:43], a[80:87], v5
    v_smfmac_f32_16x16x64_bf16 v[88:91], v[40:43], a[88:95], v5
    v_smfmac_f32_16x16x64_bf16 v[84:87], v[44:47], a[128:135], v5
    v_smfmac_f32_16x16x64_bf16 v[88:91], v[44:47], a[136:143], v5
    v_smfmac_f32_16x16x64_bf16 v[84:87], v[48:51], a[176:183], v5
    v_smfmac_f32_16x16x64_bf16 v[88:91], v[48:51], a[184:191], v5
    s_nop 7
    v_permlane16_swap_b32 v84, v88
    v_permlane16_swap_b32 v85, v89
    v_permlane16_swap_b32 v86, v90
    v_permlane16_swap_b32 v87, v91
    v_pk_add_f32 v[84:85], v[84:85], v[88:89]
    v_pk_add_f32 v[86:87], v[86:87], v[90:91]
    ds_write_b128 v17, v[84:87]
    s_waitcnt lgkmcnt(0)
    s_barrier
    s_cmp_eq_u32 s31, 3
    s_cbranch_scc1 rec_w3_41
    s_cmp_eq_u32 s31, 2
    s_cbranch_scc1 rec_w2_40
    ds_read_b128 v[180:183], v16 offset:15360
    s_branch rec_b2_15
rec_w2_40:
    ds_read_b128 v[100:103], v16 offset:10240
    ds_read_b128 v[104:107], v16 offset:11264
    ds_read_b128 v[108:111], v16 offset:12288
    ds_read_b128 v[112:115], v16 offset:13312
    s_waitcnt lgkmcnt(0)
    v_pk_add_f32 v[100:101], v[100:101], v[104:105]
    v_pk_add_f32 v[102:103], v[102:103], v[106:107]
    v_pk_add_f32 v[108:109], v[108:109], v[112:113]
    v_pk_add_f32 v[110:111], v[110:111], v[114:115]
    v_pk_add_f32 v[100:101], v[100:101], v[108:109]
    v_pk_add_f32 v[102:103], v[102:103], v[110:111]
    v_cvt_pk_bf16_f32 v180, v100, v101
    v_cvt_pk_bf16_f32 v181, v102, v103
    s_nop 0
    v_permlane32_swap_b32 v180, v182
    v_permlane32_swap_b32 v181, v183
rec_b2_15:
    s_waitcnt lgkmcnt(0)
    s_cmp_eq_u32 s32, 63
    s_cbranch_scc1 rec_done_12
    s_barrier
    s_branch rec_cs_22
rec_w3_41:
    s_cmp_eq_u32 s32, 63
    s_cbranch_scc1 rec_done_12
rec_tk_42:
    s_load_dwordx16 s[72:87], s[90:91], s55 glc
    s_add_u32 s41, s41, 1
    s_cmp_ge_u32 s41, 0x80000
    s_cbranch_scc1 rec_tkd_43
    s_sleep 1
    s_min_u32 s38, s72, s76
    s_min_u32 s39, s80, s84
    s_min_u32 s38, s38, s39
    s_cmp_lt_u32 s38, s54
    s_cbranch_scc1 rec_tk_42
rec_tkd_43:
    s_add_u32 s54, s54, 1
    s_barrier
    s_branch rec_cs_22
rec_kv_25:
    s_load_dword s94, s[90:91], s95 glc
    s_add_u32 s41, s41, 1
    s_cmp_ge_u32 s41, 0x80000
    s_cbranch_scc1 rec_kvd_26
    s_waitcnt lgkmcnt(0)
    s_cmp_gt_u32 s94, s38
    s_cbranch_scc1 rec_kvd_26
    s_sleep 2
    s_branch rec_kv_25
rec_gcfix_24:
    s_cmp_eq_u64 s[56:57], 0
    s_cbranch_scc1 rec_gcsk_44
    buffer_load_dwordx4 v[100:103], v12, s[4:7], s33 offen offset:0 sc1
rec_gcsk_44:
    s_cmp_eq_u64 s[58:59], 0
    s_cbranch_scc1 rec_gcsk_45
    buffer_load_dwordx4 v[104:107], v12, s[4:7], s33 offen offset:1024 sc1
rec_gcsk_45:
    s_cmp_eq_u64 s[60:61], 0
    s_cbranch_scc1 rec_gcsk_46
    buffer_load_dwordx4 v[108:111], v12, s[4:7], s33 offen offset:2048 sc1
rec_gcsk_46:
    s_cmp_eq_u64 s[62:63], 0
    s_cbranch_scc1 rec_gcsk_47
    buffer_load_dwordx4 v[112:115], v12, s[4:7], s33 offen offset:3072 sc1
rec_gcsk_47:
    s_cmp_eq_u64 s[64:65], 0
    s_cbranch_scc1 rec_gcsk_48
    buffer_load_dwordx4 v[116:119], v13, s[4:7], s33 offen offset:0 sc1
rec_gcsk_48:
    s_cmp_eq_u64 s[66:67], 0
    s_cbranch_scc1 rec_gcsk_49
    buffer_load_dwordx4 v[120:123], v13, s[4:7], s33 offen offset:1024 sc1
rec_gcsk_49:
    s_cmp_eq_u64 s[68:69], 0
    s_cbranch_scc1 rec_gcsk_50
    buffer_load_dwordx4 v[124:127], v13, s[4:7], s33 offen offset:2048 sc1
rec_gcsk_50:
    s_cmp_eq_u64 s[70:71], 0
    s_cbranch_scc1 rec_gcsk_51
    buffer_load_dwordx4 v[128:131], v13, s[4:7], s33 offen offset:3072 sc1
rec_gcsk_51:
rec_gclp_52:
    s_add_u32 s41, s41, 1
    s_cmp_ge_u32 s41, 0x80000
    s_cbranch_scc1 rec_gcok_23
    s_mov_b64 vcc, 0
    s_waitcnt vmcnt(0)
    s_cmp_eq_u64 s[56:57], 0
    s_cbranch_scc1 rec_gcsk_53
    v_min3_u32 v31, v100, v101, v102
    v_min_u32 v31, v31, v103
    v_cmp_eq_u32 s[56:57], 0, v31
    v_xor_b32 v36, v36, v100
    v_xor_b32 v37, v37, v101
    v_xor_b32 v38, v38, v102
    v_xor_b32 v39, v39, v103
    s_nop 1
    v_smfmac_f32_16x16x64_bf16 v[68:71], v[36:39], a[192:199], v5
    v_smfmac_f32_16x16x64_bf16 v[72:75], v[36:39], a[200:207], v5
    v_mov_b32 v36, v100
    v_mov_b32 v37, v101
    v_mov_b32 v38, v102
    v_mov_b32 v39, v103
    s_or_b64 vcc, vcc, s[56:57]
    s_cmp_eq_u64 s[56:57], 0
    s_cbranch_scc1 rec_gcsk_53
    buffer_load_dwordx4 v[100:103], v12, s[4:7], s33 offen offset:0 sc1
rec_gcsk_53:
    s_cmp_eq_u64 s[58:59], 0
    s_cbranch_scc1 rec_gcsk_54
    v_min3_u32 v31, v104, v105, v106
    v_min_u32 v31, v31, v107
    v_cmp_eq_u32 s[58:59], 0, v31
    v_xor_b32 v40, v40, v104
    v_xor_b32 v41, v41, v105
    v_xor_b32 v42, v42, v106
    v_xor_b32 v43, v43, v107
    s_nop 1
    v_smfmac_f32_16x16x64_bf16 v[68:71], v[40:43], a[208:215], v5
    v_smfmac_f32_16x16x64_bf16 v[72:75], v[40:43], a[216:223], v5
    v_mov_b32 v40, v104
    v_mov_b32 v41, v105
    v_mov_b32 v42, v106
    v_mov_b32 v43, v107
    s_or_b64 vcc, vcc, s[58:59]
    s_cmp_eq_u64 s[58:59], 0
    s_cbranch_scc1 rec_gcsk_54
    buffer_load_dwordx4 v[104:107], v12, s[4:7], s33 offen offset:1024 sc1
rec_gcsk_54:
    s_cmp_eq_u64 s[60:61], 0
    s_cbranch_scc1 rec_gcsk_55
    v_min3_u32 v31, v108, v109, v110
    v_min_u32 v31, v31, v111
    v_cmp_eq_u32 s[60:61], 0, v31
    v_xor_b32 v44, v44, v108
    v_xor_b32 v45, v45, v109
    v_xor_b32 v46, v46, v110
    v_xor_b32 v47, v47, v111
    s_nop 1
    v_smfmac_f32_16x16x64_bf16 v[68:71], v[44:47], a[224:231], v5
    v_smfmac_f32_16x16x64_bf16 v[72:75], v[44:47], a[232:239], v5
    v_mov_b32 v44, v108
    v_mov_b32 v45, v109
    v_mov_b32 v46, v110
    v_mov_b32 v47, v111
    s_or_b64 vcc, vcc, s[60:61]
    s_cmp_eq_u64 s[60:61], 0
    s_cbranch_scc1 rec_gcsk_55
    buffer_load_dwordx4 v[108:111], v12, s[4:7], s33 offen offset:2048 sc1
rec_gcsk_55:
    s_cmp_eq_u64 s[62:63], 0
    s_cbranch_scc1 rec_gcsk_56
    v_min3_u32 v31, v112, v113, v114
    v_min_u32 v31, v31, v115
    v_cmp_eq_u32 s[62:63], 0, v31
    v_xor_b32 v48, v48, v112
    v_xor_b32 v49, v49, v113
    v_xor_b32 v50, v50, v114
    v_xor_b32 v51, v51, v115
    s_nop 1
    v_smfmac_f32_16x16x64_bf16 v[68:71], v[48:51], a[240:247], v5
    v_smfmac_f32_16x16x64_bf16 v[72:75], v[48:51], a[248:255], v5
    v_mov_b32 v48, v112
    v_mov_b32 v49, v113
    v_mov_b32 v50, v114
    v_mov_b32 v51, v115
    s_or_b64 vcc, vcc, s[62:63]
    s_cmp_eq_u64 s[62:63], 0
    s_cbranch_scc1 rec_gcsk_56
    buffer_load_dwordx4 v[112:115], v12, s[4:7], s33 offen offset:3072 sc1
rec_gcsk_56:
    s_cmp_eq_u64 s[64:65], 0
    s_cbranch_scc1 rec_gcsk_57
    v_min3_u32 v31, v116, v117, v118
    v_min_u32 v31, v31, v119
    v_cmp_eq_u32 s[64:65], 0, v31
    v_xor_b32 v52, v52, v116
    v_xor_b32 v53, v53, v117
    v_xor_b32 v54, v54, v118
    v_xor_b32 v55, v55, v119
    s_nop 1
    v_smfmac_f32_16x16x64_bf16 v[68:71], v[52:55], v[192:199], v5
    v_smfmac_f32_16x16x64_bf16 v[72:75], v[52:55], v[200:207], v5
    v_mov_b32 v52, v116
    v_mov_b32 v53, v117
    v_mov_b32 v54, v118
    v_mov_b32 v55, v119
    s_or_b64 vcc, vcc, s[64:65]
    s_cmp_eq_u64 s[64:65], 0
    s_cbranch_scc1 rec_gcsk_57
    buffer_load_dwordx4 v[116:119], v13, s[4:7], s33 offen offset:0 sc1
rec_gcsk_57:
    s_cmp_eq_u64 s[66:67], 0
    s_cbranch_scc1 rec_gcsk_58
    v_min3_u32 v31, v120, v121, v122
    v_min_u32 v31, v31, v123
    v_cmp_eq_u32 s[66:67], 0, v31
    v_xor_b32 v56, v56, v120
    v_xor_b32 v57, v57, v121
    v_xor_b32 v58, v58, v122
    v_xor_b32 v59, v59, v123
    s_nop 1
    v_smfmac_f32_16x16x64_bf16 v[68:71], v[56:59], v[208:215], v5
    v_smfmac_f32_16x16x64_bf16 v[72:75], v[56:59], v[216:223], v5
    v_mov_b32 v56, v120
    v_mov_b32 v57, v121
    v_mov_b32 v58, v122
    v_mov_b32 v59, v123
    s_or_b64 vcc, vcc, s[66:67]
    s_cmp_eq_u64 s[66:67], 0
    s_cbranch_scc1 rec_gcsk_58
    buffer_load_dwordx4 v[120:123], v13, s[4:7], s33 offen offset:1024 sc1
rec_gcsk_58:
    s_cmp_eq_u64 s[68:69], 0
    s_cbranch_scc1 rec_gcsk_59
    v_min3_u32 v31, v124, v125, v126
    v_min_u32 v31, v31, v127
    v_cmp_eq_u32 s[68:69], 0, v31
    v_xor_b32 v60, v60, v124
    v_xor_b32 v61, v61, v125
    v_xor_b32 v62, v62, v126
    v_xor_b32 v63, v63, v127
    s_nop 1
    v_smfmac_f32_16x16x64_bf16 v[68:71], v[60:63], v[224:231], v5
    v_smfmac_f32_16x16x64_bf16 v[72:75], v[60:63], v[232:239], v5
    v_mov_b32 v60, v124
    v_mov_b32 v61, v125
    v_mov_b32 v62, v126
    v_mov_b32 v63, v127
    s_or_b64 vcc, vcc, s[68:69]
    s_cmp_eq_u64 s[68:69], 0
    s_cbranch_scc1 rec_gcsk_59
    buffer_load_dwordx4 v[124:127], v13, s[4:7], s33 offen offset:2048 sc1
rec_gcsk_59:
    s_cmp_eq_u64 s[70:71], 0
    s_cbranch_scc1 rec_gcsk_60
    v_min3_u32 v31, v128, v129, v130
    v_min_u32 v31, v31, v131
    v_cmp_eq_u32 s[70:71], 0, v31
    v_xor_b32 v64, v64, v128
    v_xor_b32 v65, v65, v129
    v_xor_b32 v66, v66, v130
    v_xor_b32 v67, v67, v131
    s_nop 1
    v_smfmac_f32_16x16x64_bf16 v[68:71], v[64:67], v[240:247], v5
    v_smfmac_f32_16x16x64_bf16 v[72:75], v[64:67], v[248:255], v5
    v_mov_b32 v64, v128
    v_mov_b32 v65, v129
    v_mov_b32 v66, v130
    v_mov_b32 v67, v131
    s_or_b64 vcc, vcc, s[70:71]
    s_cmp_eq_u64 s[70:71], 0
    s_cbranch_scc1 rec_gcsk_60
    buffer_load_dwordx4 v[128:131], v13, s[4:7], s33 offen offset:3072 sc1
rec_gcsk_60:
    s_cmp_eq_u64 vcc, 0
    s_cbranch_scc1 rec_gcok_23
    s_branch rec_gclp_52
rec_done_12:
    buffer_store_dwordx4 v[180:183], v93, s[4:7], s88 offen sc1
    s_waitcnt vmcnt(0)
    s_barrier
    v_add_u32 v189, 1, v189
    buffer_store_dword v189, v188, s[4:7], 0 offen sc1
    s_endpgm
L_gem:
    s_load_dwordx2 s[90:91], s[0:1], 96
    s_load_dwordx2 s[92:93], s[0:1], 88
    v_and_b32 v1, 63, v0
    v_lshrrev_b32 v2, 6, v0
    s_nop 0
    v_readfirstlane_b32 s29, v2
    v_lshlrev_b32 v5, 4, v1
    s_mov_b32 s41, 0
    s_lshl_b32 s34, s29, 10
    s_waitcnt lgkmcnt(0)
    s_mov_b32 s4, s90
    s_and_b32 s5, s91, 0xffff
    s_mov_b32 s6, 268435456
    s_mov_b32 s7, 0x00020000
    s_cmp_ge_u32 s28, 120
    s_cbranch_scc1 L_att
    s_cmp_ge_u32 s28, 96
    s_cbranch_scc1 sl_b_61
    s_lshr_b32 s31, s28, 5
    s_add_u32 s31, s31, 1
    s_cmp_eq_u32 s31, 3
    s_cselect_b32 s44, 0, s31
    s_lshl_b32 s31, s44, 3
    s_add_u32 s31, s31, 16
    s_load_dwordx2 s[72:73], s[0:1], s31
    s_load_dwordx2 s[74:75], s[0:1], 0
    s_mov_b32 s76, 8388608
    s_mov_b32 s39, 8192
    s_and_b32 s31, s28, 31
    s_lshl_b32 s31, s31, 8
    s_lshl_b32 s36, s44, 24
    s_and_b32 s33, s28, 31
    s_lshl_b32 s33, s33, 13
    s_add_u32 s36, s36, s33
    s_mov_b32 s37, 262144
    s_and_b32 s50, s28, 31
    s_lshl_b32 s50, s50, 7
    s_lshl_b32 s33, s44, 2
    s_add_u32 s50, s50, s33
    s_add_u32 s50, s50, 115343360
    s_branch sl_c_62
sl_b_61:
    s_sub_u32 s32, s28, 96
    s_lshr_b32 s44, s32, 3
    s_load_dwordx2 s[72:73], s[0:1], 64
    s_load_dwordx2 s[74:75], s[0:1], 56
    s_mov_b32 s76, 6291456
    s_mov_b32 s39, 6144
    s_lshl_b32 s31, s32, 8
    s_lshl_b32 s36, s44, 22
    s_and_b32 s33, s32, 7
    s_lshl_b32 s33, s33, 13
    s_add_u32 s36, s36, s33
    s_add_u32 s36, s36, 50331648
    s_mov_b32 s37, 65536
    s_and_b32 s50, s32, 7
    s_lshl_b32 s50, s50, 7
    s_lshl_b32 s33, s44, 2
    s_add_u32 s50, s50, s33
    s_add_u32 s50, s50, 115347456
sl_c_62:
    s_waitcnt lgkmcnt(0)
    s_cmp_lg_u32 s29, 0
    s_cbranch_scc1 sl_i_63
    v_mov_b32 v2, 0
    s_mov_b64 exec, 1
    buffer_store_dword v2, v2, s[4:7], s50 offen sc1
    v_mov_b32 v2, 0
    v_mov_b32 v3, 1
    s_waitcnt vmcnt(0)
    global_atomic_add v2, v3, s[92:93] offset:0 sc1
    s_mov_b64 exec, -1
sl_i_63:
    s_mov_b32 s8, s72
    s_and_b32 s9, s73, 0xffff
    s_mov_b32 s10, s76
    s_mov_b32 s11, 0x00020000
    s_mov_b32 s12, s74
    s_and_b32 s13, s75, 0xffff
    s_mov_b32 s14, 4194304
    s_mov_b32 s15, 0x00020000
    v_lshrrev_b32 v2, 2, v1
    v_mul_lo_u32 v6, v2, s39
    s_lshl_b32 s33, s29, 6
    s_add_u32 s31, s31, s33
    v_and_b32 v2, 3, v1
    v_lshlrev_b32 v2, 4, v2
    v_add_u32 v2, s31, v2
    v_add_u32 v6, v6, v2
    s_lshl_b32 s39, s39, 4
    s_mov_b32 s30, 0
    s_mov_b32 s51, 64
    s_mov_b32 s52, 4128768
    s_lshl_b32 s31, s29, 15
    v_lshrrev_b32 v7, 4, v1
    v_lshlrev_b32 v7, 9, v7
    v_bfe_u32 v4, v1, 2, 2
    v_lshl_add_u32 v7, v4, 6, v7
    v_bfe_u32 v4, v1, 1, 1
    v_lshl_add_u32 v7, v4, 5, v7
    v_and_b32 v4, 1, v1
    v_lshl_add_u32 v7, v4, 3, v7
    v_add_u32 v7, s31, v7
    s_lshl_b32 s32, s29, 15
    s_add_u32 m0, s32, 0
    s_mov_b32 s38, 0
    buffer_load_dwordx4 v6, s[8:11], s38 offen lds
    s_add_u32 m0, s32, 1024
    s_add_u32 s38, s38, s39
    buffer_load_dwordx4 v6, s[8:11], s38 offen lds
    s_add_u32 m0, s32, 2048
    s_add_u32 s38, s38, s39
    buffer_load_dwordx4 v6, s[8:11], s38 offen lds
    s_add_u32 m0, s32, 3072
    s_add_u32 s38, s38, s39
    buffer_load_dwordx4 v6, s[8:11], s38 offen lds
    s_add_u32 m0, s32, 4096
    s_add_u32 s38, s38, s39
    buffer_load_dwordx4 v6, s[8:11], s38 offen lds
    s_add_u32 m0, s32, 5120
    s_add_u32 s38, s38, s39
    buffer_load_dwordx4 v6, s[8:11], s38 offen lds
    s_add_u32 m0, s32, 6144
    s_add_u32 s38, s38, s39
    buffer_load_dwordx4 v6, s[8:11], s38 offen lds
    s_add_u32 m0, s32, 7168
    s_add_u32 s38, s38, s39
    buffer_load_dwordx4 v6, s[8:11], s38 offen lds
    s_add_u32 m0, s32, 8192
    s_add_u32 s38, s38, s39
    buffer_load_dwordx4 v6, s[8:11], s38 offen lds
    s_add_u32 m0, s32, 9216
    s_add_u32 s38, s38, s39
    buffer_load_dwordx4 v6, s[8:11], s38 offen lds
    s_add_u32 m0, s32, 10240
    s_add_u32 s38, s38, s39
    buffer_load_dwordx4 v6, s[8:11], s38 offen lds
    s_add_u32 m0, s32, 11264
    s_add_u32 s38, s38, s39
    buffer_load_dwordx4 v6, s[8:11], s38 offen lds
    s_add_u32 m0, s32, 12288
    s_add_u32 s38, s38, s39
    buffer_load_dwordx4 v6, s[8:11], s38 offen lds
    s_add_u32 m0, s32, 13312
    s_add_u32 s38, s38, s39
    buffer_load_dwordx4 v6, s[8:11], s38 offen lds
    s_add_u32 m0, s32, 14336
    s_add_u32 s38, s38, s39
    buffer_load_dwordx4 v6, s[8:11], s38 offen lds
    s_add_u32 m0, s32, 15360
    s_add_u32 s38, s38, s39
    buffer_load_dwordx4 v6, s[8:11], s38 offen lds
    s_add_u32 m0, s32, 16384
    s_add_u32 s38, s38, s39
    buffer_load_dwordx4 v6, s[8:11], s38 offen lds
    s_add_u32 m0, s32, 17408
    s_add_u32 s38, s38, s39
    buffer_load_dwordx4 v6, s[8:11], s38 offen lds
    s_add_u32 m0, s32, 18432
    s_add_u32 s38, s38, s39
    buffer_load_dwordx4 v6, s[8:11], s38 offen lds
    s_add_u32 m0, s32, 19456
    s_add_u32 s38, s38, s39
    buffer_load_dwordx4 v6, s[8:11], s38 offen lds
    s_add_u32 m0, s32, 20480
    s_add_u32 s38, s38, s39
    buffer_load_dwordx4 v6, s[8:11], s38 offen lds
    s_add_u32 m0, s32, 21504
    s_add_u32 s38, s38, s39
    buffer_load_dwordx4 v6, s[8:11], s38 offen lds
    s_add_u32 m0, s32, 22528
    s_add_u32 s38, s38, s39
    buffer_load_dwordx4 v6, s[8:11], s38 offen lds
    s_add_u32 m0, s32, 23552
    s_add_u32 s38, s38, s39
    buffer_load_dwordx4 v6, s[8:11], s38 offen lds
    s_add_u32 m0, s32, 24576
    s_add_u32 s38, s38, s39
    buffer_load_dwordx4 v6, s[8:11], s38 offen lds
    s_add_u32 m0, s32, 25600
    s_add_u32 s38, s38, s39
    buffer_load_dwordx4 v6, s[8:11], s38 offen lds
    s_add_u32 m0, s32, 26624
    s_add_u32 s38, s38, s39
    buffer_load_dwordx4 v6, s[8:11], s38 offen lds
    s_add_u32 m0, s32, 27648
    s_add_u32 s38, s38, s39
    buffer_load_dwordx4 v6, s[8:11], s38 offen lds
    s_add_u32 m0, s32, 28672
    s_add_u32 s38, s38, s39
    buffer_load_dwordx4 v6, s[8:11], s38 offen lds
    s_add_u32 m0, s32, 29696
    s_add_u32 s38, s38, s39
    buffer_load_dwordx4 v6, s[8:11], s38 offen lds
    s_add_u32 m0, s32, 30720
    s_add_u32 s38, s38, s39
    buffer_load_dwordx4 v6, s[8:11], s38 offen lds
    s_add_u32 m0, s32, 31744
    s_add_u32 s38, s38, s39
    buffer_load_dwordx4 v6, s[8:11], s38 offen lds
    s_waitcnt vmcnt(30)
    ds_read_b64_tr_b16 a[0:1], v7 offset:0
    ds_read_b64_tr_b16 a[2:3], v7 offset:256
    ds_read_b64_tr_b16 a[4:5], v7 offset:16
    ds_read_b64_tr_b16 a[6:7], v7 offset:272
    s_waitcnt vmcnt(28)
    ds_read_b64_tr_b16 a[8:9], v7 offset:2048
    ds_read_b64_tr_b16 a[10:11], v7 offset:2304
    ds_read_b64_tr_b16 a[12:13], v7 offset:2064
    ds_read_b64_tr_b16 a[14:15], v7 offset:2320
    s_waitcnt lgkmcnt(4)
    s_add_u32 m0, s32, 0
    s_add_u32 s38, s38, s39
    buffer_load_dwordx4 v6, s[8:11], s38 offen lds
    s_add_u32 m0, s32, 1024
    s_add_u32 s38, s38, s39
    buffer_load_dwordx4 v6, s[8:11], s38 offen lds
    s_waitcnt vmcnt(28)
    ds_read_b64_tr_b16 a[16:17], v7 offset:4096
    ds_read_b64_tr_b16 a[18:19], v7 offset:4352
    ds_read_b64_tr_b16 a[20:21], v7 offset:4112
    ds_read_b64_tr_b16 a[22:23], v7 offset:4368
    s_waitcnt lgkmcnt(4)
    s_add_u32 m0, s32, 2048
    s_add_u32 s38, s38, s39
    buffer_load_dwordx4 v6, s[8:11], s38 offen lds
    s_add_u32 m0, s32, 3072
    s_add_u32 s38, s38, s39
    buffer_load_dwordx4 v6, s[8:11], s38 offen lds
    s_waitcnt vmcnt(28)
    ds_read_b64_tr_b16 a[24:25], v7 offset:6144
    ds_read_b64_tr_b16 a[26:27], v7 offset:6400
    ds_read_b64_tr_b16 a[28:29], v7 offset:6160
    ds_read_b64_tr_b16 a[30:31], v7 offset:6416
    s_waitcnt lgkmcnt(4)
    s_add_u32 m0, s32, 4096
    s_add_u32 s38, s38, s39
    buffer_load_dwordx4 v6, s[8:11], s38 offen lds
    s_add_u32 m0, s32, 5120
    s_add_u32 s38, s38, s39
    buffer_load_dwordx4 v6, s[8:11], s38 offen lds
    s_waitcnt vmcnt(28)
    ds_read_b64_tr_b16 a[32:33], v7 offset:8192
    ds_read_b64_tr_b16 a[34:35], v7 offset:8448
    ds_read_b64_tr_b16 a[36:37], v7 offset:8208
    ds_read_b64_tr_b16 a[38:39], v7 offset:8464
    s_waitcnt lgkmcnt(4)
    s_add_u32 m0, s32, 6144
    s_add_u32 s38, s38, s39
    buffer_load_dwordx4 v6, s[8:11], s38 offen lds
    s_add_u32 m0, s32, 7168
    s_add_u32 s38, s38, s39
    buffer_load_dwordx4 v6, s[8:11], s38 offen lds
    s_waitcnt vmcnt(28)
    ds_read_b64_tr_b16 a[40:41], v7 offset:10240
    ds_read_b64_tr_b16 a[42:43], v7 offset:10496
    ds_read_b64_tr_b16 a[44:45], v7 offset:10256
    ds_read_b64_tr_b16 a[46:47], v7 offset:10512
    s_waitcnt lgkmcnt(4)
    s_add_u32 m0, s32, 8192
    s_add_u32 s38, s38, s39
    buffer_load_dwordx4 v6, s[8:11], s38 offen lds
    s_add_u32 m0, s32, 9216
    s_add_u32 s38, s38, s39
    buffer_load_dwordx4 v6, s[8:11], s38 offen lds
    s_waitcnt vmcnt(28)
    ds_read_b64_tr_b16 a[48:49], v7 offset:12288
    ds_read_b64_tr_b16 a[50:51], v7 offset:12544
    ds_read_b64_tr_b16 a[52:53], v7 offset:12304
    ds_read_b64_tr_b16 a[54:55], v7 offset:12560
    s_waitcnt lgkmcnt(4)
    s_add_u32 m0, s32, 10240
    s_add_u32 s38, s38, s39
    buffer_load_dwordx4 v6, s[8:11], s38 offen lds
    s_add_u32 m0, s32, 11264
    s_add_u32 s38, s38, s39
    buffer_load_dwordx4 v6, s[8:11], s38 offen lds
    s_waitcnt vmcnt(28)
    ds_read_b64_tr_b16 a[56:57], v7 offset:14336
    ds_read_b64_tr_b16 a[58:59], v7 offset:14592
    ds_read_b64_tr_b16 a[60:61], v7 offset:14352
    ds_read_b64_tr_b16 a[62:63], v7 offset:14608
    s_waitcnt lgkmcnt(4)
    s_add_u32 m0, s32, 12288
    s_add_u32 s38, s38, s39
    buffer_load_dwordx4 v6, s[8:11], s38 offen lds
    s_add_u32 m0, s32, 13312
    s_add_u32 s38, s38, s39
    buffer_load_dwordx4 v6, s[8:11], s38 offen lds
    s_waitcnt vmcnt(28)
    ds_read_b64_tr_b16 a[64:65], v7 offset:16384
    ds_read_b64_tr_b16 a[66:67], v7 offset:16640
    ds_read_b64_tr_b16 a[68:69], v7 offset:16400
    ds_read_b64_tr_b16 a[70:71], v7 offset:16656
    s_waitcnt lgkmcnt(4)
    s_add_u32 m0, s32, 14336
    s_add_u32 s38, s38, s39
    buffer_load_dwordx4 v6, s[8:11], s38 offen lds
    s_add_u32 m0, s32, 15360
    s_add_u32 s38, s38, s39
    buffer_load_dwordx4 v6, s[8:11], s38 offen lds
    s_waitcnt vmcnt(28)
    ds_read_b64_tr_b16 a[72:73], v7 offset:18432
    ds_read_b64_tr_b16 a[74:75], v7 offset:18688
    ds_read_b64_tr_b16 a[76:77], v7 offset:18448
    ds_read_b64_tr_b16 a[78:79], v7 offset:18704
    s_waitcnt lgkmcnt(4)
    s_add_u32 m0, s32, 16384
    s_add_u32 s38, s38, s39
    buffer_load_dwordx4 v6, s[8:11], s38 offen lds
    s_add_u32 m0, s32, 17408
    s_add_u32 s38, s38, s39
    buffer_load_dwordx4 v6, s[8:11], s38 offen lds
    s_waitcnt vmcnt(28)
    ds_read_b64_tr_b16 a[80:81], v7 offset:20480
    ds_read_b64_tr_b16 a[82:83], v7 offset:20736
    ds_read_b64_tr_b16 a[84:85], v7 offset:20496
    ds_read_b64_tr_b16 a[86:87], v7 offset:20752
    s_waitcnt lgkmcnt(4)
    s_add_u32 m0, s32, 18432
    s_add_u32 s38, s38, s39
    buffer_load_dwordx4 v6, s[8:11], s38 offen lds
    s_add_u32 m0, s32, 19456
    s_add_u32 s38, s38, s39
    buffer_load_dwordx4 v6, s[8:11], s38 offen lds
    s_waitcnt vmcnt(28)
    ds_read_b64_tr_b16 a[88:89], v7 offset:22528
    ds_read_b64_tr_b16 a[90:91], v7 offset:22784
    ds_read_b64_tr_b16 a[92:93], v7 offset:22544
    ds_read_b64_tr_b16 a[94:95], v7 offset:22800
    s_waitcnt lgkmcnt(4)
    s_add_u32 m0, s32, 20480
    s_add_u32 s38, s38, s39
    buffer_load_dwordx4 v6, s[8:11], s38 offen lds
    s_add_u32 m0, s32, 21504
    s_add_u32 s38, s38, s39
    buffer_load_dwordx4 v6, s[8:11], s38 offen lds
    s_waitcnt vmcnt(28)
    ds_read_b64_tr_b16 a[96:97], v7 offset:24576
    ds_read_b64_tr_b16 a[98:99], v7 offset:24832
    ds_read_b64_tr_b16 a[100:101], v7 offset:24592
    ds_read_b64_tr_b16 a[102:103], v7 offset:24848
    s_waitcnt lgkmcnt(4)
    s_add_u32 m0, s32, 22528
    s_add_u32 s38, s38, s39
    buffer_load_dwordx4 v6, s[8:11], s38 offen lds
    s_add_u32 m0, s32, 23552
    s_add_u32 s38, s38, s39
    buffer_load_dwordx4 v6, s[8:11], s38 offen lds
    s_waitcnt vmcnt(28)
    ds_read_b64_tr_b16 a[104:105], v7 offset:26624
    ds_read_b64_tr_b16 a[106:107], v7 offset:26880
    ds_read_b64_tr_b16 a[108:109], v7 offset:26640
    ds_read_b64_tr_b16 a[110:111], v7 offset:26896
    s_waitcnt lgkmcnt(4)
    s_add_u32 m0, s32, 24576
    s_add_u32 s38, s38, s39
    buffer_load_dwordx4 v6, s[8:11], s38 offen lds
    s_add_u32 m0, s32, 25600
    s_add_u32 s38, s38, s39
    buffer_load_dwordx4 v6, s[8:11], s38 offen lds
    s_waitcnt vmcnt(28)
    ds_read_b64_tr_b16 a[112:113], v7 offset:28672
    ds_read_b64_tr_b16 a[114:115], v7 offset:28928
    ds_read_b64_tr_b16 a[116:117], v7 offset:28688
    ds_read_b64_tr_b16 a[118:119], v7 offset:28944
    s_waitcnt lgkmcnt(4)
    s_add_u32 m0, s32, 26624
    s_add_u32 s38, s38, s39
    buffer_load_dwordx4 v6, s[8:11], s38 offen lds
    s_add_u32 m0, s32, 27648
    s_add_u32 s38, s38, s39
    buffer_load_dwordx4 v6, s[8:11], s38 offen lds
    s_waitcnt vmcnt(28)
    ds_read_b64_tr_b16 a[120:121], v7 offset:30720
    ds_read_b64_tr_b16 a[122:123], v7 offset:30976
    ds_read_b64_tr_b16 a[124:125], v7 offset:30736
    ds_read_b64_tr_b16 a[126:127], v7 offset:30992
    s_waitcnt lgkmcnt(4)
    s_add_u32 m0, s32, 28672
    s_add_u32 s38, s38, s39
    buffer_load_dwordx4 v6, s[8:11], s38 offen lds
    s_add_u32 m0, s32, 29696
    s_add_u32 s38, s38, s39
    buffer_load_dwordx4 v6, s[8:11], s38 offen lds
    s_waitcnt vmcnt(28)
    ds_read_b64_tr_b16 a[128:129], v7 offset:0
    ds_read_b64_tr_b16 a[130:131], v7 offset:256
    ds_read_b64_tr_b16 a[132:133], v7 offset:16
    ds_read_b64_tr_b16 a[134:135], v7 offset:272
    s_waitcnt lgkmcnt(4)
    s_add_u32 m0, s32, 30720
    s_add_u32 s38, s38, s39
    buffer_load_dwordx4 v6, s[8:11], s38 offen lds
    s_add_u32 m0, s32, 31744
    s_add_u32 s38, s38, s39
    buffer_load_dwordx4 v6, s[8:11], s38 offen lds
    s_waitcnt vmcnt(28)
    ds_read_b64_tr_b16 a[136:137], v7 offset:2048
    ds_read_b64_tr_b16 a[138:139], v7 offset:2304
    ds_read_b64_tr_b16 a[140:141], v7 offset:2064
    ds_read_b64_tr_b16 a[142:143], v7 offset:2320
    s_waitcnt vmcnt(26)
    ds_read_b64_tr_b16 a[144:145], v7 offset:4096
    ds_read_b64_tr_b16 a[146:147], v7 offset:4352
    ds_read_b64_tr_b16 a[148:149], v7 offset:4112
    ds_read_b64_tr_b16 a[150:151], v7 offset:4368
    s_waitcnt vmcnt(24)
    ds_read_b64_tr_b16 a[152:153], v7 offset:6144
    ds_read_b64_tr_b16 a[154:155], v7 offset:6400
    ds_read_b64_tr_b16 a[156:157], v7 offset:6160
    ds_read_b64_tr_b16 a[158:159], v7 offset:6416
    s_waitcnt vmcnt(22)
    ds_read_b64_tr_b16 a[160:161], v7 offset:8192
    ds_read_b64_tr_b16 a[162:163], v7 offset:8448
    ds_read_b64_tr_b16 a[164:165], v7 offset:8208
    ds_read_b64_tr_b16 a[166:167], v7 offset:8464
    s_waitcnt vmcnt(20)
    ds_read_b64_tr_b16 a[168:169], v7 offset:10240
    ds_read_b64_tr_b16 a[170:171], v7 offset:10496
    ds_read_b64_tr_b16 a[172:173], v7 offset:10256
    ds_read_b64_tr_b16 a[174:175], v7 offset:10512
    s_waitcnt vmcnt(18)
    ds_read_b64_tr_b16 a[176:177], v7 offset:12288
    ds_read_b64_tr_b16 a[178:179], v7 offset:12544
    ds_read_b64_tr_b16 a[180:181], v7 offset:12304
    ds_read_b64_tr_b16 a[182:183], v7 offset:12560
    s_waitcnt vmcnt(16)
    ds_read_b64_tr_b16 a[184:185], v7 offset:14336
    ds_read_b64_tr_b16 a[186:187], v7 offset:14592
    ds_read_b64_tr_b16 a[188:189], v7 offset:14352
    ds_read_b64_tr_b16 a[190:191], v7 offset:14608
    s_waitcnt vmcnt(14)
    ds_read_b64_tr_b16 a[192:193], v7 offset:16384
    ds_read_b64_tr_b16 a[194:195], v7 offset:16640
    ds_read_b64_tr_b16 a[196:197], v7 offset:16400
    ds_read_b64_tr_b16 a[198:199], v7 offset:16656
    s_waitcnt vmcnt(12)
    ds_read_b64_tr_b16 a[200:201], v7 offset:18432
    ds_read_b64_tr_b16 a[202:203], v7 offset:18688
    ds_read_b64_tr_b16 a[204:205], v7 offset:18448
    ds_read_b64_tr_b16 a[206:207], v7 offset:18704
    s_waitcnt vmcnt(10)
    ds_read_b64_tr_b16 a[208:209], v7 offset:20480
    ds_read_b64_tr_b16 a[210:211], v7 offset:20736
    ds_read_b64_tr_b16 a[212:213], v7 offset:20496
    ds_read_b64_tr_b16 a[214:215], v7 offset:20752
    s_waitcnt vmcnt(8)
    ds_read_b64_tr_b16 a[216:217], v7 offset:22528
    ds_read_b64_tr_b16 a[218:219], v7 offset:22784
    ds_read_b64_tr_b16 a[220:221], v7 offset:22544
    ds_read_b64_tr_b16 a[222:223], v7 offset:22800
    s_waitcnt vmcnt(6)
    ds_read_b64_tr_b16 a[224:225], v7 offset:24576
    ds_read_b64_tr_b16 a[226:227], v7 offset:24832
    ds_read_b64_tr_b16 a[228:229], v7 offset:24592
    ds_read_b64_tr_b16 a[230:231], v7 offset:24848
    s_waitcnt vmcnt(4)
    ds_read_b64_tr_b16 a[232:233], v7 offset:26624
    ds_read_b64_tr_b16 a[234:235], v7 offset:26880
    ds_read_b64_tr_b16 a[236:237], v7 offset:26640
    ds_read_b64_tr_b16 a[238:239], v7 offset:26896
    s_waitcnt vmcnt(2)
    ds_read_b64_tr_b16 a[240:241], v7 offset:28672
    ds_read_b64_tr_b16 a[242:243], v7 offset:28928
    ds_read_b64_tr_b16 a[244:245], v7 offset:28688
    ds_read_b64_tr_b16 a[246:247], v7 offset:28944
    s_waitcnt vmcnt(0)
    ds_read_b64_tr_b16 a[248:249], v7 offset:30720
    ds_read_b64_tr_b16 a[250:251], v7 offset:30976
    ds_read_b64_tr_b16 a[252:253], v7 offset:30736
    ds_read_b64_tr_b16 a[254:255], v7 offset:30992
    s_waitcnt lgkmcnt(0)
    s_lshr_b32 s31, s29, 1
    s_and_b32 s31, s31, 1
    s_lshl_b32 s31, s31, 2
    v_lshrrev_b32 v2, 4, v1
    v_add_u32 v2, s31, v2
    v_and_b32 v3, 7, v1
    v_xor_b32 v2, v2, v3
    s_lshl_b32 s31, s29, 14
    v_lshrrev_b32 v8, 3, v1
    v_lshlrev_b32 v8, 11, v8
    v_add_u32 v8, s31, v8
    v_lshl_add_u32 v8, v2, 4, v8
    v_bfe_u32 v2, v1, 1, 3
    v_lshrrev_b32 v3, 4, v1
    v_xor_b32 v2, v2, v3
    v_bfe_u32 v3, v1, 3, 1
    v_lshlrev_b32 v3, 11, v3
    v_and_b32 v4, 7, v1
    v_lshl_add_u32 v3, v4, 7, v3
    v_xor_b32 v12, 0, v2
    v_lshl_add_u32 v12, v12, 4, v3
    v_add_u32 v14, 65536, v12
    v_xor_b32 v13, 4, v2
    v_lshl_add_u32 v13, v13, 4, v3
    v_add_u32 v15, 65536, v13
    s_lshl_b32 s31, s29, 11
    v_lshrrev_b32 v9, 4, v1
    v_lshlrev_b32 v9, 9, v9
    v_bfe_u32 v4, v1, 3, 1
    v_lshl_add_u32 v9, v4, 8, v9
    v_and_b32 v4, 7, v1
    v_lshl_add_u32 v9, v4, 4, v9
    v_add_u32 v9, s31, v9
    v_mov_b32 v10, s50
    s_cmp_eq_u32 s29, 0
    s_cselect_b64 vcc, 1, 0
    v_mov_b32 v4, 2130706432
    v_cndmask_b32 v10, v4, v10, vcc
    v_mov_b32 v11, 0
    s_lshl_b32 s35, s30, 16
    s_sub_u32 s36, s36, s37
    s_barrier
    s_add_u32 m0, s34, 0
    s_nop 0
    buffer_load_dwordx4 v8, s[12:15], s35 offen offset:0 lds
    s_add_u32 m0, s34, 3968
    s_nop 0
    buffer_load_dwordx4 v8, s[12:15], s35 offen offset:128 lds
    s_add_u32 m0, s34, 7936
    s_nop 0
    buffer_load_dwordx4 v8, s[12:15], s35 offen offset:256 lds
    s_add_u32 m0, s34, 11904
    s_nop 0
    buffer_load_dwordx4 v8, s[12:15], s35 offen offset:384 lds
    s_add_u32 m0, s34, 15872
    s_nop 0
    buffer_load_dwordx4 v8, s[12:15], s35 offen offset:512 lds
    s_add_u32 m0, s34, 19840
    s_nop 0
    buffer_load_dwordx4 v8, s[12:15], s35 offen offset:640 lds
    s_add_u32 m0, s34, 23808
    s_nop 0
    buffer_load_dwordx4 v8, s[12:15], s35 offen offset:768 lds
    s_add_u32 m0, s34, 27776
    s_nop 0
    buffer_load_dwordx4 v8, s[12:15], s35 offen offset:896 lds
    s_add_u32 m0, s34, 31744
    s_nop 0
    buffer_load_dwordx4 v8, s[12:15], s35 offen offset:1024 lds
    s_add_u32 m0, s34, 35712
    s_nop 0
    buffer_load_dwordx4 v8, s[12:15], s35 offen offset:1152 lds
    s_add_u32 m0, s34, 39680
    s_nop 0
    buffer_load_dwordx4 v8, s[12:15], s35 offen offset:1280 lds
    s_add_u32 m0, s34, 43648
    s_nop 0
    buffer_load_dwordx4 v8, s[12:15], s35 offen offset:1408 lds
    s_add_u32 m0, s34, 47616
    s_nop 0
    buffer_load_dwordx4 v8, s[12:15], s35 offen offset:1536 lds
    s_add_u32 m0, s34, 51584
    s_nop 0
    buffer_load_dwordx4 v8, s[12:15], s35 offen offset:1664 lds
    s_add_u32 m0, s34, 55552
    s_nop 0
    buffer_load_dwordx4 v8, s[12:15], s35 offen offset:1792 lds
    s_add_u32 m0, s34, 59520
    s_nop 0
    buffer_load_dwordx4 v8, s[12:15], s35 offen offset:1920 lds
    s_add_u32 s35, s35, 65536
    s_add_u32 m0, s34, 65536
    s_nop 0
    buffer_load_dwordx4 v8, s[12:15], s35 offen offset:0 lds
    s_add_u32 m0, s34, 69504
    s_nop 0
    buffer_load_dwordx4 v8, s[12:15], s35 offen offset:128 lds
    s_add_u32 m0, s34, 73472
    s_nop 0
    buffer_load_dwordx4 v8, s[12:15], s35 offen offset:256 lds
    s_add_u32 m0, s34, 77440
    s_nop 0
    buffer_load_dwordx4 v8, s[12:15], s35 offen offset:384 lds
    s_waitcnt vmcnt(12)
    s_barrier
    ds_read_b128 v[32:35], v12 offset:0
    ds_read_b128 v[36:39], v12 offset:1024
    ds_read_b128 v[40:43], v13 offset:0
    ds_read_b128 v[44:47], v13 offset:1024
    ds_read_b128 v[48:51], v12 offset:4096
    ds_read_b128 v[52:55], v12 offset:5120
    v_add_u32 v9, 2130706432, v9
    s_cmp_eq_u32 s44, 2
    s_cbranch_scc1 sl_v_64
sl_loop_66:
    s_waitcnt lgkmcnt(4)
    v_mfma_f32_16x16x32_bf16 v[64:67], a[0:3], v[32:35], 0
    ds_read_b128 v[56:59], v13 offset:4096
    v_mfma_f32_16x16x32_bf16 v[68:71], a[4:7], v[32:35], 0
    v_mfma_f32_16x16x32_bf16 v[72:75], a[0:3], v[36:39], 0
    ds_read_b128 v[60:63], v13 offset:5120
    s_add_u32 m0, s34, 81408
    v_mfma_f32_16x16x32_bf16 v[76:79], a[4:7], v[36:39], 0
    buffer_load_dwordx4 v8, s[12:15], s35 offen offset:512 lds
    s_waitcnt lgkmcnt(4)
    v_mfma_f32_16x16x32_bf16 v[64:67], a[8:11], v[40:43], v[64:67]
    ds_read_b128 v[32:35], v12 offset:8192
    v_mfma_f32_16x16x32_bf16 v[68:71], a[12:15], v[40:43], v[68:71]
    v_mfma_f32_16x16x32_bf16 v[72:75], a[8:11], v[44:47], v[72:75]
    ds_read_b128 v[36:39], v12 offset:9216
    v_mfma_f32_16x16x32_bf16 v[76:79], a[12:15], v[44:47], v[76:79]
    s_waitcnt lgkmcnt(4)
    v_mfma_f32_16x16x32_bf16 v[64:67], a[16:19], v[48:51], v[64:67]
    ds_read_b128 v[40:43], v13 offset:8192
    v_mfma_f32_16x16x32_bf16 v[68:71], a[20:23], v[48:51], v[68:71]
    v_cvt_pk_bf16_f32 v96, v80, v81
    v_mfma_f32_16x16x32_bf16 v[72:75], a[16:19], v[52:55], v[72:75]
    ds_read_b128 v[44:47], v13 offset:9216
    s_add_u32 m0, s34, 85376
    v_mfma_f32_16x16x32_bf16 v[76:79], a[20:23], v[52:55], v[76:79]
    buffer_load_dwordx4 v8, s[12:15], s35 offen offset:640 lds
    v_cvt_pk_bf16_f32 v97, v82, v83
    s_waitcnt lgkmcnt(4)
    v_mfma_f32_16x16x32_bf16 v[64:67], a[24:27], v[56:59], v[64:67]
    ds_read_b128 v[48:51], v12 offset:12288
    v_mfma_f32_16x16x32_bf16 v[68:71], a[28:31], v[56:59], v[68:71]
    v_cvt_pk_bf16_f32 v98, v84, v85
    v_mfma_f32_16x16x32_bf16 v[72:75], a[24:27], v[60:63], v[72:75]
    ds_read_b128 v[52:55], v12 offset:13312
    v_mfma_f32_16x16x32_bf16 v[76:79], a[28:31], v[60:63], v[76:79]
    v_cvt_pk_bf16_f32 v99, v86, v87
    s_waitcnt lgkmcnt(4)
    v_mfma_f32_16x16x32_bf16 v[64:67], a[32:35], v[32:35], v[64:67]
    ds_read_b128 v[56:59], v13 offset:12288
    v_mfma_f32_16x16x32_bf16 v[68:71], a[36:39], v[32:35], v[68:71]
    v_cvt_pk_bf16_f32 v100, v88, v89
    v_mfma_f32_16x16x32_bf16 v[72:75], a[32:35], v[36:39], v[72:75]
    ds_read_b128 v[60:63], v13 offset:13312
    s_add_u32 m0, s34, 89344
    v_mfma_f32_16x16x32_bf16 v[76:79], a[36:39], v[36:39], v[76:79]
    buffer_load_dwordx4 v8, s[12:15], s35 offen offset:768 lds
    v_cvt_pk_bf16_f32 v101, v90, v91
    s_waitcnt lgkmcnt(4)
    v_mfma_f32_16x16x32_bf16 v[64:67], a[40:43], v[40:43], v[64:67]
    ds_read_b128 v[32:35], v12 offset:16384
    v_mfma_f32_16x16x32_bf16 v[68:71], a[44:47], v[40:43], v[68:71]
    v_cvt_pk_bf16_f32 v102, v92, v93
    v_mfma_f32_16x16x32_bf16 v[72:75], a[40:43], v[44:47], v[72:75]
    ds_read_b128 v[36:39], v12 offset:17408
    v_mfma_f32_16x16x32_bf16 v[76:79], a[44:47], v[44:47], v[76:79]
    v_cvt_pk_bf16_f32 v103, v94, v95
    buffer_store_dwordx4 v[96:99], v9, s[4:7], s36 offen sc1
    s_waitcnt lgkmcnt(4)
    v_mfma_f32_16x16x32_bf16 v[64:67], a[48:51], v[48:51], v[64:67]
    ds_read_b128 v[40:43], v13 offset:16384
    v_mfma_f32_16x16x32_bf16 v[68:71], a[52:55], v[48:51], v[68:71]
    v_mfma_f32_16x16x32_bf16 v[72:75], a[48:51], v[52:55], v[72:75]
    ds_read_b128 v[44:47], v13 offset:17408
    s_add_u32 m0, s34, 93312
    v_mfma_f32_16x16x32_bf16 v[76:79], a[52:55], v[52:55], v[76:79]
    buffer_load_dwordx4 v8, s[12:15], s35 offen offset:896 lds
    s_waitcnt lgkmcnt(4)
    v_mfma_f32_16x16x32_bf16 v[64:67], a[56:59], v[56:59], v[64:67]
    ds_read_b128 v[48:51], v12 offset:20480
    v_mfma_f32_16x16x32_bf16 v[68:71], a[60:63], v[56:59], v[68:71]
    v_mfma_f32_16x16x32_bf16 v[72:75], a[56:59], v[60:63], v[72:75]
    ds_read_b128 v[52:55], v12 offset:21504
    v_mfma_f32_16x16x32_bf16 v[76:79], a[60:63], v[60:63], v[76:79]
    buffer_store_dwordx4 v[100:103], v9, s[4:7], s36 offen offset:128 sc1
    s_add_u32 s36, s36, s37
    s_waitcnt vmcnt(8)
    s_barrier
    s_waitcnt lgkmcnt(4)
    v_mfma_f32_16x16x32_bf16 v[64:67], a[64:67], v[32:35], v[64:67]
    ds_read_b128 v[56:59], v13 offset:20480
    v_mfma_f32_16x16x32_bf16 v[68:71], a[68:71], v[32:35], v[68:71]
    v_mfma_f32_16x16x32_bf16 v[72:75], a[64:67], v[36:39], v[72:75]
    ds_read_b128 v[60:63], v13 offset:21504
    s_add_u32 m0, s34, 97280
    v_mfma_f32_16x16x32_bf16 v[76:79], a[68:71], v[36:39], v[76:79]
    buffer_load_dwordx4 v8, s[12:15], s35 offen offset:1024 lds
    s_waitcnt lgkmcnt(4)
    v_mfma_f32_16x16x32_bf16 v[64:67], a[72:75], v[40:43], v[64:67]
    ds_read_b128 v[32:35], v12 offset:24576
    v_mfma_f32_16x16x32_bf16 v[68:71], a[76:79], v[40:43], v[68:71]
    v_mfma_f32_16x16x32_bf16 v[72:75], a[72:75], v[44:47], v[72:75]
    ds_read_b128 v[36:39], v12 offset:25600
    v_mfma_f32_16x16x32_bf16 v[76:79], a[76:79], v[44:47], v[76:79]
    s_waitcnt lgkmcnt(4)
    v_mfma_f32_16x16x32_bf16 v[64:67], a[80:83], v[48:51], v[64:67]
    ds_read_b128 v[40:43], v13 offset:24576
    v_mfma_f32_16x16x32_bf16 v[68:71], a[84:87], v[48:51], v[68:71]
    v_and_b32 v9, 0xffffff, v9
    v_mfma_f32_16x16x32_bf16 v[72:75], a[80:83], v[52:55], v[72:75]
    ds_read_b128 v[44:47], v13 offset:25600
    s_add_u32 m0, s34, 101248
    v_mfma_f32_16x16x32_bf16 v[76:79], a[84:87], v[52:55], v[76:79]
    buffer_load_dwordx4 v8, s[12:15], s35 offen offset:1152 lds
    s_waitcnt lgkmcnt(4)
    v_mfma_f32_16x16x32_bf16 v[64:67], a[88:91], v[56:59], v[64:67]
    ds_read_b128 v[48:51], v12 offset:28672
    v_mfma_f32_16x16x32_bf16 v[68:71], a[92:95], v[56:59], v[68:71]
    v_mfma_f32_16x16x32_bf16 v[72:75], a[88:91], v[60:63], v[72:75]
    ds_read_b128 v[52:55], v12 offset:29696
    v_mfma_f32_16x16x32_bf16 v[76:79], a[92:95], v[60:63], v[76:79]
    s_waitcnt lgkmcnt(4)
    v_mfma_f32_16x16x32_bf16 v[64:67], a[96:99], v[32:35], v[64:67]
    ds_read_b128 v[56:59], v13 offset:28672
    v_mfma_f32_16x16x32_bf16 v[68:71], a[100:103], v[32:35], v[68:71]
    v_mfma_f32_16x16x32_bf16 v[72:75], a[96:99], v[36:39], v[72:75]
    ds_read_b128 v[60:63], v13 offset:29696
    s_add_u32 m0, s34, 105216
    v_mfma_f32_16x16x32_bf16 v[76:79], a[100:103], v[36:39], v[76:79]
    buffer_load_dwordx4 v8, s[12:15], s35 offen offset:1280 lds
    s_waitcnt lgkmcnt(4)
    v_mfma_f32_16x16x32_bf16 v[64:67], a[104:107], v[40:43], v[64:67]
    ds_read_b128 v[32:35], v12 offset:32768
    v_mfma_f32_16x16x32_bf16 v[68:71], a[108:111], v[40:43], v[68:71]
    v_mfma_f32_16x16x32_bf16 v[72:75], a[104:107], v[44:47], v[72:75]
    ds_read_b128 v[36:39], v12 offset:33792
    v_mfma_f32_16x16x32_bf16 v[76:79], a[108:111], v[44:47], v[76:79]
    s_waitcnt lgkmcnt(4)
    v_mfma_f32_16x16x32_bf16 v[64:67], a[112:115], v[48:51], v[64:67]
    ds_read_b128 v[40:43], v13 offset:32768
    v_mfma_f32_16x16x32_bf16 v[68:71], a[116:119], v[48:51], v[68:71]
    v_mfma_f32_16x16x32_bf16 v[72:75], a[112:115], v[52:55], v[72:75]
    ds_read_b128 v[44:47], v13 offset:33792
    s_add_u32 m0, s34, 109184
    v_mfma_f32_16x16x32_bf16 v[76:79], a[116:119], v[52:55], v[76:79]
    buffer_load_dwordx4 v8, s[12:15], s35 offen offset:1408 lds
    s_waitcnt lgkmcnt(4)
    v_mfma_f32_16x16x32_bf16 v[64:67], a[120:123], v[56:59], v[64:67]
    ds_read_b128 v[48:51], v12 offset:36864
    v_mfma_f32_16x16x32_bf16 v[68:71], a[124:127], v[56:59], v[68:71]
    v_mfma_f32_16x16x32_bf16 v[72:75], a[120:123], v[60:63], v[72:75]
    ds_read_b128 v[52:55], v12 offset:37888
    v_mfma_f32_16x16x32_bf16 v[76:79], a[124:127], v[60:63], v[76:79]
    s_waitcnt lgkmcnt(4)
    v_mfma_f32_16x16x32_bf16 v[64:67], a[128:131], v[32:35], v[64:67]
    ds_read_b128 v[56:59], v13 offset:36864
    v_mfma_f32_16x16x32_bf16 v[68:71], a[132:135], v[32:35], v[68:71]
    v_mfma_f32_16x16x32_bf16 v[72:75], a[128:131], v[36:39], v[72:75]
    ds_read_b128 v[60:63], v13 offset:37888
    s_add_u32 m0, s34, 113152
    v_mfma_f32_16x16x32_bf16 v[76:79], a[132:135], v[36:39], v[76:79]
    buffer_load_dwordx4 v8, s[12:15], s35 offen offset:1536 lds
    s_waitcnt lgkmcnt(4)
    v_mfma_f32_16x16x32_bf16 v[64:67], a[136:139], v[40:43], v[64:67]
    ds_read_b128 v[32:35], v12 offset:40960
    v_mfma_f32_16x16x32_bf16 v[68:71], a[140:143], v[40:43], v[68:71]
    v_mfma_f32_16x16x32_bf16 v[72:75], a[136:139], v[44:47], v[72:75]
    ds_read_b128 v[36:39], v12 offset:41984
    v_mfma_f32_16x16x32_bf16 v[76:79], a[140:143], v[44:47], v[76:79]
    s_waitcnt lgkmcnt(4)
    v_mfma_f32_16x16x32_bf16 v[64:67], a[144:147], v[48:51], v[64:67]
    ds_read_b128 v[40:43], v13 offset:40960
    v_mfma_f32_16x16x32_bf16 v[68:71], a[148:151], v[48:51], v[68:71]
    v_mfma_f32_16x16x32_bf16 v[72:75], a[144:147], v[52:55], v[72:75]
    ds_read_b128 v[44:47], v13 offset:41984
    s_add_u32 m0, s34, 117120
    v_mfma_f32_16x16x32_bf16 v[76:79], a[148:151], v[52:55], v[76:79]
    buffer_load_dwordx4 v8, s[12:15], s35 offen offset:1664 lds
    s_waitcnt lgkmcnt(4)
    v_mfma_f32_16x16x32_bf16 v[64:67], a[152:155], v[56:59], v[64:67]
    ds_read_b128 v[48:51], v12 offset:45056
    v_mfma_f32_16x16x32_bf16 v[68:71], a[156:159], v[56:59], v[68:71]
    v_mfma_f32_16x16x32_bf16 v[72:75], a[152:155], v[60:63], v[72:75]
    ds_read_b128 v[52:55], v12 offset:46080
    v_mfma_f32_16x16x32_bf16 v[76:79], a[156:159], v[60:63], v[76:79]
    s_waitcnt lgkmcnt(4)
    v_mfma_f32_16x16x32_bf16 v[64:67], a[160:163], v[32:35], v[64:67]
    ds_read_b128 v[56:59], v13 offset:45056
    v_mfma_f32_16x16x32_bf16 v[68:71], a[164:167], v[32:35], v[68:71]
    v_mfma_f32_16x16x32_bf16 v[72:75], a[160:163], v[36:39], v[72:75]
    ds_read_b128 v[60:63], v13 offset:46080
    s_add_u32 m0, s34, 121088
    v_mfma_f32_16x16x32_bf16 v[76:79], a[164:167], v[36:39], v[76:79]
    buffer_load_dwordx4 v8, s[12:15], s35 offen offset:1792 lds
    s_waitcnt lgkmcnt(4)
    v_mfma_f32_16x16x32_bf16 v[64:67], a[168:171], v[40:43], v[64:67]
    ds_read_b128 v[32:35], v12 offset:49152
    v_mfma_f32_16x16x32_bf16 v[68:71], a[172:175], v[40:43], v[68:71]
    v_mfma_f32_16x16x32_bf16 v[72:75], a[168:171], v[44:47], v[72:75]
    ds_read_b128 v[36:39], v12 offset:50176
    v_mfma_f32_16x16x32_bf16 v[76:79], a[172:175], v[44:47], v[76:79]
    s_waitcnt lgkmcnt(4)
    v_mfma_f32_16x16x32_bf16 v[64:67], a[176:179], v[48:51], v[64:67]
    ds_read_b128 v[40:43], v13 offset:49152
    v_mfma_f32_16x16x32_bf16 v[68:71], a[180:183], v[48:51], v[68:71]
    v_mfma_f32_16x16x32_bf16 v[72:75], a[176:179], v[52:55], v[72:75]
    ds_read_b128 v[44:47], v13 offset:50176
    s_add_u32 m0, s34, 125056
    v_mfma_f32_16x16x32_bf16 v[76:79], a[180:183], v[52:55], v[76:79]
    buffer_load_dwordx4 v8, s[12:15], s35 offen offset:1920 lds
    s_add_u32 s35, s35, 65536
    s_min_u32 s35, s35, s52
    s_waitcnt lgkmcnt(4)
    v_mfma_f32_16x16x32_bf16 v[64:67], a[184:187], v[56:59], v[64:67]
    ds_read_b128 v[48:51], v12 offset:53248
    v_mfma_f32_16x16x32_bf16 v[68:71], a[188:191], v[56:59], v[68:71]
    v_mfma_f32_16x16x32_bf16 v[72:75], a[184:187], v[60:63], v[72:75]
    ds_read_b128 v[52:55], v12 offset:54272
    v_mfma_f32_16x16x32_bf16 v[76:79], a[188:191], v[60:63], v[76:79]
    s_waitcnt vmcnt(8)
    s_barrier
    s_waitcnt lgkmcnt(4)
    v_mfma_f32_16x16x32_bf16 v[64:67], a[192:195], v[32:35], v[64:67]
    ds_read_b128 v[56:59], v13 offset:53248
    v_mfma_f32_16x16x32_bf16 v[68:71], a[196:199], v[32:35], v[68:71]
    v_mfma_f32_16x16x32_bf16 v[72:75], a[192:195], v[36:39], v[72:75]
    ds_read_b128 v[60:63], v13 offset:54272
    s_add_u32 m0, s34, 0
    v_mfma_f32_16x16x32_bf16 v[76:79], a[196:199], v[36:39], v[76:79]
    buffer_load_dwordx4 v8, s[12:15], s35 offen offset:0 lds
    s_waitcnt lgkmcnt(4)
    v_mfma_f32_16x16x32_bf16 v[64:67], a[200:203], v[40:43], v[64:67]
    ds_read_b128 v[32:35], v12 offset:57344
    v_mfma_f32_16x16x32_bf16 v[68:71], a[204:207], v[40:43], v[68:71]
    buffer_store_dword v11, v10, s[4:7], 0 offen sc1
    v_add_u32 v11, 1, v11
    v_mfma_f32_16x16x32_bf16 v[72:75], a[200:203], v[44:47], v[72:75]
    ds_read_b128 v[36:39], v12 offset:58368
    v_mfma_f32_16x16x32_bf16 v[76:79], a[204:207], v[44:47], v[76:79]
    s_waitcnt lgkmcnt(4)
    v_mfma_f32_16x16x32_bf16 v[64:67], a[208:211], v[48:51], v[64:67]
    ds_read_b128 v[40:43], v13 offset:57344
    v_mfma_f32_16x16x32_bf16 v[68:71], a[212:215], v[48:51], v[68:71]
    v_mfma_f32_16x16x32_bf16 v[72:75], a[208:211], v[52:55], v[72:75]
    ds_read_b128 v[44:47], v13 offset:58368
    s_add_u32 m0, s34, 3968
    v_mfma_f32_16x16x32_bf16 v[76:79], a[212:215], v[52:55], v[76:79]
    buffer_load_dwordx4 v8, s[12:15], s35 offen offset:128 lds
    s_waitcnt lgkmcnt(4)
    v_mfma_f32_16x16x32_bf16 v[64:67], a[216:219], v[56:59], v[64:67]
    ds_read_b128 v[48:51], v12 offset:61440
    v_mfma_f32_16x16x32_bf16 v[68:71], a[220:223], v[56:59], v[68:71]
    v_mfma_f32_16x16x32_bf16 v[72:75], a[216:219], v[60:63], v[72:75]
    ds_read_b128 v[52:55], v12 offset:62464
    v_mfma_f32_16x16x32_bf16 v[76:79], a[220:223], v[60:63], v[76:79]
    s_waitcnt lgkmcnt(4)
    v_mfma_f32_16x16x32_bf16 v[64:67], a[224:227], v[32:35], v[64:67]
    ds_read_b128 v[56:59], v13 offset:61440
    v_mfma_f32_16x16x32_bf16 v[68:71], a[228:231], v[32:35], v[68:71]
    v_mfma_f32_16x16x32_bf16 v[72:75], a[224:227], v[36:39], v[72:75]
    ds_read_b128 v[60:63], v13 offset:62464
    s_add_u32 m0, s34, 7936
    v_mfma_f32_16x16x32_bf16 v[76:79], a[228:231], v[36:39], v[76:79]
    buffer_load_dwordx4 v8, s[12:15], s35 offen offset:256 lds
    s_waitcnt lgkmcnt(4)
    v_mfma_f32_16x16x32_bf16 v[64:67], a[232:235], v[40:43], v[64:67]
    ds_read_b128 v[32:35], v14 offset:0
    v_mfma_f32_16x16x32_bf16 v[68:71], a[236:239], v[40:43], v[68:71]
    v_mfma_f32_16x16x32_bf16 v[72:75], a[232:235], v[44:47], v[72:75]
    ds_read_b128 v[36:39], v14 offset:1024
    v_mfma_f32_16x16x32_bf16 v[76:79], a[236:239], v[44:47], v[76:79]
    s_waitcnt lgkmcnt(4)
    v_mfma_f32_16x16x32_bf16 v[64:67], a[240:243], v[48:51], v[64:67]
    ds_read_b128 v[40:43], v15 offset:0
    v_mfma_f32_16x16x32_bf16 v[68:71], a[244:247], v[48:51], v[68:71]
    v_mfma_f32_16x16x32_bf16 v[72:75], a[240:243], v[52:55], v[72:75]
    ds_read_b128 v[44:47], v15 offset:1024
    s_add_u32 m0, s34, 11904
    v_mfma_f32_16x16x32_bf16 v[76:79], a[244:247], v[52:55], v[76:79]
    buffer_load_dwordx4 v8, s[12:15], s35 offen offset:384 lds
    s_waitcnt lgkmcnt(4)
    v_mfma_f32_16x16x32_bf16 v[64:67], a[248:251], v[56:59], v[64:67]
    ds_read_b128 v[48:51], v14 offset:4096
    v_mfma_f32_16x16x32_bf16 v[68:71], a[252:255], v[56:59], v[68:71]
    v_mfma_f32_16x16x32_bf16 v[72:75], a[248:251], v[60:63], v[72:75]
    ds_read_b128 v[52:55], v14 offset:5120
    v_mfma_f32_16x16x32_bf16 v[76:79], a[252:255], v[60:63], v[76:79]
    s_waitcnt lgkmcnt(4)
    v_mfma_f32_16x16x32_bf16 v[80:83], a[0:3], v[32:35], 0
    ds_read_b128 v[56:59], v15 offset:4096
    v_mfma_f32_16x16x32_bf16 v[84:87], a[4:7], v[32:35], 0
    v_mfma_f32_16x16x32_bf16 v[88:91], a[0:3], v[36:39], 0
    ds_read_b128 v[60:63], v15 offset:5120
    s_add_u32 m0, s34, 15872
    v_mfma_f32_16x16x32_bf16 v[92:95], a[4:7], v[36:39], 0
    buffer_load_dwordx4 v8, s[12:15], s35 offen offset:512 lds
    s_waitcnt lgkmcnt(4)
    v_mfma_f32_16x16x32_bf16 v[80:83], a[8:11], v[40:43], v[80:83]
    ds_read_b128 v[32:35], v14 offset:8192
    v_mfma_f32_16x16x32_bf16 v[84:87], a[12:15], v[40:43], v[84:87]
    v_mfma_f32_16x16x32_bf16 v[88:91], a[8:11], v[44:47], v[88:91]
    ds_read_b128 v[36:39], v14 offset:9216
    v_mfma_f32_16x16x32_bf16 v[92:95], a[12:15], v[44:47], v[92:95]
    s_waitcnt lgkmcnt(4)
    v_mfma_f32_16x16x32_bf16 v[80:83], a[16:19], v[48:51], v[80:83]
    ds_read_b128 v[40:43], v15 offset:8192
    v_mfma_f32_16x16x32_bf16 v[84:87], a[20:23], v[48:51], v[84:87]
    v_cvt_pk_bf16_f32 v96, v64, v65
    v_mfma_f32_16x16x32_bf16 v[88:91], a[16:19], v[52:55], v[88:91]
    ds_read_b128 v[44:47], v15 offset:9216
    s_add_u32 m0, s34, 19840
    v_mfma_f32_16x16x32_bf16 v[92:95], a[20:23], v[52:55], v[92:95]
    buffer_load_dwordx4 v8, s[12:15], s35 offen offset:640 lds
    v_cvt_pk_bf16_f32 v97, v66, v67
    s_waitcnt lgkmcnt(4)
    v_mfma_f32_16x16x32_bf16 v[80:83], a[24:27], v[56:59], v[80:83]
    ds_read_b128 v[48:51], v14 offset:12288
    v_mfma_f32_16x16x32_bf16 v[84:87], a[28:31], v[56:59], v[84:87]
    v_cvt_pk_bf16_f32 v98, v68, v69
    v_mfma_f32_16x16x32_bf16 v[88:91], a[24:27], v[60:63], v[88:91]
    ds_read_b128 v[52:55], v14 offset:13312
    v_mfma_f32_16x16x32_bf16 v[92:95], a[28:31], v[60:63], v[92:95]
    v_cvt_pk_bf16_f32 v99, v70, v71
    s_waitcnt lgkmcnt(4)
    v_mfma_f32_16x16x32_bf16 v[80:83], a[32:35], v[32:35], v[80:83]
    ds_read_b128 v[56:59], v15 offset:12288
    v_mfma_f32_16x16x32_bf16 v[84:87], a[36:39], v[32:35], v[84:87]
    v_cvt_pk_bf16_f32 v100, v72, v73
    v_mfma_f32_16x16x32_bf16 v[88:91], a[32:35], v[36:39], v[88:91]
    ds_read_b128 v[60:63], v15 offset:13312
    s_add_u32 m0, s34, 23808
    v_mfma_f32_16x16x32_bf16 v[92:95], a[36:39], v[36:39], v[92:95]
    buffer_load_dwordx4 v8, s[12:15], s35 offen offset:768 lds
    v_cvt_pk_bf16_f32 v101, v74, v75
    s_waitcnt lgkmcnt(4)
    v_mfma_f32_16x16x32_bf16 v[80:83], a[40:43], v[40:43], v[80:83]
    ds_read_b128 v[32:35], v14 offset:16384
    v_mfma_f32_16x16x32_bf16 v[84:87], a[44:47], v[40:43], v[84:87]
    v_cvt_pk_bf16_f32 v102, v76, v77
    v_mfma_f32_16x16x32_bf16 v[88:91], a[40:43], v[44:47], v[88:91]
    ds_read_b128 v[36:39], v14 offset:17408
    v_mfma_f32_16x16x32_bf16 v[92:95], a[44:47], v[44:47], v[92:95]
    v_cvt_pk_bf16_f32 v103, v78, v79
    buffer_store_dwordx4 v[96:99], v9, s[4:7], s36 offen sc1
    s_waitcnt lgkmcnt(4)
    v_mfma_f32_16x16x32_bf16 v[80:83], a[48:51], v[48:51], v[80:83]
    ds_read_b128 v[40:43], v15 offset:16384
    v_mfma_f32_16x16x32_bf16 v[84:87], a[52:55], v[48:51], v[84:87]
    v_mfma_f32_16x16x32_bf16 v[88:91], a[48:51], v[52:55], v[88:91]
    ds_read_b128 v[44:47], v15 offset:17408
    s_add_u32 m0, s34, 27776
    v_mfma_f32_16x16x32_bf16 v[92:95], a[52:55], v[52:55], v[92:95]
    buffer_load_dwordx4 v8, s[12:15], s35 offen offset:896 lds
    s_waitcnt lgkmcnt(4)
    v_mfma_f32_16x16x32_bf16 v[80:83], a[56:59], v[56:59], v[80:83]
    ds_read_b128 v[48:51], v14 offset:20480
    v_mfma_f32_16x16x32_bf16 v[84:87], a[60:63], v[56:59], v[84:87]
    v_mfma_f32_16x16x32_bf16 v[88:91], a[56:59], v[60:63], v[88:91]
    ds_read_b128 v[52:55], v14 offset:21504
    v_mfma_f32_16x16x32_bf16 v[92:95], a[60:63], v[60:63], v[92:95]
    buffer_store_dwordx4 v[100:103], v9, s[4:7], s36 offen offset:128 sc1
    s_add_u32 s36, s36, s37
    s_waitcnt vmcnt(8)
    s_barrier
    s_waitcnt lgkmcnt(4)
    v_mfma_f32_16x16x32_bf16 v[80:83], a[64:67], v[32:35], v[80:83]
    ds_read_b128 v[56:59], v15 offset:20480
    v_mfma_f32_16x16x32_bf16 v[84:87], a[68:71], v[32:35], v[84:87]
    v_mfma_f32_16x16x32_bf16 v[88:91], a[64:67], v[36:39], v[88:91]
    ds_read_b128 v[60:63], v15 offset:21504
    s_add_u32 m0, s34, 31744
    v_mfma_f32_16x16x32_bf16 v[92:95], a[68:71], v[36:39], v[92:95]
    buffer_load_dwordx4 v8, s[12:15], s35 offen offset:1024 lds
    s_waitcnt lgkmcnt(4)
    v_mfma_f32_16x16x32_bf16 v[80:83], a[72:75], v[40:43], v[80:83]
    ds_read_b128 v[32:35], v14 offset:24576
    v_mfma_f32_16x16x32_bf16 v[84:87], a[76:79], v[40:43], v[84:87]
    v_mfma_f32_16x16x32_bf16 v[88:91], a[72:75], v[44:47], v[88:91]
    ds_read_b128 v[36:39], v14 offset:25600
    v_mfma_f32_16x16x32_bf16 v[92:95], a[76:79], v[44:47], v[92:95]
    s_waitcnt lgkmcnt(4)
    v_mfma_f32_16x16x32_bf16 v[80:83], a[80:83], v[48:51], v[80:83]
    ds_read_b128 v[40:43], v15 offset:24576
    v_mfma_f32_16x16x32_bf16 v[84:87], a[84:87], v[48:51], v[84:87]
    v_mfma_f32_16x16x32_bf16 v[88:91], a[80:83], v[52:55], v[88:91]
    ds_read_b128 v[44:47], v15 offset:25600
    s_add_u32 m0, s34, 35712
    v_mfma_f32_16x16x32_bf16 v[92:95], a[84:87], v[52:55], v[92:95]
    buffer_load_dwordx4 v8, s[12:15], s35 offen offset:1152 lds
    s_waitcnt lgkmcnt(4)
    v_mfma_f32_16x16x32_bf16 v[80:83], a[88:91], v[56:59], v[80:83]
    ds_read_b128 v[48:51], v14 offset:28672
    v_mfma_f32_16x16x32_bf16 v[84:87], a[92:95], v[56:59], v[84:87]
    v_mfma_f32_16x16x32_bf16 v[88:91], a[88:91], v[60:63], v[88:91]
    ds_read_b128 v[52:55], v14 offset:29696
    v_mfma_f32_16x16x32_bf16 v[92:95], a[92:95], v[60:63], v[92:95]
    s_waitcnt lgkmcnt(4)
    v_mfma_f32_16x16x32_bf16 v[80:83], a[96:99], v[32:35], v[80:83]
    ds_read_b128 v[56:59], v15 offset:28672
    v_mfma_f32_16x16x32_bf16 v[84:87], a[100:103], v[32:35], v[84:87]
    v_mfma_f32_16x16x32_bf16 v[88:91], a[96:99], v[36:39], v[88:91]
    ds_read_b128 v[60:63], v15 offset:29696
    s_add_u32 m0, s34, 39680
    v_mfma_f32_16x16x32_bf16 v[92:95], a[100:103], v[36:39], v[92:95]
    buffer_load_dwordx4 v8, s[12:15], s35 offen offset:1280 lds
    s_waitcnt lgkmcnt(4)
    v_mfma_f32_16x16x32_bf16 v[80:83], a[104:107], v[40:43], v[80:83]
    ds_read_b128 v[32:35], v14 offset:32768
    v_mfma_f32_16x16x32_bf16 v[84:87], a[108:111], v[40:43], v[84:87]
    v_mfma_f32_16x16x32_bf16 v[88:91], a[104:107], v[44:47], v[88:91]
    ds_read_b128 v[36:39], v14 offset:33792
    v_mfma_f32_16x16x32_bf16 v[92:95], a[108:111], v[44:47], v[92:95]
    s_waitcnt lgkmcnt(4)
    v_mfma_f32_16x16x32_bf16 v[80:83], a[112:115], v[48:51], v[80:83]
    ds_read_b128 v[40:43], v15 offset:32768
    v_mfma_f32_16x16x32_bf16 v[84:87], a[116:119], v[48:51], v[84:87]
    v_mfma_f32_16x16x32_bf16 v[88:91], a[112:115], v[52:55], v[88:91]
    ds_read_b128 v[44:47], v15 offset:33792
    s_add_u32 m0, s34, 43648
    v_mfma_f32_16x16x32_bf16 v[92:95], a[116:119], v[52:55], v[92:95]
    buffer_load_dwordx4 v8, s[12:15], s35 offen offset:1408 lds
    s_waitcnt lgkmcnt(4)
    v_mfma_f32_16x16x32_bf16 v[80:83], a[120:123], v[56:59], v[80:83]
    ds_read_b128 v[48:51], v14 offset:36864
    v_mfma_f32_16x16x32_bf16 v[84:87], a[124:127], v[56:59], v[84:87]
    v_mfma_f32_16x16x32_bf16 v[88:91], a[120:123], v[60:63], v[88:91]
    ds_read_b128 v[52:55], v14 offset:37888
    v_mfma_f32_16x16x32_bf16 v[92:95], a[124:127], v[60:63], v[92:95]
    s_waitcnt lgkmcnt(4)
    v_mfma_f32_16x16x32_bf16 v[80:83], a[128:131], v[32:35], v[80:83]
    ds_read_b128 v[56:59], v15 offset:36864
    v_mfma_f32_16x16x32_bf16 v[84:87], a[132:135], v[32:35], v[84:87]
    v_mfma_f32_16x16x32_bf16 v[88:91], a[128:131], v[36:39], v[88:91]
    ds_read_b128 v[60:63], v15 offset:37888
    s_add_u32 m0, s34, 47616
    v_mfma_f32_16x16x32_bf16 v[92:95], a[132:135], v[36:39], v[92:95]
    buffer_load_dwordx4 v8, s[12:15], s35 offen offset:1536 lds
    s_waitcnt lgkmcnt(4)
    v_mfma_f32_16x16x32_bf16 v[80:83], a[136:139], v[40:43], v[80:83]
    ds_read_b128 v[32:35], v14 offset:40960
    v_mfma_f32_16x16x32_bf16 v[84:87], a[140:143], v[40:43], v[84:87]
    v_mfma_f32_16x16x32_bf16 v[88:91], a[136:139], v[44:47], v[88:91]
    ds_read_b128 v[36:39], v14 offset:41984
    v_mfma_f32_16x16x32_bf16 v[92:95], a[140:143], v[44:47], v[92:95]
    s_waitcnt lgkmcnt(4)
    v_mfma_f32_16x16x32_bf16 v[80:83], a[144:147], v[48:51], v[80:83]
    ds_read_b128 v[40:43], v15 offset:40960
    v_mfma_f32_16x16x32_bf16 v[84:87], a[148:151], v[48:51], v[84:87]
    v_mfma_f32_16x16x32_bf16 v[88:91], a[144:147], v[52:55], v[88:91]
    ds_read_b128 v[44:47], v15 offset:41984
    s_add_u32 m0, s34, 51584
    v_mfma_f32_16x16x32_bf16 v[92:95], a[148:151], v[52:55], v[92:95]
    buffer_load_dwordx4 v8, s[12:15], s35 offen offset:1664 lds
    s_waitcnt lgkmcnt(4)
    v_mfma_f32_16x16x32_bf16 v[80:83], a[152:155], v[56:59], v[80:83]
    ds_read_b128 v[48:51], v14 offset:45056
    v_mfma_f32_16x16x32_bf16 v[84:87], a[156:159], v[56:59], v[84:87]
    v_mfma_f32_16x16x32_bf16 v[88:91], a[152:155], v[60:63], v[88:91]
    ds_read_b128 v[52:55], v14 offset:46080
    v_mfma_f32_16x16x32_bf16 v[92:95], a[156:159], v[60:63], v[92:95]
    s_waitcnt lgkmcnt(4)
    v_mfma_f32_16x16x32_bf16 v[80:83], a[160:163], v[32:35], v[80:83]
    ds_read_b128 v[56:59], v15 offset:45056
    v_mfma_f32_16x16x32_bf16 v[84:87], a[164:167], v[32:35], v[84:87]
    v_mfma_f32_16x16x32_bf16 v[88:91], a[160:163], v[36:39], v[88:91]
    ds_read_b128 v[60:63], v15 offset:46080
    s_add_u32 m0, s34, 55552
    v_mfma_f32_16x16x32_bf16 v[92:95], a[164:167], v[36:39], v[92:95]
    buffer_load_dwordx4 v8, s[12:15], s35 offen offset:1792 lds
    s_waitcnt lgkmcnt(4)
    v_mfma_f32_16x16x32_bf16 v[80:83], a[168:171], v[40:43], v[80:83]
    ds_read_b128 v[32:35], v14 offset:49152
    v_mfma_f32_16x16x32_bf16 v[84:87], a[172:175], v[40:43], v[84:87]
    v_mfma_f32_16x16x32_bf16 v[88:91], a[168:171], v[44:47], v[88:91]
    ds_read_b128 v[36:39], v14 offset:50176
    v_mfma_f32_16x16x32_bf16 v[92:95], a[172:175], v[44:47], v[92:95]
    s_waitcnt lgkmcnt(4)
    v_mfma_f32_16x16x32_bf16 v[80:83], a[176:179], v[48:51], v[80:83]
    ds_read_b128 v[40:43], v15 offset:49152
    v_mfma_f32_16x16x32_bf16 v[84:87], a[180:183], v[48:51], v[84:87]
    v_mfma_f32_16x16x32_bf16 v[88:91], a[176:179], v[52:55], v[88:91]
    ds_read_b128 v[44:47], v15 offset:50176
    s_add_u32 m0, s34, 59520
    v_mfma_f32_16x16x32_bf16 v[92:95], a[180:183], v[52:55], v[92:95]
    buffer_load_dwordx4 v8, s[12:15], s35 offen offset:1920 lds
    s_add_u32 s35, s35, 65536
    s_min_u32 s35, s35, s52
    s_waitcnt lgkmcnt(4)
    v_mfma_f32_16x16x32_bf16 v[80:83], a[184:187], v[56:59], v[80:83]
    ds_read_b128 v[48:51], v14 offset:53248
    v_mfma_f32_16x16x32_bf16 v[84:87], a[188:191], v[56:59], v[84:87]
    v_mfma_f32_16x16x32_bf16 v[88:91], a[184:187], v[60:63], v[88:91]
    ds_read_b128 v[52:55], v14 offset:54272
    v_mfma_f32_16x16x32_bf16 v[92:95], a[188:191], v[60:63], v[92:95]
    s_waitcnt vmcnt(8)
    s_barrier
    s_waitcnt lgkmcnt(4)
    v_mfma_f32_16x16x32_bf16 v[80:83], a[192:195], v[32:35], v[80:83]
    ds_read_b128 v[56:59], v15 offset:53248
    v_mfma_f32_16x16x32_bf16 v[84:87], a[196:199], v[32:35], v[84:87]
    v_mfma_f32_16x16x32_bf16 v[88:91], a[192:195], v[36:39], v[88:91]
    ds_read_b128 v[60:63], v15 offset:54272
    s_add_u32 m0, s34, 65536
    v_mfma_f32_16x16x32_bf16 v[92:95], a[196:199], v[36:39], v[92:95]
    buffer_load_dwordx4 v8, s[12:15], s35 offen offset:0 lds
    s_waitcnt lgkmcnt(4)
    v_mfma_f32_16x16x32_bf16 v[80:83], a[200:203], v[40:43], v[80:83]
    ds_read_b128 v[32:35], v14 offset:57344
    v_mfma_f32_16x16x32_bf16 v[84:87], a[204:207], v[40:43], v[84:87]
    buffer_store_dword v11, v10, s[4:7], 0 offen sc1
    v_add_u32 v11, 1, v11
    v_mfma_f32_16x16x32_bf16 v[88:91], a[200:203], v[44:47], v[88:91]
    ds_read_b128 v[36:39], v14 offset:58368
    v_mfma_f32_16x16x32_bf16 v[92:95], a[204:207], v[44:47], v[92:95]
    s_waitcnt lgkmcnt(4)
    v_mfma_f32_16x16x32_bf16 v[80:83], a[208:211], v[48:51], v[80:83]
    ds_read_b128 v[40:43], v15 offset:57344
    v_mfma_f32_16x16x32_bf16 v[84:87], a[212:215], v[48:51], v[84:87]
    v_mfma_f32_16x16x32_bf16 v[88:91], a[208:211], v[52:55], v[88:91]
    ds_read_b128 v[44:47], v15 offset:58368
    s_add_u32 m0, s34, 69504
    v_mfma_f32_16x16x32_bf16 v[92:95], a[212:215], v[52:55], v[92:95]
    buffer_load_dwordx4 v8, s[12:15], s35 offen offset:128 lds
    s_waitcnt lgkmcnt(4)
    v_mfma_f32_16x16x32_bf16 v[80:83], a[216:219], v[56:59], v[80:83]
    ds_read_b128 v[48:51], v14 offset:61440
    v_mfma_f32_16x16x32_bf16 v[84:87], a[220:223], v[56:59], v[84:87]
    v_mfma_f32_16x16x32_bf16 v[88:91], a[216:219], v[60:63], v[88:91]
    ds_read_b128 v[52:55], v14 offset:62464
    v_mfma_f32_16x16x32_bf16 v[92:95], a[220:223], v[60:63], v[92:95]
    s_waitcnt lgkmcnt(4)
    v_mfma_f32_16x16x32_bf16 v[80:83], a[224:227], v[32:35], v[80:83]
    ds_read_b128 v[56:59], v15 offset:61440
    v_mfma_f32_16x16x32_bf16 v[84:87], a[228:231], v[32:35], v[84:87]
    v_mfma_f32_16x16x32_bf16 v[88:91], a[224:227], v[36:39], v[88:91]
    ds_read_b128 v[60:63], v15 offset:62464
    s_add_u32 m0, s34, 73472
    v_mfma_f32_16x16x32_bf16 v[92:95], a[228:231], v[36:39], v[92:95]
    buffer_load_dwordx4 v8, s[12:15], s35 offen offset:256 lds
    s_waitcnt lgkmcnt(4)
    v_mfma_f32_16x16x32_bf16 v[80:83], a[232:235], v[40:43], v[80:83]
    ds_read_b128 v[32:35], v12 offset:0
    v_mfma_f32_16x16x32_bf16 v[84:87], a[236:239], v[40:43], v[84:87]
    v_mfma_f32_16x16x32_bf16 v[88:91], a[232:235], v[44:47], v[88:91]
    ds_read_b128 v[36:39], v12 offset:1024
    v_mfma_f32_16x16x32_bf16 v[92:95], a[236:239], v[44:47], v[92:95]
    s_waitcnt lgkmcnt(4)
    v_mfma_f32_16x16x32_bf16 v[80:83], a[240:243], v[48:51], v[80:83]
    ds_read_b128 v[40:43], v13 offset:0
    v_mfma_f32_16x16x32_bf16 v[84:87], a[244:247], v[48:51], v[84:87]
    v_mfma_f32_16x16x32_bf16 v[88:91], a[240:243], v[52:55], v[88:91]
    ds_read_b128 v[44:47], v13 offset:1024
    s_add_u32 m0, s34, 77440
    v_mfma_f32_16x16x32_bf16 v[92:95], a[244:247], v[52:55], v[92:95]
    buffer_load_dwordx4 v8, s[12:15], s35 offen offset:384 lds
    s_waitcnt lgkmcnt(4)
    v_mfma_f32_16x16x32_bf16 v[80:83], a[248:251], v[56:59], v[80:83]
    ds_read_b128 v[48:51], v12 offset:4096
    v_mfma_f32_16x16x32_bf16 v[84:87], a[252:255], v[56:59], v[84:87]
    v_mfma_f32_16x16x32_bf16 v[88:91], a[248:251], v[60:63], v[88:91]
    ds_read_b128 v[52:55], v12 offset:5120
    v_mfma_f32_16x16x32_bf16 v[92:95], a[252:255], v[60:63], v[92:95]
    s_add_u32 s30, s30, 2
    s_cmp_lt_u32 s30, s51
    s_cbranch_scc1 sl_loop_66
    v_cvt_pk_bf16_f32 v96, v80, v81
    v_cvt_pk_bf16_f32 v97, v82, v83
    v_cvt_pk_bf16_f32 v98, v84, v85
    v_cvt_pk_bf16_f32 v99, v86, v87
    v_cvt_pk_bf16_f32 v100, v88, v89
    v_cvt_pk_bf16_f32 v101, v90, v91
    v_cvt_pk_bf16_f32 v102, v92, v93
    v_cvt_pk_bf16_f32 v103, v94, v95
    s_branch sl_e_65
sl_v_64:
sl_loop_67:
    s_waitcnt lgkmcnt(4)
    v_mfma_f32_16x16x32_bf16 v[64:67], v[32:35], a[0:3], 0
    ds_read_b128 v[56:59], v13 offset:4096
    v_mfma_f32_16x16x32_bf16 v[68:71], v[32:35], a[4:7], 0
    v_mfma_f32_16x16x32_bf16 v[72:75], v[36:39], a[0:3], 0
    ds_read_b128 v[60:63], v13 offset:5120
    s_add_u32 m0, s34, 81408
    v_mfma_f32_16x16x32_bf16 v[76:79], v[36:39], a[4:7], 0
    buffer_load_dwordx4 v8, s[12:15], s35 offen offset:512 lds
    s_waitcnt lgkmcnt(4)
    v_mfma_f32_16x16x32_bf16 v[64:67], v[40:43], a[8:11], v[64:67]
    ds_read_b128 v[32:35], v12 offset:8192
    v_mfma_f32_16x16x32_bf16 v[68:71], v[40:43], a[12:15], v[68:71]
    v_mfma_f32_16x16x32_bf16 v[72:75], v[44:47], a[8:11], v[72:75]
    ds_read_b128 v[36:39], v12 offset:9216
    v_mfma_f32_16x16x32_bf16 v[76:79], v[44:47], a[12:15], v[76:79]
    s_waitcnt lgkmcnt(4)
    v_mfma_f32_16x16x32_bf16 v[64:67], v[48:51], a[16:19], v[64:67]
    ds_read_b128 v[40:43], v13 offset:8192
    v_mfma_f32_16x16x32_bf16 v[68:71], v[48:51], a[20:23], v[68:71]
    v_cvt_pk_bf16_f32 v96, v80, v81
    v_mfma_f32_16x16x32_bf16 v[72:75], v[52:55], a[16:19], v[72:75]
    ds_read_b128 v[44:47], v13 offset:9216
    s_add_u32 m0, s34, 85376
    v_mfma_f32_16x16x32_bf16 v[76:79], v[52:55], a[20:23], v[76:79]
    buffer_load_dwordx4 v8, s[12:15], s35 offen offset:640 lds
    v_cvt_pk_bf16_f32 v97, v82, v83
    s_waitcnt lgkmcnt(4)
    v_mfma_f32_16x16x32_bf16 v[64:67], v[56:59], a[24:27], v[64:67]
    ds_read_b128 v[48:51], v12 offset:12288
    v_mfma_f32_16x16x32_bf16 v[68:71], v[56:59], a[28:31], v[68:71]
    v_cvt_pk_bf16_f32 v98, v88, v89
    v_mfma_f32_16x16x32_bf16 v[72:75], v[60:63], a[24:27], v[72:75]
    ds_read_b128 v[52:55], v12 offset:13312
    v_mfma_f32_16x16x32_bf16 v[76:79], v[60:63], a[28:31], v[76:79]
    v_cvt_pk_bf16_f32 v99, v90, v91
    s_waitcnt lgkmcnt(4)
    v_mfma_f32_16x16x32_bf16 v[64:67], v[32:35], a[32:35], v[64:67]
    ds_read_b128 v[56:59], v13 offset:12288
    v_mfma_f32_16x16x32_bf16 v[68:71], v[32:35], a[36:39], v[68:71]
    v_cvt_pk_bf16_f32 v100, v84, v85
    v_mfma_f32_16x16x32_bf16 v[72:75], v[36:39], a[32:35], v[72:75]
    ds_read_b128 v[60:63], v13 offset:13312
    s_add_u32 m0, s34, 89344
    v_mfma_f32_16x16x32_bf16 v[76:79], v[36:39], a[36:39], v[76:79]
    buffer_load_dwordx4 v8, s[12:15], s35 offen offset:768 lds
    v_cvt_pk_bf16_f32 v101, v86, v87
    s_waitcnt lgkmcnt(4)
    v_mfma_f32_16x16x32_bf16 v[64:67], v[40:43], a[40:43], v[64:67]
    ds_read_b128 v[32:35], v12 offset:16384
    v_mfma_f32_16x16x32_bf16 v[68:71], v[40:43], a[44:47], v[68:71]
    v_cvt_pk_bf16_f32 v102, v92, v93
    v_mfma_f32_16x16x32_bf16 v[72:75], v[44:47], a[40:43], v[72:75]
    ds_read_b128 v[36:39], v12 offset:17408
    v_mfma_f32_16x16x32_bf16 v[76:79], v[44:47], a[44:47], v[76:79]
    v_cvt_pk_bf16_f32 v103, v94, v95
    buffer_store_dwordx4 v[96:99], v9, s[4:7], s36 offen sc1
    s_waitcnt lgkmcnt(4)
    v_mfma_f32_16x16x32_bf16 v[64:67], v[48:51], a[48:51], v[64:67]
    ds_read_b128 v[40:43], v13 offset:16384
    v_mfma_f32_16x16x32_bf16 v[68:71], v[48:51], a[52:55], v[68:71]
    v_mfma_f32_16x16x32_bf16 v[72:75], v[52:55], a[48:51], v[72:75]
    ds_read_b128 v[44:47], v13 offset:17408
    s_add_u32 m0, s34, 93312
    v_mfma_f32_16x16x32_bf16 v[76:79], v[52:55], a[52:55], v[76:79]
    buffer_load_dwordx4 v8, s[12:15], s35 offen offset:896 lds
    s_waitcnt lgkmcnt(4)
    v_mfma_f32_16x16x32_bf16 v[64:67], v[56:59], a[56:59], v[64:67]
    ds_read_b128 v[48:51], v12 offset:20480
    v_mfma_f32_16x16x32_bf16 v[68:71], v[56:59], a[60:63], v[68:71]
    v_mfma_f32_16x16x32_bf16 v[72:75], v[60:63], a[56:59], v[72:75]
    ds_read_b128 v[52:55], v12 offset:21504
    v_mfma_f32_16x16x32_bf16 v[76:79], v[60:63], a[60:63], v[76:79]
    buffer_store_dwordx4 v[100:103], v9, s[4:7], s36 offen offset:128 sc1
    s_add_u32 s36, s36, s37
    s_waitcnt vmcnt(8)
    s_barrier
    s_waitcnt lgkmcnt(4)
    v_mfma_f32_16x16x32_bf16 v[64:67], v[32:35], a[64:67], v[64:67]
    ds_read_b128 v[56:59], v13 offset:20480
    v_mfma_f32_16x16x32_bf16 v[68:71], v[32:35], a[68:71], v[68:71]
    v_mfma_f32_16x16x32_bf16 v[72:75], v[36:39], a[64:67], v[72:75]
    ds_read_b128 v[60:63], v13 offset:21504
    s_add_u32 m0, s34, 97280
    v_mfma_f32_16x16x32_bf16 v[76:79], v[36:39], a[68:71], v[76:79]
    buffer_load_dwordx4 v8, s[12:15], s35 offen offset:1024 lds
    s_waitcnt lgkmcnt(4)
    v_mfma_f32_16x16x32_bf16 v[64:67], v[40:43], a[72:75], v[64:67]
    ds_read_b128 v[32:35], v12 offset:24576
    v_mfma_f32_16x16x32_bf16 v[68:71], v[40:43], a[76:79], v[68:71]
    v_mfma_f32_16x16x32_bf16 v[72:75], v[44:47], a[72:75], v[72:75]
    ds_read_b128 v[36:39], v12 offset:25600
    v_mfma_f32_16x16x32_bf16 v[76:79], v[44:47], a[76:79], v[76:79]
    s_waitcnt lgkmcnt(4)
    v_mfma_f32_16x16x32_bf16 v[64:67], v[48:51], a[80:83], v[64:67]
    ds_read_b128 v[40:43], v13 offset:24576
    v_mfma_f32_16x16x32_bf16 v[68:71], v[48:51], a[84:87], v[68:71]
    v_and_b32 v9, 0xffffff, v9
    v_mfma_f32_16x16x32_bf16 v[72:75], v[52:55], a[80:83], v[72:75]
    ds_read_b128 v[44:47], v13 offset:25600
    s_add_u32 m0, s34, 101248
    v_mfma_f32_16x16x32_bf16 v[76:79], v[52:55], a[84:87], v[76:79]
    buffer_load_dwordx4 v8, s[12:15], s35 offen offset:1152 lds
    s_waitcnt lgkmcnt(4)
    v_mfma_f32_16x16x32_bf16 v[64:67], v[56:59], a[88:91], v[64:67]
    ds_read_b128 v[48:51], v12 offset:28672
    v_mfma_f32_16x16x32_bf16 v[68:71], v[56:59], a[92:95], v[68:71]
    v_mfma_f32_16x16x32_bf16 v[72:75], v[60:63], a[88:91], v[72:75]
    ds_read_b128 v[52:55], v12 offset:29696
    v_mfma_f32_16x16x32_bf16 v[76:79], v[60:63], a[92:95], v[76:79]
    s_waitcnt lgkmcnt(4)
    v_mfma_f32_16x16x32_bf16 v[64:67], v[32:35], a[96:99], v[64:67]
    ds_read_b128 v[56:59], v13 offset:28672
    v_mfma_f32_16x16x32_bf16 v[68:71], v[32:35], a[100:103], v[68:71]
    v_mfma_f32_16x16x32_bf16 v[72:75], v[36:39], a[96:99], v[72:75]
    ds_read_b128 v[60:63], v13 offset:29696
    s_add_u32 m0, s34, 105216
    v_mfma_f32_16x16x32_bf16 v[76:79], v[36:39], a[100:103], v[76:79]
    buffer_load_dwordx4 v8, s[12:15], s35 offen offset:1280 lds
    s_waitcnt lgkmcnt(4)
    v_mfma_f32_16x16x32_bf16 v[64:67], v[40:43], a[104:107], v[64:67]
    ds_read_b128 v[32:35], v12 offset:32768
    v_mfma_f32_16x16x32_bf16 v[68:71], v[40:43], a[108:111], v[68:71]
    v_mfma_f32_16x16x32_bf16 v[72:75], v[44:47], a[104:107], v[72:75]
    ds_read_b128 v[36:39], v12 offset:33792
    v_mfma_f32_16x16x32_bf16 v[76:79], v[44:47], a[108:111], v[76:79]
    s_waitcnt lgkmcnt(4)
    v_mfma_f32_16x16x32_bf16 v[64:67], v[48:51], a[112:115], v[64:67]
    ds_read_b128 v[40:43], v13 offset:32768
    v_mfma_f32_16x16x32_bf16 v[68:71], v[48:51], a[116:119], v[68:71]
    v_mfma_f32_16x16x32_bf16 v[72:75], v[52:55], a[112:115], v[72:75]
    ds_read_b128 v[44:47], v13 offset:33792
    s_add_u32 m0, s34, 109184
    v_mfma_f32_16x16x32_bf16 v[76:79], v[52:55], a[116:119], v[76:79]
    buffer_load_dwordx4 v8, s[12:15], s35 offen offset:1408 lds
    s_waitcnt lgkmcnt(4)
    v_mfma_f32_16x16x32_bf16 v[64:67], v[56:59], a[120:123], v[64:67]
    ds_read_b128 v[48:51], v12 offset:36864
    v_mfma_f32_16x16x32_bf16 v[68:71], v[56:59], a[124:127], v[68:71]
    v_mfma_f32_16x16x32_bf16 v[72:75], v[60:63], a[120:123], v[72:75]
    ds_read_b128 v[52:55], v12 offset:37888
    v_mfma_f32_16x16x32_bf16 v[76:79], v[60:63], a[124:127], v[76:79]
    s_waitcnt lgkmcnt(4)
    v_mfma_f32_16x16x32_bf16 v[64:67], v[32:35], a[128:131], v[64:67]
    ds_read_b128 v[56:59], v13 offset:36864
    v_mfma_f32_16x16x32_bf16 v[68:71], v[32:35], a[132:135], v[68:71]
    v_mfma_f32_16x16x32_bf16 v[72:75], v[36:39], a[128:131], v[72:75]
    ds_read_b128 v[60:63], v13 offset:37888
    s_add_u32 m0, s34, 113152
    v_mfma_f32_16x16x32_bf16 v[76:79], v[36:39], a[132:135], v[76:79]
    buffer_load_dwordx4 v8, s[12:15], s35 offen offset:1536 lds
    s_waitcnt lgkmcnt(4)
    v_mfma_f32_16x16x32_bf16 v[64:67], v[40:43], a[136:139], v[64:67]
    ds_read_b128 v[32:35], v12 offset:40960
    v_mfma_f32_16x16x32_bf16 v[68:71], v[40:43], a[140:143], v[68:71]
    v_mfma_f32_16x16x32_bf16 v[72:75], v[44:47], a[136:139], v[72:75]
    ds_read_b128 v[36:39], v12 offset:41984
    v_mfma_f32_16x16x32_bf16 v[76:79], v[44:47], a[140:143], v[76:79]
    s_waitcnt lgkmcnt(4)
    v_mfma_f32_16x16x32_bf16 v[64:67], v[48:51], a[144:147], v[64:67]
    ds_read_b128 v[40:43], v13 offset:40960
    v_mfma_f32_16x16x32_bf16 v[68:71], v[48:51], a[148:151], v[68:71]
    v_mfma_f32_16x16x32_bf16 v[72:75], v[52:55], a[144:147], v[72:75]
    ds_read_b128 v[44:47], v13 offset:41984
    s_add_u32 m0, s34, 117120
    v_mfma_f32_16x16x32_bf16 v[76:79], v[52:55], a[148:151], v[76:79]
    buffer_load_dwordx4 v8, s[12:15], s35 offen offset:1664 lds
    s_waitcnt lgkmcnt(4)
    v_mfma_f32_16x16x32_bf16 v[64:67], v[56:59], a[152:155], v[64:67]
    ds_read_b128 v[48:51], v12 offset:45056
    v_mfma_f32_16x16x32_bf16 v[68:71], v[56:59], a[156:159], v[68:71]
    v_mfma_f32_16x16x32_bf16 v[72:75], v[60:63], a[152:155], v[72:75]
    ds_read_b128 v[52:55], v12 offset:46080
    v_mfma_f32_16x16x32_bf16 v[76:79], v[60:63], a[156:159], v[76:79]
    s_waitcnt lgkmcnt(4)
    v_mfma_f32_16x16x32_bf16 v[64:67], v[32:35], a[160:163], v[64:67]
    ds_read_b128 v[56:59], v13 offset:45056
    v_mfma_f32_16x16x32_bf16 v[68:71], v[32:35], a[164:167], v[68:71]
    v_mfma_f32_16x16x32_bf16 v[72:75], v[36:39], a[160:163], v[72:75]
    ds_read_b128 v[60:63], v13 offset:46080
    s_add_u32 m0, s34, 121088
    v_mfma_f32_16x16x32_bf16 v[76:79], v[36:39], a[164:167], v[76:79]
    buffer_load_dwordx4 v8, s[12:15], s35 offen offset:1792 lds
    s_waitcnt lgkmcnt(4)
    v_mfma_f32_16x16x32_bf16 v[64:67], v[40:43], a[168:171], v[64:67]
    ds_read_b128 v[32:35], v12 offset:49152
    v_mfma_f32_16x16x32_bf16 v[68:71], v[40:43], a[172:175], v[68:71]
    v_mfma_f32_16x16x32_bf16 v[72:75], v[44:47], a[168:171], v[72:75]
    ds_read_b128 v[36:39], v12 offset:50176
    v_mfma_f32_16x16x32_bf16 v[76:79], v[44:47], a[172:175], v[76:79]
    s_waitcnt lgkmcnt(4)
    v_mfma_f32_16x16x32_bf16 v[64:67], v[48:51], a[176:179], v[64:67]
    ds_read_b128 v[40:43], v13 offset:49152
    v_mfma_f32_16x16x32_bf16 v[68:71], v[48:51], a[180:183], v[68:71]
    v_mfma_f32_16x16x32_bf16 v[72:75], v[52:55], a[176:179], v[72:75]
    ds_read_b128 v[44:47], v13 offset:50176
    s_add_u32 m0, s34, 125056
    v_mfma_f32_16x16x32_bf16 v[76:79], v[52:55], a[180:183], v[76:79]
    buffer_load_dwordx4 v8, s[12:15], s35 offen offset:1920 lds
    s_add_u32 s35, s35, 65536
    s_min_u32 s35, s35, s52
    s_waitcnt lgkmcnt(4)
    v_mfma_f32_16x16x32_bf16 v[64:67], v[56:59], a[184:187], v[64:67]
    ds_read_b128 v[48:51], v12 offset:53248
    v_mfma_f32_16x16x32_bf16 v[68:71], v[56:59], a[188:191], v[68:71]
    v_mfma_f32_16x16x32_bf16 v[72:75], v[60:63], a[184:187], v[72:75]
    ds_read_b128 v[52:55], v12 offset:54272
    v_mfma_f32_16x16x32_bf16 v[76:79], v[60:63], a[188:191], v[76:79]
    s_waitcnt vmcnt(8)
    s_barrier
    s_waitcnt lgkmcnt(4)
    v_mfma_f32_16x16x32_bf16 v[64:67], v[32:35], a[192:195], v[64:67]
    ds_read_b128 v[56:59], v13 offset:53248
    v_mfma_f32_16x16x32_bf16 v[68:71], v[32:35], a[196:199], v[68:71]
    v_mfma_f32_16x16x32_bf16 v[72:75], v[36:39], a[192:195], v[72:75]
    ds_read_b128 v[60:63], v13 offset:54272
    s_add_u32 m0, s34, 0
    v_mfma_f32_16x16x32_bf16 v[76:79], v[36:39], a[196:199], v[76:79]
    buffer_load_dwordx4 v8, s[12:15], s35 offen offset:0 lds
    s_waitcnt lgkmcnt(4)
    v_mfma_f32_16x16x32_bf16 v[64:67], v[40:43], a[200:203], v[64:67]
    ds_read_b128 v[32:35], v12 offset:57344
    v_mfma_f32_16x16x32_bf16 v[68:71], v[40:43], a[204:207], v[68:71]
    buffer_store_dword v11, v10, s[4:7], 0 offen sc1
    v_add_u32 v11, 1, v11
    v_mfma_f32_16x16x32_bf16 v[72:75], v[44:47], a[200:203], v[72:75]
    ds_read_b128 v[36:39], v12 offset:58368
    v_mfma_f32_16x16x32_bf16 v[76:79], v[44:47], a[204:207], v[76:79]
    s_waitcnt lgkmcnt(4)
    v_mfma_f32_16x16x32_bf16 v[64:67], v[48:51], a[208:211], v[64:67]
    ds_read_b128 v[40:43], v13 offset:57344
    v_mfma_f32_16x16x32_bf16 v[68:71], v[48:51], a[212:215], v[68:71]
    v_mfma_f32_16x16x32_bf16 v[72:75], v[52:55], a[208:211], v[72:75]
    ds_read_b128 v[44:47], v13 offset:58368
    s_add_u32 m0, s34, 3968
    v_mfma_f32_16x16x32_bf16 v[76:79], v[52:55], a[212:215], v[76:79]
    buffer_load_dwordx4 v8, s[12:15], s35 offen offset:128 lds
    s_waitcnt lgkmcnt(4)
    v_mfma_f32_16x16x32_bf16 v[64:67], v[56:59], a[216:219], v[64:67]
    ds_read_b128 v[48:51], v12 offset:61440
    v_mfma_f32_16x16x32_bf16 v[68:71], v[56:59], a[220:223], v[68:71]
    v_mfma_f32_16x16x32_bf16 v[72:75], v[60:63], a[216:219], v[72:75]
    ds_read_b128 v[52:55], v12 offset:62464
    v_mfma_f32_16x16x32_bf16 v[76:79], v[60:63], a[220:223], v[76:79]
    s_waitcnt lgkmcnt(4)
    v_mfma_f32_16x16x32_bf16 v[64:67], v[32:35], a[224:227], v[64:67]
    ds_read_b128 v[56:59], v13 offset:61440
    v_mfma_f32_16x16x32_bf16 v[68:71], v[32:35], a[228:231], v[68:71]
    v_mfma_f32_16x16x32_bf16 v[72:75], v[36:39], a[224:227], v[72:75]
    ds_read_b128 v[60:63], v13 offset:62464
    s_add_u32 m0, s34, 7936
    v_mfma_f32_16x16x32_bf16 v[76:79], v[36:39], a[228:231], v[76:79]
    buffer_load_dwordx4 v8, s[12:15], s35 offen offset:256 lds
    s_waitcnt lgkmcnt(4)
    v_mfma_f32_16x16x32_bf16 v[64:67], v[40:43], a[232:235], v[64:67]
    ds_read_b128 v[32:35], v14 offset:0
    v_mfma_f32_16x16x32_bf16 v[68:71], v[40:43], a[236:239], v[68:71]
    v_mfma_f32_16x16x32_bf16 v[72:75], v[44:47], a[232:235], v[72:75]
    ds_read_b128 v[36:39], v14 offset:1024
    v_mfma_f32_16x16x32_bf16 v[76:79], v[44:47], a[236:239], v[76:79]
    s_waitcnt lgkmcnt(4)
    v_mfma_f32_16x16x32_bf16 v[64:67], v[48:51], a[240:243], v[64:67]
    ds_read_b128 v[40:43], v15 offset:0
    v_mfma_f32_16x16x32_bf16 v[68:71], v[48:51], a[244:247], v[68:71]
    v_mfma_f32_16x16x32_bf16 v[72:75], v[52:55], a[240:243], v[72:75]
    ds_read_b128 v[44:47], v15 offset:1024
    s_add_u32 m0, s34, 11904
    v_mfma_f32_16x16x32_bf16 v[76:79], v[52:55], a[244:247], v[76:79]
    buffer_load_dwordx4 v8, s[12:15], s35 offen offset:384 lds
    s_waitcnt lgkmcnt(4)
    v_mfma_f32_16x16x32_bf16 v[64:67], v[56:59], a[248:251], v[64:67]
    ds_read_b128 v[48:51], v14 offset:4096
    v_mfma_f32_16x16x32_bf16 v[68:71], v[56:59], a[252:255], v[68:71]
    v_mfma_f32_16x16x32_bf16 v[72:75], v[60:63], a[248:251], v[72:75]
    ds_read_b128 v[52:55], v14 offset:5120
    v_mfma_f32_16x16x32_bf16 v[76:79], v[60:63], a[252:255], v[76:79]
    s_waitcnt lgkmcnt(4)
    v_mfma_f32_16x16x32_bf16 v[80:83], v[32:35], a[0:3], 0
    ds_read_b128 v[56:59], v15 offset:4096
    v_mfma_f32_16x16x32_bf16 v[84:87], v[32:35], a[4:7], 0
    v_mfma_f32_16x16x32_bf16 v[88:91], v[36:39], a[0:3], 0
    ds_read_b128 v[60:63], v15 offset:5120
    s_add_u32 m0, s34, 15872
    v_mfma_f32_16x16x32_bf16 v[92:95], v[36:39], a[4:7], 0
    buffer_load_dwordx4 v8, s[12:15], s35 offen offset:512 lds
    s_waitcnt lgkmcnt(4)
    v_mfma_f32_16x16x32_bf16 v[80:83], v[40:43], a[8:11], v[80:83]
    ds_read_b128 v[32:35], v14 offset:8192
    v_mfma_f32_16x16x32_bf16 v[84:87], v[40:43], a[12:15], v[84:87]
    v_mfma_f32_16x16x32_bf16 v[88:91], v[44:47], a[8:11], v[88:91]
    ds_read_b128 v[36:39], v14 offset:9216
    v_mfma_f32_16x16x32_bf16 v[92:95], v[44:47], a[12:15], v[92:95]
    s_waitcnt lgkmcnt(4)
    v_mfma_f32_16x16x32_bf16 v[80:83], v[48:51], a[16:19], v[80:83]
    ds_read_b128 v[40:43], v15 offset:8192
    v_mfma_f32_16x16x32_bf16 v[84:87], v[48:51], a[20:23], v[84:87]
    v_cvt_pk_bf16_f32 v96, v64, v65
    v_mfma_f32_16x16x32_bf16 v[88:91], v[52:55], a[16:19], v[88:91]
    ds_read_b128 v[44:47], v15 offset:9216
    s_add_u32 m0, s34, 19840
    v_mfma_f32_16x16x32_bf16 v[92:95], v[52:55], a[20:23], v[92:95]
    buffer_load_dwordx4 v8, s[12:15], s35 offen offset:640 lds
    v_cvt_pk_bf16_f32 v97, v66, v67
    s_waitcnt lgkmcnt(4)
    v_mfma_f32_16x16x32_bf16 v[80:83], v[56:59], a[24:27], v[80:83]
    ds_read_b128 v[48:51], v14 offset:12288
    v_mfma_f32_16x16x32_bf16 v[84:87], v[56:59], a[28:31], v[84:87]
    v_cvt_pk_bf16_f32 v98, v72, v73
    v_mfma_f32_16x16x32_bf16 v[88:91], v[60:63], a[24:27], v[88:91]
    ds_read_b128 v[52:55], v14 offset:13312
    v_mfma_f32_16x16x32_bf16 v[92:95], v[60:63], a[28:31], v[92:95]
    v_cvt_pk_bf16_f32 v99, v74, v75
    s_waitcnt lgkmcnt(4)
    v_mfma_f32_16x16x32_bf16 v[80:83], v[32:35], a[32:35], v[80:83]
    ds_read_b128 v[56:59], v15 offset:12288
    v_mfma_f32_16x16x32_bf16 v[84:87], v[32:35], a[36:39], v[84:87]
    v_cvt_pk_bf16_f32 v100, v68, v69
    v_mfma_f32_16x16x32_bf16 v[88:91], v[36:39], a[32:35], v[88:91]
    ds_read_b128 v[60:63], v15 offset:13312
    s_add_u32 m0, s34, 23808
    v_mfma_f32_16x16x32_bf16 v[92:95], v[36:39], a[36:39], v[92:95]
    buffer_load_dwordx4 v8, s[12:15], s35 offen offset:768 lds
    v_cvt_pk_bf16_f32 v101, v70, v71
    s_waitcnt lgkmcnt(4)
    v_mfma_f32_16x16x32_bf16 v[80:83], v[40:43], a[40:43], v[80:83]
    ds_read_b128 v[32:35], v14 offset:16384
    v_mfma_f32_16x16x32_bf16 v[84:87], v[40:43], a[44:47], v[84:87]
    v_cvt_pk_bf16_f32 v102, v76, v77
    v_mfma_f32_16x16x32_bf16 v[88:91], v[44:47], a[40:43], v[88:91]
    ds_read_b128 v[36:39], v14 offset:17408
    v_mfma_f32_16x16x32_bf16 v[92:95], v[44:47], a[44:47], v[92:95]
    v_cvt_pk_bf16_f32 v103, v78, v79
    buffer_store_dwordx4 v[96:99], v9, s[4:7], s36 offen sc1
    s_waitcnt lgkmcnt(4)
    v_mfma_f32_16x16x32_bf16 v[80:83], v[48:51], a[48:51], v[80:83]
    ds_read_b128 v[40:43], v15 offset:16384
    v_mfma_f32_16x16x32_bf16 v[84:87], v[48:51], a[52:55], v[84:87]
    v_mfma_f32_16x16x32_bf16 v[88:91], v[52:55], a[48:51], v[88:91]
    ds_read_b128 v[44:47], v15 offset:17408
    s_add_u32 m0, s34, 27776
    v_mfma_f32_16x16x32_bf16 v[92:95], v[52:55], a[52:55], v[92:95]
    buffer_load_dwordx4 v8, s[12:15], s35 offen offset:896 lds
    s_waitcnt lgkmcnt(4)
    v_mfma_f32_16x16x32_bf16 v[80:83], v[56:59], a[56:59], v[80:83]
    ds_read_b128 v[48:51], v14 offset:20480
    v_mfma_f32_16x16x32_bf16 v[84:87], v[56:59], a[60:63], v[84:87]
    v_mfma_f32_16x16x32_bf16 v[88:91], v[60:63], a[56:59], v[88:91]
    ds_read_b128 v[52:55], v14 offset:21504
    v_mfma_f32_16x16x32_bf16 v[92:95], v[60:63], a[60:63], v[92:95]
    buffer_store_dwordx4 v[100:103], v9, s[4:7], s36 offen offset:128 sc1
    s_add_u32 s36, s36, s37
    s_waitcnt vmcnt(8)
    s_barrier
    s_waitcnt lgkmcnt(4)
    v_mfma_f32_16x16x32_bf16 v[80:83], v[32:35], a[64:67], v[80:83]
    ds_read_b128 v[56:59], v15 offset:20480
    v_mfma_f32_16x16x32_bf16 v[84:87], v[32:35], a[68:71], v[84:87]
    v_mfma_f32_16x16x32_bf16 v[88:91], v[36:39], a[64:67], v[88:91]
    ds_read_b128 v[60:63], v15 offset:21504
    s_add_u32 m0, s34, 31744
    v_mfma_f32_16x16x32_bf16 v[92:95], v[36:39], a[68:71], v[92:95]
    buffer_load_dwordx4 v8, s[12:15], s35 offen offset:1024 lds
    s_waitcnt lgkmcnt(4)
    v_mfma_f32_16x16x32_bf16 v[80:83], v[40:43], a[72:75], v[80:83]
    ds_read_b128 v[32:35], v14 offset:24576
    v_mfma_f32_16x16x32_bf16 v[84:87], v[40:43], a[76:79], v[84:87]
    v_mfma_f32_16x16x32_bf16 v[88:91], v[44:47], a[72:75], v[88:91]
    ds_read_b128 v[36:39], v14 offset:25600
    v_mfma_f32_16x16x32_bf16 v[92:95], v[44:47], a[76:79], v[92:95]
    s_waitcnt lgkmcnt(4)
    v_mfma_f32_16x16x32_bf16 v[80:83], v[48:51], a[80:83], v[80:83]
    ds_read_b128 v[40:43], v15 offset:24576
    v_mfma_f32_16x16x32_bf16 v[84:87], v[48:51], a[84:87], v[84:87]
    v_mfma_f32_16x16x32_bf16 v[88:91], v[52:55], a[80:83], v[88:91]
    ds_read_b128 v[44:47], v15 offset:25600
    s_add_u32 m0, s34, 35712
    v_mfma_f32_16x16x32_bf16 v[92:95], v[52:55], a[84:87], v[92:95]
    buffer_load_dwordx4 v8, s[12:15], s35 offen offset:1152 lds
    s_waitcnt lgkmcnt(4)
    v_mfma_f32_16x16x32_bf16 v[80:83], v[56:59], a[88:91], v[80:83]
    ds_read_b128 v[48:51], v14 offset:28672
    v_mfma_f32_16x16x32_bf16 v[84:87], v[56:59], a[92:95], v[84:87]
    v_mfma_f32_16x16x32_bf16 v[88:91], v[60:63], a[88:91], v[88:91]
    ds_read_b128 v[52:55], v14 offset:29696
    v_mfma_f32_16x16x32_bf16 v[92:95], v[60:63], a[92:95], v[92:95]
    s_waitcnt lgkmcnt(4)
    v_mfma_f32_16x16x32_bf16 v[80:83], v[32:35], a[96:99], v[80:83]
    ds_read_b128 v[56:59], v15 offset:28672
    v_mfma_f32_16x16x32_bf16 v[84:87], v[32:35], a[100:103], v[84:87]
    v_mfma_f32_16x16x32_bf16 v[88:91], v[36:39], a[96:99], v[88:91]
    ds_read_b128 v[60:63], v15 offset:29696
    s_add_u32 m0, s34, 39680
    v_mfma_f32_16x16x32_bf16 v[92:95], v[36:39], a[100:103], v[92:95]
    buffer_load_dwordx4 v8, s[12:15], s35 offen offset:1280 lds
    s_waitcnt lgkmcnt(4)
    v_mfma_f32_16x16x32_bf16 v[80:83], v[40:43], a[104:107], v[80:83]
    ds_read_b128 v[32:35], v14 offset:32768
    v_mfma_f32_16x16x32_bf16 v[84:87], v[40:43], a[108:111], v[84:87]
    v_mfma_f32_16x16x32_bf16 v[88:91], v[44:47], a[104:107], v[88:91]
    ds_read_b128 v[36:39], v14 offset:33792
    v_mfma_f32_16x16x32_bf16 v[92:95], v[44:47], a[108:111], v[92:95]
    s_waitcnt lgkmcnt(4)
    v_mfma_f32_16x16x32_bf16 v[80:83], v[48:51], a[112:115], v[80:83]
    ds_read_b128 v[40:43], v15 offset:32768
    v_mfma_f32_16x16x32_bf16 v[84:87], v[48:51], a[116:119], v[84:87]
    v_mfma_f32_16x16x32_bf16 v[88:91], v[52:55], a[112:115], v[88:91]
    ds_read_b128 v[44:47], v15 offset:33792
    s_add_u32 m0, s34, 43648
    v_mfma_f32_16x16x32_bf16 v[92:95], v[52:55], a[116:119], v[92:95]
    buffer_load_dwordx4 v8, s[12:15], s35 offen offset:1408 lds
    s_waitcnt lgkmcnt(4)
    v_mfma_f32_16x16x32_bf16 v[80:83], v[56:59], a[120:123], v[80:83]
    ds_read_b128 v[48:51], v14 offset:36864
    v_mfma_f32_16x16x32_bf16 v[84:87], v[56:59], a[124:127], v[84:87]
    v_mfma_f32_16x16x32_bf16 v[88:91], v[60:63], a[120:123], v[88:91]
    ds_read_b128 v[52:55], v14 offset:37888
    v_mfma_f32_16x16x32_bf16 v[92:95], v[60:63], a[124:127], v[92:95]
    s_waitcnt lgkmcnt(4)
    v_mfma_f32_16x16x32_bf16 v[80:83], v[32:35], a[128:131], v[80:83]
    ds_read_b128 v[56:59], v15 offset:36864
    v_mfma_f32_16x16x32_bf16 v[84:87], v[32:35], a[132:135], v[84:87]
    v_mfma_f32_16x16x32_bf16 v[88:91], v[36:39], a[128:131], v[88:91]
    ds_read_b128 v[60:63], v15 offset:37888
    s_add_u32 m0, s34, 47616
    v_mfma_f32_16x16x32_bf16 v[92:95], v[36:39], a[132:135], v[92:95]
    buffer_load_dwordx4 v8, s[12:15], s35 offen offset:1536 lds
    s_waitcnt lgkmcnt(4)
    v_mfma_f32_16x16x32_bf16 v[80:83], v[40:43], a[136:139], v[80:83]
    ds_read_b128 v[32:35], v14 offset:40960
    v_mfma_f32_16x16x32_bf16 v[84:87], v[40:43], a[140:143], v[84:87]
    v_mfma_f32_16x16x32_bf16 v[88:91], v[44:47], a[136:139], v[88:91]
    ds_read_b128 v[36:39], v14 offset:41984
    v_mfma_f32_16x16x32_bf16 v[92:95], v[44:47], a[140:143], v[92:95]
    s_waitcnt lgkmcnt(4)
    v_mfma_f32_16x16x32_bf16 v[80:83], v[48:51], a[144:147], v[80:83]
    ds_read_b128 v[40:43], v15 offset:40960
    v_mfma_f32_16x16x32_bf16 v[84:87], v[48:51], a[148:151], v[84:87]
    v_mfma_f32_16x16x32_bf16 v[88:91], v[52:55], a[144:147], v[88:91]
    ds_read_b128 v[44:47], v15 offset:41984
    s_add_u32 m0, s34, 51584
    v_mfma_f32_16x16x32_bf16 v[92:95], v[52:55], a[148:151], v[92:95]
    buffer_load_dwordx4 v8, s[12:15], s35 offen offset:1664 lds
    s_waitcnt lgkmcnt(4)
    v_mfma_f32_16x16x32_bf16 v[80:83], v[56:59], a[152:155], v[80:83]
    ds_read_b128 v[48:51], v14 offset:45056
    v_mfma_f32_16x16x32_bf16 v[84:87], v[56:59], a[156:159], v[84:87]
    v_mfma_f32_16x16x32_bf16 v[88:91], v[60:63], a[152:155], v[88:91]
    ds_read_b128 v[52:55], v14 offset:46080
    v_mfma_f32_16x16x32_bf16 v[92:95], v[60:63], a[156:159], v[92:95]
    s_waitcnt lgkmcnt(4)
    v_mfma_f32_16x16x32_bf16 v[80:83], v[32:35], a[160:163], v[80:83]
    ds_read_b128 v[56:59], v15 offset:45056
    v_mfma_f32_16x16x32_bf16 v[84:87], v[32:35], a[164:167], v[84:87]
    v_mfma_f32_16x16x32_bf16 v[88:91], v[36:39], a[160:163], v[88:91]
    ds_read_b128 v[60:63], v15 offset:46080
    s_add_u32 m0, s34, 55552
    v_mfma_f32_16x16x32_bf16 v[92:95], v[36:39], a[164:167], v[92:95]
    buffer_load_dwordx4 v8, s[12:15], s35 offen offset:1792 lds
    s_waitcnt lgkmcnt(4)
    v_mfma_f32_16x16x32_bf16 v[80:83], v[40:43], a[168:171], v[80:83]
    ds_read_b128 v[32:35], v14 offset:49152
    v_mfma_f32_16x16x32_bf16 v[84:87], v[40:43], a[172:175], v[84:87]
    v_mfma_f32_16x16x32_bf16 v[88:91], v[44:47], a[168:171], v[88:91]
    ds_read_b128 v[36:39], v14 offset:50176
    v_mfma_f32_16x16x32_bf16 v[92:95], v[44:47], a[172:175], v[92:95]
    s_waitcnt lgkmcnt(4)
    v_mfma_f32_16x16x32_bf16 v[80:83], v[48:51], a[176:179], v[80:83]
    ds_read_b128 v[40:43], v15 offset:49152
    v_mfma_f32_16x16x32_bf16 v[84:87], v[48:51], a[180:183], v[84:87]
    v_mfma_f32_16x16x32_bf16 v[88:91], v[52:55], a[176:179], v[88:91]
    ds_read_b128 v[44:47], v15 offset:50176
    s_add_u32 m0, s34, 59520
    v_mfma_f32_16x16x32_bf16 v[92:95], v[52:55], a[180:183], v[92:95]
    buffer_load_dwordx4 v8, s[12:15], s35 offen offset:1920 lds
    s_add_u32 s35, s35, 65536
    s_min_u32 s35, s35, s52
    s_waitcnt lgkmcnt(4)
    v_mfma_f32_16x16x32_bf16 v[80:83], v[56:59], a[184:187], v[80:83]
    ds_read_b128 v[48:51], v14 offset:53248
    v_mfma_f32_16x16x32_bf16 v[84:87], v[56:59], a[188:191], v[84:87]
    v_mfma_f32_16x16x32_bf16 v[88:91], v[60:63], a[184:187], v[88:91]
    ds_read_b128 v[52:55], v14 offset:54272
    v_mfma_f32_16x16x32_bf16 v[92:95], v[60:63], a[188:191], v[92:95]
    s_waitcnt vmcnt(8)
    s_barrier
    s_waitcnt lgkmcnt(4)
    v_mfma_f32_16x16x32_bf16 v[80:83], v[32:35], a[192:195], v[80:83]
    ds_read_b128 v[56:59], v15 offset:53248
    v_mfma_f32_16x16x32_bf16 v[84:87], v[32:35], a[196:199], v[84:87]
    v_mfma_f32_16x16x32_bf16 v[88:91], v[36:39], a[192:195], v[88:91]
    ds_read_b128 v[60:63], v15 offset:54272
    s_add_u32 m0, s34, 65536
    v_mfma_f32_16x16x32_bf16 v[92:95], v[36:39], a[196:199], v[92:95]
    buffer_load_dwordx4 v8, s[12:15], s35 offen offset:0 lds
    s_waitcnt lgkmcnt(4)
    v_mfma_f32_16x16x32_bf16 v[80:83], v[40:43], a[200:203], v[80:83]
    ds_read_b128 v[32:35], v14 offset:57344
    v_mfma_f32_16x16x32_bf16 v[84:87], v[40:43], a[204:207], v[84:87]
    buffer_store_dword v11, v10, s[4:7], 0 offen sc1
    v_add_u32 v11, 1, v11
    v_mfma_f32_16x16x32_bf16 v[88:91], v[44:47], a[200:203], v[88:91]
    ds_read_b128 v[36:39], v14 offset:58368
    v_mfma_f32_16x16x32_bf16 v[92:95], v[44:47], a[204:207], v[92:95]
    s_waitcnt lgkmcnt(4)
    v_mfma_f32_16x16x32_bf16 v[80:83], v[48:51], a[208:211], v[80:83]
    ds_read_b128 v[40:43], v15 offset:57344
    v_mfma_f32_16x16x32_bf16 v[84:87], v[48:51], a[212:215], v[84:87]
    v_mfma_f32_16x16x32_bf16 v[88:91], v[52:55], a[208:211], v[88:91]
    ds_read_b128 v[44:47], v15 offset:58368
    s_add_u32 m0, s34, 69504
    v_mfma_f32_16x16x32_bf16 v[92:95], v[52:55], a[212:215], v[92:95]
    buffer_load_dwordx4 v8, s[12:15], s35 offen offset:128 lds
    s_waitcnt lgkmcnt(4)
    v_mfma_f32_16x16x32_bf16 v[80:83], v[56:59], a[216:219], v[80:83]
    ds_read_b128 v[48:51], v14 offset:61440
    v_mfma_f32_16x16x32_bf16 v[84:87], v[56:59], a[220:223], v[84:87]
    v_mfma_f32_16x16x32_bf16 v[88:91], v[60:63], a[216:219], v[88:91]
    ds_read_b128 v[52:55], v14 offset:62464
    v_mfma_f32_16x16x32_bf16 v[92:95], v[60:63], a[220:223], v[92:95]
    s_waitcnt lgkmcnt(4)
    v_mfma_f32_16x16x32_bf16 v[80:83], v[32:35], a[224:227], v[80:83]
    ds_read_b128 v[56:59], v15 offset:61440
    v_mfma_f32_16x16x32_bf16 v[84:87], v[32:35], a[228:231], v[84:87]
    v_mfma_f32_16x16x32_bf16 v[88:91], v[36:39], a[224:227], v[88:91]
    ds_read_b128 v[60:63], v15 offset:62464
    s_add_u32 m0, s34, 73472
    v_mfma_f32_16x16x32_bf16 v[92:95], v[36:39], a[228:231], v[92:95]
    buffer_load_dwordx4 v8, s[12:15], s35 offen offset:256 lds
    s_waitcnt lgkmcnt(4)
    v_mfma_f32_16x16x32_bf16 v[80:83], v[40:43], a[232:235], v[80:83]
    ds_read_b128 v[32:35], v12 offset:0
    v_mfma_f32_16x16x32_bf16 v[84:87], v[40:43], a[236:239], v[84:87]
    v_mfma_f32_16x16x32_bf16 v[88:91], v[44:47], a[232:235], v[88:91]
    ds_read_b128 v[36:39], v12 offset:1024
    v_mfma_f32_16x16x32_bf16 v[92:95], v[44:47], a[236:239], v[92:95]
    s_waitcnt lgkmcnt(4)
    v_mfma_f32_16x16x32_bf16 v[80:83], v[48:51], a[240:243], v[80:83]
    ds_read_b128 v[40:43], v13 offset:0
    v_mfma_f32_16x16x32_bf16 v[84:87], v[48:51], a[244:247], v[84:87]
    v_mfma_f32_16x16x32_bf16 v[88:91], v[52:55], a[240:243], v[88:91]
    ds_read_b128 v[44:47], v13 offset:1024
    s_add_u32 m0, s34, 77440
    v_mfma_f32_16x16x32_bf16 v[92:95], v[52:55], a[244:247], v[92:95]
    buffer_load_dwordx4 v8, s[12:15], s35 offen offset:384 lds
    s_waitcnt lgkmcnt(4)
    v_mfma_f32_16x16x32_bf16 v[80:83], v[56:59], a[248:251], v[80:83]
    ds_read_b128 v[48:51], v12 offset:4096
    v_mfma_f32_16x16x32_bf16 v[84:87], v[56:59], a[252:255], v[84:87]
    v_mfma_f32_16x16x32_bf16 v[88:91], v[60:63], a[248:251], v[88:91]
    ds_read_b128 v[52:55], v12 offset:5120
    v_mfma_f32_16x16x32_bf16 v[92:95], v[60:63], a[252:255], v[92:95]
    s_add_u32 s30, s30, 2
    s_cmp_lt_u32 s30, s51
    s_cbranch_scc1 sl_loop_67
    v_cvt_pk_bf16_f32 v96, v80, v81
    v_cvt_pk_bf16_f32 v97, v82, v83
    s_nop 0
    v_cvt_pk_bf16_f32 v98, v88, v89
    v_cvt_pk_bf16_f32 v99, v90, v91
    v_cvt_pk_bf16_f32 v100, v84, v85
    v_cvt_pk_bf16_f32 v101, v86, v87
    v_cvt_pk_bf16_f32 v102, v92, v93
    v_cvt_pk_bf16_f32 v103, v94, v95
    s_branch sl_e_65
sl_e_65:
    buffer_store_dwordx4 v[96:99], v9, s[4:7], s36 offen sc1
    buffer_store_dwordx4 v[100:103], v9, s[4:7], s36 offen offset:128 sc1
    s_add_u32 s36, s36, s37
    s_waitcnt vmcnt(0) lgkmcnt(0)
    s_barrier
    buffer_store_dword v11, v10, s[4:7], 0 offen sc1
    s_branch L_ph2
L_ph2:
    s_cmp_ge_u32 s28, 96
    s_cbranch_scc1 L_ob
    s_load_dwordx2 s[72:73], s[0:1], 40
    s_load_dwordx2 s[74:75], s[0:1], 80
    s_and_b32 s44, s28, 15
    s_lshr_b32 s30, s28, 4
    s_waitcnt lgkmcnt(0)
    s_mov_b32 s8, s72
    s_and_b32 s9, s73, 0xffff
    s_mov_b32 s10, 8388608
    s_mov_b32 s11, 0x00020000
    s_mov_b32 s20, s74
    s_and_b32 s21, s75, 0xffff
    s_mov_b32 s22, 8388608
    s_mov_b32 s23, 0x00020000
    s_lshl_b32 s31, s29, 21
    s_lshl_b32 s33, s44, 7
    s_add_u32 s31, s31, s33
    v_lshrrev_b32 v6, 2, v1
    v_lshlrev_b32 v6, 11, v6
    v_and_b32 v4, 3, v1
    v_lshl_add_u32 v6, v4, 4, v6
    v_add_u32 v6, s31, v6
    s_lshl_b32 s31, s29, 15
    v_lshrrev_b32 v7, 5, v1
    v_lshlrev_b32 v7, 8, v7
    v_bfe_u32 v4, v1, 2, 2
    v_lshl_add_u32 v7, v4, 6, v7
    v_bfe_u32 v4, v1, 4, 1
    v_lshl_add_u32 v7, v4, 5, v7
    v_and_b32 v4, 3, v1
    v_lshl_add_u32 v7, v4, 3, v7
    v_add_u32 v7, s31, v7
    s_lshl_b32 s32, s29, 15
    s_add_u32 m0, s32, 0
    s_mov_b32 s38, 0
    buffer_load_dwordx4 v6, s[8:11], s38 offen lds
    s_add_u32 m0, s32, 1024
    s_add_u32 s38, s38, 32768
    buffer_load_dwordx4 v6, s[8:11], s38 offen lds
    s_add_u32 m0, s32, 2048
    s_add_u32 s38, s38, 32768
    buffer_load_dwordx4 v6, s[8:11], s38 offen lds
    s_add_u32 m0, s32, 3072
    s_add_u32 s38, s38, 32768
    buffer_load_dwordx4 v6, s[8:11], s38 offen lds
    s_add_u32 m0, s32, 4096
    s_add_u32 s38, s38, 32768
    buffer_load_dwordx4 v6, s[8:11], s38 offen lds
    s_add_u32 m0, s32, 5120
    s_add_u32 s38, s38, 32768
    buffer_load_dwordx4 v6, s[8:11], s38 offen lds
    s_add_u32 m0, s32, 6144
    s_add_u32 s38, s38, 32768
    buffer_load_dwordx4 v6, s[8:11], s38 offen lds
    s_add_u32 m0, s32, 7168
    s_add_u32 s38, s38, 32768
    buffer_load_dwordx4 v6, s[8:11], s38 offen lds
    s_add_u32 m0, s32, 8192
    s_add_u32 s38, s38, 32768
    buffer_load_dwordx4 v6, s[8:11], s38 offen lds
    s_add_u32 m0, s32, 9216
    s_add_u32 s38, s38, 32768
    buffer_load_dwordx4 v6, s[8:11], s38 offen lds
    s_add_u32 m0, s32, 10240
    s_add_u32 s38, s38, 32768
    buffer_load_dwordx4 v6, s[8:11], s38 offen lds
    s_add_u32 m0, s32, 11264
    s_add_u32 s38, s38, 32768
    buffer_load_dwordx4 v6, s[8:11], s38 offen lds
    s_add_u32 m0, s32, 12288
    s_add_u32 s38, s38, 32768
    buffer_load_dwordx4 v6, s[8:11], s38 offen lds
    s_add_u32 m0, s32, 13312
    s_add_u32 s38, s38, 32768
    buffer_load_dwordx4 v6, s[8:11], s38 offen lds
    s_add_u32 m0, s32, 14336
    s_add_u32 s38, s38, 32768
    buffer_load_dwordx4 v6, s[8:11], s38 offen lds
    s_add_u32 m0, s32, 15360
    s_add_u32 s38, s38, 32768
    buffer_load_dwordx4 v6, s[8:11], s38 offen lds
    s_add_u32 m0, s32, 16384
    s_add_u32 s38, s38, 32768
    buffer_load_dwordx4 v6, s[8:11], s38 offen lds
    s_add_u32 m0, s32, 17408
    s_add_u32 s38, s38, 32768
    buffer_load_dwordx4 v6, s[8:11], s38 offen lds
    s_add_u32 m0, s32, 18432
    s_add_u32 s38, s38, 32768
    buffer_load_dwordx4 v6, s[8:11], s38 offen lds
    s_add_u32 m0, s32, 19456
    s_add_u32 s38, s38, 32768
    buffer_load_dwordx4 v6, s[8:11], s38 offen lds
    s_add_u32 m0, s32, 20480
    s_add_u32 s38, s38, 32768
    buffer_load_dwordx4 v6, s[8:11], s38 offen lds
    s_add_u32 m0, s32, 21504
    s_add_u32 s38, s38, 32768
    buffer_load_dwordx4 v6, s[8:11], s38 offen lds
    s_add_u32 m0, s32, 22528
    s_add_u32 s38, s38, 32768
    buffer_load_dwordx4 v6, s[8:11], s38 offen lds
    s_add_u32 m0, s32, 23552
    s_add_u32 s38, s38, 32768
    buffer_load_dwordx4 v6, s[8:11], s38 offen lds
    s_add_u32 m0, s32, 24576
    s_add_u32 s38, s38, 32768
    buffer_load_dwordx4 v6, s[8:11], s38 offen lds
    s_add_u32 m0, s32, 25600
    s_add_u32 s38, s38, 32768
    buffer_load_dwordx4 v6, s[8:11], s38 offen lds
    s_add_u32 m0, s32, 26624
    s_add_u32 s38, s38, 32768
    buffer_load_dwordx4 v6, s[8:11], s38 offen lds
    s_add_u32 m0, s32, 27648
    s_add_u32 s38, s38, 32768
    buffer_load_dwordx4 v6, s[8:11], s38 offen lds
    s_add_u32 m0, s32, 28672
    s_add_u32 s38, s38, 32768
    buffer_load_dwordx4 v6, s[8:11], s38 offen lds
    s_add_u32 m0, s32, 29696
    s_add_u32 s38, s38, 32768
    buffer_load_dwordx4 v6, s[8:11], s38 offen lds
    s_add_u32 m0, s32, 30720
    s_add_u32 s38, s38, 32768
    buffer_load_dwordx4 v6, s[8:11], s38 offen lds
    s_add_u32 m0, s32, 31744
    s_add_u32 s38, s38, 32768
    buffer_load_dwordx4 v6, s[8:11], s38 offen lds
    s_waitcnt vmcnt(30)
    ds_read_b64_tr_b16 a[0:1], v7 offset:0
    ds_read_b64_tr_b16 a[2:3], v7 offset:512
    ds_read_b64_tr_b16 a[4:5], v7 offset:1024
    ds_read_b64_tr_b16 a[6:7], v7 offset:1536
    s_waitcnt vmcnt(28)
    ds_read_b64_tr_b16 a[8:9], v7 offset:2048
    ds_read_b64_tr_b16 a[10:11], v7 offset:2560
    ds_read_b64_tr_b16 a[12:13], v7 offset:3072
    ds_read_b64_tr_b16 a[14:15], v7 offset:3584
    s_waitcnt lgkmcnt(4)
    s_add_u32 m0, s32, 0
    s_add_u32 s38, s38, 32768
    buffer_load_dwordx4 v6, s[8:11], s38 offen lds
    s_add_u32 m0, s32, 1024
    s_add_u32 s38, s38, 32768
    buffer_load_dwordx4 v6, s[8:11], s38 offen lds
    s_waitcnt vmcnt(28)
    ds_read_b64_tr_b16 a[16:17], v7 offset:4096
    ds_read_b64_tr_b16 a[18:19], v7 offset:4608
    ds_read_b64_tr_b16 a[20:21], v7 offset:5120
    ds_read_b64_tr_b16 a[22:23], v7 offset:5632
    s_waitcnt lgkmcnt(4)
    s_add_u32 m0, s32, 2048
    s_add_u32 s38, s38, 32768
    buffer_load_dwordx4 v6, s[8:11], s38 offen lds
    s_add_u32 m0, s32, 3072
    s_add_u32 s38, s38, 32768
    buffer_load_dwordx4 v6, s[8:11], s38 offen lds
    s_waitcnt vmcnt(28)
    ds_read_b64_tr_b16 a[24:25], v7 offset:6144
    ds_read_b64_tr_b16 a[26:27], v7 offset:6656
    ds_read_b64_tr_b16 a[28:29], v7 offset:7168
    ds_read_b64_tr_b16 a[30:31], v7 offset:7680
    s_waitcnt lgkmcnt(4)
    s_add_u32 m0, s32, 4096
    s_add_u32 s38, s38, 32768
    buffer_load_dwordx4 v6, s[8:11], s38 offen lds
    s_add_u32 m0, s32, 5120
    s_add_u32 s38, s38, 32768
    buffer_load_dwordx4 v6, s[8:11], s38 offen lds
    s_waitcnt vmcnt(28)
    ds_read_b64_tr_b16 a[32:33], v7 offset:8192
    ds_read_b64_tr_b16 a[34:35], v7 offset:8704
    ds_read_b64_tr_b16 a[36:37], v7 offset:9216
    ds_read_b64_tr_b16 a[38:39], v7 offset:9728
    s_waitcnt lgkmcnt(4)
    s_add_u32 m0, s32, 6144
    s_add_u32 s38, s38, 32768
    buffer_load_dwordx4 v6, s[8:11], s38 offen lds
    s_add_u32 m0, s32, 7168
    s_add_u32 s38, s38, 32768
    buffer_load_dwordx4 v6, s[8:11], s38 offen lds
    s_waitcnt vmcnt(28)
    ds_read_b64_tr_b16 a[40:41], v7 offset:10240
    ds_read_b64_tr_b16 a[42:43], v7 offset:10752
    ds_read_b64_tr_b16 a[44:45], v7 offset:11264
    ds_read_b64_tr_b16 a[46:47], v7 offset:11776
    s_waitcnt lgkmcnt(4)
    s_add_u32 m0, s32, 8192
    s_add_u32 s38, s38, 32768
    buffer_load_dwordx4 v6, s[8:11], s38 offen lds
    s_add_u32 m0, s32, 9216
    s_add_u32 s38, s38, 32768
    buffer_load_dwordx4 v6, s[8:11], s38 offen lds
    s_waitcnt vmcnt(28)
    ds_read_b64_tr_b16 a[48:49], v7 offset:12288
    ds_read_b64_tr_b16 a[50:51], v7 offset:12800
    ds_read_b64_tr_b16 a[52:53], v7 offset:13312
    ds_read_b64_tr_b16 a[54:55], v7 offset:13824
    s_waitcnt lgkmcnt(4)
    s_add_u32 m0, s32, 10240
    s_add_u32 s38, s38, 32768
    buffer_load_dwordx4 v6, s[8:11], s38 offen lds
    s_add_u32 m0, s32, 11264
    s_add_u32 s38, s38, 32768
    buffer_load_dwordx4 v6, s[8:11], s38 offen lds
    s_waitcnt vmcnt(28)
    ds_read_b64_tr_b16 a[56:57], v7 offset:14336
    ds_read_b64_tr_b16 a[58:59], v7 offset:14848
    ds_read_b64_tr_b16 a[60:61], v7 offset:15360
    ds_read_b64_tr_b16 a[62:63], v7 offset:15872
    s_waitcnt lgkmcnt(4)
    s_add_u32 m0, s32, 12288
    s_add_u32 s38, s38, 32768
    buffer_load_dwordx4 v6, s[8:11], s38 offen lds
    s_add_u32 m0, s32, 13312
    s_add_u32 s38, s38, 32768
    buffer_load_dwordx4 v6, s[8:11], s38 offen lds
    s_waitcnt vmcnt(28)
    ds_read_b64_tr_b16 a[64:65], v7 offset:16384
    ds_read_b64_tr_b16 a[66:67], v7 offset:16896
    ds_read_b64_tr_b16 a[68:69], v7 offset:17408
    ds_read_b64_tr_b16 a[70:71], v7 offset:17920
    s_waitcnt lgkmcnt(4)
    s_add_u32 m0, s32, 14336
    s_add_u32 s38, s38, 32768
    buffer_load_dwordx4 v6, s[8:11], s38 offen lds
    s_add_u32 m0, s32, 15360
    s_add_u32 s38, s38, 32768
    buffer_load_dwordx4 v6, s[8:11], s38 offen lds
    s_waitcnt vmcnt(28)
    ds_read_b64_tr_b16 a[72:73], v7 offset:18432
    ds_read_b64_tr_b16 a[74:75], v7 offset:18944
    ds_read_b64_tr_b16 a[76:77], v7 offset:19456
    ds_read_b64_tr_b16 a[78:79], v7 offset:19968
    s_waitcnt lgkmcnt(4)
    s_add_u32 m0, s32, 16384
    s_add_u32 s38, s38, 32768
    buffer_load_dwordx4 v6, s[8:11], s38 offen lds
    s_add_u32 m0, s32, 17408
    s_add_u32 s38, s38, 32768
    buffer_load_dwordx4 v6, s[8:11], s38 offen lds
    s_waitcnt vmcnt(28)
    ds_read_b64_tr_b16 a[80:81], v7 offset:20480
    ds_read_b64_tr_b16 a[82:83], v7 offset:20992
    ds_read_b64_tr_b16 a[84:85], v7 offset:21504
    ds_read_b64_tr_b16 a[86:87], v7 offset:22016
    s_waitcnt lgkmcnt(4)
    s_add_u32 m0, s32, 18432
    s_add_u32 s38, s38, 32768
    buffer_load_dwordx4 v6, s[8:11], s38 offen lds
    s_add_u32 m0, s32, 19456
    s_add_u32 s38, s38, 32768
    buffer_load_dwordx4 v6, s[8:11], s38 offen lds
    s_waitcnt vmcnt(28)
    ds_read_b64_tr_b16 a[88:89], v7 offset:22528
    ds_read_b64_tr_b16 a[90:91], v7 offset:23040
    ds_read_b64_tr_b16 a[92:93], v7 offset:23552
    ds_read_b64_tr_b16 a[94:95], v7 offset:24064
    s_waitcnt lgkmcnt(4)
    s_add_u32 m0, s32, 20480
    s_add_u32 s38, s38, 32768
    buffer_load_dwordx4 v6, s[8:11], s38 offen lds
    s_add_u32 m0, s32, 21504
    s_add_u32 s38, s38, 32768
    buffer_load_dwordx4 v6, s[8:11], s38 offen lds
    s_waitcnt vmcnt(28)
    ds_read_b64_tr_b16 a[96:97], v7 offset:24576
    ds_read_b64_tr_b16 a[98:99], v7 offset:25088
    ds_read_b64_tr_b16 a[100:101], v7 offset:25600
    ds_read_b64_tr_b16 a[102:103], v7 offset:26112
    s_waitcnt lgkmcnt(4)
    s_add_u32 m0, s32, 22528
    s_add_u32 s38, s38, 32768
    buffer_load_dwordx4 v6, s[8:11], s38 offen lds
    s_add_u32 m0, s32, 23552
    s_add_u32 s38, s38, 32768
    buffer_load_dwordx4 v6, s[8:11], s38 offen lds
    s_waitcnt vmcnt(28)
    ds_read_b64_tr_b16 a[104:105], v7 offset:26624
    ds_read_b64_tr_b16 a[106:107], v7 offset:27136
    ds_read_b64_tr_b16 a[108:109], v7 offset:27648
    ds_read_b64_tr_b16 a[110:111], v7 offset:28160
    s_waitcnt lgkmcnt(4)
    s_add_u32 m0, s32, 24576
    s_add_u32 s38, s38, 32768
    buffer_load_dwordx4 v6, s[8:11], s38 offen lds
    s_add_u32 m0, s32, 25600
    s_add_u32 s38, s38, 32768
    buffer_load_dwordx4 v6, s[8:11], s38 offen lds
    s_waitcnt vmcnt(28)
    ds_read_b64_tr_b16 a[112:113], v7 offset:28672
    ds_read_b64_tr_b16 a[114:115], v7 offset:29184
    ds_read_b64_tr_b16 a[116:117], v7 offset:29696
    ds_read_b64_tr_b16 a[118:119], v7 offset:30208
    s_waitcnt lgkmcnt(4)
    s_add_u32 m0, s32, 26624
    s_add_u32 s38, s38, 32768
    buffer_load_dwordx4 v6, s[8:11], s38 offen lds
    s_add_u32 m0, s32, 27648
    s_add_u32 s38, s38, 32768
    buffer_load_dwordx4 v6, s[8:11], s38 offen lds
    s_waitcnt vmcnt(28)
    ds_read_b64_tr_b16 a[120:121], v7 offset:30720
    ds_read_b64_tr_b16 a[122:123], v7 offset:31232
    ds_read_b64_tr_b16 a[124:125], v7 offset:31744
    ds_read_b64_tr_b16 a[126:127], v7 offset:32256
    s_waitcnt lgkmcnt(4)
    s_add_u32 m0, s32, 28672
    s_add_u32 s38, s38, 32768
    buffer_load_dwordx4 v6, s[8:11], s38 offen lds
    s_add_u32 m0, s32, 29696
    s_add_u32 s38, s38, 32768
    buffer_load_dwordx4 v6, s[8:11], s38 offen lds
    s_waitcnt vmcnt(28)
    ds_read_b64_tr_b16 a[128:129], v7 offset:0
    ds_read_b64_tr_b16 a[130:131], v7 offset:512
    ds_read_b64_tr_b16 a[132:133], v7 offset:1024
    ds_read_b64_tr_b16 a[134:135], v7 offset:1536
    s_waitcnt lgkmcnt(4)
    s_add_u32 m0, s32, 30720
    s_add_u32 s38, s38, 32768
    buffer_load_dwordx4 v6, s[8:11], s38 offen lds
    s_add_u32 m0, s32, 31744
    s_add_u32 s38, s38, 32768
    buffer_load_dwordx4 v6, s[8:11], s38 offen lds
    s_waitcnt vmcnt(28)
    ds_read_b64_tr_b16 a[136:137], v7 offset:2048
    ds_read_b64_tr_b16 a[138:139], v7 offset:2560
    ds_read_b64_tr_b16 a[140:141], v7 offset:3072
    ds_read_b64_tr_b16 a[142:143], v7 offset:3584
    s_waitcnt lgkmcnt(4)
    s_add_u32 m0, s32, 0
    s_mov_b32 s38, 64
    buffer_load_dwordx4 v6, s[8:11], s38 offen lds
    s_add_u32 m0, s32, 1024
    s_add_u32 s38, s38, 65536
    buffer_load_dwordx4 v6, s[8:11], s38 offen lds
    s_waitcnt vmcnt(28)
    ds_read_b64_tr_b16 a[144:145], v7 offset:4096
    ds_read_b64_tr_b16 a[146:147], v7 offset:4608
    ds_read_b64_tr_b16 a[148:149], v7 offset:5120
    ds_read_b64_tr_b16 a[150:151], v7 offset:5632
    s_waitcnt lgkmcnt(4)
    s_add_u32 m0, s32, 2048
    s_add_u32 s38, s38, 65536
    buffer_load_dwordx4 v6, s[8:11], s38 offen lds
    s_add_u32 m0, s32, 3072
    s_add_u32 s38, s38, 65536
    buffer_load_dwordx4 v6, s[8:11], s38 offen lds
    s_waitcnt vmcnt(28)
    ds_read_b64_tr_b16 a[152:153], v7 offset:6144
    ds_read_b64_tr_b16 a[154:155], v7 offset:6656
    ds_read_b64_tr_b16 a[156:157], v7 offset:7168
    ds_read_b64_tr_b16 a[158:159], v7 offset:7680
    s_waitcnt lgkmcnt(4)
    s_add_u32 m0, s32, 4096
    s_add_u32 s38, s38, 65536
    buffer_load_dwordx4 v6, s[8:11], s38 offen lds
    s_add_u32 m0, s32, 5120
    s_add_u32 s38, s38, 65536
    buffer_load_dwordx4 v6, s[8:11], s38 offen lds
    s_waitcnt vmcnt(28)
    ds_read_b64_tr_b16 a[160:161], v7 offset:8192
    ds_read_b64_tr_b16 a[162:163], v7 offset:8704
    ds_read_b64_tr_b16 a[164:165], v7 offset:9216
    ds_read_b64_tr_b16 a[166:167], v7 offset:9728
    s_waitcnt lgkmcnt(4)
    s_add_u32 m0, s32, 6144
    s_add_u32 s38, s38, 65536
    buffer_load_dwordx4 v6, s[8:11], s38 offen lds
    s_add_u32 m0, s32, 7168
    s_add_u32 s38, s38, 65536
    buffer_load_dwordx4 v6, s[8:11], s38 offen lds
    s_waitcnt vmcnt(28)
    ds_read_b64_tr_b16 a[168:169], v7 offset:10240
    ds_read_b64_tr_b16 a[170:171], v7 offset:10752
    ds_read_b64_tr_b16 a[172:173], v7 offset:11264
    ds_read_b64_tr_b16 a[174:175], v7 offset:11776
    s_waitcnt lgkmcnt(4)
    s_add_u32 m0, s32, 8192
    s_add_u32 s38, s38, 65536
    buffer_load_dwordx4 v6, s[8:11], s38 offen lds
    s_add_u32 m0, s32, 9216
    s_add_u32 s38, s38, 65536
    buffer_load_dwordx4 v6, s[8:11], s38 offen lds
    s_waitcnt vmcnt(28)
    ds_read_b64_tr_b16 a[176:177], v7 offset:12288
    ds_read_b64_tr_b16 a[178:179], v7 offset:12800
    ds_read_b64_tr_b16 a[180:181], v7 offset:13312
    ds_read_b64_tr_b16 a[182:183], v7 offset:13824
    s_waitcnt lgkmcnt(4)
    s_add_u32 m0, s32, 10240
    s_add_u32 s38, s38, 65536
    buffer_load_dwordx4 v6, s[8:11], s38 offen lds
    s_add_u32 m0, s32, 11264
    s_add_u32 s38, s38, 65536
    buffer_load_dwordx4 v6, s[8:11], s38 offen lds
    s_waitcnt vmcnt(28)
    ds_read_b64_tr_b16 a[184:185], v7 offset:14336
    ds_read_b64_tr_b16 a[186:187], v7 offset:14848
    ds_read_b64_tr_b16 a[188:189], v7 offset:15360
    ds_read_b64_tr_b16 a[190:191], v7 offset:15872
    s_waitcnt lgkmcnt(4)
    s_add_u32 m0, s32, 12288
    s_add_u32 s38, s38, 65536
    buffer_load_dwordx4 v6, s[8:11], s38 offen lds
    s_add_u32 m0, s32, 13312
    s_add_u32 s38, s38, 65536
    buffer_load_dwordx4 v6, s[8:11], s38 offen lds
    s_waitcnt vmcnt(28)
    ds_read_b64_tr_b16 a[192:193], v7 offset:16384
    ds_read_b64_tr_b16 a[194:195], v7 offset:16896
    ds_read_b64_tr_b16 a[196:197], v7 offset:17408
    ds_read_b64_tr_b16 a[198:199], v7 offset:17920
    s_waitcnt lgkmcnt(4)
    s_add_u32 m0, s32, 14336
    s_add_u32 s38, s38, 65536
    buffer_load_dwordx4 v6, s[8:11], s38 offen lds
    s_add_u32 m0, s32, 15360
    s_add_u32 s38, s38, 65536
    buffer_load_dwordx4 v6, s[8:11], s38 offen lds
    s_waitcnt vmcnt(28)
    ds_read_b64_tr_b16 a[200:201], v7 offset:18432
    ds_read_b64_tr_b16 a[202:203], v7 offset:18944
    ds_read_b64_tr_b16 a[204:205], v7 offset:19456
    ds_read_b64_tr_b16 a[206:207], v7 offset:19968
    s_waitcnt lgkmcnt(4)
    s_add_u32 m0, s32, 16384
    s_add_u32 s38, s38, 65536
    buffer_load_dwordx4 v6, s[8:11], s38 offen lds
    s_add_u32 m0, s32, 17408
    s_add_u32 s38, s38, 65536
    buffer_load_dwordx4 v6, s[8:11], s38 offen lds
    s_waitcnt vmcnt(28)
    ds_read_b64_tr_b16 a[208:209], v7 offset:20480
    ds_read_b64_tr_b16 a[210:211], v7 offset:20992
    ds_read_b64_tr_b16 a[212:213], v7 offset:21504
    ds_read_b64_tr_b16 a[214:215], v7 offset:22016
    s_waitcnt lgkmcnt(4)
    s_add_u32 m0, s32, 18432
    s_add_u32 s38, s38, 65536
    buffer_load_dwordx4 v6, s[8:11], s38 offen lds
    s_add_u32 m0, s32, 19456
    s_add_u32 s38, s38, 65536
    buffer_load_dwordx4 v6, s[8:11], s38 offen lds
    s_waitcnt vmcnt(28)
    ds_read_b64_tr_b16 a[216:217], v7 offset:22528
    ds_read_b64_tr_b16 a[218:219], v7 offset:23040
    ds_read_b64_tr_b16 a[220:221], v7 offset:23552
    ds_read_b64_tr_b16 a[222:223], v7 offset:24064
    s_waitcnt lgkmcnt(4)
    s_add_u32 m0, s32, 20480
    s_add_u32 s38, s38, 65536
    buffer_load_dwordx4 v6, s[8:11], s38 offen lds
    s_add_u32 m0, s32, 21504
    s_add_u32 s38, s38, 65536
    buffer_load_dwordx4 v6, s[8:11], s38 offen lds
    s_waitcnt vmcnt(28)
    ds_read_b64_tr_b16 a[224:225], v7 offset:24576
    ds_read_b64_tr_b16 a[226:227], v7 offset:25088
    ds_read_b64_tr_b16 a[228:229], v7 offset:25600
    ds_read_b64_tr_b16 a[230:231], v7 offset:26112
    s_waitcnt lgkmcnt(4)
    s_add_u32 m0, s32, 22528
    s_add_u32 s38, s38, 65536
    buffer_load_dwordx4 v6, s[8:11], s38 offen lds
    s_add_u32 m0, s32, 23552
    s_add_u32 s38, s38, 65536
    buffer_load_dwordx4 v6, s[8:11], s38 offen lds
    s_waitcnt vmcnt(28)
    ds_read_b64_tr_b16 a[232:233], v7 offset:26624
    ds_read_b64_tr_b16 a[234:235], v7 offset:27136
    ds_read_b64_tr_b16 a[236:237], v7 offset:27648
    ds_read_b64_tr_b16 a[238:239], v7 offset:28160
    s_waitcnt lgkmcnt(4)
    s_add_u32 m0, s32, 24576
    s_add_u32 s38, s38, 65536
    buffer_load_dwordx4 v6, s[8:11], s38 offen lds
    s_add_u32 m0, s32, 25600
    s_add_u32 s38, s38, 65536
    buffer_load_dwordx4 v6, s[8:11], s38 offen lds
    s_waitcnt vmcnt(28)
    ds_read_b64_tr_b16 a[240:241], v7 offset:28672
    ds_read_b64_tr_b16 a[242:243], v7 offset:29184
    ds_read_b64_tr_b16 a[244:245], v7 offset:29696
    ds_read_b64_tr_b16 a[246:247], v7 offset:30208
    s_waitcnt lgkmcnt(4)
    s_add_u32 m0, s32, 26624
    s_add_u32 s38, s38, 65536
    buffer_load_dwordx4 v6, s[8:11], s38 offen lds
    s_add_u32 m0, s32, 27648
    s_add_u32 s38, s38, 65536
    buffer_load_dwordx4 v6, s[8:11], s38 offen lds
    s_waitcnt vmcnt(28)
    ds_read_b64_tr_b16 a[248:249], v7 offset:30720
    ds_read_b64_tr_b16 a[250:251], v7 offset:31232
    ds_read_b64_tr_b16 a[252:253], v7 offset:31744
    ds_read_b64_tr_b16 a[254:255], v7 offset:32256
    s_waitcnt lgkmcnt(4)
    s_add_u32 m0, s32, 28672
    s_add_u32 s38, s38, 65536
    buffer_load_dwordx4 v6, s[8:11], s38 offen lds
    s_add_u32 m0, s32, 29696
    s_add_u32 s38, s38, 65536
    buffer_load_dwordx4 v6, s[8:11], s38 offen lds
    s_waitcnt vmcnt(28)
    ds_read_b64_tr_b16 v[128:129], v7 offset:0
    ds_read_b64_tr_b16 v[130:131], v7 offset:512
    ds_read_b64_tr_b16 v[132:133], v7 offset:1024
    ds_read_b64_tr_b16 v[134:135], v7 offset:1536
    s_waitcnt lgkmcnt(4)
    s_add_u32 m0, s32, 30720
    s_add_u32 s38, s38, 65536
    buffer_load_dwordx4 v6, s[8:11], s38 offen lds
    s_add_u32 m0, s32, 31744
    s_add_u32 s38, s38, 65536
    buffer_load_dwordx4 v6, s[8:11], s38 offen lds
    s_waitcnt vmcnt(28)
    ds_read_b64_tr_b16 v[136:137], v7 offset:2048
    ds_read_b64_tr_b16 v[138:139], v7 offset:2560
    ds_read_b64_tr_b16 v[140:141], v7 offset:3072
    ds_read_b64_tr_b16 v[142:143], v7 offset:3584
    s_waitcnt lgkmcnt(4)
    s_add_u32 m0, s32, 0
    s_mov_b32 s38, 32832
    buffer_load_dwordx4 v6, s[8:11], s38 offen lds
    s_add_u32 m0, s32, 1024
    s_add_u32 s38, s38, 65536
    buffer_load_dwordx4 v6, s[8:11], s38 offen lds
    s_waitcnt vmcnt(28)
    ds_read_b64_tr_b16 v[144:145], v7 offset:4096
    ds_read_b64_tr_b16 v[146:147], v7 offset:4608
    ds_read_b64_tr_b16 v[148:149], v7 offset:5120
    ds_read_b64_tr_b16 v[150:151], v7 offset:5632
    s_waitcnt lgkmcnt(4)
    s_add_u32 m0, s32, 2048
    s_add_u32 s38, s38, 65536
    buffer_load_dwordx4 v6, s[8:11], s38 offen lds
    s_add_u32 m0, s32, 3072
    s_add_u32 s38, s38, 65536
    buffer_load_dwordx4 v6, s[8:11], s38 offen lds
    s_waitcnt vmcnt(28)
    ds_read_b64_tr_b16 v[152:153], v7 offset:6144
    ds_read_b64_tr_b16 v[154:155], v7 offset:6656
    ds_read_b64_tr_b16 v[156:157], v7 offset:7168
    ds_read_b64_tr_b16 v[158:159], v7 offset:7680
    s_waitcnt lgkmcnt(4)
    s_add_u32 m0, s32, 4096
    s_add_u32 s38, s38, 65536
    buffer_load_dwordx4 v6, s[8:11], s38 offen lds
    s_add_u32 m0, s32, 5120
    s_add_u32 s38, s38, 65536
    buffer_load_dwordx4 v6, s[8:11], s38 offen lds
    s_waitcnt vmcnt(28)
    ds_read_b64_tr_b16 v[160:161], v7 offset:8192
    ds_read_b64_tr_b16 v[162:163], v7 offset:8704
    ds_read_b64_tr_b16 v[164:165], v7 offset:9216
    ds_read_b64_tr_b16 v[166:167], v7 offset:9728
    s_waitcnt lgkmcnt(4)
    s_add_u32 m0, s32, 6144
    s_add_u32 s38, s38, 65536
    buffer_load_dwordx4 v6, s[8:11], s38 offen lds
    s_add_u32 m0, s32, 7168
    s_add_u32 s38, s38, 65536
    buffer_load_dwordx4 v6, s[8:11], s38 offen lds
    s_waitcnt vmcnt(28)
    ds_read_b64_tr_b16 v[168:169], v7 offset:10240
    ds_read_b64_tr_b16 v[170:171], v7 offset:10752
    ds_read_b64_tr_b16 v[172:173], v7 offset:11264
    ds_read_b64_tr_b16 v[174:175], v7 offset:11776
    s_waitcnt lgkmcnt(4)
    s_add_u32 m0, s32, 8192
    s_add_u32 s38, s38, 65536
    buffer_load_dwordx4 v6, s[8:11], s38 offen lds
    s_add_u32 m0, s32, 9216
    s_add_u32 s38, s38, 65536
    buffer_load_dwordx4 v6, s[8:11], s38 offen lds
    s_waitcnt vmcnt(28)
    ds_read_b64_tr_b16 v[176:177], v7 offset:12288
    ds_read_b64_tr_b16 v[178:179], v7 offset:12800
    ds_read_b64_tr_b16 v[180:181], v7 offset:13312
    ds_read_b64_tr_b16 v[182:183], v7 offset:13824
    s_waitcnt lgkmcnt(4)
    s_add_u32 m0, s32, 10240
    s_add_u32 s38, s38, 65536
    buffer_load_dwordx4 v6, s[8:11], s38 offen lds
    s_add_u32 m0, s32, 11264
    s_add_u32 s38, s38, 65536
    buffer_load_dwordx4 v6, s[8:11], s38 offen lds
    s_waitcnt vmcnt(28)
    ds_read_b64_tr_b16 v[184:185], v7 offset:14336
    ds_read_b64_tr_b16 v[186:187], v7 offset:14848
    ds_read_b64_tr_b16 v[188:189], v7 offset:15360
    ds_read_b64_tr_b16 v[190:191], v7 offset:15872
    s_waitcnt lgkmcnt(4)
    s_add_u32 m0, s32, 12288
    s_add_u32 s38, s38, 65536
    buffer_load_dwordx4 v6, s[8:11], s38 offen lds
    s_add_u32 m0, s32, 13312
    s_add_u32 s38, s38, 65536
    buffer_load_dwordx4 v6, s[8:11], s38 offen lds
    s_waitcnt vmcnt(28)
    ds_read_b64_tr_b16 v[192:193], v7 offset:16384
    ds_read_b64_tr_b16 v[194:195], v7 offset:16896
    ds_read_b64_tr_b16 v[196:197], v7 offset:17408
    ds_read_b64_tr_b16 v[198:199], v7 offset:17920
    s_waitcnt lgkmcnt(4)
    s_add_u32 m0, s32, 14336
    s_add_u32 s38, s38, 65536
    buffer_load_dwordx4 v6, s[8:11], s38 offen lds
    s_add_u32 m0, s32, 15360
    s_add_u32 s38, s38, 65536
    buffer_load_dwordx4 v6, s[8:11], s38 offen lds
    s_waitcnt vmcnt(28)
    ds_read_b64_tr_b16 v[200:201], v7 offset:18432
    ds_read_b64_tr_b16 v[202:203], v7 offset:18944
    ds_read_b64_tr_b16 v[204:205], v7 offset:19456
    ds_read_b64_tr_b16 v[206:207], v7 offset:19968
    s_waitcnt lgkmcnt(4)
    s_add_u32 m0, s32, 16384
    s_add_u32 s38, s38, 65536
    buffer_load_dwordx4 v6, s[8:11], s38 offen lds
    s_add_u32 m0, s32, 17408
    s_add_u32 s38, s38, 65536
    buffer_load_dwordx4 v6, s[8:11], s38 offen lds
    s_waitcnt vmcnt(28)
    ds_read_b64_tr_b16 v[208:209], v7 offset:20480
    ds_read_b64_tr_b16 v[210:211], v7 offset:20992
    ds_read_b64_tr_b16 v[212:213], v7 offset:21504
    ds_read_b64_tr_b16 v[214:215], v7 offset:22016
    s_waitcnt lgkmcnt(4)
    s_add_u32 m0, s32, 18432
    s_add_u32 s38, s38, 65536
    buffer_load_dwordx4 v6, s[8:11], s38 offen lds
    s_add_u32 m0, s32, 19456
    s_add_u32 s38, s38, 65536
    buffer_load_dwordx4 v6, s[8:11], s38 offen lds
    s_waitcnt vmcnt(28)
    ds_read_b64_tr_b16 v[216:217], v7 offset:22528
    ds_read_b64_tr_b16 v[218:219], v7 offset:23040
    ds_read_b64_tr_b16 v[220:221], v7 offset:23552
    ds_read_b64_tr_b16 v[222:223], v7 offset:24064
    s_waitcnt lgkmcnt(4)
    s_add_u32 m0, s32, 20480
    s_add_u32 s38, s38, 65536
    buffer_load_dwordx4 v6, s[8:11], s38 offen lds
    s_add_u32 m0, s32, 21504
    s_add_u32 s38, s38, 65536
    buffer_load_dwordx4 v6, s[8:11], s38 offen lds
    s_waitcnt vmcnt(28)
    ds_read_b64_tr_b16 v[224:225], v7 offset:24576
    ds_read_b64_tr_b16 v[226:227], v7 offset:25088
    ds_read_b64_tr_b16 v[228:229], v7 offset:25600
    ds_read_b64_tr_b16 v[230:231], v7 offset:26112
    s_waitcnt lgkmcnt(4)
    s_add_u32 m0, s32, 22528
    s_add_u32 s38, s38, 65536
    buffer_load_dwordx4 v6, s[8:11], s38 offen lds
    s_add_u32 m0, s32, 23552
    s_add_u32 s38, s38, 65536
    buffer_load_dwordx4 v6, s[8:11], s38 offen lds
    s_waitcnt vmcnt(28)
    ds_read_b64_tr_b16 v[232:233], v7 offset:26624
    ds_read_b64_tr_b16 v[234:235], v7 offset:27136
    ds_read_b64_tr_b16 v[236:237], v7 offset:27648
    ds_read_b64_tr_b16 v[238:239], v7 offset:28160
    s_waitcnt lgkmcnt(4)
    s_add_u32 m0, s32, 24576
    s_add_u32 s38, s38, 65536
    buffer_load_dwordx4 v6, s[8:11], s38 offen lds
    s_add_u32 m0, s32, 25600
    s_add_u32 s38, s38, 65536
    buffer_load_dwordx4 v6, s[8:11], s38 offen lds
    s_waitcnt vmcnt(28)
    ds_read_b64_tr_b16 v[240:241], v7 offset:28672
    ds_read_b64_tr_b16 v[242:243], v7 offset:29184
    ds_read_b64_tr_b16 v[244:245], v7 offset:29696
    ds_read_b64_tr_b16 v[246:247], v7 offset:30208
    s_waitcnt lgkmcnt(4)
    s_add_u32 m0, s32, 26624
    s_add_u32 s38, s38, 65536
    buffer_load_dwordx4 v6, s[8:11], s38 offen lds
    s_add_u32 m0, s32, 27648
    s_add_u32 s38, s38, 65536
    buffer_load_dwordx4 v6, s[8:11], s38 offen lds
    s_waitcnt vmcnt(28)
    ds_read_b64_tr_b16 v[248:249], v7 offset:30720
    ds_read_b64_tr_b16 v[250:251], v7 offset:31232
    ds_read_b64_tr_b16 v[252:253], v7 offset:31744
    ds_read_b64_tr_b16 v[254:255], v7 offset:32256
    s_waitcnt lgkmcnt(4)
    s_add_u32 m0, s32, 28672
    s_add_u32 s38, s38, 65536
    buffer_load_dwordx4 v6, s[8:11], s38 offen lds
    s_add_u32 m0, s32, 29696
    s_add_u32 s38, s38, 65536
    buffer_load_dwordx4 v6, s[8:11], s38 offen lds
    s_waitcnt vmcnt(28)
    s_waitcnt lgkmcnt(0)
    s_add_u32 m0, s32, 30720
    s_add_u32 s38, s38, 65536
    buffer_load_dwordx4 v6, s[8:11], s38 offen lds
    s_add_u32 m0, s32, 31744
    s_add_u32 s38, s38, 65536
    buffer_load_dwordx4 v6, s[8:11], s38 offen lds
    s_waitcnt vmcnt(28)
    s_waitcnt vmcnt(26)
    s_waitcnt vmcnt(24)
    s_waitcnt vmcnt(22)
    s_waitcnt vmcnt(20)
    s_waitcnt vmcnt(18)
    s_waitcnt vmcnt(16)
    s_waitcnt vmcnt(14)
    s_waitcnt vmcnt(12)
    s_waitcnt vmcnt(10)
    s_waitcnt vmcnt(8)
    s_waitcnt vmcnt(6)
    s_waitcnt vmcnt(4)
    s_waitcnt vmcnt(2)
    s_waitcnt vmcnt(0)
    s_waitcnt lgkmcnt(0)
    s_lshl_b32 s31, s29, 16
    v_add_u32 v8, s31, v5
    s_lshl_b32 s31, s29, 13
    s_add_u32 s31, s31, 131072
    v_add_u32 v9, s31, v5
    s_lshl_b32 s31, s29, 7
    s_add_u32 s31, s31, 131072
    v_bfe_u32 v10, v1, 1, 2
    v_lshlrev_b32 v10, 10, v10
    v_and_b32 v4, 1, v1
    v_lshl_add_u32 v10, v4, 9, v10
    v_lshrrev_b32 v4, 3, v1
    v_lshl_add_u32 v10, v4, 4, v10
    v_add_u32 v10, s31, v10
    s_lshl_b32 s31, s29, 15
    s_lshl_b32 s33, s44, 7
    s_add_u32 s31, s31, s33
    v_lshrrev_b32 v11, 3, v1
    v_lshlrev_b32 v11, 12, v11
    v_and_b32 v4, 7, v1
    v_lshl_add_u32 v11, v4, 3, v11
    v_add_u32 v11, s31, v11
    v_mov_b32 v2, 0
g_wd_68:
    global_load_dword v3, v2, s[92:93] offset:0 sc1
    s_add_u32 s41, s41, 1
    s_cmp_ge_u32 s41, 0x200000
    s_cbranch_scc1 g_wdd_69
    s_waitcnt vmcnt(0)
    v_cmp_le_u32 vcc, 256, v3
    s_cbranch_vccnz g_wdd_69
    s_sleep 4
    s_branch g_wd_68
g_wdd_69:
    s_waitcnt vmcnt(0)
o6_loop_70:
    s_add_u32 s35, s30, 1
    v_and_b32 v2, 31, v1
    v_lshlrev_b32 v2, 7, v2
    v_add_u32 v2, 115355648, v2
g_wl_71:
    buffer_load_dword v3, v2, s[4:7], 0 offen sc1
    s_add_u32 s41, s41, 1
    s_cmp_ge_u32 s41, 0x200000
    s_cbranch_scc1 g_wld_72
    s_waitcnt vmcnt(0)
    v_cmp_gt_u32 vcc, s35, v3
    s_cbranch_vccz g_wld_72
    s_sleep 8
    s_branch g_wl_71
g_wld_72:
    s_waitcnt vmcnt(0)
    s_lshl_b32 s47, s30, 18
    s_add_u32 s47, s47, 67108864
    s_lshl_b32 s49, s30, 17
    s_add_u32 s31, s47, 0
    buffer_load_dwordx4 v[64:67], v8, s[4:7], s31 offen offset:0 sc1
    buffer_load_dwordx4 v[68:71], v8, s[4:7], s31 offen offset:1024 sc1
    buffer_load_dwordx4 v[72:75], v8, s[4:7], s31 offen offset:2048 sc1
    buffer_load_dwordx4 v[76:79], v8, s[4:7], s31 offen offset:3072 sc1
    s_add_u32 s31, s47, 4096
    buffer_load_dwordx4 v[80:83], v8, s[4:7], s31 offen offset:0 sc1
    buffer_load_dwordx4 v[84:87], v8, s[4:7], s31 offen offset:1024 sc1
    buffer_load_dwordx4 v[88:91], v8, s[4:7], s31 offen offset:2048 sc1
    buffer_load_dwordx4 v[92:95], v8, s[4:7], s31 offen offset:3072 sc1
    s_add_u32 s31, s47, 8192
    buffer_load_dwordx4 v[96:99], v8, s[4:7], s31 offen offset:0 sc1
    buffer_load_dwordx4 v[100:103], v8, s[4:7], s31 offen offset:1024 sc1
    buffer_load_dwordx4 v[104:107], v8, s[4:7], s31 offen offset:2048 sc1
    buffer_load_dwordx4 v[108:111], v8, s[4:7], s31 offen offset:3072 sc1
    s_add_u32 s31, s47, 12288
    buffer_load_dwordx4 v[112:115], v8, s[4:7], s31 offen offset:0 sc1
    buffer_load_dwordx4 v[116:119], v8, s[4:7], s31 offen offset:1024 sc1
    buffer_load_dwordx4 v[120:123], v8, s[4:7], s31 offen offset:2048 sc1
    buffer_load_dwordx4 v[124:127], v8, s[4:7], s31 offen offset:3072 sc1
    ds_read_b64_tr_b16 v[16:17], v7 offset:0
    ds_read_b64_tr_b16 v[18:19], v7 offset:512
    ds_read_b64_tr_b16 v[20:21], v7 offset:1024
    ds_read_b64_tr_b16 v[22:23], v7 offset:1536
    ds_read_b64_tr_b16 v[24:25], v7 offset:2048
    ds_read_b64_tr_b16 v[26:27], v7 offset:2560
    s_waitcnt vmcnt(15)
    v_mfma_f32_32x32x16_bf16 v[32:47], a[0:3], v[64:67], 0
    v_mfma_f32_32x32x16_bf16 v[48:63], v[128:131], v[64:67], 0
    s_waitcnt vmcnt(14)
    v_mfma_f32_32x32x16_bf16 v[32:47], a[4:7], v[68:71], v[32:47]
    s_add_u32 s31, s47, 16384
    buffer_load_dwordx4 v[64:67], v8, s[4:7], s31 offen offset:0 sc1
    s_waitcnt lgkmcnt(4)
    v_mfma_f32_32x32x16_bf16 v[48:63], v[16:19], v[68:71], v[48:63]
    ds_read_b64_tr_b16 v[28:29], v7 offset:3072
    ds_read_b64_tr_b16 v[30:31], v7 offset:3584
    s_waitcnt vmcnt(14)
    v_mfma_f32_32x32x16_bf16 v[32:47], a[8:11], v[72:75], v[32:47]
    buffer_load_dwordx4 v[68:71], v8, s[4:7], s31 offen offset:1024 sc1
    v_mfma_f32_32x32x16_bf16 v[48:63], v[132:135], v[72:75], v[48:63]
    s_waitcnt vmcnt(14)
    v_mfma_f32_32x32x16_bf16 v[32:47], a[12:15], v[76:79], v[32:47]
    buffer_load_dwordx4 v[72:75], v8, s[4:7], s31 offen offset:2048 sc1
    s_waitcnt lgkmcnt(4)
    v_mfma_f32_32x32x16_bf16 v[48:63], v[20:23], v[76:79], v[48:63]
    ds_read_b64_tr_b16 v[16:17], v7 offset:4096
    ds_read_b64_tr_b16 v[18:19], v7 offset:4608
    s_waitcnt vmcnt(14)
    v_mfma_f32_32x32x16_bf16 v[32:47], a[16:19], v[80:83], v[32:47]
    buffer_load_dwordx4 v[76:79], v8, s[4:7], s31 offen offset:3072 sc1
    v_mfma_f32_32x32x16_bf16 v[48:63], v[136:139], v[80:83], v[48:63]
    s_waitcnt vmcnt(14)
    v_mfma_f32_32x32x16_bf16 v[32:47], a[20:23], v[84:87], v[32:47]
    s_add_u32 s31, s47, 20480
    buffer_load_dwordx4 v[80:83], v8, s[4:7], s31 offen offset:0 sc1
    s_waitcnt lgkmcnt(4)
    v_mfma_f32_32x32x16_bf16 v[48:63], v[24:27], v[84:87], v[48:63]
    ds_read_b64_tr_b16 v[20:21], v7 offset:5120
    ds_read_b64_tr_b16 v[22:23], v7 offset:5632
    s_waitcnt vmcnt(14)
    v_mfma_f32_32x32x16_bf16 v[32:47], a[24:27], v[88:91], v[32:47]
    buffer_load_dwordx4 v[84:87], v8, s[4:7], s31 offen offset:1024 sc1
    v_mfma_f32_32x32x16_bf16 v[48:63], v[140:143], v[88:91], v[48:63]
    s_waitcnt vmcnt(14)
    v_mfma_f32_32x32x16_bf16 v[32:47], a[28:31], v[92:95], v[32:47]
    buffer_load_dwordx4 v[88:91], v8, s[4:7], s31 offen offset:2048 sc1
    s_waitcnt lgkmcnt(4)
    v_mfma_f32_32x32x16_bf16 v[48:63], v[28:31], v[92:95], v[48:63]
    ds_read_b64_tr_b16 v[24:25], v7 offset:6144
    ds_read_b64_tr_b16 v[26:27], v7 offset:6656
    s_waitcnt vmcnt(14)
    v_mfma_f32_32x32x16_bf16 v[32:47], a[32:35], v[96:99], v[32:47]
    buffer_load_dwordx4 v[92:95], v8, s[4:7], s31 offen offset:3072 sc1
    v_mfma_f32_32x32x16_bf16 v[48:63], v[144:147], v[96:99], v[48:63]
    s_waitcnt vmcnt(14)
    v_mfma_f32_32x32x16_bf16 v[32:47], a[36:39], v[100:103], v[32:47]
    s_add_u32 s31, s47, 24576
    buffer_load_dwordx4 v[96:99], v8, s[4:7], s31 offen offset:0 sc1
    s_waitcnt lgkmcnt(4)
    v_mfma_f32_32x32x16_bf16 v[48:63], v[16:19], v[100:103], v[48:63]
    ds_read_b64_tr_b16 v[28:29], v7 offset:7168
    ds_read_b64_tr_b16 v[30:31], v7 offset:7680
    s_waitcnt vmcnt(14)
    v_mfma_f32_32x32x16_bf16 v[32:47], a[40:43], v[104:107], v[32:47]
    buffer_load_dwordx4 v[100:103], v8, s[4:7], s31 offen offset:1024 sc1
    v_mfma_f32_32x32x16_bf16 v[48:63], v[148:151], v[104:107], v[48:63]
    s_waitcnt vmcnt(14)
    v_mfma_f32_32x32x16_bf16 v[32:47], a[44:47], v[108:111], v[32:47]
    buffer_load_dwordx4 v[104:107], v8, s[4:7], s31 offen offset:2048 sc1
    s_waitcnt lgkmcnt(4)
    v_mfma_f32_32x32x16_bf16 v[48:63], v[20:23], v[108:111], v[48:63]
    ds_read_b64_tr_b16 v[16:17], v7 offset:8192
    ds_read_b64_tr_b16 v[18:19], v7 offset:8704
    s_waitcnt vmcnt(14)
    v_mfma_f32_32x32x16_bf16 v[32:47], a[48:51], v[112:115], v[32:47]
    buffer_load_dwordx4 v[108:111], v8, s[4:7], s31 offen offset:3072 sc1
    v_mfma_f32_32x32x16_bf16 v[48:63], v[152:155], v[112:115], v[48:63]
    s_waitcnt vmcnt(14)
    v_mfma_f32_32x32x16_bf16 v[32:47], a[52:55], v[116:119], v[32:47]
    s_add_u32 s31, s47, 28672
    buffer_load_dwordx4 v[112:115], v8, s[4:7], s31 offen offset:0 sc1
    s_waitcnt lgkmcnt(4)
    v_mfma_f32_32x32x16_bf16 v[48:63], v[24:27], v[116:119], v[48:63]
    ds_read_b64_tr_b16 v[20:21], v7 offset:9216
    ds_read_b64_tr_b16 v[22:23], v7 offset:9728
    s_waitcnt vmcnt(14)
    v_mfma_f32_32x32x16_bf16 v[32:47], a[56:59], v[120:123], v[32:47]
    buffer_load_dwordx4 v[116:119], v8, s[4:7], s31 offen offset:1024 sc1
    v_mfma_f32_32x32x16_bf16 v[48:63], v[156:159], v[120:123], v[48:63]
    s_waitcnt vmcnt(14)
    v_mfma_f32_32x32x16_bf16 v[32:47], a[60:63], v[124:127], v[32:47]
    buffer_load_dwordx4 v[120:123], v8, s[4:7], s31 offen offset:2048 sc1
    s_waitcnt lgkmcnt(4)
    v_mfma_f32_32x32x16_bf16 v[48:63], v[28:31], v[124:127], v[48:63]
    ds_read_b64_tr_b16 v[24:25], v7 offset:10240
    ds_read_b64_tr_b16 v[26:27], v7 offset:10752
    s_waitcnt vmcnt(14)
    v_mfma_f32_32x32x16_bf16 v[32:47], a[64:67], v[64:67], v[32:47]
    buffer_load_dwordx4 v[124:127], v8, s[4:7], s31 offen offset:3072 sc1
    v_mfma_f32_32x32x16_bf16 v[48:63], v[160:163], v[64:67], v[48:63]
    s_waitcnt vmcnt(14)
    v_mfma_f32_32x32x16_bf16 v[32:47], a[68:71], v[68:71], v[32:47]
    s_add_u32 s31, s47, 32768
    buffer_load_dwordx4 v[64:67], v8, s[4:7], s31 offen offset:0 sc1
    s_waitcnt lgkmcnt(4)
    v_mfma_f32_32x32x16_bf16 v[48:63], v[16:19], v[68:71], v[48:63]
    ds_read_b64_tr_b16 v[28:29], v7 offset:11264
    ds_read_b64_tr_b16 v[30:31], v7 offset:11776
    s_waitcnt vmcnt(14)
    v_mfma_f32_32x32x16_bf16 v[32:47], a[72:75], v[72:75], v[32:47]
    buffer_load_dwordx4 v[68:71], v8, s[4:7], s31 offen offset:1024 sc1
    v_mfma_f32_32x32x16_bf16 v[48:63], v[164:167], v[72:75], v[48:63]
    s_waitcnt vmcnt(14)
    v_mfma_f32_32x32x16_bf16 v[32:47], a[76:79], v[76:79], v[32:47]
    buffer_load_dwordx4 v[72:75], v8, s[4:7], s31 offen offset:2048 sc1
    s_waitcnt lgkmcnt(4)
    v_mfma_f32_32x32x16_bf16 v[48:63], v[20:23], v[76:79], v[48:63]
    ds_read_b64_tr_b16 v[16:17], v7 offset:12288
    ds_read_b64_tr_b16 v[18:19], v7 offset:12800
    s_waitcnt vmcnt(14)
    v_mfma_f32_32x32x16_bf16 v[32:47], a[80:83], v[80:83], v[32:47]
    buffer_load_dwordx4 v[76:79], v8, s[4:7], s31 offen offset:3072 sc1
    v_mfma_f32_32x32x16_bf16 v[48:63], v[168:171], v[80:83], v[48:63]
    s_waitcnt vmcnt(14)
    v_mfma_f32_32x32x16_bf16 v[32:47], a[84:87], v[84:87], v[32:47]
    s_add_u32 s31, s47, 36864
    buffer_load_dwordx4 v[80:83], v8, s[4:7], s31 offen offset:0 sc1
    s_waitcnt lgkmcnt(4)
    v_mfma_f32_32x32x16_bf16 v[48:63], v[24:27], v[84:87], v[48:63]
    ds_read_b64_tr_b16 v[20:21], v7 offset:13312
    ds_read_b64_tr_b16 v[22:23], v7 offset:13824
    s_waitcnt vmcnt(14)
    v_mfma_f32_32x32x16_bf16 v[32:47], a[88:91], v[88:91], v[32:47]
    buffer_load_dwordx4 v[84:87], v8, s[4:7], s31 offen offset:1024 sc1
    v_mfma_f32_32x32x16_bf16 v[48:63], v[172:175], v[88:91], v[48:63]
    s_waitcnt vmcnt(14)
    v_mfma_f32_32x32x16_bf16 v[32:47], a[92:95], v[92:95], v[32:47]
    buffer_load_dwordx4 v[88:91], v8, s[4:7], s31 offen offset:2048 sc1
    s_waitcnt lgkmcnt(4)
    v_mfma_f32_32x32x16_bf16 v[48:63], v[28:31], v[92:95], v[48:63]
    ds_read_b64_tr_b16 v[24:25], v7 offset:14336
    ds_read_b64_tr_b16 v[26:27], v7 offset:14848
    s_waitcnt vmcnt(14)
    v_mfma_f32_32x32x16_bf16 v[32:47], a[96:99], v[96:99], v[32:47]
    buffer_load_dwordx4 v[92:95], v8, s[4:7], s31 offen offset:3072 sc1
    v_mfma_f32_32x32x16_bf16 v[48:63], v[176:179], v[96:99], v[48:63]
    s_waitcnt vmcnt(14)
    v_mfma_f32_32x32x16_bf16 v[32:47], a[100:103], v[100:103], v[32:47]
    s_add_u32 s31, s47, 40960
    buffer_load_dwordx4 v[96:99], v8, s[4:7], s31 offen offset:0 sc1
    s_waitcnt lgkmcnt(4)
    v_mfma_f32_32x32x16_bf16 v[48:63], v[16:19], v[100:103], v[48:63]
    ds_read_b64_tr_b16 v[28:29], v7 offset:15360
    ds_read_b64_tr_b16 v[30:31], v7 offset:15872
    s_waitcnt vmcnt(14)
    v_mfma_f32_32x32x16_bf16 v[32:47], a[104:107], v[104:107], v[32:47]
    buffer_load_dwordx4 v[100:103], v8, s[4:7], s31 offen offset:1024 sc1
    v_mfma_f32_32x32x16_bf16 v[48:63], v[180:183], v[104:107], v[48:63]
    s_waitcnt vmcnt(14)
    v_mfma_f32_32x32x16_bf16 v[32:47], a[108:111], v[108:111], v[32:47]
    buffer_load_dwordx4 v[104:107], v8, s[4:7], s31 offen offset:2048 sc1
    s_waitcnt lgkmcnt(4)
    v_mfma_f32_32x32x16_bf16 v[48:63], v[20:23], v[108:111], v[48:63]
    ds_read_b64_tr_b16 v[16:17], v7 offset:16384
    ds_read_b64_tr_b16 v[18:19], v7 offset:16896
    s_waitcnt vmcnt(14)
    v_mfma_f32_32x32x16_bf16 v[32:47], a[112:115], v[112:115], v[32:47]
    buffer_load_dwordx4 v[108:111], v8, s[4:7], s31 offen offset:3072 sc1
    v_mfma_f32_32x32x16_bf16 v[48:63], v[184:187], v[112:115], v[48:63]
    s_waitcnt vmcnt(14)
    v_mfma_f32_32x32x16_bf16 v[32:47], a[116:119], v[116:119], v[32:47]
    s_add_u32 s31, s47, 45056
    buffer_load_dwordx4 v[112:115], v8, s[4:7], s31 offen offset:0 sc1
    s_waitcnt lgkmcnt(4)
    v_mfma_f32_32x32x16_bf16 v[48:63], v[24:27], v[116:119], v[48:63]
    ds_read_b64_tr_b16 v[20:21], v7 offset:17408
    ds_read_b64_tr_b16 v[22:23], v7 offset:17920
    s_waitcnt vmcnt(14)
    v_mfma_f32_32x32x16_bf16 v[32:47], a[120:123], v[120:123], v[32:47]
    buffer_load_dwordx4 v[116:119], v8, s[4:7], s31 offen offset:1024 sc1
    v_mfma_f32_32x32x16_bf16 v[48:63], v[188:191], v[120:123], v[48:63]
    s_waitcnt vmcnt(14)
    v_mfma_f32_32x32x16_bf16 v[32:47], a[124:127], v[124:127], v[32:47]
    buffer_load_dwordx4 v[120:123], v8, s[4:7], s31 offen offset:2048 sc1
    s_waitcnt lgkmcnt(4)
    v_mfma_f32_32x32x16_bf16 v[48:63], v[28:31], v[124:127], v[48:63]
    ds_read_b64_tr_b16 v[24:25], v7 offset:18432
    ds_read_b64_tr_b16 v[26:27], v7 offset:18944
    s_waitcnt vmcnt(14)
    v_mfma_f32_32x32x16_bf16 v[32:47], a[128:131], v[64:67], v[32:47]
    buffer_load_dwordx4 v[124:127], v8, s[4:7], s31 offen offset:3072 sc1
    v_mfma_f32_32x32x16_bf16 v[48:63], v[192:195], v[64:67], v[48:63]
    s_waitcnt vmcnt(14)
    v_mfma_f32_32x32x16_bf16 v[32:47], a[132:135], v[68:71], v[32:47]
    s_add_u32 s31, s47, 49152
    buffer_load_dwordx4 v[64:67], v8, s[4:7], s31 offen offset:0 sc1
    s_waitcnt lgkmcnt(4)
    v_mfma_f32_32x32x16_bf16 v[48:63], v[16:19], v[68:71], v[48:63]
    ds_read_b64_tr_b16 v[28:29], v7 offset:19456
    ds_read_b64_tr_b16 v[30:31], v7 offset:19968
    s_waitcnt vmcnt(14)
    v_mfma_f32_32x32x16_bf16 v[32:47], a[136:139], v[72:75], v[32:47]
    buffer_load_dwordx4 v[68:71], v8, s[4:7], s31 offen offset:1024 sc1
    v_mfma_f32_32x32x16_bf16 v[48:63], v[196:199], v[72:75], v[48:63]
    s_waitcnt vmcnt(14)
    v_mfma_f32_32x32x16_bf16 v[32:47], a[140:143], v[76:79], v[32:47]
    buffer_load_dwordx4 v[72:75], v8, s[4:7], s31 offen offset:2048 sc1
    s_waitcnt lgkmcnt(4)
    v_mfma_f32_32x32x16_bf16 v[48:63], v[20:23], v[76:79], v[48:63]
    ds_read_b64_tr_b16 v[16:17], v7 offset:20480
    ds_read_b64_tr_b16 v[18:19], v7 offset:20992
    s_waitcnt vmcnt(14)
    v_mfma_f32_32x32x16_bf16 v[32:47], a[144:147], v[80:83], v[32:47]
    buffer_load_dwordx4 v[76:79], v8, s[4:7], s31 offen offset:3072 sc1
    v_mfma_f32_32x32x16_bf16 v[48:63], v[200:203], v[80:83], v[48:63]
    s_waitcnt vmcnt(14)
    v_mfma_f32_32x32x16_bf16 v[32:47], a[148:151], v[84:87], v[32:47]
    s_add_u32 s31, s47, 53248
    buffer_load_dwordx4 v[80:83], v8, s[4:7], s31 offen offset:0 sc1
    s_waitcnt lgkmcnt(4)
    v_mfma_f32_32x32x16_bf16 v[48:63], v[24:27], v[84:87], v[48:63]
    ds_read_b64_tr_b16 v[20:21], v7 offset:21504
    ds_read_b64_tr_b16 v[22:23], v7 offset:22016
    s_waitcnt vmcnt(14)
    v_mfma_f32_32x32x16_bf16 v[32:47], a[152:155], v[88:91], v[32:47]
    buffer_load_dwordx4 v[84:87], v8, s[4:7], s31 offen offset:1024 sc1
    v_mfma_f32_32x32x16_bf16 v[48:63], v[204:207], v[88:91], v[48:63]
    s_waitcnt vmcnt(14)
    v_mfma_f32_32x32x16_bf16 v[32:47], a[156:159], v[92:95], v[32:47]
    buffer_load_dwordx4 v[88:91], v8, s[4:7], s31 offen offset:2048 sc1
    s_waitcnt lgkmcnt(4)
    v_mfma_f32_32x32x16_bf16 v[48:63], v[28:31], v[92:95], v[48:63]
    ds_read_b64_tr_b16 v[24:25], v7 offset:22528
    ds_read_b64_tr_b16 v[26:27], v7 offset:23040
    s_waitcnt vmcnt(14)
    v_mfma_f32_32x32x16_bf16 v[32:47], a[160:163], v[96:99], v[32:47]
    buffer_load_dwordx4 v[92:95], v8, s[4:7], s31 offen offset:3072 sc1
    v_mfma_f32_32x32x16_bf16 v[48:63], v[208:211], v[96:99], v[48:63]
    s_waitcnt vmcnt(14)
    v_mfma_f32_32x32x16_bf16 v[32:47], a[164:167], v[100:103], v[32:47]
    s_add_u32 s31, s47, 57344
    buffer_load_dwordx4 v[96:99], v8, s[4:7], s31 offen offset:0 sc1
    s_waitcnt lgkmcnt(4)
    v_mfma_f32_32x32x16_bf16 v[48:63], v[16:19], v[100:103], v[48:63]
    ds_read_b64_tr_b16 v[28:29], v7 offset:23552
    ds_read_b64_tr_b16 v[30:31], v7 offset:24064
    s_waitcnt vmcnt(14)
    v_mfma_f32_32x32x16_bf16 v[32:47], a[168:171], v[104:107], v[32:47]
    buffer_load_dwordx4 v[100:103], v8, s[4:7], s31 offen offset:1024 sc1
    v_mfma_f32_32x32x16_bf16 v[48:63], v[212:215], v[104:107], v[48:63]
    s_waitcnt vmcnt(14)
    v_mfma_f32_32x32x16_bf16 v[32:47], a[172:175], v[108:111], v[32:47]
    buffer_load_dwordx4 v[104:107], v8, s[4:7], s31 offen offset:2048 sc1
    s_waitcnt lgkmcnt(4)
    v_mfma_f32_32x32x16_bf16 v[48:63], v[20:23], v[108:111], v[48:63]
    ds_read_b64_tr_b16 v[16:17], v7 offset:24576
    ds_read_b64_tr_b16 v[18:19], v7 offset:25088
    s_waitcnt vmcnt(14)
    v_mfma_f32_32x32x16_bf16 v[32:47], a[176:179], v[112:115], v[32:47]
    buffer_load_dwordx4 v[108:111], v8, s[4:7], s31 offen offset:3072 sc1
    v_mfma_f32_32x32x16_bf16 v[48:63], v[216:219], v[112:115], v[48:63]
    s_waitcnt vmcnt(14)
    v_mfma_f32_32x32x16_bf16 v[32:47], a[180:183], v[116:119], v[32:47]
    s_add_u32 s31, s47, 61440
    buffer_load_dwordx4 v[112:115], v8, s[4:7], s31 offen offset:0 sc1
    s_waitcnt lgkmcnt(4)
    v_mfma_f32_32x32x16_bf16 v[48:63], v[24:27], v[116:119], v[48:63]
    ds_read_b64_tr_b16 v[20:21], v7 offset:25600
    ds_read_b64_tr_b16 v[22:23], v7 offset:26112
    s_waitcnt vmcnt(14)
    v_mfma_f32_32x32x16_bf16 v[32:47], a[184:187], v[120:123], v[32:47]
    buffer_load_dwordx4 v[116:119], v8, s[4:7], s31 offen offset:1024 sc1
    v_mfma_f32_32x32x16_bf16 v[48:63], v[220:223], v[120:123], v[48:63]
    s_waitcnt vmcnt(14)
    v_mfma_f32_32x32x16_bf16 v[32:47], a[188:191], v[124:127], v[32:47]
    buffer_load_dwordx4 v[120:123], v8, s[4:7], s31 offen offset:2048 sc1
    s_waitcnt lgkmcnt(4)
    v_mfma_f32_32x32x16_bf16 v[48:63], v[28:31], v[124:127], v[48:63]
    ds_read_b64_tr_b16 v[24:25], v7 offset:26624
    ds_read_b64_tr_b16 v[26:27], v7 offset:27136
    s_waitcnt vmcnt(14)
    v_mfma_f32_32x32x16_bf16 v[32:47], a[192:195], v[64:67], v[32:47]
    buffer_load_dwordx4 v[124:127], v8, s[4:7], s31 offen offset:3072 sc1
    v_mfma_f32_32x32x16_bf16 v[48:63], v[224:227], v[64:67], v[48:63]
    s_waitcnt vmcnt(14)
    v_mfma_f32_32x32x16_bf16 v[32:47], a[196:199], v[68:71], v[32:47]
    s_waitcnt lgkmcnt(4)
    v_mfma_f32_32x32x16_bf16 v[48:63], v[16:19], v[68:71], v[48:63]
    ds_read_b64_tr_b16 v[28:29], v7 offset:27648
    ds_read_b64_tr_b16 v[30:31], v7 offset:28160
    s_waitcnt vmcnt(13)
    v_mfma_f32_32x32x16_bf16 v[32:47], a[200:203], v[72:75], v[32:47]
    v_mfma_f32_32x32x16_bf16 v[48:63], v[228:231], v[72:75], v[48:63]
    s_waitcnt vmcnt(12)
    v_mfma_f32_32x32x16_bf16 v[32:47], a[204:207], v[76:79], v[32:47]
    s_waitcnt lgkmcnt(4)
    v_mfma_f32_32x32x16_bf16 v[48:63], v[20:23], v[76:79], v[48:63]
    ds_read_b64_tr_b16 v[16:17], v7 offset:28672
    ds_read_b64_tr_b16 v[18:19], v7 offset:29184
    s_waitcnt vmcnt(11)
    v_mfma_f32_32x32x16_bf16 v[32:47], a[208:211], v[80:83], v[32:47]
    v_mfma_f32_32x32x16_bf16 v[48:63], v[232:235], v[80:83], v[48:63]
    s_waitcnt vmcnt(10)
    v_mfma_f32_32x32x16_bf16 v[32:47], a[212:215], v[84:87], v[32:47]
    s_waitcnt lgkmcnt(4)
    v_mfma_f32_32x32x16_bf16 v[48:63], v[24:27], v[84:87], v[48:63]
    ds_read_b64_tr_b16 v[20:21], v7 offset:29696
    ds_read_b64_tr_b16 v[22:23], v7 offset:30208
    s_waitcnt vmcnt(9)
    v_mfma_f32_32x32x16_bf16 v[32:47], a[216:219], v[88:91], v[32:47]
    v_mfma_f32_32x32x16_bf16 v[48:63], v[236:239], v[88:91], v[48:63]
    s_waitcnt vmcnt(8)
    v_mfma_f32_32x32x16_bf16 v[32:47], a[220:223], v[92:95], v[32:47]
    s_waitcnt lgkmcnt(4)
    v_mfma_f32_32x32x16_bf16 v[48:63], v[28:31], v[92:95], v[48:63]
    ds_read_b64_tr_b16 v[24:25], v7 offset:30720
    ds_read_b64_tr_b16 v[26:27], v7 offset:31232
    s_waitcnt vmcnt(7)
    v_mfma_f32_32x32x16_bf16 v[32:47], a[224:227], v[96:99], v[32:47]
    v_mfma_f32_32x32x16_bf16 v[48:63], v[240:243], v[96:99], v[48:63]
    s_waitcnt vmcnt(6)
    v_mfma_f32_32x32x16_bf16 v[32:47], a[228:231], v[100:103], v[32:47]
    s_waitcnt lgkmcnt(4)
    v_mfma_f32_32x32x16_bf16 v[48:63], v[16:19], v[100:103], v[48:63]
    ds_read_b64_tr_b16 v[28:29], v7 offset:31744
    ds_read_b64_tr_b16 v[30:31], v7 offset:32256
    s_waitcnt vmcnt(5)
    v_mfma_f32_32x32x16_bf16 v[32:47], a[232:235], v[104:107], v[32:47]
    v_mfma_f32_32x32x16_bf16 v[48:63], v[244:247], v[104:107], v[48:63]
    s_waitcnt vmcnt(4)
    v_mfma_f32_32x32x16_bf16 v[32:47], a[236:239], v[108:111], v[32:47]
    s_waitcnt lgkmcnt(4)
    v_mfma_f32_32x32x16_bf16 v[48:63], v[20:23], v[108:111], v[48:63]
    s_waitcnt vmcnt(3)
    v_mfma_f32_32x32x16_bf16 v[32:47], a[240:243], v[112:115], v[32:47]
    v_mfma_f32_32x32x16_bf16 v[48:63], v[248:251], v[112:115], v[48:63]
    s_waitcnt vmcnt(2)
    v_mfma_f32_32x32x16_bf16 v[32:47], a[244:247], v[116:119], v[32:47]
    s_waitcnt lgkmcnt(2)
    v_mfma_f32_32x32x16_bf16 v[48:63], v[24:27], v[116:119], v[48:63]
    s_waitcnt vmcnt(1)
    v_mfma_f32_32x32x16_bf16 v[32:47], a[248:251], v[120:123], v[32:47]
    v_mfma_f32_32x32x16_bf16 v[48:63], v[252:255], v[120:123], v[48:63]
    s_waitcnt vmcnt(0)
    v_mfma_f32_32x32x16_bf16 v[32:47], a[252:255], v[124:127], v[32:47]
    s_waitcnt lgkmcnt(0)
    v_mfma_f32_32x32x16_bf16 v[48:63], v[28:31], v[124:127], v[48:63]
    s_barrier
    s_nop 8
    ds_write_b128 v9, v[32:35] offset:0
    ds_write_b128 v9, v[36:39] offset:1024
    ds_write_b128 v9, v[40:43] offset:2048
    ds_write_b128 v9, v[44:47] offset:3072
    ds_write_b128 v9, v[48:51] offset:4096
    ds_write_b128 v9, v[52:55] offset:5120
    ds_write_b128 v9, v[56:59] offset:6144
    ds_write_b128 v9, v[60:63] offset:7168
    s_waitcnt lgkmcnt(0)
    s_barrier
    ds_read_b128 v[64:67], v10 offset:0
    ds_read_b128 v[68:71], v10 offset:8192
    ds_read_b128 v[72:75], v10 offset:16384
    ds_read_b128 v[76:79], v10 offset:24576
    ds_read_b128 v[80:83], v10 offset:4096
    ds_read_b128 v[84:87], v10 offset:12288
    ds_read_b128 v[88:91], v10 offset:20480
    ds_read_b128 v[92:95], v10 offset:28672
    s_waitcnt lgkmcnt(4)
    v_pk_add_f32 v[64:65], v[64:65], v[68:69]
    v_pk_add_f32 v[66:67], v[66:67], v[70:71]
    v_pk_add_f32 v[72:73], v[72:73], v[76:77]
    v_pk_add_f32 v[74:75], v[74:75], v[78:79]
    v_pk_add_f32 v[64:65], v[64:65], v[72:73]
    v_pk_add_f32 v[66:67], v[66:67], v[74:75]
    v_cvt_pk_bf16_f32 v16, v64, v65
    v_cvt_pk_bf16_f32 v17, v66, v67
    buffer_store_dwordx2 v[16:17], v11, s[20:23], s49 offen offset:0
    s_waitcnt lgkmcnt(0)
    v_pk_add_f32 v[80:81], v[80:81], v[84:85]
    v_pk_add_f32 v[82:83], v[82:83], v[86:87]
    v_pk_add_f32 v[88:89], v[88:89], v[92:93]
    v_pk_add_f32 v[90:91], v[90:91], v[94:95]
    v_pk_add_f32 v[80:81], v[80:81], v[88:89]
    v_pk_add_f32 v[82:83], v[82:83], v[90:91]
    v_cvt_pk_bf16_f32 v18, v80, v81
    v_cvt_pk_bf16_f32 v19, v82, v83
    buffer_store_dwordx2 v[18:19], v11, s[20:23], s49 offen offset:64
    s_add_u32 s30, s30, 6
    s_cmp_lt_u32 s30, 64
    s_cbranch_scc1 o6_loop_70
    s_branch L_dump
L_ob:
    s_load_dwordx4 s[72:75], s[0:1], 72
    s_add_u32 s76, s90, 83886080
    s_addc_u32 s77, s91, 0
    s_sub_u32 s32, s28, 96
    s_lshr_b32 s32, s32, 3
    s_mul_i32 s30, s32, 22
    s_add_u32 s51, s30, 22
    s_min_u32 s51, s51, 64
    s_sub_u32 s52, s51, 1
    s_lshl_b32 s52, s52, 16
    s_waitcnt lgkmcnt(0)
    s_mov_b32 s8, s72
    s_and_b32 s9, s73, 0xffff
    s_mov_b32 s10, 2097152
    s_mov_b32 s11, 0x00020000
    s_mov_b32 s20, s74
    s_and_b32 s21, s75, 0xffff
    s_mov_b32 s22, 8388608
    s_mov_b32 s23, 0x00020000
    s_mov_b32 s12, s76
    s_and_b32 s13, s77, 0xffff
    s_mov_b32 s14, 4194304
    s_mov_b32 s15, 0x00020000
    s_and_b32 s31, s28, 7
    s_lshl_b32 s31, s31, 8
    s_lshl_b32 s33, s29, 6
    s_add_u32 s31, s31, s33
    v_lshrrev_b32 v6, 2, v1
    v_lshlrev_b32 v6, 11, v6
    v_and_b32 v4, 3, v1
    v_lshl_add_u32 v6, v4, 4, v6
    v_add_u32 v6, s31, v6
    s_mov_b32 s39, 32768
    s_lshl_b32 s36, s30, 17
    s_and_b32 s33, s28, 7
    s_lshl_b32 s33, s33, 8
    s_add_u32 s36, s36, s33
    s_add_u32 s36, s36, 2048
    s_mov_b32 s37, 131072
    s_lshl_b32 s31, s29, 15
    v_lshrrev_b32 v7, 4, v1
    v_lshlrev_b32 v7, 9, v7
    v_bfe_u32 v4, v1, 2, 2
    v_lshl_add_u32 v7, v4, 6, v7
    v_and_b32 v4, 3, v1
    v_lshl_add_u32 v7, v4, 4, v7
    v_add_u32 v7, s31, v7
    s_lshl_b32 s32, s29, 15
    s_add_u32 m0, s32, 0
    s_mov_b32 s38, 0
    buffer_load_dwordx4 v6, s[8:11], s38 offen lds
    s_add_u32 m0, s32, 1024
    s_add_u32 s38, s38, s39
    buffer_load_dwordx4 v6, s[8:11], s38 offen lds
    s_add_u32 m0, s32, 2048
    s_add_u32 s38, s38, s39
    buffer_load_dwordx4 v6, s[8:11], s38 offen lds
    s_add_u32 m0, s32, 3072
    s_add_u32 s38, s38, s39
    buffer_load_dwordx4 v6, s[8:11], s38 offen lds
    s_add_u32 m0, s32, 4096
    s_add_u32 s38, s38, s39
    buffer_load_dwordx4 v6, s[8:11], s38 offen lds
    s_add_u32 m0, s32, 5120
    s_add_u32 s38, s38, s39
    buffer_load_dwordx4 v6, s[8:11], s38 offen lds
    s_add_u32 m0, s32, 6144
    s_add_u32 s38, s38, s39
    buffer_load_dwordx4 v6, s[8:11], s38 offen lds
    s_add_u32 m0, s32, 7168
    s_add_u32 s38, s38, s39
    buffer_load_dwordx4 v6, s[8:11], s38 offen lds
    s_add_u32 m0, s32, 8192
    s_add_u32 s38, s38, s39
    buffer_load_dwordx4 v6, s[8:11], s38 offen lds
    s_add_u32 m0, s32, 9216
    s_add_u32 s38, s38, s39
    buffer_load_dwordx4 v6, s[8:11], s38 offen lds
    s_add_u32 m0, s32, 10240
    s_add_u32 s38, s38, s39
    buffer_load_dwordx4 v6, s[8:11], s38 offen lds
    s_add_u32 m0, s32, 11264
    s_add_u32 s38, s38, s39
    buffer_load_dwordx4 v6, s[8:11], s38 offen lds
    s_add_u32 m0, s32, 12288
    s_add_u32 s38, s38, s39
    buffer_load_dwordx4 v6, s[8:11], s38 offen lds
    s_add_u32 m0, s32, 13312
    s_add_u32 s38, s38, s39
    buffer_load_dwordx4 v6, s[8:11], s38 offen lds
    s_add_u32 m0, s32, 14336
    s_add_u32 s38, s38, s39
    buffer_load_dwordx4 v6, s[8:11], s38 offen lds
    s_add_u32 m0, s32, 15360
    s_add_u32 s38, s38, s39
    buffer_load_dwordx4 v6, s[8:11], s38 offen lds
    s_add_u32 m0, s32, 16384
    s_add_u32 s38, s38, s39
    buffer_load_dwordx4 v6, s[8:11], s38 offen lds
    s_add_u32 m0, s32, 17408
    s_add_u32 s38, s38, s39
    buffer_load_dwordx4 v6, s[8:11], s38 offen lds
    s_add_u32 m0, s32, 18432
    s_add_u32 s38, s38, s39
    buffer_load_dwordx4 v6, s[8:11], s38 offen lds
    s_add_u32 m0, s32, 19456
    s_add_u32 s38, s38, s39
    buffer_load_dwordx4 v6, s[8:11], s38 offen lds
    s_add_u32 m0, s32, 20480
    s_add_u32 s38, s38, s39
    buffer_load_dwordx4 v6, s[8:11], s38 offen lds
    s_add_u32 m0, s32, 21504
    s_add_u32 s38, s38, s39
    buffer_load_dwordx4 v6, s[8:11], s38 offen lds
    s_add_u32 m0, s32, 22528
    s_add_u32 s38, s38, s39
    buffer_load_dwordx4 v6, s[8:11], s38 offen lds
    s_add_u32 m0, s32, 23552
    s_add_u32 s38, s38, s39
    buffer_load_dwordx4 v6, s[8:11], s38 offen lds
    s_add_u32 m0, s32, 24576
    s_add_u32 s38, s38, s39
    buffer_load_dwordx4 v6, s[8:11], s38 offen lds
    s_add_u32 m0, s32, 25600
    s_add_u32 s38, s38, s39
    buffer_load_dwordx4 v6, s[8:11], s38 offen lds
    s_add_u32 m0, s32, 26624
    s_add_u32 s38, s38, s39
    buffer_load_dwordx4 v6, s[8:11], s38 offen lds
    s_add_u32 m0, s32, 27648
    s_add_u32 s38, s38, s39
    buffer_load_dwordx4 v6, s[8:11], s38 offen lds
    s_add_u32 m0, s32, 28672
    s_add_u32 s38, s38, s39
    buffer_load_dwordx4 v6, s[8:11], s38 offen lds
    s_add_u32 m0, s32, 29696
    s_add_u32 s38, s38, s39
    buffer_load_dwordx4 v6, s[8:11], s38 offen lds
    s_add_u32 m0, s32, 30720
    s_add_u32 s38, s38, s39
    buffer_load_dwordx4 v6, s[8:11], s38 offen lds
    s_add_u32 m0, s32, 31744
    s_add_u32 s38, s38, s39
    buffer_load_dwordx4 v6, s[8:11], s38 offen lds
    s_waitcnt vmcnt(30)
    ds_read_b64_tr_b16 a[0:1], v7 offset:0
    ds_read_b64_tr_b16 a[2:3], v7 offset:256
    ds_read_b64_tr_b16 a[4:5], v7 offset:8
    ds_read_b64_tr_b16 a[6:7], v7 offset:264
    s_waitcnt vmcnt(28)
    ds_read_b64_tr_b16 a[8:9], v7 offset:2048
    ds_read_b64_tr_b16 a[10:11], v7 offset:2304
    ds_read_b64_tr_b16 a[12:13], v7 offset:2056
    ds_read_b64_tr_b16 a[14:15], v7 offset:2312
    s_waitcnt lgkmcnt(4)
    s_add_u32 m0, s32, 0
    s_add_u32 s38, s38, s39
    buffer_load_dwordx4 v6, s[8:11], s38 offen lds
    s_add_u32 m0, s32, 1024
    s_add_u32 s38, s38, s39
    buffer_load_dwordx4 v6, s[8:11], s38 offen lds
    s_waitcnt vmcnt(28)
    ds_read_b64_tr_b16 a[16:17], v7 offset:4096
    ds_read_b64_tr_b16 a[18:19], v7 offset:4352
    ds_read_b64_tr_b16 a[20:21], v7 offset:4104
    ds_read_b64_tr_b16 a[22:23], v7 offset:4360
    s_waitcnt lgkmcnt(4)
    s_add_u32 m0, s32, 2048
    s_add_u32 s38, s38, s39
    buffer_load_dwordx4 v6, s[8:11], s38 offen lds
    s_add_u32 m0, s32, 3072
    s_add_u32 s38, s38, s39
    buffer_load_dwordx4 v6, s[8:11], s38 offen lds
    s_waitcnt vmcnt(28)
    ds_read_b64_tr_b16 a[24:25], v7 offset:6144
    ds_read_b64_tr_b16 a[26:27], v7 offset:6400
    ds_read_b64_tr_b16 a[28:29], v7 offset:6152
    ds_read_b64_tr_b16 a[30:31], v7 offset:6408
    s_waitcnt lgkmcnt(4)
    s_add_u32 m0, s32, 4096
    s_add_u32 s38, s38, s39
    buffer_load_dwordx4 v6, s[8:11], s38 offen lds
    s_add_u32 m0, s32, 5120
    s_add_u32 s38, s38, s39
    buffer_load_dwordx4 v6, s[8:11], s38 offen lds
    s_waitcnt vmcnt(28)
    ds_read_b64_tr_b16 a[32:33], v7 offset:8192
    ds_read_b64_tr_b16 a[34:35], v7 offset:8448
    ds_read_b64_tr_b16 a[36:37], v7 offset:8200
    ds_read_b64_tr_b16 a[38:39], v7 offset:8456
    s_waitcnt lgkmcnt(4)
    s_add_u32 m0, s32, 6144
    s_add_u32 s38, s38, s39
    buffer_load_dwordx4 v6, s[8:11], s38 offen lds
    s_add_u32 m0, s32, 7168
    s_add_u32 s38, s38, s39
    buffer_load_dwordx4 v6, s[8:11], s38 offen lds
    s_waitcnt vmcnt(28)
    ds_read_b64_tr_b16 a[40:41], v7 offset:10240
    ds_read_b64_tr_b16 a[42:43], v7 offset:10496
    ds_read_b64_tr_b16 a[44:45], v7 offset:10248
    ds_read_b64_tr_b16 a[46:47], v7 offset:10504
    s_waitcnt lgkmcnt(4)
    s_add_u32 m0, s32, 8192
    s_add_u32 s38, s38, s39
    buffer_load_dwordx4 v6, s[8:11], s38 offen lds
    s_add_u32 m0, s32, 9216
    s_add_u32 s38, s38, s39
    buffer_load_dwordx4 v6, s[8:11], s38 offen lds
    s_waitcnt vmcnt(28)
    ds_read_b64_tr_b16 a[48:49], v7 offset:12288
    ds_read_b64_tr_b16 a[50:51], v7 offset:12544
    ds_read_b64_tr_b16 a[52:53], v7 offset:12296
    ds_read_b64_tr_b16 a[54:55], v7 offset:12552
    s_waitcnt lgkmcnt(4)
    s_add_u32 m0, s32, 10240
    s_add_u32 s38, s38, s39
    buffer_load_dwordx4 v6, s[8:11], s38 offen lds
    s_add_u32 m0, s32, 11264
    s_add_u32 s38, s38, s39
    buffer_load_dwordx4 v6, s[8:11], s38 offen lds
    s_waitcnt vmcnt(28)
    ds_read_b64_tr_b16 a[56:57], v7 offset:14336
    ds_read_b64_tr_b16 a[58:59], v7 offset:14592
    ds_read_b64_tr_b16 a[60:61], v7 offset:14344
    ds_read_b64_tr_b16 a[62:63], v7 offset:14600
    s_waitcnt lgkmcnt(4)
    s_add_u32 m0, s32, 12288
    s_add_u32 s38, s38, s39
    buffer_load_dwordx4 v6, s[8:11], s38 offen lds
    s_add_u32 m0, s32, 13312
    s_add_u32 s38, s38, s39
    buffer_load_dwordx4 v6, s[8:11], s38 offen lds
    s_waitcnt vmcnt(28)
    ds_read_b64_tr_b16 a[64:65], v7 offset:16384
    ds_read_b64_tr_b16 a[66:67], v7 offset:16640
    ds_read_b64_tr_b16 a[68:69], v7 offset:16392
    ds_read_b64_tr_b16 a[70:71], v7 offset:16648
    s_waitcnt lgkmcnt(4)
    s_add_u32 m0, s32, 14336
    s_add_u32 s38, s38, s39
    buffer_load_dwordx4 v6, s[8:11], s38 offen lds
    s_add_u32 m0, s32, 15360
    s_add_u32 s38, s38, s39
    buffer_load_dwordx4 v6, s[8:11], s38 offen lds
    s_waitcnt vmcnt(28)
    ds_read_b64_tr_b16 a[72:73], v7 offset:18432
    ds_read_b64_tr_b16 a[74:75], v7 offset:18688
    ds_read_b64_tr_b16 a[76:77], v7 offset:18440
    ds_read_b64_tr_b16 a[78:79], v7 offset:18696
    s_waitcnt lgkmcnt(4)
    s_add_u32 m0, s32, 16384
    s_add_u32 s38, s38, s39
    buffer_load_dwordx4 v6, s[8:11], s38 offen lds
    s_add_u32 m0, s32, 17408
    s_add_u32 s38, s38, s39
    buffer_load_dwordx4 v6, s[8:11], s38 offen lds
    s_waitcnt vmcnt(28)
    ds_read_b64_tr_b16 a[80:81], v7 offset:20480
    ds_read_b64_tr_b16 a[82:83], v7 offset:20736
    ds_read_b64_tr_b16 a[84:85], v7 offset:20488
    ds_read_b64_tr_b16 a[86:87], v7 offset:20744
    s_waitcnt lgkmcnt(4)
    s_add_u32 m0, s32, 18432
    s_add_u32 s38, s38, s39
    buffer_load_dwordx4 v6, s[8:11], s38 offen lds
    s_add_u32 m0, s32, 19456
    s_add_u32 s38, s38, s39
    buffer_load_dwordx4 v6, s[8:11], s38 offen lds
    s_waitcnt vmcnt(28)
    ds_read_b64_tr_b16 a[88:89], v7 offset:22528
    ds_read_b64_tr_b16 a[90:91], v7 offset:22784
    ds_read_b64_tr_b16 a[92:93], v7 offset:22536
    ds_read_b64_tr_b16 a[94:95], v7 offset:22792
    s_waitcnt lgkmcnt(4)
    s_add_u32 m0, s32, 20480
    s_add_u32 s38, s38, s39
    buffer_load_dwordx4 v6, s[8:11], s38 offen lds
    s_add_u32 m0, s32, 21504
    s_add_u32 s38, s38, s39
    buffer_load_dwordx4 v6, s[8:11], s38 offen lds
    s_waitcnt vmcnt(28)
    ds_read_b64_tr_b16 a[96:97], v7 offset:24576
    ds_read_b64_tr_b16 a[98:99], v7 offset:24832
    ds_read_b64_tr_b16 a[100:101], v7 offset:24584
    ds_read_b64_tr_b16 a[102:103], v7 offset:24840
    s_waitcnt lgkmcnt(4)
    s_add_u32 m0, s32, 22528
    s_add_u32 s38, s38, s39
    buffer_load_dwordx4 v6, s[8:11], s38 offen lds
    s_add_u32 m0, s32, 23552
    s_add_u32 s38, s38, s39
    buffer_load_dwordx4 v6, s[8:11], s38 offen lds
    s_waitcnt vmcnt(28)
    ds_read_b64_tr_b16 a[104:105], v7 offset:26624
    ds_read_b64_tr_b16 a[106:107], v7 offset:26880
    ds_read_b64_tr_b16 a[108:109], v7 offset:26632
    ds_read_b64_tr_b16 a[110:111], v7 offset:26888
    s_waitcnt lgkmcnt(4)
    s_add_u32 m0, s32, 24576
    s_add_u32 s38, s38, s39
    buffer_load_dwordx4 v6, s[8:11], s38 offen lds
    s_add_u32 m0, s32, 25600
    s_add_u32 s38, s38, s39
    buffer_load_dwordx4 v6, s[8:11], s38 offen lds
    s_waitcnt vmcnt(28)
    ds_read_b64_tr_b16 a[112:113], v7 offset:28672
    ds_read_b64_tr_b16 a[114:115], v7 offset:28928
    ds_read_b64_tr_b16 a[116:117], v7 offset:28680
    ds_read_b64_tr_b16 a[118:119], v7 offset:28936
    s_waitcnt lgkmcnt(4)
    s_add_u32 m0, s32, 26624
    s_add_u32 s38, s38, s39
    buffer_load_dwordx4 v6, s[8:11], s38 offen lds
    s_add_u32 m0, s32, 27648
    s_add_u32 s38, s38, s39
    buffer_load_dwordx4 v6, s[8:11], s38 offen lds
    s_waitcnt vmcnt(28)
    ds_read_b64_tr_b16 a[120:121], v7 offset:30720
    ds_read_b64_tr_b16 a[122:123], v7 offset:30976
    ds_read_b64_tr_b16 a[124:125], v7 offset:30728
    ds_read_b64_tr_b16 a[126:127], v7 offset:30984
    s_waitcnt lgkmcnt(4)
    s_add_u32 m0, s32, 28672
    s_add_u32 s38, s38, s39
    buffer_load_dwordx4 v6, s[8:11], s38 offen lds
    s_add_u32 m0, s32, 29696
    s_add_u32 s38, s38, s39
    buffer_load_dwordx4 v6, s[8:11], s38 offen lds
    s_waitcnt vmcnt(28)
    ds_read_b64_tr_b16 a[128:129], v7 offset:0
    ds_read_b64_tr_b16 a[130:131], v7 offset:256
    ds_read_b64_tr_b16 a[132:133], v7 offset:8
    ds_read_b64_tr_b16 a[134:135], v7 offset:264
    s_waitcnt lgkmcnt(4)
    s_add_u32 m0, s32, 30720
    s_add_u32 s38, s38, s39
    buffer_load_dwordx4 v6, s[8:11], s38 offen lds
    s_add_u32 m0, s32, 31744
    s_add_u32 s38, s38, s39
    buffer_load_dwordx4 v6, s[8:11], s38 offen lds
    s_waitcnt vmcnt(28)
    ds_read_b64_tr_b16 a[136:137], v7 offset:2048
    ds_read_b64_tr_b16 a[138:139], v7 offset:2304
    ds_read_b64_tr_b16 a[140:141], v7 offset:2056
    ds_read_b64_tr_b16 a[142:143], v7 offset:2312
    s_waitcnt vmcnt(26)
    ds_read_b64_tr_b16 a[144:145], v7 offset:4096
    ds_read_b64_tr_b16 a[146:147], v7 offset:4352
    ds_read_b64_tr_b16 a[148:149], v7 offset:4104
    ds_read_b64_tr_b16 a[150:151], v7 offset:4360
    s_waitcnt vmcnt(24)
    ds_read_b64_tr_b16 a[152:153], v7 offset:6144
    ds_read_b64_tr_b16 a[154:155], v7 offset:6400
    ds_read_b64_tr_b16 a[156:157], v7 offset:6152
    ds_read_b64_tr_b16 a[158:159], v7 offset:6408
    s_waitcnt vmcnt(22)
    ds_read_b64_tr_b16 a[160:161], v7 offset:8192
    ds_read_b64_tr_b16 a[162:163], v7 offset:8448
    ds_read_b64_tr_b16 a[164:165], v7 offset:8200
    ds_read_b64_tr_b16 a[166:167], v7 offset:8456
    s_waitcnt vmcnt(20)
    ds_read_b64_tr_b16 a[168:169], v7 offset:10240
    ds_read_b64_tr_b16 a[170:171], v7 offset:10496
    ds_read_b64_tr_b16 a[172:173], v7 offset:10248
    ds_read_b64_tr_b16 a[174:175], v7 offset:10504
    s_waitcnt vmcnt(18)
    ds_read_b64_tr_b16 a[176:177], v7 offset:12288
    ds_read_b64_tr_b16 a[178:179], v7 offset:12544
    ds_read_b64_tr_b16 a[180:181], v7 offset:12296
    ds_read_b64_tr_b16 a[182:183], v7 offset:12552
    s_waitcnt vmcnt(16)
    ds_read_b64_tr_b16 a[184:185], v7 offset:14336
    ds_read_b64_tr_b16 a[186:187], v7 offset:14592
    ds_read_b64_tr_b16 a[188:189], v7 offset:14344
    ds_read_b64_tr_b16 a[190:191], v7 offset:14600
    s_waitcnt vmcnt(14)
    ds_read_b64_tr_b16 a[192:193], v7 offset:16384
    ds_read_b64_tr_b16 a[194:195], v7 offset:16640
    ds_read_b64_tr_b16 a[196:197], v7 offset:16392
    ds_read_b64_tr_b16 a[198:199], v7 offset:16648
    s_waitcnt vmcnt(12)
    ds_read_b64_tr_b16 a[200:201], v7 offset:18432
    ds_read_b64_tr_b16 a[202:203], v7 offset:18688
    ds_read_b64_tr_b16 a[204:205], v7 offset:18440
    ds_read_b64_tr_b16 a[206:207], v7 offset:18696
    s_waitcnt vmcnt(10)
    ds_read_b64_tr_b16 a[208:209], v7 offset:20480
    ds_read_b64_tr_b16 a[210:211], v7 offset:20736
    ds_read_b64_tr_b16 a[212:213], v7 offset:20488
    ds_read_b64_tr_b16 a[214:215], v7 offset:20744
    s_waitcnt vmcnt(8)
    ds_read_b64_tr_b16 a[216:217], v7 offset:22528
    ds_read_b64_tr_b16 a[218:219], v7 offset:22784
    ds_read_b64_tr_b16 a[220:221], v7 offset:22536
    ds_read_b64_tr_b16 a[222:223], v7 offset:22792
    s_waitcnt vmcnt(6)
    ds_read_b64_tr_b16 a[224:225], v7 offset:24576
    ds_read_b64_tr_b16 a[226:227], v7 offset:24832
    ds_read_b64_tr_b16 a[228:229], v7 offset:24584
    ds_read_b64_tr_b16 a[230:231], v7 offset:24840
    s_waitcnt vmcnt(4)
    ds_read_b64_tr_b16 a[232:233], v7 offset:26624
    ds_read_b64_tr_b16 a[234:235], v7 offset:26880
    ds_read_b64_tr_b16 a[236:237], v7 offset:26632
    ds_read_b64_tr_b16 a[238:239], v7 offset:26888
    s_waitcnt vmcnt(2)
    ds_read_b64_tr_b16 a[240:241], v7 offset:28672
    ds_read_b64_tr_b16 a[242:243], v7 offset:28928
    ds_read_b64_tr_b16 a[244:245], v7 offset:28680
    ds_read_b64_tr_b16 a[246:247], v7 offset:28936
    s_waitcnt vmcnt(0)
    ds_read_b64_tr_b16 a[248:249], v7 offset:30720
    ds_read_b64_tr_b16 a[250:251], v7 offset:30976
    ds_read_b64_tr_b16 a[252:253], v7 offset:30728
    ds_read_b64_tr_b16 a[254:255], v7 offset:30984
    s_waitcnt lgkmcnt(0)
    s_lshr_b32 s31, s29, 1
    s_and_b32 s31, s31, 1
    s_lshl_b32 s31, s31, 2
    v_lshrrev_b32 v2, 4, v1
    v_add_u32 v2, s31, v2
    v_and_b32 v3, 7, v1
    v_xor_b32 v2, v2, v3
    s_lshl_b32 s31, s29, 14
    v_lshrrev_b32 v8, 3, v1
    v_lshlrev_b32 v8, 11, v8
    v_add_u32 v8, s31, v8
    v_lshl_add_u32 v8, v2, 4, v8
    v_bfe_u32 v2, v1, 1, 3
    v_lshrrev_b32 v3, 4, v1
    v_xor_b32 v2, v2, v3
    v_bfe_u32 v3, v1, 3, 1
    v_lshlrev_b32 v3, 11, v3
    v_and_b32 v4, 7, v1
    v_lshl_add_u32 v3, v4, 7, v3
    v_xor_b32 v12, 0, v2
    v_lshl_add_u32 v12, v12, 4, v3
    v_add_u32 v14, 65536, v12
    v_xor_b32 v13, 4, v2
    v_lshl_add_u32 v13, v13, 4, v3
    v_add_u32 v15, 65536, v13
    s_lshl_b32 s31, s29, 6
    v_bfe_u32 v9, v1, 3, 1
    v_lshlrev_b32 v9, 16, v9
    v_and_b32 v4, 7, v1
    v_lshl_add_u32 v9, v4, 12, v9
    v_lshrrev_b32 v4, 4, v1
    v_lshl_add_u32 v9, v4, 4, v9
    v_add_u32 v9, s31, v9
    v_mov_b32 v2, 0
g_wd_73:
    global_load_dword v3, v2, s[92:93] offset:0 sc1
    s_add_u32 s41, s41, 1
    s_cmp_ge_u32 s41, 0x200000
    s_cbranch_scc1 g_wdd_74
    s_waitcnt vmcnt(0)
    v_cmp_le_u32 vcc, 256, v3
    s_cbranch_vccnz g_wdd_74
    s_sleep 4
    s_branch g_wd_73
g_wdd_74:
    s_waitcnt vmcnt(0)
    v_and_b32 v2, 31, v1
    v_lshlrev_b32 v2, 7, v2
    v_add_u32 v2, 115359744, v2
g_wl_75:
    buffer_load_dword v3, v2, s[4:7], 0 offen sc1
    s_add_u32 s41, s41, 1
    s_cmp_ge_u32 s41, 0x200000
    s_cbranch_scc1 g_wld_76
    s_waitcnt vmcnt(0)
    v_cmp_gt_u32 vcc, s51, v3
    s_cbranch_vccz g_wld_76
    s_sleep 8
    s_branch g_wl_75
g_wld_76:
    s_waitcnt vmcnt(0)
    s_lshl_b32 s35, s30, 16
    s_sub_u32 s36, s36, s37
    s_barrier
    s_add_u32 m0, s34, 0
    s_nop 0
    buffer_load_dwordx4 v8, s[12:15], s35 offen offset:0 sc1 lds
    s_add_u32 m0, s34, 3968
    s_nop 0
    buffer_load_dwordx4 v8, s[12:15], s35 offen offset:128 sc1 lds
    s_add_u32 m0, s34, 7936
    s_nop 0
    buffer_load_dwordx4 v8, s[12:15], s35 offen offset:256 sc1 lds
    s_add_u32 m0, s34, 11904
    s_nop 0
    buffer_load_dwordx4 v8, s[12:15], s35 offen offset:384 sc1 lds
    s_add_u32 m0, s34, 15872
    s_nop 0
    buffer_load_dwordx4 v8, s[12:15], s35 offen offset:512 sc1 lds
    s_add_u32 m0, s34, 19840
    s_nop 0
    buffer_load_dwordx4 v8, s[12:15], s35 offen offset:640 sc1 lds
    s_add_u32 m0, s34, 23808
    s_nop 0
    buffer_load_dwordx4 v8, s[12:15], s35 offen offset:768 sc1 lds
    s_add_u32 m0, s34, 27776
    s_nop 0
    buffer_load_dwordx4 v8, s[12:15], s35 offen offset:896 sc1 lds
    s_add_u32 m0, s34, 31744
    s_nop 0
    buffer_load_dwordx4 v8, s[12:15], s35 offen offset:1024 sc1 lds
    s_add_u32 m0, s34, 35712
    s_nop 0
    buffer_load_dwordx4 v8, s[12:15], s35 offen offset:1152 sc1 lds
    s_add_u32 m0, s34, 39680
    s_nop 0
    buffer_load_dwordx4 v8, s[12:15], s35 offen offset:1280 sc1 lds
    s_add_u32 m0, s34, 43648
    s_nop 0
    buffer_load_dwordx4 v8, s[12:15], s35 offen offset:1408 sc1 lds
    s_add_u32 m0, s34, 47616
    s_nop 0
    buffer_load_dwordx4 v8, s[12:15], s35 offen offset:1536 sc1 lds
    s_add_u32 m0, s34, 51584
    s_nop 0
    buffer_load_dwordx4 v8, s[12:15], s35 offen offset:1664 sc1 lds
    s_add_u32 m0, s34, 55552
    s_nop 0
    buffer_load_dwordx4 v8, s[12:15], s35 offen offset:1792 sc1 lds
    s_add_u32 m0, s34, 59520
    s_nop 0
    buffer_load_dwordx4 v8, s[12:15], s35 offen offset:1920 sc1 lds
    s_add_u32 s35, s35, 65536
    s_add_u32 m0, s34, 65536
    s_nop 0
    buffer_load_dwordx4 v8, s[12:15], s35 offen offset:0 sc1 lds
    s_add_u32 m0, s34, 69504
    s_nop 0
    buffer_load_dwordx4 v8, s[12:15], s35 offen offset:128 sc1 lds
    s_add_u32 m0, s34, 73472
    s_nop 0
    buffer_load_dwordx4 v8, s[12:15], s35 offen offset:256 sc1 lds
    s_add_u32 m0, s34, 77440
    s_nop 0
    buffer_load_dwordx4 v8, s[12:15], s35 offen offset:384 sc1 lds
    s_waitcnt vmcnt(12)
    s_barrier
    ds_read_b128 v[32:35], v12 offset:0
    ds_read_b128 v[36:39], v12 offset:1024
    ds_read_b128 v[40:43], v13 offset:0
    ds_read_b128 v[44:47], v13 offset:1024
    ds_read_b128 v[48:51], v12 offset:4096
    ds_read_b128 v[52:55], v12 offset:5120
    v_add_u32 v9, 2130706432, v9
sl_loop_79:
    s_waitcnt lgkmcnt(4)
    v_mfma_f32_16x16x32_bf16 v[64:67], a[0:3], v[32:35], 0
    ds_read_b128 v[56:59], v13 offset:4096
    v_mfma_f32_16x16x32_bf16 v[68:71], a[4:7], v[32:35], 0
    v_mfma_f32_16x16x32_bf16 v[72:75], a[0:3], v[36:39], 0
    ds_read_b128 v[60:63], v13 offset:5120
    s_add_u32 m0, s34, 81408
    v_mfma_f32_16x16x32_bf16 v[76:79], a[4:7], v[36:39], 0
    buffer_load_dwordx4 v8, s[12:15], s35 offen offset:512 sc1 lds
    s_waitcnt lgkmcnt(4)
    v_mfma_f32_16x16x32_bf16 v[64:67], a[8:11], v[40:43], v[64:67]
    ds_read_b128 v[32:35], v12 offset:8192
    v_mfma_f32_16x16x32_bf16 v[68:71], a[12:15], v[40:43], v[68:71]
    v_mfma_f32_16x16x32_bf16 v[72:75], a[8:11], v[44:47], v[72:75]
    ds_read_b128 v[36:39], v12 offset:9216
    v_mfma_f32_16x16x32_bf16 v[76:79], a[12:15], v[44:47], v[76:79]
    s_waitcnt lgkmcnt(4)
    v_mfma_f32_16x16x32_bf16 v[64:67], a[16:19], v[48:51], v[64:67]
    ds_read_b128 v[40:43], v13 offset:8192
    v_mfma_f32_16x16x32_bf16 v[68:71], a[20:23], v[48:51], v[68:71]
    v_cvt_pk_bf16_f32 v96, v80, v81
    v_mfma_f32_16x16x32_bf16 v[72:75], a[16:19], v[52:55], v[72:75]
    ds_read_b128 v[44:47], v13 offset:9216
    s_add_u32 m0, s34, 85376
    v_mfma_f32_16x16x32_bf16 v[76:79], a[20:23], v[52:55], v[76:79]
    buffer_load_dwordx4 v8, s[12:15], s35 offen offset:640 sc1 lds
    v_cvt_pk_bf16_f32 v97, v82, v83
    s_waitcnt lgkmcnt(4)
    v_mfma_f32_16x16x32_bf16 v[64:67], a[24:27], v[56:59], v[64:67]
    ds_read_b128 v[48:51], v12 offset:12288
    v_mfma_f32_16x16x32_bf16 v[68:71], a[28:31], v[56:59], v[68:71]
    v_cvt_pk_bf16_f32 v98, v84, v85
    v_mfma_f32_16x16x32_bf16 v[72:75], a[24:27], v[60:63], v[72:75]
    ds_read_b128 v[52:55], v12 offset:13312
    v_mfma_f32_16x16x32_bf16 v[76:79], a[28:31], v[60:63], v[76:79]
    v_cvt_pk_bf16_f32 v99, v86, v87
    s_waitcnt lgkmcnt(4)
    v_mfma_f32_16x16x32_bf16 v[64:67], a[32:35], v[32:35], v[64:67]
    ds_read_b128 v[56:59], v13 offset:12288
    v_mfma_f32_16x16x32_bf16 v[68:71], a[36:39], v[32:35], v[68:71]
    v_cvt_pk_bf16_f32 v100, v88, v89
    v_mfma_f32_16x16x32_bf16 v[72:75], a[32:35], v[36:39], v[72:75]
    ds_read_b128 v[60:63], v13 offset:13312
    s_add_u32 m0, s34, 89344
    v_mfma_f32_16x16x32_bf16 v[76:79], a[36:39], v[36:39], v[76:79]
    buffer_load_dwordx4 v8, s[12:15], s35 offen offset:768 sc1 lds
    v_cvt_pk_bf16_f32 v101, v90, v91
    s_waitcnt lgkmcnt(4)
    v_mfma_f32_16x16x32_bf16 v[64:67], a[40:43], v[40:43], v[64:67]
    ds_read_b128 v[32:35], v12 offset:16384
    v_mfma_f32_16x16x32_bf16 v[68:71], a[44:47], v[40:43], v[68:71]
    v_cvt_pk_bf16_f32 v102, v92, v93
    v_mfma_f32_16x16x32_bf16 v[72:75], a[40:43], v[44:47], v[72:75]
    ds_read_b128 v[36:39], v12 offset:17408
    v_mfma_f32_16x16x32_bf16 v[76:79], a[44:47], v[44:47], v[76:79]
    v_cvt_pk_bf16_f32 v103, v94, v95
    buffer_store_dwordx4 v[96:99], v9, s[20:23], s36 offen
    s_add_u32 s31, s36, 32768
    s_waitcnt lgkmcnt(4)
    v_mfma_f32_16x16x32_bf16 v[64:67], a[48:51], v[48:51], v[64:67]
    ds_read_b128 v[40:43], v13 offset:16384
    v_mfma_f32_16x16x32_bf16 v[68:71], a[52:55], v[48:51], v[68:71]
    v_mfma_f32_16x16x32_bf16 v[72:75], a[48:51], v[52:55], v[72:75]
    ds_read_b128 v[44:47], v13 offset:17408
    s_add_u32 m0, s34, 93312
    v_mfma_f32_16x16x32_bf16 v[76:79], a[52:55], v[52:55], v[76:79]
    buffer_load_dwordx4 v8, s[12:15], s35 offen offset:896 sc1 lds
    s_waitcnt lgkmcnt(4)
    v_mfma_f32_16x16x32_bf16 v[64:67], a[56:59], v[56:59], v[64:67]
    ds_read_b128 v[48:51], v12 offset:20480
    v_mfma_f32_16x16x32_bf16 v[68:71], a[60:63], v[56:59], v[68:71]
    v_mfma_f32_16x16x32_bf16 v[72:75], a[56:59], v[60:63], v[72:75]
    ds_read_b128 v[52:55], v12 offset:21504
    v_mfma_f32_16x16x32_bf16 v[76:79], a[60:63], v[60:63], v[76:79]
    buffer_store_dwordx4 v[100:103], v9, s[20:23], s31 offen
    s_add_u32 s36, s36, s37
    s_waitcnt vmcnt(8)
    s_barrier
    s_waitcnt lgkmcnt(4)
    v_mfma_f32_16x16x32_bf16 v[64:67], a[64:67], v[32:35], v[64:67]
    ds_read_b128 v[56:59], v13 offset:20480
    v_mfma_f32_16x16x32_bf16 v[68:71], a[68:71], v[32:35], v[68:71]
    v_mfma_f32_16x16x32_bf16 v[72:75], a[64:67], v[36:39], v[72:75]
    ds_read_b128 v[60:63], v13 offset:21504
    s_add_u32 m0, s34, 97280
    v_mfma_f32_16x16x32_bf16 v[76:79], a[68:71], v[36:39], v[76:79]
    buffer_load_dwordx4 v8, s[12:15], s35 offen offset:1024 sc1 lds
    s_waitcnt lgkmcnt(4)
    v_mfma_f32_16x16x32_bf16 v[64:67], a[72:75], v[40:43], v[64:67]
    ds_read_b128 v[32:35], v12 offset:24576
    v_mfma_f32_16x16x32_bf16 v[68:71], a[76:79], v[40:43], v[68:71]
    v_mfma_f32_16x16x32_bf16 v[72:75], a[72:75], v[44:47], v[72:75]
    ds_read_b128 v[36:39], v12 offset:25600
    v_mfma_f32_16x16x32_bf16 v[76:79], a[76:79], v[44:47], v[76:79]
    s_waitcnt lgkmcnt(4)
    v_mfma_f32_16x16x32_bf16 v[64:67], a[80:83], v[48:51], v[64:67]
    ds_read_b128 v[40:43], v13 offset:24576
    v_mfma_f32_16x16x32_bf16 v[68:71], a[84:87], v[48:51], v[68:71]
    v_and_b32 v9, 0xffffff, v9
    v_mfma_f32_16x16x32_bf16 v[72:75], a[80:83], v[52:55], v[72:75]
    ds_read_b128 v[44:47], v13 offset:25600
    s_add_u32 m0, s34, 101248
    v_mfma_f32_16x16x32_bf16 v[76:79], a[84:87], v[52:55], v[76:79]
    buffer_load_dwordx4 v8, s[12:15], s35 offen offset:1152 sc1 lds
    s_waitcnt lgkmcnt(4)
    v_mfma_f32_16x16x32_bf16 v[64:67], a[88:91], v[56:59], v[64:67]
    ds_read_b128 v[48:51], v12 offset:28672
    v_mfma_f32_16x16x32_bf16 v[68:71], a[92:95], v[56:59], v[68:71]
    v_mfma_f32_16x16x32_bf16 v[72:75], a[88:91], v[60:63], v[72:75]
    ds_read_b128 v[52:55], v12 offset:29696
    v_mfma_f32_16x16x32_bf16 v[76:79], a[92:95], v[60:63], v[76:79]
    s_waitcnt lgkmcnt(4)
    v_mfma_f32_16x16x32_bf16 v[64:67], a[96:99], v[32:35], v[64:67]
    ds_read_b128 v[56:59], v13 offset:28672
    v_mfma_f32_16x16x32_bf16 v[68:71], a[100:103], v[32:35], v[68:71]
    v_mfma_f32_16x16x32_bf16 v[72:75], a[96:99], v[36:39], v[72:75]
    ds_read_b128 v[60:63], v13 offset:29696
    s_add_u32 m0, s34, 105216
    v_mfma_f32_16x16x32_bf16 v[76:79], a[100:103], v[36:39], v[76:79]
    buffer_load_dwordx4 v8, s[12:15], s35 offen offset:1280 sc1 lds
    s_waitcnt lgkmcnt(4)
    v_mfma_f32_16x16x32_bf16 v[64:67], a[104:107], v[40:43], v[64:67]
    ds_read_b128 v[32:35], v12 offset:32768
    v_mfma_f32_16x16x32_bf16 v[68:71], a[108:111], v[40:43], v[68:71]
    v_mfma_f32_16x16x32_bf16 v[72:75], a[104:107], v[44:47], v[72:75]
    ds_read_b128 v[36:39], v12 offset:33792
    v_mfma_f32_16x16x32_bf16 v[76:79], a[108:111], v[44:47], v[76:79]
    s_waitcnt lgkmcnt(4)
    v_mfma_f32_16x16x32_bf16 v[64:67], a[112:115], v[48:51], v[64:67]
    ds_read_b128 v[40:43], v13 offset:32768
    v_mfma_f32_16x16x32_bf16 v[68:71], a[116:119], v[48:51], v[68:71]
    v_mfma_f32_16x16x32_bf16 v[72:75], a[112:115], v[52:55], v[72:75]
    ds_read_b128 v[44:47], v13 offset:33792
    s_add_u32 m0, s34, 109184
    v_mfma_f32_16x16x32_bf16 v[76:79], a[116:119], v[52:55], v[76:79]
    buffer_load_dwordx4 v8, s[12:15], s35 offen offset:1408 sc1 lds
    s_waitcnt lgkmcnt(4)
    v_mfma_f32_16x16x32_bf16 v[64:67], a[120:123], v[56:59], v[64:67]
    ds_read_b128 v[48:51], v12 offset:36864
    v_mfma_f32_16x16x32_bf16 v[68:71], a[124:127], v[56:59], v[68:71]
    v_mfma_f32_16x16x32_bf16 v[72:75], a[120:123], v[60:63], v[72:75]
    ds_read_b128 v[52:55], v12 offset:37888
    v_mfma_f32_16x16x32_bf16 v[76:79], a[124:127], v[60:63], v[76:79]
    s_waitcnt lgkmcnt(4)
    v_mfma_f32_16x16x32_bf16 v[64:67], a[128:131], v[32:35], v[64:67]
    ds_read_b128 v[56:59], v13 offset:36864
    v_mfma_f32_16x16x32_bf16 v[68:71], a[132:135], v[32:35], v[68:71]
    v_mfma_f32_16x16x32_bf16 v[72:75], a[128:131], v[36:39], v[72:75]
    ds_read_b128 v[60:63], v13 offset:37888
    s_add_u32 m0, s34, 113152
    v_mfma_f32_16x16x32_bf16 v[76:79], a[132:135], v[36:39], v[76:79]
    buffer_load_dwordx4 v8, s[12:15], s35 offen offset:1536 sc1 lds
    s_waitcnt lgkmcnt(4)
    v_mfma_f32_16x16x32_bf16 v[64:67], a[136:139], v[40:43], v[64:67]
    ds_read_b128 v[32:35], v12 offset:40960
    v_mfma_f32_16x16x32_bf16 v[68:71], a[140:143], v[40:43], v[68:71]
    v_mfma_f32_16x16x32_bf16 v[72:75], a[136:139], v[44:47], v[72:75]
    ds_read_b128 v[36:39], v12 offset:41984
    v_mfma_f32_16x16x32_bf16 v[76:79], a[140:143], v[44:47], v[76:79]
    s_waitcnt lgkmcnt(4)
    v_mfma_f32_16x16x32_bf16 v[64:67], a[144:147], v[48:51], v[64:67]
    ds_read_b128 v[40:43], v13 offset:40960
    v_mfma_f32_16x16x32_bf16 v[68:71], a[148:151], v[48:51], v[68:71]
    v_mfma_f32_16x16x32_bf16 v[72:75], a[144:147], v[52:55], v[72:75]
    ds_read_b128 v[44:47], v13 offset:41984
    s_add_u32 m0, s34, 117120
    v_mfma_f32_16x16x32_bf16 v[76:79], a[148:151], v[52:55], v[76:79]
    buffer_load_dwordx4 v8, s[12:15], s35 offen offset:1664 sc1 lds
    s_waitcnt lgkmcnt(4)
    v_mfma_f32_16x16x32_bf16 v[64:67], a[152:155], v[56:59], v[64:67]
    ds_read_b128 v[48:51], v12 offset:45056
    v_mfma_f32_16x16x32_bf16 v[68:71], a[156:159], v[56:59], v[68:71]
    v_mfma_f32_16x16x32_bf16 v[72:75], a[152:155], v[60:63], v[72:75]
    ds_read_b128 v[52:55], v12 offset:46080
    v_mfma_f32_16x16x32_bf16 v[76:79], a[156:159], v[60:63], v[76:79]
    s_waitcnt lgkmcnt(4)
    v_mfma_f32_16x16x32_bf16 v[64:67], a[160:163], v[32:35], v[64:67]
    ds_read_b128 v[56:59], v13 offset:45056
    v_mfma_f32_16x16x32_bf16 v[68:71], a[164:167], v[32:35], v[68:71]
    v_mfma_f32_16x16x32_bf16 v[72:75], a[160:163], v[36:39], v[72:75]
    ds_read_b128 v[60:63], v13 offset:46080
    s_add_u32 m0, s34, 121088
    v_mfma_f32_16x16x32_bf16 v[76:79], a[164:167], v[36:39], v[76:79]
    buffer_load_dwordx4 v8, s[12:15], s35 offen offset:1792 sc1 lds
    s_waitcnt lgkmcnt(4)
    v_mfma_f32_16x16x32_bf16 v[64:67], a[168:171], v[40:43], v[64:67]
    ds_read_b128 v[32:35], v12 offset:49152
    v_mfma_f32_16x16x32_bf16 v[68:71], a[172:175], v[40:43], v[68:71]
    v_mfma_f32_16x16x32_bf16 v[72:75], a[168:171], v[44:47], v[72:75]
    ds_read_b128 v[36:39], v12 offset:50176
    v_mfma_f32_16x16x32_bf16 v[76:79], a[172:175], v[44:47], v[76:79]
    s_waitcnt lgkmcnt(4)
    v_mfma_f32_16x16x32_bf16 v[64:67], a[176:179], v[48:51], v[64:67]
    ds_read_b128 v[40:43], v13 offset:49152
    v_mfma_f32_16x16x32_bf16 v[68:71], a[180:183], v[48:51], v[68:71]
    v_mfma_f32_16x16x32_bf16 v[72:75], a[176:179], v[52:55], v[72:75]
    ds_read_b128 v[44:47], v13 offset:50176
    s_add_u32 m0, s34, 125056
    v_mfma_f32_16x16x32_bf16 v[76:79], a[180:183], v[52:55], v[76:79]
    buffer_load_dwordx4 v8, s[12:15], s35 offen offset:1920 sc1 lds
    s_add_u32 s35, s35, 65536
    s_min_u32 s35, s35, s52
    s_waitcnt lgkmcnt(4)
    v_mfma_f32_16x16x32_bf16 v[64:67], a[184:187], v[56:59], v[64:67]
    ds_read_b128 v[48:51], v12 offset:53248
    v_mfma_f32_16x16x32_bf16 v[68:71], a[188:191], v[56:59], v[68:71]
    v_mfma_f32_16x16x32_bf16 v[72:75], a[184:187], v[60:63], v[72:75]
    ds_read_b128 v[52:55], v12 offset:54272
    v_mfma_f32_16x16x32_bf16 v[76:79], a[188:191], v[60:63], v[76:79]
    s_waitcnt vmcnt(8)
    s_barrier
    s_waitcnt lgkmcnt(4)
    v_mfma_f32_16x16x32_bf16 v[64:67], a[192:195], v[32:35], v[64:67]
    ds_read_b128 v[56:59], v13 offset:53248
    v_mfma_f32_16x16x32_bf16 v[68:71], a[196:199], v[32:35], v[68:71]
    v_mfma_f32_16x16x32_bf16 v[72:75], a[192:195], v[36:39], v[72:75]
    ds_read_b128 v[60:63], v13 offset:54272
    s_add_u32 m0, s34, 0
    v_mfma_f32_16x16x32_bf16 v[76:79], a[196:199], v[36:39], v[76:79]
    buffer_load_dwordx4 v8, s[12:15], s35 offen offset:0 sc1 lds
    s_waitcnt lgkmcnt(4)
    v_mfma_f32_16x16x32_bf16 v[64:67], a[200:203], v[40:43], v[64:67]
    ds_read_b128 v[32:35], v12 offset:57344
    v_mfma_f32_16x16x32_bf16 v[68:71], a[204:207], v[40:43], v[68:71]
    v_mfma_f32_16x16x32_bf16 v[72:75], a[200:203], v[44:47], v[72:75]
    ds_read_b128 v[36:39], v12 offset:58368
    v_mfma_f32_16x16x32_bf16 v[76:79], a[204:207], v[44:47], v[76:79]
    s_waitcnt lgkmcnt(4)
    v_mfma_f32_16x16x32_bf16 v[64:67], a[208:211], v[48:51], v[64:67]
    ds_read_b128 v[40:43], v13 offset:57344
    v_mfma_f32_16x16x32_bf16 v[68:71], a[212:215], v[48:51], v[68:71]
    v_mfma_f32_16x16x32_bf16 v[72:75], a[208:211], v[52:55], v[72:75]
    ds_read_b128 v[44:47], v13 offset:58368
    s_add_u32 m0, s34, 3968
    v_mfma_f32_16x16x32_bf16 v[76:79], a[212:215], v[52:55], v[76:79]
    buffer_load_dwordx4 v8, s[12:15], s35 offen offset:128 sc1 lds
    s_waitcnt lgkmcnt(4)
    v_mfma_f32_16x16x32_bf16 v[64:67], a[216:219], v[56:59], v[64:67]
    ds_read_b128 v[48:51], v12 offset:61440
    v_mfma_f32_16x16x32_bf16 v[68:71], a[220:223], v[56:59], v[68:71]
    v_mfma_f32_16x16x32_bf16 v[72:75], a[216:219], v[60:63], v[72:75]
    ds_read_b128 v[52:55], v12 offset:62464
    v_mfma_f32_16x16x32_bf16 v[76:79], a[220:223], v[60:63], v[76:79]
    s_waitcnt lgkmcnt(4)
    v_mfma_f32_16x16x32_bf16 v[64:67], a[224:227], v[32:35], v[64:67]
    ds_read_b128 v[56:59], v13 offset:61440
    v_mfma_f32_16x16x32_bf16 v[68:71], a[228:231], v[32:35], v[68:71]
    v_mfma_f32_16x16x32_bf16 v[72:75], a[224:227], v[36:39], v[72:75]
    ds_read_b128 v[60:63], v13 offset:62464
    s_add_u32 m0, s34, 7936
    v_mfma_f32_16x16x32_bf16 v[76:79], a[228:231], v[36:39], v[76:79]
    buffer_load_dwordx4 v8, s[12:15], s35 offen offset:256 sc1 lds
    s_waitcnt lgkmcnt(4)
    v_mfma_f32_16x16x32_bf16 v[64:67], a[232:235], v[40:43], v[64:67]
    ds_read_b128 v[32:35], v14 offset:0
    v_mfma_f32_16x16x32_bf16 v[68:71], a[236:239], v[40:43], v[68:71]
    v_mfma_f32_16x16x32_bf16 v[72:75], a[232:235], v[44:47], v[72:75]
    ds_read_b128 v[36:39], v14 offset:1024
    v_mfma_f32_16x16x32_bf16 v[76:79], a[236:239], v[44:47], v[76:79]
    s_waitcnt lgkmcnt(4)
    v_mfma_f32_16x16x32_bf16 v[64:67], a[240:243], v[48:51], v[64:67]
    ds_read_b128 v[40:43], v15 offset:0
    v_mfma_f32_16x16x32_bf16 v[68:71], a[244:247], v[48:51], v[68:71]
    v_mfma_f32_16x16x32_bf16 v[72:75], a[240:243], v[52:55], v[72:75]
    ds_read_b128 v[44:47], v15 offset:1024
    s_add_u32 m0, s34, 11904
    v_mfma_f32_16x16x32_bf16 v[76:79], a[244:247], v[52:55], v[76:79]
    buffer_load_dwordx4 v8, s[12:15], s35 offen offset:384 sc1 lds
    s_waitcnt lgkmcnt(4)
    v_mfma_f32_16x16x32_bf16 v[64:67], a[248:251], v[56:59], v[64:67]
    ds_read_b128 v[48:51], v14 offset:4096
    v_mfma_f32_16x16x32_bf16 v[68:71], a[252:255], v[56:59], v[68:71]
    v_mfma_f32_16x16x32_bf16 v[72:75], a[248:251], v[60:63], v[72:75]
    ds_read_b128 v[52:55], v14 offset:5120
    v_mfma_f32_16x16x32_bf16 v[76:79], a[252:255], v[60:63], v[76:79]
    s_waitcnt lgkmcnt(4)
    v_mfma_f32_16x16x32_bf16 v[80:83], a[0:3], v[32:35], 0
    ds_read_b128 v[56:59], v15 offset:4096
    v_mfma_f32_16x16x32_bf16 v[84:87], a[4:7], v[32:35], 0
    v_mfma_f32_16x16x32_bf16 v[88:91], a[0:3], v[36:39], 0
    ds_read_b128 v[60:63], v15 offset:5120
    s_add_u32 m0, s34, 15872
    v_mfma_f32_16x16x32_bf16 v[92:95], a[4:7], v[36:39], 0
    buffer_load_dwordx4 v8, s[12:15], s35 offen offset:512 sc1 lds
    s_waitcnt lgkmcnt(4)
    v_mfma_f32_16x16x32_bf16 v[80:83], a[8:11], v[40:43], v[80:83]
    ds_read_b128 v[32:35], v14 offset:8192
    v_mfma_f32_16x16x32_bf16 v[84:87], a[12:15], v[40:43], v[84:87]
    v_mfma_f32_16x16x32_bf16 v[88:91], a[8:11], v[44:47], v[88:91]
    ds_read_b128 v[36:39], v14 offset:9216
    v_mfma_f32_16x16x32_bf16 v[92:95], a[12:15], v[44:47], v[92:95]
    s_waitcnt lgkmcnt(4)
    v_mfma_f32_16x16x32_bf16 v[80:83], a[16:19], v[48:51], v[80:83]
    ds_read_b128 v[40:43], v15 offset:8192
    v_mfma_f32_16x16x32_bf16 v[84:87], a[20:23], v[48:51], v[84:87]
    v_cvt_pk_bf16_f32 v96, v64, v65
    v_mfma_f32_16x16x32_bf16 v[88:91], a[16:19], v[52:55], v[88:91]
    ds_read_b128 v[44:47], v15 offset:9216
    s_add_u32 m0, s34, 19840
    v_mfma_f32_16x16x32_bf16 v[92:95], a[20:23], v[52:55], v[92:95]
    buffer_load_dwordx4 v8, s[12:15], s35 offen offset:640 sc1 lds
    v_cvt_pk_bf16_f32 v97, v66, v67
    s_waitcnt lgkmcnt(4)
    v_mfma_f32_16x16x32_bf16 v[80:83], a[24:27], v[56:59], v[80:83]
    ds_read_b128 v[48:51], v14 offset:12288
    v_mfma_f32_16x16x32_bf16 v[84:87], a[28:31], v[56:59], v[84:87]
    v_cvt_pk_bf16_f32 v98, v68, v69
    v_mfma_f32_16x16x32_bf16 v[88:91], a[24:27], v[60:63], v[88:91]
    ds_read_b128 v[52:55], v14 offset:13312
    v_mfma_f32_16x16x32_bf16 v[92:95], a[28:31], v[60:63], v[92:95]
    v_cvt_pk_bf16_f32 v99, v70, v71
    s_waitcnt lgkmcnt(4)
    v_mfma_f32_16x16x32_bf16 v[80:83], a[32:35], v[32:35], v[80:83]
    ds_read_b128 v[56:59], v15 offset:12288
    v_mfma_f32_16x16x32_bf16 v[84:87], a[36:39], v[32:35], v[84:87]
    v_cvt_pk_bf16_f32 v100, v72, v73
    v_mfma_f32_16x16x32_bf16 v[88:91], a[32:35], v[36:39], v[88:91]
    ds_read_b128 v[60:63], v15 offset:13312
    s_add_u32 m0, s34, 23808
    v_mfma_f32_16x16x32_bf16 v[92:95], a[36:39], v[36:39], v[92:95]
    buffer_load_dwordx4 v8, s[12:15], s35 offen offset:768 sc1 lds
    v_cvt_pk_bf16_f32 v101, v74, v75
    s_waitcnt lgkmcnt(4)
    v_mfma_f32_16x16x32_bf16 v[80:83], a[40:43], v[40:43], v[80:83]
    ds_read_b128 v[32:35], v14 offset:16384
    v_mfma_f32_16x16x32_bf16 v[84:87], a[44:47], v[40:43], v[84:87]
    v_cvt_pk_bf16_f32 v102, v76, v77
    v_mfma_f32_16x16x32_bf16 v[88:91], a[40:43], v[44:47], v[88:91]
    ds_read_b128 v[36:39], v14 offset:17408
    v_mfma_f32_16x16x32_bf16 v[92:95], a[44:47], v[44:47], v[92:95]
    v_cvt_pk_bf16_f32 v103, v78, v79
    buffer_store_dwordx4 v[96:99], v9, s[20:23], s36 offen
    s_add_u32 s31, s36, 32768
    s_waitcnt lgkmcnt(4)
    v_mfma_f32_16x16x32_bf16 v[80:83], a[48:51], v[48:51], v[80:83]
    ds_read_b128 v[40:43], v15 offset:16384
    v_mfma_f32_16x16x32_bf16 v[84:87], a[52:55], v[48:51], v[84:87]
    v_mfma_f32_16x16x32_bf16 v[88:91], a[48:51], v[52:55], v[88:91]
    ds_read_b128 v[44:47], v15 offset:17408
    s_add_u32 m0, s34, 27776
    v_mfma_f32_16x16x32_bf16 v[92:95], a[52:55], v[52:55], v[92:95]
    buffer_load_dwordx4 v8, s[12:15], s35 offen offset:896 sc1 lds
    s_waitcnt lgkmcnt(4)
    v_mfma_f32_16x16x32_bf16 v[80:83], a[56:59], v[56:59], v[80:83]
    ds_read_b128 v[48:51], v14 offset:20480
    v_mfma_f32_16x16x32_bf16 v[84:87], a[60:63], v[56:59], v[84:87]
    v_mfma_f32_16x16x32_bf16 v[88:91], a[56:59], v[60:63], v[88:91]
    ds_read_b128 v[52:55], v14 offset:21504
    v_mfma_f32_16x16x32_bf16 v[92:95], a[60:63], v[60:63], v[92:95]
    buffer_store_dwordx4 v[100:103], v9, s[20:23], s31 offen
    s_add_u32 s36, s36, s37
    s_waitcnt vmcnt(8)
    s_barrier
    s_waitcnt lgkmcnt(4)
    v_mfma_f32_16x16x32_bf16 v[80:83], a[64:67], v[32:35], v[80:83]
    ds_read_b128 v[56:59], v15 offset:20480
    v_mfma_f32_16x16x32_bf16 v[84:87], a[68:71], v[32:35], v[84:87]
    v_mfma_f32_16x16x32_bf16 v[88:91], a[64:67], v[36:39], v[88:91]
    ds_read_b128 v[60:63], v15 offset:21504
    s_add_u32 m0, s34, 31744
    v_mfma_f32_16x16x32_bf16 v[92:95], a[68:71], v[36:39], v[92:95]
    buffer_load_dwordx4 v8, s[12:15], s35 offen offset:1024 sc1 lds
    s_waitcnt lgkmcnt(4)
    v_mfma_f32_16x16x32_bf16 v[80:83], a[72:75], v[40:43], v[80:83]
    ds_read_b128 v[32:35], v14 offset:24576
    v_mfma_f32_16x16x32_bf16 v[84:87], a[76:79], v[40:43], v[84:87]
    v_mfma_f32_16x16x32_bf16 v[88:91], a[72:75], v[44:47], v[88:91]
    ds_read_b128 v[36:39], v14 offset:25600
    v_mfma_f32_16x16x32_bf16 v[92:95], a[76:79], v[44:47], v[92:95]
    s_waitcnt lgkmcnt(4)
    v_mfma_f32_16x16x32_bf16 v[80:83], a[80:83], v[48:51], v[80:83]
    ds_read_b128 v[40:43], v15 offset:24576
    v_mfma_f32_16x16x32_bf16 v[84:87], a[84:87], v[48:51], v[84:87]
    v_mfma_f32_16x16x32_bf16 v[88:91], a[80:83], v[52:55], v[88:91]
    ds_read_b128 v[44:47], v15 offset:25600
    s_add_u32 m0, s34, 35712
    v_mfma_f32_16x16x32_bf16 v[92:95], a[84:87], v[52:55], v[92:95]
    buffer_load_dwordx4 v8, s[12:15], s35 offen offset:1152 sc1 lds
    s_waitcnt lgkmcnt(4)
    v_mfma_f32_16x16x32_bf16 v[80:83], a[88:91], v[56:59], v[80:83]
    ds_read_b128 v[48:51], v14 offset:28672
    v_mfma_f32_16x16x32_bf16 v[84:87], a[92:95], v[56:59], v[84:87]
    v_mfma_f32_16x16x32_bf16 v[88:91], a[88:91], v[60:63], v[88:91]
    ds_read_b128 v[52:55], v14 offset:29696
    v_mfma_f32_16x16x32_bf16 v[92:95], a[92:95], v[60:63], v[92:95]
    s_waitcnt lgkmcnt(4)
    v_mfma_f32_16x16x32_bf16 v[80:83], a[96:99], v[32:35], v[80:83]
    ds_read_b128 v[56:59], v15 offset:28672
    v_mfma_f32_16x16x32_bf16 v[84:87], a[100:103], v[32:35], v[84:87]
    v_mfma_f32_16x16x32_bf16 v[88:91], a[96:99], v[36:39], v[88:91]
    ds_read_b128 v[60:63], v15 offset:29696
    s_add_u32 m0, s34, 39680
    v_mfma_f32_16x16x32_bf16 v[92:95], a[100:103], v[36:39], v[92:95]
    buffer_load_dwordx4 v8, s[12:15], s35 offen offset:1280 sc1 lds
    s_waitcnt lgkmcnt(4)
    v_mfma_f32_16x16x32_bf16 v[80:83], a[104:107], v[40:43], v[80:83]
    ds_read_b128 v[32:35], v14 offset:32768
    v_mfma_f32_16x16x32_bf16 v[84:87], a[108:111], v[40:43], v[84:87]
    v_mfma_f32_16x16x32_bf16 v[88:91], a[104:107], v[44:47], v[88:91]
    ds_read_b128 v[36:39], v14 offset:33792
    v_mfma_f32_16x16x32_bf16 v[92:95], a[108:111], v[44:47], v[92:95]
    s_waitcnt lgkmcnt(4)
    v_mfma_f32_16x16x32_bf16 v[80:83], a[112:115], v[48:51], v[80:83]
    ds_read_b128 v[40:43], v15 offset:32768
    v_mfma_f32_16x16x32_bf16 v[84:87], a[116:119], v[48:51], v[84:87]
    v_mfma_f32_16x16x32_bf16 v[88:91], a[112:115], v[52:55], v[88:91]
    ds_read_b128 v[44:47], v15 offset:33792
    s_add_u32 m0, s34, 43648
    v_mfma_f32_16x16x32_bf16 v[92:95], a[116:119], v[52:55], v[92:95]
    buffer_load_dwordx4 v8, s[12:15], s35 offen offset:1408 sc1 lds
    s_waitcnt lgkmcnt(4)
    v_mfma_f32_16x16x32_bf16 v[80:83], a[120:123], v[56:59], v[80:83]
    ds_read_b128 v[48:51], v14 offset:36864
    v_mfma_f32_16x16x32_bf16 v[84:87], a[124:127], v[56:59], v[84:87]
    v_mfma_f32_16x16x32_bf16 v[88:91], a[120:123], v[60:63], v[88:91]
    ds_read_b128 v[52:55], v14 offset:37888
    v_mfma_f32_16x16x32_bf16 v[92:95], a[124:127], v[60:63], v[92:95]
    s_waitcnt lgkmcnt(4)
    v_mfma_f32_16x16x32_bf16 v[80:83], a[128:131], v[32:35], v[80:83]
    ds_read_b128 v[56:59], v15 offset:36864
    v_mfma_f32_16x16x32_bf16 v[84:87], a[132:135], v[32:35], v[84:87]
    v_mfma_f32_16x16x32_bf16 v[88:91], a[128:131], v[36:39], v[88:91]
    ds_read_b128 v[60:63], v15 offset:37888
    s_add_u32 m0, s34, 47616
    v_mfma_f32_16x16x32_bf16 v[92:95], a[132:135], v[36:39], v[92:95]
    buffer_load_dwordx4 v8, s[12:15], s35 offen offset:1536 sc1 lds
    s_waitcnt lgkmcnt(4)
    v_mfma_f32_16x16x32_bf16 v[80:83], a[136:139], v[40:43], v[80:83]
    ds_read_b128 v[32:35], v14 offset:40960
    v_mfma_f32_16x16x32_bf16 v[84:87], a[140:143], v[40:43], v[84:87]
    v_mfma_f32_16x16x32_bf16 v[88:91], a[136:139], v[44:47], v[88:91]
    ds_read_b128 v[36:39], v14 offset:41984
    v_mfma_f32_16x16x32_bf16 v[92:95], a[140:143], v[44:47], v[92:95]
    s_waitcnt lgkmcnt(4)
    v_mfma_f32_16x16x32_bf16 v[80:83], a[144:147], v[48:51], v[80:83]
    ds_read_b128 v[40:43], v15 offset:40960
    v_mfma_f32_16x16x32_bf16 v[84:87], a[148:151], v[48:51], v[84:87]
    v_mfma_f32_16x16x32_bf16 v[88:91], a[144:147], v[52:55], v[88:91]
    ds_read_b128 v[44:47], v15 offset:41984
    s_add_u32 m0, s34, 51584
    v_mfma_f32_16x16x32_bf16 v[92:95], a[148:151], v[52:55], v[92:95]
    buffer_load_dwordx4 v8, s[12:15], s35 offen offset:1664 sc1 lds
    s_waitcnt lgkmcnt(4)
    v_mfma_f32_16x16x32_bf16 v[80:83], a[152:155], v[56:59], v[80:83]
    ds_read_b128 v[48:51], v14 offset:45056
    v_mfma_f32_16x16x32_bf16 v[84:87], a[156:159], v[56:59], v[84:87]
    v_mfma_f32_16x16x32_bf16 v[88:91], a[152:155], v[60:63], v[88:91]
    ds_read_b128 v[52:55], v14 offset:46080
    v_mfma_f32_16x16x32_bf16 v[92:95], a[156:159], v[60:63], v[92:95]
    s_waitcnt lgkmcnt(4)
    v_mfma_f32_16x16x32_bf16 v[80:83], a[160:163], v[32:35], v[80:83]
    ds_read_b128 v[56:59], v15 offset:45056
    v_mfma_f32_16x16x32_bf16 v[84:87], a[164:167], v[32:35], v[84:87]
    v_mfma_f32_16x16x32_bf16 v[88:91], a[160:163], v[36:39], v[88:91]
    ds_read_b128 v[60:63], v15 offset:46080
    s_add_u32 m0, s34, 55552
    v_mfma_f32_16x16x32_bf16 v[92:95], a[164:167], v[36:39], v[92:95]
    buffer_load_dwordx4 v8, s[12:15], s35 offen offset:1792 sc1 lds
    s_waitcnt lgkmcnt(4)
    v_mfma_f32_16x16x32_bf16 v[80:83], a[168:171], v[40:43], v[80:83]
    ds_read_b128 v[32:35], v14 offset:49152
    v_mfma_f32_16x16x32_bf16 v[84:87], a[172:175], v[40:43], v[84:87]
    v_mfma_f32_16x16x32_bf16 v[88:91], a[168:171], v[44:47], v[88:91]
    ds_read_b128 v[36:39], v14 offset:50176
    v_mfma_f32_16x16x32_bf16 v[92:95], a[172:175], v[44:47], v[92:95]
    s_waitcnt lgkmcnt(4)
    v_mfma_f32_16x16x32_bf16 v[80:83], a[176:179], v[48:51], v[80:83]
    ds_read_b128 v[40:43], v15 offset:49152
    v_mfma_f32_16x16x32_bf16 v[84:87], a[180:183], v[48:51], v[84:87]
    v_mfma_f32_16x16x32_bf16 v[88:91], a[176:179], v[52:55], v[88:91]
    ds_read_b128 v[44:47], v15 offset:50176
    s_add_u32 m0, s34, 59520
    v_mfma_f32_16x16x32_bf16 v[92:95], a[180:183], v[52:55], v[92:95]
    buffer_load_dwordx4 v8, s[12:15], s35 offen offset:1920 sc1 lds
    s_add_u32 s35, s35, 65536
    s_min_u32 s35, s35, s52
    s_waitcnt lgkmcnt(4)
    v_mfma_f32_16x16x32_bf16 v[80:83], a[184:187], v[56:59], v[80:83]
    ds_read_b128 v[48:51], v14 offset:53248
    v_mfma_f32_16x16x32_bf16 v[84:87], a[188:191], v[56:59], v[84:87]
    v_mfma_f32_16x16x32_bf16 v[88:91], a[184:187], v[60:63], v[88:91]
    ds_read_b128 v[52:55], v14 offset:54272
    v_mfma_f32_16x16x32_bf16 v[92:95], a[188:191], v[60:63], v[92:95]
    s_waitcnt vmcnt(8)
    s_barrier
    s_waitcnt lgkmcnt(4)
    v_mfma_f32_16x16x32_bf16 v[80:83], a[192:195], v[32:35], v[80:83]
    ds_read_b128 v[56:59], v15 offset:53248
    v_mfma_f32_16x16x32_bf16 v[84:87], a[196:199], v[32:35], v[84:87]
    v_mfma_f32_16x16x32_bf16 v[88:91], a[192:195], v[36:39], v[88:91]
    ds_read_b128 v[60:63], v15 offset:54272
    s_add_u32 m0, s34, 65536
    v_mfma_f32_16x16x32_bf16 v[92:95], a[196:199], v[36:39], v[92:95]
    buffer_load_dwordx4 v8, s[12:15], s35 offen offset:0 sc1 lds
    s_waitcnt lgkmcnt(4)
    v_mfma_f32_16x16x32_bf16 v[80:83], a[200:203], v[40:43], v[80:83]
    ds_read_b128 v[32:35], v14 offset:57344
    v_mfma_f32_16x16x32_bf16 v[84:87], a[204:207], v[40:43], v[84:87]
    v_mfma_f32_16x16x32_bf16 v[88:91], a[200:203], v[44:47], v[88:91]
    ds_read_b128 v[36:39], v14 offset:58368
    v_mfma_f32_16x16x32_bf16 v[92:95], a[204:207], v[44:47], v[92:95]
    s_waitcnt lgkmcnt(4)
    v_mfma_f32_16x16x32_bf16 v[80:83], a[208:211], v[48:51], v[80:83]
    ds_read_b128 v[40:43], v15 offset:57344
    v_mfma_f32_16x16x32_bf16 v[84:87], a[212:215], v[48:51], v[84:87]
    v_mfma_f32_16x16x32_bf16 v[88:91], a[208:211], v[52:55], v[88:91]
    ds_read_b128 v[44:47], v15 offset:58368
    s_add_u32 m0, s34, 69504
    v_mfma_f32_16x16x32_bf16 v[92:95], a[212:215], v[52:55], v[92:95]
    buffer_load_dwordx4 v8, s[12:15], s35 offen offset:128 sc1 lds
    s_waitcnt lgkmcnt(4)
    v_mfma_f32_16x16x32_bf16 v[80:83], a[216:219], v[56:59], v[80:83]
    ds_read_b128 v[48:51], v14 offset:61440
    v_mfma_f32_16x16x32_bf16 v[84:87], a[220:223], v[56:59], v[84:87]
    v_mfma_f32_16x16x32_bf16 v[88:91], a[216:219], v[60:63], v[88:91]
    ds_read_b128 v[52:55], v14 offset:62464
    v_mfma_f32_16x16x32_bf16 v[92:95], a[220:223], v[60:63], v[92:95]
    s_waitcnt lgkmcnt(4)
    v_mfma_f32_16x16x32_bf16 v[80:83], a[224:227], v[32:35], v[80:83]
    ds_read_b128 v[56:59], v15 offset:61440
    v_mfma_f32_16x16x32_bf16 v[84:87], a[228:231], v[32:35], v[84:87]
    v_mfma_f32_16x16x32_bf16 v[88:91], a[224:227], v[36:39], v[88:91]
    ds_read_b128 v[60:63], v15 offset:62464
    s_add_u32 m0, s34, 73472
    v_mfma_f32_16x16x32_bf16 v[92:95], a[228:231], v[36:39], v[92:95]
    buffer_load_dwordx4 v8, s[12:15], s35 offen offset:256 sc1 lds
    s_waitcnt lgkmcnt(4)
    v_mfma_f32_16x16x32_bf16 v[80:83], a[232:235], v[40:43], v[80:83]
    ds_read_b128 v[32:35], v12 offset:0
    v_mfma_f32_16x16x32_bf16 v[84:87], a[236:239], v[40:43], v[84:87]
    v_mfma_f32_16x16x32_bf16 v[88:91], a[232:235], v[44:47], v[88:91]
    ds_read_b128 v[36:39], v12 offset:1024
    v_mfma_f32_16x16x32_bf16 v[92:95], a[236:239], v[44:47], v[92:95]
    s_waitcnt lgkmcnt(4)
    v_mfma_f32_16x16x32_bf16 v[80:83], a[240:243], v[48:51], v[80:83]
    ds_read_b128 v[40:43], v13 offset:0
    v_mfma_f32_16x16x32_bf16 v[84:87], a[244:247], v[48:51], v[84:87]
    v_mfma_f32_16x16x32_bf16 v[88:91], a[240:243], v[52:55], v[88:91]
    ds_read_b128 v[44:47], v13 offset:1024
    s_add_u32 m0, s34, 77440
    v_mfma_f32_16x16x32_bf16 v[92:95], a[244:247], v[52:55], v[92:95]
    buffer_load_dwordx4 v8, s[12:15], s35 offen offset:384 sc1 lds
    s_waitcnt lgkmcnt(4)
    v_mfma_f32_16x16x32_bf16 v[80:83], a[248:251], v[56:59], v[80:83]
    ds_read_b128 v[48:51], v12 offset:4096
    v_mfma_f32_16x16x32_bf16 v[84:87], a[252:255], v[56:59], v[84:87]
    v_mfma_f32_16x16x32_bf16 v[88:91], a[248:251], v[60:63], v[88:91]
    ds_read_b128 v[52:55], v12 offset:5120
    v_mfma_f32_16x16x32_bf16 v[92:95], a[252:255], v[60:63], v[92:95]
    s_add_u32 s30, s30, 2
    s_cmp_lt_u32 s30, s51
    s_cbranch_scc1 sl_loop_79
    v_cvt_pk_bf16_f32 v96, v80, v81
    v_cvt_pk_bf16_f32 v97, v82, v83
    v_cvt_pk_bf16_f32 v98, v84, v85
    v_cvt_pk_bf16_f32 v99, v86, v87
    v_cvt_pk_bf16_f32 v100, v88, v89
    v_cvt_pk_bf16_f32 v101, v90, v91
    v_cvt_pk_bf16_f32 v102, v92, v93
    v_cvt_pk_bf16_f32 v103, v94, v95
    s_branch sl_e_78
sl_e_78:
    buffer_store_dwordx4 v[96:99], v9, s[20:23], s36 offen
    s_add_u32 s31, s36, 32768
    buffer_store_dwordx4 v[100:103], v9, s[20:23], s31 offen
    s_add_u32 s36, s36, s37
    s_waitcnt vmcnt(0) lgkmcnt(0)
    s_barrier
    s_branch L_dump
L_att:
    s_mov_b32 s42, 0x3e0293ee
    s_mov_b32 s58, 0x3e8293ee
    s_sub_u32 s31, s28, 120
    s_lshl_b32 s44, s31, 2
    s_add_u32 s44, s44, s29
    s_lshl_b32 s31, s44, 11
    v_add_u32 v6, s31, v5
    v_lshrrev_b32 v9, 5, v1
    v_lshlrev_b32 v9, 7, v9
    v_and_b32 v4, 7, v1
    v_lshl_add_u32 v9, v4, 4, v9
    v_add_u32 v9, s31, v9
    s_add_u32 s31, s31, 4194304
    v_and_b32 v10, 31, v1
    v_lshlrev_b32 v10, 4, v10
    v_lshrrev_b32 v4, 5, v1
    v_lshl_add_u32 v10, v4, 3, v10
    v_add_u32 v10, s31, v10
    s_lshl_b32 s31, s44, 13
    v_add_u32 v8, s31, v5
    s_lshl_b32 s31, s44, 6
    v_and_b32 v7, 31, v1
    v_lshlrev_b32 v7, 11, v7
    v_lshrrev_b32 v4, 5, v1
    v_lshl_add_u32 v7, v4, 4, v7
    v_add_u32 v7, s31, v7
    s_lshl_b32 s55, s44, 7
    s_add_u32 s55, s55, 115343360
    s_lshr_b32 s56, s44, 2
    s_lshl_b32 s56, s56, 7
    s_add_u32 s56, s56, 115347456
    s_lshl_b32 s57, s44, 7
    s_add_u32 s57, s57, 115351552
    s_lshl_b32 s31, s44, 7
    s_add_u32 s31, s31, 115355648
    v_mov_b32 v12, s31
    s_mov_b64 vcc, 1
    v_mov_b32 v4, 2130706432
    v_cndmask_b32 v12, v4, v12, vcc
    v_add_u32 v13, 4096, v12
    v_mov_b32 v2, 0
    buffer_store_dword v2, v12, s[4:7], 0 offen sc1
    buffer_store_dword v2, v13, s[4:7], 0 offen sc1
    s_waitcnt vmcnt(0)
    s_barrier
    s_cmp_lg_u32 s29, 0
    s_cbranch_scc1 at_i_80
    s_mov_b64 exec, 1
    v_mov_b32 v2, 0
    v_mov_b32 v3, 1
    s_waitcnt vmcnt(0)
    global_atomic_add v2, v3, s[92:93] offset:0 sc1
    s_mov_b64 exec, -1
at_i_80:
    v_and_b32 v11, 31, v1
    v_lshrrev_b32 v3, 5, v1
    v_lshlrev_b32 v3, 2, v3
    v_sub_u32 v11, v11, v3
    v_mov_b32 v14, 0xf149f2ca
    v_add_u32 v3, 0, v11
    v_and_b32 v3, 0xfffffff1, v3
    v_cmp_ne_u32 vcc, 0, v3
    s_nop 1
    v_cndmask_b32 v64, 0, v14, vcc
    v_add_u32 v3, -1, v11
    v_and_b32 v3, 0xfffffff1, v3
    v_cmp_ne_u32 vcc, 0, v3
    s_nop 1
    v_cndmask_b32 v65, 0, v14, vcc
    v_add_u32 v3, -2, v11
    v_and_b32 v3, 0xfffffff1, v3
    v_cmp_ne_u32 vcc, 0, v3
    s_nop 1
    v_cndmask_b32 v66, 0, v14, vcc
    v_add_u32 v3, -3, v11
    v_and_b32 v3, 0xfffffff1, v3
    v_cmp_ne_u32 vcc, 0, v3
    s_nop 1
    v_cndmask_b32 v67, 0, v14, vcc
    v_add_u32 v3, -8, v11
    v_and_b32 v3, 0xfffffff1, v3
    v_cmp_ne_u32 vcc, 0, v3
    s_nop 1
    v_cndmask_b32 v68, 0, v14, vcc
    v_add_u32 v3, -9, v11
    v_and_b32 v3, 0xfffffff1, v3
    v_cmp_ne_u32 vcc, 0, v3
    s_nop 1
    v_cndmask_b32 v69, 0, v14, vcc
    v_add_u32 v3, -10, v11
    v_and_b32 v3, 0xfffffff1, v3
    v_cmp_ne_u32 vcc, 0, v3
    s_nop 1
    v_cndmask_b32 v70, 0, v14, vcc
    v_add_u32 v3, -11, v11
    v_and_b32 v3, 0xfffffff1, v3
    v_cmp_ne_u32 vcc, 0, v3
    s_nop 1
    v_cndmask_b32 v71, 0, v14, vcc
    v_add_u32 v3, -16, v11
    v_and_b32 v3, 0xfffffff1, v3
    v_cmp_ne_u32 vcc, 0, v3
    s_nop 1
    v_cndmask_b32 v72, 0, v14, vcc
    v_add_u32 v3, -17, v11
    v_and_b32 v3, 0xfffffff1, v3
    v_cmp_ne_u32 vcc, 0, v3
    s_nop 1
    v_cndmask_b32 v73, 0, v14, vcc
    v_add_u32 v3, -18, v11
    v_and_b32 v3, 0xfffffff1, v3
    v_cmp_ne_u32 vcc, 0, v3
    s_nop 1
    v_cndmask_b32 v74, 0, v14, vcc
    v_add_u32 v3, -19, v11
    v_and_b32 v3, 0xfffffff1, v3
    v_cmp_ne_u32 vcc, 0, v3
    s_nop 1
    v_cndmask_b32 v75, 0, v14, vcc
    v_add_u32 v3, -24, v11
    v_and_b32 v3, 0xfffffff1, v3
    v_cmp_ne_u32 vcc, 0, v3
    s_nop 1
    v_cndmask_b32 v76, 0, v14, vcc
    v_add_u32 v3, -25, v11
    v_and_b32 v3, 0xfffffff1, v3
    v_cmp_ne_u32 vcc, 0, v3
    s_nop 1
    v_cndmask_b32 v77, 0, v14, vcc
    v_add_u32 v3, -26, v11
    v_and_b32 v3, 0xfffffff1, v3
    v_cmp_ne_u32 vcc, 0, v3
    s_nop 1
    v_cndmask_b32 v78, 0, v14, vcc
    v_add_u32 v3, -27, v11
    v_and_b32 v3, 0xfffffff1, v3
    v_cmp_ne_u32 vcc, 0, v3
    s_nop 1
    v_cndmask_b32 v79, 0, v14, vcc
    v_cmp_gt_i32 vcc, 0, v11
    s_nop 1
    v_cndmask_b32 v96, 0, v14, vcc
    v_cmp_gt_i32 vcc, 1, v11
    s_nop 1
    v_cndmask_b32 v97, 0, v14, vcc
    v_cmp_gt_i32 vcc, 2, v11
    s_nop 1
    v_cndmask_b32 v98, 0, v14, vcc
    v_cmp_gt_i32 vcc, 3, v11
    s_nop 1
    v_cndmask_b32 v99, 0, v14, vcc
    v_cmp_gt_i32 vcc, 8, v11
    s_nop 1
    v_cndmask_b32 v100, 0, v14, vcc
    v_cmp_gt_i32 vcc, 9, v11
    s_nop 1
    v_cndmask_b32 v101, 0, v14, vcc
    v_cmp_gt_i32 vcc, 10, v11
    s_nop 1
    v_cndmask_b32 v102, 0, v14, vcc
    v_cmp_gt_i32 vcc, 11, v11
    s_nop 1
    v_cndmask_b32 v103, 0, v14, vcc
    v_cmp_gt_i32 vcc, 16, v11
    s_nop 1
    v_cndmask_b32 v104, 0, v14, vcc
    v_cmp_gt_i32 vcc, 17, v11
    s_nop 1
    v_cndmask_b32 v105, 0, v14, vcc
    v_cmp_gt_i32 vcc, 18, v11
    s_nop 1
    v_cndmask_b32 v106, 0, v14, vcc
    v_cmp_gt_i32 vcc, 19, v11
    s_nop 1
    v_cndmask_b32 v107, 0, v14, vcc
    v_cmp_gt_i32 vcc, 24, v11
    s_nop 1
    v_cndmask_b32 v108, 0, v14, vcc
    v_cmp_gt_i32 vcc, 25, v11
    s_nop 1
    v_cndmask_b32 v109, 0, v14, vcc
    v_cmp_gt_i32 vcc, 26, v11
    s_nop 1
    v_cndmask_b32 v110, 0, v14, vcc
    v_cmp_gt_i32 vcc, 27, v11
    s_nop 1
    v_cndmask_b32 v111, 0, v14, vcc
    v_mov_b32 v80, 0xf149f2ca
    v_mov_b32 v81, 0xf149f2ca
    v_mov_b32 v82, 0xf149f2ca
    v_mov_b32 v83, 0xf149f2ca
    v_mov_b32 v84, 0xf149f2ca
    v_mov_b32 v85, 0xf149f2ca
    v_mov_b32 v86, 0xf149f2ca
    v_mov_b32 v87, 0xf149f2ca
    v_mov_b32 v88, 0xf149f2ca
    v_mov_b32 v89, 0xf149f2ca
    v_mov_b32 v90, 0xf149f2ca
    v_mov_b32 v91, 0xf149f2ca
    v_mov_b32 v92, 0xf149f2ca
    v_mov_b32 v93, 0xf149f2ca
    v_mov_b32 v94, 0xf149f2ca
    v_mov_b32 v95, 0xf149f2ca
    v_accvgpr_write_b32 a184, 0
    v_accvgpr_write_b32 a185, 0
    v_accvgpr_write_b32 a186, 0
    v_accvgpr_write_b32 a187, 0
    v_accvgpr_write_b32 a188, 0
    v_accvgpr_write_b32 a189, 0
    v_accvgpr_write_b32 a190, 0
    v_accvgpr_write_b32 a191, 0
    v_accvgpr_write_b32 a192, 0
    v_accvgpr_write_b32 a193, 0
    v_accvgpr_write_b32 a194, 0
    v_accvgpr_write_b32 a195, 0
    v_accvgpr_write_b32 a128, 0
    v_accvgpr_write_b32 a129, 0
    v_accvgpr_write_b32 a130, 0
    v_accvgpr_write_b32 a131, 0
    v_accvgpr_write_b32 a132, 0
    v_accvgpr_write_b32 a133, 0
    v_accvgpr_write_b32 a134, 0
    v_accvgpr_write_b32 a135, 0
    v_accvgpr_write_b32 a136, 0
    v_accvgpr_write_b32 a137, 0
    v_accvgpr_write_b32 a138, 0
    v_accvgpr_write_b32 a139, 0
    v_accvgpr_write_b32 a140, 0
    v_accvgpr_write_b32 a141, 0
    v_accvgpr_write_b32 a142, 0
    v_accvgpr_write_b32 a143, 0
    v_mov_b32 v40, 0
    v_mov_b32 v41, 0
    v_mov_b32 v42, 0
    v_mov_b32 v43, 0
    s_mov_b32 s53, 0
    s_mov_b32 s54, 0
    v_mov_b32 v2, 0
g_wd_81:
    global_load_dword v3, v2, s[92:93] offset:0 sc1
    s_add_u32 s41, s41, 1
    s_cmp_ge_u32 s41, 0x200000
    s_cbranch_scc1 g_wdd_82
    s_waitcnt vmcnt(0)
    v_cmp_le_u32 vcc, 256, v3
    s_cbranch_vccnz g_wdd_82
    s_sleep 4
    s_branch g_wd_81
g_wdd_82:
    s_waitcnt vmcnt(0)
at_top_83:
    s_load_dwordx4 s[72:75], s[90:91], s57 glc
    s_load_dwordx4 s[76:79], s[90:91], s55 glc
    s_load_dwordx4 s[80:83], s[90:91], s56 glc
    s_waitcnt lgkmcnt(0)
    s_min_u32 s72, s72, s73
    s_min_u32 s72, s72, s74
    s_min_u32 s72, s72, s75
    s_min_u32 s72, s72, s76
    s_min_u32 s72, s72, s77
    s_min_u32 s72, s72, s78
    s_min_u32 s80, s80, s81
    s_min_u32 s80, s80, s82
    s_min_u32 s72, s72, 64
    s_min_u32 s80, s80, 64
    s_cmp_lt_u32 s53, s72
    s_cbranch_scc1 at_a_84
    s_cmp_lt_u32 s54, s80
    s_cbranch_scc1 at_b_85
    s_add_u32 s31, s53, s54
    s_cmp_ge_u32 s31, 128
    s_cbranch_scc1 at_end_86
    s_add_u32 s41, s41, 1
    s_cmp_ge_u32 s41, 0x200000
    s_cbranch_scc1 at_end_86
    s_sleep 2
    s_branch at_top_83
at_a_84:
    s_lshl_b32 s36, s53, 18
    s_lshl_b32 s46, s53, 16
    s_add_u32 s46, s46, 88080384
    s_add_u32 s31, s36, 0
    buffer_load_dwordx4 a[0:3], v8, s[4:7], s31 offen offset:0 sc1
    buffer_load_dwordx4 a[4:7], v8, s[4:7], s31 offen offset:1024 sc1
    buffer_load_dwordx4 a[8:11], v8, s[4:7], s31 offen offset:2048 sc1
    buffer_load_dwordx4 a[12:15], v8, s[4:7], s31 offen offset:3072 sc1
    s_add_u32 s31, s36, 4096
    buffer_load_dwordx4 a[16:19], v8, s[4:7], s31 offen offset:0 sc1
    buffer_load_dwordx4 a[20:23], v8, s[4:7], s31 offen offset:1024 sc1
    buffer_load_dwordx4 a[24:27], v8, s[4:7], s31 offen offset:2048 sc1
    buffer_load_dwordx4 a[28:31], v8, s[4:7], s31 offen offset:3072 sc1
    s_add_u32 s31, s36, 16777216
    buffer_load_dwordx4 a[32:35], v8, s[4:7], s31 offen offset:0 sc1
    buffer_load_dwordx4 a[36:39], v8, s[4:7], s31 offen offset:1024 sc1
    buffer_load_dwordx4 a[40:43], v8, s[4:7], s31 offen offset:2048 sc1
    buffer_load_dwordx4 a[44:47], v8, s[4:7], s31 offen offset:3072 sc1
    s_add_u32 s31, s36, 16781312
    buffer_load_dwordx4 a[48:51], v8, s[4:7], s31 offen offset:0 sc1
    buffer_load_dwordx4 a[52:55], v8, s[4:7], s31 offen offset:1024 sc1
    buffer_load_dwordx4 a[56:59], v8, s[4:7], s31 offen offset:2048 sc1
    buffer_load_dwordx4 a[60:63], v8, s[4:7], s31 offen offset:3072 sc1
    buffer_load_dwordx4 a[64:67], v9, s[4:7], s46 offen offset:0 sc1
    buffer_load_dwordx4 a[68:71], v9, s[4:7], s46 offen offset:256 sc1
    buffer_load_dwordx4 a[72:75], v9, s[4:7], s46 offen offset:512 sc1
    buffer_load_dwordx4 a[76:79], v9, s[4:7], s46 offen offset:768 sc1
    buffer_load_dwordx4 a[80:83], v9, s[4:7], s46 offen offset:1024 sc1
    buffer_load_dwordx4 a[84:87], v9, s[4:7], s46 offen offset:1280 sc1
    buffer_load_dwordx4 a[88:91], v9, s[4:7], s46 offen offset:1536 sc1
    buffer_load_dwordx4 a[92:95], v9, s[4:7], s46 offen offset:1792 sc1
    s_add_u32 s31, s36, 33554432
    buffer_load_dwordx4 a[96:99], v8, s[4:7], s31 offen offset:0 sc1
    buffer_load_dwordx4 a[100:103], v8, s[4:7], s31 offen offset:1024 sc1
    buffer_load_dwordx4 a[104:107], v8, s[4:7], s31 offen offset:2048 sc1
    buffer_load_dwordx4 a[108:111], v8, s[4:7], s31 offen offset:3072 sc1
    s_add_u32 s31, s36, 33558528
    buffer_load_dwordx4 a[112:115], v8, s[4:7], s31 offen offset:0 sc1
    buffer_load_dwordx4 a[116:119], v8, s[4:7], s31 offen offset:1024 sc1
    buffer_load_dwordx4 a[120:123], v8, s[4:7], s31 offen offset:2048 sc1
    buffer_load_dwordx4 a[124:127], v8, s[4:7], s31 offen offset:3072 sc1
    buffer_load_dwordx2 a[128:129], v10, s[4:7], s46 offen offset:0 sc1
    buffer_load_dwordx2 a[132:133], v10, s[4:7], s46 offen offset:512 sc1
    buffer_load_dwordx2 a[136:137], v10, s[4:7], s46 offen offset:1024 sc1
    buffer_load_dwordx2 a[140:141], v10, s[4:7], s46 offen offset:1536 sc1
    s_waitcnt vmcnt(27)
    v_mfma_f32_32x32x16_bf16 v[112:127], a[32:35], a[0:3], v[96:111]
    s_waitcnt vmcnt(26)
    v_mfma_f32_32x32x16_bf16 v[112:127], a[36:39], a[4:7], v[112:127]
    s_waitcnt vmcnt(25)
    v_mfma_f32_32x32x16_bf16 v[112:127], a[40:43], a[8:11], v[112:127]
    s_waitcnt vmcnt(24)
    v_mfma_f32_32x32x16_bf16 v[112:127], a[44:47], a[12:15], v[112:127]
    s_waitcnt vmcnt(23)
    v_mfma_f32_32x32x16_bf16 v[112:127], a[48:51], a[16:19], v[112:127]
    s_waitcnt vmcnt(22)
    v_mfma_f32_32x32x16_bf16 v[112:127], a[52:55], a[20:23], v[112:127]
    s_waitcnt vmcnt(21)
    v_mfma_f32_32x32x16_bf16 v[112:127], a[56:59], a[24:27], v[112:127]
    s_waitcnt vmcnt(20)
    v_mfma_f32_32x32x16_bf16 v[112:127], a[60:63], a[28:31], v[112:127]
    s_waitcnt vmcnt(19)
    v_mfma_f32_32x32x16_bf16 v[128:143], a[64:67], a[0:3], 0
    s_waitcnt vmcnt(18)
    v_mfma_f32_32x32x16_bf16 v[128:143], a[68:71], a[4:7], v[128:143]
    s_waitcnt vmcnt(17)
    v_mfma_f32_32x32x16_bf16 v[128:143], a[72:75], a[8:11], v[128:143]
    s_waitcnt vmcnt(16)
    v_mfma_f32_32x32x16_bf16 v[128:143], a[76:79], a[12:15], v[128:143]
    s_waitcnt vmcnt(15)
    v_mfma_f32_32x32x16_bf16 v[128:143], a[80:83], a[16:19], v[128:143]
    s_waitcnt vmcnt(14)
    v_mfma_f32_32x32x16_bf16 v[128:143], a[84:87], a[20:23], v[128:143]
    s_waitcnt vmcnt(13)
    v_mfma_f32_32x32x16_bf16 v[128:143], a[88:91], a[24:27], v[128:143]
    s_waitcnt vmcnt(12)
    v_mfma_f32_32x32x16_bf16 v[128:143], a[92:95], a[28:31], v[128:143]
    v_max3_f32 v14, v112, v113, v114
    v_max3_f32 v14, v14, v115, v116
    v_max3_f32 v14, v14, v117, v118
    v_max3_f32 v14, v14, v119, v120
    v_max3_f32 v14, v14, v121, v122
    v_max3_f32 v14, v14, v123, v124
    v_max3_f32 v14, v14, v125, v126
    s_nop 4
    v_max3_f32 v14, v14, v127, v128
    v_max3_f32 v14, v14, v129, v130
    v_max_f32 v14, v14, v131
    v_mov_b32 v15, v14
    s_nop 1
    v_permlane32_swap_b32 v14, v15
    v_max_f32 v14, v14, v15
    v_mul_f32 v14, s42, v14
    v_fma_f32 v112, v112, s42, -v14
    v_fma_f32 v113, v113, s42, -v14
    v_fma_f32 v114, v114, s42, -v14
    v_fma_f32 v115, v115, s42, -v14
    v_fma_f32 v116, v116, s42, -v14
    v_fma_f32 v117, v117, s42, -v14
    v_fma_f32 v118, v118, s42, -v14
    v_fma_f32 v119, v119, s42, -v14
    v_fma_f32 v120, v120, s42, -v14
    v_fma_f32 v121, v121, s42, -v14
    v_fma_f32 v122, v122, s42, -v14
    v_fma_f32 v123, v123, s42, -v14
    v_fma_f32 v124, v124, s42, -v14
    v_fma_f32 v125, v125, s42, -v14
    v_fma_f32 v126, v126, s42, -v14
    v_fma_f32 v127, v127, s42, -v14
    v_fma_f32 v128, v128, s42, -v14
    v_fma_f32 v129, v129, s42, -v14
    v_fma_f32 v130, v130, s42, -v14
    v_fma_f32 v131, v131, s42, -v14
    v_exp_f32 v112, v112
    v_exp_f32 v113, v113
    v_exp_f32 v114, v114
    v_exp_f32 v115, v115
    v_exp_f32 v116, v116
    v_exp_f32 v117, v117
    v_exp_f32 v118, v118
    v_exp_f32 v119, v119
    v_exp_f32 v120, v120
    v_exp_f32 v121, v121
    v_exp_f32 v122, v122
    v_exp_f32 v123, v123
    v_exp_f32 v124, v124
    v_exp_f32 v125, v125
    v_exp_f32 v126, v126
    v_exp_f32 v127, v127
    v_exp_f32 v128, v128
    v_exp_f32 v129, v129
    v_exp_f32 v130, v130
    v_exp_f32 v131, v131
    v_add_f32 v26, v112, v113
    v_add_f32 v15, v114, v115
    v_add_f32 v26, v26, v116
    v_add_f32 v15, v15, v117
    v_add_f32 v26, v26, v118
    v_add_f32 v15, v15, v119
    v_add_f32 v26, v26, v120
    v_add_f32 v15, v15, v121
    v_add_f32 v26, v26, v122
    v_add_f32 v15, v15, v123
    v_add_f32 v26, v26, v124
    v_add_f32 v15, v15, v125
    v_add_f32 v26, v26, v126
    v_add_f32 v15, v15, v127
    v_add_f32 v26, v26, v128
    v_add_f32 v15, v15, v129
    v_add_f32 v26, v26, v130
    v_add_f32 v15, v15, v131
    v_add_f32 v26, v26, v15
    v_mov_b32 v15, v26
    s_nop 1
    v_permlane32_swap_b32 v26, v15
    v_add_f32 v26, v26, v15
    v_rcp_f32 v26, v26
    v_cvt_pk_bf16_f32 v28, v112, v113
    v_cvt_pk_bf16_f32 v29, v114, v115
    v_cvt_pk_bf16_f32 v30, v116, v117
    v_cvt_pk_bf16_f32 v31, v118, v119
    v_cvt_pk_bf16_f32 v32, v120, v121
    v_cvt_pk_bf16_f32 v33, v122, v123
    v_cvt_pk_bf16_f32 v34, v124, v125
    v_cvt_pk_bf16_f32 v35, v126, v127
    v_cvt_pk_bf16_f32 v40, v128, v129
    v_cvt_pk_bf16_f32 v41, v130, v131
    s_waitcnt vmcnt(0)
    v_mfma_f32_32x32x16_bf16 v[144:159], a[96:99], v[28:31], 0
    v_mfma_f32_32x32x16_bf16 v[144:159], a[100:103], v[32:35], v[144:159]
    v_mfma_f32_32x32x16_bf16 v[144:159], a[128:131], v[40:43], v[144:159]
    v_mfma_f32_32x32x16_bf16 v[160:175], a[104:107], v[28:31], 0
    v_mfma_f32_32x32x16_bf16 v[160:175], a[108:111], v[32:35], v[160:175]
    v_mfma_f32_32x32x16_bf16 v[160:175], a[132:135], v[40:43], v[160:175]
    v_mfma_f32_32x32x16_bf16 v[176:191], a[112:115], v[28:31], 0
    v_mfma_f32_32x32x16_bf16 v[176:191], a[116:119], v[32:35], v[176:191]
    v_mfma_f32_32x32x16_bf16 v[176:191], a[136:139], v[40:43], v[176:191]
    v_mfma_f32_32x32x16_bf16 v[192:207], a[120:123], v[28:31], 0
    v_mfma_f32_32x32x16_bf16 v[192:207], a[124:127], v[32:35], v[192:207]
    v_mfma_f32_32x32x16_bf16 v[192:207], a[140:143], v[40:43], v[192:207]
    s_nop 2
    v_mul_f32 v144, v144, v26
    v_mul_f32 v145, v145, v26
    v_mul_f32 v146, v146, v26
    v_mul_f32 v147, v147, v26
    v_mul_f32 v148, v148, v26
    v_mul_f32 v149, v149, v26
    v_mul_f32 v150, v150, v26
    v_mul_f32 v151, v151, v26
    v_mul_f32 v152, v152, v26
    v_mul_f32 v153, v153, v26
    v_mul_f32 v154, v154, v26
    v_mul_f32 v155, v155, v26
    v_mul_f32 v156, v156, v26
    v_mul_f32 v157, v157, v26
    v_mul_f32 v158, v158, v26
    v_mul_f32 v159, v159, v26
    v_cvt_pk_bf16_f32 v44, v144, v145
    v_cvt_pk_bf16_f32 v45, v146, v147
    v_cvt_pk_bf16_f32 v46, v148, v149
    v_cvt_pk_bf16_f32 v47, v150, v151
    v_cvt_pk_bf16_f32 v48, v152, v153
    v_cvt_pk_bf16_f32 v49, v154, v155
    v_cvt_pk_bf16_f32 v50, v156, v157
    v_cvt_pk_bf16_f32 v51, v158, v159
    s_add_u32 s31, s36, 67108864
    buffer_store_dwordx4 v[44:47], v8, s[4:7], s31 offen offset:0 sc1
    buffer_store_dwordx4 v[48:51], v8, s[4:7], s31 offen offset:1024 sc1
    v_mul_f32 v160, v160, v26
    v_mul_f32 v161, v161, v26
    v_mul_f32 v162, v162, v26
    v_mul_f32 v163, v163, v26
    v_mul_f32 v164, v164, v26
    v_mul_f32 v165, v165, v26
    v_mul_f32 v166, v166, v26
    v_mul_f32 v167, v167, v26
    v_mul_f32 v168, v168, v26
    v_mul_f32 v169, v169, v26
    v_mul_f32 v170, v170, v26
    v_mul_f32 v171, v171, v26
    v_mul_f32 v172, v172, v26
    v_mul_f32 v173, v173, v26
    v_mul_f32 v174, v174, v26
    v_mul_f32 v175, v175, v26
    v_cvt_pk_bf16_f32 v52, v160, v161
    v_cvt_pk_bf16_f32 v53, v162, v163
    v_cvt_pk_bf16_f32 v54, v164, v165
    v_cvt_pk_bf16_f32 v55, v166, v167
    v_cvt_pk_bf16_f32 v56, v168, v169
    v_cvt_pk_bf16_f32 v57, v170, v171
    v_cvt_pk_bf16_f32 v58, v172, v173
    v_cvt_pk_bf16_f32 v59, v174, v175
    buffer_store_dwordx4 v[52:55], v8, s[4:7], s31 offen offset:2048 sc1
    buffer_store_dwordx4 v[56:59], v8, s[4:7], s31 offen offset:3072 sc1
    v_mul_f32 v176, v176, v26
    v_mul_f32 v177, v177, v26
    v_mul_f32 v178, v178, v26
    v_mul_f32 v179, v179, v26
    v_mul_f32 v180, v180, v26
    v_mul_f32 v181, v181, v26
    v_mul_f32 v182, v182, v26
    v_mul_f32 v183, v183, v26
    v_mul_f32 v184, v184, v26
    v_mul_f32 v185, v185, v26
    v_mul_f32 v186, v186, v26
    v_mul_f32 v187, v187, v26
    v_mul_f32 v188, v188, v26
    v_mul_f32 v189, v189, v26
    v_mul_f32 v190, v190, v26
    v_mul_f32 v191, v191, v26
    v_cvt_pk_bf16_f32 v44, v176, v177
    v_cvt_pk_bf16_f32 v45, v178, v179
    v_cvt_pk_bf16_f32 v46, v180, v181
    v_cvt_pk_bf16_f32 v47, v182, v183
    v_cvt_pk_bf16_f32 v48, v184, v185
    v_cvt_pk_bf16_f32 v49, v186, v187
    v_cvt_pk_bf16_f32 v50, v188, v189
    v_cvt_pk_bf16_f32 v51, v190, v191
    s_add_u32 s31, s36, 67112960
    buffer_store_dwordx4 v[44:47], v8, s[4:7], s31 offen offset:0 sc1
    buffer_store_dwordx4 v[48:51], v8, s[4:7], s31 offen offset:1024 sc1
    v_mul_f32 v192, v192, v26
    v_mul_f32 v193, v193, v26
    v_mul_f32 v194, v194, v26
    v_mul_f32 v195, v195, v26
    v_mul_f32 v196, v196, v26
    v_mul_f32 v197, v197, v26
    v_mul_f32 v198, v198, v26
    v_mul_f32 v199, v199, v26
    v_mul_f32 v200, v200, v26
    v_mul_f32 v201, v201, v26
    v_mul_f32 v202, v202, v26
    v_mul_f32 v203, v203, v26
    v_mul_f32 v204, v204, v26
    v_mul_f32 v205, v205, v26
    v_mul_f32 v206, v206, v26
    v_mul_f32 v207, v207, v26
    v_cvt_pk_bf16_f32 v52, v192, v193
    v_cvt_pk_bf16_f32 v53, v194, v195
    v_cvt_pk_bf16_f32 v54, v196, v197
    v_cvt_pk_bf16_f32 v55, v198, v199
    v_cvt_pk_bf16_f32 v56, v200, v201
    v_cvt_pk_bf16_f32 v57, v202, v203
    v_cvt_pk_bf16_f32 v58, v204, v205
    v_cvt_pk_bf16_f32 v59, v206, v207
    buffer_store_dwordx4 v[52:55], v8, s[4:7], s31 offen offset:2048 sc1
    buffer_store_dwordx4 v[56:59], v8, s[4:7], s31 offen offset:3072 sc1
    s_add_u32 s53, s53, 1
    v_mov_b32 v2, s53
    s_waitcnt vmcnt(0)
    buffer_store_dword v2, v12, s[4:7], 0 offen sc1
    s_branch at_top_83
at_b_85:
    s_lshl_b32 s36, s54, 16
    s_add_u32 s36, s36, 50331648
    buffer_load_dwordx4 a[160:163], v6, s[4:7], s36 offen offset:0 sc1
    buffer_load_dwordx4 a[164:167], v6, s[4:7], s36 offen offset:1024 sc1
    s_add_u32 s36, s36, 4194304
    buffer_load_dwordx4 a[168:171], v6, s[4:7], s36 offen offset:0 sc1
    buffer_load_dwordx4 a[172:175], v6, s[4:7], s36 offen offset:1024 sc1
    s_add_u32 s36, s36, 4194304
    buffer_load_dwordx4 a[176:179], v6, s[4:7], s36 offen offset:0 sc1
    buffer_load_dwordx4 a[180:183], v6, s[4:7], s36 offen offset:1024 sc1
    s_lshl_b32 s48, s54, 16
    s_add_u32 s48, s48, 83886080
    s_waitcnt vmcnt(4)
    v_mfma_f32_32x32x16_bf16 v[128:143], a[184:187], a[160:163], v[80:95]
    v_mfma_f32_32x32x16_bf16 v[128:143], a[188:191], a[164:167], v[128:143]
    s_waitcnt vmcnt(2)
    v_mfma_f32_32x32x16_bf16 v[112:127], a[168:171], a[160:163], v[64:79]
    v_mfma_f32_32x32x16_bf16 v[112:127], a[172:175], a[164:167], v[112:127]
    v_accvgpr_mov_b32 a184, a168
    v_accvgpr_mov_b32 a185, a169
    v_accvgpr_mov_b32 a186, a170
    v_accvgpr_mov_b32 a187, a171
    v_accvgpr_mov_b32 a188, a172
    v_accvgpr_mov_b32 a189, a173
    v_accvgpr_mov_b32 a190, a174
    v_accvgpr_mov_b32 a191, a175
    s_nop 0
    v_max3_f32 v14, v136, v137, v138
    v_max3_f32 v14, v14, v139, v140
    v_max3_f32 v14, v14, v141, v142
    v_max3_f32 v14, v14, v143, v112
    v_max3_f32 v14, v14, v113, v114
    v_max3_f32 v14, v14, v115, v116
    v_max3_f32 v14, v14, v117, v118
    v_max3_f32 v14, v14, v119, v120
    v_max3_f32 v14, v14, v121, v122
    v_max3_f32 v14, v14, v123, v124
    v_max3_f32 v14, v14, v125, v126
    v_max_f32 v14, v14, v127
    v_mov_b32 v15, v14
    s_nop 1
    v_permlane32_swap_b32 v14, v15
    v_max_f32 v14, v14, v15
    v_mul_f32 v14, s58, v14
    v_fma_f32 v136, v136, s58, -v14
    v_fma_f32 v137, v137, s58, -v14
    v_fma_f32 v138, v138, s58, -v14
    v_fma_f32 v139, v139, s58, -v14
    v_fma_f32 v140, v140, s58, -v14
    v_fma_f32 v141, v141, s58, -v14
    v_fma_f32 v142, v142, s58, -v14
    v_fma_f32 v143, v143, s58, -v14
    v_fma_f32 v112, v112, s58, -v14
    v_fma_f32 v113, v113, s58, -v14
    v_fma_f32 v114, v114, s58, -v14
    v_fma_f32 v115, v115, s58, -v14
    v_fma_f32 v116, v116, s58, -v14
    v_fma_f32 v117, v117, s58, -v14
    v_fma_f32 v118, v118, s58, -v14
    v_fma_f32 v119, v119, s58, -v14
    v_fma_f32 v120, v120, s58, -v14
    v_fma_f32 v121, v121, s58, -v14
    v_fma_f32 v122, v122, s58, -v14
    v_fma_f32 v123, v123, s58, -v14
    v_fma_f32 v124, v124, s58, -v14
    v_fma_f32 v125, v125, s58, -v14
    v_fma_f32 v126, v126, s58, -v14
    v_fma_f32 v127, v127, s58, -v14
    v_exp_f32 v136, v136
    v_exp_f32 v137, v137
    v_exp_f32 v138, v138
    v_exp_f32 v139, v139
    v_exp_f32 v140, v140
    v_exp_f32 v141, v141
    v_exp_f32 v142, v142
    v_exp_f32 v143, v143
    v_exp_f32 v112, v112
    v_exp_f32 v113, v113
    v_exp_f32 v114, v114
    v_exp_f32 v115, v115
    v_exp_f32 v116, v116
    v_exp_f32 v117, v117
    v_exp_f32 v118, v118
    v_exp_f32 v119, v119
    v_exp_f32 v120, v120
    v_exp_f32 v121, v121
    v_exp_f32 v122, v122
    v_exp_f32 v123, v123
    v_exp_f32 v124, v124
    v_exp_f32 v125, v125
    v_exp_f32 v126, v126
    v_exp_f32 v127, v127
    v_add_f32 v26, v136, v137
    v_add_f32 v15, v138, v139
    v_add_f32 v26, v26, v140
    v_add_f32 v15, v15, v141
    v_add_f32 v26, v26, v142
    v_add_f32 v15, v15, v143
    v_add_f32 v26, v26, v112
    v_add_f32 v15, v15, v113
    v_add_f32 v26, v26, v114
    v_add_f32 v15, v15, v115
    v_add_f32 v26, v26, v116
    v_add_f32 v15, v15, v117
    v_add_f32 v26, v26, v118
    v_add_f32 v15, v15, v119
    v_add_f32 v26, v26, v120
    v_add_f32 v15, v15, v121
    v_add_f32 v26, v26, v122
    v_add_f32 v15, v15, v123
    v_add_f32 v26, v26, v124
    v_add_f32 v15, v15, v125
    v_add_f32 v26, v26, v126
    v_add_f32 v15, v15, v127
    v_add_f32 v26, v26, v15
    v_mov_b32 v15, v26
    s_nop 1
    v_permlane32_swap_b32 v26, v15
    v_add_f32 v26, v26, v15
    v_rcp_f32 v26, v26
    v_cvt_pk_bf16_f32 v28, v112, v113
    v_cvt_pk_bf16_f32 v29, v114, v115
    v_cvt_pk_bf16_f32 v30, v116, v117
    v_cvt_pk_bf16_f32 v31, v118, v119
    v_cvt_pk_bf16_f32 v32, v120, v121
    v_cvt_pk_bf16_f32 v33, v122, v123
    v_cvt_pk_bf16_f32 v34, v124, v125
    v_cvt_pk_bf16_f32 v35, v126, v127
    v_cvt_pk_bf16_f32 v36, v136, v137
    v_cvt_pk_bf16_f32 v37, v138, v139
    v_cvt_pk_bf16_f32 v38, v140, v141
    v_cvt_pk_bf16_f32 v39, v142, v143
    s_waitcnt vmcnt(0)
    v_mfma_f32_32x32x16_bf16 v[144:159], a[176:179], v[28:31], 0
    v_mfma_f32_32x32x16_bf16 v[144:159], a[180:183], v[32:35], v[144:159]
    v_mfma_f32_32x32x16_bf16 v[144:159], a[192:195], v[36:39], v[144:159]
    v_accvgpr_mov_b32 a192, a180
    v_accvgpr_mov_b32 a193, a181
    v_accvgpr_mov_b32 a194, a182
    v_accvgpr_mov_b32 a195, a183
    s_cmp_lg_u32 s54, 0
    s_cbranch_scc1 at_nb_87
    v_mov_b32 v14, 0xf149f2ca
    v_add_u32 v3, 32, v11
    v_and_b32 v3, 0xfffffff1, v3
    v_cmp_ne_u32 vcc, 0, v3
    s_nop 1
    v_cndmask_b32 v80, 0, v14, vcc
    v_add_u32 v3, 31, v11
    v_and_b32 v3, 0xfffffff1, v3
    v_cmp_ne_u32 vcc, 0, v3
    s_nop 1
    v_cndmask_b32 v81, 0, v14, vcc
    v_add_u32 v3, 30, v11
    v_and_b32 v3, 0xfffffff1, v3
    v_cmp_ne_u32 vcc, 0, v3
    s_nop 1
    v_cndmask_b32 v82, 0, v14, vcc
    v_add_u32 v3, 29, v11
    v_and_b32 v3, 0xfffffff1, v3
    v_cmp_ne_u32 vcc, 0, v3
    s_nop 1
    v_cndmask_b32 v83, 0, v14, vcc
    v_add_u32 v3, 24, v11
    v_and_b32 v3, 0xfffffff1, v3
    v_cmp_ne_u32 vcc, 0, v3
    s_nop 1
    v_cndmask_b32 v84, 0, v14, vcc
    v_add_u32 v3, 23, v11
    v_and_b32 v3, 0xfffffff1, v3
    v_cmp_ne_u32 vcc, 0, v3
    s_nop 1
    v_cndmask_b32 v85, 0, v14, vcc
    v_add_u32 v3, 22, v11
    v_and_b32 v3, 0xfffffff1, v3
    v_cmp_ne_u32 vcc, 0, v3
    s_nop 1
    v_cndmask_b32 v86, 0, v14, vcc
    v_add_u32 v3, 21, v11
    v_and_b32 v3, 0xfffffff1, v3
    v_cmp_ne_u32 vcc, 0, v3
    s_nop 1
    v_cndmask_b32 v87, 0, v14, vcc
    v_add_u32 v3, 16, v11
    v_and_b32 v3, 0xfffffff1, v3
    v_cmp_ne_u32 vcc, 0, v3
    s_nop 1
    v_cndmask_b32 v88, 0, v14, vcc
    v_add_u32 v3, 15, v11
    v_and_b32 v3, 0xfffffff1, v3
    v_cmp_ne_u32 vcc, 0, v3
    s_nop 1
    v_cndmask_b32 v89, 0, v14, vcc
    v_add_u32 v3, 14, v11
    v_and_b32 v3, 0xfffffff1, v3
    v_cmp_ne_u32 vcc, 0, v3
    s_nop 1
    v_cndmask_b32 v90, 0, v14, vcc
    v_add_u32 v3, 13, v11
    v_and_b32 v3, 0xfffffff1, v3
    v_cmp_ne_u32 vcc, 0, v3
    s_nop 1
    v_cndmask_b32 v91, 0, v14, vcc
    v_add_u32 v3, 8, v11
    v_and_b32 v3, 0xfffffff1, v3
    v_cmp_ne_u32 vcc, 0, v3
    s_nop 1
    v_cndmask_b32 v92, 0, v14, vcc
    v_add_u32 v3, 7, v11
    v_and_b32 v3, 0xfffffff1, v3
    v_cmp_ne_u32 vcc, 0, v3
    s_nop 1
    v_cndmask_b32 v93, 0, v14, vcc
    v_add_u32 v3, 6, v11
    v_and_b32 v3, 0xfffffff1, v3
    v_cmp_ne_u32 vcc, 0, v3
    s_nop 1
    v_cndmask_b32 v94, 0, v14, vcc
    v_add_u32 v3, 5, v11
    v_and_b32 v3, 0xfffffff1, v3
    v_cmp_ne_u32 vcc, 0, v3
    s_nop 1
    v_cndmask_b32 v95, 0, v14, vcc
at_nb_87:
    s_nop 5
    v_mul_f32 v144, v144, v26
    v_mul_f32 v145, v145, v26
    v_mul_f32 v146, v146, v26
    v_mul_f32 v147, v147, v26
    v_mul_f32 v148, v148, v26
    v_mul_f32 v149, v149, v26
    v_mul_f32 v150, v150, v26
    v_mul_f32 v151, v151, v26
    v_mul_f32 v152, v152, v26
    v_mul_f32 v153, v153, v26
    v_mul_f32 v154, v154, v26
    v_mul_f32 v155, v155, v26
    v_mul_f32 v156, v156, v26
    v_mul_f32 v157, v157, v26
    v_mul_f32 v158, v158, v26
    v_mul_f32 v159, v159, v26
    v_cvt_pk_bf16_f32 v44, v144, v145
    v_cvt_pk_bf16_f32 v45, v146, v147
    v_cvt_pk_bf16_f32 v46, v148, v149
    v_cvt_pk_bf16_f32 v47, v150, v151
    v_cvt_pk_bf16_f32 v48, v152, v153
    v_cvt_pk_bf16_f32 v49, v154, v155
    v_cvt_pk_bf16_f32 v50, v156, v157
    v_cvt_pk_bf16_f32 v51, v158, v159
    v_permlane32_swap_b32 v44, v46
    v_permlane32_swap_b32 v45, v47
    v_permlane32_swap_b32 v48, v50
    v_permlane32_swap_b32 v49, v51
    buffer_store_dwordx4 v[44:47], v7, s[4:7], s48 offen offset:0 sc1
    buffer_store_dwordx4 v[48:51], v7, s[4:7], s48 offen offset:32 sc1
    s_add_u32 s54, s54, 1
    v_mov_b32 v2, s54
    s_waitcnt vmcnt(0)
    buffer_store_dword v2, v13, s[4:7], 0 offen sc1
    s_branch at_top_83
at_end_86:
    s_branch L_dump
L_dump:
L_end:
    s_endpgm
.section .rodata,"a"
.p2align 6
.amdhsa_kernel concat_heads__memory_aug_recurrent_mem_tr__sliding_local_dilated__prompt_kernel
  .amdhsa_next_free_vgpr 512
  .amdhsa_next_free_sgpr 102
  .amdhsa_accum_offset 256
  .amdhsa_group_segment_fixed_size 0
  .amdhsa_kernarg_size 104
  .amdhsa_user_sgpr_count 2
  .amdhsa_user_sgpr_kernarg_segment_ptr 1
  .amdhsa_system_sgpr_workgroup_id_x 1
.end_amdhsa_kernel
```

```asm
; @launch grid=(256,1,1) block=(256,1,1) lds=163840
.amdgcn_target "amdgcn-amd-amdhsa--gfx950"
.text
.globl concat_heads__memory_aug_recurrent_mem_tr__sliding_local_dilated__prompt_kernel
.p2align 8
.type concat_heads__memory_aug_recurrent_mem_tr__sliding_local_dilated__prompt_kernel,@function
concat_heads__memory_aug_recurrent_mem_tr__sliding_local_dilated__prompt_kernel:
    s_cmp_ge_u32 s2, 256
    s_cbranch_scc1 L_end
    s_and_b32 s3, s2, 3
    s_lshl_b32 s3, s3, 5
    s_lshr_b32 s28, s2, 3
    s_add_u32 s28, s28, s3
    s_bitcmp1_b32 s2, 2
    s_cbranch_scc1 L_gem
    s_load_dwordx2 s[72:73], s[0:1], 8
    s_load_dwordx4 s[76:79], s[0:1], 16
    s_load_dwordx4 s[80:83], s[0:1], 32
    s_load_dwordx2 s[90:91], s[0:1], 96
    s_load_dwordx2 s[92:93], s[0:1], 88
    v_and_b32 v1, 63, v0
    v_lshrrev_b32 v2, 6, v0
    s_nop 0
    v_readfirstlane_b32 s31, v2
    s_lshr_b32 s29, s28, 2
    s_and_b32 s30, s28, 3
    s_mov_b32 s41, 0
    s_waitcnt lgkmcnt(0)
    s_mov_b32 s24, s72
    s_and_b32 s25, s73, 0xffff
    s_mov_b32 s26, 16384
    s_mov_b32 s27, 0x00020000
    s_mov_b32 s8, s76
    s_and_b32 s9, s77, 0xffff
    s_mov_b32 s10, 8388608
    s_mov_b32 s11, 0x00020000
    s_mov_b32 s12, s78
    s_and_b32 s13, s79, 0xffff
    s_mov_b32 s14, 8388608
    s_mov_b32 s15, 0x00020000
    s_mov_b32 s16, s80
    s_and_b32 s17, s81, 0xffff
    s_mov_b32 s18, 8388608
    s_mov_b32 s19, 0x00020000
    s_mov_b32 s20, s82
    s_and_b32 s21, s83, 0xffff
    s_mov_b32 s22, 8388608
    s_mov_b32 s23, 0x00020000
    s_mov_b32 s4, s90
    s_and_b32 s5, s91, 0xffff
    s_mov_b32 s6, 268435456
    s_mov_b32 s7, 0x00020000
    s_sub_u32 s49, 0, s90
    s_and_b32 s49, s49, 2097151
    s_add_u32 s49, s49, 117440512
    s_mov_b32 s48, 1
    s_cmp_lg_u32 s31, 3
    s_cbranch_scc1 rec_cal_1
    s_and_b32 s38, s28, 7
    s_lshl_b32 s38, s38, 21
    s_lshr_b32 s40, s28, 3
    s_and_b32 s40, s40, 1
    s_lshl_b32 s40, s40, 13
    s_add_u32 s38, s38, s40
    s_lshr_b32 s40, s28, 4
    s_and_b32 s40, s40, 7
    s_lshl_b32 s40, s40, 8
    s_add_u32 s38, s38, s40
    s_add_u32 s38, s38, s49
    s_add_u32 s38, s38, 245760
    s_lshr_b32 s39, s28, 3
    s_and_b32 s39, s39, 1
    s_lshl_b32 s39, s39, 14
    s_sub_u32 s39, s38, s39
    s_add_u32 s39, s39, 8192
    s_load_dword s80, s[90:91], s38 glc
    s_load_dword s81, s[90:91], s39 glc
    s_waitcnt lgkmcnt(0)
    s_memtime s[76:77]
    s_waitcnt lgkmcnt(0)
    s_load_dword s80, s[90:91], s38 glc
    s_waitcnt lgkmcnt(0)
    s_memtime s[78:79]
    s_waitcnt lgkmcnt(0)
    s_sub_u32 s72, s78, s76
    s_waitcnt lgkmcnt(0)
    s_memtime s[76:77]
    s_waitcnt lgkmcnt(0)
    s_load_dword s80, s[90:91], s39 glc
    s_waitcnt lgkmcnt(0)
    s_memtime s[78:79]
    s_waitcnt lgkmcnt(0)
    s_sub_u32 s73, s78, s76
    s_cmp_lt_u32 s73, s72
    s_cselect_b32 s38, 1, 0
    s_lshr_b32 s39, s28, 3
    s_xor_b32 s38, s38, s39
    s_xor_b32 s38, s38, s28
    s_and_b32 s48, s38, 1
    s_lshl_b32 s48, s48, 16
    s_add_u32 s48, s48, 1
rec_cal_1:
    s_lshl_b32 s38, s31, 21
    s_lshl_b32 s40, s28, 6
    s_add_u32 s38, s38, s40
    v_lshrrev_b32 v184, 2, v1
    v_lshlrev_b32 v184, 13, v184
    v_and_b32 v4, 3, v1
    v_lshl_add_u32 v184, v4, 4, v184
    v_add_u32 v184, s38, v184
    s_mov_b32 s98, s28
    s_lshl_b32 s38, s31, 21
    s_lshr_b32 s40, s98, 1
    s_lshl_b32 s40, s40, 5
    s_add_u32 s38, s38, s40
    v_lshrrev_b32 v185, 1, v1
    v_lshlrev_b32 v185, 11, v185
    v_and_b32 v4, 1, v1
    v_lshl_add_u32 v185, v4, 4, v185
    v_add_u32 v185, s38, v185
    s_and_b32 s34, s28, 1
    s_lshl_b32 s34, s34, 20
    s_mov_b32 s35, 0
    s_mov_b32 s34, 0
    s_mov_b32 s35, 0
    s_lshl_b32 s33, s31, 15
    v_lshrrev_b32 v186, 4, v1
    v_lshlrev_b32 v186, 9, v186
    v_bfe_u32 v4, v1, 2, 2
    v_lshl_add_u32 v186, v4, 6, v186
    v_and_b32 v4, 3, v1
    v_lshl_add_u32 v186, v4, 3, v186
    v_add_u32 v186, s33, v186
    v_lshrrev_b32 v187, 4, v1
    v_lshlrev_b32 v187, 8, v187
    v_bfe_u32 v4, v1, 2, 2
    v_lshl_add_u32 v187, v4, 5, v187
    v_and_b32 v4, 3, v1
    v_lshl_add_u32 v187, v4, 3, v187
    v_add_u32 v187, s33, v187
    s_add_u32 m0, s33, 0
    s_xor_b32 s38, s34, 0
    buffer_load_dwordx4 v184, s[8:11], s38 offen lds
    s_add_u32 m0, s33, 1024
    s_xor_b32 s38, s34, 131072
    buffer_load_dwordx4 v184, s[8:11], s38 offen lds
    s_add_u32 m0, s33, 2048
    s_xor_b32 s38, s34, 0
    buffer_load_dwordx4 v184, s[12:15], s38 offen lds
    s_add_u32 m0, s33, 3072
    s_xor_b32 s38, s34, 131072
    buffer_load_dwordx4 v184, s[12:15], s38 offen lds
    s_add_u32 m0, s33, 4096
    s_xor_b32 s38, s34, 0
    buffer_load_dwordx4 v184, s[16:19], s38 offen lds
    s_add_u32 m0, s33, 5120
    s_xor_b32 s38, s34, 131072
    buffer_load_dwordx4 v184, s[16:19], s38 offen lds
    s_add_u32 m0, s33, 6144
    s_xor_b32 s38, s34, 262144
    buffer_load_dwordx4 v184, s[8:11], s38 offen lds
    s_add_u32 m0, s33, 7168
    s_xor_b32 s38, s34, 393216
    buffer_load_dwordx4 v184, s[8:11], s38 offen lds
    s_add_u32 m0, s33, 8192
    s_xor_b32 s38, s34, 262144
    buffer_load_dwordx4 v184, s[12:15], s38 offen lds
    s_add_u32 m0, s33, 9216
    s_xor_b32 s38, s34, 393216
    buffer_load_dwordx4 v184, s[12:15], s38 offen lds
    s_add_u32 m0, s33, 10240
    s_xor_b32 s38, s34, 262144
    buffer_load_dwordx4 v184, s[16:19], s38 offen lds
    s_add_u32 m0, s33, 11264
    s_xor_b32 s38, s34, 393216
    buffer_load_dwordx4 v184, s[16:19], s38 offen lds
    v_bfe_u32 v2, v1, 2, 1
    v_mov_b32 v3, 0xaaaa
    v_mul_u32_u24 v2, v2, v3
    v_add_u32 v5, 0x4444, v2
    v_lshlrev_b32 v16, 4, v1
    s_lshr_b32 s38, s98, 6
    s_lshl_b32 s38, s38, 14
    s_and_b32 s40, s98, 63
    s_lshl_b32 s40, s40, 7
    s_add_u32 s38, s38, s40
    s_add_u32 s38, s38, 131072
    v_lshl_add_u32 v6, v1, 2, s38
    s_lshr_b32 s38, s31, 1
    s_lshl_b32 s38, s38, 14
    s_and_b32 s40, s31, 1
    s_lshl_b32 s40, s40, 12
    s_add_u32 s38, s38, s40
    s_add_u32 s38, s38, 131072
    v_add_u32 v7, s38, v16
    s_lshr_b32 s38, s34, 9
    v_xor_b32 v7, s38, v7
    v_xor_b32 v12, 2048, v7
    s_and_b32 s38, s28, 1
    s_lshl_b32 s38, s38, 16
    s_lshl_b32 s40, s31, 14
    s_add_u32 s38, s38, s40
    v_add_u32 v13, s38, v16
    s_lshr_b32 s38, s35, 8
    v_xor_b32 v13, s38, v13
    v_lshrrev_b32 v2, 5, v1
    v_mul_u32_u24 v2, 640, v2
    v_and_b32 v3, 31, v1
    v_lshl_add_u32 v2, v3, 2, v2
    s_mul_i32 s38, s31, 2560
    v_add_u32 v14, s38, v2
    v_add_u32 v15, 1280, v14
    s_lshl_b32 s38, s31, 10
    s_add_u32 s38, s38, 10240
    v_add_u32 v17, s38, v16
    v_lshrrev_b32 v2, 5, v1
    v_lshlrev_b32 v2, 6, v2
    v_bfe_u32 v4, v1, 4, 1
    v_lshl_add_u32 v2, v4, 4, v2
    v_and_b32 v3, 15, v1
    v_mul_u32_u24 v3, 160, v3
    v_add_u32 v18, v2, v3
    s_lshl_b32 s38, s28, 11
    v_add_u32 v19, s38, v16
    v_bfe_u32 v20, v1, 4, 1
    v_lshlrev_b32 v20, 7, v20
    v_and_b32 v4, 7, v1
    v_lshl_add_u32 v20, v4, 4, v20
    v_add_u32 v20, s38, v20
    s_add_u32 s39, s30, 1
    s_and_b32 s38, s39, 3
    s_lshl_b32 s38, s38, 11
    s_lshl_b32 s40, s29, 13
    s_add_u32 s38, s38, s40
    v_add_u32 v22, s38, v16
    s_add_u32 s39, s30, 2
    s_and_b32 s38, s39, 3
    s_lshl_b32 s38, s38, 11
    s_lshl_b32 s40, s29, 13
    s_add_u32 s38, s38, s40
    v_add_u32 v23, s38, v16
    s_add_u32 s39, s30, 3
    s_and_b32 s38, s39, 3
    s_lshl_b32 s38, s38, 11
    s_lshl_b32 s40, s29, 13
    s_add_u32 s38, s38, s40
    v_add_u32 v24, s38, v16
    s_lshl_b32 s38, s29, 13
    v_lshrrev_b32 v21, 4, v1
    v_lshlrev_b32 v21, 11, v21
    v_and_b32 v4, 15, v1
    v_lshl_add_u32 v21, v4, 4, v21
    v_add_u32 v21, s38, v21
    v_bfe_u32 v25, v1, 3, 1
    v_lshlrev_b32 v25, 8, v25
    v_bfe_u32 v4, v1, 1, 1
    v_lshl_add_u32 v25, v4, 6, v25
    v_bfe_u32 v4, v1, 2, 1
    v_lshl_add_u32 v25, v4, 5, v25
    v_and_b32 v4, 1, v1
    v_lshl_add_u32 v25, v4, 4, v25
    v_lshrrev_b32 v4, 4, v1
    v_lshl_add_u32 v25, v4, 2, v25
    v_add_u32 v25, 10240, v25
    v_add_u32 v26, 128, v25
    s_lshl_b32 s38, s28, 11
    s_and_b32 s40, s31, 1
    s_lshl_b32 s40, s40, 7
    s_add_u32 s38, s38, s40
    s_add_u32 s38, s38, 16777216
    v_bfe_u32 v2, v1, 3, 1
    v_lshlrev_b32 v2, 8, v2
    v_and_b32 v4, 7, v1
    v_lshl_add_u32 v2, v4, 4, v2
    v_bfe_u32 v4, v1, 4, 1
    v_lshl_add_u32 v2, v4, 9, v2
    v_lshrrev_b32 v4, 5, v1
    v_lshl_add_u32 v2, v4, 10, v2
    v_add_u32 v2, s38, v2
    s_add_u32 s38, s38, 16777216
    v_bfe_u32 v3, v1, 3, 1
    v_lshlrev_b32 v3, 8, v3
    v_bfe_u32 v4, v1, 1, 1
    v_lshl_add_u32 v3, v4, 6, v3
    v_bfe_u32 v4, v1, 2, 1
    v_lshl_add_u32 v3, v4, 5, v3
    v_and_b32 v4, 1, v1
    v_lshl_add_u32 v3, v4, 4, v3
    v_bfe_u32 v4, v1, 4, 1
    v_lshl_add_u32 v3, v4, 9, v3
    v_lshrrev_b32 v4, 5, v1
    v_lshl_add_u32 v3, v4, 10, v3
    v_add_u32 v3, s38, v3
    s_cmp_lt_u32 s31, 2
    s_cselect_b64 vcc, -1, 0
    v_cndmask_b32 v30, v3, v2, vcc
    s_lshl_b32 s3, s31, 10
    s_lshr_b32 s38, s29, 3
    s_lshl_b32 s38, s38, 14
    s_and_b32 s40, s29, 7
    s_lshl_b32 s40, s40, 10
    s_add_u32 s38, s38, s40
    s_and_b32 s40, s30, 1
    s_lshl_b32 s40, s40, 9
    s_add_u32 s38, s38, s40
    s_lshr_b32 s40, s30, 1
    s_lshl_b32 s40, s40, 7
    s_add_u32 s38, s38, s40
    v_bfe_u32 v27, v1, 2, 1
    v_lshlrev_b32 v27, 16, v27
    v_lshrrev_b32 v4, 5, v1
    v_lshl_add_u32 v27, v4, 8, v27
    v_bfe_u32 v4, v1, 4, 1
    v_lshl_add_u32 v27, v4, 6, v27
    v_and_b32 v4, 3, v1
    v_lshl_add_u32 v27, v4, 4, v27
    v_add_u32 v27, s38, v27
    s_lshr_b32 s39, s31, 1
    s_lshl_b32 s39, s39, 16
    s_and_b32 s40, s31, 1
    s_lshl_b32 s40, s40, 8
    s_add_u32 s39, s39, s40
    s_add_u32 s39, s39, s38
    v_add_u32 v95, s39, v16
    v_cmp_gt_u32 vcc, 8, v1
    v_mov_b32 v4, 2130706432
    s_nop 0
    v_cndmask_b32 v95, v4, v95, vcc
    s_lshl_b32 s38, s31, 8
    s_add_u32 s38, s38, 14336
    v_lshl_add_u32 v28, v1, 2, s38
    v_and_b32 v29, 15, v1
    v_lshlrev_b32 v29, 4, v29
    v_bfe_u32 v4, v1, 4, 1
    v_lshl_add_u32 v29, v4, 3, v29
    v_add_u32 v29, 14336, v29
    s_mul_i32 s39, s31, 320
    s_lshl_b32 s38, s28, 11
    s_add_u32 s38, s38, s39
    v_add_u32 v94, s38, v16
    v_cmp_gt_u32 vcc, 20, v1
    v_mov_b32 v4, 2130706432
    s_nop 0
    v_cndmask_b32 v94, v4, v94, vcc
    s_mul_i32 s38, s31, 3
    v_min_u32 v2, 2, v1
    v_add_u32 v2, s38, v2
    v_min_u32 v2, 9, v2
    s_lshl_b32 s38, s28, 11
    s_add_u32 s38, s38, 262144
    v_lshl_add_u32 v92, v2, 7, s38
    s_lshl_b32 s38, s28, 9
    v_lshrrev_b32 v93, 4, v1
    v_lshlrev_b32 v93, 7, v93
    v_and_b32 v4, 7, v1
    v_lshl_add_u32 v93, v4, 4, v93
    v_add_u32 v93, s38, v93
    s_mov_b32 vcc_lo, 0xff00ff00
    s_mov_b32 vcc_hi, 0xff00ff00
    s_cmp_eq_u32 s31, 1
    s_cbranch_scc1 rec_ns_2
    s_add_u32 s38, s38, 4194304
    v_add_u32 v93, s38, v16
    s_mov_b32 vcc_lo, -1
    s_mov_b32 vcc_hi, 0
    s_cmp_eq_u32 s31, 2
    s_cbranch_scc1 rec_ns_2
    s_lshr_b32 s38, s98, 6
    s_lshl_b32 s38, s38, 14
    s_and_b32 s40, s98, 63
    s_lshl_b32 s40, s40, 7
    s_add_u32 s38, s38, s40
    s_add_u32 s38, s38, 131072
    v_add_u32 v93, s38, v16
    s_cmp_eq_u32 s31, 3
    s_cselect_b32 vcc_lo, 0xff, 0
rec_ns_2:
    s_nop 0
    v_mov_b32 v4, 2130706432
    v_cndmask_b32 v93, v4, v93, vcc
    v_mov_b32 v32, 0x3f803f80
    v_mov_b32 v33, 0x3f803f80
    v_mov_b32 v34, 0x3f803f80
    v_mov_b32 v35, 0x3f803f80
    v_mov_b32 v8, -1
    v_mov_b32 v9, -1
    v_mov_b32 v10, -1
    v_mov_b32 v11, -1
    v_mov_b32 v144, 0
    v_mov_b32 v145, 0
    v_mov_b32 v146, 0
    v_mov_b32 v147, 0
    v_mov_b32 v180, 0
    v_mov_b32 v181, 0
    v_mov_b32 v182, 0
    v_mov_b32 v183, 0
    v_mov_b32 v161, 0
    v_mov_b32 v162, 0
    v_mov_b32 v163, 0
    v_mov_b32 v138, 0
    v_mov_b32 v139, 0
    v_mov_b32 v140, 0
    v_mov_b32 v141, 0
    v_mov_b32 v142, 0
    v_mov_b32 v143, 0
    s_mov_b32 s42, 0x00ff00ff
    s_mov_b32 s43, 0x00ff00ff
    s_mov_b32 s44, 0
    s_mov_b32 s45, -1
    s_mov_b32 s46, 0
    s_mov_b32 s47, 0x00ff00ff
    s_mov_b32 s50, 0x3e0293ee
    s_mov_b32 s36, 96468992
    s_mov_b32 s37, 0
    s_mov_b32 s32, 0
    s_mov_b32 s51, 16384
    s_mov_b32 s54, 1
    s_add_u32 s38, s31, 1
    v_mov_b32 v134, s38
    s_lshl_b32 s95, s29, 7
    s_lshr_b32 s40, s31, 1
    s_lshl_b32 s40, s40, 2
    s_add_u32 s95, s95, s40
    s_add_u32 s95, s95, 115343364
    s_lshl_b32 s97, s29, 7
    s_add_u32 s97, s97, 115351552
    s_lshl_b32 s38, s30, 2
    s_add_u32 s38, s38, s97
    v_mov_b32 v188, s38
    s_cmp_eq_u32 s31, 2
    s_cselect_b64 vcc, 1, 0
    v_mov_b32 v4, 2130706432
    v_cndmask_b32 v188, v4, v188, vcc
    v_mov_b32 v189, 0
    s_mov_b32 s94, 0
    s_add_u32 s38, s49, 0
    buffer_store_dwordx4 v[144:147], v95, s[4:7], s38 offen sc1
    s_add_u32 s38, s49, 262144
    buffer_store_dwordx4 v[144:147], v95, s[4:7], s38 offen sc1
    s_add_u32 s38, s49, 8192
    buffer_store_dwordx4 v[144:147], v95, s[4:7], s38 offen sc1
    s_add_u32 s38, s49, 270336
    buffer_store_dwordx4 v[144:147], v95, s[4:7], s38 offen sc1
    buffer_store_dwordx4 v[8:11], v94, s[4:7], s36 offen sc1
    v_add_u32 v94, 262144, v94
    buffer_store_dwordx4 v[8:11], v94, s[4:7], s36 offen sc1
    v_add_u32 v94, 262144, v94
    buffer_store_dword v189, v188, s[4:7], 0 offen sc1
    s_getreg_b32 s38, hwreg(HW_REG_XCC_ID)
    v_mov_b32 v2, s38
    buffer_store_dword v2, v188, s[4:7], 0 offen offset:16 sc1
    s_cmp_lg_u32 s31, 3
    s_cbranch_scc1 rec_i3_3
    s_add_u32 s38, s49, 262144
    buffer_store_dwordx4 v[144:147], v93, s[4:7], s38 offen sc1
    s_add_u32 s38, s49, 270336
    buffer_store_dwordx4 v[144:147], v93, s[4:7], s38 offen sc1
    s_lshr_b32 s39, s28, 5
    s_lshl_b32 s39, s39, 14
    s_and_b32 s40, s28, 31
    s_lshl_b32 s40, s40, 8
    s_add_u32 s39, s39, s40
    s_add_u32 s39, s39, s49
    s_add_u32 s39, s39, 163840
    s_mov_b64 exec, 0xffff
    s_add_u32 s38, s39, 0
    buffer_store_dwordx4 v[144:147], v16, s[4:7], s38 offen sc1
    s_add_u32 s38, s39, 8192
    buffer_store_dwordx4 v[144:147], v16, s[4:7], s38 offen sc1
    s_mov_b64 exec, -1
rec_i3_3:
    s_lshl_b32 s38, s31, 9
    s_lshr_b32 s40, s34, 12
    s_add_u32 s38, s38, s40
    v_bfe_u32 v2, v1, 3, 1
    v_lshlrev_b32 v2, 13, v2
    v_and_b32 v4, 3, v1
    v_lshl_add_u32 v2, v4, 11, v2
    v_lshrrev_b32 v4, 4, v1
    v_lshl_add_u32 v2, v4, 5, v2
    v_bfe_u32 v4, v1, 2, 1
    v_lshl_add_u32 v2, v4, 2, v2
    v_add_u32 v2, s38, v2
    v_xor_b32 v3, 256, v2
    buffer_load_dword v36, v2, s[24:27], 0 offen offset:0
    buffer_load_dword v37, v2, s[24:27], 0 offen offset:8
    buffer_load_dword v38, v2, s[24:27], 0 offen offset:16
    buffer_load_dword v39, v2, s[24:27], 0 offen offset:24
    buffer_load_dword v40, v2, s[24:27], 0 offen offset:128
    buffer_load_dword v41, v2, s[24:27], 0 offen offset:136
    buffer_load_dword v42, v2, s[24:27], 0 offen offset:144
    buffer_load_dword v43, v2, s[24:27], 0 offen offset:152
    buffer_load_dword v44, v3, s[24:27], 0 offen offset:0
    buffer_load_dword v45, v3, s[24:27], 0 offen offset:8
    buffer_load_dword v46, v3, s[24:27], 0 offen offset:16
    buffer_load_dword v47, v3, s[24:27], 0 offen offset:24
    buffer_load_dword v48, v3, s[24:27], 0 offen offset:128
    buffer_load_dword v49, v3, s[24:27], 0 offen offset:136
    buffer_load_dword v50, v3, s[24:27], 0 offen offset:144
    buffer_load_dword v51, v3, s[24:27], 0 offen offset:152
    s_add_u32 m0, s33, 12288
    s_xor_b32 s38, s34, 524288
    buffer_load_dwordx4 v184, s[8:11], s38 offen lds
    s_add_u32 m0, s33, 13312
    s_xor_b32 s38, s34, 655360
    buffer_load_dwordx4 v184, s[8:11], s38 offen lds
    s_add_u32 m0, s33, 14336
    s_xor_b32 s38, s34, 524288
    buffer_load_dwordx4 v184, s[12:15], s38 offen lds
    s_add_u32 m0, s33, 15360
    s_xor_b32 s38, s34, 655360
    buffer_load_dwordx4 v184, s[12:15], s38 offen lds
    s_add_u32 m0, s33, 16384
    s_xor_b32 s38, s34, 524288
    buffer_load_dwordx4 v184, s[16:19], s38 offen lds
    s_add_u32 m0, s33, 17408
    s_xor_b32 s38, s34, 655360
    buffer_load_dwordx4 v184, s[16:19], s38 offen lds
    s_add_u32 m0, s33, 18432
    s_xor_b32 s38, s34, 786432
    buffer_load_dwordx4 v184, s[8:11], s38 offen lds
    s_add_u32 m0, s33, 19456
    s_xor_b32 s38, s34, 917504
    buffer_load_dwordx4 v184, s[8:11], s38 offen lds
    s_add_u32 m0, s33, 20480
    s_xor_b32 s38, s34, 786432
    buffer_load_dwordx4 v184, s[12:15], s38 offen lds
    s_add_u32 m0, s33, 21504
    s_xor_b32 s38, s34, 917504
    buffer_load_dwordx4 v184, s[12:15], s38 offen lds
    s_add_u32 m0, s33, 22528
    s_xor_b32 s38, s34, 786432
    buffer_load_dwordx4 v184, s[16:19], s38 offen lds
    s_add_u32 m0, s33, 23552
    s_xor_b32 s38, s34, 917504
    buffer_load_dwordx4 v184, s[16:19], s38 offen lds
    s_add_u32 m0, s33, 24576
    s_xor_b32 s38, s34, 1048576
    buffer_load_dwordx4 v184, s[8:11], s38 offen lds
    s_add_u32 m0, s33, 25600
    s_xor_b32 s38, s34, 1179648
    buffer_load_dwordx4 v184, s[8:11], s38 offen lds
    s_add_u32 m0, s33, 26624
    s_xor_b32 s38, s34, 1048576
    buffer_load_dwordx4 v184, s[12:15], s38 offen lds
    s_add_u32 m0, s33, 27648
    s_xor_b32 s38, s34, 1179648
    buffer_load_dwordx4 v184, s[12:15], s38 offen lds
    s_add_u32 m0, s33, 28672
    s_xor_b32 s38, s34, 1048576
    buffer_load_dwordx4 v184, s[16:19], s38 offen lds
    s_add_u32 m0, s33, 29696
    s_xor_b32 s38, s34, 1179648
    buffer_load_dwordx4 v184, s[16:19], s38 offen lds
    s_add_u32 m0, s33, 30720
    s_xor_b32 s38, s34, 1310720
    buffer_load_dwordx4 v184, s[8:11], s38 offen lds
    s_add_u32 m0, s33, 31744
    s_xor_b32 s38, s34, 1441792
    buffer_load_dwordx4 v184, s[8:11], s38 offen lds
    s_waitcnt vmcnt(54)
    ds_read_b64_tr_b16 a[0:1], v186 offset:0
    ds_read_b64_tr_b16 a[2:3], v186 offset:256
    ds_read_b64_tr_b16 a[8:9], v186 offset:32
    ds_read_b64_tr_b16 a[10:11], v186 offset:288
    s_waitcnt vmcnt(52)
    ds_read_b64_tr_b16 a[16:17], v186 offset:2048
    ds_read_b64_tr_b16 a[18:19], v186 offset:2304
    ds_read_b64_tr_b16 a[24:25], v186 offset:2080
    ds_read_b64_tr_b16 a[26:27], v186 offset:2336
    s_waitcnt lgkmcnt(4)
    s_add_u32 m0, s33, 0
    s_xor_b32 s38, s34, 1310720
    buffer_load_dwordx4 v184, s[12:15], s38 offen lds
    s_add_u32 m0, s33, 1024
    s_xor_b32 s38, s34, 1441792
    buffer_load_dwordx4 v184, s[12:15], s38 offen lds
    s_waitcnt vmcnt(52)
    ds_read_b64_tr_b16 a[32:33], v186 offset:4096
    ds_read_b64_tr_b16 a[34:35], v186 offset:4352
    ds_read_b64_tr_b16 a[40:41], v186 offset:4128
    ds_read_b64_tr_b16 a[42:43], v186 offset:4384
    s_waitcnt lgkmcnt(4)
    s_add_u32 m0, s33, 2048
    s_xor_b32 s38, s34, 1310720
    buffer_load_dwordx4 v184, s[16:19], s38 offen lds
    s_add_u32 m0, s33, 3072
    s_xor_b32 s38, s34, 1441792
    buffer_load_dwordx4 v184, s[16:19], s38 offen lds
    s_waitcnt vmcnt(52)
    ds_read_b64_tr_b16 a[4:5], v186 offset:6144
    ds_read_b64_tr_b16 a[6:7], v186 offset:6400
    ds_read_b64_tr_b16 a[12:13], v186 offset:6176
    ds_read_b64_tr_b16 a[14:15], v186 offset:6432
    s_waitcnt lgkmcnt(4)
    s_add_u32 m0, s33, 4096
    s_xor_b32 s38, s34, 1572864
    buffer_load_dwordx4 v184, s[8:11], s38 offen lds
    s_add_u32 m0, s33, 5120
    s_xor_b32 s38, s34, 1703936
    buffer_load_dwordx4 v184, s[8:11], s38 offen lds
    s_waitcnt vmcnt(52)
    ds_read_b64_tr_b16 a[20:21], v186 offset:8192
    ds_read_b64_tr_b16 a[22:23], v186 offset:8448
    ds_read_b64_tr_b16 a[28:29], v186 offset:8224
    ds_read_b64_tr_b16 a[30:31], v186 offset:8480
    s_waitcnt lgkmcnt(4)
    s_add_u32 m0, s33, 6144
    s_xor_b32 s38, s34, 1572864
    buffer_load_dwordx4 v184, s[12:15], s38 offen lds
    s_add_u32 m0, s33, 7168
    s_xor_b32 s38, s34, 1703936
    buffer_load_dwordx4 v184, s[12:15], s38 offen lds
    s_waitcnt vmcnt(52)
    ds_read_b64_tr_b16 a[36:37], v186 offset:10240
    ds_read_b64_tr_b16 a[38:39], v186 offset:10496
    ds_read_b64_tr_b16 a[44:45], v186 offset:10272
    ds_read_b64_tr_b16 a[46:47], v186 offset:10528
    s_waitcnt lgkmcnt(4)
    s_add_u32 m0, s33, 8192
    s_xor_b32 s38, s34, 1572864
    buffer_load_dwordx4 v184, s[16:19], s38 offen lds
    s_add_u32 m0, s33, 9216
    s_xor_b32 s38, s34, 1703936
    buffer_load_dwordx4 v184, s[16:19], s38 offen lds
    s_waitcnt vmcnt(28)
    s_barrier
    s_cmp_lg_u32 s31, 3
    s_cbranch_scc1 rec_arr_4
    v_mov_b32 v2, 0
    v_mov_b32 v3, s48
    s_mov_b64 exec, 1
    global_atomic_add v2, v3, s[92:93] offset:0 sc1
    s_mov_b64 exec, -1
rec_arr_4:
    ds_read_b64_tr_b16 a[48:49], v186 offset:12288
    ds_read_b64_tr_b16 a[50:51], v186 offset:12544
    ds_read_b64_tr_b16 a[56:57], v186 offset:12320
    ds_read_b64_tr_b16 a[58:59], v186 offset:12576
    s_waitcnt lgkmcnt(4)
    s_add_u32 m0, s33, 10240
    s_xor_b32 s38, s34, 1835008
    buffer_load_dwordx4 v184, s[8:11], s38 offen lds
    s_add_u32 m0, s33, 11264
    s_xor_b32 s38, s34, 1966080
    buffer_load_dwordx4 v184, s[8:11], s38 offen lds
    s_waitcnt vmcnt(28)
    ds_read_b64_tr_b16 a[64:65], v186 offset:14336
    ds_read_b64_tr_b16 a[66:67], v186 offset:14592
    ds_read_b64_tr_b16 a[72:73], v186 offset:14368
    ds_read_b64_tr_b16 a[74:75], v186 offset:14624
    s_waitcnt lgkmcnt(4)
    s_add_u32 m0, s33, 12288
    s_xor_b32 s38, s34, 1835008
    buffer_load_dwordx4 v184, s[12:15], s38 offen lds
    s_add_u32 m0, s33, 13312
    s_xor_b32 s38, s34, 1966080
    buffer_load_dwordx4 v184, s[12:15], s38 offen lds
    s_waitcnt vmcnt(28)
    ds_read_b64_tr_b16 a[80:81], v186 offset:16384
    ds_read_b64_tr_b16 a[82:83], v186 offset:16640
    ds_read_b64_tr_b16 a[88:89], v186 offset:16416
    ds_read_b64_tr_b16 a[90:91], v186 offset:16672
    s_waitcnt lgkmcnt(4)
    s_add_u32 m0, s33, 14336
    s_xor_b32 s38, s34, 1835008
    buffer_load_dwordx4 v184, s[16:19], s38 offen lds
    s_add_u32 m0, s33, 15360
    s_xor_b32 s38, s34, 1966080
    buffer_load_dwordx4 v184, s[16:19], s38 offen lds
    s_waitcnt vmcnt(28)
    ds_read_b64_tr_b16 a[52:53], v186 offset:18432
    ds_read_b64_tr_b16 a[54:55], v186 offset:18688
    ds_read_b64_tr_b16 a[60:61], v186 offset:18464
    ds_read_b64_tr_b16 a[62:63], v186 offset:18720
    s_waitcnt lgkmcnt(4)
    s_add_u32 m0, s33, 16384
    s_mov_b32 s38, 0
    buffer_load_dwordx4 v185, s[20:23], s38 offen lds
    s_add_u32 m0, s33, 17408
    s_mov_b32 s38, 65536
    buffer_load_dwordx4 v185, s[20:23], s38 offen lds
    s_waitcnt vmcnt(28)
    ds_read_b64_tr_b16 a[68:69], v186 offset:20480
    ds_read_b64_tr_b16 a[70:71], v186 offset:20736
    ds_read_b64_tr_b16 a[76:77], v186 offset:20512
    ds_read_b64_tr_b16 a[78:79], v186 offset:20768
    s_waitcnt lgkmcnt(4)
    s_add_u32 m0, s33, 18432
    s_mov_b32 s38, 131072
    buffer_load_dwordx4 v185, s[20:23], s38 offen lds
    s_add_u32 m0, s33, 19456
    s_mov_b32 s38, 196608
    buffer_load_dwordx4 v185, s[20:23], s38 offen lds
    s_waitcnt vmcnt(28)
    ds_read_b64_tr_b16 a[84:85], v186 offset:22528
    ds_read_b64_tr_b16 a[86:87], v186 offset:22784
    ds_read_b64_tr_b16 a[92:93], v186 offset:22560
    ds_read_b64_tr_b16 a[94:95], v186 offset:22816
    s_waitcnt lgkmcnt(4)
    s_add_u32 m0, s33, 20480
    s_mov_b32 s38, 262144
    buffer_load_dwordx4 v185, s[20:23], s38 offen lds
    s_add_u32 m0, s33, 21504
    s_mov_b32 s38, 327680
    buffer_load_dwordx4 v185, s[20:23], s38 offen lds
    s_waitcnt vmcnt(28)
    ds_read_b64_tr_b16 a[96:97], v186 offset:24576
    ds_read_b64_tr_b16 a[98:99], v186 offset:24832
    ds_read_b64_tr_b16 a[104:105], v186 offset:24608
    ds_read_b64_tr_b16 a[106:107], v186 offset:24864
    s_waitcnt lgkmcnt(4)
    s_add_u32 m0, s33, 22528
    s_mov_b32 s38, 393216
    buffer_load_dwordx4 v185, s[20:23], s38 offen lds
    s_add_u32 m0, s33, 23552
    s_mov_b32 s38, 458752
    buffer_load_dwordx4 v185, s[20:23], s38 offen lds
    s_waitcnt vmcnt(28)
    ds_read_b64_tr_b16 a[112:113], v186 offset:26624
    ds_read_b64_tr_b16 a[114:115], v186 offset:26880
    ds_read_b64_tr_b16 a[120:121], v186 offset:26656
    ds_read_b64_tr_b16 a[122:123], v186 offset:26912
    s_waitcnt lgkmcnt(4)
    s_add_u32 m0, s33, 24576
    s_mov_b32 s38, 524288
    buffer_load_dwordx4 v185, s[20:23], s38 offen lds
    s_add_u32 m0, s33, 25600
    s_mov_b32 s38, 589824
    buffer_load_dwordx4 v185, s[20:23], s38 offen lds
    s_waitcnt vmcnt(28)
    ds_read_b64_tr_b16 a[128:129], v186 offset:28672
    ds_read_b64_tr_b16 a[130:131], v186 offset:28928
    ds_read_b64_tr_b16 a[136:137], v186 offset:28704
    ds_read_b64_tr_b16 a[138:139], v186 offset:28960
    s_waitcnt lgkmcnt(4)
    s_add_u32 m0, s33, 26624
    s_mov_b32 s38, 655360
    buffer_load_dwordx4 v185, s[20:23], s38 offen lds
    s_add_u32 m0, s33, 27648
    s_mov_b32 s38, 720896
    buffer_load_dwordx4 v185, s[20:23], s38 offen lds
    s_waitcnt vmcnt(28)
    ds_read_b64_tr_b16 a[100:101], v186 offset:30720
    ds_read_b64_tr_b16 a[102:103], v186 offset:30976
    ds_read_b64_tr_b16 a[108:109], v186 offset:30752
    ds_read_b64_tr_b16 a[110:111], v186 offset:31008
    s_waitcnt lgkmcnt(4)
    s_add_u32 m0, s33, 28672
    s_mov_b32 s38, 786432
    buffer_load_dwordx4 v185, s[20:23], s38 offen lds
    s_add_u32 m0, s33, 29696
    s_mov_b32 s38, 851968
    buffer_load_dwordx4 v185, s[20:23], s38 offen lds
    s_waitcnt vmcnt(28)
    ds_read_b64_tr_b16 a[116:117], v186 offset:0
    ds_read_b64_tr_b16 a[118:119], v186 offset:256
    ds_read_b64_tr_b16 a[124:125], v186 offset:32
    ds_read_b64_tr_b16 a[126:127], v186 offset:288
    s_waitcnt lgkmcnt(4)
    s_add_u32 m0, s33, 30720
    s_mov_b32 s38, 917504
    buffer_load_dwordx4 v185, s[20:23], s38 offen lds
    s_add_u32 m0, s33, 31744
    s_mov_b32 s38, 983040
    buffer_load_dwordx4 v185, s[20:23], s38 offen lds
    s_waitcnt vmcnt(28)
    ds_read_b64_tr_b16 a[132:133], v186 offset:2048
    ds_read_b64_tr_b16 a[134:135], v186 offset:2304
    ds_read_b64_tr_b16 a[140:141], v186 offset:2080
    ds_read_b64_tr_b16 a[142:143], v186 offset:2336
    s_waitcnt lgkmcnt(4)
    s_add_u32 m0, s33, 0
    s_mov_b32 s38, 1048576
    buffer_load_dwordx4 v185, s[20:23], s38 offen lds
    s_add_u32 m0, s33, 1024
    s_mov_b32 s38, 1114112
    buffer_load_dwordx4 v185, s[20:23], s38 offen lds
    s_waitcnt vmcnt(28)
    ds_read_b64_tr_b16 a[144:145], v186 offset:4096
    ds_read_b64_tr_b16 a[146:147], v186 offset:4352
    ds_read_b64_tr_b16 a[152:153], v186 offset:4128
    ds_read_b64_tr_b16 a[154:155], v186 offset:4384
    s_waitcnt lgkmcnt(4)
    s_add_u32 m0, s33, 2048
    s_mov_b32 s38, 1179648
    buffer_load_dwordx4 v185, s[20:23], s38 offen lds
    s_add_u32 m0, s33, 3072
    s_mov_b32 s38, 1245184
    buffer_load_dwordx4 v185, s[20:23], s38 offen lds
    s_waitcnt vmcnt(28)
    ds_read_b64_tr_b16 a[160:161], v186 offset:6144
    ds_read_b64_tr_b16 a[162:163], v186 offset:6400
    ds_read_b64_tr_b16 a[168:169], v186 offset:6176
    ds_read_b64_tr_b16 a[170:171], v186 offset:6432
    s_waitcnt lgkmcnt(4)
    s_add_u32 m0, s33, 4096
    s_mov_b32 s38, 1310720
    buffer_load_dwordx4 v185, s[20:23], s38 offen lds
    s_add_u32 m0, s33, 5120
    s_mov_b32 s38, 1376256
    buffer_load_dwordx4 v185, s[20:23], s38 offen lds
    s_waitcnt vmcnt(28)
    ds_read_b64_tr_b16 a[176:177], v186 offset:8192
    ds_read_b64_tr_b16 a[178:179], v186 offset:8448
    ds_read_b64_tr_b16 a[184:185], v186 offset:8224
    ds_read_b64_tr_b16 a[186:187], v186 offset:8480
    s_waitcnt lgkmcnt(4)
    s_add_u32 m0, s33, 6144
    s_mov_b32 s38, 1441792
    buffer_load_dwordx4 v185, s[20:23], s38 offen lds
    s_add_u32 m0, s33, 7168
    s_mov_b32 s38, 1507328
    buffer_load_dwordx4 v185, s[20:23], s38 offen lds
    s_waitcnt vmcnt(28)
    ds_read_b64_tr_b16 a[148:149], v186 offset:10240
    ds_read_b64_tr_b16 a[150:151], v186 offset:10496
    ds_read_b64_tr_b16 a[156:157], v186 offset:10272
    ds_read_b64_tr_b16 a[158:159], v186 offset:10528
    s_waitcnt lgkmcnt(4)
    s_add_u32 m0, s33, 8192
    s_mov_b32 s38, 1572864
    buffer_load_dwordx4 v185, s[20:23], s38 offen lds
    s_add_u32 m0, s33, 9216
    s_mov_b32 s38, 1638400
    buffer_load_dwordx4 v185, s[20:23], s38 offen lds
    s_waitcnt vmcnt(28)
    ds_read_b64_tr_b16 a[164:165], v186 offset:12288
    ds_read_b64_tr_b16 a[166:167], v186 offset:12544
    ds_read_b64_tr_b16 a[172:173], v186 offset:12320
    ds_read_b64_tr_b16 a[174:175], v186 offset:12576
    s_waitcnt lgkmcnt(4)
    s_add_u32 m0, s33, 10240
    s_mov_b32 s38, 1703936
    buffer_load_dwordx4 v185, s[20:23], s38 offen lds
    s_add_u32 m0, s33, 11264
    s_mov_b32 s38, 1769472
    buffer_load_dwordx4 v185, s[20:23], s38 offen lds
    s_waitcnt vmcnt(28)
    ds_read_b64_tr_b16 a[180:181], v186 offset:14336
    ds_read_b64_tr_b16 a[182:183], v186 offset:14592
    ds_read_b64_tr_b16 a[188:189], v186 offset:14368
    ds_read_b64_tr_b16 a[190:191], v186 offset:14624
    s_waitcnt lgkmcnt(4)
    s_add_u32 m0, s33, 12288
    s_mov_b32 s38, 1835008
    buffer_load_dwordx4 v185, s[20:23], s38 offen lds
    s_add_u32 m0, s33, 13312
    s_mov_b32 s38, 1900544
    buffer_load_dwordx4 v185, s[20:23], s38 offen lds
    s_waitcnt vmcnt(28)
    ds_read_b64_tr_b16 a[192:193], v187 offset:16384
    ds_read_b64_tr_b16 a[194:195], v187 offset:16512
    ds_read_b64_tr_b16 a[196:197], v187 offset:17408
    ds_read_b64_tr_b16 a[198:199], v187 offset:17536
    s_waitcnt lgkmcnt(4)
    s_add_u32 m0, s33, 14336
    s_mov_b32 s38, 1966080
    buffer_load_dwordx4 v185, s[20:23], s38 offen lds
    s_add_u32 m0, s33, 15360
    s_mov_b32 s38, 2031616
    buffer_load_dwordx4 v185, s[20:23], s38 offen lds
    s_waitcnt vmcnt(28)
    ds_read_b64_tr_b16 a[200:201], v187 offset:18432
    ds_read_b64_tr_b16 a[202:203], v187 offset:18560
    ds_read_b64_tr_b16 a[204:205], v187 offset:19456
    ds_read_b64_tr_b16 a[206:207], v187 offset:19584
    s_waitcnt vmcnt(26)
    s_cmp_lg_u32 s31, 0
    s_cbranch_scc1 rec_rdy_5
    v_mov_b32 v2, 0
    v_mov_b32 v3, 1
    s_mov_b64 exec, 1
    global_atomic_add v2, v3, s[92:93] offset:128 sc1
    s_mov_b64 exec, -1
rec_rdy_5:
    ds_read_b64_tr_b16 a[208:209], v187 offset:20480
    ds_read_b64_tr_b16 a[210:211], v187 offset:20608
    ds_read_b64_tr_b16 a[212:213], v187 offset:21504
    ds_read_b64_tr_b16 a[214:215], v187 offset:21632
    s_waitcnt vmcnt(24)
    ds_read_b64_tr_b16 a[216:217], v187 offset:22528
    ds_read_b64_tr_b16 a[218:219], v187 offset:22656
    ds_read_b64_tr_b16 a[220:221], v187 offset:23552
    ds_read_b64_tr_b16 a[222:223], v187 offset:23680
    s_waitcnt vmcnt(22)
    ds_read_b64_tr_b16 a[224:225], v187 offset:24576
    ds_read_b64_tr_b16 a[226:227], v187 offset:24704
    ds_read_b64_tr_b16 a[228:229], v187 offset:25600
    ds_read_b64_tr_b16 a[230:231], v187 offset:25728
    s_waitcnt vmcnt(20)
    ds_read_b64_tr_b16 a[232:233], v187 offset:26624
    ds_read_b64_tr_b16 a[234:235], v187 offset:26752
    ds_read_b64_tr_b16 a[236:237], v187 offset:27648
    ds_read_b64_tr_b16 a[238:239], v187 offset:27776
    s_waitcnt vmcnt(18)
    ds_read_b64_tr_b16 a[240:241], v187 offset:28672
    ds_read_b64_tr_b16 a[242:243], v187 offset:28800
    ds_read_b64_tr_b16 a[244:245], v187 offset:29696
    ds_read_b64_tr_b16 a[246:247], v187 offset:29824
    s_waitcnt vmcnt(16)
    ds_read_b64_tr_b16 a[248:249], v187 offset:30720
    ds_read_b64_tr_b16 a[250:251], v187 offset:30848
    ds_read_b64_tr_b16 a[252:253], v187 offset:31744
    ds_read_b64_tr_b16 a[254:255], v187 offset:31872
    s_waitcnt vmcnt(14)
    ds_read_b64_tr_b16 v[192:193], v187 offset:0
    ds_read_b64_tr_b16 v[194:195], v187 offset:128
    ds_read_b64_tr_b16 v[196:197], v187 offset:1024
    ds_read_b64_tr_b16 v[198:199], v187 offset:1152
    s_waitcnt vmcnt(12)
    ds_read_b64_tr_b16 v[200:201], v187 offset:2048
    ds_read_b64_tr_b16 v[202:203], v187 offset:2176
    ds_read_b64_tr_b16 v[204:205], v187 offset:3072
    ds_read_b64_tr_b16 v[206:207], v187 offset:3200
    s_waitcnt vmcnt(10)
    ds_read_b64_tr_b16 v[208:209], v187 offset:4096
    ds_read_b64_tr_b16 v[210:211], v187 offset:4224
    ds_read_b64_tr_b16 v[212:213], v187 offset:5120
    ds_read_b64_tr_b16 v[214:215], v187 offset:5248
    s_waitcnt vmcnt(8)
    ds_read_b64_tr_b16 v[216:217], v187 offset:6144
    ds_read_b64_tr_b16 v[218:219], v187 offset:6272
    ds_read_b64_tr_b16 v[220:221], v187 offset:7168
    ds_read_b64_tr_b16 v[222:223], v187 offset:7296
    s_waitcnt vmcnt(6)
    ds_read_b64_tr_b16 v[224:225], v187 offset:8192
    ds_read_b64_tr_b16 v[226:227], v187 offset:8320
    ds_read_b64_tr_b16 v[228:229], v187 offset:9216
    ds_read_b64_tr_b16 v[230:231], v187 offset:9344
    s_waitcnt vmcnt(4)
    ds_read_b64_tr_b16 v[232:233], v187 offset:10240
    ds_read_b64_tr_b16 v[234:235], v187 offset:10368
    ds_read_b64_tr_b16 v[236:237], v187 offset:11264
    ds_read_b64_tr_b16 v[238:239], v187 offset:11392
    s_waitcnt vmcnt(2)
    ds_read_b64_tr_b16 v[240:241], v187 offset:12288
    ds_read_b64_tr_b16 v[242:243], v187 offset:12416
    ds_read_b64_tr_b16 v[244:245], v187 offset:13312
    ds_read_b64_tr_b16 v[246:247], v187 offset:13440
    s_waitcnt vmcnt(0)
    ds_read_b64_tr_b16 v[248:249], v187 offset:14336
    ds_read_b64_tr_b16 v[250:251], v187 offset:14464
    ds_read_b64_tr_b16 v[252:253], v187 offset:15360
    ds_read_b64_tr_b16 v[254:255], v187 offset:15488
    s_waitcnt lgkmcnt(0)
    v_xor_b32 v137, 1024, v13
    v_xor_b32 v184, 2048, v13
    v_xor_b32 v185, 3072, v13
    v_xor_b32 v186, 4096, v13
    v_xor_b32 v187, 5120, v13
    v_xor_b32 v190, 6144, v13
    v_xor_b32 v191, 7168, v13
    v_max_u32 v36, 1, v36
    v_max_u32 v37, 1, v37
    v_max_u32 v38, 1, v38
    v_max_u32 v39, 1, v39
    v_max_u32 v40, 1, v40
    v_max_u32 v41, 1, v41
    v_max_u32 v42, 1, v42
    v_max_u32 v43, 1, v43
    v_max_u32 v44, 1, v44
    v_max_u32 v45, 1, v45
    v_max_u32 v46, 1, v46
    v_max_u32 v47, 1, v47
    v_max_u32 v48, 1, v48
    v_max_u32 v49, 1, v49
    v_max_u32 v50, 1, v50
    v_max_u32 v51, 1, v51
    v_mov_b32 v68, 0
    v_mov_b32 v69, 0
    v_mov_b32 v70, 0
    v_mov_b32 v71, 0
    v_mov_b32 v72, 0
    v_mov_b32 v73, 0
    v_mov_b32 v74, 0
    v_mov_b32 v75, 0
    v_mov_b32 v76, 0
    v_mov_b32 v77, 0
    v_mov_b32 v78, 0
    v_mov_b32 v79, 0
    v_mov_b32 v80, 0
    v_mov_b32 v81, 0
    v_mov_b32 v82, 0
    v_mov_b32 v83, 0
    v_mov_b32 v84, 0
    v_mov_b32 v85, 0
    v_mov_b32 v86, 0
    v_mov_b32 v87, 0
    v_mov_b32 v88, 0
    v_mov_b32 v89, 0
    v_mov_b32 v90, 0
    v_mov_b32 v91, 0
    s_mov_b32 s72, 0
    s_mov_b32 s73, 0
    s_mov_b32 s74, 0
    s_mov_b32 s75, 0
    s_mov_b32 s76, 0
    s_mov_b32 s77, 0
    s_mov_b32 s78, 0
    s_mov_b32 s79, 0
    s_mov_b32 s80, 0
    s_mov_b32 s81, 0
    s_mov_b32 s82, 0
    s_mov_b32 s83, 0
    s_mov_b32 s84, 0
    s_mov_b32 s85, 0
    s_mov_b32 s86, 0
    s_mov_b32 s87, 0
    v_mov_b32 v2, 0
    s_branch rec_ibq_8
rec_ibp_7:
    s_sleep 16
rec_ibq_8:
    global_load_dword v3, v2, s[92:93] offset:0 sc1
    s_add_u32 s41, s41, 1
    s_cmp_ge_u32 s41, 0x80000
    s_cbranch_scc1 rec_ib_6
    s_waitcnt vmcnt(0)
    v_readfirstlane_b32 s38, v3
    s_and_b32 s39, s38, 0xffff
    s_cmp_lt_u32 s39, 256
    s_cbranch_scc1 rec_ibp_7
rec_ib_6:
    s_cmp_ge_u32 s38, 4194304
    s_cselect_b32 s48, -1, 0
    s_xor_b32 s48, s48, 0xaaa
    s_and_b32 s33, s48, 1
    s_lshl_b32 s33, s33, 13
    s_add_u32 s33, s33, s49
    s_add_u32 s34, s33, 262144
    s_add_u32 s35, s33, 524288
    s_lshr_b32 s39, s28, 5
    v_subrev_u32 v2, s39, v1
    v_and_b32 v2, 3, v2
    v_mul_u32_u24 v2, 6, v2
    s_add_u32 s38, s28, 5
    v_add_u32 v2, s38, v2
    v_and_b32 v2, 31, v2
    v_lshlrev_b32 v2, 8, v2
    v_lshl_add_u32 v2, v1, 14, v2
    s_lshr_b32 s38, s28, 5
    s_lshl_b32 s38, s38, 4
    s_add_u32 s38, s38, s33
    s_add_u32 s38, s38, 163840
    v_add_u32 v132, s38, v2
    s_mov_b64 vcc, 15
    v_mov_b32 v4, 2130706432
    v_cndmask_b32 v132, v4, v132, vcc
    v_add_u32 v133, 128, v132
    s_cmp_eq_u32 s31, 1
    s_cselect_b64 vcc, 15, 0
    v_mov_b32 v4, 2130706432
    v_cndmask_b32 v133, v4, v133, vcc
    s_lshr_b32 s55, s28, 5
    s_lshl_b32 s55, s55, 14
    s_and_b32 s40, s28, 31
    s_lshl_b32 s40, s40, 8
    s_add_u32 s55, s55, s40
    s_add_u32 s55, s55, s33
    s_add_u32 s55, s55, 163840
    s_cmp_eq_u32 s31, 3
    s_cselect_b32 s88, s35, 88080384
    s_barrier
    s_load_dwordx4 s[72:75], s[90:91], s97 offset:16 glc
    s_waitcnt lgkmcnt(0)
    s_xor_b32 s73, s73, s72
    s_xor_b32 s74, s74, s72
    s_xor_b32 s75, s75, s72
    s_or_b32 s73, s73, s74
    s_or_b32 s96, s73, s75
    s_mov_b32 s72, 0
    s_mov_b32 s73, 0
    s_mov_b32 s74, 0
    s_mov_b32 s75, 0
    s_cmp_gt_u32 s94, 0
    s_cbranch_scc0 rec_kv_9
rec_kvd_10:
    s_add_u32 m0, s51, s3
    s_nop 0
    buffer_load_dwordx4 v30, s[4:7], s37 offen sc1 lds
    s_waitcnt vmcnt(0)
    s_branch rec_entry_11
rec_loop_12:
    buffer_load_dwordx4 v[36:39], v7, s[4:7], s33 offen offset:0 sc1
    v_mov_b32 v68, 0
    v_mov_b32 v69, 0
    v_mov_b32 v70, 0
    v_mov_b32 v71, 0
    v_mov_b32 v72, 0
    v_mov_b32 v73, 0
    buffer_load_dwordx4 v[40:43], v7, s[4:7], s33 offen offset:1024 sc1
    v_mov_b32 v74, 0
    v_mov_b32 v75, 0
    v_mov_b32 v76, 0
    v_mov_b32 v77, 0
    v_mov_b32 v78, 0
    v_mov_b32 v79, 0
    buffer_load_dwordx4 v[44:47], v12, s[4:7], s33 offen offset:0 sc1
    v_mov_b32 v80, 0
    v_mov_b32 v81, 0
    v_mov_b32 v82, 0
    v_mov_b32 v83, 0
    v_mov_b32 v84, 0
    v_mov_b32 v85, 0
    buffer_load_dwordx4 v[48:51], v12, s[4:7], s33 offen offset:1024 sc1
    v_mov_b32 v86, 0
    v_mov_b32 v87, 0
    v_mov_b32 v88, 0
    v_mov_b32 v89, 0
    v_mov_b32 v90, 0
    v_mov_b32 v91, 0
rec_entry_11:
    s_waitcnt vmcnt(3)
    buffer_store_dwordx4 v[8:11], v94, s[4:7], s36 offen sc1
    v_smfmac_f32_16x16x64_bf16 v[68:71], v[36:39], a[0:7], v5
    v_min3_u32 v31, v36, v37, v38
    v_min_u32 v31, v31, v39
    v_smfmac_f32_16x16x64_bf16 v[72:75], v[36:39], a[8:15], v5
    v_cmp_eq_u32 s[56:57], 0, v31
    v_smfmac_f32_16x16x64_bf16 v[76:79], v[36:39], a[16:23], v5
    v_smfmac_f32_16x16x64_bf16 v[80:83], v[36:39], a[24:31], v5
    s_waitcnt vmcnt(3)
    v_smfmac_f32_16x16x64_bf16 v[68:71], v[40:43], a[48:55], v5
    v_min3_u32 v31, v40, v41, v42
    v_min_u32 v31, v31, v43
    v_smfmac_f32_16x16x64_bf16 v[72:75], v[40:43], a[56:63], v5
    v_cmp_eq_u32 s[58:59], 0, v31
    s_mov_b64 vcc, s[56:57]
    v_smfmac_f32_16x16x64_bf16 v[76:79], v[40:43], a[64:71], v5
    v_smfmac_f32_16x16x64_bf16 v[80:83], v[40:43], a[72:79], v5
    s_waitcnt vmcnt(2)
    v_smfmac_f32_16x16x64_bf16 v[68:71], v[44:47], a[96:103], v5
    v_min3_u32 v31, v44, v45, v46
    v_min_u32 v31, v31, v47
    v_smfmac_f32_16x16x64_bf16 v[72:75], v[44:47], a[104:111], v5
    v_cmp_eq_u32 s[60:61], 0, v31
    s_or_b64 vcc, vcc, s[58:59]
    v_smfmac_f32_16x16x64_bf16 v[76:79], v[44:47], a[112:119], v5
    v_smfmac_f32_16x16x64_bf16 v[80:83], v[44:47], a[120:127], v5
    s_waitcnt vmcnt(1)
    v_smfmac_f32_16x16x64_bf16 v[68:71], v[48:51], a[144:151], v5
    v_min3_u32 v31, v48, v49, v50
    v_min_u32 v31, v31, v51
    v_smfmac_f32_16x16x64_bf16 v[72:75], v[48:51], a[152:159], v5
    v_cmp_eq_u32 s[62:63], 0, v31
    s_or_b64 vcc, vcc, s[60:61]
    v_smfmac_f32_16x16x64_bf16 v[76:79], v[48:51], a[160:167], v5
    v_smfmac_f32_16x16x64_bf16 v[80:83], v[48:51], a[168:175], v5
    s_or_b64 vcc, vcc, s[62:63]
    s_cbranch_scc1 rec_gafix_15
rec_gaok_14:
    v_add_u32 v2, s51, v16
    s_nop 0
    v_permlane16_swap_b32 v68, v72
    v_permlane16_swap_b32 v69, v73
    v_permlane16_swap_b32 v70, v74
    v_permlane16_swap_b32 v71, v75
    v_pk_add_f32 v[68:69], v[68:69], v[72:73]
    v_pk_add_f32 v[70:71], v[70:71], v[74:75]
    ds_write2_b32 v14, v68, v69 offset0:0 offset1:40
    ds_write2_b32 v14, v70, v71 offset0:80 offset1:120
    v_permlane16_swap_b32 v76, v80
    v_permlane16_swap_b32 v77, v81
    v_permlane16_swap_b32 v78, v82
    v_permlane16_swap_b32 v79, v83
    v_pk_add_f32 v[76:77], v[76:77], v[80:81]
    v_pk_add_f32 v[78:79], v[78:79], v[82:83]
    ds_write2_b32 v15, v76, v77 offset0:0 offset1:40
    ds_write2_b32 v15, v78, v79 offset0:80 offset1:120
    s_cmp_lg_u32 s31, 0
    s_cbranch_scc1 rec_w1_17
    s_waitcnt lgkmcnt(0)
    s_barrier
    ds_read_b128 v[100:103], v18 offset:0
    ds_read_b128 v[104:107], v18 offset:32
    ds_read_b128 v[108:111], v18 offset:2560
    ds_read_b128 v[112:115], v18 offset:2592
    ds_read_b128 v[116:119], v18 offset:5120
    ds_read_b128 v[120:123], v18 offset:5152
    ds_read_b128 v[124:127], v18 offset:7680
    ds_read_b128 v[128:131], v18 offset:7712
    ds_read_b128 v[60:63], v2 offset:0
    ds_read_b128 v[64:67], v2 offset:1024
    ds_read_b128 v[52:55], v2 offset:2048
    ds_read_b128 v[56:59], v2 offset:3072
    v_smfmac_f32_16x16x64_bf16 v[84:87], v[36:39], a[32:39], v5
    v_smfmac_f32_16x16x64_bf16 v[88:91], v[36:39], a[40:47], v5
    v_smfmac_f32_16x16x64_bf16 v[84:87], v[40:43], a[80:87], v5
    v_smfmac_f32_16x16x64_bf16 v[88:91], v[40:43], a[88:95], v5
    v_smfmac_f32_16x16x64_bf16 v[84:87], v[44:47], a[128:135], v5
    v_smfmac_f32_16x16x64_bf16 v[88:91], v[44:47], a[136:143], v5
    v_smfmac_f32_16x16x64_bf16 v[84:87], v[48:51], a[176:183], v5
    v_smfmac_f32_16x16x64_bf16 v[88:91], v[48:51], a[184:191], v5
    s_waitcnt lgkmcnt(2)
    v_pk_add_f32 v[100:101], v[100:101], v[108:109]
    v_pk_add_f32 v[102:103], v[102:103], v[110:111]
    v_pk_add_f32 v[104:105], v[104:105], v[112:113]
    v_pk_add_f32 v[106:107], v[106:107], v[114:115]
    v_pk_add_f32 v[116:117], v[116:117], v[124:125]
    v_pk_add_f32 v[118:119], v[118:119], v[126:127]
    v_pk_add_f32 v[120:121], v[120:121], v[128:129]
    v_pk_add_f32 v[122:123], v[122:123], v[130:131]
    v_pk_add_f32 v[100:101], v[100:101], v[116:117]
    v_pk_add_f32 v[102:103], v[102:103], v[118:119]
    v_pk_add_f32 v[104:105], v[104:105], v[120:121]
    v_pk_add_f32 v[106:107], v[106:107], v[122:123]
    v_cvt_pk_bf16_f32 v96, v100, v101
    v_cvt_pk_bf16_f32 v97, v102, v103
    v_cvt_pk_bf16_f32 v98, v104, v105
    v_cvt_pk_bf16_f32 v99, v106, v107
    s_nop 1
    v_mfma_f32_16x16x32_bf16 v[68:71], v[60:63], v[96:99], 0
    v_mfma_f32_16x16x32_bf16 v[72:75], v[64:67], v[96:99], 0
    v_mfma_f32_16x16x32_bf16 v[76:79], v[96:99], v[96:99], 0
    s_cmp_lg_u32 s96, 0
    v_permlane16_swap_b32 v84, v88
    v_permlane16_swap_b32 v85, v89
    v_permlane16_swap_b32 v86, v90
    v_permlane16_swap_b32 v87, v91
    v_pk_add_f32 v[84:85], v[84:85], v[88:89]
    v_pk_add_f32 v[86:87], v[86:87], v[90:91]
    s_cbranch_scc1 rec_slow_18
    s_mov_b64 exec, s[42:43]
    buffer_store_dwordx4 v[68:71], v19, s[4:7], s36 offen
    buffer_store_dwordx4 v[72:75], v19, s[4:7], s36 offen offset:128
    s_mov_b64 exec, s[46:47]
    buffer_store_dwordx4 v[76:79], v20, s[4:7], s36 offen offset:1024
    s_mov_b64 exec, -1
rec_slowr_19:
    ds_write_b128 v17, v[84:87]
    ds_write_b128 v16, v[96:99] offset:15360
    s_waitcnt lgkmcnt(0)
    s_barrier
    ds_read2st64_b32 v[100:101], v25 offset0:0 offset1:2
    ds_read2st64_b32 v[102:103], v26 offset0:0 offset1:2
    ds_read2st64_b32 v[104:105], v25 offset0:4 offset1:6
    ds_read2st64_b32 v[106:107], v26 offset0:4 offset1:6
    ds_read2st64_b32 v[108:109], v25 offset0:8 offset1:10
    ds_read2st64_b32 v[110:111], v26 offset0:8 offset1:10
    ds_read2st64_b32 v[112:113], v25 offset0:12 offset1:14
    ds_read2st64_b32 v[114:115], v26 offset0:12 offset1:14
    s_sleep 1
    buffer_load_dwordx4 v[176:179], v21, s[4:7], s36 offen offset:1024 sc1
    buffer_load_dwordx4 v[164:167], v22, s[4:7], s36 offen sc1
    buffer_load_dwordx4 v[168:171], v23, s[4:7], s36 offen sc1
    buffer_load_dwordx4 v[172:175], v24, s[4:7], s36 offen sc1
    v_mov_b32_dpp v68, v72 row_ror:8 row_mask:0xf bank_mask:0xc
    v_mov_b32_dpp v69, v73 row_ror:8 row_mask:0xf bank_mask:0xc
    v_mov_b32_dpp v70, v74 row_ror:8 row_mask:0xf bank_mask:0xc
    v_mov_b32_dpp v71, v75 row_ror:8 row_mask:0xf bank_mask:0xc
    s_waitcnt lgkmcnt(0)
    v_pk_add_f32 v[100:101], v[100:101], v[104:105]
    v_pk_add_f32 v[102:103], v[102:103], v[106:107]
    v_pk_add_f32 v[108:109], v[108:109], v[112:113]
    v_pk_add_f32 v[110:111], v[110:111], v[114:115]
    v_pk_add_f32 v[100:101], v[100:101], v[108:109]
    v_pk_add_f32 v[102:103], v[102:103], v[110:111]
    v_cvt_pk_bf16_f32 v138, v100, v101
    v_cvt_pk_bf16_f32 v140, v102, v103
    s_cmp_eq_u32 s32, 63
    s_cbranch_scc1 rec_b2_16
rec_gbw_22:
    s_waitcnt vmcnt(3)
    v_max3_u32 v31, v176, v177, v178
    v_max_u32 v31, v31, v179
    v_permlane32_swap_b32 v176, v178
    v_permlane32_swap_b32 v177, v179
    v_pk_add_f32 v[124:125], v[176:177], v[178:179]
    s_waitcnt vmcnt(2)
    v_pk_add_f32 v[120:121], v[68:69], v[164:165]
    v_pk_add_f32 v[122:123], v[70:71], v[166:167]
    v_permlane16_swap_b32 v124, v125
    s_waitcnt vmcnt(1)
    v_pk_add_f32 v[120:121], v[120:121], v[168:169]
    v_pk_add_f32 v[122:123], v[122:123], v[170:171]
    v_add_f32 v124, v124, v125
    s_waitcnt vmcnt(0)
    v_pk_add_f32 v[120:121], v[120:121], v[172:173]
    v_pk_add_f32 v[122:123], v[122:123], v[174:175]
    v_maximum3_f32 v135, v120, v121, v124
    v_maximum3_f32 v135, v135, v122, v123
    v_cmp_u_f32 vcc, v135, v135
    s_nop 0
    v_max_f32_dpp v135, v135, v135 row_ror:8 row_mask:0xf bank_mask:0xf
    v_mov_b32 v136, v135
    s_cbranch_vccnz rec_gbr_20
rec_gbo_21:
    buffer_store_dword v134, v132, s[4:7], 0 offen sc1
    v_permlane16_swap_b32 v135, v136
    v_max_f32 v135, v135, v136
    v_mov_b32 v136, v135
    s_nop 1
    v_permlane32_swap_b32 v135, v136
    v_max_f32 v135, v135, v136
    v_mul_f32 v135, s50, v135
    v_fma_f32 v124, v124, s50, -v135
    v_fma_f32 v120, v120, s50, -v135
    v_fma_f32 v121, v121, s50, -v135
    v_fma_f32 v122, v122, s50, -v135
    v_fma_f32 v123, v123, s50, -v135
    v_exp_f32 v124, v124
    v_exp_f32 v120, v120
    v_exp_f32 v121, v121
    v_exp_f32 v122, v122
    v_exp_f32 v123, v123
    v_mov_b32_dpp v125, v124 row_ror:8 row_mask:0xf bank_mask:0xf
    v_cvt_pk_bf16_f32 v156, v120, v121
    v_cvt_pk_bf16_f32 v157, v122, v123
    v_cvt_pk_bf16_f32 v160, v124, v125
    v_mov_b32_dpp v158, v156 row_ror:8 row_mask:0xf bank_mask:0xf
    v_mov_b32_dpp v159, v157 row_ror:8 row_mask:0xf bank_mask:0xf
    v_mfma_f32_16x16x32_bf16 v[116:119], v[32:35], v[160:163], 0
    s_nop 0
    v_mfma_f32_16x16x32_bf16 v[116:119], v[32:35], v[156:159], v[116:119]
    v_mfma_f32_16x16x32_bf16 v[108:111], v[52:55], v[156:159], 0
    v_mfma_f32_16x16x32_bf16 v[108:111], v[138:141], v[160:163], v[108:111]
    v_mfma_f32_16x16x32_bf16 v[112:115], v[56:59], v[156:159], 0
    v_mfma_f32_16x16x32_bf16 v[112:115], v[140:143], v[160:163], v[112:115]
    s_nop 3
    v_rcp_f32 v135, v116
    s_nop 0
    v_mul_f32 v108, v108, v135
    v_mul_f32 v109, v109, v135
    v_mul_f32 v110, v110, v135
    v_mul_f32 v111, v111, v135
    v_mul_f32 v112, v112, v135
    v_mul_f32 v113, v113, v135
    v_mul_f32 v114, v114, v135
    v_mul_f32 v115, v115, v135
    v_cvt_pk_bf16_f32 v108, v108, v109
    v_cvt_pk_bf16_f32 v109, v110, v111
    v_cvt_pk_bf16_f32 v110, v112, v113
    v_cvt_pk_bf16_f32 v111, v114, v115
    v_max_u32 v108, 1, v108
    v_max_u32 v109, 1, v109
    v_max_u32 v110, 1, v110
    v_max_u32 v111, 1, v111
    s_mov_b64 exec, s[42:43]
    buffer_store_dwordx4 v[108:111], v27, s[4:7], s33 offen sc1
    s_mov_b64 exec, -1
    s_barrier
rec_cs_23:
    buffer_load_dwordx4 v[36:39], v13, s[4:7], s33 offen sc1
    v_mov_b32 v68, 0
    buffer_load_dwordx4 v[40:43], v137, s[4:7], s33 offen sc1
    v_mov_b32 v69, 0
    buffer_load_dwordx4 v[44:47], v184, s[4:7], s33 offen sc1
    v_mov_b32 v70, 0
    buffer_load_dwordx4 v[48:51], v185, s[4:7], s33 offen sc1
    v_mov_b32 v71, 0
    buffer_load_dwordx4 v[52:55], v186, s[4:7], s33 offen sc1
    v_mov_b32 v72, 0
    buffer_load_dwordx4 v[56:59], v187, s[4:7], s33 offen sc1
    v_mov_b32 v73, 0
    buffer_load_dwordx4 v[60:63], v190, s[4:7], s33 offen sc1
    v_mov_b32 v74, 0
    buffer_load_dwordx4 v[64:67], v191, s[4:7], s33 offen sc1
    v_mov_b32 v75, 0
    s_waitcnt vmcnt(7)
    buffer_store_dwordx4 v[180:183], v93, s[4:7], s88 offen sc1
    buffer_store_dwordx4 v[144:147], v95, s[4:7], s35 offen sc1
    buffer_load_dword v3, v92, s[4:7], s36 offen sc1
    s_add_u32 s38, s32, 1
    s_cmp_gt_u32 s94, s38
    s_cbranch_scc0 rec_kv_26
rec_kvd_27:
    s_xor_b32 s51, s51, 4096
    s_add_u32 m0, s51, s3
    s_add_u32 s37, s37, 262144
    buffer_load_dwordx4 v30, s[4:7], s37 offen sc1 lds
    v_smfmac_f32_16x16x64_bf16 v[68:71], v[36:39], a[192:199], v5
    v_min3_u32 v31, v36, v37, v38
    v_min_u32 v31, v31, v39
    v_smfmac_f32_16x16x64_bf16 v[72:75], v[36:39], a[200:207], v5
    v_cmp_eq_u32 s[56:57], 0, v31
    s_waitcnt vmcnt(10)
    v_smfmac_f32_16x16x64_bf16 v[68:71], v[40:43], a[208:215], v5
    v_min3_u32 v31, v40, v41, v42
    v_min_u32 v31, v31, v43
    v_smfmac_f32_16x16x64_bf16 v[72:75], v[40:43], a[216:223], v5
    v_cmp_eq_u32 s[58:59], 0, v31
    s_mov_b64 vcc, s[56:57]
    s_waitcnt vmcnt(9)
    v_smfmac_f32_16x16x64_bf16 v[68:71], v[44:47], a[224:231], v5
    v_min3_u32 v31, v44, v45, v46
    v_min_u32 v31, v31, v47
    v_smfmac_f32_16x16x64_bf16 v[72:75], v[44:47], a[232:239], v5
    v_cmp_eq_u32 s[60:61], 0, v31
    s_or_b64 vcc, vcc, s[58:59]
    s_waitcnt vmcnt(8)
    v_smfmac_f32_16x16x64_bf16 v[68:71], v[48:51], a[240:247], v5
    v_min3_u32 v31, v48, v49, v50
    v_min_u32 v31, v31, v51
    v_smfmac_f32_16x16x64_bf16 v[72:75], v[48:51], a[248:255], v5
    v_cmp_eq_u32 s[62:63], 0, v31
    s_or_b64 vcc, vcc, s[60:61]
    s_waitcnt vmcnt(7)
    v_smfmac_f32_16x16x64_bf16 v[68:71], v[52:55], v[192:199], v5
    v_min3_u32 v31, v52, v53, v54
    v_min_u32 v31, v31, v55
    v_smfmac_f32_16x16x64_bf16 v[72:75], v[52:55], v[200:207], v5
    v_cmp_eq_u32 s[64:65], 0, v31
    s_or_b64 vcc, vcc, s[62:63]
    s_waitcnt vmcnt(6)
    v_smfmac_f32_16x16x64_bf16 v[68:71], v[56:59], v[208:215], v5
    v_min3_u32 v31, v56, v57, v58
    v_min_u32 v31, v31, v59
    v_smfmac_f32_16x16x64_bf16 v[72:75], v[56:59], v[216:223], v5
    v_cmp_eq_u32 s[66:67], 0, v31
    s_or_b64 vcc, vcc, s[64:65]
    s_waitcnt vmcnt(5)
    v_smfmac_f32_16x16x64_bf16 v[68:71], v[60:63], v[224:231], v5
    v_min3_u32 v31, v60, v61, v62
    v_min_u32 v31, v31, v63
    v_smfmac_f32_16x16x64_bf16 v[72:75], v[60:63], v[232:239], v5
    v_cmp_eq_u32 s[68:69], 0, v31
    s_or_b64 vcc, vcc, s[66:67]
    s_waitcnt vmcnt(4)
    v_smfmac_f32_16x16x64_bf16 v[68:71], v[64:67], v[240:247], v5
    v_min3_u32 v31, v64, v65, v66
    v_min_u32 v31, v31, v67
    v_smfmac_f32_16x16x64_bf16 v[72:75], v[64:67], v[248:255], v5
    v_cmp_eq_u32 s[70:71], 0, v31
    s_or_b64 vcc, vcc, s[68:69]
    s_or_b64 vcc, vcc, s[70:71]
    s_cbranch_scc1 rec_gcfix_25
rec_gcok_24:
    s_add_u32 s32, s32, 1
    s_mov_b32 s33, s34
    s_mov_b32 s34, s35
    s_add_u32 s38, s32, 2
    s_lshr_b32 s39, s38, 3
    s_lshr_b32 s39, s48, s39
    v_cndmask_b32 v68, v68, v72, s[44:45]
    v_cndmask_b32 v69, v69, v73, s[44:45]
    v_cndmask_b32 v70, v70, v74, s[44:45]
    v_cndmask_b32 v71, v71, v75, s[44:45]
    s_nop 0
    v_permlane32_swap_b32 v68, v70
    v_permlane32_swap_b32 v69, v71
    v_pk_add_f32 v[68:69], v[68:69], v[70:71]
    s_nop 1
    v_permlane16_swap_b32 v68, v69
    v_add_f32 v68, v68, v69
    ds_write_b32 v28, v68
    s_and_b32 s35, s39, 1
    s_lshl_b32 s35, s35, 13
    s_lshl_b32 s40, s38, 18
    s_add_u32 s35, s35, s40
    s_add_u32 s35, s35, s49
    s_add_u32 s36, s36, 262144
    s_add_u32 s88, s88, 65536
    s_cmp_eq_u32 s31, 3
    s_cselect_b32 s88, s35, s88
    s_cmp_lg_u32 s31, 0
    s_cbranch_scc1 rec_b4_28
    s_waitcnt lgkmcnt(0)
    s_barrier
    ds_read_b64 v[100:101], v29 offset:0
    ds_read_b64 v[102:103], v29 offset:256
    ds_read_b64 v[104:105], v29 offset:512
    ds_read_b64 v[106:107], v29 offset:768
    v_add_u32 v134, 2, v134
    s_waitcnt lgkmcnt(0)
    v_pk_add_f32 v[100:101], v[100:101], v[102:103]
    v_pk_add_f32 v[104:105], v[104:105], v[106:107]
    v_pk_add_f32 v[100:101], v[100:101], v[104:105]
    v_cvt_pk_bf16_f32 v100, v100, v101
    v_max_u32 v100, 1, v100
    s_nop 1
    v_mov_b32_dpp v101, v100 quad_perm:[1,1,1,1] row_mask:0xf bank_mask:0xf
    v_mov_b32_dpp v102, v100 quad_perm:[2,2,2,2] row_mask:0xf bank_mask:0xf
    v_mov_b32_dpp v103, v100 quad_perm:[3,3,3,3] row_mask:0xf bank_mask:0xf
    s_mov_b64 exec, 0x11111111
    buffer_store_dwordx4 v[100:103], v6, s[4:7], s33 offen sc1
    s_mov_b64 exec, -1
    s_barrier
    s_branch rec_loop_12
rec_b4_28:
    s_waitcnt vmcnt(3) lgkmcnt(0)
    s_barrier
    buffer_store_dword v134, v133, s[4:7], 0 offen sc1
    v_add_u32 v189, 1, v189
    buffer_store_dword v189, v188, s[4:7], 0 offen sc1
    v_add_u32 v134, 2, v134
    s_cmp_lg_u32 s31, 3
    s_cbranch_scc1 rec_b4b_29
    s_add_u32 s40, s55, 128
rec_tk_30:
    s_load_dwordx16 s[72:87], s[90:91], s40 glc
    s_add_u32 s41, s41, 1
    s_cmp_ge_u32 s41, 0x80000
    s_cbranch_scc1 rec_tkd_31
    s_sleep 1
    s_min_u32 s38, s72, s76
    s_min_u32 s39, s80, s84
    s_min_u32 s38, s38, s39
    s_cmp_lt_u32 s38, s54
    s_cbranch_scc1 rec_tk_30
rec_tkd_31:
    s_add_u32 s54, s54, 1
rec_b4b_29:
    s_barrier
    s_branch rec_loop_12
rec_kv_9:
    s_load_dword s94, s[90:91], s95 glc
    s_add_u32 s41, s41, 1
    s_cmp_ge_u32 s41, 0x80000
    s_cbranch_scc1 rec_kvd_10
    s_waitcnt lgkmcnt(0)
    s_cmp_gt_u32 s94, 0
    s_cbranch_scc1 rec_kvd_10
    s_sleep 2
    s_branch rec_kv_9
rec_gafix_15:
    s_cmp_eq_u64 s[56:57], 0
    s_cbranch_scc1 rec_gask_32
    buffer_load_dwordx4 v[100:103], v7, s[4:7], s33 offen offset:0 sc1
rec_gask_32:
    s_cmp_eq_u64 s[58:59], 0
    s_cbranch_scc1 rec_gask_33
    buffer_load_dwordx4 v[104:107], v7, s[4:7], s33 offen offset:1024 sc1
rec_gask_33:
    s_cmp_eq_u64 s[60:61], 0
    s_cbranch_scc1 rec_gask_34
    buffer_load_dwordx4 v[108:111], v12, s[4:7], s33 offen offset:0 sc1
rec_gask_34:
    s_cmp_eq_u64 s[62:63], 0
    s_cbranch_scc1 rec_gask_35
    buffer_load_dwordx4 v[112:115], v12, s[4:7], s33 offen offset:1024 sc1
rec_gask_35:
rec_galp_36:
    s_add_u32 s41, s41, 1
    s_cmp_ge_u32 s41, 0x80000
    s_cbranch_scc1 rec_gaok_14
    s_mov_b64 vcc, 0
    s_waitcnt vmcnt(0)
    s_cmp_eq_u64 s[56:57], 0
    s_cbranch_scc1 rec_gask_37
    v_min3_u32 v31, v100, v101, v102
    v_min_u32 v31, v31, v103
    v_cmp_eq_u32 s[56:57], 0, v31
    v_xor_b32 v36, v36, v100
    v_xor_b32 v37, v37, v101
    v_xor_b32 v38, v38, v102
    v_xor_b32 v39, v39, v103
    s_nop 1
    v_smfmac_f32_16x16x64_bf16 v[68:71], v[36:39], a[0:7], v5
    v_smfmac_f32_16x16x64_bf16 v[72:75], v[36:39], a[8:15], v5
    v_smfmac_f32_16x16x64_bf16 v[76:79], v[36:39], a[16:23], v5
    v_smfmac_f32_16x16x64_bf16 v[80:83], v[36:39], a[24:31], v5
    v_mov_b32 v36, v100
    v_mov_b32 v37, v101
    v_mov_b32 v38, v102
    v_mov_b32 v39, v103
    s_or_b64 vcc, vcc, s[56:57]
    s_cmp_eq_u64 s[56:57], 0
    s_cbranch_scc1 rec_gask_37
    buffer_load_dwordx4 v[100:103], v7, s[4:7], s33 offen offset:0 sc1
rec_gask_37:
    s_cmp_eq_u64 s[58:59], 0
    s_cbranch_scc1 rec_gask_38
    v_min3_u32 v31, v104, v105, v106
    v_min_u32 v31, v31, v107
    v_cmp_eq_u32 s[58:59], 0, v31
    v_xor_b32 v40, v40, v104
    v_xor_b32 v41, v41, v105
    v_xor_b32 v42, v42, v106
    v_xor_b32 v43, v43, v107
    s_nop 1
    v_smfmac_f32_16x16x64_bf16 v[68:71], v[40:43], a[48:55], v5
    v_smfmac_f32_16x16x64_bf16 v[72:75], v[40:43], a[56:63], v5
    v_smfmac_f32_16x16x64_bf16 v[76:79], v[40:43], a[64:71], v5
    v_smfmac_f32_16x16x64_bf16 v[80:83], v[40:43], a[72:79], v5
    v_mov_b32 v40, v104
    v_mov_b32 v41, v105
    v_mov_b32 v42, v106
    v_mov_b32 v43, v107
    s_or_b64 vcc, vcc, s[58:59]
    s_cmp_eq_u64 s[58:59], 0
    s_cbranch_scc1 rec_gask_38
    buffer_load_dwordx4 v[104:107], v7, s[4:7], s33 offen offset:1024 sc1
rec_gask_38:
    s_cmp_eq_u64 s[60:61], 0
    s_cbranch_scc1 rec_gask_39
    v_min3_u32 v31, v108, v109, v110
    v_min_u32 v31, v31, v111
    v_cmp_eq_u32 s[60:61], 0, v31
    v_xor_b32 v44, v44, v108
    v_xor_b32 v45, v45, v109
    v_xor_b32 v46, v46, v110
    v_xor_b32 v47, v47, v111
    s_nop 1
    v_smfmac_f32_16x16x64_bf16 v[68:71], v[44:47], a[96:103], v5
    v_smfmac_f32_16x16x64_bf16 v[72:75], v[44:47], a[104:111], v5
    v_smfmac_f32_16x16x64_bf16 v[76:79], v[44:47], a[112:119], v5
    v_smfmac_f32_16x16x64_bf16 v[80:83], v[44:47], a[120:127], v5
    v_mov_b32 v44, v108
    v_mov_b32 v45, v109
    v_mov_b32 v46, v110
    v_mov_b32 v47, v111
    s_or_b64 vcc, vcc, s[60:61]
    s_cmp_eq_u64 s[60:61], 0
    s_cbranch_scc1 rec_gask_39
    buffer_load_dwordx4 v[108:111], v12, s[4:7], s33 offen offset:0 sc1
rec_gask_39:
    s_cmp_eq_u64 s[62:63], 0
    s_cbranch_scc1 rec_gask_40
    v_min3_u32 v31, v112, v113, v114
    v_min_u32 v31, v31, v115
    v_cmp_eq_u32 s[62:63], 0, v31
    v_xor_b32 v48, v48, v112
    v_xor_b32 v49, v49, v113
    v_xor_b32 v50, v50, v114
    v_xor_b32 v51, v51, v115
    s_nop 1
    v_smfmac_f32_16x16x64_bf16 v[68:71], v[48:51], a[144:151], v5
    v_smfmac_f32_16x16x64_bf16 v[72:75], v[48:51], a[152:159], v5
    v_smfmac_f32_16x16x64_bf16 v[76:79], v[48:51], a[160:167], v5
    v_smfmac_f32_16x16x64_bf16 v[80:83], v[48:51], a[168:175], v5
    v_mov_b32 v48, v112
    v_mov_b32 v49, v113
    v_mov_b32 v50, v114
    v_mov_b32 v51, v115
    s_or_b64 vcc, vcc, s[62:63]
    s_cmp_eq_u64 s[62:63], 0
    s_cbranch_scc1 rec_gask_40
    buffer_load_dwordx4 v[112:115], v12, s[4:7], s33 offen offset:1024 sc1
rec_gask_40:
    s_cmp_eq_u64 vcc, 0
    s_cbranch_scc1 rec_gaok_14
    s_branch rec_galp_36
rec_slow_18:
    s_mov_b64 exec, s[42:43]
    buffer_store_dwordx4 v[68:71], v19, s[4:7], s36 offen sc1
    buffer_store_dwordx4 v[72:75], v19, s[4:7], s36 offen offset:128 sc1
    s_mov_b64 exec, s[46:47]
    buffer_store_dwordx4 v[76:79], v20, s[4:7], s36 offen offset:1024 sc1
    s_mov_b64 exec, -1
    s_branch rec_slowr_19
rec_gbr_20:
    v_max3_u32 v31, v31, v164, v165
    v_max3_u32 v31, v31, v166, v167
    v_max3_u32 v31, v31, v168, v169
    v_max3_u32 v31, v31, v170, v171
    v_max3_u32 v31, v31, v172, v173
    v_max3_u32 v31, v31, v174, v175
    buffer_load_dwordx4 v[176:179], v21, s[4:7], s36 offen offset:1024 sc1
    buffer_load_dwordx4 v[164:167], v22, s[4:7], s36 offen sc1
    buffer_load_dwordx4 v[168:171], v23, s[4:7], s36 offen sc1
    buffer_load_dwordx4 v[172:175], v24, s[4:7], s36 offen sc1
    v_cmp_eq_u32 vcc, -1, v31
    s_add_u32 s41, s41, 1
    s_cmp_ge_u32 s41, 0x80000
    s_cbranch_scc1 rec_gbo_21
    s_cbranch_vccnz rec_gbw_22
    s_waitcnt vmcnt(0)
    s_branch rec_gbo_21
rec_w1_17:
    s_waitcnt lgkmcnt(0)
    s_barrier
    v_smfmac_f32_16x16x64_bf16 v[84:87], v[36:39], a[32:39], v5
    v_smfmac_f32_16x16x64_bf16 v[88:91], v[36:39], a[40:47], v5
    v_smfmac_f32_16x16x64_bf16 v[84:87], v[40:43], a[80:87], v5
    v_smfmac_f32_16x16x64_bf16 v[88:91], v[40:43], a[88:95], v5
    v_smfmac_f32_16x16x64_bf16 v[84:87], v[44:47], a[128:135], v5
    v_smfmac_f32_16x16x64_bf16 v[88:91], v[44:47], a[136:143], v5
    v_smfmac_f32_16x16x64_bf16 v[84:87], v[48:51], a[176:183], v5
    v_smfmac_f32_16x16x64_bf16 v[88:91], v[48:51], a[184:191], v5
    s_nop 7
    v_permlane16_swap_b32 v84, v88
    v_permlane16_swap_b32 v85, v89
    v_permlane16_swap_b32 v86, v90
    v_permlane16_swap_b32 v87, v91
    v_pk_add_f32 v[84:85], v[84:85], v[88:89]
    v_pk_add_f32 v[86:87], v[86:87], v[90:91]
    ds_write_b128 v17, v[84:87]
    s_waitcnt lgkmcnt(0)
    s_barrier
    s_cmp_eq_u32 s31, 3
    s_cbranch_scc1 rec_w3_42
    s_cmp_eq_u32 s31, 2
    s_cbranch_scc1 rec_w2_41
    ds_read_b128 v[180:183], v16 offset:15360
    s_branch rec_b2_16
rec_w2_41:
    ds_read_b128 v[100:103], v16 offset:10240
    ds_read_b128 v[104:107], v16 offset:11264
    ds_read_b128 v[108:111], v16 offset:12288
    ds_read_b128 v[112:115], v16 offset:13312
    s_waitcnt lgkmcnt(0)
    v_pk_add_f32 v[100:101], v[100:101], v[104:105]
    v_pk_add_f32 v[102:103], v[102:103], v[106:107]
    v_pk_add_f32 v[108:109], v[108:109], v[112:113]
    v_pk_add_f32 v[110:111], v[110:111], v[114:115]
    v_pk_add_f32 v[100:101], v[100:101], v[108:109]
    v_pk_add_f32 v[102:103], v[102:103], v[110:111]
    v_cvt_pk_bf16_f32 v180, v100, v101
    v_cvt_pk_bf16_f32 v181, v102, v103
    s_nop 0
    v_permlane32_swap_b32 v180, v182
    v_permlane32_swap_b32 v181, v183
rec_b2_16:
    s_waitcnt lgkmcnt(0)
    s_cmp_eq_u32 s32, 63
    s_cbranch_scc1 rec_done_13
    s_barrier
    s_branch rec_cs_23
rec_w3_42:
    s_cmp_eq_u32 s32, 63
    s_cbranch_scc1 rec_done_13
rec_tk_43:
    s_load_dwordx16 s[72:87], s[90:91], s55 glc
    s_add_u32 s41, s41, 1
    s_cmp_ge_u32 s41, 0x80000
    s_cbranch_scc1 rec_tkd_44
    s_sleep 1
    s_min_u32 s38, s72, s76
    s_min_u32 s39, s80, s84
    s_min_u32 s38, s38, s39
    s_cmp_lt_u32 s38, s54
    s_cbranch_scc1 rec_tk_43
rec_tkd_44:
    s_add_u32 s54, s54, 1
    s_barrier
    s_branch rec_cs_23
rec_kv_26:
    s_load_dword s94, s[90:91], s95 glc
    s_add_u32 s41, s41, 1
    s_cmp_ge_u32 s41, 0x80000
    s_cbranch_scc1 rec_kvd_27
    s_waitcnt lgkmcnt(0)
    s_cmp_gt_u32 s94, s38
    s_cbranch_scc1 rec_kvd_27
    s_sleep 2
    s_branch rec_kv_26
rec_gcfix_25:
    s_cmp_eq_u64 s[56:57], 0
    s_cbranch_scc1 rec_gcsk_45
    buffer_load_dwordx4 v[100:103], v13, s[4:7], s33 offen sc1
rec_gcsk_45:
    s_cmp_eq_u64 s[58:59], 0
    s_cbranch_scc1 rec_gcsk_46
    buffer_load_dwordx4 v[104:107], v137, s[4:7], s33 offen sc1
rec_gcsk_46:
    s_cmp_eq_u64 s[60:61], 0
    s_cbranch_scc1 rec_gcsk_47
    buffer_load_dwordx4 v[108:111], v184, s[4:7], s33 offen sc1
rec_gcsk_47:
    s_cmp_eq_u64 s[62:63], 0
    s_cbranch_scc1 rec_gcsk_48
    buffer_load_dwordx4 v[112:115], v185, s[4:7], s33 offen sc1
rec_gcsk_48:
    s_cmp_eq_u64 s[64:65], 0
    s_cbranch_scc1 rec_gcsk_49
    buffer_load_dwordx4 v[116:119], v186, s[4:7], s33 offen sc1
rec_gcsk_49:
    s_cmp_eq_u64 s[66:67], 0
    s_cbranch_scc1 rec_gcsk_50
    buffer_load_dwordx4 v[120:123], v187, s[4:7], s33 offen sc1
rec_gcsk_50:
    s_cmp_eq_u64 s[68:69], 0
    s_cbranch_scc1 rec_gcsk_51
    buffer_load_dwordx4 v[124:127], v190, s[4:7], s33 offen sc1
rec_gcsk_51:
    s_cmp_eq_u64 s[70:71], 0
    s_cbranch_scc1 rec_gcsk_52
    buffer_load_dwordx4 v[128:131], v191, s[4:7], s33 offen sc1
rec_gcsk_52:
rec_gclp_53:
    s_add_u32 s41, s41, 1
    s_cmp_ge_u32 s41, 0x80000
    s_cbranch_scc1 rec_gcok_24
    s_mov_b64 vcc, 0
    s_waitcnt vmcnt(0)
    s_cmp_eq_u64 s[56:57], 0
    s_cbranch_scc1 rec_gcsk_54
    v_min3_u32 v31, v100, v101, v102
    v_min_u32 v31, v31, v103
    v_cmp_eq_u32 s[56:57], 0, v31
    v_xor_b32 v36, v36, v100
    v_xor_b32 v37, v37, v101
    v_xor_b32 v38, v38, v102
    v_xor_b32 v39, v39, v103
    s_nop 1
    v_smfmac_f32_16x16x64_bf16 v[68:71], v[36:39], a[192:199], v5
    v_smfmac_f32_16x16x64_bf16 v[72:75], v[36:39], a[200:207], v5
    v_mov_b32 v36, v100
    v_mov_b32 v37, v101
    v_mov_b32 v38, v102
    v_mov_b32 v39, v103
    s_or_b64 vcc, vcc, s[56:57]
    s_cmp_eq_u64 s[56:57], 0
    s_cbranch_scc1 rec_gcsk_54
    buffer_load_dwordx4 v[100:103], v13, s[4:7], s33 offen sc1
rec_gcsk_54:
    s_cmp_eq_u64 s[58:59], 0
    s_cbranch_scc1 rec_gcsk_55
    v_min3_u32 v31, v104, v105, v106
    v_min_u32 v31, v31, v107
    v_cmp_eq_u32 s[58:59], 0, v31
    v_xor_b32 v40, v40, v104
    v_xor_b32 v41, v41, v105
    v_xor_b32 v42, v42, v106
    v_xor_b32 v43, v43, v107
    s_nop 1
    v_smfmac_f32_16x16x64_bf16 v[68:71], v[40:43], a[208:215], v5
    v_smfmac_f32_16x16x64_bf16 v[72:75], v[40:43], a[216:223], v5
    v_mov_b32 v40, v104
    v_mov_b32 v41, v105
    v_mov_b32 v42, v106
    v_mov_b32 v43, v107
    s_or_b64 vcc, vcc, s[58:59]
    s_cmp_eq_u64 s[58:59], 0
    s_cbranch_scc1 rec_gcsk_55
    buffer_load_dwordx4 v[104:107], v137, s[4:7], s33 offen sc1
rec_gcsk_55:
    s_cmp_eq_u64 s[60:61], 0
    s_cbranch_scc1 rec_gcsk_56
    v_min3_u32 v31, v108, v109, v110
    v_min_u32 v31, v31, v111
    v_cmp_eq_u32 s[60:61], 0, v31
    v_xor_b32 v44, v44, v108
    v_xor_b32 v45, v45, v109
    v_xor_b32 v46, v46, v110
    v_xor_b32 v47, v47, v111
    s_nop 1
    v_smfmac_f32_16x16x64_bf16 v[68:71], v[44:47], a[224:231], v5
    v_smfmac_f32_16x16x64_bf16 v[72:75], v[44:47], a[232:239], v5
    v_mov_b32 v44, v108
    v_mov_b32 v45, v109
    v_mov_b32 v46, v110
    v_mov_b32 v47, v111
    s_or_b64 vcc, vcc, s[60:61]
    s_cmp_eq_u64 s[60:61], 0
    s_cbranch_scc1 rec_gcsk_56
    buffer_load_dwordx4 v[108:111], v184, s[4:7], s33 offen sc1
rec_gcsk_56:
    s_cmp_eq_u64 s[62:63], 0
    s_cbranch_scc1 rec_gcsk_57
    v_min3_u32 v31, v112, v113, v114
    v_min_u32 v31, v31, v115
    v_cmp_eq_u32 s[62:63], 0, v31
    v_xor_b32 v48, v48, v112
    v_xor_b32 v49, v49, v113
    v_xor_b32 v50, v50, v114
    v_xor_b32 v51, v51, v115
    s_nop 1
    v_smfmac_f32_16x16x64_bf16 v[68:71], v[48:51], a[240:247], v5
    v_smfmac_f32_16x16x64_bf16 v[72:75], v[48:51], a[248:255], v5
    v_mov_b32 v48, v112
    v_mov_b32 v49, v113
    v_mov_b32 v50, v114
    v_mov_b32 v51, v115
    s_or_b64 vcc, vcc, s[62:63]
    s_cmp_eq_u64 s[62:63], 0
    s_cbranch_scc1 rec_gcsk_57
    buffer_load_dwordx4 v[112:115], v185, s[4:7], s33 offen sc1
rec_gcsk_57:
    s_cmp_eq_u64 s[64:65], 0
    s_cbranch_scc1 rec_gcsk_58
    v_min3_u32 v31, v116, v117, v118
    v_min_u32 v31, v31, v119
    v_cmp_eq_u32 s[64:65], 0, v31
    v_xor_b32 v52, v52, v116
    v_xor_b32 v53, v53, v117
    v_xor_b32 v54, v54, v118
    v_xor_b32 v55, v55, v119
    s_nop 1
    v_smfmac_f32_16x16x64_bf16 v[68:71], v[52:55], v[192:199], v5
    v_smfmac_f32_16x16x64_bf16 v[72:75], v[52:55], v[200:207], v5
    v_mov_b32 v52, v116
    v_mov_b32 v53, v117
    v_mov_b32 v54, v118
    v_mov_b32 v55, v119
    s_or_b64 vcc, vcc, s[64:65]
    s_cmp_eq_u64 s[64:65], 0
    s_cbranch_scc1 rec_gcsk_58
    buffer_load_dwordx4 v[116:119], v186, s[4:7], s33 offen sc1
rec_gcsk_58:
    s_cmp_eq_u64 s[66:67], 0
    s_cbranch_scc1 rec_gcsk_59
    v_min3_u32 v31, v120, v121, v122
    v_min_u32 v31, v31, v123
    v_cmp_eq_u32 s[66:67], 0, v31
    v_xor_b32 v56, v56, v120
    v_xor_b32 v57, v57, v121
    v_xor_b32 v58, v58, v122
    v_xor_b32 v59, v59, v123
    s_nop 1
    v_smfmac_f32_16x16x64_bf16 v[68:71], v[56:59], v[208:215], v5
    v_smfmac_f32_16x16x64_bf16 v[72:75], v[56:59], v[216:223], v5
    v_mov_b32 v56, v120
    v_mov_b32 v57, v121
    v_mov_b32 v58, v122
    v_mov_b32 v59, v123
    s_or_b64 vcc, vcc, s[66:67]
    s_cmp_eq_u64 s[66:67], 0
    s_cbranch_scc1 rec_gcsk_59
    buffer_load_dwordx4 v[120:123], v187, s[4:7], s33 offen sc1
rec_gcsk_59:
    s_cmp_eq_u64 s[68:69], 0
    s_cbranch_scc1 rec_gcsk_60
    v_min3_u32 v31, v124, v125, v126
    v_min_u32 v31, v31, v127
    v_cmp_eq_u32 s[68:69], 0, v31
    v_xor_b32 v60, v60, v124
    v_xor_b32 v61, v61, v125
    v_xor_b32 v62, v62, v126
    v_xor_b32 v63, v63, v127
    s_nop 1
    v_smfmac_f32_16x16x64_bf16 v[68:71], v[60:63], v[224:231], v5
    v_smfmac_f32_16x16x64_bf16 v[72:75], v[60:63], v[232:239], v5
    v_mov_b32 v60, v124
    v_mov_b32 v61, v125
    v_mov_b32 v62, v126
    v_mov_b32 v63, v127
    s_or_b64 vcc, vcc, s[68:69]
    s_cmp_eq_u64 s[68:69], 0
    s_cbranch_scc1 rec_gcsk_60
    buffer_load_dwordx4 v[124:127], v190, s[4:7], s33 offen sc1
rec_gcsk_60:
    s_cmp_eq_u64 s[70:71], 0
    s_cbranch_scc1 rec_gcsk_61
    v_min3_u32 v31, v128, v129, v130
    v_min_u32 v31, v31, v131
    v_cmp_eq_u32 s[70:71], 0, v31
    v_xor_b32 v64, v64, v128
    v_xor_b32 v65, v65, v129
    v_xor_b32 v66, v66, v130
    v_xor_b32 v67, v67, v131
    s_nop 1
    v_smfmac_f32_16x16x64_bf16 v[68:71], v[64:67], v[240:247], v5
    v_smfmac_f32_16x16x64_bf16 v[72:75], v[64:67], v[248:255], v5
    v_mov_b32 v64, v128
    v_mov_b32 v65, v129
    v_mov_b32 v66, v130
    v_mov_b32 v67, v131
    s_or_b64 vcc, vcc, s[70:71]
    s_cmp_eq_u64 s[70:71], 0
    s_cbranch_scc1 rec_gcsk_61
    buffer_load_dwordx4 v[128:131], v191, s[4:7], s33 offen sc1
rec_gcsk_61:
    s_cmp_eq_u64 vcc, 0
    s_cbranch_scc1 rec_gcok_24
    s_branch rec_gclp_53
rec_done_13:
    buffer_store_dwordx4 v[180:183], v93, s[4:7], s88 offen sc1
    s_waitcnt vmcnt(0)
    s_barrier
    v_add_u32 v189, 1, v189
    buffer_store_dword v189, v188, s[4:7], 0 offen sc1
    s_endpgm
L_gem:
    s_load_dwordx2 s[90:91], s[0:1], 96
    s_load_dwordx2 s[92:93], s[0:1], 88
    v_and_b32 v1, 63, v0
    v_lshrrev_b32 v2, 6, v0
    s_nop 0
    v_readfirstlane_b32 s29, v2
    v_lshlrev_b32 v5, 4, v1
    s_mov_b32 s41, 0
    s_lshl_b32 s34, s29, 10
    s_waitcnt lgkmcnt(0)
    s_mov_b32 s4, s90
    s_and_b32 s5, s91, 0xffff
    s_mov_b32 s6, 268435456
    s_mov_b32 s7, 0x00020000
    s_cmp_ge_u32 s28, 120
    s_cbranch_scc1 L_att
    s_cmp_ge_u32 s28, 96
    s_cbranch_scc1 sl_b_62
    s_lshr_b32 s31, s28, 5
    s_add_u32 s31, s31, 1
    s_cmp_eq_u32 s31, 3
    s_cselect_b32 s44, 0, s31
    s_lshl_b32 s31, s44, 3
    s_add_u32 s31, s31, 16
    s_load_dwordx2 s[72:73], s[0:1], s31
    s_load_dwordx2 s[74:75], s[0:1], 0
    s_mov_b32 s76, 8388608
    s_mov_b32 s39, 8192
    s_and_b32 s31, s28, 31
    s_lshl_b32 s31, s31, 8
    s_lshl_b32 s36, s44, 24
    s_and_b32 s33, s28, 31
    s_lshl_b32 s33, s33, 13
    s_add_u32 s36, s36, s33
    s_mov_b32 s37, 262144
    s_and_b32 s50, s28, 31
    s_lshl_b32 s50, s50, 7
    s_lshl_b32 s33, s44, 2
    s_add_u32 s50, s50, s33
    s_add_u32 s50, s50, 115343360
    s_branch sl_c_63
sl_b_62:
    s_sub_u32 s32, s28, 96
    s_lshr_b32 s44, s32, 3
    s_load_dwordx2 s[72:73], s[0:1], 64
    s_load_dwordx2 s[74:75], s[0:1], 56
    s_mov_b32 s76, 6291456
    s_mov_b32 s39, 6144
    s_lshl_b32 s31, s32, 8
    s_lshl_b32 s36, s44, 22
    s_and_b32 s33, s32, 7
    s_lshl_b32 s33, s33, 13
    s_add_u32 s36, s36, s33
    s_add_u32 s36, s36, 50331648
    s_mov_b32 s37, 65536
    s_and_b32 s50, s32, 7
    s_lshl_b32 s50, s50, 7
    s_lshl_b32 s33, s44, 2
    s_add_u32 s50, s50, s33
    s_add_u32 s50, s50, 115347456
sl_c_63:
    s_waitcnt lgkmcnt(0)
    s_cmp_lg_u32 s29, 0
    s_cbranch_scc1 sl_i_64
    v_mov_b32 v2, 0
    s_mov_b64 exec, 1
    buffer_store_dword v2, v2, s[4:7], s50 offen sc1
    s_mov_b64 exec, -1
sl_i_64:
    s_mov_b32 s8, s72
    s_and_b32 s9, s73, 0xffff
    s_mov_b32 s10, s76
    s_mov_b32 s11, 0x00020000
    s_mov_b32 s12, s74
    s_and_b32 s13, s75, 0xffff
    s_mov_b32 s14, 4194304
    s_mov_b32 s15, 0x00020000
    s_mov_b64 s[80:81], s[72:73]
    s_mov_b32 s45, s31
    s_cmp_lt_u32 s28, 96
    s_cbranch_scc1 sl_go_65
    s_cmp_lg_u32 s29, 0
    s_cbranch_scc1 sl_a2_66
    s_mov_b64 exec, 1
    v_mov_b32 v2, 0
    v_mov_b32 v3, 1
    s_waitcnt vmcnt(0)
    global_atomic_add v2, v3, s[92:93] offset:0 sc1
    s_mov_b64 exec, -1
sl_a2_66:
    s_cmp_lt_u32 s28, 96
    s_cbranch_scc1 tw_skip_67
    s_load_dwordx2 s[72:73], s[0:1], 40
    s_and_b32 s31, s28, 31
    s_lshl_b32 s31, s31, 13
    s_lshl_b32 s33, s29, 21
    s_add_u32 s31, s31, s33
    v_lshl_add_u32 v2, v1, 7, s31
    s_waitcnt lgkmcnt(0)
    s_mov_b32 s8, s72
    s_and_b32 s9, s73, 0xffff
    s_mov_b32 s10, 8388608
    s_mov_b32 s11, 0x00020000
    s_mov_b32 s31, 0
    buffer_load_dword v128, v2, s[8:11], s31 offen
    s_mov_b32 s31, 262144
    buffer_load_dword v129, v2, s[8:11], s31 offen
    s_mov_b32 s31, 524288
    buffer_load_dword v130, v2, s[8:11], s31 offen
    s_mov_b32 s31, 786432
    buffer_load_dword v131, v2, s[8:11], s31 offen
    s_mov_b32 s31, 1048576
    buffer_load_dword v132, v2, s[8:11], s31 offen
    s_mov_b32 s31, 1310720
    buffer_load_dword v133, v2, s[8:11], s31 offen
    s_mov_b32 s31, 1572864
    buffer_load_dword v134, v2, s[8:11], s31 offen
    s_mov_b32 s31, 1835008
    buffer_load_dword v135, v2, s[8:11], s31 offen
tw_skip_67:
    s_mov_b32 s8, s80
    s_and_b32 s9, s81, 0xffff
    s_mov_b32 s10, s76
    s_mov_b32 s11, 0x00020000
    s_cmp_lg_u32 s29, 0
    s_cbranch_scc1 g_wdd_69
g_wd_68:
    s_load_dword s84, s[92:93], 128 glc
    s_add_u32 s41, s41, 1
    s_cmp_ge_u32 s41, 0x200000
    s_cbranch_scc1 g_wdd_69
    s_waitcnt lgkmcnt(0)
    s_and_b32 s84, s84, 0xffff
    s_cmp_ge_u32 s84, 96
    s_cbranch_scc1 g_wdd_69
    s_sleep 32
    s_branch g_wd_68
g_wdd_69:
    s_waitcnt lgkmcnt(0)
    s_barrier
sl_go_65:
    v_lshrrev_b32 v2, 2, v1
    v_mul_lo_u32 v6, v2, s39
    s_mov_b32 s31, s45
    s_lshl_b32 s33, s29, 6
    s_add_u32 s31, s31, s33
    v_and_b32 v2, 3, v1
    v_lshlrev_b32 v2, 4, v2
    v_add_u32 v2, s31, v2
    v_add_u32 v6, v6, v2
    s_lshl_b32 s39, s39, 4
    s_mov_b32 s30, 0
    s_mov_b32 s51, 64
    s_mov_b32 s52, 4128768
    s_lshl_b32 s31, s29, 15
    v_lshrrev_b32 v7, 4, v1
    v_lshlrev_b32 v7, 9, v7
    v_bfe_u32 v4, v1, 2, 2
    v_lshl_add_u32 v7, v4, 6, v7
    v_bfe_u32 v4, v1, 1, 1
    v_lshl_add_u32 v7, v4, 5, v7
    v_and_b32 v4, 1, v1
    v_lshl_add_u32 v7, v4, 3, v7
    v_add_u32 v7, s31, v7
    s_lshl_b32 s32, s29, 15
    s_add_u32 m0, s32, 0
    s_mov_b32 s38, 0
    buffer_load_dwordx4 v6, s[8:11], s38 offen lds
    s_add_u32 m0, s32, 1024
    s_add_u32 s38, s38, s39
    buffer_load_dwordx4 v6, s[8:11], s38 offen lds
    s_add_u32 m0, s32, 2048
    s_add_u32 s38, s38, s39
    buffer_load_dwordx4 v6, s[8:11], s38 offen lds
    s_add_u32 m0, s32, 3072
    s_add_u32 s38, s38, s39
    buffer_load_dwordx4 v6, s[8:11], s38 offen lds
    s_add_u32 m0, s32, 4096
    s_add_u32 s38, s38, s39
    buffer_load_dwordx4 v6, s[8:11], s38 offen lds
    s_add_u32 m0, s32, 5120
    s_add_u32 s38, s38, s39
    buffer_load_dwordx4 v6, s[8:11], s38 offen lds
    s_add_u32 m0, s32, 6144
    s_add_u32 s38, s38, s39
    buffer_load_dwordx4 v6, s[8:11], s38 offen lds
    s_add_u32 m0, s32, 7168
    s_add_u32 s38, s38, s39
    buffer_load_dwordx4 v6, s[8:11], s38 offen lds
    s_add_u32 m0, s32, 8192
    s_add_u32 s38, s38, s39
    buffer_load_dwordx4 v6, s[8:11], s38 offen lds
    s_add_u32 m0, s32, 9216
    s_add_u32 s38, s38, s39
    buffer_load_dwordx4 v6, s[8:11], s38 offen lds
    s_add_u32 m0, s32, 10240
    s_add_u32 s38, s38, s39
    buffer_load_dwordx4 v6, s[8:11], s38 offen lds
    s_add_u32 m0, s32, 11264
    s_add_u32 s38, s38, s39
    buffer_load_dwordx4 v6, s[8:11], s38 offen lds
    s_add_u32 m0, s32, 12288
    s_add_u32 s38, s38, s39
    buffer_load_dwordx4 v6, s[8:11], s38 offen lds
    s_add_u32 m0, s32, 13312
    s_add_u32 s38, s38, s39
    buffer_load_dwordx4 v6, s[8:11], s38 offen lds
    s_add_u32 m0, s32, 14336
    s_add_u32 s38, s38, s39
    buffer_load_dwordx4 v6, s[8:11], s38 offen lds
    s_add_u32 m0, s32, 15360
    s_add_u32 s38, s38, s39
    buffer_load_dwordx4 v6, s[8:11], s38 offen lds
    s_add_u32 m0, s32, 16384
    s_add_u32 s38, s38, s39
    buffer_load_dwordx4 v6, s[8:11], s38 offen lds
    s_add_u32 m0, s32, 17408
    s_add_u32 s38, s38, s39
    buffer_load_dwordx4 v6, s[8:11], s38 offen lds
    s_add_u32 m0, s32, 18432
    s_add_u32 s38, s38, s39
    buffer_load_dwordx4 v6, s[8:11], s38 offen lds
    s_add_u32 m0, s32, 19456
    s_add_u32 s38, s38, s39
    buffer_load_dwordx4 v6, s[8:11], s38 offen lds
    s_add_u32 m0, s32, 20480
    s_add_u32 s38, s38, s39
    buffer_load_dwordx4 v6, s[8:11], s38 offen lds
    s_add_u32 m0, s32, 21504
    s_add_u32 s38, s38, s39
    buffer_load_dwordx4 v6, s[8:11], s38 offen lds
    s_add_u32 m0, s32, 22528
    s_add_u32 s38, s38, s39
    buffer_load_dwordx4 v6, s[8:11], s38 offen lds
    s_add_u32 m0, s32, 23552
    s_add_u32 s38, s38, s39
    buffer_load_dwordx4 v6, s[8:11], s38 offen lds
    s_add_u32 m0, s32, 24576
    s_add_u32 s38, s38, s39
    buffer_load_dwordx4 v6, s[8:11], s38 offen lds
    s_add_u32 m0, s32, 25600
    s_add_u32 s38, s38, s39
    buffer_load_dwordx4 v6, s[8:11], s38 offen lds
    s_add_u32 m0, s32, 26624
    s_add_u32 s38, s38, s39
    buffer_load_dwordx4 v6, s[8:11], s38 offen lds
    s_add_u32 m0, s32, 27648
    s_add_u32 s38, s38, s39
    buffer_load_dwordx4 v6, s[8:11], s38 offen lds
    s_add_u32 m0, s32, 28672
    s_add_u32 s38, s38, s39
    buffer_load_dwordx4 v6, s[8:11], s38 offen lds
    s_add_u32 m0, s32, 29696
    s_add_u32 s38, s38, s39
    buffer_load_dwordx4 v6, s[8:11], s38 offen lds
    s_add_u32 m0, s32, 30720
    s_add_u32 s38, s38, s39
    buffer_load_dwordx4 v6, s[8:11], s38 offen lds
    s_add_u32 m0, s32, 31744
    s_add_u32 s38, s38, s39
    buffer_load_dwordx4 v6, s[8:11], s38 offen lds
    s_waitcnt vmcnt(30)
    s_cmp_lg_u32 s29, 0
    s_cbranch_scc1 sl_ar_70
    s_cmp_ge_u32 s28, 96
    s_cbranch_scc1 sl_ar_70
    s_mov_b64 exec, 1
    v_mov_b32 v2, 0
    v_mov_b32 v3, 1
    global_atomic_add v2, v3, s[92:93] offset:0 sc1
    s_mov_b64 exec, -1
sl_ar_70:
    ds_read_b64_tr_b16 a[0:1], v7 offset:0
    ds_read_b64_tr_b16 a[2:3], v7 offset:256
    ds_read_b64_tr_b16 a[4:5], v7 offset:16
    ds_read_b64_tr_b16 a[6:7], v7 offset:272
    s_waitcnt vmcnt(28)
    ds_read_b64_tr_b16 a[8:9], v7 offset:2048
    ds_read_b64_tr_b16 a[10:11], v7 offset:2304
    ds_read_b64_tr_b16 a[12:13], v7 offset:2064
    ds_read_b64_tr_b16 a[14:15], v7 offset:2320
    s_waitcnt lgkmcnt(4)
    s_add_u32 m0, s32, 0
    s_add_u32 s38, s38, s39
    buffer_load_dwordx4 v6, s[8:11], s38 offen lds
    s_add_u32 m0, s32, 1024
    s_add_u32 s38, s38, s39
    buffer_load_dwordx4 v6, s[8:11], s38 offen lds
    s_waitcnt vmcnt(28)
    ds_read_b64_tr_b16 a[16:17], v7 offset:4096
    ds_read_b64_tr_b16 a[18:19], v7 offset:4352
    ds_read_b64_tr_b16 a[20:21], v7 offset:4112
    ds_read_b64_tr_b16 a[22:23], v7 offset:4368
    s_waitcnt lgkmcnt(4)
    s_add_u32 m0, s32, 2048
    s_add_u32 s38, s38, s39
    buffer_load_dwordx4 v6, s[8:11], s38 offen lds
    s_add_u32 m0, s32, 3072
    s_add_u32 s38, s38, s39
    buffer_load_dwordx4 v6, s[8:11], s38 offen lds
    s_waitcnt vmcnt(28)
    ds_read_b64_tr_b16 a[24:25], v7 offset:6144
    ds_read_b64_tr_b16 a[26:27], v7 offset:6400
    ds_read_b64_tr_b16 a[28:29], v7 offset:6160
    ds_read_b64_tr_b16 a[30:31], v7 offset:6416
    s_waitcnt lgkmcnt(4)
    s_add_u32 m0, s32, 4096
    s_add_u32 s38, s38, s39
    buffer_load_dwordx4 v6, s[8:11], s38 offen lds
    s_add_u32 m0, s32, 5120
    s_add_u32 s38, s38, s39
    buffer_load_dwordx4 v6, s[8:11], s38 offen lds
    s_waitcnt vmcnt(28)
    ds_read_b64_tr_b16 a[32:33], v7 offset:8192
    ds_read_b64_tr_b16 a[34:35], v7 offset:8448
    ds_read_b64_tr_b16 a[36:37], v7 offset:8208
    ds_read_b64_tr_b16 a[38:39], v7 offset:8464
    s_waitcnt lgkmcnt(4)
    s_add_u32 m0, s32, 6144
    s_add_u32 s38, s38, s39
    buffer_load_dwordx4 v6, s[8:11], s38 offen lds
    s_add_u32 m0, s32, 7168
    s_add_u32 s38, s38, s39
    buffer_load_dwordx4 v6, s[8:11], s38 offen lds
    s_waitcnt vmcnt(28)
    ds_read_b64_tr_b16 a[40:41], v7 offset:10240
    ds_read_b64_tr_b16 a[42:43], v7 offset:10496
    ds_read_b64_tr_b16 a[44:45], v7 offset:10256
    ds_read_b64_tr_b16 a[46:47], v7 offset:10512
    s_waitcnt lgkmcnt(4)
    s_add_u32 m0, s32, 8192
    s_add_u32 s38, s38, s39
    buffer_load_dwordx4 v6, s[8:11], s38 offen lds
    s_add_u32 m0, s32, 9216
    s_add_u32 s38, s38, s39
    buffer_load_dwordx4 v6, s[8:11], s38 offen lds
    s_waitcnt vmcnt(28)
    ds_read_b64_tr_b16 a[48:49], v7 offset:12288
    ds_read_b64_tr_b16 a[50:51], v7 offset:12544
    ds_read_b64_tr_b16 a[52:53], v7 offset:12304
    ds_read_b64_tr_b16 a[54:55], v7 offset:12560
    s_waitcnt lgkmcnt(4)
    s_add_u32 m0, s32, 10240
    s_add_u32 s38, s38, s39
    buffer_load_dwordx4 v6, s[8:11], s38 offen lds
    s_add_u32 m0, s32, 11264
    s_add_u32 s38, s38, s39
    buffer_load_dwordx4 v6, s[8:11], s38 offen lds
    s_waitcnt vmcnt(28)
    ds_read_b64_tr_b16 a[56:57], v7 offset:14336
    ds_read_b64_tr_b16 a[58:59], v7 offset:14592
    ds_read_b64_tr_b16 a[60:61], v7 offset:14352
    ds_read_b64_tr_b16 a[62:63], v7 offset:14608
    s_waitcnt lgkmcnt(4)
    s_add_u32 m0, s32, 12288
    s_add_u32 s38, s38, s39
    buffer_load_dwordx4 v6, s[8:11], s38 offen lds
    s_add_u32 m0, s32, 13312
    s_add_u32 s38, s38, s39
    buffer_load_dwordx4 v6, s[8:11], s38 offen lds
    s_waitcnt vmcnt(28)
    ds_read_b64_tr_b16 a[64:65], v7 offset:16384
    ds_read_b64_tr_b16 a[66:67], v7 offset:16640
    ds_read_b64_tr_b16 a[68:69], v7 offset:16400
    ds_read_b64_tr_b16 a[70:71], v7 offset:16656
    s_waitcnt lgkmcnt(4)
    s_add_u32 m0, s32, 14336
    s_add_u32 s38, s38, s39
    buffer_load_dwordx4 v6, s[8:11], s38 offen lds
    s_add_u32 m0, s32, 15360
    s_add_u32 s38, s38, s39
    buffer_load_dwordx4 v6, s[8:11], s38 offen lds
    s_waitcnt vmcnt(28)
    ds_read_b64_tr_b16 a[72:73], v7 offset:18432
    ds_read_b64_tr_b16 a[74:75], v7 offset:18688
    ds_read_b64_tr_b16 a[76:77], v7 offset:18448
    ds_read_b64_tr_b16 a[78:79], v7 offset:18704
    s_waitcnt lgkmcnt(4)
    s_add_u32 m0, s32, 16384
    s_add_u32 s38, s38, s39
    buffer_load_dwordx4 v6, s[8:11], s38 offen lds
    s_add_u32 m0, s32, 17408
    s_add_u32 s38, s38, s39
    buffer_load_dwordx4 v6, s[8:11], s38 offen lds
    s_waitcnt vmcnt(28)
    ds_read_b64_tr_b16 a[80:81], v7 offset:20480
    ds_read_b64_tr_b16 a[82:83], v7 offset:20736
    ds_read_b64_tr_b16 a[84:85], v7 offset:20496
    ds_read_b64_tr_b16 a[86:87], v7 offset:20752
    s_waitcnt lgkmcnt(4)
    s_add_u32 m0, s32, 18432
    s_add_u32 s38, s38, s39
    buffer_load_dwordx4 v6, s[8:11], s38 offen lds
    s_add_u32 m0, s32, 19456
    s_add_u32 s38, s38, s39
    buffer_load_dwordx4 v6, s[8:11], s38 offen lds
    s_waitcnt vmcnt(28)
    ds_read_b64_tr_b16 a[88:89], v7 offset:22528
    ds_read_b64_tr_b16 a[90:91], v7 offset:22784
    ds_read_b64_tr_b16 a[92:93], v7 offset:22544
    ds_read_b64_tr_b16 a[94:95], v7 offset:22800
    s_waitcnt lgkmcnt(4)
    s_add_u32 m0, s32, 20480
    s_add_u32 s38, s38, s39
    buffer_load_dwordx4 v6, s[8:11], s38 offen lds
    s_add_u32 m0, s32, 21504
    s_add_u32 s38, s38, s39
    buffer_load_dwordx4 v6, s[8:11], s38 offen lds
    s_waitcnt vmcnt(28)
    ds_read_b64_tr_b16 a[96:97], v7 offset:24576
    ds_read_b64_tr_b16 a[98:99], v7 offset:24832
    ds_read_b64_tr_b16 a[100:101], v7 offset:24592
    ds_read_b64_tr_b16 a[102:103], v7 offset:24848
    s_waitcnt lgkmcnt(4)
    s_add_u32 m0, s32, 22528
    s_add_u32 s38, s38, s39
    buffer_load_dwordx4 v6, s[8:11], s38 offen lds
    s_add_u32 m0, s32, 23552
    s_add_u32 s38, s38, s39
    buffer_load_dwordx4 v6, s[8:11], s38 offen lds
    s_waitcnt vmcnt(28)
    ds_read_b64_tr_b16 a[104:105], v7 offset:26624
    ds_read_b64_tr_b16 a[106:107], v7 offset:26880
    ds_read_b64_tr_b16 a[108:109], v7 offset:26640
    ds_read_b64_tr_b16 a[110:111], v7 offset:26896
    s_waitcnt lgkmcnt(4)
    s_add_u32 m0, s32, 24576
    s_add_u32 s38, s38, s39
    buffer_load_dwordx4 v6, s[8:11], s38 offen lds
    s_add_u32 m0, s32, 25600
    s_add_u32 s38, s38, s39
    buffer_load_dwordx4 v6, s[8:11], s38 offen lds
    s_waitcnt vmcnt(28)
    ds_read_b64_tr_b16 a[112:113], v7 offset:28672
    ds_read_b64_tr_b16 a[114:115], v7 offset:28928
    ds_read_b64_tr_b16 a[116:117], v7 offset:28688
    ds_read_b64_tr_b16 a[118:119], v7 offset:28944
    s_waitcnt lgkmcnt(4)
    s_add_u32 m0, s32, 26624
    s_add_u32 s38, s38, s39
    buffer_load_dwordx4 v6, s[8:11], s38 offen lds
    s_add_u32 m0, s32, 27648
    s_add_u32 s38, s38, s39
    buffer_load_dwordx4 v6, s[8:11], s38 offen lds
    s_waitcnt vmcnt(28)
    ds_read_b64_tr_b16 a[120:121], v7 offset:30720
    ds_read_b64_tr_b16 a[122:123], v7 offset:30976
    ds_read_b64_tr_b16 a[124:125], v7 offset:30736
    ds_read_b64_tr_b16 a[126:127], v7 offset:30992
    s_waitcnt lgkmcnt(4)
    s_add_u32 m0, s32, 28672
    s_add_u32 s38, s38, s39
    buffer_load_dwordx4 v6, s[8:11], s38 offen lds
    s_add_u32 m0, s32, 29696
    s_add_u32 s38, s38, s39
    buffer_load_dwordx4 v6, s[8:11], s38 offen lds
    s_waitcnt vmcnt(28)
    ds_read_b64_tr_b16 a[128:129], v7 offset:0
    ds_read_b64_tr_b16 a[130:131], v7 offset:256
    ds_read_b64_tr_b16 a[132:133], v7 offset:16
    ds_read_b64_tr_b16 a[134:135], v7 offset:272
    s_waitcnt lgkmcnt(4)
    s_add_u32 m0, s32, 30720
    s_add_u32 s38, s38, s39
    buffer_load_dwordx4 v6, s[8:11], s38 offen lds
    s_add_u32 m0, s32, 31744
    s_add_u32 s38, s38, s39
    buffer_load_dwordx4 v6, s[8:11], s38 offen lds
    s_waitcnt vmcnt(28)
    ds_read_b64_tr_b16 a[136:137], v7 offset:2048
    ds_read_b64_tr_b16 a[138:139], v7 offset:2304
    ds_read_b64_tr_b16 a[140:141], v7 offset:2064
    ds_read_b64_tr_b16 a[142:143], v7 offset:2320
    s_waitcnt vmcnt(26)
    ds_read_b64_tr_b16 a[144:145], v7 offset:4096
    ds_read_b64_tr_b16 a[146:147], v7 offset:4352
    ds_read_b64_tr_b16 a[148:149], v7 offset:4112
    ds_read_b64_tr_b16 a[150:151], v7 offset:4368
    s_waitcnt vmcnt(24)
    ds_read_b64_tr_b16 a[152:153], v7 offset:6144
    ds_read_b64_tr_b16 a[154:155], v7 offset:6400
    ds_read_b64_tr_b16 a[156:157], v7 offset:6160
    ds_read_b64_tr_b16 a[158:159], v7 offset:6416
    s_waitcnt vmcnt(22)
    ds_read_b64_tr_b16 a[160:161], v7 offset:8192
    ds_read_b64_tr_b16 a[162:163], v7 offset:8448
    ds_read_b64_tr_b16 a[164:165], v7 offset:8208
    ds_read_b64_tr_b16 a[166:167], v7 offset:8464
    s_waitcnt vmcnt(20)
    ds_read_b64_tr_b16 a[168:169], v7 offset:10240
    ds_read_b64_tr_b16 a[170:171], v7 offset:10496
    ds_read_b64_tr_b16 a[172:173], v7 offset:10256
    ds_read_b64_tr_b16 a[174:175], v7 offset:10512
    s_waitcnt vmcnt(18)
    ds_read_b64_tr_b16 a[176:177], v7 offset:12288
    ds_read_b64_tr_b16 a[178:179], v7 offset:12544
    ds_read_b64_tr_b16 a[180:181], v7 offset:12304
    ds_read_b64_tr_b16 a[182:183], v7 offset:12560
    s_waitcnt vmcnt(16)
    ds_read_b64_tr_b16 a[184:185], v7 offset:14336
    ds_read_b64_tr_b16 a[186:187], v7 offset:14592
    ds_read_b64_tr_b16 a[188:189], v7 offset:14352
    ds_read_b64_tr_b16 a[190:191], v7 offset:14608
    s_waitcnt vmcnt(14)
    ds_read_b64_tr_b16 a[192:193], v7 offset:16384
    ds_read_b64_tr_b16 a[194:195], v7 offset:16640
    ds_read_b64_tr_b16 a[196:197], v7 offset:16400
    ds_read_b64_tr_b16 a[198:199], v7 offset:16656
    s_waitcnt vmcnt(12)
    ds_read_b64_tr_b16 a[200:201], v7 offset:18432
    ds_read_b64_tr_b16 a[202:203], v7 offset:18688
    ds_read_b64_tr_b16 a[204:205], v7 offset:18448
    ds_read_b64_tr_b16 a[206:207], v7 offset:18704
    s_waitcnt vmcnt(10)
    ds_read_b64_tr_b16 a[208:209], v7 offset:20480
    ds_read_b64_tr_b16 a[210:211], v7 offset:20736
    ds_read_b64_tr_b16 a[212:213], v7 offset:20496
    ds_read_b64_tr_b16 a[214:215], v7 offset:20752
    s_waitcnt vmcnt(8)
    ds_read_b64_tr_b16 a[216:217], v7 offset:22528
    ds_read_b64_tr_b16 a[218:219], v7 offset:22784
    ds_read_b64_tr_b16 a[220:221], v7 offset:22544
    ds_read_b64_tr_b16 a[222:223], v7 offset:22800
    s_waitcnt vmcnt(6)
    ds_read_b64_tr_b16 a[224:225], v7 offset:24576
    ds_read_b64_tr_b16 a[226:227], v7 offset:24832
    ds_read_b64_tr_b16 a[228:229], v7 offset:24592
    ds_read_b64_tr_b16 a[230:231], v7 offset:24848
    s_waitcnt vmcnt(4)
    ds_read_b64_tr_b16 a[232:233], v7 offset:26624
    ds_read_b64_tr_b16 a[234:235], v7 offset:26880
    ds_read_b64_tr_b16 a[236:237], v7 offset:26640
    ds_read_b64_tr_b16 a[238:239], v7 offset:26896
    s_waitcnt vmcnt(2)
    ds_read_b64_tr_b16 a[240:241], v7 offset:28672
    ds_read_b64_tr_b16 a[242:243], v7 offset:28928
    ds_read_b64_tr_b16 a[244:245], v7 offset:28688
    ds_read_b64_tr_b16 a[246:247], v7 offset:28944
    s_waitcnt vmcnt(0)
    ds_read_b64_tr_b16 a[248:249], v7 offset:30720
    ds_read_b64_tr_b16 a[250:251], v7 offset:30976
    ds_read_b64_tr_b16 a[252:253], v7 offset:30736
    ds_read_b64_tr_b16 a[254:255], v7 offset:30992
    s_waitcnt lgkmcnt(0)
    s_lshr_b32 s31, s29, 1
    s_and_b32 s31, s31, 1
    s_lshl_b32 s31, s31, 2
    v_lshrrev_b32 v2, 4, v1
    v_add_u32 v2, s31, v2
    v_and_b32 v3, 7, v1
    v_xor_b32 v2, v2, v3
    s_lshl_b32 s31, s29, 14
    v_lshrrev_b32 v8, 3, v1
    v_lshlrev_b32 v8, 11, v8
    v_add_u32 v8, s31, v8
    v_lshl_add_u32 v8, v2, 4, v8
    v_bfe_u32 v2, v1, 1, 3
    v_lshrrev_b32 v3, 4, v1
    v_xor_b32 v2, v2, v3
    v_bfe_u32 v3, v1, 3, 1
    v_lshlrev_b32 v3, 11, v3
    v_and_b32 v4, 7, v1
    v_lshl_add_u32 v3, v4, 7, v3
    v_xor_b32 v12, 0, v2
    v_lshl_add_u32 v12, v12, 4, v3
    v_add_u32 v14, 65536, v12
    v_xor_b32 v13, 4, v2
    v_lshl_add_u32 v13, v13, 4, v3
    v_add_u32 v15, 65536, v13
    s_lshl_b32 s31, s29, 11
    v_lshrrev_b32 v9, 4, v1
    v_lshlrev_b32 v9, 9, v9
    v_bfe_u32 v4, v1, 3, 1
    v_lshl_add_u32 v9, v4, 8, v9
    v_and_b32 v4, 7, v1
    v_lshl_add_u32 v9, v4, 4, v9
    v_add_u32 v9, s31, v9
    v_mov_b32 v10, s50
    s_cmp_eq_u32 s29, 0
    s_cselect_b64 vcc, 1, 0
    v_mov_b32 v4, 2130706432
    v_cndmask_b32 v10, v4, v10, vcc
    v_mov_b32 v11, 0
    s_lshl_b32 s35, s30, 16
    s_sub_u32 s36, s36, s37
    s_barrier
    s_add_u32 m0, s34, 0
    s_nop 0
    buffer_load_dwordx4 v8, s[12:15], s35 offen offset:0 lds
    s_add_u32 m0, s34, 3968
    s_nop 0
    buffer_load_dwordx4 v8, s[12:15], s35 offen offset:128 lds
    s_add_u32 m0, s34, 7936
    s_nop 0
    buffer_load_dwordx4 v8, s[12:15], s35 offen offset:256 lds
    s_add_u32 m0, s34, 11904
    s_nop 0
    buffer_load_dwordx4 v8, s[12:15], s35 offen offset:384 lds
    s_add_u32 m0, s34, 15872
    s_nop 0
    buffer_load_dwordx4 v8, s[12:15], s35 offen offset:512 lds
    s_add_u32 m0, s34, 19840
    s_nop 0
    buffer_load_dwordx4 v8, s[12:15], s35 offen offset:640 lds
    s_add_u32 m0, s34, 23808
    s_nop 0
    buffer_load_dwordx4 v8, s[12:15], s35 offen offset:768 lds
    s_add_u32 m0, s34, 27776
    s_nop 0
    buffer_load_dwordx4 v8, s[12:15], s35 offen offset:896 lds
    s_add_u32 m0, s34, 31744
    s_nop 0
    buffer_load_dwordx4 v8, s[12:15], s35 offen offset:1024 lds
    s_add_u32 m0, s34, 35712
    s_nop 0
    buffer_load_dwordx4 v8, s[12:15], s35 offen offset:1152 lds
    s_add_u32 m0, s34, 39680
    s_nop 0
    buffer_load_dwordx4 v8, s[12:15], s35 offen offset:1280 lds
    s_add_u32 m0, s34, 43648
    s_nop 0
    buffer_load_dwordx4 v8, s[12:15], s35 offen offset:1408 lds
    s_add_u32 m0, s34, 47616
    s_nop 0
    buffer_load_dwordx4 v8, s[12:15], s35 offen offset:1536 lds
    s_add_u32 m0, s34, 51584
    s_nop 0
    buffer_load_dwordx4 v8, s[12:15], s35 offen offset:1664 lds
    s_add_u32 m0, s34, 55552
    s_nop 0
    buffer_load_dwordx4 v8, s[12:15], s35 offen offset:1792 lds
    s_add_u32 m0, s34, 59520
    s_nop 0
    buffer_load_dwordx4 v8, s[12:15], s35 offen offset:1920 lds
    s_add_u32 s35, s35, 65536
    s_add_u32 m0, s34, 65536
    s_nop 0
    buffer_load_dwordx4 v8, s[12:15], s35 offen offset:0 lds
    s_add_u32 m0, s34, 69504
    s_nop 0
    buffer_load_dwordx4 v8, s[12:15], s35 offen offset:128 lds
    s_add_u32 m0, s34, 73472
    s_nop 0
    buffer_load_dwordx4 v8, s[12:15], s35 offen offset:256 lds
    s_add_u32 m0, s34, 77440
    s_nop 0
    buffer_load_dwordx4 v8, s[12:15], s35 offen offset:384 lds
    s_waitcnt vmcnt(12)
    s_barrier
    ds_read_b128 v[32:35], v12 offset:0
    ds_read_b128 v[36:39], v12 offset:1024
    ds_read_b128 v[40:43], v13 offset:0
    ds_read_b128 v[44:47], v13 offset:1024
    ds_read_b128 v[48:51], v12 offset:4096
    ds_read_b128 v[52:55], v12 offset:5120
    v_add_u32 v9, 2130706432, v9
    s_cmp_eq_u32 s44, 2
    s_cbranch_scc1 sl_v_71
sl_loop_73:
    s_waitcnt lgkmcnt(4)
    v_mfma_f32_16x16x32_bf16 v[64:67], a[0:3], v[32:35], 0
    ds_read_b128 v[56:59], v13 offset:4096
    v_mfma_f32_16x16x32_bf16 v[68:71], a[4:7], v[32:35], 0
    v_mfma_f32_16x16x32_bf16 v[72:75], a[0:3], v[36:39], 0
    ds_read_b128 v[60:63], v13 offset:5120
    s_add_u32 m0, s34, 81408
    v_mfma_f32_16x16x32_bf16 v[76:79], a[4:7], v[36:39], 0
    buffer_load_dwordx4 v8, s[12:15], s35 offen offset:512 lds
    s_waitcnt lgkmcnt(4)
    v_mfma_f32_16x16x32_bf16 v[64:67], a[8:11], v[40:43], v[64:67]
    ds_read_b128 v[32:35], v12 offset:8192
    v_mfma_f32_16x16x32_bf16 v[68:71], a[12:15], v[40:43], v[68:71]
    v_mfma_f32_16x16x32_bf16 v[72:75], a[8:11], v[44:47], v[72:75]
    ds_read_b128 v[36:39], v12 offset:9216
    v_mfma_f32_16x16x32_bf16 v[76:79], a[12:15], v[44:47], v[76:79]
    s_waitcnt lgkmcnt(4)
    v_mfma_f32_16x16x32_bf16 v[64:67], a[16:19], v[48:51], v[64:67]
    ds_read_b128 v[40:43], v13 offset:8192
    v_mfma_f32_16x16x32_bf16 v[68:71], a[20:23], v[48:51], v[68:71]
    v_cvt_pk_bf16_f32 v96, v80, v81
    v_mfma_f32_16x16x32_bf16 v[72:75], a[16:19], v[52:55], v[72:75]
    ds_read_b128 v[44:47], v13 offset:9216
    s_add_u32 m0, s34, 85376
    v_mfma_f32_16x16x32_bf16 v[76:79], a[20:23], v[52:55], v[76:79]
    buffer_load_dwordx4 v8, s[12:15], s35 offen offset:640 lds
    v_cvt_pk_bf16_f32 v97, v82, v83
    s_waitcnt lgkmcnt(4)
    v_mfma_f32_16x16x32_bf16 v[64:67], a[24:27], v[56:59], v[64:67]
    ds_read_b128 v[48:51], v12 offset:12288
    v_mfma_f32_16x16x32_bf16 v[68:71], a[28:31], v[56:59], v[68:71]
    v_cvt_pk_bf16_f32 v98, v84, v85
    v_mfma_f32_16x16x32_bf16 v[72:75], a[24:27], v[60:63], v[72:75]
    ds_read_b128 v[52:55], v12 offset:13312
    v_mfma_f32_16x16x32_bf16 v[76:79], a[28:31], v[60:63], v[76:79]
    v_cvt_pk_bf16_f32 v99, v86, v87
    s_waitcnt lgkmcnt(4)
    v_mfma_f32_16x16x32_bf16 v[64:67], a[32:35], v[32:35], v[64:67]
    ds_read_b128 v[56:59], v13 offset:12288
    v_mfma_f32_16x16x32_bf16 v[68:71], a[36:39], v[32:35], v[68:71]
    v_cvt_pk_bf16_f32 v100, v88, v89
    v_mfma_f32_16x16x32_bf16 v[72:75], a[32:35], v[36:39], v[72:75]
    ds_read_b128 v[60:63], v13 offset:13312
    s_add_u32 m0, s34, 89344
    v_mfma_f32_16x16x32_bf16 v[76:79], a[36:39], v[36:39], v[76:79]
    buffer_load_dwordx4 v8, s[12:15], s35 offen offset:768 lds
    v_cvt_pk_bf16_f32 v101, v90, v91
    s_waitcnt lgkmcnt(4)
    v_mfma_f32_16x16x32_bf16 v[64:67], a[40:43], v[40:43], v[64:67]
    ds_read_b128 v[32:35], v12 offset:16384
    v_mfma_f32_16x16x32_bf16 v[68:71], a[44:47], v[40:43], v[68:71]
    v_cvt_pk_bf16_f32 v102, v92, v93
    v_mfma_f32_16x16x32_bf16 v[72:75], a[40:43], v[44:47], v[72:75]
    ds_read_b128 v[36:39], v12 offset:17408
    v_mfma_f32_16x16x32_bf16 v[76:79], a[44:47], v[44:47], v[76:79]
    v_cvt_pk_bf16_f32 v103, v94, v95
    buffer_store_dwordx4 v[96:99], v9, s[4:7], s36 offen sc1
    s_waitcnt lgkmcnt(4)
    v_mfma_f32_16x16x32_bf16 v[64:67], a[48:51], v[48:51], v[64:67]
    ds_read_b128 v[40:43], v13 offset:16384
    v_mfma_f32_16x16x32_bf16 v[68:71], a[52:55], v[48:51], v[68:71]
    v_mfma_f32_16x16x32_bf16 v[72:75], a[48:51], v[52:55], v[72:75]
    ds_read_b128 v[44:47], v13 offset:17408
    s_add_u32 m0, s34, 93312
    v_mfma_f32_16x16x32_bf16 v[76:79], a[52:55], v[52:55], v[76:79]
    buffer_load_dwordx4 v8, s[12:15], s35 offen offset:896 lds
    s_waitcnt lgkmcnt(4)
    v_mfma_f32_16x16x32_bf16 v[64:67], a[56:59], v[56:59], v[64:67]
    ds_read_b128 v[48:51], v12 offset:20480
    v_mfma_f32_16x16x32_bf16 v[68:71], a[60:63], v[56:59], v[68:71]
    v_mfma_f32_16x16x32_bf16 v[72:75], a[56:59], v[60:63], v[72:75]
    ds_read_b128 v[52:55], v12 offset:21504
    v_mfma_f32_16x16x32_bf16 v[76:79], a[60:63], v[60:63], v[76:79]
    buffer_store_dwordx4 v[100:103], v9, s[4:7], s36 offen offset:128 sc1
    s_add_u32 s36, s36, s37
    s_waitcnt vmcnt(8)
    s_barrier
    s_waitcnt lgkmcnt(4)
    v_mfma_f32_16x16x32_bf16 v[64:67], a[64:67], v[32:35], v[64:67]
    ds_read_b128 v[56:59], v13 offset:20480
    v_mfma_f32_16x16x32_bf16 v[68:71], a[68:71], v[32:35], v[68:71]
    v_mfma_f32_16x16x32_bf16 v[72:75], a[64:67], v[36:39], v[72:75]
    ds_read_b128 v[60:63], v13 offset:21504
    s_add_u32 m0, s34, 97280
    v_mfma_f32_16x16x32_bf16 v[76:79], a[68:71], v[36:39], v[76:79]
    buffer_load_dwordx4 v8, s[12:15], s35 offen offset:1024 lds
    s_waitcnt lgkmcnt(4)
    v_mfma_f32_16x16x32_bf16 v[64:67], a[72:75], v[40:43], v[64:67]
    ds_read_b128 v[32:35], v12 offset:24576
    v_mfma_f32_16x16x32_bf16 v[68:71], a[76:79], v[40:43], v[68:71]
    v_mfma_f32_16x16x32_bf16 v[72:75], a[72:75], v[44:47], v[72:75]
    ds_read_b128 v[36:39], v12 offset:25600
    v_mfma_f32_16x16x32_bf16 v[76:79], a[76:79], v[44:47], v[76:79]
    s_waitcnt lgkmcnt(4)
    v_mfma_f32_16x16x32_bf16 v[64:67], a[80:83], v[48:51], v[64:67]
    ds_read_b128 v[40:43], v13 offset:24576
    v_mfma_f32_16x16x32_bf16 v[68:71], a[84:87], v[48:51], v[68:71]
    v_and_b32 v9, 0xffffff, v9
    v_mfma_f32_16x16x32_bf16 v[72:75], a[80:83], v[52:55], v[72:75]
    ds_read_b128 v[44:47], v13 offset:25600
    s_add_u32 m0, s34, 101248
    v_mfma_f32_16x16x32_bf16 v[76:79], a[84:87], v[52:55], v[76:79]
    buffer_load_dwordx4 v8, s[12:15], s35 offen offset:1152 lds
    s_waitcnt lgkmcnt(4)
    v_mfma_f32_16x16x32_bf16 v[64:67], a[88:91], v[56:59], v[64:67]
    ds_read_b128 v[48:51], v12 offset:28672
    v_mfma_f32_16x16x32_bf16 v[68:71], a[92:95], v[56:59], v[68:71]
    v_mfma_f32_16x16x32_bf16 v[72:75], a[88:91], v[60:63], v[72:75]
    ds_read_b128 v[52:55], v12 offset:29696
    v_mfma_f32_16x16x32_bf16 v[76:79], a[92:95], v[60:63], v[76:79]
    s_waitcnt lgkmcnt(4)
    v_mfma_f32_16x16x32_bf16 v[64:67], a[96:99], v[32:35], v[64:67]
    ds_read_b128 v[56:59], v13 offset:28672
    v_mfma_f32_16x16x32_bf16 v[68:71], a[100:103], v[32:35], v[68:71]
    v_mfma_f32_16x16x32_bf16 v[72:75], a[96:99], v[36:39], v[72:75]
    ds_read_b128 v[60:63], v13 offset:29696
    s_add_u32 m0, s34, 105216
    v_mfma_f32_16x16x32_bf16 v[76:79], a[100:103], v[36:39], v[76:79]
    buffer_load_dwordx4 v8, s[12:15], s35 offen offset:1280 lds
    s_waitcnt lgkmcnt(4)
    v_mfma_f32_16x16x32_bf16 v[64:67], a[104:107], v[40:43], v[64:67]
    ds_read_b128 v[32:35], v12 offset:32768
    v_mfma_f32_16x16x32_bf16 v[68:71], a[108:111], v[40:43], v[68:71]
    v_mfma_f32_16x16x32_bf16 v[72:75], a[104:107], v[44:47], v[72:75]
    ds_read_b128 v[36:39], v12 offset:33792
    v_mfma_f32_16x16x32_bf16 v[76:79], a[108:111], v[44:47], v[76:79]
    s_waitcnt lgkmcnt(4)
    v_mfma_f32_16x16x32_bf16 v[64:67], a[112:115], v[48:51], v[64:67]
    ds_read_b128 v[40:43], v13 offset:32768
    v_mfma_f32_16x16x32_bf16 v[68:71], a[116:119], v[48:51], v[68:71]
    v_mfma_f32_16x16x32_bf16 v[72:75], a[112:115], v[52:55], v[72:75]
    ds_read_b128 v[44:47], v13 offset:33792
    s_add_u32 m0, s34, 109184
    v_mfma_f32_16x16x32_bf16 v[76:79], a[116:119], v[52:55], v[76:79]
    buffer_load_dwordx4 v8, s[12:15], s35 offen offset:1408 lds
    s_waitcnt lgkmcnt(4)
    v_mfma_f32_16x16x32_bf16 v[64:67], a[120:123], v[56:59], v[64:67]
    ds_read_b128 v[48:51], v12 offset:36864
    v_mfma_f32_16x16x32_bf16 v[68:71], a[124:127], v[56:59], v[68:71]
    v_mfma_f32_16x16x32_bf16 v[72:75], a[120:123], v[60:63], v[72:75]
    ds_read_b128 v[52:55], v12 offset:37888
    v_mfma_f32_16x16x32_bf16 v[76:79], a[124:127], v[60:63], v[76:79]
    s_waitcnt lgkmcnt(4)
    v_mfma_f32_16x16x32_bf16 v[64:67], a[128:131], v[32:35], v[64:67]
    ds_read_b128 v[56:59], v13 offset:36864
    v_mfma_f32_16x16x32_bf16 v[68:71], a[132:135], v[32:35], v[68:71]
    v_mfma_f32_16x16x32_bf16 v[72:75], a[128:131], v[36:39], v[72:75]
    ds_read_b128 v[60:63], v13 offset:37888
    s_add_u32 m0, s34, 113152
    v_mfma_f32_16x16x32_bf16 v[76:79], a[132:135], v[36:39], v[76:79]
    buffer_load_dwordx4 v8, s[12:15], s35 offen offset:1536 lds
    s_waitcnt lgkmcnt(4)
    v_mfma_f32_16x16x32_bf16 v[64:67], a[136:139], v[40:43], v[64:67]
    ds_read_b128 v[32:35], v12 offset:40960
    v_mfma_f32_16x16x32_bf16 v[68:71], a[140:143], v[40:43], v[68:71]
    v_mfma_f32_16x16x32_bf16 v[72:75], a[136:139], v[44:47], v[72:75]
    ds_read_b128 v[36:39], v12 offset:41984
    v_mfma_f32_16x16x32_bf16 v[76:79], a[140:143], v[44:47], v[76:79]
    s_waitcnt lgkmcnt(4)
    v_mfma_f32_16x16x32_bf16 v[64:67], a[144:147], v[48:51], v[64:67]
    ds_read_b128 v[40:43], v13 offset:40960
    v_mfma_f32_16x16x32_bf16 v[68:71], a[148:151], v[48:51], v[68:71]
    v_mfma_f32_16x16x32_bf16 v[72:75], a[144:147], v[52:55], v[72:75]
    ds_read_b128 v[44:47], v13 offset:41984
    s_add_u32 m0, s34, 117120
    v_mfma_f32_16x16x32_bf16 v[76:79], a[148:151], v[52:55], v[76:79]
    buffer_load_dwordx4 v8, s[12:15], s35 offen offset:1664 lds
    s_waitcnt lgkmcnt(4)
    v_mfma_f32_16x16x32_bf16 v[64:67], a[152:155], v[56:59], v[64:67]
    ds_read_b128 v[48:51], v12 offset:45056
    v_mfma_f32_16x16x32_bf16 v[68:71], a[156:159], v[56:59], v[68:71]
    v_mfma_f32_16x16x32_bf16 v[72:75], a[152:155], v[60:63], v[72:75]
    ds_read_b128 v[52:55], v12 offset:46080
    v_mfma_f32_16x16x32_bf16 v[76:79], a[156:159], v[60:63], v[76:79]
    s_waitcnt lgkmcnt(4)
    v_mfma_f32_16x16x32_bf16 v[64:67], a[160:163], v[32:35], v[64:67]
    ds_read_b128 v[56:59], v13 offset:45056
    v_mfma_f32_16x16x32_bf16 v[68:71], a[164:167], v[32:35], v[68:71]
    v_mfma_f32_16x16x32_bf16 v[72:75], a[160:163], v[36:39], v[72:75]
    ds_read_b128 v[60:63], v13 offset:46080
    s_add_u32 m0, s34, 121088
    v_mfma_f32_16x16x32_bf16 v[76:79], a[164:167], v[36:39], v[76:79]
    buffer_load_dwordx4 v8, s[12:15], s35 offen offset:1792 lds
    s_waitcnt lgkmcnt(4)
    v_mfma_f32_16x16x32_bf16 v[64:67], a[168:171], v[40:43], v[64:67]
    ds_read_b128 v[32:35], v12 offset:49152
    v_mfma_f32_16x16x32_bf16 v[68:71], a[172:175], v[40:43], v[68:71]
    v_mfma_f32_16x16x32_bf16 v[72:75], a[168:171], v[44:47], v[72:75]
    ds_read_b128 v[36:39], v12 offset:50176
    v_mfma_f32_16x16x32_bf16 v[76:79], a[172:175], v[44:47], v[76:79]
    s_waitcnt lgkmcnt(4)
    v_mfma_f32_16x16x32_bf16 v[64:67], a[176:179], v[48:51], v[64:67]
    ds_read_b128 v[40:43], v13 offset:49152
    v_mfma_f32_16x16x32_bf16 v[68:71], a[180:183], v[48:51], v[68:71]
    v_mfma_f32_16x16x32_bf16 v[72:75], a[176:179], v[52:55], v[72:75]
    ds_read_b128 v[44:47], v13 offset:50176
    s_add_u32 m0, s34, 125056
    v_mfma_f32_16x16x32_bf16 v[76:79], a[180:183], v[52:55], v[76:79]
    buffer_load_dwordx4 v8, s[12:15], s35 offen offset:1920 lds
    s_add_u32 s35, s35, 65536
    s_min_u32 s35, s35, s52
    s_waitcnt lgkmcnt(4)
    v_mfma_f32_16x16x32_bf16 v[64:67], a[184:187], v[56:59], v[64:67]
    ds_read_b128 v[48:51], v12 offset:53248
    v_mfma_f32_16x16x32_bf16 v[68:71], a[188:191], v[56:59], v[68:71]
    v_mfma_f32_16x16x32_bf16 v[72:75], a[184:187], v[60:63], v[72:75]
    ds_read_b128 v[52:55], v12 offset:54272
    v_mfma_f32_16x16x32_bf16 v[76:79], a[188:191], v[60:63], v[76:79]
    s_waitcnt vmcnt(8)
    s_barrier
    s_waitcnt lgkmcnt(4)
    v_mfma_f32_16x16x32_bf16 v[64:67], a[192:195], v[32:35], v[64:67]
    ds_read_b128 v[56:59], v13 offset:53248
    v_mfma_f32_16x16x32_bf16 v[68:71], a[196:199], v[32:35], v[68:71]
    v_mfma_f32_16x16x32_bf16 v[72:75], a[192:195], v[36:39], v[72:75]
    ds_read_b128 v[60:63], v13 offset:54272
    s_add_u32 m0, s34, 0
    v_mfma_f32_16x16x32_bf16 v[76:79], a[196:199], v[36:39], v[76:79]
    buffer_load_dwordx4 v8, s[12:15], s35 offen offset:0 lds
    s_waitcnt lgkmcnt(4)
    v_mfma_f32_16x16x32_bf16 v[64:67], a[200:203], v[40:43], v[64:67]
    ds_read_b128 v[32:35], v12 offset:57344
    v_mfma_f32_16x16x32_bf16 v[68:71], a[204:207], v[40:43], v[68:71]
    buffer_store_dword v11, v10, s[4:7], 0 offen sc1
    v_add_u32 v11, 1, v11
    v_mfma_f32_16x16x32_bf16 v[72:75], a[200:203], v[44:47], v[72:75]
    ds_read_b128 v[36:39], v12 offset:58368
    v_mfma_f32_16x16x32_bf16 v[76:79], a[204:207], v[44:47], v[76:79]
    s_waitcnt lgkmcnt(4)
    v_mfma_f32_16x16x32_bf16 v[64:67], a[208:211], v[48:51], v[64:67]
    ds_read_b128 v[40:43], v13 offset:57344
    v_mfma_f32_16x16x32_bf16 v[68:71], a[212:215], v[48:51], v[68:71]
    v_mfma_f32_16x16x32_bf16 v[72:75], a[208:211], v[52:55], v[72:75]
    ds_read_b128 v[44:47], v13 offset:58368
    s_add_u32 m0, s34, 3968
    v_mfma_f32_16x16x32_bf16 v[76:79], a[212:215], v[52:55], v[76:79]
    buffer_load_dwordx4 v8, s[12:15], s35 offen offset:128 lds
    s_waitcnt lgkmcnt(4)
    v_mfma_f32_16x16x32_bf16 v[64:67], a[216:219], v[56:59], v[64:67]
    ds_read_b128 v[48:51], v12 offset:61440
    v_mfma_f32_16x16x32_bf16 v[68:71], a[220:223], v[56:59], v[68:71]
    v_mfma_f32_16x16x32_bf16 v[72:75], a[216:219], v[60:63], v[72:75]
    ds_read_b128 v[52:55], v12 offset:62464
    v_mfma_f32_16x16x32_bf16 v[76:79], a[220:223], v[60:63], v[76:79]
    s_waitcnt lgkmcnt(4)
    v_mfma_f32_16x16x32_bf16 v[64:67], a[224:227], v[32:35], v[64:67]
    ds_read_b128 v[56:59], v13 offset:61440
    v_mfma_f32_16x16x32_bf16 v[68:71], a[228:231], v[32:35], v[68:71]
    v_mfma_f32_16x16x32_bf16 v[72:75], a[224:227], v[36:39], v[72:75]
    ds_read_b128 v[60:63], v13 offset:62464
    s_add_u32 m0, s34, 7936
    v_mfma_f32_16x16x32_bf16 v[76:79], a[228:231], v[36:39], v[76:79]
    buffer_load_dwordx4 v8, s[12:15], s35 offen offset:256 lds
    s_waitcnt lgkmcnt(4)
    v_mfma_f32_16x16x32_bf16 v[64:67], a[232:235], v[40:43], v[64:67]
    ds_read_b128 v[32:35], v14 offset:0
    v_mfma_f32_16x16x32_bf16 v[68:71], a[236:239], v[40:43], v[68:71]
    v_mfma_f32_16x16x32_bf16 v[72:75], a[232:235], v[44:47], v[72:75]
    ds_read_b128 v[36:39], v14 offset:1024
    v_mfma_f32_16x16x32_bf16 v[76:79], a[236:239], v[44:47], v[76:79]
    s_waitcnt lgkmcnt(4)
    v_mfma_f32_16x16x32_bf16 v[64:67], a[240:243], v[48:51], v[64:67]
    ds_read_b128 v[40:43], v15 offset:0
    v_mfma_f32_16x16x32_bf16 v[68:71], a[244:247], v[48:51], v[68:71]
    v_mfma_f32_16x16x32_bf16 v[72:75], a[240:243], v[52:55], v[72:75]
    ds_read_b128 v[44:47], v15 offset:1024
    s_add_u32 m0, s34, 11904
    v_mfma_f32_16x16x32_bf16 v[76:79], a[244:247], v[52:55], v[76:79]
    buffer_load_dwordx4 v8, s[12:15], s35 offen offset:384 lds
    s_waitcnt lgkmcnt(4)
    v_mfma_f32_16x16x32_bf16 v[64:67], a[248:251], v[56:59], v[64:67]
    ds_read_b128 v[48:51], v14 offset:4096
    v_mfma_f32_16x16x32_bf16 v[68:71], a[252:255], v[56:59], v[68:71]
    v_mfma_f32_16x16x32_bf16 v[72:75], a[248:251], v[60:63], v[72:75]
    ds_read_b128 v[52:55], v14 offset:5120
    v_mfma_f32_16x16x32_bf16 v[76:79], a[252:255], v[60:63], v[76:79]
    s_waitcnt lgkmcnt(4)
    v_mfma_f32_16x16x32_bf16 v[80:83], a[0:3], v[32:35], 0
    ds_read_b128 v[56:59], v15 offset:4096
    v_mfma_f32_16x16x32_bf16 v[84:87], a[4:7], v[32:35], 0
    v_mfma_f32_16x16x32_bf16 v[88:91], a[0:3], v[36:39], 0
    ds_read_b128 v[60:63], v15 offset:5120
    s_add_u32 m0, s34, 15872
    v_mfma_f32_16x16x32_bf16 v[92:95], a[4:7], v[36:39], 0
    buffer_load_dwordx4 v8, s[12:15], s35 offen offset:512 lds
    s_waitcnt lgkmcnt(4)
    v_mfma_f32_16x16x32_bf16 v[80:83], a[8:11], v[40:43], v[80:83]
    ds_read_b128 v[32:35], v14 offset:8192
    v_mfma_f32_16x16x32_bf16 v[84:87], a[12:15], v[40:43], v[84:87]
    v_mfma_f32_16x16x32_bf16 v[88:91], a[8:11], v[44:47], v[88:91]
    ds_read_b128 v[36:39], v14 offset:9216
    v_mfma_f32_16x16x32_bf16 v[92:95], a[12:15], v[44:47], v[92:95]
    s_waitcnt lgkmcnt(4)
    v_mfma_f32_16x16x32_bf16 v[80:83], a[16:19], v[48:51], v[80:83]
    ds_read_b128 v[40:43], v15 offset:8192
    v_mfma_f32_16x16x32_bf16 v[84:87], a[20:23], v[48:51], v[84:87]
    v_cvt_pk_bf16_f32 v96, v64, v65
    v_mfma_f32_16x16x32_bf16 v[88:91], a[16:19], v[52:55], v[88:91]
    ds_read_b128 v[44:47], v15 offset:9216
    s_add_u32 m0, s34, 19840
    v_mfma_f32_16x16x32_bf16 v[92:95], a[20:23], v[52:55], v[92:95]
    buffer_load_dwordx4 v8, s[12:15], s35 offen offset:640 lds
    v_cvt_pk_bf16_f32 v97, v66, v67
    s_waitcnt lgkmcnt(4)
    v_mfma_f32_16x16x32_bf16 v[80:83], a[24:27], v[56:59], v[80:83]
    ds_read_b128 v[48:51], v14 offset:12288
    v_mfma_f32_16x16x32_bf16 v[84:87], a[28:31], v[56:59], v[84:87]
    v_cvt_pk_bf16_f32 v98, v68, v69
    v_mfma_f32_16x16x32_bf16 v[88:91], a[24:27], v[60:63], v[88:91]
    ds_read_b128 v[52:55], v14 offset:13312
    v_mfma_f32_16x16x32_bf16 v[92:95], a[28:31], v[60:63], v[92:95]
    v_cvt_pk_bf16_f32 v99, v70, v71
    s_waitcnt lgkmcnt(4)
    v_mfma_f32_16x16x32_bf16 v[80:83], a[32:35], v[32:35], v[80:83]
    ds_read_b128 v[56:59], v15 offset:12288
    v_mfma_f32_16x16x32_bf16 v[84:87], a[36:39], v[32:35], v[84:87]
    v_cvt_pk_bf16_f32 v100, v72, v73
    v_mfma_f32_16x16x32_bf16 v[88:91], a[32:35], v[36:39], v[88:91]
    ds_read_b128 v[60:63], v15 offset:13312
    s_add_u32 m0, s34, 23808
    v_mfma_f32_16x16x32_bf16 v[92:95], a[36:39], v[36:39], v[92:95]
    buffer_load_dwordx4 v8, s[12:15], s35 offen offset:768 lds
    v_cvt_pk_bf16_f32 v101, v74, v75
    s_waitcnt lgkmcnt(4)
    v_mfma_f32_16x16x32_bf16 v[80:83], a[40:43], v[40:43], v[80:83]
    ds_read_b128 v[32:35], v14 offset:16384
    v_mfma_f32_16x16x32_bf16 v[84:87], a[44:47], v[40:43], v[84:87]
    v_cvt_pk_bf16_f32 v102, v76, v77
    v_mfma_f32_16x16x32_bf16 v[88:91], a[40:43], v[44:47], v[88:91]
    ds_read_b128 v[36:39], v14 offset:17408
    v_mfma_f32_16x16x32_bf16 v[92:95], a[44:47], v[44:47], v[92:95]
    v_cvt_pk_bf16_f32 v103, v78, v79
    buffer_store_dwordx4 v[96:99], v9, s[4:7], s36 offen sc1
    s_waitcnt lgkmcnt(4)
    v_mfma_f32_16x16x32_bf16 v[80:83], a[48:51], v[48:51], v[80:83]
    ds_read_b128 v[40:43], v15 offset:16384
    v_mfma_f32_16x16x32_bf16 v[84:87], a[52:55], v[48:51], v[84:87]
    v_mfma_f32_16x16x32_bf16 v[88:91], a[48:51], v[52:55], v[88:91]
    ds_read_b128 v[44:47], v15 offset:17408
    s_add_u32 m0, s34, 27776
    v_mfma_f32_16x16x32_bf16 v[92:95], a[52:55], v[52:55], v[92:95]
    buffer_load_dwordx4 v8, s[12:15], s35 offen offset:896 lds
    s_waitcnt lgkmcnt(4)
    v_mfma_f32_16x16x32_bf16 v[80:83], a[56:59], v[56:59], v[80:83]
    ds_read_b128 v[48:51], v14 offset:20480
    v_mfma_f32_16x16x32_bf16 v[84:87], a[60:63], v[56:59], v[84:87]
    v_mfma_f32_16x16x32_bf16 v[88:91], a[56:59], v[60:63], v[88:91]
    ds_read_b128 v[52:55], v14 offset:21504
    v_mfma_f32_16x16x32_bf16 v[92:95], a[60:63], v[60:63], v[92:95]
    buffer_store_dwordx4 v[100:103], v9, s[4:7], s36 offen offset:128 sc1
    s_add_u32 s36, s36, s37
    s_waitcnt vmcnt(8)
    s_barrier
    s_waitcnt lgkmcnt(4)
    v_mfma_f32_16x16x32_bf16 v[80:83], a[64:67], v[32:35], v[80:83]
    ds_read_b128 v[56:59], v15 offset:20480
    v_mfma_f32_16x16x32_bf16 v[84:87], a[68:71], v[32:35], v[84:87]
    v_mfma_f32_16x16x32_bf16 v[88:91], a[64:67], v[36:39], v[88:91]
    ds_read_b128 v[60:63], v15 offset:21504
    s_add_u32 m0, s34, 31744
    v_mfma_f32_16x16x32_bf16 v[92:95], a[68:71], v[36:39], v[92:95]
    buffer_load_dwordx4 v8, s[12:15], s35 offen offset:1024 lds
    s_waitcnt lgkmcnt(4)
    v_mfma_f32_16x16x32_bf16 v[80:83], a[72:75], v[40:43], v[80:83]
    ds_read_b128 v[32:35], v14 offset:24576
    v_mfma_f32_16x16x32_bf16 v[84:87], a[76:79], v[40:43], v[84:87]
    v_mfma_f32_16x16x32_bf16 v[88:91], a[72:75], v[44:47], v[88:91]
    ds_read_b128 v[36:39], v14 offset:25600
    v_mfma_f32_16x16x32_bf16 v[92:95], a[76:79], v[44:47], v[92:95]
    s_waitcnt lgkmcnt(4)
    v_mfma_f32_16x16x32_bf16 v[80:83], a[80:83], v[48:51], v[80:83]
    ds_read_b128 v[40:43], v15 offset:24576
    v_mfma_f32_16x16x32_bf16 v[84:87], a[84:87], v[48:51], v[84:87]
    v_mfma_f32_16x16x32_bf16 v[88:91], a[80:83], v[52:55], v[88:91]
    ds_read_b128 v[44:47], v15 offset:25600
    s_add_u32 m0, s34, 35712
    v_mfma_f32_16x16x32_bf16 v[92:95], a[84:87], v[52:55], v[92:95]
    buffer_load_dwordx4 v8, s[12:15], s35 offen offset:1152 lds
    s_waitcnt lgkmcnt(4)
    v_mfma_f32_16x16x32_bf16 v[80:83], a[88:91], v[56:59], v[80:83]
    ds_read_b128 v[48:51], v14 offset:28672
    v_mfma_f32_16x16x32_bf16 v[84:87], a[92:95], v[56:59], v[84:87]
    v_mfma_f32_16x16x32_bf16 v[88:91], a[88:91], v[60:63], v[88:91]
    ds_read_b128 v[52:55], v14 offset:29696
    v_mfma_f32_16x16x32_bf16 v[92:95], a[92:95], v[60:63], v[92:95]
    s_waitcnt lgkmcnt(4)
    v_mfma_f32_16x16x32_bf16 v[80:83], a[96:99], v[32:35], v[80:83]
    ds_read_b128 v[56:59], v15 offset:28672
    v_mfma_f32_16x16x32_bf16 v[84:87], a[100:103], v[32:35], v[84:87]
    v_mfma_f32_16x16x32_bf16 v[88:91], a[96:99], v[36:39], v[88:91]
    ds_read_b128 v[60:63], v15 offset:29696
    s_add_u32 m0, s34, 39680
    v_mfma_f32_16x16x32_bf16 v[92:95], a[100:103], v[36:39], v[92:95]
    buffer_load_dwordx4 v8, s[12:15], s35 offen offset:1280 lds
    s_waitcnt lgkmcnt(4)
    v_mfma_f32_16x16x32_bf16 v[80:83], a[104:107], v[40:43], v[80:83]
    ds_read_b128 v[32:35], v14 offset:32768
    v_mfma_f32_16x16x32_bf16 v[84:87], a[108:111], v[40:43], v[84:87]
    v_mfma_f32_16x16x32_bf16 v[88:91], a[104:107], v[44:47], v[88:91]
    ds_read_b128 v[36:39], v14 offset:33792
    v_mfma_f32_16x16x32_bf16 v[92:95], a[108:111], v[44:47], v[92:95]
    s_waitcnt lgkmcnt(4)
    v_mfma_f32_16x16x32_bf16 v[80:83], a[112:115], v[48:51], v[80:83]
    ds_read_b128 v[40:43], v15 offset:32768
    v_mfma_f32_16x16x32_bf16 v[84:87], a[116:119], v[48:51], v[84:87]
    v_mfma_f32_16x16x32_bf16 v[88:91], a[112:115], v[52:55], v[88:91]
    ds_read_b128 v[44:47], v15 offset:33792
    s_add_u32 m0, s34, 43648
    v_mfma_f32_16x16x32_bf16 v[92:95], a[116:119], v[52:55], v[92:95]
    buffer_load_dwordx4 v8, s[12:15], s35 offen offset:1408 lds
    s_waitcnt lgkmcnt(4)
    v_mfma_f32_16x16x32_bf16 v[80:83], a[120:123], v[56:59], v[80:83]
    ds_read_b128 v[48:51], v14 offset:36864
    v_mfma_f32_16x16x32_bf16 v[84:87], a[124:127], v[56:59], v[84:87]
    v_mfma_f32_16x16x32_bf16 v[88:91], a[120:123], v[60:63], v[88:91]
    ds_read_b128 v[52:55], v14 offset:37888
    v_mfma_f32_16x16x32_bf16 v[92:95], a[124:127], v[60:63], v[92:95]
    s_waitcnt lgkmcnt(4)
    v_mfma_f32_16x16x32_bf16 v[80:83], a[128:131], v[32:35], v[80:83]
    ds_read_b128 v[56:59], v15 offset:36864
    v_mfma_f32_16x16x32_bf16 v[84:87], a[132:135], v[32:35], v[84:87]
    v_mfma_f32_16x16x32_bf16 v[88:91], a[128:131], v[36:39], v[88:91]
    ds_read_b128 v[60:63], v15 offset:37888
    s_add_u32 m0, s34, 47616
    v_mfma_f32_16x16x32_bf16 v[92:95], a[132:135], v[36:39], v[92:95]
    buffer_load_dwordx4 v8, s[12:15], s35 offen offset:1536 lds
    s_waitcnt lgkmcnt(4)
    v_mfma_f32_16x16x32_bf16 v[80:83], a[136:139], v[40:43], v[80:83]
    ds_read_b128 v[32:35], v14 offset:40960
    v_mfma_f32_16x16x32_bf16 v[84:87], a[140:143], v[40:43], v[84:87]
    v_mfma_f32_16x16x32_bf16 v[88:91], a[136:139], v[44:47], v[88:91]
    ds_read_b128 v[36:39], v14 offset:41984
    v_mfma_f32_16x16x32_bf16 v[92:95], a[140:143], v[44:47], v[92:95]
    s_waitcnt lgkmcnt(4)
    v_mfma_f32_16x16x32_bf16 v[80:83], a[144:147], v[48:51], v[80:83]
    ds_read_b128 v[40:43], v15 offset:40960
    v_mfma_f32_16x16x32_bf16 v[84:87], a[148:151], v[48:51], v[84:87]
    v_mfma_f32_16x16x32_bf16 v[88:91], a[144:147], v[52:55], v[88:91]
    ds_read_b128 v[44:47], v15 offset:41984
    s_add_u32 m0, s34, 51584
    v_mfma_f32_16x16x32_bf16 v[92:95], a[148:151], v[52:55], v[92:95]
    buffer_load_dwordx4 v8, s[12:15], s35 offen offset:1664 lds
    s_waitcnt lgkmcnt(4)
    v_mfma_f32_16x16x32_bf16 v[80:83], a[152:155], v[56:59], v[80:83]
    ds_read_b128 v[48:51], v14 offset:45056
    v_mfma_f32_16x16x32_bf16 v[84:87], a[156:159], v[56:59], v[84:87]
    v_mfma_f32_16x16x32_bf16 v[88:91], a[152:155], v[60:63], v[88:91]
    ds_read_b128 v[52:55], v14 offset:46080
    v_mfma_f32_16x16x32_bf16 v[92:95], a[156:159], v[60:63], v[92:95]
    s_waitcnt lgkmcnt(4)
    v_mfma_f32_16x16x32_bf16 v[80:83], a[160:163], v[32:35], v[80:83]
    ds_read_b128 v[56:59], v15 offset:45056
    v_mfma_f32_16x16x32_bf16 v[84:87], a[164:167], v[32:35], v[84:87]
    v_mfma_f32_16x16x32_bf16 v[88:91], a[160:163], v[36:39], v[88:91]
    ds_read_b128 v[60:63], v15 offset:46080
    s_add_u32 m0, s34, 55552
    v_mfma_f32_16x16x32_bf16 v[92:95], a[164:167], v[36:39], v[92:95]
    buffer_load_dwordx4 v8, s[12:15], s35 offen offset:1792 lds
    s_waitcnt lgkmcnt(4)
    v_mfma_f32_16x16x32_bf16 v[80:83], a[168:171], v[40:43], v[80:83]
    ds_read_b128 v[32:35], v14 offset:49152
    v_mfma_f32_16x16x32_bf16 v[84:87], a[172:175], v[40:43], v[84:87]
    v_mfma_f32_16x16x32_bf16 v[88:91], a[168:171], v[44:47], v[88:91]
    ds_read_b128 v[36:39], v14 offset:50176
    v_mfma_f32_16x16x32_bf16 v[92:95], a[172:175], v[44:47], v[92:95]
    s_waitcnt lgkmcnt(4)
    v_mfma_f32_16x16x32_bf16 v[80:83], a[176:179], v[48:51], v[80:83]
    ds_read_b128 v[40:43], v15 offset:49152
    v_mfma_f32_16x16x32_bf16 v[84:87], a[180:183], v[48:51], v[84:87]
    v_mfma_f32_16x16x32_bf16 v[88:91], a[176:179], v[52:55], v[88:91]
    ds_read_b128 v[44:47], v15 offset:50176
    s_add_u32 m0, s34, 59520
    v_mfma_f32_16x16x32_bf16 v[92:95], a[180:183], v[52:55], v[92:95]
    buffer_load_dwordx4 v8, s[12:15], s35 offen offset:1920 lds
    s_add_u32 s35, s35, 65536
    s_min_u32 s35, s35, s52
    s_waitcnt lgkmcnt(4)
    v_mfma_f32_16x16x32_bf16 v[80:83], a[184:187], v[56:59], v[80:83]
    ds_read_b128 v[48:51], v14 offset:53248
    v_mfma_f32_16x16x32_bf16 v[84:87], a[188:191], v[56:59], v[84:87]
    v_mfma_f32_16x16x32_bf16 v[88:91], a[184:187], v[60:63], v[88:91]
    ds_read_b128 v[52:55], v14 offset:54272
    v_mfma_f32_16x16x32_bf16 v[92:95], a[188:191], v[60:63], v[92:95]
    s_waitcnt vmcnt(8)
    s_barrier
    s_waitcnt lgkmcnt(4)
    v_mfma_f32_16x16x32_bf16 v[80:83], a[192:195], v[32:35], v[80:83]
    ds_read_b128 v[56:59], v15 offset:53248
    v_mfma_f32_16x16x32_bf16 v[84:87], a[196:199], v[32:35], v[84:87]
    v_mfma_f32_16x16x32_bf16 v[88:91], a[192:195], v[36:39], v[88:91]
    ds_read_b128 v[60:63], v15 offset:54272
    s_add_u32 m0, s34, 65536
    v_mfma_f32_16x16x32_bf16 v[92:95], a[196:199], v[36:39], v[92:95]
    buffer_load_dwordx4 v8, s[12:15], s35 offen offset:0 lds
    s_waitcnt lgkmcnt(4)
    v_mfma_f32_16x16x32_bf16 v[80:83], a[200:203], v[40:43], v[80:83]
    ds_read_b128 v[32:35], v14 offset:57344
    v_mfma_f32_16x16x32_bf16 v[84:87], a[204:207], v[40:43], v[84:87]
    buffer_store_dword v11, v10, s[4:7], 0 offen sc1
    v_add_u32 v11, 1, v11
    v_mfma_f32_16x16x32_bf16 v[88:91], a[200:203], v[44:47], v[88:91]
    ds_read_b128 v[36:39], v14 offset:58368
    v_mfma_f32_16x16x32_bf16 v[92:95], a[204:207], v[44:47], v[92:95]
    s_waitcnt lgkmcnt(4)
    v_mfma_f32_16x16x32_bf16 v[80:83], a[208:211], v[48:51], v[80:83]
    ds_read_b128 v[40:43], v15 offset:57344
    v_mfma_f32_16x16x32_bf16 v[84:87], a[212:215], v[48:51], v[84:87]
    v_mfma_f32_16x16x32_bf16 v[88:91], a[208:211], v[52:55], v[88:91]
    ds_read_b128 v[44:47], v15 offset:58368
    s_add_u32 m0, s34, 69504
    v_mfma_f32_16x16x32_bf16 v[92:95], a[212:215], v[52:55], v[92:95]
    buffer_load_dwordx4 v8, s[12:15], s35 offen offset:128 lds
    s_waitcnt lgkmcnt(4)
    v_mfma_f32_16x16x32_bf16 v[80:83], a[216:219], v[56:59], v[80:83]
    ds_read_b128 v[48:51], v14 offset:61440
    v_mfma_f32_16x16x32_bf16 v[84:87], a[220:223], v[56:59], v[84:87]
    v_mfma_f32_16x16x32_bf16 v[88:91], a[216:219], v[60:63], v[88:91]
    ds_read_b128 v[52:55], v14 offset:62464
    v_mfma_f32_16x16x32_bf16 v[92:95], a[220:223], v[60:63], v[92:95]
    s_waitcnt lgkmcnt(4)
    v_mfma_f32_16x16x32_bf16 v[80:83], a[224:227], v[32:35], v[80:83]
    ds_read_b128 v[56:59], v15 offset:61440
    v_mfma_f32_16x16x32_bf16 v[84:87], a[228:231], v[32:35], v[84:87]
    v_mfma_f32_16x16x32_bf16 v[88:91], a[224:227], v[36:39], v[88:91]
    ds_read_b128 v[60:63], v15 offset:62464
    s_add_u32 m0, s34, 73472
    v_mfma_f32_16x16x32_bf16 v[92:95], a[228:231], v[36:39], v[92:95]
    buffer_load_dwordx4 v8, s[12:15], s35 offen offset:256 lds
    s_waitcnt lgkmcnt(4)
    v_mfma_f32_16x16x32_bf16 v[80:83], a[232:235], v[40:43], v[80:83]
    ds_read_b128 v[32:35], v12 offset:0
    v_mfma_f32_16x16x32_bf16 v[84:87], a[236:239], v[40:43], v[84:87]
    v_mfma_f32_16x16x32_bf16 v[88:91], a[232:235], v[44:47], v[88:91]
    ds_read_b128 v[36:39], v12 offset:1024
    v_mfma_f32_16x16x32_bf16 v[92:95], a[236:239], v[44:47], v[92:95]
    s_waitcnt lgkmcnt(4)
    v_mfma_f32_16x16x32_bf16 v[80:83], a[240:243], v[48:51], v[80:83]
    ds_read_b128 v[40:43], v13 offset:0
    v_mfma_f32_16x16x32_bf16 v[84:87], a[244:247], v[48:51], v[84:87]
    v_mfma_f32_16x16x32_bf16 v[88:91], a[240:243], v[52:55], v[88:91]
    ds_read_b128 v[44:47], v13 offset:1024
    s_add_u32 m0, s34, 77440
    v_mfma_f32_16x16x32_bf16 v[92:95], a[244:247], v[52:55], v[92:95]
    buffer_load_dwordx4 v8, s[12:15], s35 offen offset:384 lds
    s_waitcnt lgkmcnt(4)
    v_mfma_f32_16x16x32_bf16 v[80:83], a[248:251], v[56:59], v[80:83]
    ds_read_b128 v[48:51], v12 offset:4096
    v_mfma_f32_16x16x32_bf16 v[84:87], a[252:255], v[56:59], v[84:87]
    v_mfma_f32_16x16x32_bf16 v[88:91], a[248:251], v[60:63], v[88:91]
    ds_read_b128 v[52:55], v12 offset:5120
    v_mfma_f32_16x16x32_bf16 v[92:95], a[252:255], v[60:63], v[92:95]
    s_add_u32 s30, s30, 2
    s_cmp_lt_u32 s30, s51
    s_cbranch_scc1 sl_loop_73
    v_cvt_pk_bf16_f32 v96, v80, v81
    v_cvt_pk_bf16_f32 v97, v82, v83
    v_cvt_pk_bf16_f32 v98, v84, v85
    v_cvt_pk_bf16_f32 v99, v86, v87
    v_cvt_pk_bf16_f32 v100, v88, v89
    v_cvt_pk_bf16_f32 v101, v90, v91
    v_cvt_pk_bf16_f32 v102, v92, v93
    v_cvt_pk_bf16_f32 v103, v94, v95
    s_branch sl_e_72
sl_v_71:
sl_loop_74:
    s_waitcnt lgkmcnt(4)
    v_mfma_f32_16x16x32_bf16 v[64:67], v[32:35], a[0:3], 0
    ds_read_b128 v[56:59], v13 offset:4096
    v_mfma_f32_16x16x32_bf16 v[68:71], v[32:35], a[4:7], 0
    v_mfma_f32_16x16x32_bf16 v[72:75], v[36:39], a[0:3], 0
    ds_read_b128 v[60:63], v13 offset:5120
    s_add_u32 m0, s34, 81408
    v_mfma_f32_16x16x32_bf16 v[76:79], v[36:39], a[4:7], 0
    buffer_load_dwordx4 v8, s[12:15], s35 offen offset:512 lds
    s_waitcnt lgkmcnt(4)
    v_mfma_f32_16x16x32_bf16 v[64:67], v[40:43], a[8:11], v[64:67]
    ds_read_b128 v[32:35], v12 offset:8192
    v_mfma_f32_16x16x32_bf16 v[68:71], v[40:43], a[12:15], v[68:71]
    v_mfma_f32_16x16x32_bf16 v[72:75], v[44:47], a[8:11], v[72:75]
    ds_read_b128 v[36:39], v12 offset:9216
    v_mfma_f32_16x16x32_bf16 v[76:79], v[44:47], a[12:15], v[76:79]
    s_waitcnt lgkmcnt(4)
    v_mfma_f32_16x16x32_bf16 v[64:67], v[48:51], a[16:19], v[64:67]
    ds_read_b128 v[40:43], v13 offset:8192
    v_mfma_f32_16x16x32_bf16 v[68:71], v[48:51], a[20:23], v[68:71]
    v_cvt_pk_bf16_f32 v96, v80, v81
    v_mfma_f32_16x16x32_bf16 v[72:75], v[52:55], a[16:19], v[72:75]
    ds_read_b128 v[44:47], v13 offset:9216
    s_add_u32 m0, s34, 85376
    v_mfma_f32_16x16x32_bf16 v[76:79], v[52:55], a[20:23], v[76:79]
    buffer_load_dwordx4 v8, s[12:15], s35 offen offset:640 lds
    v_cvt_pk_bf16_f32 v97, v82, v83
    s_waitcnt lgkmcnt(4)
    v_mfma_f32_16x16x32_bf16 v[64:67], v[56:59], a[24:27], v[64:67]
    ds_read_b128 v[48:51], v12 offset:12288
    v_mfma_f32_16x16x32_bf16 v[68:71], v[56:59], a[28:31], v[68:71]
    v_cvt_pk_bf16_f32 v98, v88, v89
    v_mfma_f32_16x16x32_bf16 v[72:75], v[60:63], a[24:27], v[72:75]
    ds_read_b128 v[52:55], v12 offset:13312
    v_mfma_f32_16x16x32_bf16 v[76:79], v[60:63], a[28:31], v[76:79]
    v_cvt_pk_bf16_f32 v99, v90, v91
    s_waitcnt lgkmcnt(4)
    v_mfma_f32_16x16x32_bf16 v[64:67], v[32:35], a[32:35], v[64:67]
    ds_read_b128 v[56:59], v13 offset:12288
    v_mfma_f32_16x16x32_bf16 v[68:71], v[32:35], a[36:39], v[68:71]
    v_cvt_pk_bf16_f32 v100, v84, v85
    v_mfma_f32_16x16x32_bf16 v[72:75], v[36:39], a[32:35], v[72:75]
    ds_read_b128 v[60:63], v13 offset:13312
    s_add_u32 m0, s34, 89344
    v_mfma_f32_16x16x32_bf16 v[76:79], v[36:39], a[36:39], v[76:79]
    buffer_load_dwordx4 v8, s[12:15], s35 offen offset:768 lds
    v_cvt_pk_bf16_f32 v101, v86, v87
    s_waitcnt lgkmcnt(4)
    v_mfma_f32_16x16x32_bf16 v[64:67], v[40:43], a[40:43], v[64:67]
    ds_read_b128 v[32:35], v12 offset:16384
    v_mfma_f32_16x16x32_bf16 v[68:71], v[40:43], a[44:47], v[68:71]
    v_cvt_pk_bf16_f32 v102, v92, v93
    v_mfma_f32_16x16x32_bf16 v[72:75], v[44:47], a[40:43], v[72:75]
    ds_read_b128 v[36:39], v12 offset:17408
    v_mfma_f32_16x16x32_bf16 v[76:79], v[44:47], a[44:47], v[76:79]
    v_cvt_pk_bf16_f32 v103, v94, v95
    buffer_store_dwordx4 v[96:99], v9, s[4:7], s36 offen sc1
    s_waitcnt lgkmcnt(4)
    v_mfma_f32_16x16x32_bf16 v[64:67], v[48:51], a[48:51], v[64:67]
    ds_read_b128 v[40:43], v13 offset:16384
    v_mfma_f32_16x16x32_bf16 v[68:71], v[48:51], a[52:55], v[68:71]
    v_mfma_f32_16x16x32_bf16 v[72:75], v[52:55], a[48:51], v[72:75]
    ds_read_b128 v[44:47], v13 offset:17408
    s_add_u32 m0, s34, 93312
    v_mfma_f32_16x16x32_bf16 v[76:79], v[52:55], a[52:55], v[76:79]
    buffer_load_dwordx4 v8, s[12:15], s35 offen offset:896 lds
    s_waitcnt lgkmcnt(4)
    v_mfma_f32_16x16x32_bf16 v[64:67], v[56:59], a[56:59], v[64:67]
    ds_read_b128 v[48:51], v12 offset:20480
    v_mfma_f32_16x16x32_bf16 v[68:71], v[56:59], a[60:63], v[68:71]
    v_mfma_f32_16x16x32_bf16 v[72:75], v[60:63], a[56:59], v[72:75]
    ds_read_b128 v[52:55], v12 offset:21504
    v_mfma_f32_16x16x32_bf16 v[76:79], v[60:63], a[60:63], v[76:79]
    buffer_store_dwordx4 v[100:103], v9, s[4:7], s36 offen offset:128 sc1
    s_add_u32 s36, s36, s37
    s_waitcnt vmcnt(8)
    s_barrier
    s_waitcnt lgkmcnt(4)
    v_mfma_f32_16x16x32_bf16 v[64:67], v[32:35], a[64:67], v[64:67]
    ds_read_b128 v[56:59], v13 offset:20480
    v_mfma_f32_16x16x32_bf16 v[68:71], v[32:35], a[68:71], v[68:71]
    v_mfma_f32_16x16x32_bf16 v[72:75], v[36:39], a[64:67], v[72:75]
    ds_read_b128 v[60:63], v13 offset:21504
    s_add_u32 m0, s34, 97280
    v_mfma_f32_16x16x32_bf16 v[76:79], v[36:39], a[68:71], v[76:79]
    buffer_load_dwordx4 v8, s[12:15], s35 offen offset:1024 lds
    s_waitcnt lgkmcnt(4)
    v_mfma_f32_16x16x32_bf16 v[64:67], v[40:43], a[72:75], v[64:67]
    ds_read_b128 v[32:35], v12 offset:24576
    v_mfma_f32_16x16x32_bf16 v[68:71], v[40:43], a[76:79], v[68:71]
    v_mfma_f32_16x16x32_bf16 v[72:75], v[44:47], a[72:75], v[72:75]
    ds_read_b128 v[36:39], v12 offset:25600
    v_mfma_f32_16x16x32_bf16 v[76:79], v[44:47], a[76:79], v[76:79]
    s_waitcnt lgkmcnt(4)
    v_mfma_f32_16x16x32_bf16 v[64:67], v[48:51], a[80:83], v[64:67]
    ds_read_b128 v[40:43], v13 offset:24576
    v_mfma_f32_16x16x32_bf16 v[68:71], v[48:51], a[84:87], v[68:71]
    v_and_b32 v9, 0xffffff, v9
    v_mfma_f32_16x16x32_bf16 v[72:75], v[52:55], a[80:83], v[72:75]
    ds_read_b128 v[44:47], v13 offset:25600
    s_add_u32 m0, s34, 101248
    v_mfma_f32_16x16x32_bf16 v[76:79], v[52:55], a[84:87], v[76:79]
    buffer_load_dwordx4 v8, s[12:15], s35 offen offset:1152 lds
    s_waitcnt lgkmcnt(4)
    v_mfma_f32_16x16x32_bf16 v[64:67], v[56:59], a[88:91], v[64:67]
    ds_read_b128 v[48:51], v12 offset:28672
    v_mfma_f32_16x16x32_bf16 v[68:71], v[56:59], a[92:95], v[68:71]
    v_mfma_f32_16x16x32_bf16 v[72:75], v[60:63], a[88:91], v[72:75]
    ds_read_b128 v[52:55], v12 offset:29696
    v_mfma_f32_16x16x32_bf16 v[76:79], v[60:63], a[92:95], v[76:79]
    s_waitcnt lgkmcnt(4)
    v_mfma_f32_16x16x32_bf16 v[64:67], v[32:35], a[96:99], v[64:67]
    ds_read_b128 v[56:59], v13 offset:28672
    v_mfma_f32_16x16x32_bf16 v[68:71], v[32:35], a[100:103], v[68:71]
    v_mfma_f32_16x16x32_bf16 v[72:75], v[36:39], a[96:99], v[72:75]
    ds_read_b128 v[60:63], v13 offset:29696
    s_add_u32 m0, s34, 105216
    v_mfma_f32_16x16x32_bf16 v[76:79], v[36:39], a[100:103], v[76:79]
    buffer_load_dwordx4 v8, s[12:15], s35 offen offset:1280 lds
    s_waitcnt lgkmcnt(4)
    v_mfma_f32_16x16x32_bf16 v[64:67], v[40:43], a[104:107], v[64:67]
    ds_read_b128 v[32:35], v12 offset:32768
    v_mfma_f32_16x16x32_bf16 v[68:71], v[40:43], a[108:111], v[68:71]
    v_mfma_f32_16x16x32_bf16 v[72:75], v[44:47], a[104:107], v[72:75]
    ds_read_b128 v[36:39], v12 offset:33792
    v_mfma_f32_16x16x32_bf16 v[76:79], v[44:47], a[108:111], v[76:79]
    s_waitcnt lgkmcnt(4)
    v_mfma_f32_16x16x32_bf16 v[64:67], v[48:51], a[112:115], v[64:67]
    ds_read_b128 v[40:43], v13 offset:32768
    v_mfma_f32_16x16x32_bf16 v[68:71], v[48:51], a[116:119], v[68:71]
    v_mfma_f32_16x16x32_bf16 v[72:75], v[52:55], a[112:115], v[72:75]
    ds_read_b128 v[44:47], v13 offset:33792
    s_add_u32 m0, s34, 109184
    v_mfma_f32_16x16x32_bf16 v[76:79], v[52:55], a[116:119], v[76:79]
    buffer_load_dwordx4 v8, s[12:15], s35 offen offset:1408 lds
    s_waitcnt lgkmcnt(4)
    v_mfma_f32_16x16x32_bf16 v[64:67], v[56:59], a[120:123], v[64:67]
    ds_read_b128 v[48:51], v12 offset:36864
    v_mfma_f32_16x16x32_bf16 v[68:71], v[56:59], a[124:127], v[68:71]
    v_mfma_f32_16x16x32_bf16 v[72:75], v[60:63], a[120:123], v[72:75]
    ds_read_b128 v[52:55], v12 offset:37888
    v_mfma_f32_16x16x32_bf16 v[76:79], v[60:63], a[124:127], v[76:79]
    s_waitcnt lgkmcnt(4)
    v_mfma_f32_16x16x32_bf16 v[64:67], v[32:35], a[128:131], v[64:67]
    ds_read_b128 v[56:59], v13 offset:36864
    v_mfma_f32_16x16x32_bf16 v[68:71], v[32:35], a[132:135], v[68:71]
    v_mfma_f32_16x16x32_bf16 v[72:75], v[36:39], a[128:131], v[72:75]
    ds_read_b128 v[60:63], v13 offset:37888
    s_add_u32 m0, s34, 113152
    v_mfma_f32_16x16x32_bf16 v[76:79], v[36:39], a[132:135], v[76:79]
    buffer_load_dwordx4 v8, s[12:15], s35 offen offset:1536 lds
    s_waitcnt lgkmcnt(4)
    v_mfma_f32_16x16x32_bf16 v[64:67], v[40:43], a[136:139], v[64:67]
    ds_read_b128 v[32:35], v12 offset:40960
    v_mfma_f32_16x16x32_bf16 v[68:71], v[40:43], a[140:143], v[68:71]
    v_mfma_f32_16x16x32_bf16 v[72:75], v[44:47], a[136:139], v[72:75]
    ds_read_b128 v[36:39], v12 offset:41984
    v_mfma_f32_16x16x32_bf16 v[76:79], v[44:47], a[140:143], v[76:79]
    s_waitcnt lgkmcnt(4)
    v_mfma_f32_16x16x32_bf16 v[64:67], v[48:51], a[144:147], v[64:67]
    ds_read_b128 v[40:43], v13 offset:40960
    v_mfma_f32_16x16x32_bf16 v[68:71], v[48:51], a[148:151], v[68:71]
    v_mfma_f32_16x16x32_bf16 v[72:75], v[52:55], a[144:147], v[72:75]
    ds_read_b128 v[44:47], v13 offset:41984
    s_add_u32 m0, s34, 117120
    v_mfma_f32_16x16x32_bf16 v[76:79], v[52:55], a[148:151], v[76:79]
    buffer_load_dwordx4 v8, s[12:15], s35 offen offset:1664 lds
    s_waitcnt lgkmcnt(4)
    v_mfma_f32_16x16x32_bf16 v[64:67], v[56:59], a[152:155], v[64:67]
    ds_read_b128 v[48:51], v12 offset:45056
    v_mfma_f32_16x16x32_bf16 v[68:71], v[56:59], a[156:159], v[68:71]
    v_mfma_f32_16x16x32_bf16 v[72:75], v[60:63], a[152:155], v[72:75]
    ds_read_b128 v[52:55], v12 offset:46080
    v_mfma_f32_16x16x32_bf16 v[76:79], v[60:63], a[156:159], v[76:79]
    s_waitcnt lgkmcnt(4)
    v_mfma_f32_16x16x32_bf16 v[64:67], v[32:35], a[160:163], v[64:67]
    ds_read_b128 v[56:59], v13 offset:45056
    v_mfma_f32_16x16x32_bf16 v[68:71], v[32:35], a[164:167], v[68:71]
    v_mfma_f32_16x16x32_bf16 v[72:75], v[36:39], a[160:163], v[72:75]
    ds_read_b128 v[60:63], v13 offset:46080
    s_add_u32 m0, s34, 121088
    v_mfma_f32_16x16x32_bf16 v[76:79], v[36:39], a[164:167], v[76:79]
    buffer_load_dwordx4 v8, s[12:15], s35 offen offset:1792 lds
    s_waitcnt lgkmcnt(4)
    v_mfma_f32_16x16x32_bf16 v[64:67], v[40:43], a[168:171], v[64:67]
    ds_read_b128 v[32:35], v12 offset:49152
    v_mfma_f32_16x16x32_bf16 v[68:71], v[40:43], a[172:175], v[68:71]
    v_mfma_f32_16x16x32_bf16 v[72:75], v[44:47], a[168:171], v[72:75]
    ds_read_b128 v[36:39], v12 offset:50176
    v_mfma_f32_16x16x32_bf16 v[76:79], v[44:47], a[172:175], v[76:79]
    s_waitcnt lgkmcnt(4)
    v_mfma_f32_16x16x32_bf16 v[64:67], v[48:51], a[176:179], v[64:67]
    ds_read_b128 v[40:43], v13 offset:49152
    v_mfma_f32_16x16x32_bf16 v[68:71], v[48:51], a[180:183], v[68:71]
    v_mfma_f32_16x16x32_bf16 v[72:75], v[52:55], a[176:179], v[72:75]
    ds_read_b128 v[44:47], v13 offset:50176
    s_add_u32 m0, s34, 125056
    v_mfma_f32_16x16x32_bf16 v[76:79], v[52:55], a[180:183], v[76:79]
    buffer_load_dwordx4 v8, s[12:15], s35 offen offset:1920 lds
    s_add_u32 s35, s35, 65536
    s_min_u32 s35, s35, s52
    s_waitcnt lgkmcnt(4)
    v_mfma_f32_16x16x32_bf16 v[64:67], v[56:59], a[184:187], v[64:67]
    ds_read_b128 v[48:51], v12 offset:53248
    v_mfma_f32_16x16x32_bf16 v[68:71], v[56:59], a[188:191], v[68:71]
    v_mfma_f32_16x16x32_bf16 v[72:75], v[60:63], a[184:187], v[72:75]
    ds_read_b128 v[52:55], v12 offset:54272
    v_mfma_f32_16x16x32_bf16 v[76:79], v[60:63], a[188:191], v[76:79]
    s_waitcnt vmcnt(8)
    s_barrier
    s_waitcnt lgkmcnt(4)
    v_mfma_f32_16x16x32_bf16 v[64:67], v[32:35], a[192:195], v[64:67]
    ds_read_b128 v[56:59], v13 offset:53248
    v_mfma_f32_16x16x32_bf16 v[68:71], v[32:35], a[196:199], v[68:71]
    v_mfma_f32_16x16x32_bf16 v[72:75], v[36:39], a[192:195], v[72:75]
    ds_read_b128 v[60:63], v13 offset:54272
    s_add_u32 m0, s34, 0
    v_mfma_f32_16x16x32_bf16 v[76:79], v[36:39], a[196:199], v[76:79]
    buffer_load_dwordx4 v8, s[12:15], s35 offen offset:0 lds
    s_waitcnt lgkmcnt(4)
    v_mfma_f32_16x16x32_bf16 v[64:67], v[40:43], a[200:203], v[64:67]
    ds_read_b128 v[32:35], v12 offset:57344
    v_mfma_f32_16x16x32_bf16 v[68:71], v[40:43], a[204:207], v[68:71]
    buffer_store_dword v11, v10, s[4:7], 0 offen sc1
    v_add_u32 v11, 1, v11
    v_mfma_f32_16x16x32_bf16 v[72:75], v[44:47], a[200:203], v[72:75]
    ds_read_b128 v[36:39], v12 offset:58368
    v_mfma_f32_16x16x32_bf16 v[76:79], v[44:47], a[204:207], v[76:79]
    s_waitcnt lgkmcnt(4)
    v_mfma_f32_16x16x32_bf16 v[64:67], v[48:51], a[208:211], v[64:67]
    ds_read_b128 v[40:43], v13 offset:57344
    v_mfma_f32_16x16x32_bf16 v[68:71], v[48:51], a[212:215], v[68:71]
    v_mfma_f32_16x16x32_bf16 v[72:75], v[52:55], a[208:211], v[72:75]
    ds_read_b128 v[44:47], v13 offset:58368
    s_add_u32 m0, s34, 3968
    v_mfma_f32_16x16x32_bf16 v[76:79], v[52:55], a[212:215], v[76:79]
    buffer_load_dwordx4 v8, s[12:15], s35 offen offset:128 lds
    s_waitcnt lgkmcnt(4)
    v_mfma_f32_16x16x32_bf16 v[64:67], v[56:59], a[216:219], v[64:67]
    ds_read_b128 v[48:51], v12 offset:61440
    v_mfma_f32_16x16x32_bf16 v[68:71], v[56:59], a[220:223], v[68:71]
    v_mfma_f32_16x16x32_bf16 v[72:75], v[60:63], a[216:219], v[72:75]
    ds_read_b128 v[52:55], v12 offset:62464
    v_mfma_f32_16x16x32_bf16 v[76:79], v[60:63], a[220:223], v[76:79]
    s_waitcnt lgkmcnt(4)
    v_mfma_f32_16x16x32_bf16 v[64:67], v[32:35], a[224:227], v[64:67]
    ds_read_b128 v[56:59], v13 offset:61440
    v_mfma_f32_16x16x32_bf16 v[68:71], v[32:35], a[228:231], v[68:71]
    v_mfma_f32_16x16x32_bf16 v[72:75], v[36:39], a[224:227], v[72:75]
    ds_read_b128 v[60:63], v13 offset:62464
    s_add_u32 m0, s34, 7936
    v_mfma_f32_16x16x32_bf16 v[76:79], v[36:39], a[228:231], v[76:79]
    buffer_load_dwordx4 v8, s[12:15], s35 offen offset:256 lds
    s_waitcnt lgkmcnt(4)
    v_mfma_f32_16x16x32_bf16 v[64:67], v[40:43], a[232:235], v[64:67]
    ds_read_b128 v[32:35], v14 offset:0
    v_mfma_f32_16x16x32_bf16 v[68:71], v[40:43], a[236:239], v[68:71]
    v_mfma_f32_16x16x32_bf16 v[72:75], v[44:47], a[232:235], v[72:75]
    ds_read_b128 v[36:39], v14 offset:1024
    v_mfma_f32_16x16x32_bf16 v[76:79], v[44:47], a[236:239], v[76:79]
    s_waitcnt lgkmcnt(4)
    v_mfma_f32_16x16x32_bf16 v[64:67], v[48:51], a[240:243], v[64:67]
    ds_read_b128 v[40:43], v15 offset:0
    v_mfma_f32_16x16x32_bf16 v[68:71], v[48:51], a[244:247], v[68:71]
    v_mfma_f32_16x16x32_bf16 v[72:75], v[52:55], a[240:243], v[72:75]
    ds_read_b128 v[44:47], v15 offset:1024
    s_add_u32 m0, s34, 11904
    v_mfma_f32_16x16x32_bf16 v[76:79], v[52:55], a[244:247], v[76:79]
    buffer_load_dwordx4 v8, s[12:15], s35 offen offset:384 lds
    s_waitcnt lgkmcnt(4)
    v_mfma_f32_16x16x32_bf16 v[64:67], v[56:59], a[248:251], v[64:67]
    ds_read_b128 v[48:51], v14 offset:4096
    v_mfma_f32_16x16x32_bf16 v[68:71], v[56:59], a[252:255], v[68:71]
    v_mfma_f32_16x16x32_bf16 v[72:75], v[60:63], a[248:251], v[72:75]
    ds_read_b128 v[52:55], v14 offset:5120
    v_mfma_f32_16x16x32_bf16 v[76:79], v[60:63], a[252:255], v[76:79]
    s_waitcnt lgkmcnt(4)
    v_mfma_f32_16x16x32_bf16 v[80:83], v[32:35], a[0:3], 0
    ds_read_b128 v[56:59], v15 offset:4096
    v_mfma_f32_16x16x32_bf16 v[84:87], v[32:35], a[4:7], 0
    v_mfma_f32_16x16x32_bf16 v[88:91], v[36:39], a[0:3], 0
    ds_read_b128 v[60:63], v15 offset:5120
    s_add_u32 m0, s34, 15872
    v_mfma_f32_16x16x32_bf16 v[92:95], v[36:39], a[4:7], 0
    buffer_load_dwordx4 v8, s[12:15], s35 offen offset:512 lds
    s_waitcnt lgkmcnt(4)
    v_mfma_f32_16x16x32_bf16 v[80:83], v[40:43], a[8:11], v[80:83]
    ds_read_b128 v[32:35], v14 offset:8192
    v_mfma_f32_16x16x32_bf16 v[84:87], v[40:43], a[12:15], v[84:87]
    v_mfma_f32_16x16x32_bf16 v[88:91], v[44:47], a[8:11], v[88:91]
    ds_read_b128 v[36:39], v14 offset:9216
    v_mfma_f32_16x16x32_bf16 v[92:95], v[44:47], a[12:15], v[92:95]
    s_waitcnt lgkmcnt(4)
    v_mfma_f32_16x16x32_bf16 v[80:83], v[48:51], a[16:19], v[80:83]
    ds_read_b128 v[40:43], v15 offset:8192
    v_mfma_f32_16x16x32_bf16 v[84:87], v[48:51], a[20:23], v[84:87]
    v_cvt_pk_bf16_f32 v96, v64, v65
    v_mfma_f32_16x16x32_bf16 v[88:91], v[52:55], a[16:19], v[88:91]
    ds_read_b128 v[44:47], v15 offset:9216
    s_add_u32 m0, s34, 19840
    v_mfma_f32_16x16x32_bf16 v[92:95], v[52:55], a[20:23], v[92:95]
    buffer_load_dwordx4 v8, s[12:15], s35 offen offset:640 lds
    v_cvt_pk_bf16_f32 v97, v66, v67
    s_waitcnt lgkmcnt(4)
    v_mfma_f32_16x16x32_bf16 v[80:83], v[56:59], a[24:27], v[80:83]
    ds_read_b128 v[48:51], v14 offset:12288
    v_mfma_f32_16x16x32_bf16 v[84:87], v[56:59], a[28:31], v[84:87]
    v_cvt_pk_bf16_f32 v98, v72, v73
    v_mfma_f32_16x16x32_bf16 v[88:91], v[60:63], a[24:27], v[88:91]
    ds_read_b128 v[52:55], v14 offset:13312
    v_mfma_f32_16x16x32_bf16 v[92:95], v[60:63], a[28:31], v[92:95]
    v_cvt_pk_bf16_f32 v99, v74, v75
    s_waitcnt lgkmcnt(4)
    v_mfma_f32_16x16x32_bf16 v[80:83], v[32:35], a[32:35], v[80:83]
    ds_read_b128 v[56:59], v15 offset:12288
    v_mfma_f32_16x16x32_bf16 v[84:87], v[32:35], a[36:39], v[84:87]
    v_cvt_pk_bf16_f32 v100, v68, v69
    v_mfma_f32_16x16x32_bf16 v[88:91], v[36:39], a[32:35], v[88:91]
    ds_read_b128 v[60:63], v15 offset:13312
    s_add_u32 m0, s34, 23808
    v_mfma_f32_16x16x32_bf16 v[92:95], v[36:39], a[36:39], v[92:95]
    buffer_load_dwordx4 v8, s[12:15], s35 offen offset:768 lds
    v_cvt_pk_bf16_f32 v101, v70, v71
    s_waitcnt lgkmcnt(4)
    v_mfma_f32_16x16x32_bf16 v[80:83], v[40:43], a[40:43], v[80:83]
    ds_read_b128 v[32:35], v14 offset:16384
    v_mfma_f32_16x16x32_bf16 v[84:87], v[40:43], a[44:47], v[84:87]
    v_cvt_pk_bf16_f32 v102, v76, v77
    v_mfma_f32_16x16x32_bf16 v[88:91], v[44:47], a[40:43], v[88:91]
    ds_read_b128 v[36:39], v14 offset:17408
    v_mfma_f32_16x16x32_bf16 v[92:95], v[44:47], a[44:47], v[92:95]
    v_cvt_pk_bf16_f32 v103, v78, v79
    buffer_store_dwordx4 v[96:99], v9, s[4:7], s36 offen sc1
    s_waitcnt lgkmcnt(4)
    v_mfma_f32_16x16x32_bf16 v[80:83], v[48:51], a[48:51], v[80:83]
    ds_read_b128 v[40:43], v15 offset:16384
    v_mfma_f32_16x16x32_bf16 v[84:87], v[48:51], a[52:55], v[84:87]
    v_mfma_f32_16x16x32_bf16 v[88:91], v[52:55], a[48:51], v[88:91]
    ds_read_b128 v[44:47], v15 offset:17408
    s_add_u32 m0, s34, 27776
    v_mfma_f32_16x16x32_bf16 v[92:95], v[52:55], a[52:55], v[92:95]
    buffer_load_dwordx4 v8, s[12:15], s35 offen offset:896 lds
    s_waitcnt lgkmcnt(4)
    v_mfma_f32_16x16x32_bf16 v[80:83], v[56:59], a[56:59], v[80:83]
    ds_read_b128 v[48:51], v14 offset:20480
    v_mfma_f32_16x16x32_bf16 v[84:87], v[56:59], a[60:63], v[84:87]
    v_mfma_f32_16x16x32_bf16 v[88:91], v[60:63], a[56:59], v[88:91]
    ds_read_b128 v[52:55], v14 offset:21504
    v_mfma_f32_16x16x32_bf16 v[92:95], v[60:63], a[60:63], v[92:95]
    buffer_store_dwordx4 v[100:103], v9, s[4:7], s36 offen offset:128 sc1
    s_add_u32 s36, s36, s37
    s_waitcnt vmcnt(8)
    s_barrier
    s_waitcnt lgkmcnt(4)
    v_mfma_f32_16x16x32_bf16 v[80:83], v[32:35], a[64:67], v[80:83]
    ds_read_b128 v[56:59], v15 offset:20480
    v_mfma_f32_16x16x32_bf16 v[84:87], v[32:35], a[68:71], v[84:87]
    v_mfma_f32_16x16x32_bf16 v[88:91], v[36:39], a[64:67], v[88:91]
    ds_read_b128 v[60:63], v15 offset:21504
    s_add_u32 m0, s34, 31744
    v_mfma_f32_16x16x32_bf16 v[92:95], v[36:39], a[68:71], v[92:95]
    buffer_load_dwordx4 v8, s[12:15], s35 offen offset:1024 lds
    s_waitcnt lgkmcnt(4)
    v_mfma_f32_16x16x32_bf16 v[80:83], v[40:43], a[72:75], v[80:83]
    ds_read_b128 v[32:35], v14 offset:24576
    v_mfma_f32_16x16x32_bf16 v[84:87], v[40:43], a[76:79], v[84:87]
    v_mfma_f32_16x16x32_bf16 v[88:91], v[44:47], a[72:75], v[88:91]
    ds_read_b128 v[36:39], v14 offset:25600
    v_mfma_f32_16x16x32_bf16 v[92:95], v[44:47], a[76:79], v[92:95]
    s_waitcnt lgkmcnt(4)
    v_mfma_f32_16x16x32_bf16 v[80:83], v[48:51], a[80:83], v[80:83]
    ds_read_b128 v[40:43], v15 offset:24576
    v_mfma_f32_16x16x32_bf16 v[84:87], v[48:51], a[84:87], v[84:87]
    v_mfma_f32_16x16x32_bf16 v[88:91], v[52:55], a[80:83], v[88:91]
    ds_read_b128 v[44:47], v15 offset:25600
    s_add_u32 m0, s34, 35712
    v_mfma_f32_16x16x32_bf16 v[92:95], v[52:55], a[84:87], v[92:95]
    buffer_load_dwordx4 v8, s[12:15], s35 offen offset:1152 lds
    s_waitcnt lgkmcnt(4)
    v_mfma_f32_16x16x32_bf16 v[80:83], v[56:59], a[88:91], v[80:83]
    ds_read_b128 v[48:51], v14 offset:28672
    v_mfma_f32_16x16x32_bf16 v[84:87], v[56:59], a[92:95], v[84:87]
    v_mfma_f32_16x16x32_bf16 v[88:91], v[60:63], a[88:91], v[88:91]
    ds_read_b128 v[52:55], v14 offset:29696
    v_mfma_f32_16x16x32_bf16 v[92:95], v[60:63], a[92:95], v[92:95]
    s_waitcnt lgkmcnt(4)
    v_mfma_f32_16x16x32_bf16 v[80:83], v[32:35], a[96:99], v[80:83]
    ds_read_b128 v[56:59], v15 offset:28672
    v_mfma_f32_16x16x32_bf16 v[84:87], v[32:35], a[100:103], v[84:87]
    v_mfma_f32_16x16x32_bf16 v[88:91], v[36:39], a[96:99], v[88:91]
    ds_read_b128 v[60:63], v15 offset:29696
    s_add_u32 m0, s34, 39680
    v_mfma_f32_16x16x32_bf16 v[92:95], v[36:39], a[100:103], v[92:95]
    buffer_load_dwordx4 v8, s[12:15], s35 offen offset:1280 lds
    s_waitcnt lgkmcnt(4)
    v_mfma_f32_16x16x32_bf16 v[80:83], v[40:43], a[104:107], v[80:83]
    ds_read_b128 v[32:35], v14 offset:32768
    v_mfma_f32_16x16x32_bf16 v[84:87], v[40:43], a[108:111], v[84:87]
    v_mfma_f32_16x16x32_bf16 v[88:91], v[44:47], a[104:107], v[88:91]
    ds_read_b128 v[36:39], v14 offset:33792
    v_mfma_f32_16x16x32_bf16 v[92:95], v[44:47], a[108:111], v[92:95]
    s_waitcnt lgkmcnt(4)
    v_mfma_f32_16x16x32_bf16 v[80:83], v[48:51], a[112:115], v[80:83]
    ds_read_b128 v[40:43], v15 offset:32768
    v_mfma_f32_16x16x32_bf16 v[84:87], v[48:51], a[116:119], v[84:87]
    v_mfma_f32_16x16x32_bf16 v[88:91], v[52:55], a[112:115], v[88:91]
    ds_read_b128 v[44:47], v15 offset:33792
    s_add_u32 m0, s34, 43648
    v_mfma_f32_16x16x32_bf16 v[92:95], v[52:55], a[116:119], v[92:95]
    buffer_load_dwordx4 v8, s[12:15], s35 offen offset:1408 lds
    s_waitcnt lgkmcnt(4)
    v_mfma_f32_16x16x32_bf16 v[80:83], v[56:59], a[120:123], v[80:83]
    ds_read_b128 v[48:51], v14 offset:36864
    v_mfma_f32_16x16x32_bf16 v[84:87], v[56:59], a[124:127], v[84:87]
    v_mfma_f32_16x16x32_bf16 v[88:91], v[60:63], a[120:123], v[88:91]
    ds_read_b128 v[52:55], v14 offset:37888
    v_mfma_f32_16x16x32_bf16 v[92:95], v[60:63], a[124:127], v[92:95]
    s_waitcnt lgkmcnt(4)
    v_mfma_f32_16x16x32_bf16 v[80:83], v[32:35], a[128:131], v[80:83]
    ds_read_b128 v[56:59], v15 offset:36864
    v_mfma_f32_16x16x32_bf16 v[84:87], v[32:35], a[132:135], v[84:87]
    v_mfma_f32_16x16x32_bf16 v[88:91], v[36:39], a[128:131], v[88:91]
    ds_read_b128 v[60:63], v15 offset:37888
    s_add_u32 m0, s34, 47616
    v_mfma_f32_16x16x32_bf16 v[92:95], v[36:39], a[132:135], v[92:95]
    buffer_load_dwordx4 v8, s[12:15], s35 offen offset:1536 lds
    s_waitcnt lgkmcnt(4)
    v_mfma_f32_16x16x32_bf16 v[80:83], v[40:43], a[136:139], v[80:83]
    ds_read_b128 v[32:35], v14 offset:40960
    v_mfma_f32_16x16x32_bf16 v[84:87], v[40:43], a[140:143], v[84:87]
    v_mfma_f32_16x16x32_bf16 v[88:91], v[44:47], a[136:139], v[88:91]
    ds_read_b128 v[36:39], v14 offset:41984
    v_mfma_f32_16x16x32_bf16 v[92:95], v[44:47], a[140:143], v[92:95]
    s_waitcnt lgkmcnt(4)
    v_mfma_f32_16x16x32_bf16 v[80:83], v[48:51], a[144:147], v[80:83]
    ds_read_b128 v[40:43], v15 offset:40960
    v_mfma_f32_16x16x32_bf16 v[84:87], v[48:51], a[148:151], v[84:87]
    v_mfma_f32_16x16x32_bf16 v[88:91], v[52:55], a[144:147], v[88:91]
    ds_read_b128 v[44:47], v15 offset:41984
    s_add_u32 m0, s34, 51584
    v_mfma_f32_16x16x32_bf16 v[92:95], v[52:55], a[148:151], v[92:95]
    buffer_load_dwordx4 v8, s[12:15], s35 offen offset:1664 lds
    s_waitcnt lgkmcnt(4)
    v_mfma_f32_16x16x32_bf16 v[80:83], v[56:59], a[152:155], v[80:83]
    ds_read_b128 v[48:51], v14 offset:45056
    v_mfma_f32_16x16x32_bf16 v[84:87], v[56:59], a[156:159], v[84:87]
    v_mfma_f32_16x16x32_bf16 v[88:91], v[60:63], a[152:155], v[88:91]
    ds_read_b128 v[52:55], v14 offset:46080
    v_mfma_f32_16x16x32_bf16 v[92:95], v[60:63], a[156:159], v[92:95]
    s_waitcnt lgkmcnt(4)
    v_mfma_f32_16x16x32_bf16 v[80:83], v[32:35], a[160:163], v[80:83]
    ds_read_b128 v[56:59], v15 offset:45056
    v_mfma_f32_16x16x32_bf16 v[84:87], v[32:35], a[164:167], v[84:87]
    v_mfma_f32_16x16x32_bf16 v[88:91], v[36:39], a[160:163], v[88:91]
    ds_read_b128 v[60:63], v15 offset:46080
    s_add_u32 m0, s34, 55552
    v_mfma_f32_16x16x32_bf16 v[92:95], v[36:39], a[164:167], v[92:95]
    buffer_load_dwordx4 v8, s[12:15], s35 offen offset:1792 lds
    s_waitcnt lgkmcnt(4)
    v_mfma_f32_16x16x32_bf16 v[80:83], v[40:43], a[168:171], v[80:83]
    ds_read_b128 v[32:35], v14 offset:49152
    v_mfma_f32_16x16x32_bf16 v[84:87], v[40:43], a[172:175], v[84:87]
    v_mfma_f32_16x16x32_bf16 v[88:91], v[44:47], a[168:171], v[88:91]
    ds_read_b128 v[36:39], v14 offset:50176
    v_mfma_f32_16x16x32_bf16 v[92:95], v[44:47], a[172:175], v[92:95]
    s_waitcnt lgkmcnt(4)
    v_mfma_f32_16x16x32_bf16 v[80:83], v[48:51], a[176:179], v[80:83]
    ds_read_b128 v[40:43], v15 offset:49152
    v_mfma_f32_16x16x32_bf16 v[84:87], v[48:51], a[180:183], v[84:87]
    v_mfma_f32_16x16x32_bf16 v[88:91], v[52:55], a[176:179], v[88:91]
    ds_read_b128 v[44:47], v15 offset:50176
    s_add_u32 m0, s34, 59520
    v_mfma_f32_16x16x32_bf16 v[92:95], v[52:55], a[180:183], v[92:95]
    buffer_load_dwordx4 v8, s[12:15], s35 offen offset:1920 lds
    s_add_u32 s35, s35, 65536
    s_min_u32 s35, s35, s52
    s_waitcnt lgkmcnt(4)
    v_mfma_f32_16x16x32_bf16 v[80:83], v[56:59], a[184:187], v[80:83]
    ds_read_b128 v[48:51], v14 offset:53248
    v_mfma_f32_16x16x32_bf16 v[84:87], v[56:59], a[188:191], v[84:87]
    v_mfma_f32_16x16x32_bf16 v[88:91], v[60:63], a[184:187], v[88:91]
    ds_read_b128 v[52:55], v14 offset:54272
    v_mfma_f32_16x16x32_bf16 v[92:95], v[60:63], a[188:191], v[92:95]
    s_waitcnt vmcnt(8)
    s_barrier
    s_waitcnt lgkmcnt(4)
    v_mfma_f32_16x16x32_bf16 v[80:83], v[32:35], a[192:195], v[80:83]
    ds_read_b128 v[56:59], v15 offset:53248
    v_mfma_f32_16x16x32_bf16 v[84:87], v[32:35], a[196:199], v[84:87]
    v_mfma_f32_16x16x32_bf16 v[88:91], v[36:39], a[192:195], v[88:91]
    ds_read_b128 v[60:63], v15 offset:54272
    s_add_u32 m0, s34, 65536
    v_mfma_f32_16x16x32_bf16 v[92:95], v[36:39], a[196:199], v[92:95]
    buffer_load_dwordx4 v8, s[12:15], s35 offen offset:0 lds
    s_waitcnt lgkmcnt(4)
    v_mfma_f32_16x16x32_bf16 v[80:83], v[40:43], a[200:203], v[80:83]
    ds_read_b128 v[32:35], v14 offset:57344
    v_mfma_f32_16x16x32_bf16 v[84:87], v[40:43], a[204:207], v[84:87]
    buffer_store_dword v11, v10, s[4:7], 0 offen sc1
    v_add_u32 v11, 1, v11
    v_mfma_f32_16x16x32_bf16 v[88:91], v[44:47], a[200:203], v[88:91]
    ds_read_b128 v[36:39], v14 offset:58368
    v_mfma_f32_16x16x32_bf16 v[92:95], v[44:47], a[204:207], v[92:95]
    s_waitcnt lgkmcnt(4)
    v_mfma_f32_16x16x32_bf16 v[80:83], v[48:51], a[208:211], v[80:83]
    ds_read_b128 v[40:43], v15 offset:57344
    v_mfma_f32_16x16x32_bf16 v[84:87], v[48:51], a[212:215], v[84:87]
    v_mfma_f32_16x16x32_bf16 v[88:91], v[52:55], a[208:211], v[88:91]
    ds_read_b128 v[44:47], v15 offset:58368
    s_add_u32 m0, s34, 69504
    v_mfma_f32_16x16x32_bf16 v[92:95], v[52:55], a[212:215], v[92:95]
    buffer_load_dwordx4 v8, s[12:15], s35 offen offset:128 lds
    s_waitcnt lgkmcnt(4)
    v_mfma_f32_16x16x32_bf16 v[80:83], v[56:59], a[216:219], v[80:83]
    ds_read_b128 v[48:51], v14 offset:61440
    v_mfma_f32_16x16x32_bf16 v[84:87], v[56:59], a[220:223], v[84:87]
    v_mfma_f32_16x16x32_bf16 v[88:91], v[60:63], a[216:219], v[88:91]
    ds_read_b128 v[52:55], v14 offset:62464
    v_mfma_f32_16x16x32_bf16 v[92:95], v[60:63], a[220:223], v[92:95]
    s_waitcnt lgkmcnt(4)
    v_mfma_f32_16x16x32_bf16 v[80:83], v[32:35], a[224:227], v[80:83]
    ds_read_b128 v[56:59], v15 offset:61440
    v_mfma_f32_16x16x32_bf16 v[84:87], v[32:35], a[228:231], v[84:87]
    v_mfma_f32_16x16x32_bf16 v[88:91], v[36:39], a[224:227], v[88:91]
    ds_read_b128 v[60:63], v15 offset:62464
    s_add_u32 m0, s34, 73472
    v_mfma_f32_16x16x32_bf16 v[92:95], v[36:39], a[228:231], v[92:95]
    buffer_load_dwordx4 v8, s[12:15], s35 offen offset:256 lds
    s_waitcnt lgkmcnt(4)
    v_mfma_f32_16x16x32_bf16 v[80:83], v[40:43], a[232:235], v[80:83]
    ds_read_b128 v[32:35], v12 offset:0
    v_mfma_f32_16x16x32_bf16 v[84:87], v[40:43], a[236:239], v[84:87]
    v_mfma_f32_16x16x32_bf16 v[88:91], v[44:47], a[232:235], v[88:91]
    ds_read_b128 v[36:39], v12 offset:1024
    v_mfma_f32_16x16x32_bf16 v[92:95], v[44:47], a[236:239], v[92:95]
    s_waitcnt lgkmcnt(4)
    v_mfma_f32_16x16x32_bf16 v[80:83], v[48:51], a[240:243], v[80:83]
    ds_read_b128 v[40:43], v13 offset:0
    v_mfma_f32_16x16x32_bf16 v[84:87], v[48:51], a[244:247], v[84:87]
    v_mfma_f32_16x16x32_bf16 v[88:91], v[52:55], a[240:243], v[88:91]
    ds_read_b128 v[44:47], v13 offset:1024
    s_add_u32 m0, s34, 77440
    v_mfma_f32_16x16x32_bf16 v[92:95], v[52:55], a[244:247], v[92:95]
    buffer_load_dwordx4 v8, s[12:15], s35 offen offset:384 lds
    s_waitcnt lgkmcnt(4)
    v_mfma_f32_16x16x32_bf16 v[80:83], v[56:59], a[248:251], v[80:83]
    ds_read_b128 v[48:51], v12 offset:4096
    v_mfma_f32_16x16x32_bf16 v[84:87], v[56:59], a[252:255], v[84:87]
    v_mfma_f32_16x16x32_bf16 v[88:91], v[60:63], a[248:251], v[88:91]
    ds_read_b128 v[52:55], v12 offset:5120
    v_mfma_f32_16x16x32_bf16 v[92:95], v[60:63], a[252:255], v[92:95]
    s_add_u32 s30, s30, 2
    s_cmp_lt_u32 s30, s51
    s_cbranch_scc1 sl_loop_74
    v_cvt_pk_bf16_f32 v96, v80, v81
    v_cvt_pk_bf16_f32 v97, v82, v83
    s_nop 0
    v_cvt_pk_bf16_f32 v98, v88, v89
    v_cvt_pk_bf16_f32 v99, v90, v91
    v_cvt_pk_bf16_f32 v100, v84, v85
    v_cvt_pk_bf16_f32 v101, v86, v87
    v_cvt_pk_bf16_f32 v102, v92, v93
    v_cvt_pk_bf16_f32 v103, v94, v95
    s_branch sl_e_72
sl_e_72:
    buffer_store_dwordx4 v[96:99], v9, s[4:7], s36 offen sc1
    buffer_store_dwordx4 v[100:103], v9, s[4:7], s36 offen offset:128 sc1
    s_add_u32 s36, s36, s37
    s_waitcnt vmcnt(0) lgkmcnt(0)
    s_barrier
    buffer_store_dword v11, v10, s[4:7], 0 offen sc1
    s_branch L_ph2
L_ph2:
    s_cmp_ge_u32 s28, 96
    s_cbranch_scc1 L_ob
    s_cmp_ge_u32 s28, 80
    s_cbranch_scc1 L_att
    s_load_dwordx2 s[72:73], s[0:1], 40
    s_load_dwordx2 s[74:75], s[0:1], 80
    s_mul_i32 s44, s28, 205
    s_lshr_b32 s44, s44, 10
    s_mul_i32 s31, s44, 5
    s_sub_u32 s30, s28, s31
    s_waitcnt lgkmcnt(0)
    s_mov_b32 s8, s72
    s_and_b32 s9, s73, 0xffff
    s_mov_b32 s10, 8388608
    s_mov_b32 s11, 0x00020000
    s_mov_b32 s20, s74
    s_and_b32 s21, s75, 0xffff
    s_mov_b32 s22, 8388608
    s_mov_b32 s23, 0x00020000
    s_lshl_b32 s31, s29, 21
    s_lshl_b32 s33, s44, 7
    s_add_u32 s31, s31, s33
    v_lshrrev_b32 v6, 3, v1
    v_lshlrev_b32 v6, 11, v6
    v_and_b32 v4, 7, v1
    v_lshl_add_u32 v6, v4, 4, v6
    v_add_u32 v6, s31, v6
    s_lshl_b32 s31, s29, 15
    v_lshrrev_b32 v7, 5, v1
    v_lshlrev_b32 v7, 9, v7
    v_bfe_u32 v4, v1, 2, 2
    v_lshl_add_u32 v7, v4, 7, v7
    v_bfe_u32 v4, v1, 4, 1
    v_lshl_add_u32 v7, v4, 5, v7
    v_and_b32 v4, 3, v1
    v_lshl_add_u32 v7, v4, 3, v7
    v_add_u32 v7, s31, v7
    s_lshl_b32 s32, s29, 15
    s_add_u32 m0, s32, 0
    s_mov_b32 s38, 0
    buffer_load_dwordx4 v6, s[8:11], s38 offen lds
    s_add_u32 m0, s32, 1024
    s_add_u32 s38, s38, 16384
    buffer_load_dwordx4 v6, s[8:11], s38 offen lds
    s_add_u32 m0, s32, 2048
    s_add_u32 s38, s38, 16384
    buffer_load_dwordx4 v6, s[8:11], s38 offen lds
    s_add_u32 m0, s32, 3072
    s_add_u32 s38, s38, 16384
    buffer_load_dwordx4 v6, s[8:11], s38 offen lds
    s_add_u32 m0, s32, 4096
    s_add_u32 s38, s38, 16384
    buffer_load_dwordx4 v6, s[8:11], s38 offen lds
    s_add_u32 m0, s32, 5120
    s_add_u32 s38, s38, 16384
    buffer_load_dwordx4 v6, s[8:11], s38 offen lds
    s_add_u32 m0, s32, 6144
    s_add_u32 s38, s38, 16384
    buffer_load_dwordx4 v6, s[8:11], s38 offen lds
    s_add_u32 m0, s32, 7168
    s_add_u32 s38, s38, 16384
    buffer_load_dwordx4 v6, s[8:11], s38 offen lds
    s_add_u32 m0, s32, 8192
    s_add_u32 s38, s38, 16384
    buffer_load_dwordx4 v6, s[8:11], s38 offen lds
    s_add_u32 m0, s32, 9216
    s_add_u32 s38, s38, 16384
    buffer_load_dwordx4 v6, s[8:11], s38 offen lds
    s_add_u32 m0, s32, 10240
    s_add_u32 s38, s38, 16384
    buffer_load_dwordx4 v6, s[8:11], s38 offen lds
    s_add_u32 m0, s32, 11264
    s_add_u32 s38, s38, 16384
    buffer_load_dwordx4 v6, s[8:11], s38 offen lds
    s_add_u32 m0, s32, 12288
    s_add_u32 s38, s38, 16384
    buffer_load_dwordx4 v6, s[8:11], s38 offen lds
    s_add_u32 m0, s32, 13312
    s_add_u32 s38, s38, 16384
    buffer_load_dwordx4 v6, s[8:11], s38 offen lds
    s_add_u32 m0, s32, 14336
    s_add_u32 s38, s38, 16384
    buffer_load_dwordx4 v6, s[8:11], s38 offen lds
    s_add_u32 m0, s32, 15360
    s_add_u32 s38, s38, 16384
    buffer_load_dwordx4 v6, s[8:11], s38 offen lds
    s_add_u32 m0, s32, 16384
    s_add_u32 s38, s38, 16384
    buffer_load_dwordx4 v6, s[8:11], s38 offen lds
    s_add_u32 m0, s32, 17408
    s_add_u32 s38, s38, 16384
    buffer_load_dwordx4 v6, s[8:11], s38 offen lds
    s_add_u32 m0, s32, 18432
    s_add_u32 s38, s38, 16384
    buffer_load_dwordx4 v6, s[8:11], s38 offen lds
    s_add_u32 m0, s32, 19456
    s_add_u32 s38, s38, 16384
    buffer_load_dwordx4 v6, s[8:11], s38 offen lds
    s_add_u32 m0, s32, 20480
    s_add_u32 s38, s38, 16384
    buffer_load_dwordx4 v6, s[8:11], s38 offen lds
    s_add_u32 m0, s32, 21504
    s_add_u32 s38, s38, 16384
    buffer_load_dwordx4 v6, s[8:11], s38 offen lds
    s_add_u32 m0, s32, 22528
    s_add_u32 s38, s38, 16384
    buffer_load_dwordx4 v6, s[8:11], s38 offen lds
    s_add_u32 m0, s32, 23552
    s_add_u32 s38, s38, 16384
    buffer_load_dwordx4 v6, s[8:11], s38 offen lds
    s_add_u32 m0, s32, 24576
    s_add_u32 s38, s38, 16384
    buffer_load_dwordx4 v6, s[8:11], s38 offen lds
    s_add_u32 m0, s32, 25600
    s_add_u32 s38, s38, 16384
    buffer_load_dwordx4 v6, s[8:11], s38 offen lds
    s_add_u32 m0, s32, 26624
    s_add_u32 s38, s38, 16384
    buffer_load_dwordx4 v6, s[8:11], s38 offen lds
    s_add_u32 m0, s32, 27648
    s_add_u32 s38, s38, 16384
    buffer_load_dwordx4 v6, s[8:11], s38 offen lds
    s_add_u32 m0, s32, 28672
    s_add_u32 s38, s38, 16384
    buffer_load_dwordx4 v6, s[8:11], s38 offen lds
    s_add_u32 m0, s32, 29696
    s_add_u32 s38, s38, 16384
    buffer_load_dwordx4 v6, s[8:11], s38 offen lds
    s_add_u32 m0, s32, 30720
    s_add_u32 s38, s38, 16384
    buffer_load_dwordx4 v6, s[8:11], s38 offen lds
    s_add_u32 m0, s32, 31744
    s_add_u32 s38, s38, 16384
    buffer_load_dwordx4 v6, s[8:11], s38 offen lds
    s_waitcnt vmcnt(30)
    ds_read_b64_tr_b16 a[0:1], v7 offset:0
    ds_read_b64_tr_b16 a[2:3], v7 offset:1024
    ds_read_b64_tr_b16 a[4:5], v7 offset:64
    ds_read_b64_tr_b16 a[6:7], v7 offset:1088
    s_waitcnt vmcnt(28)
    ds_read_b64_tr_b16 a[8:9], v7 offset:2048
    ds_read_b64_tr_b16 a[10:11], v7 offset:3072
    ds_read_b64_tr_b16 a[12:13], v7 offset:2112
    ds_read_b64_tr_b16 a[14:15], v7 offset:3136
    s_waitcnt lgkmcnt(4)
    s_add_u32 m0, s32, 0
    s_add_u32 s38, s38, 16384
    buffer_load_dwordx4 v6, s[8:11], s38 offen lds
    s_add_u32 m0, s32, 1024
    s_add_u32 s38, s38, 16384
    buffer_load_dwordx4 v6, s[8:11], s38 offen lds
    s_waitcnt vmcnt(28)
    ds_read_b64_tr_b16 a[16:17], v7 offset:4096
    ds_read_b64_tr_b16 a[18:19], v7 offset:5120
    ds_read_b64_tr_b16 a[20:21], v7 offset:4160
    ds_read_b64_tr_b16 a[22:23], v7 offset:5184
    s_waitcnt lgkmcnt(4)
    s_add_u32 m0, s32, 2048
    s_add_u32 s38, s38, 16384
    buffer_load_dwordx4 v6, s[8:11], s38 offen lds
    s_add_u32 m0, s32, 3072
    s_add_u32 s38, s38, 16384
    buffer_load_dwordx4 v6, s[8:11], s38 offen lds
    s_waitcnt vmcnt(28)
    ds_read_b64_tr_b16 a[24:25], v7 offset:6144
    ds_read_b64_tr_b16 a[26:27], v7 offset:7168
    ds_read_b64_tr_b16 a[28:29], v7 offset:6208
    ds_read_b64_tr_b16 a[30:31], v7 offset:7232
    s_waitcnt lgkmcnt(4)
    s_add_u32 m0, s32, 4096
    s_add_u32 s38, s38, 16384
    buffer_load_dwordx4 v6, s[8:11], s38 offen lds
    s_add_u32 m0, s32, 5120
    s_add_u32 s38, s38, 16384
    buffer_load_dwordx4 v6, s[8:11], s38 offen lds
    s_waitcnt vmcnt(28)
    ds_read_b64_tr_b16 a[32:33], v7 offset:8192
    ds_read_b64_tr_b16 a[34:35], v7 offset:9216
    ds_read_b64_tr_b16 a[36:37], v7 offset:8256
    ds_read_b64_tr_b16 a[38:39], v7 offset:9280
    s_waitcnt lgkmcnt(4)
    s_add_u32 m0, s32, 6144
    s_add_u32 s38, s38, 16384
    buffer_load_dwordx4 v6, s[8:11], s38 offen lds
    s_add_u32 m0, s32, 7168
    s_add_u32 s38, s38, 16384
    buffer_load_dwordx4 v6, s[8:11], s38 offen lds
    s_waitcnt vmcnt(28)
    ds_read_b64_tr_b16 a[40:41], v7 offset:10240
    ds_read_b64_tr_b16 a[42:43], v7 offset:11264
    ds_read_b64_tr_b16 a[44:45], v7 offset:10304
    ds_read_b64_tr_b16 a[46:47], v7 offset:11328
    s_waitcnt lgkmcnt(4)
    s_add_u32 m0, s32, 8192
    s_add_u32 s38, s38, 16384
    buffer_load_dwordx4 v6, s[8:11], s38 offen lds
    s_add_u32 m0, s32, 9216
    s_add_u32 s38, s38, 16384
    buffer_load_dwordx4 v6, s[8:11], s38 offen lds
    s_waitcnt vmcnt(28)
    ds_read_b64_tr_b16 a[48:49], v7 offset:12288
    ds_read_b64_tr_b16 a[50:51], v7 offset:13312
    ds_read_b64_tr_b16 a[52:53], v7 offset:12352
    ds_read_b64_tr_b16 a[54:55], v7 offset:13376
    s_waitcnt lgkmcnt(4)
    s_add_u32 m0, s32, 10240
    s_add_u32 s38, s38, 16384
    buffer_load_dwordx4 v6, s[8:11], s38 offen lds
    s_add_u32 m0, s32, 11264
    s_add_u32 s38, s38, 16384
    buffer_load_dwordx4 v6, s[8:11], s38 offen lds
    s_waitcnt vmcnt(28)
    ds_read_b64_tr_b16 a[56:57], v7 offset:14336
    ds_read_b64_tr_b16 a[58:59], v7 offset:15360
    ds_read_b64_tr_b16 a[60:61], v7 offset:14400
    ds_read_b64_tr_b16 a[62:63], v7 offset:15424
    s_waitcnt lgkmcnt(4)
    s_add_u32 m0, s32, 12288
    s_add_u32 s38, s38, 16384
    buffer_load_dwordx4 v6, s[8:11], s38 offen lds
    s_add_u32 m0, s32, 13312
    s_add_u32 s38, s38, 16384
    buffer_load_dwordx4 v6, s[8:11], s38 offen lds
    s_waitcnt vmcnt(28)
    ds_read_b64_tr_b16 a[64:65], v7 offset:16384
    ds_read_b64_tr_b16 a[66:67], v7 offset:17408
    ds_read_b64_tr_b16 a[68:69], v7 offset:16448
    ds_read_b64_tr_b16 a[70:71], v7 offset:17472
    s_waitcnt lgkmcnt(4)
    s_add_u32 m0, s32, 14336
    s_add_u32 s38, s38, 16384
    buffer_load_dwordx4 v6, s[8:11], s38 offen lds
    s_add_u32 m0, s32, 15360
    s_add_u32 s38, s38, 16384
    buffer_load_dwordx4 v6, s[8:11], s38 offen lds
    s_waitcnt vmcnt(28)
    ds_read_b64_tr_b16 a[72:73], v7 offset:18432
    ds_read_b64_tr_b16 a[74:75], v7 offset:19456
    ds_read_b64_tr_b16 a[76:77], v7 offset:18496
    ds_read_b64_tr_b16 a[78:79], v7 offset:19520
    s_waitcnt lgkmcnt(4)
    s_add_u32 m0, s32, 16384
    s_add_u32 s38, s38, 16384
    buffer_load_dwordx4 v6, s[8:11], s38 offen lds
    s_add_u32 m0, s32, 17408
    s_add_u32 s38, s38, 16384
    buffer_load_dwordx4 v6, s[8:11], s38 offen lds
    s_waitcnt vmcnt(28)
    ds_read_b64_tr_b16 a[80:81], v7 offset:20480
    ds_read_b64_tr_b16 a[82:83], v7 offset:21504
    ds_read_b64_tr_b16 a[84:85], v7 offset:20544
    ds_read_b64_tr_b16 a[86:87], v7 offset:21568
    s_waitcnt lgkmcnt(4)
    s_add_u32 m0, s32, 18432
    s_add_u32 s38, s38, 16384
    buffer_load_dwordx4 v6, s[8:11], s38 offen lds
    s_add_u32 m0, s32, 19456
    s_add_u32 s38, s38, 16384
    buffer_load_dwordx4 v6, s[8:11], s38 offen lds
    s_waitcnt vmcnt(28)
    ds_read_b64_tr_b16 a[88:89], v7 offset:22528
    ds_read_b64_tr_b16 a[90:91], v7 offset:23552
    ds_read_b64_tr_b16 a[92:93], v7 offset:22592
    ds_read_b64_tr_b16 a[94:95], v7 offset:23616
    s_waitcnt lgkmcnt(4)
    s_add_u32 m0, s32, 20480
    s_add_u32 s38, s38, 16384
    buffer_load_dwordx4 v6, s[8:11], s38 offen lds
    s_add_u32 m0, s32, 21504
    s_add_u32 s38, s38, 16384
    buffer_load_dwordx4 v6, s[8:11], s38 offen lds
    s_waitcnt vmcnt(28)
    ds_read_b64_tr_b16 a[96:97], v7 offset:24576
    ds_read_b64_tr_b16 a[98:99], v7 offset:25600
    ds_read_b64_tr_b16 a[100:101], v7 offset:24640
    ds_read_b64_tr_b16 a[102:103], v7 offset:25664
    s_waitcnt lgkmcnt(4)
    s_add_u32 m0, s32, 22528
    s_add_u32 s38, s38, 16384
    buffer_load_dwordx4 v6, s[8:11], s38 offen lds
    s_add_u32 m0, s32, 23552
    s_add_u32 s38, s38, 16384
    buffer_load_dwordx4 v6, s[8:11], s38 offen lds
    s_waitcnt vmcnt(28)
    ds_read_b64_tr_b16 a[104:105], v7 offset:26624
    ds_read_b64_tr_b16 a[106:107], v7 offset:27648
    ds_read_b64_tr_b16 a[108:109], v7 offset:26688
    ds_read_b64_tr_b16 a[110:111], v7 offset:27712
    s_waitcnt lgkmcnt(4)
    s_add_u32 m0, s32, 24576
    s_add_u32 s38, s38, 16384
    buffer_load_dwordx4 v6, s[8:11], s38 offen lds
    s_add_u32 m0, s32, 25600
    s_add_u32 s38, s38, 16384
    buffer_load_dwordx4 v6, s[8:11], s38 offen lds
    s_waitcnt vmcnt(28)
    ds_read_b64_tr_b16 a[112:113], v7 offset:28672
    ds_read_b64_tr_b16 a[114:115], v7 offset:29696
    ds_read_b64_tr_b16 a[116:117], v7 offset:28736
    ds_read_b64_tr_b16 a[118:119], v7 offset:29760
    s_waitcnt lgkmcnt(4)
    s_add_u32 m0, s32, 26624
    s_add_u32 s38, s38, 16384
    buffer_load_dwordx4 v6, s[8:11], s38 offen lds
    s_add_u32 m0, s32, 27648
    s_add_u32 s38, s38, 16384
    buffer_load_dwordx4 v6, s[8:11], s38 offen lds
    s_waitcnt vmcnt(28)
    ds_read_b64_tr_b16 a[120:121], v7 offset:30720
    ds_read_b64_tr_b16 a[122:123], v7 offset:31744
    ds_read_b64_tr_b16 a[124:125], v7 offset:30784
    ds_read_b64_tr_b16 a[126:127], v7 offset:31808
    s_waitcnt lgkmcnt(4)
    s_add_u32 m0, s32, 28672
    s_add_u32 s38, s38, 16384
    buffer_load_dwordx4 v6, s[8:11], s38 offen lds
    s_add_u32 m0, s32, 29696
    s_add_u32 s38, s38, 16384
    buffer_load_dwordx4 v6, s[8:11], s38 offen lds
    s_waitcnt vmcnt(28)
    ds_read_b64_tr_b16 a[128:129], v7 offset:0
    ds_read_b64_tr_b16 a[130:131], v7 offset:1024
    ds_read_b64_tr_b16 a[132:133], v7 offset:64
    ds_read_b64_tr_b16 a[134:135], v7 offset:1088
    s_waitcnt lgkmcnt(4)
    s_add_u32 m0, s32, 30720
    s_add_u32 s38, s38, 16384
    buffer_load_dwordx4 v6, s[8:11], s38 offen lds
    s_add_u32 m0, s32, 31744
    s_add_u32 s38, s38, 16384
    buffer_load_dwordx4 v6, s[8:11], s38 offen lds
    s_waitcnt vmcnt(28)
    ds_read_b64_tr_b16 a[136:137], v7 offset:2048
    ds_read_b64_tr_b16 a[138:139], v7 offset:3072
    ds_read_b64_tr_b16 a[140:141], v7 offset:2112
    ds_read_b64_tr_b16 a[142:143], v7 offset:3136
    s_waitcnt lgkmcnt(4)
    s_add_u32 m0, s32, 0
    s_add_u32 s38, s38, 16384
    buffer_load_dwordx4 v6, s[8:11], s38 offen lds
    s_add_u32 m0, s32, 1024
    s_add_u32 s38, s38, 16384
    buffer_load_dwordx4 v6, s[8:11], s38 offen lds
    s_waitcnt vmcnt(28)
    ds_read_b64_tr_b16 a[144:145], v7 offset:4096
    ds_read_b64_tr_b16 a[146:147], v7 offset:5120
    ds_read_b64_tr_b16 a[148:149], v7 offset:4160
    ds_read_b64_tr_b16 a[150:151], v7 offset:5184
    s_waitcnt lgkmcnt(4)
    s_add_u32 m0, s32, 2048
    s_add_u32 s38, s38, 16384
    buffer_load_dwordx4 v6, s[8:11], s38 offen lds
    s_add_u32 m0, s32, 3072
    s_add_u32 s38, s38, 16384
    buffer_load_dwordx4 v6, s[8:11], s38 offen lds
    s_waitcnt vmcnt(28)
    ds_read_b64_tr_b16 a[152:153], v7 offset:6144
    ds_read_b64_tr_b16 a[154:155], v7 offset:7168
    ds_read_b64_tr_b16 a[156:157], v7 offset:6208
    ds_read_b64_tr_b16 a[158:159], v7 offset:7232
    s_waitcnt lgkmcnt(4)
    s_add_u32 m0, s32, 4096
    s_add_u32 s38, s38, 16384
    buffer_load_dwordx4 v6, s[8:11], s38 offen lds
    s_add_u32 m0, s32, 5120
    s_add_u32 s38, s38, 16384
    buffer_load_dwordx4 v6, s[8:11], s38 offen lds
    s_waitcnt vmcnt(28)
    ds_read_b64_tr_b16 a[160:161], v7 offset:8192
    ds_read_b64_tr_b16 a[162:163], v7 offset:9216
    ds_read_b64_tr_b16 a[164:165], v7 offset:8256
    ds_read_b64_tr_b16 a[166:167], v7 offset:9280
    s_waitcnt lgkmcnt(4)
    s_add_u32 m0, s32, 6144
    s_add_u32 s38, s38, 16384
    buffer_load_dwordx4 v6, s[8:11], s38 offen lds
    s_add_u32 m0, s32, 7168
    s_add_u32 s38, s38, 16384
    buffer_load_dwordx4 v6, s[8:11], s38 offen lds
    s_waitcnt vmcnt(28)
    ds_read_b64_tr_b16 a[168:169], v7 offset:10240
    ds_read_b64_tr_b16 a[170:171], v7 offset:11264
    ds_read_b64_tr_b16 a[172:173], v7 offset:10304
    ds_read_b64_tr_b16 a[174:175], v7 offset:11328
    s_waitcnt lgkmcnt(4)
    s_add_u32 m0, s32, 8192
    s_add_u32 s38, s38, 16384
    buffer_load_dwordx4 v6, s[8:11], s38 offen lds
    s_add_u32 m0, s32, 9216
    s_add_u32 s38, s38, 16384
    buffer_load_dwordx4 v6, s[8:11], s38 offen lds
    s_waitcnt vmcnt(28)
    ds_read_b64_tr_b16 a[176:177], v7 offset:12288
    ds_read_b64_tr_b16 a[178:179], v7 offset:13312
    ds_read_b64_tr_b16 a[180:181], v7 offset:12352
    ds_read_b64_tr_b16 a[182:183], v7 offset:13376
    s_waitcnt lgkmcnt(4)
    s_add_u32 m0, s32, 10240
    s_add_u32 s38, s38, 16384
    buffer_load_dwordx4 v6, s[8:11], s38 offen lds
    s_add_u32 m0, s32, 11264
    s_add_u32 s38, s38, 16384
    buffer_load_dwordx4 v6, s[8:11], s38 offen lds
    s_waitcnt vmcnt(28)
    ds_read_b64_tr_b16 a[184:185], v7 offset:14336
    ds_read_b64_tr_b16 a[186:187], v7 offset:15360
    ds_read_b64_tr_b16 a[188:189], v7 offset:14400
    ds_read_b64_tr_b16 a[190:191], v7 offset:15424
    s_waitcnt lgkmcnt(4)
    s_add_u32 m0, s32, 12288
    s_add_u32 s38, s38, 16384
    buffer_load_dwordx4 v6, s[8:11], s38 offen lds
    s_add_u32 m0, s32, 13312
    s_add_u32 s38, s38, 16384
    buffer_load_dwordx4 v6, s[8:11], s38 offen lds
    s_waitcnt vmcnt(28)
    ds_read_b64_tr_b16 a[192:193], v7 offset:16384
    ds_read_b64_tr_b16 a[194:195], v7 offset:17408
    ds_read_b64_tr_b16 a[196:197], v7 offset:16448
    ds_read_b64_tr_b16 a[198:199], v7 offset:17472
    s_waitcnt lgkmcnt(4)
    s_add_u32 m0, s32, 14336
    s_add_u32 s38, s38, 16384
    buffer_load_dwordx4 v6, s[8:11], s38 offen lds
    s_add_u32 m0, s32, 15360
    s_add_u32 s38, s38, 16384
    buffer_load_dwordx4 v6, s[8:11], s38 offen lds
    s_waitcnt vmcnt(28)
    ds_read_b64_tr_b16 a[200:201], v7 offset:18432
    ds_read_b64_tr_b16 a[202:203], v7 offset:19456
    ds_read_b64_tr_b16 a[204:205], v7 offset:18496
    ds_read_b64_tr_b16 a[206:207], v7 offset:19520
    s_waitcnt lgkmcnt(4)
    s_add_u32 m0, s32, 16384
    s_add_u32 s38, s38, 16384
    buffer_load_dwordx4 v6, s[8:11], s38 offen lds
    s_add_u32 m0, s32, 17408
    s_add_u32 s38, s38, 16384
    buffer_load_dwordx4 v6, s[8:11], s38 offen lds
    s_waitcnt vmcnt(28)
    ds_read_b64_tr_b16 a[208:209], v7 offset:20480
    ds_read_b64_tr_b16 a[210:211], v7 offset:21504
    ds_read_b64_tr_b16 a[212:213], v7 offset:20544
    ds_read_b64_tr_b16 a[214:215], v7 offset:21568
    s_waitcnt lgkmcnt(4)
    s_add_u32 m0, s32, 18432
    s_add_u32 s38, s38, 16384
    buffer_load_dwordx4 v6, s[8:11], s38 offen lds
    s_add_u32 m0, s32, 19456
    s_add_u32 s38, s38, 16384
    buffer_load_dwordx4 v6, s[8:11], s38 offen lds
    s_waitcnt vmcnt(28)
    ds_read_b64_tr_b16 a[216:217], v7 offset:22528
    ds_read_b64_tr_b16 a[218:219], v7 offset:23552
    ds_read_b64_tr_b16 a[220:221], v7 offset:22592
    ds_read_b64_tr_b16 a[222:223], v7 offset:23616
    s_waitcnt lgkmcnt(4)
    s_add_u32 m0, s32, 20480
    s_add_u32 s38, s38, 16384
    buffer_load_dwordx4 v6, s[8:11], s38 offen lds
    s_add_u32 m0, s32, 21504
    s_add_u32 s38, s38, 16384
    buffer_load_dwordx4 v6, s[8:11], s38 offen lds
    s_waitcnt vmcnt(28)
    ds_read_b64_tr_b16 a[224:225], v7 offset:24576
    ds_read_b64_tr_b16 a[226:227], v7 offset:25600
    ds_read_b64_tr_b16 a[228:229], v7 offset:24640
    ds_read_b64_tr_b16 a[230:231], v7 offset:25664
    s_waitcnt lgkmcnt(4)
    s_add_u32 m0, s32, 22528
    s_add_u32 s38, s38, 16384
    buffer_load_dwordx4 v6, s[8:11], s38 offen lds
    s_add_u32 m0, s32, 23552
    s_add_u32 s38, s38, 16384
    buffer_load_dwordx4 v6, s[8:11], s38 offen lds
    s_waitcnt vmcnt(28)
    ds_read_b64_tr_b16 a[232:233], v7 offset:26624
    ds_read_b64_tr_b16 a[234:235], v7 offset:27648
    ds_read_b64_tr_b16 a[236:237], v7 offset:26688
    ds_read_b64_tr_b16 a[238:239], v7 offset:27712
    s_waitcnt lgkmcnt(4)
    s_add_u32 m0, s32, 24576
    s_add_u32 s38, s38, 16384
    buffer_load_dwordx4 v6, s[8:11], s38 offen lds
    s_add_u32 m0, s32, 25600
    s_add_u32 s38, s38, 16384
    buffer_load_dwordx4 v6, s[8:11], s38 offen lds
    s_waitcnt vmcnt(28)
    ds_read_b64_tr_b16 a[240:241], v7 offset:28672
    ds_read_b64_tr_b16 a[242:243], v7 offset:29696
    ds_read_b64_tr_b16 a[244:245], v7 offset:28736
    ds_read_b64_tr_b16 a[246:247], v7 offset:29760
    s_waitcnt lgkmcnt(4)
    s_add_u32 m0, s32, 26624
    s_add_u32 s38, s38, 16384
    buffer_load_dwordx4 v6, s[8:11], s38 offen lds
    s_add_u32 m0, s32, 27648
    s_add_u32 s38, s38, 16384
    buffer_load_dwordx4 v6, s[8:11], s38 offen lds
    s_waitcnt vmcnt(28)
    ds_read_b64_tr_b16 a[248:249], v7 offset:30720
    ds_read_b64_tr_b16 a[250:251], v7 offset:31744
    ds_read_b64_tr_b16 a[252:253], v7 offset:30784
    ds_read_b64_tr_b16 a[254:255], v7 offset:31808
    s_waitcnt lgkmcnt(4)
    s_add_u32 m0, s32, 28672
    s_add_u32 s38, s38, 16384
    buffer_load_dwordx4 v6, s[8:11], s38 offen lds
    s_add_u32 m0, s32, 29696
    s_add_u32 s38, s38, 16384
    buffer_load_dwordx4 v6, s[8:11], s38 offen lds
    s_waitcnt vmcnt(28)
    ds_read_b64_tr_b16 v[128:129], v7 offset:0
    ds_read_b64_tr_b16 v[130:131], v7 offset:1024
    ds_read_b64_tr_b16 v[132:133], v7 offset:64
    ds_read_b64_tr_b16 v[134:135], v7 offset:1088
    s_waitcnt lgkmcnt(4)
    s_add_u32 m0, s32, 30720
    s_add_u32 s38, s38, 16384
    buffer_load_dwordx4 v6, s[8:11], s38 offen lds
    s_add_u32 m0, s32, 31744
    s_add_u32 s38, s38, 16384
    buffer_load_dwordx4 v6, s[8:11], s38 offen lds
    s_waitcnt vmcnt(28)
    ds_read_b64_tr_b16 v[136:137], v7 offset:2048
    ds_read_b64_tr_b16 v[138:139], v7 offset:3072
    ds_read_b64_tr_b16 v[140:141], v7 offset:2112
    ds_read_b64_tr_b16 v[142:143], v7 offset:3136
    s_waitcnt lgkmcnt(4)
    s_add_u32 m0, s32, 0
    s_add_u32 s38, s38, 16384
    buffer_load_dwordx4 v6, s[8:11], s38 offen lds
    s_add_u32 m0, s32, 1024
    s_add_u32 s38, s38, 16384
    buffer_load_dwordx4 v6, s[8:11], s38 offen lds
    s_waitcnt vmcnt(28)
    ds_read_b64_tr_b16 v[144:145], v7 offset:4096
    ds_read_b64_tr_b16 v[146:147], v7 offset:5120
    ds_read_b64_tr_b16 v[148:149], v7 offset:4160
    ds_read_b64_tr_b16 v[150:151], v7 offset:5184
    s_waitcnt lgkmcnt(4)
    s_add_u32 m0, s32, 2048
    s_add_u32 s38, s38, 16384
    buffer_load_dwordx4 v6, s[8:11], s38 offen lds
    s_add_u32 m0, s32, 3072
    s_add_u32 s38, s38, 16384
    buffer_load_dwordx4 v6, s[8:11], s38 offen lds
    s_waitcnt vmcnt(28)
    ds_read_b64_tr_b16 v[152:153], v7 offset:6144
    ds_read_b64_tr_b16 v[154:155], v7 offset:7168
    ds_read_b64_tr_b16 v[156:157], v7 offset:6208
    ds_read_b64_tr_b16 v[158:159], v7 offset:7232
    s_waitcnt lgkmcnt(4)
    s_add_u32 m0, s32, 4096
    s_add_u32 s38, s38, 16384
    buffer_load_dwordx4 v6, s[8:11], s38 offen lds
    s_add_u32 m0, s32, 5120
    s_add_u32 s38, s38, 16384
    buffer_load_dwordx4 v6, s[8:11], s38 offen lds
    s_waitcnt vmcnt(28)
    ds_read_b64_tr_b16 v[160:161], v7 offset:8192
    ds_read_b64_tr_b16 v[162:163], v7 offset:9216
    ds_read_b64_tr_b16 v[164:165], v7 offset:8256
    ds_read_b64_tr_b16 v[166:167], v7 offset:9280
    s_waitcnt lgkmcnt(4)
    s_add_u32 m0, s32, 6144
    s_add_u32 s38, s38, 16384
    buffer_load_dwordx4 v6, s[8:11], s38 offen lds
    s_add_u32 m0, s32, 7168
    s_add_u32 s38, s38, 16384
    buffer_load_dwordx4 v6, s[8:11], s38 offen lds
    s_waitcnt vmcnt(28)
    ds_read_b64_tr_b16 v[168:169], v7 offset:10240
    ds_read_b64_tr_b16 v[170:171], v7 offset:11264
    ds_read_b64_tr_b16 v[172:173], v7 offset:10304
    ds_read_b64_tr_b16 v[174:175], v7 offset:11328
    s_waitcnt lgkmcnt(4)
    s_add_u32 m0, s32, 8192
    s_add_u32 s38, s38, 16384
    buffer_load_dwordx4 v6, s[8:11], s38 offen lds
    s_add_u32 m0, s32, 9216
    s_add_u32 s38, s38, 16384
    buffer_load_dwordx4 v6, s[8:11], s38 offen lds
    s_waitcnt vmcnt(28)
    ds_read_b64_tr_b16 v[176:177], v7 offset:12288
    ds_read_b64_tr_b16 v[178:179], v7 offset:13312
    ds_read_b64_tr_b16 v[180:181], v7 offset:12352
    ds_read_b64_tr_b16 v[182:183], v7 offset:13376
    s_waitcnt lgkmcnt(4)
    s_add_u32 m0, s32, 10240
    s_add_u32 s38, s38, 16384
    buffer_load_dwordx4 v6, s[8:11], s38 offen lds
    s_add_u32 m0, s32, 11264
    s_add_u32 s38, s38, 16384
    buffer_load_dwordx4 v6, s[8:11], s38 offen lds
    s_waitcnt vmcnt(28)
    ds_read_b64_tr_b16 v[184:185], v7 offset:14336
    ds_read_b64_tr_b16 v[186:187], v7 offset:15360
    ds_read_b64_tr_b16 v[188:189], v7 offset:14400
    ds_read_b64_tr_b16 v[190:191], v7 offset:15424
    s_waitcnt lgkmcnt(4)
    s_add_u32 m0, s32, 12288
    s_add_u32 s38, s38, 16384
    buffer_load_dwordx4 v6, s[8:11], s38 offen lds
    s_add_u32 m0, s32, 13312
    s_add_u32 s38, s38, 16384
    buffer_load_dwordx4 v6, s[8:11], s38 offen lds
    s_waitcnt vmcnt(28)
    ds_read_b64_tr_b16 v[192:193], v7 offset:16384
    ds_read_b64_tr_b16 v[194:195], v7 offset:17408
    ds_read_b64_tr_b16 v[196:197], v7 offset:16448
    ds_read_b64_tr_b16 v[198:199], v7 offset:17472
    s_waitcnt lgkmcnt(4)
    s_add_u32 m0, s32, 14336
    s_add_u32 s38, s38, 16384
    buffer_load_dwordx4 v6, s[8:11], s38 offen lds
    s_add_u32 m0, s32, 15360
    s_add_u32 s38, s38, 16384
    buffer_load_dwordx4 v6, s[8:11], s38 offen lds
    s_waitcnt vmcnt(28)
    ds_read_b64_tr_b16 v[200:201], v7 offset:18432
    ds_read_b64_tr_b16 v[202:203], v7 offset:19456
    ds_read_b64_tr_b16 v[204:205], v7 offset:18496
    ds_read_b64_tr_b16 v[206:207], v7 offset:19520
    s_waitcnt lgkmcnt(4)
    s_add_u32 m0, s32, 16384
    s_add_u32 s38, s38, 16384
    buffer_load_dwordx4 v6, s[8:11], s38 offen lds
    s_add_u32 m0, s32, 17408
    s_add_u32 s38, s38, 16384
    buffer_load_dwordx4 v6, s[8:11], s38 offen lds
    s_waitcnt vmcnt(28)
    ds_read_b64_tr_b16 v[208:209], v7 offset:20480
    ds_read_b64_tr_b16 v[210:211], v7 offset:21504
    ds_read_b64_tr_b16 v[212:213], v7 offset:20544
    ds_read_b64_tr_b16 v[214:215], v7 offset:21568
    s_waitcnt lgkmcnt(4)
    s_add_u32 m0, s32, 18432
    s_add_u32 s38, s38, 16384
    buffer_load_dwordx4 v6, s[8:11], s38 offen lds
    s_add_u32 m0, s32, 19456
    s_add_u32 s38, s38, 16384
    buffer_load_dwordx4 v6, s[8:11], s38 offen lds
    s_waitcnt vmcnt(28)
    ds_read_b64_tr_b16 v[216:217], v7 offset:22528
    ds_read_b64_tr_b16 v[218:219], v7 offset:23552
    ds_read_b64_tr_b16 v[220:221], v7 offset:22592
    ds_read_b64_tr_b16 v[222:223], v7 offset:23616
    s_waitcnt lgkmcnt(4)
    s_add_u32 m0, s32, 20480
    s_add_u32 s38, s38, 16384
    buffer_load_dwordx4 v6, s[8:11], s38 offen lds
    s_add_u32 m0, s32, 21504
    s_add_u32 s38, s38, 16384
    buffer_load_dwordx4 v6, s[8:11], s38 offen lds
    s_waitcnt vmcnt(28)
    ds_read_b64_tr_b16 v[224:225], v7 offset:24576
    ds_read_b64_tr_b16 v[226:227], v7 offset:25600
    ds_read_b64_tr_b16 v[228:229], v7 offset:24640
    ds_read_b64_tr_b16 v[230:231], v7 offset:25664
    s_waitcnt lgkmcnt(4)
    s_add_u32 m0, s32, 22528
    s_add_u32 s38, s38, 16384
    buffer_load_dwordx4 v6, s[8:11], s38 offen lds
    s_add_u32 m0, s32, 23552
    s_add_u32 s38, s38, 16384
    buffer_load_dwordx4 v6, s[8:11], s38 offen lds
    s_waitcnt vmcnt(28)
    ds_read_b64_tr_b16 v[232:233], v7 offset:26624
    ds_read_b64_tr_b16 v[234:235], v7 offset:27648
    ds_read_b64_tr_b16 v[236:237], v7 offset:26688
    ds_read_b64_tr_b16 v[238:239], v7 offset:27712
    s_waitcnt lgkmcnt(4)
    s_add_u32 m0, s32, 24576
    s_add_u32 s38, s38, 16384
    buffer_load_dwordx4 v6, s[8:11], s38 offen lds
    s_add_u32 m0, s32, 25600
    s_add_u32 s38, s38, 16384
    buffer_load_dwordx4 v6, s[8:11], s38 offen lds
    s_waitcnt vmcnt(28)
    ds_read_b64_tr_b16 v[240:241], v7 offset:28672
    ds_read_b64_tr_b16 v[242:243], v7 offset:29696
    ds_read_b64_tr_b16 v[244:245], v7 offset:28736
    ds_read_b64_tr_b16 v[246:247], v7 offset:29760
    s_waitcnt lgkmcnt(4)
    s_add_u32 m0, s32, 26624
    s_add_u32 s38, s38, 16384
    buffer_load_dwordx4 v6, s[8:11], s38 offen lds
    s_add_u32 m0, s32, 27648
    s_add_u32 s38, s38, 16384
    buffer_load_dwordx4 v6, s[8:11], s38 offen lds
    s_waitcnt vmcnt(28)
    ds_read_b64_tr_b16 v[248:249], v7 offset:30720
    ds_read_b64_tr_b16 v[250:251], v7 offset:31744
    ds_read_b64_tr_b16 v[252:253], v7 offset:30784
    ds_read_b64_tr_b16 v[254:255], v7 offset:31808
    s_waitcnt lgkmcnt(4)
    s_add_u32 m0, s32, 28672
    s_add_u32 s38, s38, 16384
    buffer_load_dwordx4 v6, s[8:11], s38 offen lds
    s_add_u32 m0, s32, 29696
    s_add_u32 s38, s38, 16384
    buffer_load_dwordx4 v6, s[8:11], s38 offen lds
    s_waitcnt vmcnt(28)
    s_waitcnt lgkmcnt(0)
    s_add_u32 m0, s32, 30720
    s_add_u32 s38, s38, 16384
    buffer_load_dwordx4 v6, s[8:11], s38 offen lds
    s_add_u32 m0, s32, 31744
    s_add_u32 s38, s38, 16384
    buffer_load_dwordx4 v6, s[8:11], s38 offen lds
    s_waitcnt vmcnt(28)
    s_waitcnt vmcnt(26)
    s_waitcnt vmcnt(24)
    s_waitcnt vmcnt(22)
    s_waitcnt vmcnt(20)
    s_waitcnt vmcnt(18)
    s_waitcnt vmcnt(16)
    s_waitcnt vmcnt(14)
    s_waitcnt vmcnt(12)
    s_waitcnt vmcnt(10)
    s_waitcnt vmcnt(8)
    s_waitcnt vmcnt(6)
    s_waitcnt vmcnt(4)
    s_waitcnt vmcnt(2)
    s_waitcnt vmcnt(0)
    s_waitcnt lgkmcnt(0)
    s_lshl_b32 s31, s29, 16
    v_add_u32 v8, s31, v5
    s_lshl_b32 s31, s29, 13
    s_add_u32 s31, s31, 131072
    v_add_u32 v9, s31, v5
    s_lshl_b32 s31, s29, 7
    s_add_u32 s31, s31, 131072
    v_bfe_u32 v10, v1, 1, 2
    v_lshlrev_b32 v10, 10, v10
    v_and_b32 v4, 1, v1
    v_lshl_add_u32 v10, v4, 9, v10
    v_lshrrev_b32 v4, 3, v1
    v_lshl_add_u32 v10, v4, 4, v10
    v_add_u32 v10, s31, v10
    s_lshl_b32 s31, s29, 15
    s_lshl_b32 s33, s44, 7
    s_add_u32 s31, s31, s33
    v_lshrrev_b32 v11, 3, v1
    v_lshlrev_b32 v11, 12, v11
    v_and_b32 v4, 7, v1
    v_lshl_add_u32 v11, v4, 3, v11
    v_add_u32 v11, s31, v11
    v_and_b32 v12, 31, v1
    v_lshlrev_b32 v12, 7, v12
    v_add_u32 v12, 115343360, v12
    s_cmp_lg_u32 s29, 0
    s_cbranch_scc1 g_wdd_76
g_wd_75:
    s_load_dword s72, s[92:93], 0 glc
    s_add_u32 s41, s41, 1
    s_cmp_ge_u32 s41, 0x200000
    s_cbranch_scc1 g_wdd_76
    s_waitcnt lgkmcnt(0)
    s_and_b32 s72, s72, 0xffff
    s_cmp_ge_u32 s72, 256
    s_cbranch_scc1 g_wdd_76
    s_sleep 32
    s_branch g_wd_75
g_wdd_76:
    s_waitcnt lgkmcnt(0)
    s_barrier
o6_loop_77:
    s_lshl_b32 s47, s30, 18
    s_add_u32 s47, s47, 67108864
    s_sub_u32 s31, s30, 6
    s_and_b32 s52, s31, 1
    s_lshl_b32 s52, s52, 12
    s_add_u32 s52, s52, 24576
    s_cmp_lt_u32 s30, 6
    s_cselect_b32 s52, 12288, s52
o6_w_79:
    buffer_load_dword v13, v12, s[4:7], s52 offen sc1
    s_add_u32 s41, s41, 1
    s_cmp_ge_u32 s41, 0x200000
    s_cbranch_scc1 o6_wd_80
    s_waitcnt vmcnt(0)
    v_cmp_ge_u32 vcc, s30, v13
    s_cbranch_vccz o6_wd_80
    s_sleep 10
    s_branch o6_w_79
o6_wd_80:
    s_add_u32 s31, s47, 0
    buffer_load_dwordx4 v[64:67], v8, s[4:7], s31 offen sc1
    s_add_u32 s31, s47, 1024
    buffer_load_dwordx4 v[68:71], v8, s[4:7], s31 offen sc1
    s_add_u32 s31, s47, 2048
    buffer_load_dwordx4 v[72:75], v8, s[4:7], s31 offen sc1
    s_add_u32 s31, s47, 49152
    buffer_load_dwordx4 v[76:79], v8, s[4:7], s31 offen sc1
    s_add_u32 s31, s47, 3072
    buffer_load_dwordx4 v[80:83], v8, s[4:7], s31 offen sc1
    s_add_u32 s31, s47, 4096
    buffer_load_dwordx4 v[84:87], v8, s[4:7], s31 offen sc1
    s_add_u32 s31, s47, 5120
    buffer_load_dwordx4 v[88:91], v8, s[4:7], s31 offen sc1
    s_add_u32 s31, s47, 50176
    buffer_load_dwordx4 v[92:95], v8, s[4:7], s31 offen sc1
    s_add_u32 s31, s47, 6144
    buffer_load_dwordx4 v[96:99], v8, s[4:7], s31 offen sc1
    s_add_u32 s31, s47, 7168
    buffer_load_dwordx4 v[100:103], v8, s[4:7], s31 offen sc1
    s_add_u32 s31, s47, 8192
    buffer_load_dwordx4 v[104:107], v8, s[4:7], s31 offen sc1
    s_add_u32 s31, s47, 51200
    buffer_load_dwordx4 v[108:111], v8, s[4:7], s31 offen sc1
    s_add_u32 s31, s47, 9216
    buffer_load_dwordx4 v[112:115], v8, s[4:7], s31 offen sc1
    s_add_u32 s31, s47, 10240
    buffer_load_dwordx4 v[116:119], v8, s[4:7], s31 offen sc1
    s_add_u32 s31, s47, 11264
    buffer_load_dwordx4 v[120:123], v8, s[4:7], s31 offen sc1
o6_go_78:
    s_lshl_b32 s49, s30, 17
    s_add_u32 s35, s30, 5
    s_sub_u32 s31, s35, 6
    s_and_b32 s52, s31, 1
    s_lshl_b32 s52, s52, 12
    s_add_u32 s52, s52, 24576
    s_cmp_lt_u32 s35, 6
    s_cselect_b32 s52, 12288, s52
    ds_read_b64_tr_b16 v[16:17], v7 offset:0
    ds_read_b64_tr_b16 v[18:19], v7 offset:1024
    ds_read_b64_tr_b16 v[20:21], v7 offset:64
    ds_read_b64_tr_b16 v[22:23], v7 offset:1088
    s_waitcnt vmcnt(14)
    v_mfma_f32_32x32x16_bf16 v[32:47], a[0:3], v[64:67], 0
    s_add_u32 s31, s47, 52224
    buffer_load_dwordx4 v[124:127], v8, s[4:7], s31 offen sc1
    v_mfma_f32_32x32x16_bf16 v[48:63], a[4:7], v[64:67], 0
    s_waitcnt vmcnt(14)
    v_mfma_f32_32x32x16_bf16 v[32:47], a[8:11], v[68:71], v[32:47]
    s_add_u32 s31, s47, 12288
    buffer_load_dwordx4 v[64:67], v8, s[4:7], s31 offen sc1
    v_mfma_f32_32x32x16_bf16 v[48:63], a[12:15], v[68:71], v[48:63]
    s_waitcnt vmcnt(14)
    v_mfma_f32_32x32x16_bf16 v[32:47], a[16:19], v[72:75], v[32:47]
    s_add_u32 s31, s47, 13312
    buffer_load_dwordx4 v[68:71], v8, s[4:7], s31 offen sc1
    v_mfma_f32_32x32x16_bf16 v[48:63], a[20:23], v[72:75], v[48:63]
    s_waitcnt vmcnt(14)
    s_waitcnt lgkmcnt(0)
    v_mfma_f32_32x32x16_bf16 v[32:47], v[16:19], v[76:79], v[32:47]
    s_add_u32 s31, s47, 14336
    buffer_load_dwordx4 v[72:75], v8, s[4:7], s31 offen sc1
    v_mfma_f32_32x32x16_bf16 v[48:63], v[20:23], v[76:79], v[48:63]
    ds_read_b64_tr_b16 v[24:25], v7 offset:2048
    ds_read_b64_tr_b16 v[26:27], v7 offset:3072
    ds_read_b64_tr_b16 v[28:29], v7 offset:2112
    ds_read_b64_tr_b16 v[30:31], v7 offset:3136
    s_waitcnt vmcnt(14)
    v_mfma_f32_32x32x16_bf16 v[32:47], a[24:27], v[80:83], v[32:47]
    s_add_u32 s31, s47, 53248
    buffer_load_dwordx4 v[76:79], v8, s[4:7], s31 offen sc1
    v_mfma_f32_32x32x16_bf16 v[48:63], a[28:31], v[80:83], v[48:63]
    s_waitcnt vmcnt(14)
    v_mfma_f32_32x32x16_bf16 v[32:47], a[32:35], v[84:87], v[32:47]
    s_add_u32 s31, s47, 15360
    buffer_load_dwordx4 v[80:83], v8, s[4:7], s31 offen sc1
    v_mfma_f32_32x32x16_bf16 v[48:63], a[36:39], v[84:87], v[48:63]
    s_waitcnt vmcnt(14)
    v_mfma_f32_32x32x16_bf16 v[32:47], a[40:43], v[88:91], v[32:47]
    s_add_u32 s31, s47, 16384
    buffer_load_dwordx4 v[84:87], v8, s[4:7], s31 offen sc1
    v_mfma_f32_32x32x16_bf16 v[48:63], a[44:47], v[88:91], v[48:63]
    s_waitcnt vmcnt(14)
    s_waitcnt lgkmcnt(0)
    v_mfma_f32_32x32x16_bf16 v[32:47], v[24:27], v[92:95], v[32:47]
    s_add_u32 s31, s47, 17408
    buffer_load_dwordx4 v[88:91], v8, s[4:7], s31 offen sc1
    v_mfma_f32_32x32x16_bf16 v[48:63], v[28:31], v[92:95], v[48:63]
    ds_read_b64_tr_b16 v[16:17], v7 offset:4096
    ds_read_b64_tr_b16 v[18:19], v7 offset:5120
    ds_read_b64_tr_b16 v[20:21], v7 offset:4160
    ds_read_b64_tr_b16 v[22:23], v7 offset:5184
    s_waitcnt vmcnt(14)
    v_mfma_f32_32x32x16_bf16 v[32:47], a[48:51], v[96:99], v[32:47]
    s_add_u32 s31, s47, 54272
    buffer_load_dwordx4 v[92:95], v8, s[4:7], s31 offen sc1
    v_mfma_f32_32x32x16_bf16 v[48:63], a[52:55], v[96:99], v[48:63]
    s_waitcnt vmcnt(14)
    v_mfma_f32_32x32x16_bf16 v[32:47], a[56:59], v[100:103], v[32:47]
    s_add_u32 s31, s47, 18432
    buffer_load_dwordx4 v[96:99], v8, s[4:7], s31 offen sc1
    v_mfma_f32_32x32x16_bf16 v[48:63], a[60:63], v[100:103], v[48:63]
    s_waitcnt vmcnt(14)
    v_mfma_f32_32x32x16_bf16 v[32:47], a[64:67], v[104:107], v[32:47]
    s_add_u32 s31, s47, 19456
    buffer_load_dwordx4 v[100:103], v8, s[4:7], s31 offen sc1
    v_mfma_f32_32x32x16_bf16 v[48:63], a[68:71], v[104:107], v[48:63]
    s_waitcnt vmcnt(14)
    s_waitcnt lgkmcnt(0)
    v_mfma_f32_32x32x16_bf16 v[32:47], v[16:19], v[108:111], v[32:47]
    s_add_u32 s31, s47, 20480
    buffer_load_dwordx4 v[104:107], v8, s[4:7], s31 offen sc1
    v_mfma_f32_32x32x16_bf16 v[48:63], v[20:23], v[108:111], v[48:63]
    ds_read_b64_tr_b16 v[24:25], v7 offset:6144
    ds_read_b64_tr_b16 v[26:27], v7 offset:7168
    ds_read_b64_tr_b16 v[28:29], v7 offset:6208
    ds_read_b64_tr_b16 v[30:31], v7 offset:7232
    s_waitcnt vmcnt(14)
    v_mfma_f32_32x32x16_bf16 v[32:47], a[72:75], v[112:115], v[32:47]
    s_add_u32 s31, s47, 55296
    buffer_load_dwordx4 v[108:111], v8, s[4:7], s31 offen sc1
    v_mfma_f32_32x32x16_bf16 v[48:63], a[76:79], v[112:115], v[48:63]
    s_waitcnt vmcnt(14)
    v_mfma_f32_32x32x16_bf16 v[32:47], a[80:83], v[116:119], v[32:47]
    s_add_u32 s31, s47, 21504
    buffer_load_dwordx4 v[112:115], v8, s[4:7], s31 offen sc1
    v_mfma_f32_32x32x16_bf16 v[48:63], a[84:87], v[116:119], v[48:63]
    s_waitcnt vmcnt(14)
    v_mfma_f32_32x32x16_bf16 v[32:47], a[88:91], v[120:123], v[32:47]
    s_add_u32 s31, s47, 22528
    buffer_load_dwordx4 v[116:119], v8, s[4:7], s31 offen sc1
    v_mfma_f32_32x32x16_bf16 v[48:63], a[92:95], v[120:123], v[48:63]
    s_waitcnt vmcnt(14)
    s_waitcnt lgkmcnt(0)
    v_mfma_f32_32x32x16_bf16 v[32:47], v[24:27], v[124:127], v[32:47]
    s_add_u32 s31, s47, 23552
    buffer_load_dwordx4 v[120:123], v8, s[4:7], s31 offen sc1
    v_mfma_f32_32x32x16_bf16 v[48:63], v[28:31], v[124:127], v[48:63]
    ds_read_b64_tr_b16 v[16:17], v7 offset:8192
    ds_read_b64_tr_b16 v[18:19], v7 offset:9216
    ds_read_b64_tr_b16 v[20:21], v7 offset:8256
    ds_read_b64_tr_b16 v[22:23], v7 offset:9280
    s_waitcnt vmcnt(14)
    v_mfma_f32_32x32x16_bf16 v[32:47], a[96:99], v[64:67], v[32:47]
    s_add_u32 s31, s47, 56320
    buffer_load_dwordx4 v[124:127], v8, s[4:7], s31 offen sc1
    v_mfma_f32_32x32x16_bf16 v[48:63], a[100:103], v[64:67], v[48:63]
    s_waitcnt vmcnt(14)
    v_mfma_f32_32x32x16_bf16 v[32:47], a[104:107], v[68:71], v[32:47]
    s_add_u32 s31, s47, 24576
    buffer_load_dwordx4 v[64:67], v8, s[4:7], s31 offen sc1
    v_mfma_f32_32x32x16_bf16 v[48:63], a[108:111], v[68:71], v[48:63]
    s_waitcnt vmcnt(14)
    v_mfma_f32_32x32x16_bf16 v[32:47], a[112:115], v[72:75], v[32:47]
    s_add_u32 s31, s47, 25600
    buffer_load_dwordx4 v[68:71], v8, s[4:7], s31 offen sc1
    v_mfma_f32_32x32x16_bf16 v[48:63], a[116:119], v[72:75], v[48:63]
    s_waitcnt vmcnt(14)
    s_waitcnt lgkmcnt(0)
    v_mfma_f32_32x32x16_bf16 v[32:47], v[16:19], v[76:79], v[32:47]
    s_add_u32 s31, s47, 26624
    buffer_load_dwordx4 v[72:75], v8, s[4:7], s31 offen sc1
    v_mfma_f32_32x32x16_bf16 v[48:63], v[20:23], v[76:79], v[48:63]
    ds_read_b64_tr_b16 v[24:25], v7 offset:10240
    ds_read_b64_tr_b16 v[26:27], v7 offset:11264
    ds_read_b64_tr_b16 v[28:29], v7 offset:10304
    ds_read_b64_tr_b16 v[30:31], v7 offset:11328
    s_waitcnt vmcnt(14)
    v_mfma_f32_32x32x16_bf16 v[32:47], a[120:123], v[80:83], v[32:47]
    s_add_u32 s31, s47, 57344
    buffer_load_dwordx4 v[76:79], v8, s[4:7], s31 offen sc1
    v_mfma_f32_32x32x16_bf16 v[48:63], a[124:127], v[80:83], v[48:63]
    s_waitcnt vmcnt(14)
    v_mfma_f32_32x32x16_bf16 v[32:47], a[128:131], v[84:87], v[32:47]
    s_add_u32 s31, s47, 27648
    buffer_load_dwordx4 v[80:83], v8, s[4:7], s31 offen sc1
    v_mfma_f32_32x32x16_bf16 v[48:63], a[132:135], v[84:87], v[48:63]
    s_waitcnt vmcnt(14)
    v_mfma_f32_32x32x16_bf16 v[32:47], a[136:139], v[88:91], v[32:47]
    s_add_u32 s31, s47, 28672
    buffer_load_dwordx4 v[84:87], v8, s[4:7], s31 offen sc1
    v_mfma_f32_32x32x16_bf16 v[48:63], a[140:143], v[88:91], v[48:63]
    s_waitcnt vmcnt(14)
    s_waitcnt lgkmcnt(0)
    v_mfma_f32_32x32x16_bf16 v[32:47], v[24:27], v[92:95], v[32:47]
    s_add_u32 s31, s47, 29696
    buffer_load_dwordx4 v[88:91], v8, s[4:7], s31 offen sc1
    v_mfma_f32_32x32x16_bf16 v[48:63], v[28:31], v[92:95], v[48:63]
    ds_read_b64_tr_b16 v[16:17], v7 offset:12288
    ds_read_b64_tr_b16 v[18:19], v7 offset:13312
    ds_read_b64_tr_b16 v[20:21], v7 offset:12352
    ds_read_b64_tr_b16 v[22:23], v7 offset:13376
    s_waitcnt vmcnt(14)
    v_mfma_f32_32x32x16_bf16 v[32:47], a[144:147], v[96:99], v[32:47]
    s_add_u32 s31, s47, 58368
    buffer_load_dwordx4 v[92:95], v8, s[4:7], s31 offen sc1
    buffer_load_dword v13, v12, s[4:7], s52 offen sc1
    v_mfma_f32_32x32x16_bf16 v[48:63], a[148:151], v[96:99], v[48:63]
    s_waitcnt vmcnt(15)
    v_mfma_f32_32x32x16_bf16 v[32:47], a[152:155], v[100:103], v[32:47]
    s_add_u32 s31, s47, 30720
    buffer_load_dwordx4 v[96:99], v8, s[4:7], s31 offen sc1
    v_mfma_f32_32x32x16_bf16 v[48:63], a[156:159], v[100:103], v[48:63]
    s_waitcnt vmcnt(15)
    v_mfma_f32_32x32x16_bf16 v[32:47], a[160:163], v[104:107], v[32:47]
    s_add_u32 s31, s47, 31744
    buffer_load_dwordx4 v[100:103], v8, s[4:7], s31 offen sc1
    v_mfma_f32_32x32x16_bf16 v[48:63], a[164:167], v[104:107], v[48:63]
    s_waitcnt vmcnt(15)
    s_waitcnt lgkmcnt(0)
    v_mfma_f32_32x32x16_bf16 v[32:47], v[16:19], v[108:111], v[32:47]
    s_add_u32 s31, s47, 32768
    buffer_load_dwordx4 v[104:107], v8, s[4:7], s31 offen sc1
    v_mfma_f32_32x32x16_bf16 v[48:63], v[20:23], v[108:111], v[48:63]
    ds_read_b64_tr_b16 v[24:25], v7 offset:14336
    ds_read_b64_tr_b16 v[26:27], v7 offset:15360
    ds_read_b64_tr_b16 v[28:29], v7 offset:14400
    ds_read_b64_tr_b16 v[30:31], v7 offset:15424
    s_waitcnt vmcnt(15)
    v_mfma_f32_32x32x16_bf16 v[32:47], a[168:171], v[112:115], v[32:47]
    s_add_u32 s31, s47, 59392
    buffer_load_dwordx4 v[108:111], v8, s[4:7], s31 offen sc1
    v_mfma_f32_32x32x16_bf16 v[48:63], a[172:175], v[112:115], v[48:63]
    s_waitcnt vmcnt(15)
    v_mfma_f32_32x32x16_bf16 v[32:47], a[176:179], v[116:119], v[32:47]
    s_add_u32 s31, s47, 33792
    buffer_load_dwordx4 v[112:115], v8, s[4:7], s31 offen sc1
    v_mfma_f32_32x32x16_bf16 v[48:63], a[180:183], v[116:119], v[48:63]
    s_waitcnt vmcnt(15)
    v_mfma_f32_32x32x16_bf16 v[32:47], a[184:187], v[120:123], v[32:47]
    s_add_u32 s31, s47, 34816
    buffer_load_dwordx4 v[116:119], v8, s[4:7], s31 offen sc1
    v_mfma_f32_32x32x16_bf16 v[48:63], a[188:191], v[120:123], v[48:63]
    s_waitcnt vmcnt(15)
    s_waitcnt lgkmcnt(0)
    v_mfma_f32_32x32x16_bf16 v[32:47], v[24:27], v[124:127], v[32:47]
    s_add_u32 s31, s47, 35840
    buffer_load_dwordx4 v[120:123], v8, s[4:7], s31 offen sc1
    v_mfma_f32_32x32x16_bf16 v[48:63], v[28:31], v[124:127], v[48:63]
    ds_read_b64_tr_b16 v[16:17], v7 offset:16384
    ds_read_b64_tr_b16 v[18:19], v7 offset:17408
    ds_read_b64_tr_b16 v[20:21], v7 offset:16448
    ds_read_b64_tr_b16 v[22:23], v7 offset:17472
    s_waitcnt vmcnt(15)
    v_mfma_f32_32x32x16_bf16 v[32:47], a[192:195], v[64:67], v[32:47]
    s_add_u32 s31, s47, 60416
    buffer_load_dwordx4 v[124:127], v8, s[4:7], s31 offen sc1
    v_mfma_f32_32x32x16_bf16 v[48:63], a[196:199], v[64:67], v[48:63]
    s_waitcnt vmcnt(15)
    v_mfma_f32_32x32x16_bf16 v[32:47], a[200:203], v[68:71], v[32:47]
    s_add_u32 s31, s47, 36864
    buffer_load_dwordx4 v[64:67], v8, s[4:7], s31 offen sc1
    v_mfma_f32_32x32x16_bf16 v[48:63], a[204:207], v[68:71], v[48:63]
    s_waitcnt vmcnt(15)
    v_mfma_f32_32x32x16_bf16 v[32:47], a[208:211], v[72:75], v[32:47]
    s_add_u32 s31, s47, 37888
    buffer_load_dwordx4 v[68:71], v8, s[4:7], s31 offen sc1
    v_mfma_f32_32x32x16_bf16 v[48:63], a[212:215], v[72:75], v[48:63]
    s_waitcnt vmcnt(15)
    s_waitcnt lgkmcnt(0)
    v_mfma_f32_32x32x16_bf16 v[32:47], v[16:19], v[76:79], v[32:47]
    s_add_u32 s31, s47, 38912
    buffer_load_dwordx4 v[72:75], v8, s[4:7], s31 offen sc1
    v_mfma_f32_32x32x16_bf16 v[48:63], v[20:23], v[76:79], v[48:63]
    ds_read_b64_tr_b16 v[24:25], v7 offset:18432
    ds_read_b64_tr_b16 v[26:27], v7 offset:19456
    ds_read_b64_tr_b16 v[28:29], v7 offset:18496
    ds_read_b64_tr_b16 v[30:31], v7 offset:19520
    s_waitcnt vmcnt(15)
    v_mfma_f32_32x32x16_bf16 v[32:47], a[216:219], v[80:83], v[32:47]
    s_add_u32 s31, s47, 61440
    buffer_load_dwordx4 v[76:79], v8, s[4:7], s31 offen sc1
    v_mfma_f32_32x32x16_bf16 v[48:63], a[220:223], v[80:83], v[48:63]
    s_waitcnt vmcnt(15)
    v_mfma_f32_32x32x16_bf16 v[32:47], a[224:227], v[84:87], v[32:47]
    s_add_u32 s31, s47, 39936
    buffer_load_dwordx4 v[80:83], v8, s[4:7], s31 offen sc1
    v_mfma_f32_32x32x16_bf16 v[48:63], a[228:231], v[84:87], v[48:63]
    s_waitcnt vmcnt(15)
    v_mfma_f32_32x32x16_bf16 v[32:47], a[232:235], v[88:91], v[32:47]
    s_add_u32 s31, s47, 40960
    buffer_load_dwordx4 v[84:87], v8, s[4:7], s31 offen sc1
    v_mfma_f32_32x32x16_bf16 v[48:63], a[236:239], v[88:91], v[48:63]
    s_waitcnt vmcnt(15)
    s_waitcnt lgkmcnt(0)
    v_mfma_f32_32x32x16_bf16 v[32:47], v[24:27], v[92:95], v[32:47]
    s_add_u32 s31, s47, 41984
    buffer_load_dwordx4 v[88:91], v8, s[4:7], s31 offen sc1
    v_mfma_f32_32x32x16_bf16 v[48:63], v[28:31], v[92:95], v[48:63]
    ds_read_b64_tr_b16 v[16:17], v7 offset:20480
    ds_read_b64_tr_b16 v[18:19], v7 offset:21504
    ds_read_b64_tr_b16 v[20:21], v7 offset:20544
    ds_read_b64_tr_b16 v[22:23], v7 offset:21568
    s_waitcnt vmcnt(14)
    v_mfma_f32_32x32x16_bf16 v[32:47], a[240:243], v[96:99], v[32:47]
    s_add_u32 s31, s47, 62464
    buffer_load_dwordx4 v[92:95], v8, s[4:7], s31 offen sc1
    v_mfma_f32_32x32x16_bf16 v[48:63], a[244:247], v[96:99], v[48:63]
    s_waitcnt vmcnt(14)
    v_mfma_f32_32x32x16_bf16 v[32:47], a[248:251], v[100:103], v[32:47]
    s_add_u32 s31, s47, 43008
    buffer_load_dwordx4 v[96:99], v8, s[4:7], s31 offen sc1
    v_mfma_f32_32x32x16_bf16 v[48:63], a[252:255], v[100:103], v[48:63]
    s_waitcnt vmcnt(14)
    v_mfma_f32_32x32x16_bf16 v[32:47], v[128:131], v[104:107], v[32:47]
    s_add_u32 s31, s47, 44032
    buffer_load_dwordx4 v[100:103], v8, s[4:7], s31 offen sc1
    v_mfma_f32_32x32x16_bf16 v[48:63], v[132:135], v[104:107], v[48:63]
    s_waitcnt vmcnt(14)
    s_waitcnt lgkmcnt(0)
    v_mfma_f32_32x32x16_bf16 v[32:47], v[16:19], v[108:111], v[32:47]
    s_add_u32 s31, s47, 45056
    buffer_load_dwordx4 v[104:107], v8, s[4:7], s31 offen sc1
    v_mfma_f32_32x32x16_bf16 v[48:63], v[20:23], v[108:111], v[48:63]
    ds_read_b64_tr_b16 v[24:25], v7 offset:22528
    ds_read_b64_tr_b16 v[26:27], v7 offset:23552
    ds_read_b64_tr_b16 v[28:29], v7 offset:22592
    ds_read_b64_tr_b16 v[30:31], v7 offset:23616
    s_waitcnt vmcnt(14)
    v_mfma_f32_32x32x16_bf16 v[32:47], v[136:139], v[112:115], v[32:47]
    s_add_u32 s31, s47, 63488
    buffer_load_dwordx4 v[108:111], v8, s[4:7], s31 offen sc1
    v_mfma_f32_32x32x16_bf16 v[48:63], v[140:143], v[112:115], v[48:63]
    s_waitcnt vmcnt(14)
    v_mfma_f32_32x32x16_bf16 v[32:47], v[144:147], v[116:119], v[32:47]
    s_add_u32 s31, s47, 46080
    buffer_load_dwordx4 v[112:115], v8, s[4:7], s31 offen sc1
    v_mfma_f32_32x32x16_bf16 v[48:63], v[148:151], v[116:119], v[48:63]
    s_waitcnt vmcnt(14)
    v_mfma_f32_32x32x16_bf16 v[32:47], v[152:155], v[120:123], v[32:47]
    s_add_u32 s31, s47, 47104
    buffer_load_dwordx4 v[116:119], v8, s[4:7], s31 offen sc1
    v_mfma_f32_32x32x16_bf16 v[48:63], v[156:159], v[120:123], v[48:63]
    s_waitcnt vmcnt(14)
    s_waitcnt lgkmcnt(0)
    v_mfma_f32_32x32x16_bf16 v[32:47], v[24:27], v[124:127], v[32:47]
    s_add_u32 s31, s47, 48128
    buffer_load_dwordx4 v[120:123], v8, s[4:7], s31 offen sc1
    v_mfma_f32_32x32x16_bf16 v[48:63], v[28:31], v[124:127], v[48:63]
    ds_read_b64_tr_b16 v[16:17], v7 offset:24576
    ds_read_b64_tr_b16 v[18:19], v7 offset:25600
    ds_read_b64_tr_b16 v[20:21], v7 offset:24640
    ds_read_b64_tr_b16 v[22:23], v7 offset:25664
    s_waitcnt vmcnt(14)
    v_mfma_f32_32x32x16_bf16 v[32:47], v[160:163], v[64:67], v[32:47]
    s_add_u32 s31, s47, 64512
    buffer_load_dwordx4 v[124:127], v8, s[4:7], s31 offen sc1
    v_mfma_f32_32x32x16_bf16 v[48:63], v[164:167], v[64:67], v[48:63]
    s_waitcnt vmcnt(14)
    v_mfma_f32_32x32x16_bf16 v[32:47], v[168:171], v[68:71], v[32:47]
    v_cmp_ge_u32 vcc, s35, v13
    s_lshl_b32 s46, s35, 18
    s_add_u32 s46, s46, 67108864
    s_cmp_eq_u64 vcc, 0
    s_cselect_b32 s51, 1, 0
    s_cmp_ge_u32 s35, 64
    s_cselect_b32 s51, 0, s51
    s_cmp_eq_u32 s51, 0
    s_cselect_b32 s46, s47, s46
    s_add_u32 s31, s46, 0
    buffer_load_dwordx4 v[64:67], v8, s[4:7], s31 offen sc1
    v_mfma_f32_32x32x16_bf16 v[48:63], v[172:175], v[68:71], v[48:63]
    s_waitcnt vmcnt(14)
    v_mfma_f32_32x32x16_bf16 v[32:47], v[176:179], v[72:75], v[32:47]
    s_add_u32 s31, s46, 1024
    buffer_load_dwordx4 v[68:71], v8, s[4:7], s31 offen sc1
    v_mfma_f32_32x32x16_bf16 v[48:63], v[180:183], v[72:75], v[48:63]
    s_waitcnt vmcnt(14)
    s_waitcnt lgkmcnt(0)
    v_mfma_f32_32x32x16_bf16 v[32:47], v[16:19], v[76:79], v[32:47]
    s_add_u32 s31, s46, 2048
    buffer_load_dwordx4 v[72:75], v8, s[4:7], s31 offen sc1
    v_mfma_f32_32x32x16_bf16 v[48:63], v[20:23], v[76:79], v[48:63]
    ds_read_b64_tr_b16 v[24:25], v7 offset:26624
    ds_read_b64_tr_b16 v[26:27], v7 offset:27648
    ds_read_b64_tr_b16 v[28:29], v7 offset:26688
    ds_read_b64_tr_b16 v[30:31], v7 offset:27712
    s_waitcnt vmcnt(14)
    v_mfma_f32_32x32x16_bf16 v[32:47], v[184:187], v[80:83], v[32:47]
    s_add_u32 s31, s46, 49152
    buffer_load_dwordx4 v[76:79], v8, s[4:7], s31 offen sc1
    v_mfma_f32_32x32x16_bf16 v[48:63], v[188:191], v[80:83], v[48:63]
    s_waitcnt vmcnt(14)
    v_mfma_f32_32x32x16_bf16 v[32:47], v[192:195], v[84:87], v[32:47]
    s_add_u32 s31, s46, 3072
    buffer_load_dwordx4 v[80:83], v8, s[4:7], s31 offen sc1
    v_mfma_f32_32x32x16_bf16 v[48:63], v[196:199], v[84:87], v[48:63]
    s_waitcnt vmcnt(14)
    v_mfma_f32_32x32x16_bf16 v[32:47], v[200:203], v[88:91], v[32:47]
    s_add_u32 s31, s46, 4096
    buffer_load_dwordx4 v[84:87], v8, s[4:7], s31 offen sc1
    v_mfma_f32_32x32x16_bf16 v[48:63], v[204:207], v[88:91], v[48:63]
    s_waitcnt vmcnt(14)
    s_waitcnt lgkmcnt(0)
    v_mfma_f32_32x32x16_bf16 v[32:47], v[24:27], v[92:95], v[32:47]
    s_add_u32 s31, s46, 5120
    buffer_load_dwordx4 v[88:91], v8, s[4:7], s31 offen sc1
    v_mfma_f32_32x32x16_bf16 v[48:63], v[28:31], v[92:95], v[48:63]
    ds_read_b64_tr_b16 v[16:17], v7 offset:28672
    ds_read_b64_tr_b16 v[18:19], v7 offset:29696
    ds_read_b64_tr_b16 v[20:21], v7 offset:28736
    ds_read_b64_tr_b16 v[22:23], v7 offset:29760
    s_waitcnt vmcnt(14)
    v_mfma_f32_32x32x16_bf16 v[32:47], v[208:211], v[96:99], v[32:47]
    s_add_u32 s31, s46, 50176
    buffer_load_dwordx4 v[92:95], v8, s[4:7], s31 offen sc1
    v_mfma_f32_32x32x16_bf16 v[48:63], v[212:215], v[96:99], v[48:63]
    s_waitcnt vmcnt(14)
    v_mfma_f32_32x32x16_bf16 v[32:47], v[216:219], v[100:103], v[32:47]
    s_add_u32 s31, s46, 6144
    buffer_load_dwordx4 v[96:99], v8, s[4:7], s31 offen sc1
    v_mfma_f32_32x32x16_bf16 v[48:63], v[220:223], v[100:103], v[48:63]
    s_waitcnt vmcnt(14)
    v_mfma_f32_32x32x16_bf16 v[32:47], v[224:227], v[104:107], v[32:47]
    s_add_u32 s31, s46, 7168
    buffer_load_dwordx4 v[100:103], v8, s[4:7], s31 offen sc1
    v_mfma_f32_32x32x16_bf16 v[48:63], v[228:231], v[104:107], v[48:63]
    s_waitcnt vmcnt(14)
    s_waitcnt lgkmcnt(0)
    v_mfma_f32_32x32x16_bf16 v[32:47], v[16:19], v[108:111], v[32:47]
    s_add_u32 s31, s46, 8192
    buffer_load_dwordx4 v[104:107], v8, s[4:7], s31 offen sc1
    v_mfma_f32_32x32x16_bf16 v[48:63], v[20:23], v[108:111], v[48:63]
    ds_read_b64_tr_b16 v[24:25], v7 offset:30720
    ds_read_b64_tr_b16 v[26:27], v7 offset:31744
    ds_read_b64_tr_b16 v[28:29], v7 offset:30784
    ds_read_b64_tr_b16 v[30:31], v7 offset:31808
    s_waitcnt vmcnt(14)
    v_mfma_f32_32x32x16_bf16 v[32:47], v[232:235], v[112:115], v[32:47]
    s_add_u32 s31, s46, 51200
    buffer_load_dwordx4 v[108:111], v8, s[4:7], s31 offen sc1
    v_mfma_f32_32x32x16_bf16 v[48:63], v[236:239], v[112:115], v[48:63]
    s_waitcnt vmcnt(14)
    v_mfma_f32_32x32x16_bf16 v[32:47], v[240:243], v[116:119], v[32:47]
    s_add_u32 s31, s46, 9216
    buffer_load_dwordx4 v[112:115], v8, s[4:7], s31 offen sc1
    v_mfma_f32_32x32x16_bf16 v[48:63], v[244:247], v[116:119], v[48:63]
    s_waitcnt vmcnt(14)
    v_mfma_f32_32x32x16_bf16 v[32:47], v[248:251], v[120:123], v[32:47]
    s_add_u32 s31, s46, 10240
    buffer_load_dwordx4 v[116:119], v8, s[4:7], s31 offen sc1
    v_mfma_f32_32x32x16_bf16 v[48:63], v[252:255], v[120:123], v[48:63]
    s_waitcnt vmcnt(14)
    s_waitcnt lgkmcnt(0)
    v_mfma_f32_32x32x16_bf16 v[32:47], v[24:27], v[124:127], v[32:47]
    s_add_u32 s31, s46, 11264
    buffer_load_dwordx4 v[120:123], v8, s[4:7], s31 offen sc1
    v_mfma_f32_32x32x16_bf16 v[48:63], v[28:31], v[124:127], v[48:63]
    s_barrier
    s_nop 7
    ds_write_b128 v9, v[32:35] offset:0
    ds_write_b128 v9, v[36:39] offset:1024
    ds_write_b128 v9, v[40:43] offset:2048
    ds_write_b128 v9, v[44:47] offset:3072
    ds_write_b128 v9, v[48:51] offset:4096
    ds_write_b128 v9, v[52:55] offset:5120
    ds_write_b128 v9, v[56:59] offset:6144
    ds_write_b128 v9, v[60:63] offset:7168
    s_waitcnt lgkmcnt(0)
    s_barrier
    ds_read_b128 v[32:35], v10 offset:0
    ds_read_b128 v[36:39], v10 offset:8192
    ds_read_b128 v[40:43], v10 offset:16384
    ds_read_b128 v[44:47], v10 offset:24576
    ds_read_b128 v[48:51], v10 offset:4096
    ds_read_b128 v[52:55], v10 offset:12288
    ds_read_b128 v[56:59], v10 offset:20480
    ds_read_b128 v[60:63], v10 offset:28672
    s_waitcnt lgkmcnt(4)
    v_pk_add_f32 v[32:33], v[32:33], v[36:37]
    v_pk_add_f32 v[34:35], v[34:35], v[38:39]
    v_pk_add_f32 v[40:41], v[40:41], v[44:45]
    v_pk_add_f32 v[42:43], v[42:43], v[46:47]
    v_pk_add_f32 v[32:33], v[32:33], v[40:41]
    v_pk_add_f32 v[34:35], v[34:35], v[42:43]
    v_cvt_pk_bf16_f32 v24, v32, v33
    v_cvt_pk_bf16_f32 v25, v34, v35
    buffer_store_dwordx2 v[24:25], v11, s[20:23], s49 offen offset:0
    s_waitcnt lgkmcnt(0)
    v_pk_add_f32 v[48:49], v[48:49], v[52:53]
    v_pk_add_f32 v[50:51], v[50:51], v[54:55]
    v_pk_add_f32 v[56:57], v[56:57], v[60:61]
    v_pk_add_f32 v[58:59], v[58:59], v[62:63]
    v_pk_add_f32 v[48:49], v[48:49], v[56:57]
    v_pk_add_f32 v[50:51], v[50:51], v[58:59]
    v_cvt_pk_bf16_f32 v26, v48, v49
    v_cvt_pk_bf16_f32 v27, v50, v51
    buffer_store_dwordx2 v[26:27], v11, s[20:23], s49 offen offset:64
    s_mov_b32 s30, s35
    s_mov_b32 s47, s46
    s_cmp_lg_u32 s51, 0
    s_cbranch_scc1 o6_go_78
    s_cmp_lt_u32 s30, 64
    s_cbranch_scc1 o6_loop_77
    s_branch L_dump
L_ob:
    s_load_dwordx4 s[72:75], s[0:1], 72
    s_add_u32 s76, s90, 83886080
    s_addc_u32 s77, s91, 0
    s_sub_u32 s32, s28, 96
    s_lshr_b32 s32, s32, 3
    s_mul_i32 s30, s32, 22
    s_add_u32 s51, s30, 22
    s_min_u32 s51, s51, 64
    s_sub_u32 s52, s51, 1
    s_lshl_b32 s52, s52, 16
    s_waitcnt lgkmcnt(0)
    s_mov_b32 s8, s72
    s_and_b32 s9, s73, 0xffff
    s_mov_b32 s10, 2097152
    s_mov_b32 s11, 0x00020000
    s_mov_b32 s20, s74
    s_and_b32 s21, s75, 0xffff
    s_mov_b32 s22, 8388608
    s_mov_b32 s23, 0x00020000
    s_mov_b32 s12, s76
    s_and_b32 s13, s77, 0xffff
    s_mov_b32 s14, 4194304
    s_mov_b32 s15, 0x00020000
    s_and_b32 s31, s28, 7
    s_lshl_b32 s31, s31, 8
    s_lshl_b32 s33, s29, 6
    s_add_u32 s31, s31, s33
    v_lshrrev_b32 v6, 2, v1
    v_lshlrev_b32 v6, 11, v6
    v_and_b32 v4, 3, v1
    v_lshl_add_u32 v6, v4, 4, v6
    v_add_u32 v6, s31, v6
    s_mov_b32 s39, 32768
    s_lshl_b32 s36, s30, 17
    s_and_b32 s33, s28, 7
    s_lshl_b32 s33, s33, 8
    s_add_u32 s36, s36, s33
    s_add_u32 s36, s36, 2048
    s_mov_b32 s37, 131072
    s_lshl_b32 s31, s29, 15
    v_lshrrev_b32 v7, 4, v1
    v_lshlrev_b32 v7, 9, v7
    v_bfe_u32 v4, v1, 2, 2
    v_lshl_add_u32 v7, v4, 6, v7
    v_and_b32 v4, 3, v1
    v_lshl_add_u32 v7, v4, 4, v7
    v_add_u32 v7, s31, v7
    s_lshl_b32 s32, s29, 15
    s_add_u32 m0, s32, 0
    s_mov_b32 s38, 0
    buffer_load_dwordx4 v6, s[8:11], s38 offen lds
    s_add_u32 m0, s32, 1024
    s_add_u32 s38, s38, s39
    buffer_load_dwordx4 v6, s[8:11], s38 offen lds
    s_add_u32 m0, s32, 2048
    s_add_u32 s38, s38, s39
    buffer_load_dwordx4 v6, s[8:11], s38 offen lds
    s_add_u32 m0, s32, 3072
    s_add_u32 s38, s38, s39
    buffer_load_dwordx4 v6, s[8:11], s38 offen lds
    s_add_u32 m0, s32, 4096
    s_add_u32 s38, s38, s39
    buffer_load_dwordx4 v6, s[8:11], s38 offen lds
    s_add_u32 m0, s32, 5120
    s_add_u32 s38, s38, s39
    buffer_load_dwordx4 v6, s[8:11], s38 offen lds
    s_add_u32 m0, s32, 6144
    s_add_u32 s38, s38, s39
    buffer_load_dwordx4 v6, s[8:11], s38 offen lds
    s_add_u32 m0, s32, 7168
    s_add_u32 s38, s38, s39
    buffer_load_dwordx4 v6, s[8:11], s38 offen lds
    s_add_u32 m0, s32, 8192
    s_add_u32 s38, s38, s39
    buffer_load_dwordx4 v6, s[8:11], s38 offen lds
    s_add_u32 m0, s32, 9216
    s_add_u32 s38, s38, s39
    buffer_load_dwordx4 v6, s[8:11], s38 offen lds
    s_add_u32 m0, s32, 10240
    s_add_u32 s38, s38, s39
    buffer_load_dwordx4 v6, s[8:11], s38 offen lds
    s_add_u32 m0, s32, 11264
    s_add_u32 s38, s38, s39
    buffer_load_dwordx4 v6, s[8:11], s38 offen lds
    s_add_u32 m0, s32, 12288
    s_add_u32 s38, s38, s39
    buffer_load_dwordx4 v6, s[8:11], s38 offen lds
    s_add_u32 m0, s32, 13312
    s_add_u32 s38, s38, s39
    buffer_load_dwordx4 v6, s[8:11], s38 offen lds
    s_add_u32 m0, s32, 14336
    s_add_u32 s38, s38, s39
    buffer_load_dwordx4 v6, s[8:11], s38 offen lds
    s_add_u32 m0, s32, 15360
    s_add_u32 s38, s38, s39
    buffer_load_dwordx4 v6, s[8:11], s38 offen lds
    s_add_u32 m0, s32, 16384
    s_add_u32 s38, s38, s39
    buffer_load_dwordx4 v6, s[8:11], s38 offen lds
    s_add_u32 m0, s32, 17408
    s_add_u32 s38, s38, s39
    buffer_load_dwordx4 v6, s[8:11], s38 offen lds
    s_add_u32 m0, s32, 18432
    s_add_u32 s38, s38, s39
    buffer_load_dwordx4 v6, s[8:11], s38 offen lds
    s_add_u32 m0, s32, 19456
    s_add_u32 s38, s38, s39
    buffer_load_dwordx4 v6, s[8:11], s38 offen lds
    s_add_u32 m0, s32, 20480
    s_add_u32 s38, s38, s39
    buffer_load_dwordx4 v6, s[8:11], s38 offen lds
    s_add_u32 m0, s32, 21504
    s_add_u32 s38, s38, s39
    buffer_load_dwordx4 v6, s[8:11], s38 offen lds
    s_add_u32 m0, s32, 22528
    s_add_u32 s38, s38, s39
    buffer_load_dwordx4 v6, s[8:11], s38 offen lds
    s_add_u32 m0, s32, 23552
    s_add_u32 s38, s38, s39
    buffer_load_dwordx4 v6, s[8:11], s38 offen lds
    s_add_u32 m0, s32, 24576
    s_add_u32 s38, s38, s39
    buffer_load_dwordx4 v6, s[8:11], s38 offen lds
    s_add_u32 m0, s32, 25600
    s_add_u32 s38, s38, s39
    buffer_load_dwordx4 v6, s[8:11], s38 offen lds
    s_add_u32 m0, s32, 26624
    s_add_u32 s38, s38, s39
    buffer_load_dwordx4 v6, s[8:11], s38 offen lds
    s_add_u32 m0, s32, 27648
    s_add_u32 s38, s38, s39
    buffer_load_dwordx4 v6, s[8:11], s38 offen lds
    s_add_u32 m0, s32, 28672
    s_add_u32 s38, s38, s39
    buffer_load_dwordx4 v6, s[8:11], s38 offen lds
    s_add_u32 m0, s32, 29696
    s_add_u32 s38, s38, s39
    buffer_load_dwordx4 v6, s[8:11], s38 offen lds
    s_add_u32 m0, s32, 30720
    s_add_u32 s38, s38, s39
    buffer_load_dwordx4 v6, s[8:11], s38 offen lds
    s_add_u32 m0, s32, 31744
    s_add_u32 s38, s38, s39
    buffer_load_dwordx4 v6, s[8:11], s38 offen lds
    s_waitcnt vmcnt(30)
    ds_read_b64_tr_b16 a[0:1], v7 offset:0
    ds_read_b64_tr_b16 a[2:3], v7 offset:256
    ds_read_b64_tr_b16 a[4:5], v7 offset:8
    ds_read_b64_tr_b16 a[6:7], v7 offset:264
    s_waitcnt vmcnt(28)
    ds_read_b64_tr_b16 a[8:9], v7 offset:2048
    ds_read_b64_tr_b16 a[10:11], v7 offset:2304
    ds_read_b64_tr_b16 a[12:13], v7 offset:2056
    ds_read_b64_tr_b16 a[14:15], v7 offset:2312
    s_waitcnt lgkmcnt(4)
    s_add_u32 m0, s32, 0
    s_add_u32 s38, s38, s39
    buffer_load_dwordx4 v6, s[8:11], s38 offen lds
    s_add_u32 m0, s32, 1024
    s_add_u32 s38, s38, s39
    buffer_load_dwordx4 v6, s[8:11], s38 offen lds
    s_waitcnt vmcnt(28)
    ds_read_b64_tr_b16 a[16:17], v7 offset:4096
    ds_read_b64_tr_b16 a[18:19], v7 offset:4352
    ds_read_b64_tr_b16 a[20:21], v7 offset:4104
    ds_read_b64_tr_b16 a[22:23], v7 offset:4360
    s_waitcnt lgkmcnt(4)
    s_add_u32 m0, s32, 2048
    s_add_u32 s38, s38, s39
    buffer_load_dwordx4 v6, s[8:11], s38 offen lds
    s_add_u32 m0, s32, 3072
    s_add_u32 s38, s38, s39
    buffer_load_dwordx4 v6, s[8:11], s38 offen lds
    s_waitcnt vmcnt(28)
    ds_read_b64_tr_b16 a[24:25], v7 offset:6144
    ds_read_b64_tr_b16 a[26:27], v7 offset:6400
    ds_read_b64_tr_b16 a[28:29], v7 offset:6152
    ds_read_b64_tr_b16 a[30:31], v7 offset:6408
    s_waitcnt lgkmcnt(4)
    s_add_u32 m0, s32, 4096
    s_add_u32 s38, s38, s39
    buffer_load_dwordx4 v6, s[8:11], s38 offen lds
    s_add_u32 m0, s32, 5120
    s_add_u32 s38, s38, s39
    buffer_load_dwordx4 v6, s[8:11], s38 offen lds
    s_waitcnt vmcnt(28)
    ds_read_b64_tr_b16 a[32:33], v7 offset:8192
    ds_read_b64_tr_b16 a[34:35], v7 offset:8448
    ds_read_b64_tr_b16 a[36:37], v7 offset:8200
    ds_read_b64_tr_b16 a[38:39], v7 offset:8456
    s_waitcnt lgkmcnt(4)
    s_add_u32 m0, s32, 6144
    s_add_u32 s38, s38, s39
    buffer_load_dwordx4 v6, s[8:11], s38 offen lds
    s_add_u32 m0, s32, 7168
    s_add_u32 s38, s38, s39
    buffer_load_dwordx4 v6, s[8:11], s38 offen lds
    s_waitcnt vmcnt(28)
    ds_read_b64_tr_b16 a[40:41], v7 offset:10240
    ds_read_b64_tr_b16 a[42:43], v7 offset:10496
    ds_read_b64_tr_b16 a[44:45], v7 offset:10248
    ds_read_b64_tr_b16 a[46:47], v7 offset:10504
    s_waitcnt lgkmcnt(4)
    s_add_u32 m0, s32, 8192
    s_add_u32 s38, s38, s39
    buffer_load_dwordx4 v6, s[8:11], s38 offen lds
    s_add_u32 m0, s32, 9216
    s_add_u32 s38, s38, s39
    buffer_load_dwordx4 v6, s[8:11], s38 offen lds
    s_waitcnt vmcnt(28)
    ds_read_b64_tr_b16 a[48:49], v7 offset:12288
    ds_read_b64_tr_b16 a[50:51], v7 offset:12544
    ds_read_b64_tr_b16 a[52:53], v7 offset:12296
    ds_read_b64_tr_b16 a[54:55], v7 offset:12552
    s_waitcnt lgkmcnt(4)
    s_add_u32 m0, s32, 10240
    s_add_u32 s38, s38, s39
    buffer_load_dwordx4 v6, s[8:11], s38 offen lds
    s_add_u32 m0, s32, 11264
    s_add_u32 s38, s38, s39
    buffer_load_dwordx4 v6, s[8:11], s38 offen lds
    s_waitcnt vmcnt(28)
    ds_read_b64_tr_b16 a[56:57], v7 offset:14336
    ds_read_b64_tr_b16 a[58:59], v7 offset:14592
    ds_read_b64_tr_b16 a[60:61], v7 offset:14344
    ds_read_b64_tr_b16 a[62:63], v7 offset:14600
    s_waitcnt lgkmcnt(4)
    s_add_u32 m0, s32, 12288
    s_add_u32 s38, s38, s39
    buffer_load_dwordx4 v6, s[8:11], s38 offen lds
    s_add_u32 m0, s32, 13312
    s_add_u32 s38, s38, s39
    buffer_load_dwordx4 v6, s[8:11], s38 offen lds
    s_waitcnt vmcnt(28)
    ds_read_b64_tr_b16 a[64:65], v7 offset:16384
    ds_read_b64_tr_b16 a[66:67], v7 offset:16640
    ds_read_b64_tr_b16 a[68:69], v7 offset:16392
    ds_read_b64_tr_b16 a[70:71], v7 offset:16648
    s_waitcnt lgkmcnt(4)
    s_add_u32 m0, s32, 14336
    s_add_u32 s38, s38, s39
    buffer_load_dwordx4 v6, s[8:11], s38 offen lds
    s_add_u32 m0, s32, 15360
    s_add_u32 s38, s38, s39
    buffer_load_dwordx4 v6, s[8:11], s38 offen lds
    s_waitcnt vmcnt(28)
    ds_read_b64_tr_b16 a[72:73], v7 offset:18432
    ds_read_b64_tr_b16 a[74:75], v7 offset:18688
    ds_read_b64_tr_b16 a[76:77], v7 offset:18440
    ds_read_b64_tr_b16 a[78:79], v7 offset:18696
    s_waitcnt lgkmcnt(4)
    s_add_u32 m0, s32, 16384
    s_add_u32 s38, s38, s39
    buffer_load_dwordx4 v6, s[8:11], s38 offen lds
    s_add_u32 m0, s32, 17408
    s_add_u32 s38, s38, s39
    buffer_load_dwordx4 v6, s[8:11], s38 offen lds
    s_waitcnt vmcnt(28)
    ds_read_b64_tr_b16 a[80:81], v7 offset:20480
    ds_read_b64_tr_b16 a[82:83], v7 offset:20736
    ds_read_b64_tr_b16 a[84:85], v7 offset:20488
    ds_read_b64_tr_b16 a[86:87], v7 offset:20744
    s_waitcnt lgkmcnt(4)
    s_add_u32 m0, s32, 18432
    s_add_u32 s38, s38, s39
    buffer_load_dwordx4 v6, s[8:11], s38 offen lds
    s_add_u32 m0, s32, 19456
    s_add_u32 s38, s38, s39
    buffer_load_dwordx4 v6, s[8:11], s38 offen lds
    s_waitcnt vmcnt(28)
    ds_read_b64_tr_b16 a[88:89], v7 offset:22528
    ds_read_b64_tr_b16 a[90:91], v7 offset:22784
    ds_read_b64_tr_b16 a[92:93], v7 offset:22536
    ds_read_b64_tr_b16 a[94:95], v7 offset:22792
    s_waitcnt lgkmcnt(4)
    s_add_u32 m0, s32, 20480
    s_add_u32 s38, s38, s39
    buffer_load_dwordx4 v6, s[8:11], s38 offen lds
    s_add_u32 m0, s32, 21504
    s_add_u32 s38, s38, s39
    buffer_load_dwordx4 v6, s[8:11], s38 offen lds
    s_waitcnt vmcnt(28)
    ds_read_b64_tr_b16 a[96:97], v7 offset:24576
    ds_read_b64_tr_b16 a[98:99], v7 offset:24832
    ds_read_b64_tr_b16 a[100:101], v7 offset:24584
    ds_read_b64_tr_b16 a[102:103], v7 offset:24840
    s_waitcnt lgkmcnt(4)
    s_add_u32 m0, s32, 22528
    s_add_u32 s38, s38, s39
    buffer_load_dwordx4 v6, s[8:11], s38 offen lds
    s_add_u32 m0, s32, 23552
    s_add_u32 s38, s38, s39
    buffer_load_dwordx4 v6, s[8:11], s38 offen lds
    s_waitcnt vmcnt(28)
    ds_read_b64_tr_b16 a[104:105], v7 offset:26624
    ds_read_b64_tr_b16 a[106:107], v7 offset:26880
    ds_read_b64_tr_b16 a[108:109], v7 offset:26632
    ds_read_b64_tr_b16 a[110:111], v7 offset:26888
    s_waitcnt lgkmcnt(4)
    s_add_u32 m0, s32, 24576
    s_add_u32 s38, s38, s39
    buffer_load_dwordx4 v6, s[8:11], s38 offen lds
    s_add_u32 m0, s32, 25600
    s_add_u32 s38, s38, s39
    buffer_load_dwordx4 v6, s[8:11], s38 offen lds
    s_waitcnt vmcnt(28)
    ds_read_b64_tr_b16 a[112:113], v7 offset:28672
    ds_read_b64_tr_b16 a[114:115], v7 offset:28928
    ds_read_b64_tr_b16 a[116:117], v7 offset:28680
    ds_read_b64_tr_b16 a[118:119], v7 offset:28936
    s_waitcnt lgkmcnt(4)
    s_add_u32 m0, s32, 26624
    s_add_u32 s38, s38, s39
    buffer_load_dwordx4 v6, s[8:11], s38 offen lds
    s_add_u32 m0, s32, 27648
    s_add_u32 s38, s38, s39
    buffer_load_dwordx4 v6, s[8:11], s38 offen lds
    s_waitcnt vmcnt(28)
    ds_read_b64_tr_b16 a[120:121], v7 offset:30720
    ds_read_b64_tr_b16 a[122:123], v7 offset:30976
    ds_read_b64_tr_b16 a[124:125], v7 offset:30728
    ds_read_b64_tr_b16 a[126:127], v7 offset:30984
    s_waitcnt lgkmcnt(4)
    s_add_u32 m0, s32, 28672
    s_add_u32 s38, s38, s39
    buffer_load_dwordx4 v6, s[8:11], s38 offen lds
    s_add_u32 m0, s32, 29696
    s_add_u32 s38, s38, s39
    buffer_load_dwordx4 v6, s[8:11], s38 offen lds
    s_waitcnt vmcnt(28)
    ds_read_b64_tr_b16 a[128:129], v7 offset:0
    ds_read_b64_tr_b16 a[130:131], v7 offset:256
    ds_read_b64_tr_b16 a[132:133], v7 offset:8
    ds_read_b64_tr_b16 a[134:135], v7 offset:264
    s_waitcnt lgkmcnt(4)
    s_add_u32 m0, s32, 30720
    s_add_u32 s38, s38, s39
    buffer_load_dwordx4 v6, s[8:11], s38 offen lds
    s_add_u32 m0, s32, 31744
    s_add_u32 s38, s38, s39
    buffer_load_dwordx4 v6, s[8:11], s38 offen lds
    s_waitcnt vmcnt(28)
    ds_read_b64_tr_b16 a[136:137], v7 offset:2048
    ds_read_b64_tr_b16 a[138:139], v7 offset:2304
    ds_read_b64_tr_b16 a[140:141], v7 offset:2056
    ds_read_b64_tr_b16 a[142:143], v7 offset:2312
    s_waitcnt vmcnt(26)
    ds_read_b64_tr_b16 a[144:145], v7 offset:4096
    ds_read_b64_tr_b16 a[146:147], v7 offset:4352
    ds_read_b64_tr_b16 a[148:149], v7 offset:4104
    ds_read_b64_tr_b16 a[150:151], v7 offset:4360
    s_waitcnt vmcnt(24)
    ds_read_b64_tr_b16 a[152:153], v7 offset:6144
    ds_read_b64_tr_b16 a[154:155], v7 offset:6400
    ds_read_b64_tr_b16 a[156:157], v7 offset:6152
    ds_read_b64_tr_b16 a[158:159], v7 offset:6408
    s_waitcnt vmcnt(22)
    ds_read_b64_tr_b16 a[160:161], v7 offset:8192
    ds_read_b64_tr_b16 a[162:163], v7 offset:8448
    ds_read_b64_tr_b16 a[164:165], v7 offset:8200
    ds_read_b64_tr_b16 a[166:167], v7 offset:8456
    s_waitcnt vmcnt(20)
    ds_read_b64_tr_b16 a[168:169], v7 offset:10240
    ds_read_b64_tr_b16 a[170:171], v7 offset:10496
    ds_read_b64_tr_b16 a[172:173], v7 offset:10248
    ds_read_b64_tr_b16 a[174:175], v7 offset:10504
    s_waitcnt vmcnt(18)
    ds_read_b64_tr_b16 a[176:177], v7 offset:12288
    ds_read_b64_tr_b16 a[178:179], v7 offset:12544
    ds_read_b64_tr_b16 a[180:181], v7 offset:12296
    ds_read_b64_tr_b16 a[182:183], v7 offset:12552
    s_waitcnt vmcnt(16)
    ds_read_b64_tr_b16 a[184:185], v7 offset:14336
    ds_read_b64_tr_b16 a[186:187], v7 offset:14592
    ds_read_b64_tr_b16 a[188:189], v7 offset:14344
    ds_read_b64_tr_b16 a[190:191], v7 offset:14600
    s_waitcnt vmcnt(14)
    ds_read_b64_tr_b16 a[192:193], v7 offset:16384
    ds_read_b64_tr_b16 a[194:195], v7 offset:16640
    ds_read_b64_tr_b16 a[196:197], v7 offset:16392
    ds_read_b64_tr_b16 a[198:199], v7 offset:16648
    s_waitcnt vmcnt(12)
    ds_read_b64_tr_b16 a[200:201], v7 offset:18432
    ds_read_b64_tr_b16 a[202:203], v7 offset:18688
    ds_read_b64_tr_b16 a[204:205], v7 offset:18440
    ds_read_b64_tr_b16 a[206:207], v7 offset:18696
    s_waitcnt vmcnt(10)
    ds_read_b64_tr_b16 a[208:209], v7 offset:20480
    ds_read_b64_tr_b16 a[210:211], v7 offset:20736
    ds_read_b64_tr_b16 a[212:213], v7 offset:20488
    ds_read_b64_tr_b16 a[214:215], v7 offset:20744
    s_waitcnt vmcnt(8)
    ds_read_b64_tr_b16 a[216:217], v7 offset:22528
    ds_read_b64_tr_b16 a[218:219], v7 offset:22784
    ds_read_b64_tr_b16 a[220:221], v7 offset:22536
    ds_read_b64_tr_b16 a[222:223], v7 offset:22792
    s_waitcnt vmcnt(6)
    ds_read_b64_tr_b16 a[224:225], v7 offset:24576
    ds_read_b64_tr_b16 a[226:227], v7 offset:24832
    ds_read_b64_tr_b16 a[228:229], v7 offset:24584
    ds_read_b64_tr_b16 a[230:231], v7 offset:24840
    s_waitcnt vmcnt(4)
    ds_read_b64_tr_b16 a[232:233], v7 offset:26624
    ds_read_b64_tr_b16 a[234:235], v7 offset:26880
    ds_read_b64_tr_b16 a[236:237], v7 offset:26632
    ds_read_b64_tr_b16 a[238:239], v7 offset:26888
    s_waitcnt vmcnt(2)
    ds_read_b64_tr_b16 a[240:241], v7 offset:28672
    ds_read_b64_tr_b16 a[242:243], v7 offset:28928
    ds_read_b64_tr_b16 a[244:245], v7 offset:28680
    ds_read_b64_tr_b16 a[246:247], v7 offset:28936
    s_waitcnt vmcnt(0)
    ds_read_b64_tr_b16 a[248:249], v7 offset:30720
    ds_read_b64_tr_b16 a[250:251], v7 offset:30976
    ds_read_b64_tr_b16 a[252:253], v7 offset:30728
    ds_read_b64_tr_b16 a[254:255], v7 offset:30984
    s_waitcnt lgkmcnt(0)
    s_lshr_b32 s31, s29, 1
    s_and_b32 s31, s31, 1
    s_lshl_b32 s31, s31, 2
    v_lshrrev_b32 v2, 4, v1
    v_add_u32 v2, s31, v2
    v_and_b32 v3, 7, v1
    v_xor_b32 v2, v2, v3
    s_lshl_b32 s31, s29, 14
    v_lshrrev_b32 v8, 3, v1
    v_lshlrev_b32 v8, 11, v8
    v_add_u32 v8, s31, v8
    v_lshl_add_u32 v8, v2, 4, v8
    v_bfe_u32 v2, v1, 1, 3
    v_lshrrev_b32 v3, 4, v1
    v_xor_b32 v2, v2, v3
    v_bfe_u32 v3, v1, 3, 1
    v_lshlrev_b32 v3, 11, v3
    v_and_b32 v4, 7, v1
    v_lshl_add_u32 v3, v4, 7, v3
    v_xor_b32 v12, 0, v2
    v_lshl_add_u32 v12, v12, 4, v3
    v_add_u32 v14, 65536, v12
    v_xor_b32 v13, 4, v2
    v_lshl_add_u32 v13, v13, 4, v3
    v_add_u32 v15, 65536, v13
    s_lshl_b32 s31, s29, 6
    v_and_b32 v9, 15, v1
    v_lshlrev_b32 v9, 12, v9
    v_lshrrev_b32 v4, 4, v1
    v_lshl_add_u32 v9, v4, 4, v9
    v_add_u32 v9, s31, v9
    v_add_u32 v8, s34, v5
    v_lshrrev_b32 v12, 4, v1
    v_lshlrev_b32 v12, 9, v12
    v_and_b32 v4, 15, v1
    v_lshl_add_u32 v12, v4, 4, v12
    v_add_u32 v14, 65536, v12
    s_cmp_lg_u32 s29, 0
    s_cbranch_scc1 g_wdd_82
g_wd_81:
    s_load_dword s72, s[92:93], 0 glc
    s_add_u32 s41, s41, 1
    s_cmp_ge_u32 s41, 0x200000
    s_cbranch_scc1 g_wdd_82
    s_waitcnt lgkmcnt(0)
    s_and_b32 s72, s72, 0xffff
    s_cmp_ge_u32 s72, 256
    s_cbranch_scc1 g_wdd_82
    s_sleep 32
    s_branch g_wd_81
g_wdd_82:
    s_waitcnt lgkmcnt(0)
    s_barrier
    v_and_b32 v2, 31, v1
    v_lshlrev_b32 v2, 7, v2
    v_add_u32 v2, 115359744, v2
    s_cmp_lg_u32 s29, 0
    s_cbranch_scc1 g_wld_84
g_wl_83:
    buffer_load_dword v3, v2, s[4:7], 0 offen sc1
    s_add_u32 s41, s41, 1
    s_cmp_ge_u32 s41, 0x200000
    s_cbranch_scc1 g_wld_84
    s_waitcnt vmcnt(0)
    v_cmp_gt_u32 vcc, s51, v3
    s_cbranch_vccz g_wld_84
    s_sleep 8
    s_branch g_wl_83
g_wld_84:
    s_barrier
    s_lshl_b32 s35, s30, 16
    s_sub_u32 s36, s36, s37
    s_barrier
    s_add_u32 m0, s34, 0
    s_add_u32 s32, s35, 0
    buffer_load_dwordx4 v8, s[12:15], s32 offen sc1 lds
    s_add_u32 m0, s34, 4096
    s_add_u32 s32, s35, 4096
    buffer_load_dwordx4 v8, s[12:15], s32 offen sc1 lds
    s_add_u32 m0, s34, 8192
    s_add_u32 s32, s35, 8192
    buffer_load_dwordx4 v8, s[12:15], s32 offen sc1 lds
    s_add_u32 m0, s34, 12288
    s_add_u32 s32, s35, 12288
    buffer_load_dwordx4 v8, s[12:15], s32 offen sc1 lds
    s_add_u32 m0, s34, 16384
    s_add_u32 s32, s35, 16384
    buffer_load_dwordx4 v8, s[12:15], s32 offen sc1 lds
    s_add_u32 m0, s34, 20480
    s_add_u32 s32, s35, 20480
    buffer_load_dwordx4 v8, s[12:15], s32 offen sc1 lds
    s_add_u32 m0, s34, 24576
    s_add_u32 s32, s35, 24576
    buffer_load_dwordx4 v8, s[12:15], s32 offen sc1 lds
    s_add_u32 m0, s34, 28672
    s_add_u32 s32, s35, 28672
    buffer_load_dwordx4 v8, s[12:15], s32 offen sc1 lds
    s_add_u32 m0, s34, 32768
    s_add_u32 s32, s35, 32768
    buffer_load_dwordx4 v8, s[12:15], s32 offen sc1 lds
    s_add_u32 m0, s34, 36864
    s_add_u32 s32, s35, 36864
    buffer_load_dwordx4 v8, s[12:15], s32 offen sc1 lds
    s_add_u32 m0, s34, 40960
    s_add_u32 s32, s35, 40960
    buffer_load_dwordx4 v8, s[12:15], s32 offen sc1 lds
    s_add_u32 m0, s34, 45056
    s_add_u32 s32, s35, 45056
    buffer_load_dwordx4 v8, s[12:15], s32 offen sc1 lds
    s_add_u32 m0, s34, 49152
    s_add_u32 s32, s35, 49152
    buffer_load_dwordx4 v8, s[12:15], s32 offen sc1 lds
    s_add_u32 m0, s34, 53248
    s_add_u32 s32, s35, 53248
    buffer_load_dwordx4 v8, s[12:15], s32 offen sc1 lds
    s_add_u32 m0, s34, 57344
    s_add_u32 s32, s35, 57344
    buffer_load_dwordx4 v8, s[12:15], s32 offen sc1 lds
    s_add_u32 m0, s34, 61440
    s_add_u32 s32, s35, 61440
    buffer_load_dwordx4 v8, s[12:15], s32 offen sc1 lds
    s_add_u32 s35, s35, 65536
    s_add_u32 m0, s34, 65536
    s_add_u32 s32, s35, 0
    buffer_load_dwordx4 v8, s[12:15], s32 offen sc1 lds
    s_add_u32 m0, s34, 69632
    s_add_u32 s32, s35, 4096
    buffer_load_dwordx4 v8, s[12:15], s32 offen sc1 lds
    s_add_u32 m0, s34, 73728
    s_add_u32 s32, s35, 8192
    buffer_load_dwordx4 v8, s[12:15], s32 offen sc1 lds
    s_add_u32 m0, s34, 77824
    s_add_u32 s32, s35, 12288
    buffer_load_dwordx4 v8, s[12:15], s32 offen sc1 lds
    s_waitcnt vmcnt(12)
    s_barrier
    ds_read_b128 v[32:35], v12 offset:0
    ds_read_b128 v[36:39], v12 offset:256
    ds_read_b128 v[40:43], v12 offset:2048
    ds_read_b128 v[44:47], v12 offset:2304
    ds_read_b128 v[48:51], v12 offset:4096
    ds_read_b128 v[52:55], v12 offset:4352
    v_add_u32 v9, 2130706432, v9
sl_loop_87:
    s_waitcnt lgkmcnt(4)
    v_mfma_f32_16x16x32_bf16 v[64:67], a[0:3], v[32:35], 0
    ds_read_b128 v[56:59], v12 offset:6144
    v_mfma_f32_16x16x32_bf16 v[68:71], a[4:7], v[32:35], 0
    v_mfma_f32_16x16x32_bf16 v[72:75], a[0:3], v[36:39], 0
    ds_read_b128 v[60:63], v12 offset:6400
    s_add_u32 m0, s34, 81920
    s_add_u32 s32, s35, 16384
    v_mfma_f32_16x16x32_bf16 v[76:79], a[4:7], v[36:39], 0
    buffer_load_dwordx4 v8, s[12:15], s32 offen sc1 lds
    s_waitcnt lgkmcnt(4)
    v_mfma_f32_16x16x32_bf16 v[64:67], a[8:11], v[40:43], v[64:67]
    ds_read_b128 v[32:35], v12 offset:8192
    v_mfma_f32_16x16x32_bf16 v[68:71], a[12:15], v[40:43], v[68:71]
    v_mfma_f32_16x16x32_bf16 v[72:75], a[8:11], v[44:47], v[72:75]
    ds_read_b128 v[36:39], v12 offset:8448
    v_mfma_f32_16x16x32_bf16 v[76:79], a[12:15], v[44:47], v[76:79]
    s_waitcnt lgkmcnt(4)
    v_mfma_f32_16x16x32_bf16 v[64:67], a[16:19], v[48:51], v[64:67]
    ds_read_b128 v[40:43], v12 offset:10240
    v_mfma_f32_16x16x32_bf16 v[68:71], a[20:23], v[48:51], v[68:71]
    v_cvt_pk_bf16_f32 v96, v80, v81
    v_mfma_f32_16x16x32_bf16 v[72:75], a[16:19], v[52:55], v[72:75]
    ds_read_b128 v[44:47], v12 offset:10496
    s_add_u32 m0, s34, 86016
    s_add_u32 s32, s35, 20480
    v_mfma_f32_16x16x32_bf16 v[76:79], a[20:23], v[52:55], v[76:79]
    buffer_load_dwordx4 v8, s[12:15], s32 offen sc1 lds
    v_cvt_pk_bf16_f32 v97, v82, v83
    s_waitcnt lgkmcnt(4)
    v_mfma_f32_16x16x32_bf16 v[64:67], a[24:27], v[56:59], v[64:67]
    ds_read_b128 v[48:51], v12 offset:12288
    v_mfma_f32_16x16x32_bf16 v[68:71], a[28:31], v[56:59], v[68:71]
    v_cvt_pk_bf16_f32 v98, v84, v85
    v_mfma_f32_16x16x32_bf16 v[72:75], a[24:27], v[60:63], v[72:75]
    ds_read_b128 v[52:55], v12 offset:12544
    v_mfma_f32_16x16x32_bf16 v[76:79], a[28:31], v[60:63], v[76:79]
    v_cvt_pk_bf16_f32 v99, v86, v87
    s_waitcnt lgkmcnt(4)
    v_mfma_f32_16x16x32_bf16 v[64:67], a[32:35], v[32:35], v[64:67]
    ds_read_b128 v[56:59], v12 offset:14336
    v_mfma_f32_16x16x32_bf16 v[68:71], a[36:39], v[32:35], v[68:71]
    v_cvt_pk_bf16_f32 v100, v88, v89
    v_mfma_f32_16x16x32_bf16 v[72:75], a[32:35], v[36:39], v[72:75]
    ds_read_b128 v[60:63], v12 offset:14592
    s_add_u32 m0, s34, 90112
    s_add_u32 s32, s35, 24576
    v_mfma_f32_16x16x32_bf16 v[76:79], a[36:39], v[36:39], v[76:79]
    buffer_load_dwordx4 v8, s[12:15], s32 offen sc1 lds
    v_cvt_pk_bf16_f32 v101, v90, v91
    s_waitcnt lgkmcnt(4)
    v_mfma_f32_16x16x32_bf16 v[64:67], a[40:43], v[40:43], v[64:67]
    ds_read_b128 v[32:35], v12 offset:16384
    v_mfma_f32_16x16x32_bf16 v[68:71], a[44:47], v[40:43], v[68:71]
    v_cvt_pk_bf16_f32 v102, v92, v93
    v_mfma_f32_16x16x32_bf16 v[72:75], a[40:43], v[44:47], v[72:75]
    ds_read_b128 v[36:39], v12 offset:16640
    v_mfma_f32_16x16x32_bf16 v[76:79], a[44:47], v[44:47], v[76:79]
    v_cvt_pk_bf16_f32 v103, v94, v95
    buffer_store_dwordx4 v[96:99], v9, s[20:23], s36 offen
    s_add_u32 s31, s36, 65536
    s_waitcnt lgkmcnt(4)
    v_mfma_f32_16x16x32_bf16 v[64:67], a[48:51], v[48:51], v[64:67]
    ds_read_b128 v[40:43], v12 offset:18432
    v_mfma_f32_16x16x32_bf16 v[68:71], a[52:55], v[48:51], v[68:71]
    v_mfma_f32_16x16x32_bf16 v[72:75], a[48:51], v[52:55], v[72:75]
    ds_read_b128 v[44:47], v12 offset:18688
    s_add_u32 m0, s34, 94208
    s_add_u32 s32, s35, 28672
    v_mfma_f32_16x16x32_bf16 v[76:79], a[52:55], v[52:55], v[76:79]
    buffer_load_dwordx4 v8, s[12:15], s32 offen sc1 lds
    s_waitcnt lgkmcnt(4)
    v_mfma_f32_16x16x32_bf16 v[64:67], a[56:59], v[56:59], v[64:67]
    ds_read_b128 v[48:51], v12 offset:20480
    v_mfma_f32_16x16x32_bf16 v[68:71], a[60:63], v[56:59], v[68:71]
    v_mfma_f32_16x16x32_bf16 v[72:75], a[56:59], v[60:63], v[72:75]
    ds_read_b128 v[52:55], v12 offset:20736
    v_mfma_f32_16x16x32_bf16 v[76:79], a[60:63], v[60:63], v[76:79]
    buffer_store_dwordx4 v[100:103], v9, s[20:23], s31 offen
    s_add_u32 s36, s36, s37
    s_waitcnt vmcnt(8)
    s_barrier
    s_waitcnt lgkmcnt(4)
    v_mfma_f32_16x16x32_bf16 v[64:67], a[64:67], v[32:35], v[64:67]
    ds_read_b128 v[56:59], v12 offset:22528
    v_mfma_f32_16x16x32_bf16 v[68:71], a[68:71], v[32:35], v[68:71]
    v_mfma_f32_16x16x32_bf16 v[72:75], a[64:67], v[36:39], v[72:75]
    ds_read_b128 v[60:63], v12 offset:22784
    s_add_u32 m0, s34, 98304
    s_add_u32 s32, s35, 32768
    v_mfma_f32_16x16x32_bf16 v[76:79], a[68:71], v[36:39], v[76:79]
    buffer_load_dwordx4 v8, s[12:15], s32 offen sc1 lds
    s_waitcnt lgkmcnt(4)
    v_mfma_f32_16x16x32_bf16 v[64:67], a[72:75], v[40:43], v[64:67]
    ds_read_b128 v[32:35], v12 offset:24576
    v_mfma_f32_16x16x32_bf16 v[68:71], a[76:79], v[40:43], v[68:71]
    v_mfma_f32_16x16x32_bf16 v[72:75], a[72:75], v[44:47], v[72:75]
    ds_read_b128 v[36:39], v12 offset:24832
    v_mfma_f32_16x16x32_bf16 v[76:79], a[76:79], v[44:47], v[76:79]
    s_waitcnt lgkmcnt(4)
    v_mfma_f32_16x16x32_bf16 v[64:67], a[80:83], v[48:51], v[64:67]
    ds_read_b128 v[40:43], v12 offset:26624
    v_mfma_f32_16x16x32_bf16 v[68:71], a[84:87], v[48:51], v[68:71]
    v_and_b32 v9, 0xffffff, v9
    v_mfma_f32_16x16x32_bf16 v[72:75], a[80:83], v[52:55], v[72:75]
    ds_read_b128 v[44:47], v12 offset:26880
    s_add_u32 m0, s34, 102400
    s_add_u32 s32, s35, 36864
    v_mfma_f32_16x16x32_bf16 v[76:79], a[84:87], v[52:55], v[76:79]
    buffer_load_dwordx4 v8, s[12:15], s32 offen sc1 lds
    s_waitcnt lgkmcnt(4)
    v_mfma_f32_16x16x32_bf16 v[64:67], a[88:91], v[56:59], v[64:67]
    ds_read_b128 v[48:51], v12 offset:28672
    v_mfma_f32_16x16x32_bf16 v[68:71], a[92:95], v[56:59], v[68:71]
    v_mfma_f32_16x16x32_bf16 v[72:75], a[88:91], v[60:63], v[72:75]
    ds_read_b128 v[52:55], v12 offset:28928
    v_mfma_f32_16x16x32_bf16 v[76:79], a[92:95], v[60:63], v[76:79]
    s_waitcnt lgkmcnt(4)
    v_mfma_f32_16x16x32_bf16 v[64:67], a[96:99], v[32:35], v[64:67]
    ds_read_b128 v[56:59], v12 offset:30720
    v_mfma_f32_16x16x32_bf16 v[68:71], a[100:103], v[32:35], v[68:71]
    v_mfma_f32_16x16x32_bf16 v[72:75], a[96:99], v[36:39], v[72:75]
    ds_read_b128 v[60:63], v12 offset:30976
    s_add_u32 m0, s34, 106496
    s_add_u32 s32, s35, 40960
    v_mfma_f32_16x16x32_bf16 v[76:79], a[100:103], v[36:39], v[76:79]
    buffer_load_dwordx4 v8, s[12:15], s32 offen sc1 lds
    s_waitcnt lgkmcnt(4)
    v_mfma_f32_16x16x32_bf16 v[64:67], a[104:107], v[40:43], v[64:67]
    ds_read_b128 v[32:35], v12 offset:32768
    v_mfma_f32_16x16x32_bf16 v[68:71], a[108:111], v[40:43], v[68:71]
    v_mfma_f32_16x16x32_bf16 v[72:75], a[104:107], v[44:47], v[72:75]
    ds_read_b128 v[36:39], v12 offset:33024
    v_mfma_f32_16x16x32_bf16 v[76:79], a[108:111], v[44:47], v[76:79]
    s_waitcnt lgkmcnt(4)
    v_mfma_f32_16x16x32_bf16 v[64:67], a[112:115], v[48:51], v[64:67]
    ds_read_b128 v[40:43], v12 offset:34816
    v_mfma_f32_16x16x32_bf16 v[68:71], a[116:119], v[48:51], v[68:71]
    v_mfma_f32_16x16x32_bf16 v[72:75], a[112:115], v[52:55], v[72:75]
    ds_read_b128 v[44:47], v12 offset:35072
    s_add_u32 m0, s34, 110592
    s_add_u32 s32, s35, 45056
    v_mfma_f32_16x16x32_bf16 v[76:79], a[116:119], v[52:55], v[76:79]
    buffer_load_dwordx4 v8, s[12:15], s32 offen sc1 lds
    s_waitcnt lgkmcnt(4)
    v_mfma_f32_16x16x32_bf16 v[64:67], a[120:123], v[56:59], v[64:67]
    ds_read_b128 v[48:51], v12 offset:36864
    v_mfma_f32_16x16x32_bf16 v[68:71], a[124:127], v[56:59], v[68:71]
    v_mfma_f32_16x16x32_bf16 v[72:75], a[120:123], v[60:63], v[72:75]
    ds_read_b128 v[52:55], v12 offset:37120
    v_mfma_f32_16x16x32_bf16 v[76:79], a[124:127], v[60:63], v[76:79]
    s_waitcnt lgkmcnt(4)
    v_mfma_f32_16x16x32_bf16 v[64:67], a[128:131], v[32:35], v[64:67]
    ds_read_b128 v[56:59], v12 offset:38912
    v_mfma_f32_16x16x32_bf16 v[68:71], a[132:135], v[32:35], v[68:71]
    v_mfma_f32_16x16x32_bf16 v[72:75], a[128:131], v[36:39], v[72:75]
    ds_read_b128 v[60:63], v12 offset:39168
    s_add_u32 m0, s34, 114688
    s_add_u32 s32, s35, 49152
    v_mfma_f32_16x16x32_bf16 v[76:79], a[132:135], v[36:39], v[76:79]
    buffer_load_dwordx4 v8, s[12:15], s32 offen sc1 lds
    s_waitcnt lgkmcnt(4)
    v_mfma_f32_16x16x32_bf16 v[64:67], a[136:139], v[40:43], v[64:67]
    ds_read_b128 v[32:35], v12 offset:40960
    v_mfma_f32_16x16x32_bf16 v[68:71], a[140:143], v[40:43], v[68:71]
    v_mfma_f32_16x16x32_bf16 v[72:75], a[136:139], v[44:47], v[72:75]
    ds_read_b128 v[36:39], v12 offset:41216
    v_mfma_f32_16x16x32_bf16 v[76:79], a[140:143], v[44:47], v[76:79]
    s_waitcnt lgkmcnt(4)
    v_mfma_f32_16x16x32_bf16 v[64:67], a[144:147], v[48:51], v[64:67]
    ds_read_b128 v[40:43], v12 offset:43008
    v_mfma_f32_16x16x32_bf16 v[68:71], a[148:151], v[48:51], v[68:71]
    v_mfma_f32_16x16x32_bf16 v[72:75], a[144:147], v[52:55], v[72:75]
    ds_read_b128 v[44:47], v12 offset:43264
    s_add_u32 m0, s34, 118784
    s_add_u32 s32, s35, 53248
    v_mfma_f32_16x16x32_bf16 v[76:79], a[148:151], v[52:55], v[76:79]
    buffer_load_dwordx4 v8, s[12:15], s32 offen sc1 lds
    s_waitcnt lgkmcnt(4)
    v_mfma_f32_16x16x32_bf16 v[64:67], a[152:155], v[56:59], v[64:67]
    ds_read_b128 v[48:51], v12 offset:45056
    v_mfma_f32_16x16x32_bf16 v[68:71], a[156:159], v[56:59], v[68:71]
    v_mfma_f32_16x16x32_bf16 v[72:75], a[152:155], v[60:63], v[72:75]
    ds_read_b128 v[52:55], v12 offset:45312
    v_mfma_f32_16x16x32_bf16 v[76:79], a[156:159], v[60:63], v[76:79]
    s_waitcnt lgkmcnt(4)
    v_mfma_f32_16x16x32_bf16 v[64:67], a[160:163], v[32:35], v[64:67]
    ds_read_b128 v[56:59], v12 offset:47104
    v_mfma_f32_16x16x32_bf16 v[68:71], a[164:167], v[32:35], v[68:71]
    v_mfma_f32_16x16x32_bf16 v[72:75], a[160:163], v[36:39], v[72:75]
    ds_read_b128 v[60:63], v12 offset:47360
    s_add_u32 m0, s34, 122880
    s_add_u32 s32, s35, 57344
    v_mfma_f32_16x16x32_bf16 v[76:79], a[164:167], v[36:39], v[76:79]
    buffer_load_dwordx4 v8, s[12:15], s32 offen sc1 lds
    s_waitcnt lgkmcnt(4)
    v_mfma_f32_16x16x32_bf16 v[64:67], a[168:171], v[40:43], v[64:67]
    ds_read_b128 v[32:35], v12 offset:49152
    v_mfma_f32_16x16x32_bf16 v[68:71], a[172:175], v[40:43], v[68:71]
    v_mfma_f32_16x16x32_bf16 v[72:75], a[168:171], v[44:47], v[72:75]
    ds_read_b128 v[36:39], v12 offset:49408
    v_mfma_f32_16x16x32_bf16 v[76:79], a[172:175], v[44:47], v[76:79]
    s_waitcnt lgkmcnt(4)
    v_mfma_f32_16x16x32_bf16 v[64:67], a[176:179], v[48:51], v[64:67]
    ds_read_b128 v[40:43], v12 offset:51200
    v_mfma_f32_16x16x32_bf16 v[68:71], a[180:183], v[48:51], v[68:71]
    v_mfma_f32_16x16x32_bf16 v[72:75], a[176:179], v[52:55], v[72:75]
    ds_read_b128 v[44:47], v12 offset:51456
    s_add_u32 m0, s34, 126976
    s_add_u32 s32, s35, 61440
    v_mfma_f32_16x16x32_bf16 v[76:79], a[180:183], v[52:55], v[76:79]
    buffer_load_dwordx4 v8, s[12:15], s32 offen sc1 lds
    s_add_u32 s35, s35, 65536
    s_min_u32 s35, s35, s52
    s_waitcnt lgkmcnt(4)
    v_mfma_f32_16x16x32_bf16 v[64:67], a[184:187], v[56:59], v[64:67]
    ds_read_b128 v[48:51], v12 offset:53248
    v_mfma_f32_16x16x32_bf16 v[68:71], a[188:191], v[56:59], v[68:71]
    v_mfma_f32_16x16x32_bf16 v[72:75], a[184:187], v[60:63], v[72:75]
    ds_read_b128 v[52:55], v12 offset:53504
    v_mfma_f32_16x16x32_bf16 v[76:79], a[188:191], v[60:63], v[76:79]
    s_waitcnt vmcnt(8)
    s_barrier
    s_waitcnt lgkmcnt(4)
    v_mfma_f32_16x16x32_bf16 v[64:67], a[192:195], v[32:35], v[64:67]
    ds_read_b128 v[56:59], v12 offset:55296
    v_mfma_f32_16x16x32_bf16 v[68:71], a[196:199], v[32:35], v[68:71]
    v_mfma_f32_16x16x32_bf16 v[72:75], a[192:195], v[36:39], v[72:75]
    ds_read_b128 v[60:63], v12 offset:55552
    s_add_u32 m0, s34, 0
    s_add_u32 s32, s35, 0
    v_mfma_f32_16x16x32_bf16 v[76:79], a[196:199], v[36:39], v[76:79]
    buffer_load_dwordx4 v8, s[12:15], s32 offen sc1 lds
    s_waitcnt lgkmcnt(4)
    v_mfma_f32_16x16x32_bf16 v[64:67], a[200:203], v[40:43], v[64:67]
    ds_read_b128 v[32:35], v12 offset:57344
    v_mfma_f32_16x16x32_bf16 v[68:71], a[204:207], v[40:43], v[68:71]
    v_mfma_f32_16x16x32_bf16 v[72:75], a[200:203], v[44:47], v[72:75]
    ds_read_b128 v[36:39], v12 offset:57600
    v_mfma_f32_16x16x32_bf16 v[76:79], a[204:207], v[44:47], v[76:79]
    s_waitcnt lgkmcnt(4)
    v_mfma_f32_16x16x32_bf16 v[64:67], a[208:211], v[48:51], v[64:67]
    ds_read_b128 v[40:43], v12 offset:59392
    v_mfma_f32_16x16x32_bf16 v[68:71], a[212:215], v[48:51], v[68:71]
    v_mfma_f32_16x16x32_bf16 v[72:75], a[208:211], v[52:55], v[72:75]
    ds_read_b128 v[44:47], v12 offset:59648
    s_add_u32 m0, s34, 4096
    s_add_u32 s32, s35, 4096
    v_mfma_f32_16x16x32_bf16 v[76:79], a[212:215], v[52:55], v[76:79]
    buffer_load_dwordx4 v8, s[12:15], s32 offen sc1 lds
    s_waitcnt lgkmcnt(4)
    v_mfma_f32_16x16x32_bf16 v[64:67], a[216:219], v[56:59], v[64:67]
    ds_read_b128 v[48:51], v12 offset:61440
    v_mfma_f32_16x16x32_bf16 v[68:71], a[220:223], v[56:59], v[68:71]
    v_mfma_f32_16x16x32_bf16 v[72:75], a[216:219], v[60:63], v[72:75]
    ds_read_b128 v[52:55], v12 offset:61696
    v_mfma_f32_16x16x32_bf16 v[76:79], a[220:223], v[60:63], v[76:79]
    s_waitcnt lgkmcnt(4)
    v_mfma_f32_16x16x32_bf16 v[64:67], a[224:227], v[32:35], v[64:67]
    ds_read_b128 v[56:59], v12 offset:63488
    v_mfma_f32_16x16x32_bf16 v[68:71], a[228:231], v[32:35], v[68:71]
    v_mfma_f32_16x16x32_bf16 v[72:75], a[224:227], v[36:39], v[72:75]
    ds_read_b128 v[60:63], v12 offset:63744
    s_add_u32 m0, s34, 8192
    s_add_u32 s32, s35, 8192
    v_mfma_f32_16x16x32_bf16 v[76:79], a[228:231], v[36:39], v[76:79]
    buffer_load_dwordx4 v8, s[12:15], s32 offen sc1 lds
    s_waitcnt lgkmcnt(4)
    v_mfma_f32_16x16x32_bf16 v[64:67], a[232:235], v[40:43], v[64:67]
    ds_read_b128 v[32:35], v14 offset:0
    v_mfma_f32_16x16x32_bf16 v[68:71], a[236:239], v[40:43], v[68:71]
    v_mfma_f32_16x16x32_bf16 v[72:75], a[232:235], v[44:47], v[72:75]
    ds_read_b128 v[36:39], v14 offset:256
    v_mfma_f32_16x16x32_bf16 v[76:79], a[236:239], v[44:47], v[76:79]
    s_waitcnt lgkmcnt(4)
    v_mfma_f32_16x16x32_bf16 v[64:67], a[240:243], v[48:51], v[64:67]
    ds_read_b128 v[40:43], v14 offset:2048
    v_mfma_f32_16x16x32_bf16 v[68:71], a[244:247], v[48:51], v[68:71]
    v_mfma_f32_16x16x32_bf16 v[72:75], a[240:243], v[52:55], v[72:75]
    ds_read_b128 v[44:47], v14 offset:2304
    s_add_u32 m0, s34, 12288
    s_add_u32 s32, s35, 12288
    v_mfma_f32_16x16x32_bf16 v[76:79], a[244:247], v[52:55], v[76:79]
    buffer_load_dwordx4 v8, s[12:15], s32 offen sc1 lds
    s_waitcnt lgkmcnt(4)
    v_mfma_f32_16x16x32_bf16 v[64:67], a[248:251], v[56:59], v[64:67]
    ds_read_b128 v[48:51], v14 offset:4096
    v_mfma_f32_16x16x32_bf16 v[68:71], a[252:255], v[56:59], v[68:71]
    v_mfma_f32_16x16x32_bf16 v[72:75], a[248:251], v[60:63], v[72:75]
    ds_read_b128 v[52:55], v14 offset:4352
    v_mfma_f32_16x16x32_bf16 v[76:79], a[252:255], v[60:63], v[76:79]
    s_waitcnt lgkmcnt(4)
    v_mfma_f32_16x16x32_bf16 v[80:83], a[0:3], v[32:35], 0
    ds_read_b128 v[56:59], v14 offset:6144
    v_mfma_f32_16x16x32_bf16 v[84:87], a[4:7], v[32:35], 0
    v_mfma_f32_16x16x32_bf16 v[88:91], a[0:3], v[36:39], 0
    ds_read_b128 v[60:63], v14 offset:6400
    s_add_u32 m0, s34, 16384
    s_add_u32 s32, s35, 16384
    v_mfma_f32_16x16x32_bf16 v[92:95], a[4:7], v[36:39], 0
    buffer_load_dwordx4 v8, s[12:15], s32 offen sc1 lds
    s_waitcnt lgkmcnt(4)
    v_mfma_f32_16x16x32_bf16 v[80:83], a[8:11], v[40:43], v[80:83]
    ds_read_b128 v[32:35], v14 offset:8192
    v_mfma_f32_16x16x32_bf16 v[84:87], a[12:15], v[40:43], v[84:87]
    v_mfma_f32_16x16x32_bf16 v[88:91], a[8:11], v[44:47], v[88:91]
    ds_read_b128 v[36:39], v14 offset:8448
    v_mfma_f32_16x16x32_bf16 v[92:95], a[12:15], v[44:47], v[92:95]
    s_waitcnt lgkmcnt(4)
    v_mfma_f32_16x16x32_bf16 v[80:83], a[16:19], v[48:51], v[80:83]
    ds_read_b128 v[40:43], v14 offset:10240
    v_mfma_f32_16x16x32_bf16 v[84:87], a[20:23], v[48:51], v[84:87]
    v_cvt_pk_bf16_f32 v96, v64, v65
    v_mfma_f32_16x16x32_bf16 v[88:91], a[16:19], v[52:55], v[88:91]
    ds_read_b128 v[44:47], v14 offset:10496
    s_add_u32 m0, s34, 20480
    s_add_u32 s32, s35, 20480
    v_mfma_f32_16x16x32_bf16 v[92:95], a[20:23], v[52:55], v[92:95]
    buffer_load_dwordx4 v8, s[12:15], s32 offen sc1 lds
    v_cvt_pk_bf16_f32 v97, v66, v67
    s_waitcnt lgkmcnt(4)
    v_mfma_f32_16x16x32_bf16 v[80:83], a[24:27], v[56:59], v[80:83]
    ds_read_b128 v[48:51], v14 offset:12288
    v_mfma_f32_16x16x32_bf16 v[84:87], a[28:31], v[56:59], v[84:87]
    v_cvt_pk_bf16_f32 v98, v68, v69
    v_mfma_f32_16x16x32_bf16 v[88:91], a[24:27], v[60:63], v[88:91]
    ds_read_b128 v[52:55], v14 offset:12544
    v_mfma_f32_16x16x32_bf16 v[92:95], a[28:31], v[60:63], v[92:95]
    v_cvt_pk_bf16_f32 v99, v70, v71
    s_waitcnt lgkmcnt(4)
    v_mfma_f32_16x16x32_bf16 v[80:83], a[32:35], v[32:35], v[80:83]
    ds_read_b128 v[56:59], v14 offset:14336
    v_mfma_f32_16x16x32_bf16 v[84:87], a[36:39], v[32:35], v[84:87]
    v_cvt_pk_bf16_f32 v100, v72, v73
    v_mfma_f32_16x16x32_bf16 v[88:91], a[32:35], v[36:39], v[88:91]
    ds_read_b128 v[60:63], v14 offset:14592
    s_add_u32 m0, s34, 24576
    s_add_u32 s32, s35, 24576
    v_mfma_f32_16x16x32_bf16 v[92:95], a[36:39], v[36:39], v[92:95]
    buffer_load_dwordx4 v8, s[12:15], s32 offen sc1 lds
    v_cvt_pk_bf16_f32 v101, v74, v75
    s_waitcnt lgkmcnt(4)
    v_mfma_f32_16x16x32_bf16 v[80:83], a[40:43], v[40:43], v[80:83]
    ds_read_b128 v[32:35], v14 offset:16384
    v_mfma_f32_16x16x32_bf16 v[84:87], a[44:47], v[40:43], v[84:87]
    v_cvt_pk_bf16_f32 v102, v76, v77
    v_mfma_f32_16x16x32_bf16 v[88:91], a[40:43], v[44:47], v[88:91]
    ds_read_b128 v[36:39], v14 offset:16640
    v_mfma_f32_16x16x32_bf16 v[92:95], a[44:47], v[44:47], v[92:95]
    v_cvt_pk_bf16_f32 v103, v78, v79
    buffer_store_dwordx4 v[96:99], v9, s[20:23], s36 offen
    s_add_u32 s31, s36, 65536
    s_waitcnt lgkmcnt(4)
    v_mfma_f32_16x16x32_bf16 v[80:83], a[48:51], v[48:51], v[80:83]
    ds_read_b128 v[40:43], v14 offset:18432
    v_mfma_f32_16x16x32_bf16 v[84:87], a[52:55], v[48:51], v[84:87]
    v_mfma_f32_16x16x32_bf16 v[88:91], a[48:51], v[52:55], v[88:91]
    ds_read_b128 v[44:47], v14 offset:18688
    s_add_u32 m0, s34, 28672
    s_add_u32 s32, s35, 28672
    v_mfma_f32_16x16x32_bf16 v[92:95], a[52:55], v[52:55], v[92:95]
    buffer_load_dwordx4 v8, s[12:15], s32 offen sc1 lds
    s_waitcnt lgkmcnt(4)
    v_mfma_f32_16x16x32_bf16 v[80:83], a[56:59], v[56:59], v[80:83]
    ds_read_b128 v[48:51], v14 offset:20480
    v_mfma_f32_16x16x32_bf16 v[84:87], a[60:63], v[56:59], v[84:87]
    v_mfma_f32_16x16x32_bf16 v[88:91], a[56:59], v[60:63], v[88:91]
    ds_read_b128 v[52:55], v14 offset:20736
    v_mfma_f32_16x16x32_bf16 v[92:95], a[60:63], v[60:63], v[92:95]
    buffer_store_dwordx4 v[100:103], v9, s[20:23], s31 offen
    s_add_u32 s36, s36, s37
    s_waitcnt vmcnt(8)
    s_barrier
    s_waitcnt lgkmcnt(4)
    v_mfma_f32_16x16x32_bf16 v[80:83], a[64:67], v[32:35], v[80:83]
    ds_read_b128 v[56:59], v14 offset:22528
    v_mfma_f32_16x16x32_bf16 v[84:87], a[68:71], v[32:35], v[84:87]
    v_mfma_f32_16x16x32_bf16 v[88:91], a[64:67], v[36:39], v[88:91]
    ds_read_b128 v[60:63], v14 offset:22784
    s_add_u32 m0, s34, 32768
    s_add_u32 s32, s35, 32768
    v_mfma_f32_16x16x32_bf16 v[92:95], a[68:71], v[36:39], v[92:95]
    buffer_load_dwordx4 v8, s[12:15], s32 offen sc1 lds
    s_waitcnt lgkmcnt(4)
    v_mfma_f32_16x16x32_bf16 v[80:83], a[72:75], v[40:43], v[80:83]
    ds_read_b128 v[32:35], v14 offset:24576
    v_mfma_f32_16x16x32_bf16 v[84:87], a[76:79], v[40:43], v[84:87]
    v_mfma_f32_16x16x32_bf16 v[88:91], a[72:75], v[44:47], v[88:91]
    ds_read_b128 v[36:39], v14 offset:24832
    v_mfma_f32_16x16x32_bf16 v[92:95], a[76:79], v[44:47], v[92:95]
    s_waitcnt lgkmcnt(4)
    v_mfma_f32_16x16x32_bf16 v[80:83], a[80:83], v[48:51], v[80:83]
    ds_read_b128 v[40:43], v14 offset:26624
    v_mfma_f32_16x16x32_bf16 v[84:87], a[84:87], v[48:51], v[84:87]
    v_mfma_f32_16x16x32_bf16 v[88:91], a[80:83], v[52:55], v[88:91]
    ds_read_b128 v[44:47], v14 offset:26880
    s_add_u32 m0, s34, 36864
    s_add_u32 s32, s35, 36864
    v_mfma_f32_16x16x32_bf16 v[92:95], a[84:87], v[52:55], v[92:95]
    buffer_load_dwordx4 v8, s[12:15], s32 offen sc1 lds
    s_waitcnt lgkmcnt(4)
    v_mfma_f32_16x16x32_bf16 v[80:83], a[88:91], v[56:59], v[80:83]
    ds_read_b128 v[48:51], v14 offset:28672
    v_mfma_f32_16x16x32_bf16 v[84:87], a[92:95], v[56:59], v[84:87]
    v_mfma_f32_16x16x32_bf16 v[88:91], a[88:91], v[60:63], v[88:91]
    ds_read_b128 v[52:55], v14 offset:28928
    v_mfma_f32_16x16x32_bf16 v[92:95], a[92:95], v[60:63], v[92:95]
    s_waitcnt lgkmcnt(4)
    v_mfma_f32_16x16x32_bf16 v[80:83], a[96:99], v[32:35], v[80:83]
    ds_read_b128 v[56:59], v14 offset:30720
    v_mfma_f32_16x16x32_bf16 v[84:87], a[100:103], v[32:35], v[84:87]
    v_mfma_f32_16x16x32_bf16 v[88:91], a[96:99], v[36:39], v[88:91]
    ds_read_b128 v[60:63], v14 offset:30976
    s_add_u32 m0, s34, 40960
    s_add_u32 s32, s35, 40960
    v_mfma_f32_16x16x32_bf16 v[92:95], a[100:103], v[36:39], v[92:95]
    buffer_load_dwordx4 v8, s[12:15], s32 offen sc1 lds
    s_waitcnt lgkmcnt(4)
    v_mfma_f32_16x16x32_bf16 v[80:83], a[104:107], v[40:43], v[80:83]
    ds_read_b128 v[32:35], v14 offset:32768
    v_mfma_f32_16x16x32_bf16 v[84:87], a[108:111], v[40:43], v[84:87]
    v_mfma_f32_16x16x32_bf16 v[88:91], a[104:107], v[44:47], v[88:91]
    ds_read_b128 v[36:39], v14 offset:33024
    v_mfma_f32_16x16x32_bf16 v[92:95], a[108:111], v[44:47], v[92:95]
    s_waitcnt lgkmcnt(4)
    v_mfma_f32_16x16x32_bf16 v[80:83], a[112:115], v[48:51], v[80:83]
    ds_read_b128 v[40:43], v14 offset:34816
    v_mfma_f32_16x16x32_bf16 v[84:87], a[116:119], v[48:51], v[84:87]
    v_mfma_f32_16x16x32_bf16 v[88:91], a[112:115], v[52:55], v[88:91]
    ds_read_b128 v[44:47], v14 offset:35072
    s_add_u32 m0, s34, 45056
    s_add_u32 s32, s35, 45056
    v_mfma_f32_16x16x32_bf16 v[92:95], a[116:119], v[52:55], v[92:95]
    buffer_load_dwordx4 v8, s[12:15], s32 offen sc1 lds
    s_waitcnt lgkmcnt(4)
    v_mfma_f32_16x16x32_bf16 v[80:83], a[120:123], v[56:59], v[80:83]
    ds_read_b128 v[48:51], v14 offset:36864
    v_mfma_f32_16x16x32_bf16 v[84:87], a[124:127], v[56:59], v[84:87]
    v_mfma_f32_16x16x32_bf16 v[88:91], a[120:123], v[60:63], v[88:91]
    ds_read_b128 v[52:55], v14 offset:37120
    v_mfma_f32_16x16x32_bf16 v[92:95], a[124:127], v[60:63], v[92:95]
    s_waitcnt lgkmcnt(4)
    v_mfma_f32_16x16x32_bf16 v[80:83], a[128:131], v[32:35], v[80:83]
    ds_read_b128 v[56:59], v14 offset:38912
    v_mfma_f32_16x16x32_bf16 v[84:87], a[132:135], v[32:35], v[84:87]
    v_mfma_f32_16x16x32_bf16 v[88:91], a[128:131], v[36:39], v[88:91]
    ds_read_b128 v[60:63], v14 offset:39168
    s_add_u32 m0, s34, 49152
    s_add_u32 s32, s35, 49152
    v_mfma_f32_16x16x32_bf16 v[92:95], a[132:135], v[36:39], v[92:95]
    buffer_load_dwordx4 v8, s[12:15], s32 offen sc1 lds
    s_waitcnt lgkmcnt(4)
    v_mfma_f32_16x16x32_bf16 v[80:83], a[136:139], v[40:43], v[80:83]
    ds_read_b128 v[32:35], v14 offset:40960
    v_mfma_f32_16x16x32_bf16 v[84:87], a[140:143], v[40:43], v[84:87]
    v_mfma_f32_16x16x32_bf16 v[88:91], a[136:139], v[44:47], v[88:91]
    ds_read_b128 v[36:39], v14 offset:41216
    v_mfma_f32_16x16x32_bf16 v[92:95], a[140:143], v[44:47], v[92:95]
    s_waitcnt lgkmcnt(4)
    v_mfma_f32_16x16x32_bf16 v[80:83], a[144:147], v[48:51], v[80:83]
    ds_read_b128 v[40:43], v14 offset:43008
    v_mfma_f32_16x16x32_bf16 v[84:87], a[148:151], v[48:51], v[84:87]
    v_mfma_f32_16x16x32_bf16 v[88:91], a[144:147], v[52:55], v[88:91]
    ds_read_b128 v[44:47], v14 offset:43264
    s_add_u32 m0, s34, 53248
    s_add_u32 s32, s35, 53248
    v_mfma_f32_16x16x32_bf16 v[92:95], a[148:151], v[52:55], v[92:95]
    buffer_load_dwordx4 v8, s[12:15], s32 offen sc1 lds
    s_waitcnt lgkmcnt(4)
    v_mfma_f32_16x16x32_bf16 v[80:83], a[152:155], v[56:59], v[80:83]
    ds_read_b128 v[48:51], v14 offset:45056
    v_mfma_f32_16x16x32_bf16 v[84:87], a[156:159], v[56:59], v[84:87]
    v_mfma_f32_16x16x32_bf16 v[88:91], a[152:155], v[60:63], v[88:91]
    ds_read_b128 v[52:55], v14 offset:45312
    v_mfma_f32_16x16x32_bf16 v[92:95], a[156:159], v[60:63], v[92:95]
    s_waitcnt lgkmcnt(4)
    v_mfma_f32_16x16x32_bf16 v[80:83], a[160:163], v[32:35], v[80:83]
    ds_read_b128 v[56:59], v14 offset:47104
    v_mfma_f32_16x16x32_bf16 v[84:87], a[164:167], v[32:35], v[84:87]
    v_mfma_f32_16x16x32_bf16 v[88:91], a[160:163], v[36:39], v[88:91]
    ds_read_b128 v[60:63], v14 offset:47360
    s_add_u32 m0, s34, 57344
    s_add_u32 s32, s35, 57344
    v_mfma_f32_16x16x32_bf16 v[92:95], a[164:167], v[36:39], v[92:95]
    buffer_load_dwordx4 v8, s[12:15], s32 offen sc1 lds
    s_waitcnt lgkmcnt(4)
    v_mfma_f32_16x16x32_bf16 v[80:83], a[168:171], v[40:43], v[80:83]
    ds_read_b128 v[32:35], v14 offset:49152
    v_mfma_f32_16x16x32_bf16 v[84:87], a[172:175], v[40:43], v[84:87]
    v_mfma_f32_16x16x32_bf16 v[88:91], a[168:171], v[44:47], v[88:91]
    ds_read_b128 v[36:39], v14 offset:49408
    v_mfma_f32_16x16x32_bf16 v[92:95], a[172:175], v[44:47], v[92:95]
    s_waitcnt lgkmcnt(4)
    v_mfma_f32_16x16x32_bf16 v[80:83], a[176:179], v[48:51], v[80:83]
    ds_read_b128 v[40:43], v14 offset:51200
    v_mfma_f32_16x16x32_bf16 v[84:87], a[180:183], v[48:51], v[84:87]
    v_mfma_f32_16x16x32_bf16 v[88:91], a[176:179], v[52:55], v[88:91]
    ds_read_b128 v[44:47], v14 offset:51456
    s_add_u32 m0, s34, 61440
    s_add_u32 s32, s35, 61440
    v_mfma_f32_16x16x32_bf16 v[92:95], a[180:183], v[52:55], v[92:95]
    buffer_load_dwordx4 v8, s[12:15], s32 offen sc1 lds
    s_add_u32 s35, s35, 65536
    s_min_u32 s35, s35, s52
    s_waitcnt lgkmcnt(4)
    v_mfma_f32_16x16x32_bf16 v[80:83], a[184:187], v[56:59], v[80:83]
    ds_read_b128 v[48:51], v14 offset:53248
    v_mfma_f32_16x16x32_bf16 v[84:87], a[188:191], v[56:59], v[84:87]
    v_mfma_f32_16x16x32_bf16 v[88:91], a[184:187], v[60:63], v[88:91]
    ds_read_b128 v[52:55], v14 offset:53504
    v_mfma_f32_16x16x32_bf16 v[92:95], a[188:191], v[60:63], v[92:95]
    s_waitcnt vmcnt(8)
    s_barrier
    s_waitcnt lgkmcnt(4)
    v_mfma_f32_16x16x32_bf16 v[80:83], a[192:195], v[32:35], v[80:83]
    ds_read_b128 v[56:59], v14 offset:55296
    v_mfma_f32_16x16x32_bf16 v[84:87], a[196:199], v[32:35], v[84:87]
    v_mfma_f32_16x16x32_bf16 v[88:91], a[192:195], v[36:39], v[88:91]
    ds_read_b128 v[60:63], v14 offset:55552
    s_add_u32 m0, s34, 65536
    s_add_u32 s32, s35, 0
    v_mfma_f32_16x16x32_bf16 v[92:95], a[196:199], v[36:39], v[92:95]
    buffer_load_dwordx4 v8, s[12:15], s32 offen sc1 lds
    s_waitcnt lgkmcnt(4)
    v_mfma_f32_16x16x32_bf16 v[80:83], a[200:203], v[40:43], v[80:83]
    ds_read_b128 v[32:35], v14 offset:57344
    v_mfma_f32_16x16x32_bf16 v[84:87], a[204:207], v[40:43], v[84:87]
    v_mfma_f32_16x16x32_bf16 v[88:91], a[200:203], v[44:47], v[88:91]
    ds_read_b128 v[36:39], v14 offset:57600
    v_mfma_f32_16x16x32_bf16 v[92:95], a[204:207], v[44:47], v[92:95]
    s_waitcnt lgkmcnt(4)
    v_mfma_f32_16x16x32_bf16 v[80:83], a[208:211], v[48:51], v[80:83]
    ds_read_b128 v[40:43], v14 offset:59392
    v_mfma_f32_16x16x32_bf16 v[84:87], a[212:215], v[48:51], v[84:87]
    v_mfma_f32_16x16x32_bf16 v[88:91], a[208:211], v[52:55], v[88:91]
    ds_read_b128 v[44:47], v14 offset:59648
    s_add_u32 m0, s34, 69632
    s_add_u32 s32, s35, 4096
    v_mfma_f32_16x16x32_bf16 v[92:95], a[212:215], v[52:55], v[92:95]
    buffer_load_dwordx4 v8, s[12:15], s32 offen sc1 lds
    s_waitcnt lgkmcnt(4)
    v_mfma_f32_16x16x32_bf16 v[80:83], a[216:219], v[56:59], v[80:83]
    ds_read_b128 v[48:51], v14 offset:61440
    v_mfma_f32_16x16x32_bf16 v[84:87], a[220:223], v[56:59], v[84:87]
    v_mfma_f32_16x16x32_bf16 v[88:91], a[216:219], v[60:63], v[88:91]
    ds_read_b128 v[52:55], v14 offset:61696
    v_mfma_f32_16x16x32_bf16 v[92:95], a[220:223], v[60:63], v[92:95]
    s_waitcnt lgkmcnt(4)
    v_mfma_f32_16x16x32_bf16 v[80:83], a[224:227], v[32:35], v[80:83]
    ds_read_b128 v[56:59], v14 offset:63488
    v_mfma_f32_16x16x32_bf16 v[84:87], a[228:231], v[32:35], v[84:87]
    v_mfma_f32_16x16x32_bf16 v[88:91], a[224:227], v[36:39], v[88:91]
    ds_read_b128 v[60:63], v14 offset:63744
    s_add_u32 m0, s34, 73728
    s_add_u32 s32, s35, 8192
    v_mfma_f32_16x16x32_bf16 v[92:95], a[228:231], v[36:39], v[92:95]
    buffer_load_dwordx4 v8, s[12:15], s32 offen sc1 lds
    s_waitcnt lgkmcnt(4)
    v_mfma_f32_16x16x32_bf16 v[80:83], a[232:235], v[40:43], v[80:83]
    ds_read_b128 v[32:35], v12 offset:0
    v_mfma_f32_16x16x32_bf16 v[84:87], a[236:239], v[40:43], v[84:87]
    v_mfma_f32_16x16x32_bf16 v[88:91], a[232:235], v[44:47], v[88:91]
    ds_read_b128 v[36:39], v12 offset:256
    v_mfma_f32_16x16x32_bf16 v[92:95], a[236:239], v[44:47], v[92:95]
    s_waitcnt lgkmcnt(4)
    v_mfma_f32_16x16x32_bf16 v[80:83], a[240:243], v[48:51], v[80:83]
    ds_read_b128 v[40:43], v12 offset:2048
    v_mfma_f32_16x16x32_bf16 v[84:87], a[244:247], v[48:51], v[84:87]
    v_mfma_f32_16x16x32_bf16 v[88:91], a[240:243], v[52:55], v[88:91]
    ds_read_b128 v[44:47], v12 offset:2304
    s_add_u32 m0, s34, 77824
    s_add_u32 s32, s35, 12288
    v_mfma_f32_16x16x32_bf16 v[92:95], a[244:247], v[52:55], v[92:95]
    buffer_load_dwordx4 v8, s[12:15], s32 offen sc1 lds
    s_waitcnt lgkmcnt(4)
    v_mfma_f32_16x16x32_bf16 v[80:83], a[248:251], v[56:59], v[80:83]
    ds_read_b128 v[48:51], v12 offset:4096
    v_mfma_f32_16x16x32_bf16 v[84:87], a[252:255], v[56:59], v[84:87]
    v_mfma_f32_16x16x32_bf16 v[88:91], a[248:251], v[60:63], v[88:91]
    ds_read_b128 v[52:55], v12 offset:4352
    v_mfma_f32_16x16x32_bf16 v[92:95], a[252:255], v[60:63], v[92:95]
    s_add_u32 s30, s30, 2
    s_cmp_lt_u32 s30, s51
    s_cbranch_scc1 sl_loop_87
    v_cvt_pk_bf16_f32 v96, v80, v81
    v_cvt_pk_bf16_f32 v97, v82, v83
    v_cvt_pk_bf16_f32 v98, v84, v85
    v_cvt_pk_bf16_f32 v99, v86, v87
    v_cvt_pk_bf16_f32 v100, v88, v89
    v_cvt_pk_bf16_f32 v101, v90, v91
    v_cvt_pk_bf16_f32 v102, v92, v93
    v_cvt_pk_bf16_f32 v103, v94, v95
    s_branch sl_e_86
sl_e_86:
    buffer_store_dwordx4 v[96:99], v9, s[20:23], s36 offen
    s_add_u32 s31, s36, 65536
    buffer_store_dwordx4 v[100:103], v9, s[20:23], s31 offen
    s_add_u32 s36, s36, s37
    s_waitcnt vmcnt(0) lgkmcnt(0)
    s_barrier
    s_branch L_dump
L_att:
    s_mov_b32 s42, 0x3e0293ee
    s_mov_b32 s58, 0x3e8293ee
    s_and_b32 s44, s28, 7
    s_lshl_b32 s44, s44, 2
    s_add_u32 s44, s44, s29
    s_lshl_b32 s31, s44, 11
    v_add_u32 v6, s31, v5
    v_lshrrev_b32 v9, 5, v1
    v_lshlrev_b32 v9, 7, v9
    v_and_b32 v4, 7, v1
    v_lshl_add_u32 v9, v4, 4, v9
    v_add_u32 v9, s31, v9
    s_add_u32 s31, s31, 4194304
    v_and_b32 v10, 31, v1
    v_lshlrev_b32 v10, 4, v10
    v_lshrrev_b32 v4, 5, v1
    v_lshl_add_u32 v10, v4, 3, v10
    v_add_u32 v10, s31, v10
    s_lshl_b32 s31, s44, 13
    v_add_u32 v8, s31, v5
    s_lshl_b32 s55, s44, 7
    s_add_u32 s55, s55, 115343360
    s_lshr_b32 s56, s44, 2
    s_lshl_b32 s56, s56, 7
    s_add_u32 s56, s56, 115347456
    s_lshl_b32 s57, s44, 7
    s_add_u32 s57, s57, 115351552
    s_lshl_b32 s31, s44, 7
    s_add_u32 s31, s31, 115355648
    v_mov_b32 v12, s31
    s_mov_b64 vcc, 1
    v_mov_b32 v4, 2130706432
    v_cndmask_b32 v12, v4, v12, vcc
    s_cmp_lt_u32 s28, 120
    s_cbranch_scc1 at_help_88
    s_mov_b32 s53, 0
    s_mov_b32 s54, 0
    s_mov_b32 s37, 1
    s_mov_b32 s38, 6
    s_mov_b32 s39, 0
    v_mov_b32 v2, 0
    s_mov_b32 s31, 0
    buffer_store_dword v2, v12, s[4:7], s31 offen sc1
    s_mov_b32 s31, 4096
    buffer_store_dword v2, v12, s[4:7], s31 offen sc1
    s_mov_b32 s31, 12288
    buffer_store_dword v2, v12, s[4:7], s31 offen sc1
    s_mov_b32 s31, 16384
    buffer_store_dword v2, v12, s[4:7], s31 offen sc1
    s_waitcnt vmcnt(0)
    s_barrier
    s_cmp_lg_u32 s29, 0
    s_cbranch_scc1 at_i_90
    s_mov_b64 exec, 1
    v_mov_b32 v2, 0
    v_mov_b32 v3, 1
    s_waitcnt vmcnt(0)
    global_atomic_add v2, v3, s[92:93] offset:0 sc1
    s_mov_b64 exec, -1
at_i_90:
    s_cmp_lt_u32 s28, 96
    s_cbranch_scc1 tw_skip_91
    s_load_dwordx2 s[72:73], s[0:1], 40
    s_and_b32 s31, s28, 31
    s_lshl_b32 s31, s31, 13
    s_lshl_b32 s33, s29, 21
    s_add_u32 s31, s31, s33
    v_lshl_add_u32 v2, v1, 7, s31
    s_waitcnt lgkmcnt(0)
    s_mov_b32 s8, s72
    s_and_b32 s9, s73, 0xffff
    s_mov_b32 s10, 8388608
    s_mov_b32 s11, 0x00020000
    s_mov_b32 s31, 0
    buffer_load_dword v128, v2, s[8:11], s31 offen
    s_mov_b32 s31, 262144
    buffer_load_dword v129, v2, s[8:11], s31 offen
    s_mov_b32 s31, 524288
    buffer_load_dword v130, v2, s[8:11], s31 offen
    s_mov_b32 s31, 786432
    buffer_load_dword v131, v2, s[8:11], s31 offen
    s_mov_b32 s31, 1048576
    buffer_load_dword v132, v2, s[8:11], s31 offen
    s_mov_b32 s31, 1310720
    buffer_load_dword v133, v2, s[8:11], s31 offen
    s_mov_b32 s31, 1572864
    buffer_load_dword v134, v2, s[8:11], s31 offen
    s_mov_b32 s31, 1835008
    buffer_load_dword v135, v2, s[8:11], s31 offen
tw_skip_91:
    s_load_dwordx2 s[72:73], s[0:1], 0
    s_load_dwordx2 s[74:75], s[0:1], 56
    s_load_dwordx2 s[76:77], s[0:1], 72
    s_waitcnt lgkmcnt(0)
    s_mov_b32 s8, s72
    s_and_b32 s9, s73, 0xffff
    s_mov_b32 s10, 4194304
    s_mov_b32 s11, 0x00020000
    s_mov_b32 s12, s74
    s_and_b32 s13, s75, 0xffff
    s_mov_b32 s14, 4194304
    s_mov_b32 s15, 0x00020000
    s_mov_b32 s16, s76
    s_and_b32 s17, s77, 0xffff
    s_mov_b32 s18, 2097152
    s_mov_b32 s19, 0x00020000
    s_lshl_b32 s31, s44, 13
    v_lshl_add_u32 v11, v1, 7, s31
    buffer_load_dword v144, v11, s[8:11], 0 offen
    s_cmp_lg_u32 s29, 0
    s_cbranch_scc1 g_wdd_93
g_wd_92:
    s_load_dword s84, s[92:93], 128 glc
    s_add_u32 s41, s41, 1
    s_cmp_ge_u32 s41, 0x200000
    s_cbranch_scc1 g_wdd_93
    s_waitcnt lgkmcnt(0)
    s_and_b32 s84, s84, 0xffff
    s_cmp_ge_u32 s84, 96
    s_cbranch_scc1 g_wdd_93
    s_sleep 32
    s_branch g_wd_92
g_wdd_93:
    s_waitcnt lgkmcnt(0)
    s_barrier
    s_mov_b32 s31, 0
    buffer_load_dword v144, v11, s[8:11], s31 offen
    buffer_load_dword v145, v11, s[12:15], s31 offen
    s_mov_b32 s31, 262144
    buffer_load_dword v146, v11, s[8:11], s31 offen
    buffer_load_dword v147, v11, s[12:15], s31 offen
    s_mov_b32 s31, 524288
    buffer_load_dword v148, v11, s[8:11], s31 offen
    buffer_load_dword v149, v11, s[12:15], s31 offen
    s_mov_b32 s31, 786432
    buffer_load_dword v150, v11, s[8:11], s31 offen
    buffer_load_dword v151, v11, s[12:15], s31 offen
    s_mov_b32 s31, 1048576
    buffer_load_dword v152, v11, s[8:11], s31 offen
    buffer_load_dword v153, v11, s[12:15], s31 offen
    s_mov_b32 s31, 1310720
    buffer_load_dword v154, v11, s[8:11], s31 offen
    buffer_load_dword v155, v11, s[12:15], s31 offen
    s_mov_b32 s31, 1572864
    buffer_load_dword v156, v11, s[8:11], s31 offen
    buffer_load_dword v157, v11, s[12:15], s31 offen
    s_mov_b32 s31, 1835008
    buffer_load_dword v158, v11, s[8:11], s31 offen
    buffer_load_dword v159, v11, s[12:15], s31 offen
    s_mov_b32 s31, 2097152
    buffer_load_dword v160, v11, s[8:11], s31 offen
    buffer_load_dword v161, v11, s[12:15], s31 offen
    s_mov_b32 s31, 2359296
    buffer_load_dword v162, v11, s[8:11], s31 offen
    buffer_load_dword v163, v11, s[12:15], s31 offen
    s_mov_b32 s31, 2621440
    buffer_load_dword v164, v11, s[8:11], s31 offen
    buffer_load_dword v165, v11, s[12:15], s31 offen
    s_mov_b32 s31, 2883584
    buffer_load_dword v166, v11, s[8:11], s31 offen
    buffer_load_dword v167, v11, s[12:15], s31 offen
    s_mov_b32 s31, 3145728
    buffer_load_dword v168, v11, s[8:11], s31 offen
    buffer_load_dword v169, v11, s[12:15], s31 offen
    s_mov_b32 s31, 3407872
    buffer_load_dword v170, v11, s[8:11], s31 offen
    buffer_load_dword v171, v11, s[12:15], s31 offen
    s_mov_b32 s31, 3670016
    buffer_load_dword v172, v11, s[8:11], s31 offen
    buffer_load_dword v173, v11, s[12:15], s31 offen
    s_mov_b32 s31, 3932160
    buffer_load_dword v174, v11, s[8:11], s31 offen
    buffer_load_dword v175, v11, s[12:15], s31 offen
    s_mov_b32 s31, 0
    buffer_load_dword v176, v11, s[16:19], s31 offen
    s_mov_b32 s31, 262144
    buffer_load_dword v177, v11, s[16:19], s31 offen
    s_mov_b32 s31, 524288
    buffer_load_dword v178, v11, s[16:19], s31 offen
    s_mov_b32 s31, 786432
    buffer_load_dword v179, v11, s[16:19], s31 offen
    s_mov_b32 s31, 1048576
    buffer_load_dword v180, v11, s[16:19], s31 offen
    s_mov_b32 s31, 1310720
    buffer_load_dword v181, v11, s[16:19], s31 offen
    s_mov_b32 s31, 1572864
    buffer_load_dword v182, v11, s[16:19], s31 offen
    s_mov_b32 s31, 1835008
    buffer_load_dword v183, v11, s[16:19], s31 offen
    s_branch at_com_89
at_help_88:
    s_lshr_b32 s53, s28, 3
    s_and_b32 s53, s53, 1
    s_add_u32 s53, s53, 6
    s_mov_b32 s54, 64
    s_mov_b32 s37, 2
    s_mov_b32 s38, 64
    s_lshr_b32 s39, s28, 3
    s_and_b32 s39, s39, 1
    s_lshl_b32 s39, s39, 12
    s_add_u32 s39, s39, 12288
at_com_89:
    v_and_b32 v11, 31, v1
    v_lshrrev_b32 v3, 5, v1
    v_lshlrev_b32 v3, 2, v3
    v_sub_u32 v11, v11, v3
    v_mov_b32 v14, 0xf149f2ca
    v_add_u32 v3, 0, v11
    v_and_b32 v3, 0xfffffff1, v3
    v_cmp_ne_u32 vcc, 0, v3
    s_nop 1
    v_cndmask_b32 v64, 0, v14, vcc
    v_add_u32 v3, -1, v11
    v_and_b32 v3, 0xfffffff1, v3
    v_cmp_ne_u32 vcc, 0, v3
    s_nop 1
    v_cndmask_b32 v65, 0, v14, vcc
    v_add_u32 v3, -2, v11
    v_and_b32 v3, 0xfffffff1, v3
    v_cmp_ne_u32 vcc, 0, v3
    s_nop 1
    v_cndmask_b32 v66, 0, v14, vcc
    v_add_u32 v3, -3, v11
    v_and_b32 v3, 0xfffffff1, v3
    v_cmp_ne_u32 vcc, 0, v3
    s_nop 1
    v_cndmask_b32 v67, 0, v14, vcc
    v_add_u32 v3, -8, v11
    v_and_b32 v3, 0xfffffff1, v3
    v_cmp_ne_u32 vcc, 0, v3
    s_nop 1
    v_cndmask_b32 v68, 0, v14, vcc
    v_add_u32 v3, -9, v11
    v_and_b32 v3, 0xfffffff1, v3
    v_cmp_ne_u32 vcc, 0, v3
    s_nop 1
    v_cndmask_b32 v69, 0, v14, vcc
    v_add_u32 v3, -10, v11
    v_and_b32 v3, 0xfffffff1, v3
    v_cmp_ne_u32 vcc, 0, v3
    s_nop 1
    v_cndmask_b32 v70, 0, v14, vcc
    v_add_u32 v3, -11, v11
    v_and_b32 v3, 0xfffffff1, v3
    v_cmp_ne_u32 vcc, 0, v3
    s_nop 1
    v_cndmask_b32 v71, 0, v14, vcc
    v_add_u32 v3, -16, v11
    v_and_b32 v3, 0xfffffff1, v3
    v_cmp_ne_u32 vcc, 0, v3
    s_nop 1
    v_cndmask_b32 v72, 0, v14, vcc
    v_add_u32 v3, -17, v11
    v_and_b32 v3, 0xfffffff1, v3
    v_cmp_ne_u32 vcc, 0, v3
    s_nop 1
    v_cndmask_b32 v73, 0, v14, vcc
    v_add_u32 v3, -18, v11
    v_and_b32 v3, 0xfffffff1, v3
    v_cmp_ne_u32 vcc, 0, v3
    s_nop 1
    v_cndmask_b32 v74, 0, v14, vcc
    v_add_u32 v3, -19, v11
    v_and_b32 v3, 0xfffffff1, v3
    v_cmp_ne_u32 vcc, 0, v3
    s_nop 1
    v_cndmask_b32 v75, 0, v14, vcc
    v_add_u32 v3, -24, v11
    v_and_b32 v3, 0xfffffff1, v3
    v_cmp_ne_u32 vcc, 0, v3
    s_nop 1
    v_cndmask_b32 v76, 0, v14, vcc
    v_add_u32 v3, -25, v11
    v_and_b32 v3, 0xfffffff1, v3
    v_cmp_ne_u32 vcc, 0, v3
    s_nop 1
    v_cndmask_b32 v77, 0, v14, vcc
    v_add_u32 v3, -26, v11
    v_and_b32 v3, 0xfffffff1, v3
    v_cmp_ne_u32 vcc, 0, v3
    s_nop 1
    v_cndmask_b32 v78, 0, v14, vcc
    v_add_u32 v3, -27, v11
    v_and_b32 v3, 0xfffffff1, v3
    v_cmp_ne_u32 vcc, 0, v3
    s_nop 1
    v_cndmask_b32 v79, 0, v14, vcc
    v_cmp_gt_i32 vcc, 0, v11
    s_nop 1
    v_cndmask_b32 v96, 0, v14, vcc
    v_cmp_gt_i32 vcc, 1, v11
    s_nop 1
    v_cndmask_b32 v97, 0, v14, vcc
    v_cmp_gt_i32 vcc, 2, v11
    s_nop 1
    v_cndmask_b32 v98, 0, v14, vcc
    v_cmp_gt_i32 vcc, 3, v11
    s_nop 1
    v_cndmask_b32 v99, 0, v14, vcc
    v_cmp_gt_i32 vcc, 8, v11
    s_nop 1
    v_cndmask_b32 v100, 0, v14, vcc
    v_cmp_gt_i32 vcc, 9, v11
    s_nop 1
    v_cndmask_b32 v101, 0, v14, vcc
    v_cmp_gt_i32 vcc, 10, v11
    s_nop 1
    v_cndmask_b32 v102, 0, v14, vcc
    v_cmp_gt_i32 vcc, 11, v11
    s_nop 1
    v_cndmask_b32 v103, 0, v14, vcc
    v_cmp_gt_i32 vcc, 16, v11
    s_nop 1
    v_cndmask_b32 v104, 0, v14, vcc
    v_cmp_gt_i32 vcc, 17, v11
    s_nop 1
    v_cndmask_b32 v105, 0, v14, vcc
    v_cmp_gt_i32 vcc, 18, v11
    s_nop 1
    v_cndmask_b32 v106, 0, v14, vcc
    v_cmp_gt_i32 vcc, 19, v11
    s_nop 1
    v_cndmask_b32 v107, 0, v14, vcc
    v_cmp_gt_i32 vcc, 24, v11
    s_nop 1
    v_cndmask_b32 v108, 0, v14, vcc
    v_cmp_gt_i32 vcc, 25, v11
    s_nop 1
    v_cndmask_b32 v109, 0, v14, vcc
    v_cmp_gt_i32 vcc, 26, v11
    s_nop 1
    v_cndmask_b32 v110, 0, v14, vcc
    v_cmp_gt_i32 vcc, 27, v11
    s_nop 1
    v_cndmask_b32 v111, 0, v14, vcc
    v_mov_b32 v80, 0xf149f2ca
    v_mov_b32 v81, 0xf149f2ca
    v_mov_b32 v82, 0xf149f2ca
    v_mov_b32 v83, 0xf149f2ca
    v_mov_b32 v84, 0xf149f2ca
    v_mov_b32 v85, 0xf149f2ca
    v_mov_b32 v86, 0xf149f2ca
    v_mov_b32 v87, 0xf149f2ca
    v_mov_b32 v88, 0xf149f2ca
    v_mov_b32 v89, 0xf149f2ca
    v_mov_b32 v90, 0xf149f2ca
    v_mov_b32 v91, 0xf149f2ca
    v_mov_b32 v92, 0xf149f2ca
    v_mov_b32 v93, 0xf149f2ca
    v_mov_b32 v94, 0xf149f2ca
    v_mov_b32 v95, 0xf149f2ca
    v_accvgpr_write_b32 a184, 0
    v_accvgpr_write_b32 a185, 0
    v_accvgpr_write_b32 a186, 0
    v_accvgpr_write_b32 a187, 0
    v_accvgpr_write_b32 a188, 0
    v_accvgpr_write_b32 a189, 0
    v_accvgpr_write_b32 a190, 0
    v_accvgpr_write_b32 a191, 0
    v_accvgpr_write_b32 a192, 0
    v_accvgpr_write_b32 a193, 0
    v_accvgpr_write_b32 a194, 0
    v_accvgpr_write_b32 a195, 0
    v_accvgpr_write_b32 a128, 0
    v_accvgpr_write_b32 a129, 0
    v_accvgpr_write_b32 a130, 0
    v_accvgpr_write_b32 a131, 0
    v_accvgpr_write_b32 a132, 0
    v_accvgpr_write_b32 a133, 0
    v_accvgpr_write_b32 a134, 0
    v_accvgpr_write_b32 a135, 0
    v_accvgpr_write_b32 a136, 0
    v_accvgpr_write_b32 a137, 0
    v_accvgpr_write_b32 a138, 0
    v_accvgpr_write_b32 a139, 0
    v_accvgpr_write_b32 a140, 0
    v_accvgpr_write_b32 a141, 0
    v_accvgpr_write_b32 a142, 0
    v_accvgpr_write_b32 a143, 0
    v_mov_b32 v40, 0
    v_mov_b32 v41, 0
    v_mov_b32 v42, 0
    v_mov_b32 v43, 0
    s_cmp_lg_u32 s29, 0
    s_cbranch_scc1 g_wdd_95
g_wd_94:
    s_load_dword s72, s[92:93], 0 glc
    s_add_u32 s41, s41, 1
    s_cmp_ge_u32 s41, 0x200000
    s_cbranch_scc1 g_wdd_95
    s_waitcnt lgkmcnt(0)
    s_and_b32 s72, s72, 0xffff
    s_cmp_ge_u32 s72, 256
    s_cbranch_scc1 g_wdd_95
    s_sleep 32
    s_branch g_wd_94
g_wdd_95:
    s_waitcnt lgkmcnt(0)
    s_barrier
g_wf_103:
    s_load_dwordx4 s[72:75], s[90:91], s56 glc
    s_add_u32 s41, s41, 1
    s_cmp_ge_u32 s41, 0x200000
    s_cbranch_scc1 g_wfd_104
    s_waitcnt lgkmcnt(0)
    s_min_u32 s76, s72, s73
    s_min_u32 s76, s76, s74
    s_cmp_ge_u32 s76, 1
    s_cbranch_scc1 g_wfd_104
    s_sleep 4
    s_branch g_wf_103
g_wfd_104:
    s_waitcnt lgkmcnt(0)
    s_mov_b32 s35, 0
    s_add_u32 s31, s35, 50331648
    buffer_load_dwordx4 a[160:163], v6, s[4:7], s31 offen offset:0 sc1
    buffer_load_dwordx4 a[164:167], v6, s[4:7], s31 offen offset:1024 sc1
    s_add_u32 s31, s35, 54525952
    buffer_load_dwordx4 a[168:171], v6, s[4:7], s31 offen offset:0 sc1
    buffer_load_dwordx4 a[172:175], v6, s[4:7], s31 offen offset:1024 sc1
    s_add_u32 s31, s35, 58720256
    buffer_load_dwordx4 a[176:179], v6, s[4:7], s31 offen offset:0 sc1
    buffer_load_dwordx4 a[180:183], v6, s[4:7], s31 offen offset:1024 sc1
    s_max_u32 s32, s54, 1
g_wf_105:
    s_load_dwordx4 s[72:75], s[90:91], s55 glc
    s_add_u32 s41, s41, 1
    s_cmp_ge_u32 s41, 0x200000
    s_cbranch_scc1 g_wfd_106
    s_waitcnt lgkmcnt(0)
    s_min_u32 s76, s72, s73
    s_min_u32 s76, s76, s74
    s_cmp_ge_u32 s76, s32
    s_cbranch_scc1 g_wfd_106
    s_sleep 4
    s_branch g_wf_105
g_wfd_106:
    s_waitcnt lgkmcnt(0)
    s_lshl_b32 s36, s53, 18
    s_add_u32 s31, s36, 0
    buffer_load_dwordx4 a[0:3], v8, s[4:7], s31 offen offset:0 sc1
    buffer_load_dwordx4 a[4:7], v8, s[4:7], s31 offen offset:1024 sc1
    buffer_load_dwordx4 a[8:11], v8, s[4:7], s31 offen offset:2048 sc1
    buffer_load_dwordx4 a[12:15], v8, s[4:7], s31 offen offset:3072 sc1
    s_add_u32 s31, s36, 4096
    buffer_load_dwordx4 a[16:19], v8, s[4:7], s31 offen offset:0 sc1
    buffer_load_dwordx4 a[20:23], v8, s[4:7], s31 offen offset:1024 sc1
    buffer_load_dwordx4 a[24:27], v8, s[4:7], s31 offen offset:2048 sc1
    buffer_load_dwordx4 a[28:31], v8, s[4:7], s31 offen offset:3072 sc1
    s_add_u32 s31, s36, 16777216
    buffer_load_dwordx4 a[32:35], v8, s[4:7], s31 offen offset:0 sc1
    buffer_load_dwordx4 a[36:39], v8, s[4:7], s31 offen offset:1024 sc1
    buffer_load_dwordx4 a[40:43], v8, s[4:7], s31 offen offset:2048 sc1
    buffer_load_dwordx4 a[44:47], v8, s[4:7], s31 offen offset:3072 sc1
    s_add_u32 s31, s36, 16781312
    buffer_load_dwordx4 a[48:51], v8, s[4:7], s31 offen offset:0 sc1
    buffer_load_dwordx4 a[52:55], v8, s[4:7], s31 offen offset:1024 sc1
    buffer_load_dwordx4 a[56:59], v8, s[4:7], s31 offen offset:2048 sc1
    buffer_load_dwordx4 a[60:63], v8, s[4:7], s31 offen offset:3072 sc1
    s_add_u32 s31, s36, 33554432
    buffer_load_dwordx4 a[96:99], v8, s[4:7], s31 offen offset:0 sc1
    buffer_load_dwordx4 a[100:103], v8, s[4:7], s31 offen offset:1024 sc1
    buffer_load_dwordx4 a[104:107], v8, s[4:7], s31 offen offset:2048 sc1
    buffer_load_dwordx4 a[108:111], v8, s[4:7], s31 offen offset:3072 sc1
    s_add_u32 s31, s36, 33558528
    buffer_load_dwordx4 a[112:115], v8, s[4:7], s31 offen offset:0 sc1
    buffer_load_dwordx4 a[116:119], v8, s[4:7], s31 offen offset:1024 sc1
    buffer_load_dwordx4 a[120:123], v8, s[4:7], s31 offen offset:2048 sc1
    buffer_load_dwordx4 a[124:127], v8, s[4:7], s31 offen offset:3072 sc1
    s_mov_b32 s43, 8192
    s_mov_b32 s45, 0
    s_mov_b32 s51, 0
    s_waitcnt vmcnt(0)
at_poll_101:
    s_load_dwordx4 s[72:75], s[90:91], s57 glc
    s_load_dwordx4 s[76:79], s[90:91], s55 glc
    s_load_dwordx4 s[80:83], s[90:91], s56 glc
at_top_96:
    s_waitcnt lgkmcnt(0)
    s_min_u32 s72, s72, s73
    s_min_u32 s72, s72, s74
    s_min_u32 s72, s72, s75
    s_min_u32 s76, s76, s77
    s_min_u32 s76, s76, s78
    s_sub_u32 s77, s76, 1
    s_cmp_ge_u32 s76, 64
    s_cselect_b32 s76, 64, s77
    s_min_u32 s80, s80, s81
    s_min_u32 s80, s80, s82
    s_sub_u32 s81, s80, 1
    s_cmp_ge_u32 s80, 64
    s_cselect_b32 s80, 64, s81
    s_min_u32 s72, s72, s76
    s_min_u32 s72, s72, s38
    s_cmp_lt_u32 s54, s80
    s_cbranch_scc1 at_b_98
    s_cmp_lt_u32 s53, s72
    s_cbranch_scc1 at_a_97
    s_cmp_eq_u32 s43, 8192
    s_cbranch_scc1 at_nf_102
    s_waitcnt vmcnt(0)
    v_mov_b32 v2, s45
    buffer_store_dword v2, v12, s[4:7], s43 offen sc1
    s_mov_b32 s43, 8192
at_nf_102:
    s_cmp_ge_u32 s53, s38
    s_cselect_b32 s31, s54, 0
    s_cmp_ge_u32 s31, 64
    s_cbranch_scc1 at_end_99
    s_add_u32 s41, s41, 1
    s_cmp_ge_u32 s41, 0x200000
    s_cbranch_scc1 at_end_99
    s_sleep 1
    s_branch at_poll_101
at_a_97:
    s_lshl_b32 s46, s53, 16
    s_add_u32 s46, s46, 88080384
    s_cmp_lg_u32 s51, 0
    s_cbranch_scc1 at_k1_107
    s_mov_b32 exec_lo, 0xff
    s_mov_b32 exec_hi, 0xff
    buffer_load_dwordx4 a[64:67], v9, s[4:7], s46 offen offset:0 sc1
    buffer_load_dwordx4 a[68:71], v9, s[4:7], s46 offen offset:256 sc1
    buffer_load_dwordx4 a[72:75], v9, s[4:7], s46 offen offset:512 sc1
    buffer_load_dwordx4 a[76:79], v9, s[4:7], s46 offen offset:768 sc1
    buffer_load_dwordx4 a[80:83], v9, s[4:7], s46 offen offset:1024 sc1
    buffer_load_dwordx4 a[84:87], v9, s[4:7], s46 offen offset:1280 sc1
    buffer_load_dwordx4 a[88:91], v9, s[4:7], s46 offen offset:1536 sc1
    buffer_load_dwordx4 a[92:95], v9, s[4:7], s46 offen offset:1792 sc1
    s_mov_b64 exec, -1
    buffer_load_dwordx2 a[128:129], v10, s[4:7], s46 offen offset:0 sc1
    buffer_load_dwordx2 a[132:133], v10, s[4:7], s46 offen offset:512 sc1
    buffer_load_dwordx2 a[136:137], v10, s[4:7], s46 offen offset:1024 sc1
    buffer_load_dwordx2 a[140:141], v10, s[4:7], s46 offen offset:1536 sc1
at_k1_107:
    s_lshl_b32 s47, s53, 18
    s_add_u32 s47, s47, 67108864
    s_add_u32 s32, s53, s37
    s_cmp_lt_u32 s32, s72
    s_cselect_b32 s52, 1, 0
    s_min_u32 s32, s32, 63
    s_lshl_b32 s36, s32, 18
    s_lshl_b32 s46, s32, 16
    s_add_u32 s46, s46, 88080384
    s_load_dwordx4 s[72:75], s[90:91], s57 glc
    s_load_dwordx4 s[76:79], s[90:91], s55 glc
    s_load_dwordx4 s[80:83], s[90:91], s56 glc
    v_mfma_f32_32x32x16_bf16 v[112:127], a[32:35], a[0:3], v[96:111]
    v_mfma_f32_32x32x16_bf16 v[112:127], a[36:39], a[4:7], v[112:127]
    v_mfma_f32_32x32x16_bf16 v[112:127], a[40:43], a[8:11], v[112:127]
    v_mfma_f32_32x32x16_bf16 v[112:127], a[44:47], a[12:15], v[112:127]
    v_mfma_f32_32x32x16_bf16 v[112:127], a[48:51], a[16:19], v[112:127]
    v_mfma_f32_32x32x16_bf16 v[112:127], a[52:55], a[20:23], v[112:127]
    v_mfma_f32_32x32x16_bf16 v[112:127], a[56:59], a[24:27], v[112:127]
    v_mfma_f32_32x32x16_bf16 v[112:127], a[60:63], a[28:31], v[112:127]
    s_cmp_lg_u32 s51, 0
    s_cbranch_scc1 at_k2_108
    s_waitcnt vmcnt(4)
at_k2_108:
    s_add_u32 s31, s36, 16777216
    buffer_load_dwordx4 a[32:35], v8, s[4:7], s31 offen offset:0 sc1
    buffer_load_dwordx4 a[36:39], v8, s[4:7], s31 offen offset:1024 sc1
    buffer_load_dwordx4 a[40:43], v8, s[4:7], s31 offen offset:2048 sc1
    buffer_load_dwordx4 a[44:47], v8, s[4:7], s31 offen offset:3072 sc1
    s_add_u32 s31, s36, 16781312
    buffer_load_dwordx4 a[48:51], v8, s[4:7], s31 offen offset:0 sc1
    buffer_load_dwordx4 a[52:55], v8, s[4:7], s31 offen offset:1024 sc1
    buffer_load_dwordx4 a[56:59], v8, s[4:7], s31 offen offset:2048 sc1
    buffer_load_dwordx4 a[60:63], v8, s[4:7], s31 offen offset:3072 sc1
    v_mfma_f32_32x32x16_bf16 v[128:143], a[64:67], a[0:3], 0
    v_mfma_f32_32x32x16_bf16 v[128:143], a[68:71], a[4:7], v[128:143]
    v_mfma_f32_32x32x16_bf16 v[128:143], a[72:75], a[8:11], v[128:143]
    v_mfma_f32_32x32x16_bf16 v[128:143], a[76:79], a[12:15], v[128:143]
    v_mfma_f32_32x32x16_bf16 v[128:143], a[80:83], a[16:19], v[128:143]
    v_mfma_f32_32x32x16_bf16 v[128:143], a[84:87], a[20:23], v[128:143]
    v_mfma_f32_32x32x16_bf16 v[128:143], a[88:91], a[24:27], v[128:143]
    v_mfma_f32_32x32x16_bf16 v[128:143], a[92:95], a[28:31], v[128:143]
    s_mov_b32 s51, s52
    s_add_u32 s31, s36, 0
    buffer_load_dwordx4 a[0:3], v8, s[4:7], s31 offen offset:0 sc1
    buffer_load_dwordx4 a[4:7], v8, s[4:7], s31 offen offset:1024 sc1
    buffer_load_dwordx4 a[8:11], v8, s[4:7], s31 offen offset:2048 sc1
    buffer_load_dwordx4 a[12:15], v8, s[4:7], s31 offen offset:3072 sc1
    s_add_u32 s31, s36, 4096
    buffer_load_dwordx4 a[16:19], v8, s[4:7], s31 offen offset:0 sc1
    buffer_load_dwordx4 a[20:23], v8, s[4:7], s31 offen offset:1024 sc1
    buffer_load_dwordx4 a[24:27], v8, s[4:7], s31 offen offset:2048 sc1
    buffer_load_dwordx4 a[28:31], v8, s[4:7], s31 offen offset:3072 sc1
    s_cmp_eq_u32 s51, 0
    s_cbranch_scc1 at_k3_109
    s_mov_b32 exec_lo, 0xff
    s_mov_b32 exec_hi, 0xff
    buffer_load_dwordx4 a[64:67], v9, s[4:7], s46 offen offset:0 sc1
    buffer_load_dwordx4 a[68:71], v9, s[4:7], s46 offen offset:256 sc1
    buffer_load_dwordx4 a[72:75], v9, s[4:7], s46 offen offset:512 sc1
    buffer_load_dwordx4 a[76:79], v9, s[4:7], s46 offen offset:768 sc1
    buffer_load_dwordx4 a[80:83], v9, s[4:7], s46 offen offset:1024 sc1
    buffer_load_dwordx4 a[84:87], v9, s[4:7], s46 offen offset:1280 sc1
    buffer_load_dwordx4 a[88:91], v9, s[4:7], s46 offen offset:1536 sc1
    buffer_load_dwordx4 a[92:95], v9, s[4:7], s46 offen offset:1792 sc1
    s_mov_b64 exec, -1
at_k3_109:
    v_max3_f32 v14, v112, v113, v114
    v_max3_f32 v14, v14, v115, v116
    v_max3_f32 v14, v14, v117, v118
    v_max3_f32 v14, v14, v119, v120
    v_max3_f32 v14, v14, v121, v122
    v_max3_f32 v14, v14, v123, v124
    v_max3_f32 v14, v14, v125, v126
    v_max3_f32 v14, v14, v127, v128
    v_max3_f32 v14, v14, v129, v130
    v_max_f32 v14, v14, v131
    v_mov_b32 v15, v14
    s_nop 1
    v_permlane32_swap_b32 v14, v15
    v_max_f32 v14, v14, v15
    v_mul_f32 v14, s42, v14
    v_fma_f32 v112, v112, s42, -v14
    v_fma_f32 v113, v113, s42, -v14
    v_fma_f32 v114, v114, s42, -v14
    v_fma_f32 v115, v115, s42, -v14
    v_fma_f32 v116, v116, s42, -v14
    v_fma_f32 v117, v117, s42, -v14
    v_fma_f32 v118, v118, s42, -v14
    v_fma_f32 v119, v119, s42, -v14
    v_fma_f32 v120, v120, s42, -v14
    v_fma_f32 v121, v121, s42, -v14
    v_fma_f32 v122, v122, s42, -v14
    v_fma_f32 v123, v123, s42, -v14
    v_fma_f32 v124, v124, s42, -v14
    v_fma_f32 v125, v125, s42, -v14
    v_fma_f32 v126, v126, s42, -v14
    v_fma_f32 v127, v127, s42, -v14
    v_fma_f32 v128, v128, s42, -v14
    v_fma_f32 v129, v129, s42, -v14
    v_fma_f32 v130, v130, s42, -v14
    v_fma_f32 v131, v131, s42, -v14
    v_exp_f32 v112, v112
    v_exp_f32 v113, v113
    v_exp_f32 v114, v114
    v_exp_f32 v115, v115
    v_exp_f32 v116, v116
    v_exp_f32 v117, v117
    v_exp_f32 v118, v118
    v_exp_f32 v119, v119
    v_exp_f32 v120, v120
    v_exp_f32 v121, v121
    v_exp_f32 v122, v122
    v_exp_f32 v123, v123
    v_exp_f32 v124, v124
    v_exp_f32 v125, v125
    v_exp_f32 v126, v126
    v_exp_f32 v127, v127
    v_exp_f32 v128, v128
    v_exp_f32 v129, v129
    v_exp_f32 v130, v130
    v_exp_f32 v131, v131
    v_add_f32 v26, v112, v113
    v_add_f32 v15, v114, v115
    v_add_f32 v26, v26, v116
    v_add_f32 v15, v15, v117
    v_add_f32 v26, v26, v118
    v_add_f32 v15, v15, v119
    v_add_f32 v26, v26, v120
    v_add_f32 v15, v15, v121
    v_add_f32 v26, v26, v122
    v_add_f32 v15, v15, v123
    v_add_f32 v26, v26, v124
    v_add_f32 v15, v15, v125
    v_add_f32 v26, v26, v126
    v_add_f32 v15, v15, v127
    v_add_f32 v26, v26, v128
    v_add_f32 v15, v15, v129
    v_add_f32 v26, v26, v130
    v_add_f32 v15, v15, v131
    v_add_f32 v26, v26, v15
    v_mov_b32 v15, v26
    s_nop 1
    v_permlane32_swap_b32 v26, v15
    v_add_f32 v26, v26, v15
    v_rcp_f32 v26, v26
    v_cvt_pk_bf16_f32 v28, v112, v113
    v_cvt_pk_bf16_f32 v29, v114, v115
    v_cvt_pk_bf16_f32 v30, v116, v117
    v_cvt_pk_bf16_f32 v31, v118, v119
    v_cvt_pk_bf16_f32 v32, v120, v121
    v_cvt_pk_bf16_f32 v33, v122, v123
    v_cvt_pk_bf16_f32 v34, v124, v125
    v_cvt_pk_bf16_f32 v35, v126, v127
    v_cvt_pk_bf16_f32 v40, v128, v129
    v_cvt_pk_bf16_f32 v41, v130, v131
    s_waitcnt vmcnt(16)
    v_mov_b32 v2, s45
    buffer_store_dword v2, v12, s[4:7], s43 offen sc1
    v_mfma_f32_32x32x16_bf16 v[144:159], a[96:99], v[28:31], 0
    v_mfma_f32_32x32x16_bf16 v[144:159], a[100:103], v[32:35], v[144:159]
    v_mfma_f32_32x32x16_bf16 v[144:159], a[128:131], v[40:43], v[144:159]
    v_mfma_f32_32x32x16_bf16 v[160:175], a[104:107], v[28:31], 0
    v_mfma_f32_32x32x16_bf16 v[160:175], a[108:111], v[32:35], v[160:175]
    v_mfma_f32_32x32x16_bf16 v[160:175], a[132:135], v[40:43], v[160:175]
    v_mfma_f32_32x32x16_bf16 v[176:191], a[112:115], v[28:31], 0
    s_nop 7
    v_mul_f32 v144, v144, v26
    v_mul_f32 v145, v145, v26
    v_mul_f32 v146, v146, v26
    v_mul_f32 v147, v147, v26
    v_mul_f32 v148, v148, v26
    v_mul_f32 v149, v149, v26
    v_mfma_f32_32x32x16_bf16 v[176:191], a[116:119], v[32:35], v[176:191]
    v_mul_f32 v150, v150, v26
    v_mul_f32 v151, v151, v26
    v_mul_f32 v152, v152, v26
    v_mul_f32 v153, v153, v26
    v_mul_f32 v154, v154, v26
    v_mul_f32 v155, v155, v26
    v_mfma_f32_32x32x16_bf16 v[176:191], a[136:139], v[40:43], v[176:191]
    v_mul_f32 v156, v156, v26
    v_mul_f32 v157, v157, v26
    v_mul_f32 v158, v158, v26
    v_mul_f32 v159, v159, v26
    v_cvt_pk_bf16_f32 v208, v144, v145
    v_cvt_pk_bf16_f32 v209, v146, v147
    v_mfma_f32_32x32x16_bf16 v[192:207], a[120:123], v[28:31], 0
    v_cvt_pk_bf16_f32 v210, v148, v149
    v_cvt_pk_bf16_f32 v211, v150, v151
    v_cvt_pk_bf16_f32 v212, v152, v153
    v_cvt_pk_bf16_f32 v213, v154, v155
    v_cvt_pk_bf16_f32 v214, v156, v157
    v_cvt_pk_bf16_f32 v215, v158, v159
    v_mfma_f32_32x32x16_bf16 v[192:207], a[124:127], v[32:35], v[192:207]
    v_mul_f32 v160, v160, v26
    v_mul_f32 v161, v161, v26
    v_mul_f32 v162, v162, v26
    v_mul_f32 v163, v163, v26
    v_mul_f32 v164, v164, v26
    v_mul_f32 v165, v165, v26
    v_mfma_f32_32x32x16_bf16 v[192:207], a[140:143], v[40:43], v[192:207]
    v_mul_f32 v166, v166, v26
    v_mul_f32 v167, v167, v26
    v_mul_f32 v168, v168, v26
    v_mul_f32 v169, v169, v26
    v_mul_f32 v170, v170, v26
    v_mul_f32 v171, v171, v26
    s_add_u32 s31, s36, 33554432
    buffer_load_dwordx4 a[96:99], v8, s[4:7], s31 offen offset:0 sc1
    buffer_load_dwordx4 a[100:103], v8, s[4:7], s31 offen offset:1024 sc1
    buffer_load_dwordx4 a[104:107], v8, s[4:7], s31 offen offset:2048 sc1
    buffer_load_dwordx4 a[108:111], v8, s[4:7], s31 offen offset:3072 sc1
    s_add_u32 s31, s36, 33558528
    buffer_load_dwordx4 a[112:115], v8, s[4:7], s31 offen offset:0 sc1
    buffer_load_dwordx4 a[116:119], v8, s[4:7], s31 offen offset:1024 sc1
    buffer_load_dwordx4 a[120:123], v8, s[4:7], s31 offen offset:2048 sc1
    buffer_load_dwordx4 a[124:127], v8, s[4:7], s31 offen offset:3072 sc1
    s_cmp_eq_u32 s51, 0
    s_cbranch_scc1 at_k4_110
    buffer_load_dwordx2 a[128:129], v10, s[4:7], s46 offen offset:0 sc1
    buffer_load_dwordx2 a[132:133], v10, s[4:7], s46 offen offset:512 sc1
    buffer_load_dwordx2 a[136:137], v10, s[4:7], s46 offen offset:1024 sc1
    buffer_load_dwordx2 a[140:141], v10, s[4:7], s46 offen offset:1536 sc1
at_k4_110:
    v_mul_f32 v172, v172, v26
    v_mul_f32 v173, v173, v26
    v_mul_f32 v174, v174, v26
    v_mul_f32 v175, v175, v26
    v_cvt_pk_bf16_f32 v216, v160, v161
    v_cvt_pk_bf16_f32 v217, v162, v163
    v_cvt_pk_bf16_f32 v218, v164, v165
    v_cvt_pk_bf16_f32 v219, v166, v167
    v_cvt_pk_bf16_f32 v220, v168, v169
    v_cvt_pk_bf16_f32 v221, v170, v171
    v_cvt_pk_bf16_f32 v222, v172, v173
    v_cvt_pk_bf16_f32 v223, v174, v175
    v_mul_f32 v176, v176, v26
    v_mul_f32 v177, v177, v26
    v_mul_f32 v178, v178, v26
    v_mul_f32 v179, v179, v26
    v_mul_f32 v180, v180, v26
    v_mul_f32 v181, v181, v26
    v_mul_f32 v182, v182, v26
    v_mul_f32 v183, v183, v26
    v_mul_f32 v184, v184, v26
    v_mul_f32 v185, v185, v26
    v_mul_f32 v186, v186, v26
    v_mul_f32 v187, v187, v26
    v_mul_f32 v188, v188, v26
    v_mul_f32 v189, v189, v26
    v_mul_f32 v190, v190, v26
    v_mul_f32 v191, v191, v26
    v_cvt_pk_bf16_f32 v224, v176, v177
    v_cvt_pk_bf16_f32 v225, v178, v179
    v_cvt_pk_bf16_f32 v226, v180, v181
    v_cvt_pk_bf16_f32 v227, v182, v183
    v_cvt_pk_bf16_f32 v228, v184, v185
    v_cvt_pk_bf16_f32 v229, v186, v187
    v_cvt_pk_bf16_f32 v230, v188, v189
    v_cvt_pk_bf16_f32 v231, v190, v191
    v_mul_f32 v192, v192, v26
    v_mul_f32 v193, v193, v26
    v_mul_f32 v194, v194, v26
    v_mul_f32 v195, v195, v26
    v_mul_f32 v196, v196, v26
    v_mul_f32 v197, v197, v26
    v_mul_f32 v198, v198, v26
    v_mul_f32 v199, v199, v26
    v_mul_f32 v200, v200, v26
    v_mul_f32 v201, v201, v26
    v_mul_f32 v202, v202, v26
    v_mul_f32 v203, v203, v26
    v_mul_f32 v204, v204, v26
    v_mul_f32 v205, v205, v26
    v_mul_f32 v206, v206, v26
    v_mul_f32 v207, v207, v26
    v_cvt_pk_bf16_f32 v232, v192, v193
    v_cvt_pk_bf16_f32 v233, v194, v195
    v_cvt_pk_bf16_f32 v234, v196, v197
    v_cvt_pk_bf16_f32 v235, v198, v199
    v_cvt_pk_bf16_f32 v236, v200, v201
    v_cvt_pk_bf16_f32 v237, v202, v203
    v_cvt_pk_bf16_f32 v238, v204, v205
    v_cvt_pk_bf16_f32 v239, v206, v207
    s_add_u32 s31, s47, 0
    buffer_store_dwordx4 v[208:211], v8, s[4:7], s31 offen offset:0 sc1
    buffer_store_dwordx4 v[212:215], v8, s[4:7], s31 offen offset:1024 sc1
    buffer_store_dwordx4 v[216:219], v8, s[4:7], s31 offen offset:2048 sc1
    buffer_store_dwordx4 v[220:223], v8, s[4:7], s31 offen offset:3072 sc1
    s_add_u32 s31, s47, 4096
    buffer_store_dwordx4 v[224:227], v8, s[4:7], s31 offen offset:0 sc1
    buffer_store_dwordx4 v[228:231], v8, s[4:7], s31 offen offset:1024 sc1
    buffer_store_dwordx4 v[232:235], v8, s[4:7], s31 offen offset:2048 sc1
    buffer_store_dwordx4 v[236:239], v8, s[4:7], s31 offen offset:3072 sc1
    s_add_u32 s45, s53, 1
    s_add_u32 s53, s53, s37
    s_mov_b32 s43, s39
    s_waitcnt vmcnt(17)
    s_branch at_top_96
at_b_98:
    s_load_dwordx4 s[72:75], s[90:91], s57 glc
    s_load_dwordx4 s[76:79], s[90:91], s55 glc
    s_load_dwordx4 s[80:83], s[90:91], s56 glc
    s_lshl_b32 s48, s54, 16
    s_add_u32 s48, s48, 83886080
    s_add_u32 s32, s54, 1
    s_min_u32 s32, s32, 63
    s_lshl_b32 s35, s32, 16
    v_mfma_f32_32x32x16_bf16 v[128:143], a[184:187], a[160:163], v[80:95]
    v_mfma_f32_32x32x16_bf16 v[128:143], a[188:191], a[164:167], v[128:143]
    v_mfma_f32_32x32x16_bf16 v[112:127], a[168:171], a[160:163], v[64:79]
    v_mfma_f32_32x32x16_bf16 v[112:127], a[172:175], a[164:167], v[112:127]
    v_accvgpr_mov_b32 a184, a168
    v_accvgpr_mov_b32 a185, a169
    v_accvgpr_mov_b32 a186, a170
    v_accvgpr_mov_b32 a187, a171
    v_accvgpr_mov_b32 a188, a172
    v_accvgpr_mov_b32 a189, a173
    v_accvgpr_mov_b32 a190, a174
    v_accvgpr_mov_b32 a191, a175
    v_accvgpr_mov_b32 a196, a176
    v_accvgpr_mov_b32 a197, a177
    v_accvgpr_mov_b32 a198, a178
    v_accvgpr_mov_b32 a199, a179
    v_accvgpr_mov_b32 a200, a180
    v_accvgpr_mov_b32 a201, a181
    v_accvgpr_mov_b32 a202, a182
    v_accvgpr_mov_b32 a203, a183
    s_add_u32 s31, s35, 50331648
    buffer_load_dwordx4 a[160:163], v6, s[4:7], s31 offen offset:0 sc1
    buffer_load_dwordx4 a[164:167], v6, s[4:7], s31 offen offset:1024 sc1
    s_add_u32 s31, s35, 54525952
    buffer_load_dwordx4 a[168:171], v6, s[4:7], s31 offen offset:0 sc1
    buffer_load_dwordx4 a[172:175], v6, s[4:7], s31 offen offset:1024 sc1
    s_add_u32 s31, s35, 58720256
    buffer_load_dwordx4 a[176:179], v6, s[4:7], s31 offen offset:0 sc1
    buffer_load_dwordx4 a[180:183], v6, s[4:7], s31 offen offset:1024 sc1
    v_max3_f32 v14, v136, v137, v138
    v_max3_f32 v14, v14, v139, v140
    v_max3_f32 v14, v14, v141, v142
    v_max3_f32 v14, v14, v143, v112
    v_max3_f32 v14, v14, v113, v114
    v_max3_f32 v14, v14, v115, v116
    v_max3_f32 v14, v14, v117, v118
    v_max3_f32 v14, v14, v119, v120
    v_max3_f32 v14, v14, v121, v122
    v_max3_f32 v14, v14, v123, v124
    v_max3_f32 v14, v14, v125, v126
    v_max_f32 v14, v14, v127
    v_mov_b32 v15, v14
    s_nop 1
    v_permlane32_swap_b32 v14, v15
    v_max_f32 v14, v14, v15
    v_mul_f32 v14, s58, v14
    v_fma_f32 v136, v136, s58, -v14
    v_fma_f32 v137, v137, s58, -v14
    v_fma_f32 v138, v138, s58, -v14
    v_fma_f32 v139, v139, s58, -v14
    v_fma_f32 v140, v140, s58, -v14
    v_fma_f32 v141, v141, s58, -v14
    v_fma_f32 v142, v142, s58, -v14
    v_fma_f32 v143, v143, s58, -v14
    v_fma_f32 v112, v112, s58, -v14
    v_fma_f32 v113, v113, s58, -v14
    v_fma_f32 v114, v114, s58, -v14
    v_fma_f32 v115, v115, s58, -v14
    v_fma_f32 v116, v116, s58, -v14
    v_fma_f32 v117, v117, s58, -v14
    v_fma_f32 v118, v118, s58, -v14
    v_fma_f32 v119, v119, s58, -v14
    v_fma_f32 v120, v120, s58, -v14
    v_fma_f32 v121, v121, s58, -v14
    v_fma_f32 v122, v122, s58, -v14
    v_fma_f32 v123, v123, s58, -v14
    v_fma_f32 v124, v124, s58, -v14
    v_fma_f32 v125, v125, s58, -v14
    v_fma_f32 v126, v126, s58, -v14
    v_fma_f32 v127, v127, s58, -v14
    v_exp_f32 v136, v136
    v_exp_f32 v137, v137
    v_exp_f32 v138, v138
    v_exp_f32 v139, v139
    v_exp_f32 v140, v140
    v_exp_f32 v141, v141
    v_exp_f32 v142, v142
    v_exp_f32 v143, v143
    v_exp_f32 v112, v112
    v_exp_f32 v113, v113
    v_exp_f32 v114, v114
    v_exp_f32 v115, v115
    v_exp_f32 v116, v116
    v_exp_f32 v117, v117
    v_exp_f32 v118, v118
    v_exp_f32 v119, v119
    v_exp_f32 v120, v120
    v_exp_f32 v121, v121
    v_exp_f32 v122, v122
    v_exp_f32 v123, v123
    v_exp_f32 v124, v124
    v_exp_f32 v125, v125
    v_exp_f32 v126, v126
    v_exp_f32 v127, v127
    v_add_f32 v26, v136, v137
    v_add_f32 v15, v138, v139
    v_add_f32 v26, v26, v140
    v_add_f32 v15, v15, v141
    v_add_f32 v26, v26, v142
    v_add_f32 v15, v15, v143
    v_add_f32 v26, v26, v112
    v_add_f32 v15, v15, v113
    v_add_f32 v26, v26, v114
    v_add_f32 v15, v15, v115
    v_add_f32 v26, v26, v116
    v_add_f32 v15, v15, v117
    v_add_f32 v26, v26, v118
    v_add_f32 v15, v15, v119
    v_add_f32 v26, v26, v120
    v_add_f32 v15, v15, v121
    v_add_f32 v26, v26, v122
    v_add_f32 v15, v15, v123
    v_add_f32 v26, v26, v124
    v_add_f32 v15, v15, v125
    v_add_f32 v26, v26, v126
    v_add_f32 v15, v15, v127
    v_add_f32 v26, v26, v15
    v_mov_b32 v15, v26
    s_nop 1
    v_permlane32_swap_b32 v26, v15
    v_add_f32 v26, v26, v15
    v_rcp_f32 v26, v26
    v_cvt_pk_bf16_f32 v28, v112, v113
    v_cvt_pk_bf16_f32 v29, v114, v115
    v_cvt_pk_bf16_f32 v30, v116, v117
    v_cvt_pk_bf16_f32 v31, v118, v119
    v_cvt_pk_bf16_f32 v32, v120, v121
    v_cvt_pk_bf16_f32 v33, v122, v123
    v_cvt_pk_bf16_f32 v34, v124, v125
    v_cvt_pk_bf16_f32 v35, v126, v127
    v_cvt_pk_bf16_f32 v36, v136, v137
    v_cvt_pk_bf16_f32 v37, v138, v139
    v_cvt_pk_bf16_f32 v38, v140, v141
    v_cvt_pk_bf16_f32 v39, v142, v143
    v_mfma_f32_32x32x16_bf16 v[144:159], a[196:199], v[28:31], 0
    v_mfma_f32_32x32x16_bf16 v[144:159], a[200:203], v[32:35], v[144:159]
    v_mfma_f32_32x32x16_bf16 v[144:159], a[192:195], v[36:39], v[144:159]
    v_accvgpr_mov_b32 a192, a200
    v_accvgpr_mov_b32 a193, a201
    v_accvgpr_mov_b32 a194, a202
    v_accvgpr_mov_b32 a195, a203
    s_waitcnt vmcnt(6)
    v_mov_b32 v2, s45
    buffer_store_dword v2, v12, s[4:7], s43 offen sc1
    s_cmp_lg_u32 s54, 0
    s_cbranch_scc1 at_nb_100
    v_mov_b32 v14, 0xf149f2ca
    v_add_u32 v3, 32, v11
    v_and_b32 v3, 0xfffffff1, v3
    v_cmp_ne_u32 vcc, 0, v3
    s_nop 1
    v_cndmask_b32 v80, 0, v14, vcc
    v_add_u32 v3, 31, v11
    v_and_b32 v3, 0xfffffff1, v3
    v_cmp_ne_u32 vcc, 0, v3
    s_nop 1
    v_cndmask_b32 v81, 0, v14, vcc
    v_add_u32 v3, 30, v11
    v_and_b32 v3, 0xfffffff1, v3
    v_cmp_ne_u32 vcc, 0, v3
    s_nop 1
    v_cndmask_b32 v82, 0, v14, vcc
    v_add_u32 v3, 29, v11
    v_and_b32 v3, 0xfffffff1, v3
    v_cmp_ne_u32 vcc, 0, v3
    s_nop 1
    v_cndmask_b32 v83, 0, v14, vcc
    v_add_u32 v3, 24, v11
    v_and_b32 v3, 0xfffffff1, v3
    v_cmp_ne_u32 vcc, 0, v3
    s_nop 1
    v_cndmask_b32 v84, 0, v14, vcc
    v_add_u32 v3, 23, v11
    v_and_b32 v3, 0xfffffff1, v3
    v_cmp_ne_u32 vcc, 0, v3
    s_nop 1
    v_cndmask_b32 v85, 0, v14, vcc
    v_add_u32 v3, 22, v11
    v_and_b32 v3, 0xfffffff1, v3
    v_cmp_ne_u32 vcc, 0, v3
    s_nop 1
    v_cndmask_b32 v86, 0, v14, vcc
    v_add_u32 v3, 21, v11
    v_and_b32 v3, 0xfffffff1, v3
    v_cmp_ne_u32 vcc, 0, v3
    s_nop 1
    v_cndmask_b32 v87, 0, v14, vcc
    v_add_u32 v3, 16, v11
    v_and_b32 v3, 0xfffffff1, v3
    v_cmp_ne_u32 vcc, 0, v3
    s_nop 1
    v_cndmask_b32 v88, 0, v14, vcc
    v_add_u32 v3, 15, v11
    v_and_b32 v3, 0xfffffff1, v3
    v_cmp_ne_u32 vcc, 0, v3
    s_nop 1
    v_cndmask_b32 v89, 0, v14, vcc
    v_add_u32 v3, 14, v11
    v_and_b32 v3, 0xfffffff1, v3
    v_cmp_ne_u32 vcc, 0, v3
    s_nop 1
    v_cndmask_b32 v90, 0, v14, vcc
    v_add_u32 v3, 13, v11
    v_and_b32 v3, 0xfffffff1, v3
    v_cmp_ne_u32 vcc, 0, v3
    s_nop 1
    v_cndmask_b32 v91, 0, v14, vcc
    v_add_u32 v3, 8, v11
    v_and_b32 v3, 0xfffffff1, v3
    v_cmp_ne_u32 vcc, 0, v3
    s_nop 1
    v_cndmask_b32 v92, 0, v14, vcc
    v_add_u32 v3, 7, v11
    v_and_b32 v3, 0xfffffff1, v3
    v_cmp_ne_u32 vcc, 0, v3
    s_nop 1
    v_cndmask_b32 v93, 0, v14, vcc
    v_add_u32 v3, 6, v11
    v_and_b32 v3, 0xfffffff1, v3
    v_cmp_ne_u32 vcc, 0, v3
    s_nop 1
    v_cndmask_b32 v94, 0, v14, vcc
    v_add_u32 v3, 5, v11
    v_and_b32 v3, 0xfffffff1, v3
    v_cmp_ne_u32 vcc, 0, v3
    s_nop 1
    v_cndmask_b32 v95, 0, v14, vcc
at_nb_100:
    s_nop 2
    v_mul_f32 v144, v144, v26
    v_mul_f32 v145, v145, v26
    v_mul_f32 v146, v146, v26
    v_mul_f32 v147, v147, v26
    v_mul_f32 v148, v148, v26
    v_mul_f32 v149, v149, v26
    v_mul_f32 v150, v150, v26
    v_mul_f32 v151, v151, v26
    v_mul_f32 v152, v152, v26
    v_mul_f32 v153, v153, v26
    v_mul_f32 v154, v154, v26
    v_mul_f32 v155, v155, v26
    v_mul_f32 v156, v156, v26
    v_mul_f32 v157, v157, v26
    v_mul_f32 v158, v158, v26
    v_mul_f32 v159, v159, v26
    v_cvt_pk_bf16_f32 v208, v144, v145
    v_cvt_pk_bf16_f32 v209, v146, v147
    v_cvt_pk_bf16_f32 v210, v148, v149
    v_cvt_pk_bf16_f32 v211, v150, v151
    v_cvt_pk_bf16_f32 v212, v152, v153
    v_cvt_pk_bf16_f32 v213, v154, v155
    v_cvt_pk_bf16_f32 v214, v156, v157
    v_cvt_pk_bf16_f32 v215, v158, v159
    v_permlane32_swap_b32 v208, v210
    v_permlane32_swap_b32 v209, v211
    v_permlane32_swap_b32 v212, v214
    v_permlane32_swap_b32 v213, v215
    buffer_store_dwordx4 v[208:211], v6, s[4:7], s48 offen offset:0 sc1
    buffer_store_dwordx4 v[212:215], v6, s[4:7], s48 offen offset:1024 sc1
    s_add_u32 s54, s54, 1
    s_mov_b32 s43, 4096
    s_mov_b32 s45, s54
    s_waitcnt vmcnt(3)
    s_branch at_top_96
at_end_99:
    s_branch L_dump
L_dump:
L_end:
    s_endpgm
.section .rodata,"a"
.p2align 6
.amdhsa_kernel concat_heads__memory_aug_recurrent_mem_tr__sliding_local_dilated__prompt_kernel
  .amdhsa_next_free_vgpr 512
  .amdhsa_next_free_sgpr 102
  .amdhsa_accum_offset 256
  .amdhsa_group_segment_fixed_size 0
  .amdhsa_kernarg_size 104
  .amdhsa_user_sgpr_count 2
  .amdhsa_user_sgpr_kernarg_segment_ptr 1
  .amdhsa_system_sgpr_workgroup_id_x 1
.end_amdhsa_kernel
```

```asm
; @launch grid=(256,1,1) block=(256,1,1) lds=163840
.amdgcn_target "amdgcn-amd-amdhsa--gfx950"
.text
.globl concat_heads__memory_aug_recurrent_mem_tr__sliding_local_dilated__prompt_kernel
.p2align 8
.type concat_heads__memory_aug_recurrent_mem_tr__sliding_local_dilated__prompt_kernel,@function
concat_heads__memory_aug_recurrent_mem_tr__sliding_local_dilated__prompt_kernel:
    s_cmp_ge_u32 s2, 256
    s_cbranch_scc1 L_end
    s_and_b32 s3, s2, 3
    s_lshl_b32 s3, s3, 5
    s_lshr_b32 s28, s2, 3
    s_add_u32 s28, s28, s3
    s_bitcmp1_b32 s2, 2
    s_cbranch_scc1 L_gem
    s_load_dwordx2 s[72:73], s[0:1], 8
    s_load_dwordx4 s[76:79], s[0:1], 16
    s_load_dwordx4 s[80:83], s[0:1], 32
    s_load_dwordx2 s[90:91], s[0:1], 96
    s_load_dwordx2 s[92:93], s[0:1], 88
    v_and_b32 v1, 63, v0
    v_lshrrev_b32 v2, 6, v0
    s_nop 0
    v_readfirstlane_b32 s31, v2
    s_lshr_b32 s29, s28, 2
    s_and_b32 s30, s28, 3
    s_mov_b32 s41, 0
    s_waitcnt lgkmcnt(0)
    s_mov_b32 s24, s72
    s_and_b32 s25, s73, 0xffff
    s_mov_b32 s26, 16384
    s_mov_b32 s27, 0x00020000
    s_mov_b32 s8, s76
    s_and_b32 s9, s77, 0xffff
    s_mov_b32 s10, 8388608
    s_mov_b32 s11, 0x00020000
    s_mov_b32 s12, s78
    s_and_b32 s13, s79, 0xffff
    s_mov_b32 s14, 8388608
    s_mov_b32 s15, 0x00020000
    s_mov_b32 s16, s80
    s_and_b32 s17, s81, 0xffff
    s_mov_b32 s18, 8388608
    s_mov_b32 s19, 0x00020000
    s_mov_b32 s20, s82
    s_and_b32 s21, s83, 0xffff
    s_mov_b32 s22, 8388608
    s_mov_b32 s23, 0x00020000
    s_mov_b32 s4, s90
    s_and_b32 s5, s91, 0xffff
    s_mov_b32 s6, 268435456
    s_mov_b32 s7, 0x00020000
    s_sub_u32 s49, 0, s90
    s_and_b32 s49, s49, 2097151
    s_add_u32 s49, s49, 117440512
    s_mov_b32 s48, 1
    s_cmp_lg_u32 s31, 3
    s_cbranch_scc1 rec_cal_1
    s_and_b32 s38, s28, 7
    s_lshl_b32 s38, s38, 21
    s_lshr_b32 s40, s28, 3
    s_and_b32 s40, s40, 1
    s_lshl_b32 s40, s40, 13
    s_add_u32 s38, s38, s40
    s_lshr_b32 s40, s28, 4
    s_and_b32 s40, s40, 7
    s_lshl_b32 s40, s40, 8
    s_add_u32 s38, s38, s40
    s_add_u32 s38, s38, s49
    s_add_u32 s38, s38, 245760
    s_lshr_b32 s39, s28, 3
    s_and_b32 s39, s39, 1
    s_lshl_b32 s39, s39, 14
    s_sub_u32 s39, s38, s39
    s_add_u32 s39, s39, 8192
    s_load_dword s80, s[90:91], s38 glc
    s_load_dword s81, s[90:91], s39 glc
    s_waitcnt lgkmcnt(0)
    s_memtime s[76:77]
    s_waitcnt lgkmcnt(0)
    s_load_dword s80, s[90:91], s38 glc
    s_waitcnt lgkmcnt(0)
    s_memtime s[78:79]
    s_waitcnt lgkmcnt(0)
    s_sub_u32 s72, s78, s76
    s_waitcnt lgkmcnt(0)
    s_memtime s[76:77]
    s_waitcnt lgkmcnt(0)
    s_load_dword s80, s[90:91], s39 glc
    s_waitcnt lgkmcnt(0)
    s_memtime s[78:79]
    s_waitcnt lgkmcnt(0)
    s_sub_u32 s73, s78, s76
    s_cmp_lt_u32 s73, s72
    s_cselect_b32 s38, 1, 0
    s_lshr_b32 s39, s28, 3
    s_xor_b32 s38, s38, s39
    s_xor_b32 s38, s38, s28
    s_and_b32 s48, s38, 1
    s_lshl_b32 s48, s48, 16
    s_add_u32 s48, s48, 1
rec_cal_1:
    s_lshl_b32 s38, s31, 21
    s_lshl_b32 s40, s28, 6
    s_add_u32 s38, s38, s40
    v_lshrrev_b32 v184, 2, v1
    v_lshlrev_b32 v184, 13, v184
    v_and_b32 v4, 3, v1
    v_lshl_add_u32 v184, v4, 4, v184
    v_add_u32 v184, s38, v184
    s_mov_b32 s98, s28
    s_lshl_b32 s38, s31, 21
    s_lshr_b32 s40, s98, 1
    s_lshl_b32 s40, s40, 5
    s_add_u32 s38, s38, s40
    v_lshrrev_b32 v185, 1, v1
    v_lshlrev_b32 v185, 11, v185
    v_and_b32 v4, 1, v1
    v_lshl_add_u32 v185, v4, 4, v185
    v_add_u32 v185, s38, v185
    s_mov_b32 s34, 0
    s_mov_b32 s35, 0
    s_lshl_b32 s33, s31, 15
    v_lshrrev_b32 v186, 4, v1
    v_lshlrev_b32 v186, 9, v186
    v_bfe_u32 v4, v1, 2, 2
    v_lshl_add_u32 v186, v4, 6, v186
    v_and_b32 v4, 3, v1
    v_lshl_add_u32 v186, v4, 3, v186
    v_add_u32 v186, s33, v186
    v_lshrrev_b32 v187, 4, v1
    v_lshlrev_b32 v187, 8, v187
    v_bfe_u32 v4, v1, 2, 2
    v_lshl_add_u32 v187, v4, 5, v187
    v_and_b32 v4, 3, v1
    v_lshl_add_u32 v187, v4, 3, v187
    v_add_u32 v187, s33, v187
    s_add_u32 m0, s33, 0
    s_xor_b32 s38, s34, 0
    buffer_load_dwordx4 v184, s[8:11], s38 offen lds
    s_add_u32 m0, s33, 1024
    s_xor_b32 s38, s34, 131072
    buffer_load_dwordx4 v184, s[8:11], s38 offen lds
    s_add_u32 m0, s33, 2048
    s_xor_b32 s38, s34, 0
    buffer_load_dwordx4 v184, s[12:15], s38 offen lds
    s_add_u32 m0, s33, 3072
    s_xor_b32 s38, s34, 131072
    buffer_load_dwordx4 v184, s[12:15], s38 offen lds
    s_add_u32 m0, s33, 4096
    s_xor_b32 s38, s34, 0
    buffer_load_dwordx4 v184, s[16:19], s38 offen lds
    s_add_u32 m0, s33, 5120
    s_xor_b32 s38, s34, 131072
    buffer_load_dwordx4 v184, s[16:19], s38 offen lds
    s_add_u32 m0, s33, 6144
    s_xor_b32 s38, s34, 262144
    buffer_load_dwordx4 v184, s[8:11], s38 offen lds
    s_add_u32 m0, s33, 7168
    s_xor_b32 s38, s34, 393216
    buffer_load_dwordx4 v184, s[8:11], s38 offen lds
    s_add_u32 m0, s33, 8192
    s_xor_b32 s38, s34, 262144
    buffer_load_dwordx4 v184, s[12:15], s38 offen lds
    s_add_u32 m0, s33, 9216
    s_xor_b32 s38, s34, 393216
    buffer_load_dwordx4 v184, s[12:15], s38 offen lds
    s_add_u32 m0, s33, 10240
    s_xor_b32 s38, s34, 262144
    buffer_load_dwordx4 v184, s[16:19], s38 offen lds
    s_add_u32 m0, s33, 11264
    s_xor_b32 s38, s34, 393216
    buffer_load_dwordx4 v184, s[16:19], s38 offen lds
    v_bfe_u32 v2, v1, 2, 1
    v_mov_b32 v3, 0xaaaa
    v_mul_u32_u24 v2, v2, v3
    v_add_u32 v5, 0x4444, v2
    v_lshlrev_b32 v16, 4, v1
    s_lshr_b32 s38, s98, 6
    s_lshl_b32 s38, s38, 14
    s_and_b32 s40, s98, 63
    s_lshl_b32 s40, s40, 7
    s_add_u32 s38, s38, s40
    s_add_u32 s38, s38, 131072
    v_lshl_add_u32 v6, v1, 2, s38
    s_lshr_b32 s38, s31, 1
    s_lshl_b32 s38, s38, 14
    s_and_b32 s40, s31, 1
    s_lshl_b32 s40, s40, 12
    s_add_u32 s38, s38, s40
    s_add_u32 s38, s38, 131072
    v_add_u32 v7, s38, v16
    s_lshr_b32 s38, s34, 9
    v_xor_b32 v7, s38, v7
    v_xor_b32 v12, 1024, v7
    v_xor_b32 v142, 2048, v7
    v_xor_b32 v143, 3072, v7
    s_and_b32 s38, s28, 1
    s_lshl_b32 s38, s38, 16
    s_lshl_b32 s40, s31, 14
    s_add_u32 s38, s38, s40
    v_add_u32 v13, s38, v16
    s_lshr_b32 s38, s35, 8
    v_xor_b32 v13, s38, v13
    v_lshrrev_b32 v2, 5, v1
    v_mul_u32_u24 v2, 640, v2
    v_and_b32 v3, 31, v1
    v_lshl_add_u32 v2, v3, 2, v2
    s_mul_i32 s38, s31, 2560
    v_add_u32 v14, s38, v2
    v_add_u32 v15, 1280, v14
    s_lshl_b32 s38, s31, 10
    s_add_u32 s38, s38, 10240
    v_add_u32 v17, s38, v16
    v_lshrrev_b32 v2, 5, v1
    v_lshlrev_b32 v2, 6, v2
    v_bfe_u32 v4, v1, 4, 1
    v_lshl_add_u32 v2, v4, 4, v2
    v_and_b32 v3, 15, v1
    v_mul_u32_u24 v3, 160, v3
    v_add_u32 v18, v2, v3
    s_lshl_b32 s38, s28, 11
    v_add_u32 v19, s38, v16
    v_bfe_u32 v20, v1, 4, 1
    v_lshlrev_b32 v20, 7, v20
    v_and_b32 v4, 7, v1
    v_lshl_add_u32 v20, v4, 4, v20
    v_add_u32 v20, s38, v20
    s_add_u32 s39, s30, 1
    s_and_b32 s38, s39, 3
    s_lshl_b32 s38, s38, 11
    s_lshl_b32 s40, s29, 13
    s_add_u32 s38, s38, s40
    v_add_u32 v22, s38, v16
    s_add_u32 s39, s30, 2
    s_and_b32 s38, s39, 3
    s_lshl_b32 s38, s38, 11
    s_lshl_b32 s40, s29, 13
    s_add_u32 s38, s38, s40
    v_add_u32 v23, s38, v16
    s_add_u32 s39, s30, 3
    s_and_b32 s38, s39, 3
    s_lshl_b32 s38, s38, 11
    s_lshl_b32 s40, s29, 13
    s_add_u32 s38, s38, s40
    v_add_u32 v24, s38, v16
    s_lshl_b32 s38, s29, 13
    v_lshrrev_b32 v21, 4, v1
    v_lshlrev_b32 v21, 11, v21
    v_and_b32 v4, 15, v1
    v_lshl_add_u32 v21, v4, 4, v21
    v_add_u32 v21, s38, v21
    v_bfe_u32 v25, v1, 3, 1
    v_lshlrev_b32 v25, 8, v25
    v_bfe_u32 v4, v1, 1, 1
    v_lshl_add_u32 v25, v4, 6, v25
    v_bfe_u32 v4, v1, 2, 1
    v_lshl_add_u32 v25, v4, 5, v25
    v_and_b32 v4, 1, v1
    v_lshl_add_u32 v25, v4, 4, v25
    v_lshrrev_b32 v4, 4, v1
    v_lshl_add_u32 v25, v4, 2, v25
    v_add_u32 v25, 10240, v25
    v_add_u32 v26, 128, v25
    s_lshl_b32 s38, s28, 11
    s_and_b32 s40, s31, 1
    s_lshl_b32 s40, s40, 7
    s_add_u32 s38, s38, s40
    s_add_u32 s38, s38, 16777216
    v_bfe_u32 v2, v1, 3, 1
    v_lshlrev_b32 v2, 8, v2
    v_and_b32 v4, 7, v1
    v_lshl_add_u32 v2, v4, 4, v2
    v_bfe_u32 v4, v1, 4, 1
    v_lshl_add_u32 v2, v4, 9, v2
    v_lshrrev_b32 v4, 5, v1
    v_lshl_add_u32 v2, v4, 10, v2
    v_add_u32 v2, s38, v2
    s_add_u32 s38, s38, 16777216
    v_bfe_u32 v3, v1, 3, 1
    v_lshlrev_b32 v3, 8, v3
    v_bfe_u32 v4, v1, 1, 1
    v_lshl_add_u32 v3, v4, 6, v3
    v_bfe_u32 v4, v1, 2, 1
    v_lshl_add_u32 v3, v4, 5, v3
    v_and_b32 v4, 1, v1
    v_lshl_add_u32 v3, v4, 4, v3
    v_bfe_u32 v4, v1, 4, 1
    v_lshl_add_u32 v3, v4, 9, v3
    v_lshrrev_b32 v4, 5, v1
    v_lshl_add_u32 v3, v4, 10, v3
    v_add_u32 v3, s38, v3
    s_cmp_lt_u32 s31, 2
    s_cselect_b64 vcc, -1, 0
    v_cndmask_b32 v30, v3, v2, vcc
    s_lshl_b32 s3, s31, 10
    s_lshr_b32 s38, s29, 3
    s_lshl_b32 s38, s38, 14
    s_and_b32 s40, s29, 7
    s_lshl_b32 s40, s40, 10
    s_add_u32 s38, s38, s40
    s_and_b32 s40, s30, 1
    s_lshl_b32 s40, s40, 9
    s_add_u32 s38, s38, s40
    s_lshr_b32 s40, s30, 1
    s_lshl_b32 s40, s40, 7
    s_add_u32 s38, s38, s40
    v_bfe_u32 v27, v1, 2, 1
    v_lshlrev_b32 v27, 16, v27
    v_lshrrev_b32 v4, 5, v1
    v_lshl_add_u32 v27, v4, 8, v27
    v_bfe_u32 v4, v1, 4, 1
    v_lshl_add_u32 v27, v4, 6, v27
    v_and_b32 v4, 3, v1
    v_lshl_add_u32 v27, v4, 4, v27
    v_add_u32 v27, s38, v27
    s_lshr_b32 s39, s31, 1
    s_lshl_b32 s39, s39, 16
    s_and_b32 s40, s31, 1
    s_lshl_b32 s40, s40, 8
    s_add_u32 s39, s39, s40
    s_add_u32 s39, s39, s38
    v_add_u32 v95, s39, v16
    v_cmp_gt_u32 vcc, 8, v1
    v_mov_b32 v4, 2130706432
    s_nop 0
    v_cndmask_b32 v95, v4, v95, vcc
    s_lshl_b32 s38, s31, 8
    s_add_u32 s38, s38, 14336
    v_lshl_add_u32 v28, v1, 2, s38
    v_and_b32 v29, 15, v1
    v_lshlrev_b32 v29, 4, v29
    v_bfe_u32 v4, v1, 4, 1
    v_lshl_add_u32 v29, v4, 3, v29
    v_add_u32 v29, 14336, v29
    s_mul_i32 s39, s31, 320
    s_lshl_b32 s38, s28, 11
    s_add_u32 s38, s38, s39
    v_add_u32 v94, s38, v16
    v_cmp_gt_u32 vcc, 20, v1
    v_mov_b32 v4, 2130706432
    s_nop 0
    v_cndmask_b32 v94, v4, v94, vcc
    s_mul_i32 s38, s31, 3
    v_min_u32 v2, 2, v1
    v_add_u32 v2, s38, v2
    v_min_u32 v2, 9, v2
    s_lshl_b32 s38, s28, 11
    s_add_u32 s38, s38, 262144
    v_lshl_add_u32 v92, v2, 7, s38
    s_lshl_b32 s38, s28, 9
    v_lshrrev_b32 v93, 4, v1
    v_lshlrev_b32 v93, 7, v93
    v_and_b32 v4, 7, v1
    v_lshl_add_u32 v93, v4, 4, v93
    v_add_u32 v93, s38, v93
    s_mov_b32 vcc_lo, 0xff00ff00
    s_mov_b32 vcc_hi, 0xff00ff00
    s_cmp_eq_u32 s31, 1
    s_cbranch_scc1 rec_ns_2
    s_add_u32 s38, s38, 4194304
    v_add_u32 v93, s38, v16
    s_mov_b32 vcc_lo, -1
    s_mov_b32 vcc_hi, 0
    s_cmp_eq_u32 s31, 2
    s_cbranch_scc1 rec_ns_2
    s_lshr_b32 s38, s98, 6
    s_lshl_b32 s38, s38, 14
    s_and_b32 s40, s98, 63
    s_lshl_b32 s40, s40, 7
    s_add_u32 s38, s38, s40
    s_add_u32 s38, s38, 131072
    v_add_u32 v93, s38, v16
    s_cmp_eq_u32 s31, 3
    s_cselect_b32 vcc_lo, 0xff, 0
rec_ns_2:
    s_nop 0
    v_mov_b32 v4, 2130706432
    v_cndmask_b32 v93, v4, v93, vcc
    v_mov_b32 v32, 0x3f803f80
    v_mov_b32 v33, 0x3f803f80
    v_mov_b32 v34, 0x3f803f80
    v_mov_b32 v35, 0x3f803f80
    v_mov_b32 v8, -1
    v_mov_b32 v9, -1
    v_mov_b32 v10, -1
    v_mov_b32 v11, -1
    v_mov_b32 v144, 0
    v_mov_b32 v145, 0
    v_mov_b32 v146, 0
    v_mov_b32 v147, 0
    v_mov_b32 v180, 0
    v_mov_b32 v181, 0
    v_mov_b32 v182, 0
    v_mov_b32 v183, 0
    v_mov_b32 v161, 0
    v_mov_b32 v162, 0
    v_mov_b32 v163, 0
    v_mov_b32 v138, 0
    v_mov_b32 v139, 0
    v_mov_b32 v140, 0
    v_mov_b32 v141, 0
    s_mov_b32 s42, 0x00ff00ff
    s_mov_b32 s43, 0x00ff00ff
    s_mov_b32 s44, 0
    s_mov_b32 s45, -1
    s_mov_b32 s46, 0
    s_mov_b32 s47, 0x00ff00ff
    s_mov_b32 s50, 0x3e0293ee
    s_mov_b32 s36, 96468992
    s_mov_b32 s37, 0
    s_mov_b32 s32, 0
    s_mov_b32 s51, 16384
    s_mov_b32 s54, 1
    s_min_u32 s38, s31, 1
    s_add_u32 s38, s38, 1
    v_mov_b32 v134, s38
    s_lshl_b32 s95, s29, 7
    s_lshr_b32 s40, s31, 1
    s_lshl_b32 s40, s40, 2
    s_add_u32 s95, s95, s40
    s_add_u32 s95, s95, 115343364
    s_lshl_b32 s97, s29, 7
    s_add_u32 s97, s97, 115351552
    s_lshl_b32 s38, s30, 2
    s_add_u32 s38, s38, s97
    v_mov_b32 v188, s38
    s_cmp_eq_u32 s31, 2
    s_cselect_b64 vcc, 1, 0
    v_mov_b32 v4, 2130706432
    v_cndmask_b32 v188, v4, v188, vcc
    v_mov_b32 v189, 0
    s_mov_b32 s94, 0
    s_add_u32 s38, s49, 0
    buffer_store_dwordx4 v[144:147], v95, s[4:7], s38 offen sc1
    s_add_u32 s38, s49, 262144
    buffer_store_dwordx4 v[144:147], v95, s[4:7], s38 offen sc1
    s_add_u32 s38, s49, 8192
    buffer_store_dwordx4 v[144:147], v95, s[4:7], s38 offen sc1
    s_add_u32 s38, s49, 270336
    buffer_store_dwordx4 v[144:147], v95, s[4:7], s38 offen sc1
    buffer_store_dwordx4 v[8:11], v94, s[4:7], s36 offen sc1
    v_add_u32 v94, 262144, v94
    buffer_store_dwordx4 v[8:11], v94, s[4:7], s36 offen sc1
    v_add_u32 v94, 262144, v94
    buffer_store_dwordx4 v[8:11], v94, s[4:7], s36 offen sc1
    buffer_store_dword v189, v188, s[4:7], 0 offen sc1
    s_getreg_b32 s38, hwreg(HW_REG_XCC_ID)
    v_mov_b32 v2, s38
    buffer_store_dword v2, v188, s[4:7], 0 offen offset:16 sc1
    s_cmp_lg_u32 s31, 3
    s_cbranch_scc1 rec_i3_3
    s_add_u32 s38, s49, 262144
    buffer_store_dwordx4 v[144:147], v93, s[4:7], s38 offen sc1
    s_add_u32 s38, s49, 270336
    buffer_store_dwordx4 v[144:147], v93, s[4:7], s38 offen sc1
    s_lshr_b32 s39, s28, 5
    s_lshl_b32 s39, s39, 14
    s_and_b32 s40, s28, 31
    s_lshl_b32 s40, s40, 8
    s_add_u32 s39, s39, s40
    s_add_u32 s39, s39, s49
    s_add_u32 s39, s39, 163840
    s_mov_b64 exec, 0xffff
    s_add_u32 s38, s39, 0
    buffer_store_dwordx4 v[144:147], v16, s[4:7], s38 offen sc1
    s_add_u32 s38, s39, 8192
    buffer_store_dwordx4 v[144:147], v16, s[4:7], s38 offen sc1
    s_mov_b64 exec, -1
rec_i3_3:
    s_lshl_b32 s38, s31, 9
    s_lshr_b32 s40, s34, 12
    s_add_u32 s38, s38, s40
    v_bfe_u32 v2, v1, 3, 1
    v_lshlrev_b32 v2, 13, v2
    v_and_b32 v4, 3, v1
    v_lshl_add_u32 v2, v4, 11, v2
    v_lshrrev_b32 v4, 4, v1
    v_lshl_add_u32 v2, v4, 5, v2
    v_bfe_u32 v4, v1, 2, 1
    v_lshl_add_u32 v2, v4, 2, v2
    v_add_u32 v2, s38, v2
    v_xor_b32 v3, 0, v2
    buffer_load_dword v36, v3, s[24:27], 0 offen offset:0
    buffer_load_dword v37, v3, s[24:27], 0 offen offset:8
    buffer_load_dword v38, v3, s[24:27], 0 offen offset:16
    buffer_load_dword v39, v3, s[24:27], 0 offen offset:24
    v_xor_b32 v3, 128, v2
    buffer_load_dword v40, v3, s[24:27], 0 offen offset:0
    buffer_load_dword v41, v3, s[24:27], 0 offen offset:8
    buffer_load_dword v42, v3, s[24:27], 0 offen offset:16
    buffer_load_dword v43, v3, s[24:27], 0 offen offset:24
    v_xor_b32 v3, 256, v2
    buffer_load_dword v44, v3, s[24:27], 0 offen offset:0
    buffer_load_dword v45, v3, s[24:27], 0 offen offset:8
    buffer_load_dword v46, v3, s[24:27], 0 offen offset:16
    buffer_load_dword v47, v3, s[24:27], 0 offen offset:24
    v_xor_b32 v3, 384, v2
    buffer_load_dword v48, v3, s[24:27], 0 offen offset:0
    buffer_load_dword v49, v3, s[24:27], 0 offen offset:8
    buffer_load_dword v50, v3, s[24:27], 0 offen offset:16
    buffer_load_dword v51, v3, s[24:27], 0 offen offset:24
    s_add_u32 m0, s33, 12288
    s_xor_b32 s38, s34, 524288
    buffer_load_dwordx4 v184, s[8:11], s38 offen lds
    s_add_u32 m0, s33, 13312
    s_xor_b32 s38, s34, 655360
    buffer_load_dwordx4 v184, s[8:11], s38 offen lds
    s_add_u32 m0, s33, 14336
    s_xor_b32 s38, s34, 524288
    buffer_load_dwordx4 v184, s[12:15], s38 offen lds
    s_add_u32 m0, s33, 15360
    s_xor_b32 s38, s34, 655360
    buffer_load_dwordx4 v184, s[12:15], s38 offen lds
    s_add_u32 m0, s33, 16384
    s_xor_b32 s38, s34, 524288
    buffer_load_dwordx4 v184, s[16:19], s38 offen lds
    s_add_u32 m0, s33, 17408
    s_xor_b32 s38, s34, 655360
    buffer_load_dwordx4 v184, s[16:19], s38 offen lds
    s_add_u32 m0, s33, 18432
    s_xor_b32 s38, s34, 786432
    buffer_load_dwordx4 v184, s[8:11], s38 offen lds
    s_add_u32 m0, s33, 19456
    s_xor_b32 s38, s34, 917504
    buffer_load_dwordx4 v184, s[8:11], s38 offen lds
    s_add_u32 m0, s33, 20480
    s_xor_b32 s38, s34, 786432
    buffer_load_dwordx4 v184, s[12:15], s38 offen lds
    s_add_u32 m0, s33, 21504
    s_xor_b32 s38, s34, 917504
    buffer_load_dwordx4 v184, s[12:15], s38 offen lds
    s_add_u32 m0, s33, 22528
    s_xor_b32 s38, s34, 786432
    buffer_load_dwordx4 v184, s[16:19], s38 offen lds
    s_add_u32 m0, s33, 23552
    s_xor_b32 s38, s34, 917504
    buffer_load_dwordx4 v184, s[16:19], s38 offen lds
    s_add_u32 m0, s33, 24576
    s_xor_b32 s38, s34, 1048576
    buffer_load_dwordx4 v184, s[8:11], s38 offen lds
    s_add_u32 m0, s33, 25600
    s_xor_b32 s38, s34, 1179648
    buffer_load_dwordx4 v184, s[8:11], s38 offen lds
    s_add_u32 m0, s33, 26624
    s_xor_b32 s38, s34, 1048576
    buffer_load_dwordx4 v184, s[12:15], s38 offen lds
    s_add_u32 m0, s33, 27648
    s_xor_b32 s38, s34, 1179648
    buffer_load_dwordx4 v184, s[12:15], s38 offen lds
    s_add_u32 m0, s33, 28672
    s_xor_b32 s38, s34, 1048576
    buffer_load_dwordx4 v184, s[16:19], s38 offen lds
    s_add_u32 m0, s33, 29696
    s_xor_b32 s38, s34, 1179648
    buffer_load_dwordx4 v184, s[16:19], s38 offen lds
    s_add_u32 m0, s33, 30720
    s_xor_b32 s38, s34, 1310720
    buffer_load_dwordx4 v184, s[8:11], s38 offen lds
    s_add_u32 m0, s33, 31744
    s_xor_b32 s38, s34, 1441792
    buffer_load_dwordx4 v184, s[8:11], s38 offen lds
    s_waitcnt vmcnt(54)
    ds_read_b64_tr_b16 a[0:1], v186 offset:0
    ds_read_b64_tr_b16 a[2:3], v186 offset:256
    ds_read_b64_tr_b16 a[8:9], v186 offset:32
    ds_read_b64_tr_b16 a[10:11], v186 offset:288
    s_waitcnt vmcnt(52)
    ds_read_b64_tr_b16 a[16:17], v186 offset:2048
    ds_read_b64_tr_b16 a[18:19], v186 offset:2304
    ds_read_b64_tr_b16 a[24:25], v186 offset:2080
    ds_read_b64_tr_b16 a[26:27], v186 offset:2336
    s_waitcnt lgkmcnt(4)
    s_add_u32 m0, s33, 0
    s_xor_b32 s38, s34, 1310720
    buffer_load_dwordx4 v184, s[12:15], s38 offen lds
    s_add_u32 m0, s33, 1024
    s_xor_b32 s38, s34, 1441792
    buffer_load_dwordx4 v184, s[12:15], s38 offen lds
    s_waitcnt vmcnt(52)
    ds_read_b64_tr_b16 a[32:33], v186 offset:4096
    ds_read_b64_tr_b16 a[34:35], v186 offset:4352
    ds_read_b64_tr_b16 a[40:41], v186 offset:4128
    ds_read_b64_tr_b16 a[42:43], v186 offset:4384
    s_waitcnt lgkmcnt(4)
    s_add_u32 m0, s33, 2048
    s_xor_b32 s38, s34, 1310720
    buffer_load_dwordx4 v184, s[16:19], s38 offen lds
    s_add_u32 m0, s33, 3072
    s_xor_b32 s38, s34, 1441792
    buffer_load_dwordx4 v184, s[16:19], s38 offen lds
    s_waitcnt vmcnt(52)
    ds_read_b64_tr_b16 a[4:5], v186 offset:6144
    ds_read_b64_tr_b16 a[6:7], v186 offset:6400
    ds_read_b64_tr_b16 a[12:13], v186 offset:6176
    ds_read_b64_tr_b16 a[14:15], v186 offset:6432
    s_waitcnt lgkmcnt(4)
    s_add_u32 m0, s33, 4096
    s_xor_b32 s38, s34, 1572864
    buffer_load_dwordx4 v184, s[8:11], s38 offen lds
    s_add_u32 m0, s33, 5120
    s_xor_b32 s38, s34, 1703936
    buffer_load_dwordx4 v184, s[8:11], s38 offen lds
    s_waitcnt vmcnt(52)
    ds_read_b64_tr_b16 a[20:21], v186 offset:8192
    ds_read_b64_tr_b16 a[22:23], v186 offset:8448
    ds_read_b64_tr_b16 a[28:29], v186 offset:8224
    ds_read_b64_tr_b16 a[30:31], v186 offset:8480
    s_waitcnt lgkmcnt(4)
    s_add_u32 m0, s33, 6144
    s_xor_b32 s38, s34, 1572864
    buffer_load_dwordx4 v184, s[12:15], s38 offen lds
    s_add_u32 m0, s33, 7168
    s_xor_b32 s38, s34, 1703936
    buffer_load_dwordx4 v184, s[12:15], s38 offen lds
    s_waitcnt vmcnt(52)
    ds_read_b64_tr_b16 a[36:37], v186 offset:10240
    ds_read_b64_tr_b16 a[38:39], v186 offset:10496
    ds_read_b64_tr_b16 a[44:45], v186 offset:10272
    ds_read_b64_tr_b16 a[46:47], v186 offset:10528
    s_waitcnt lgkmcnt(4)
    s_add_u32 m0, s33, 8192
    s_xor_b32 s38, s34, 1572864
    buffer_load_dwordx4 v184, s[16:19], s38 offen lds
    s_add_u32 m0, s33, 9216
    s_xor_b32 s38, s34, 1703936
    buffer_load_dwordx4 v184, s[16:19], s38 offen lds
    s_waitcnt vmcnt(28)
    s_barrier
    s_cmp_lg_u32 s31, 3
    s_cbranch_scc1 rec_arr_4
    v_mov_b32 v2, 0
    v_mov_b32 v3, s48
    s_mov_b64 exec, 1
    global_atomic_add v2, v3, s[92:93] offset:0 sc1
    s_mov_b64 exec, -1
rec_arr_4:
    ds_read_b64_tr_b16 a[48:49], v186 offset:12288
    ds_read_b64_tr_b16 a[50:51], v186 offset:12544
    ds_read_b64_tr_b16 a[56:57], v186 offset:12320
    ds_read_b64_tr_b16 a[58:59], v186 offset:12576
    s_waitcnt lgkmcnt(4)
    s_add_u32 m0, s33, 10240
    s_xor_b32 s38, s34, 1835008
    buffer_load_dwordx4 v184, s[8:11], s38 offen lds
    s_add_u32 m0, s33, 11264
    s_xor_b32 s38, s34, 1966080
    buffer_load_dwordx4 v184, s[8:11], s38 offen lds
    s_waitcnt vmcnt(28)
    ds_read_b64_tr_b16 a[64:65], v186 offset:14336
    ds_read_b64_tr_b16 a[66:67], v186 offset:14592
    ds_read_b64_tr_b16 a[72:73], v186 offset:14368
    ds_read_b64_tr_b16 a[74:75], v186 offset:14624
    s_waitcnt lgkmcnt(4)
    s_add_u32 m0, s33, 12288
    s_xor_b32 s38, s34, 1835008
    buffer_load_dwordx4 v184, s[12:15], s38 offen lds
    s_add_u32 m0, s33, 13312
    s_xor_b32 s38, s34, 1966080
    buffer_load_dwordx4 v184, s[12:15], s38 offen lds
    s_waitcnt vmcnt(28)
    ds_read_b64_tr_b16 a[80:81], v186 offset:16384
    ds_read_b64_tr_b16 a[82:83], v186 offset:16640
    ds_read_b64_tr_b16 a[88:89], v186 offset:16416
    ds_read_b64_tr_b16 a[90:91], v186 offset:16672
    s_waitcnt lgkmcnt(4)
    s_add_u32 m0, s33, 14336
    s_xor_b32 s38, s34, 1835008
    buffer_load_dwordx4 v184, s[16:19], s38 offen lds
    s_add_u32 m0, s33, 15360
    s_xor_b32 s38, s34, 1966080
    buffer_load_dwordx4 v184, s[16:19], s38 offen lds
    s_waitcnt vmcnt(28)
    ds_read_b64_tr_b16 a[52:53], v186 offset:18432
    ds_read_b64_tr_b16 a[54:55], v186 offset:18688
    ds_read_b64_tr_b16 a[60:61], v186 offset:18464
    ds_read_b64_tr_b16 a[62:63], v186 offset:18720
    s_waitcnt lgkmcnt(4)
    s_add_u32 m0, s33, 16384
    s_xor_b32 s38, s35, 0
    buffer_load_dwordx4 v185, s[20:23], s38 offen lds
    s_add_u32 m0, s33, 17408
    s_xor_b32 s38, s35, 65536
    buffer_load_dwordx4 v185, s[20:23], s38 offen lds
    s_waitcnt vmcnt(28)
    ds_read_b64_tr_b16 a[68:69], v186 offset:20480
    ds_read_b64_tr_b16 a[70:71], v186 offset:20736
    ds_read_b64_tr_b16 a[76:77], v186 offset:20512
    ds_read_b64_tr_b16 a[78:79], v186 offset:20768
    s_waitcnt lgkmcnt(4)
    s_add_u32 m0, s33, 18432
    s_xor_b32 s38, s35, 131072
    buffer_load_dwordx4 v185, s[20:23], s38 offen lds
    s_add_u32 m0, s33, 19456
    s_xor_b32 s38, s35, 196608
    buffer_load_dwordx4 v185, s[20:23], s38 offen lds
    s_waitcnt vmcnt(28)
    ds_read_b64_tr_b16 a[84:85], v186 offset:22528
    ds_read_b64_tr_b16 a[86:87], v186 offset:22784
    ds_read_b64_tr_b16 a[92:93], v186 offset:22560
    ds_read_b64_tr_b16 a[94:95], v186 offset:22816
    s_waitcnt lgkmcnt(4)
    s_add_u32 m0, s33, 20480
    s_xor_b32 s38, s35, 262144
    buffer_load_dwordx4 v185, s[20:23], s38 offen lds
    s_add_u32 m0, s33, 21504
    s_xor_b32 s38, s35, 327680
    buffer_load_dwordx4 v185, s[20:23], s38 offen lds
    s_waitcnt vmcnt(28)
    ds_read_b64_tr_b16 a[96:97], v186 offset:24576
    ds_read_b64_tr_b16 a[98:99], v186 offset:24832
    ds_read_b64_tr_b16 a[104:105], v186 offset:24608
    ds_read_b64_tr_b16 a[106:107], v186 offset:24864
    s_waitcnt lgkmcnt(4)
    s_add_u32 m0, s33, 22528
    s_xor_b32 s38, s35, 393216
    buffer_load_dwordx4 v185, s[20:23], s38 offen lds
    s_add_u32 m0, s33, 23552
    s_xor_b32 s38, s35, 458752
    buffer_load_dwordx4 v185, s[20:23], s38 offen lds
    s_waitcnt vmcnt(28)
    ds_read_b64_tr_b16 a[112:113], v186 offset:26624
    ds_read_b64_tr_b16 a[114:115], v186 offset:26880
    ds_read_b64_tr_b16 a[120:121], v186 offset:26656
    ds_read_b64_tr_b16 a[122:123], v186 offset:26912
    s_waitcnt lgkmcnt(4)
    s_add_u32 m0, s33, 24576
    s_xor_b32 s38, s35, 524288
    buffer_load_dwordx4 v185, s[20:23], s38 offen lds
    s_add_u32 m0, s33, 25600
    s_xor_b32 s38, s35, 589824
    buffer_load_dwordx4 v185, s[20:23], s38 offen lds
    s_waitcnt vmcnt(28)
    ds_read_b64_tr_b16 a[128:129], v186 offset:28672
    ds_read_b64_tr_b16 a[130:131], v186 offset:28928
    ds_read_b64_tr_b16 a[136:137], v186 offset:28704
    ds_read_b64_tr_b16 a[138:139], v186 offset:28960
    s_waitcnt lgkmcnt(4)
    s_add_u32 m0, s33, 26624
    s_xor_b32 s38, s35, 655360
    buffer_load_dwordx4 v185, s[20:23], s38 offen lds
    s_add_u32 m0, s33, 27648
    s_xor_b32 s38, s35, 720896
    buffer_load_dwordx4 v185, s[20:23], s38 offen lds
    s_waitcnt vmcnt(28)
    ds_read_b64_tr_b16 a[100:101], v186 offset:30720
    ds_read_b64_tr_b16 a[102:103], v186 offset:30976
    ds_read_b64_tr_b16 a[108:109], v186 offset:30752
    ds_read_b64_tr_b16 a[110:111], v186 offset:31008
    s_waitcnt lgkmcnt(4)
    s_add_u32 m0, s33, 28672
    s_xor_b32 s38, s35, 786432
    buffer_load_dwordx4 v185, s[20:23], s38 offen lds
    s_add_u32 m0, s33, 29696
    s_xor_b32 s38, s35, 851968
    buffer_load_dwordx4 v185, s[20:23], s38 offen lds
    s_waitcnt vmcnt(28)
    ds_read_b64_tr_b16 a[116:117], v186 offset:0
    ds_read_b64_tr_b16 a[118:119], v186 offset:256
    ds_read_b64_tr_b16 a[124:125], v186 offset:32
    ds_read_b64_tr_b16 a[126:127], v186 offset:288
    s_waitcnt lgkmcnt(4)
    s_add_u32 m0, s33, 30720
    s_xor_b32 s38, s35, 917504
    buffer_load_dwordx4 v185, s[20:23], s38 offen lds
    s_add_u32 m0, s33, 31744
    s_xor_b32 s38, s35, 983040
    buffer_load_dwordx4 v185, s[20:23], s38 offen lds
    s_waitcnt vmcnt(28)
    ds_read_b64_tr_b16 a[132:133], v186 offset:2048
    ds_read_b64_tr_b16 a[134:135], v186 offset:2304
    ds_read_b64_tr_b16 a[140:141], v186 offset:2080
    ds_read_b64_tr_b16 a[142:143], v186 offset:2336
    s_waitcnt lgkmcnt(4)
    s_add_u32 m0, s33, 0
    s_xor_b32 s38, s35, 1048576
    buffer_load_dwordx4 v185, s[20:23], s38 offen lds
    s_add_u32 m0, s33, 1024
    s_xor_b32 s38, s35, 1114112
    buffer_load_dwordx4 v185, s[20:23], s38 offen lds
    s_waitcnt vmcnt(28)
    ds_read_b64_tr_b16 a[144:145], v186 offset:4096
    ds_read_b64_tr_b16 a[146:147], v186 offset:4352
    ds_read_b64_tr_b16 a[152:153], v186 offset:4128
    ds_read_b64_tr_b16 a[154:155], v186 offset:4384
    s_waitcnt lgkmcnt(4)
    s_add_u32 m0, s33, 2048
    s_xor_b32 s38, s35, 1179648
    buffer_load_dwordx4 v185, s[20:23], s38 offen lds
    s_add_u32 m0, s33, 3072
    s_xor_b32 s38, s35, 1245184
    buffer_load_dwordx4 v185, s[20:23], s38 offen lds
    s_waitcnt vmcnt(28)
    ds_read_b64_tr_b16 a[160:161], v186 offset:6144
    ds_read_b64_tr_b16 a[162:163], v186 offset:6400
    ds_read_b64_tr_b16 a[168:169], v186 offset:6176
    ds_read_b64_tr_b16 a[170:171], v186 offset:6432
    s_waitcnt lgkmcnt(4)
    s_add_u32 m0, s33, 4096
    s_xor_b32 s38, s35, 1310720
    buffer_load_dwordx4 v185, s[20:23], s38 offen lds
    s_add_u32 m0, s33, 5120
    s_xor_b32 s38, s35, 1376256
    buffer_load_dwordx4 v185, s[20:23], s38 offen lds
    s_waitcnt vmcnt(28)
    ds_read_b64_tr_b16 a[176:177], v186 offset:8192
    ds_read_b64_tr_b16 a[178:179], v186 offset:8448
    ds_read_b64_tr_b16 a[184:185], v186 offset:8224
    ds_read_b64_tr_b16 a[186:187], v186 offset:8480
    s_waitcnt lgkmcnt(4)
    s_add_u32 m0, s33, 6144
    s_xor_b32 s38, s35, 1441792
    buffer_load_dwordx4 v185, s[20:23], s38 offen lds
    s_add_u32 m0, s33, 7168
    s_xor_b32 s38, s35, 1507328
    buffer_load_dwordx4 v185, s[20:23], s38 offen lds
    s_waitcnt vmcnt(28)
    ds_read_b64_tr_b16 a[148:149], v186 offset:10240
    ds_read_b64_tr_b16 a[150:151], v186 offset:10496
    ds_read_b64_tr_b16 a[156:157], v186 offset:10272
    ds_read_b64_tr_b16 a[158:159], v186 offset:10528
    s_waitcnt lgkmcnt(4)
    s_add_u32 m0, s33, 8192
    s_xor_b32 s38, s35, 1572864
    buffer_load_dwordx4 v185, s[20:23], s38 offen lds
    s_add_u32 m0, s33, 9216
    s_xor_b32 s38, s35, 1638400
    buffer_load_dwordx4 v185, s[20:23], s38 offen lds
    s_waitcnt vmcnt(28)
    ds_read_b64_tr_b16 a[164:165], v186 offset:12288
    ds_read_b64_tr_b16 a[166:167], v186 offset:12544
    ds_read_b64_tr_b16 a[172:173], v186 offset:12320
    ds_read_b64_tr_b16 a[174:175], v186 offset:12576
    s_waitcnt lgkmcnt(4)
    s_add_u32 m0, s33, 10240
    s_xor_b32 s38, s35, 1703936
    buffer_load_dwordx4 v185, s[20:23], s38 offen lds
    s_add_u32 m0, s33, 11264
    s_xor_b32 s38, s35, 1769472
    buffer_load_dwordx4 v185, s[20:23], s38 offen lds
    s_waitcnt vmcnt(28)
    ds_read_b64_tr_b16 a[180:181], v186 offset:14336
    ds_read_b64_tr_b16 a[182:183], v186 offset:14592
    ds_read_b64_tr_b16 a[188:189], v186 offset:14368
    ds_read_b64_tr_b16 a[190:191], v186 offset:14624
    s_waitcnt lgkmcnt(4)
    s_add_u32 m0, s33, 12288
    s_xor_b32 s38, s35, 1835008
    buffer_load_dwordx4 v185, s[20:23], s38 offen lds
    s_add_u32 m0, s33, 13312
    s_xor_b32 s38, s35, 1900544
    buffer_load_dwordx4 v185, s[20:23], s38 offen lds
    s_waitcnt vmcnt(28)
    ds_read_b64_tr_b16 a[192:193], v187 offset:16384
    ds_read_b64_tr_b16 a[194:195], v187 offset:16512
    ds_read_b64_tr_b16 a[196:197], v187 offset:17408
    ds_read_b64_tr_b16 a[198:199], v187 offset:17536
    s_waitcnt lgkmcnt(4)
    s_add_u32 m0, s33, 14336
    s_xor_b32 s38, s35, 1966080
    buffer_load_dwordx4 v185, s[20:23], s38 offen lds
    s_add_u32 m0, s33, 15360
    s_xor_b32 s38, s35, 2031616
    buffer_load_dwordx4 v185, s[20:23], s38 offen lds
    s_waitcnt vmcnt(28)
    ds_read_b64_tr_b16 a[200:201], v187 offset:18432
    ds_read_b64_tr_b16 a[202:203], v187 offset:18560
    ds_read_b64_tr_b16 a[204:205], v187 offset:19456
    ds_read_b64_tr_b16 a[206:207], v187 offset:19584
    s_waitcnt vmcnt(26)
    s_cmp_lg_u32 s31, 0
    s_cbranch_scc1 rec_rdy_5
    v_mov_b32 v2, 0
    v_mov_b32 v3, 1
    s_mov_b64 exec, 1
    global_atomic_add v2, v3, s[92:93] offset:128 sc1
    s_mov_b64 exec, -1
rec_rdy_5:
    ds_read_b64_tr_b16 a[208:209], v187 offset:20480
    ds_read_b64_tr_b16 a[210:211], v187 offset:20608
    ds_read_b64_tr_b16 a[212:213], v187 offset:21504
    ds_read_b64_tr_b16 a[214:215], v187 offset:21632
    s_waitcnt vmcnt(24)
    ds_read_b64_tr_b16 a[216:217], v187 offset:22528
    ds_read_b64_tr_b16 a[218:219], v187 offset:22656
    ds_read_b64_tr_b16 a[220:221], v187 offset:23552
    ds_read_b64_tr_b16 a[222:223], v187 offset:23680
    s_waitcnt vmcnt(22)
    ds_read_b64_tr_b16 a[224:225], v187 offset:24576
    ds_read_b64_tr_b16 a[226:227], v187 offset:24704
    ds_read_b64_tr_b16 a[228:229], v187 offset:25600
    ds_read_b64_tr_b16 a[230:231], v187 offset:25728
    s_waitcnt vmcnt(20)
    ds_read_b64_tr_b16 a[232:233], v187 offset:26624
    ds_read_b64_tr_b16 a[234:235], v187 offset:26752
    ds_read_b64_tr_b16 a[236:237], v187 offset:27648
    ds_read_b64_tr_b16 a[238:239], v187 offset:27776
    s_waitcnt vmcnt(18)
    ds_read_b64_tr_b16 a[240:241], v187 offset:28672
    ds_read_b64_tr_b16 a[242:243], v187 offset:28800
    ds_read_b64_tr_b16 a[244:245], v187 offset:29696
    ds_read_b64_tr_b16 a[246:247], v187 offset:29824
    s_waitcnt vmcnt(16)
    ds_read_b64_tr_b16 a[248:249], v187 offset:30720
    ds_read_b64_tr_b16 a[250:251], v187 offset:30848
    ds_read_b64_tr_b16 a[252:253], v187 offset:31744
    ds_read_b64_tr_b16 a[254:255], v187 offset:31872
    s_waitcnt vmcnt(14)
    ds_read_b64_tr_b16 v[192:193], v187 offset:0
    ds_read_b64_tr_b16 v[194:195], v187 offset:128
    ds_read_b64_tr_b16 v[196:197], v187 offset:1024
    ds_read_b64_tr_b16 v[198:199], v187 offset:1152
    s_waitcnt vmcnt(12)
    ds_read_b64_tr_b16 v[200:201], v187 offset:2048
    ds_read_b64_tr_b16 v[202:203], v187 offset:2176
    ds_read_b64_tr_b16 v[204:205], v187 offset:3072
    ds_read_b64_tr_b16 v[206:207], v187 offset:3200
    s_waitcnt vmcnt(10)
    ds_read_b64_tr_b16 v[208:209], v187 offset:4096
    ds_read_b64_tr_b16 v[210:211], v187 offset:4224
    ds_read_b64_tr_b16 v[212:213], v187 offset:5120
    ds_read_b64_tr_b16 v[214:215], v187 offset:5248
    s_waitcnt vmcnt(8)
    ds_read_b64_tr_b16 v[216:217], v187 offset:6144
    ds_read_b64_tr_b16 v[218:219], v187 offset:6272
    ds_read_b64_tr_b16 v[220:221], v187 offset:7168
    ds_read_b64_tr_b16 v[222:223], v187 offset:7296
    s_waitcnt vmcnt(6)
    ds_read_b64_tr_b16 v[224:225], v187 offset:8192
    ds_read_b64_tr_b16 v[226:227], v187 offset:8320
    ds_read_b64_tr_b16 v[228:229], v187 offset:9216
    ds_read_b64_tr_b16 v[230:231], v187 offset:9344
    s_waitcnt vmcnt(4)
    ds_read_b64_tr_b16 v[232:233], v187 offset:10240
    ds_read_b64_tr_b16 v[234:235], v187 offset:10368
    ds_read_b64_tr_b16 v[236:237], v187 offset:11264
    ds_read_b64_tr_b16 v[238:239], v187 offset:11392
    s_waitcnt vmcnt(2)
    ds_read_b64_tr_b16 v[240:241], v187 offset:12288
    ds_read_b64_tr_b16 v[242:243], v187 offset:12416
    ds_read_b64_tr_b16 v[244:245], v187 offset:13312
    ds_read_b64_tr_b16 v[246:247], v187 offset:13440
    s_waitcnt vmcnt(0)
    ds_read_b64_tr_b16 v[248:249], v187 offset:14336
    ds_read_b64_tr_b16 v[250:251], v187 offset:14464
    ds_read_b64_tr_b16 v[252:253], v187 offset:15360
    ds_read_b64_tr_b16 v[254:255], v187 offset:15488
    s_waitcnt lgkmcnt(0)
    v_xor_b32 v137, 1024, v13
    v_xor_b32 v184, 2048, v13
    v_xor_b32 v185, 3072, v13
    v_xor_b32 v186, 4096, v13
    v_xor_b32 v187, 5120, v13
    v_xor_b32 v190, 6144, v13
    v_xor_b32 v191, 7168, v13
    v_max_u32 v36, 1, v36
    v_max_u32 v37, 1, v37
    v_max_u32 v38, 1, v38
    v_max_u32 v39, 1, v39
    v_max_u32 v40, 1, v40
    v_max_u32 v41, 1, v41
    v_max_u32 v42, 1, v42
    v_max_u32 v43, 1, v43
    v_max_u32 v44, 1, v44
    v_max_u32 v45, 1, v45
    v_max_u32 v46, 1, v46
    v_max_u32 v47, 1, v47
    v_max_u32 v48, 1, v48
    v_max_u32 v49, 1, v49
    v_max_u32 v50, 1, v50
    v_max_u32 v51, 1, v51
    v_mov_b32 v68, 0
    v_mov_b32 v69, 0
    v_mov_b32 v70, 0
    v_mov_b32 v71, 0
    v_mov_b32 v72, 0
    v_mov_b32 v73, 0
    v_mov_b32 v74, 0
    v_mov_b32 v75, 0
    v_mov_b32 v76, 0
    v_mov_b32 v77, 0
    v_mov_b32 v78, 0
    v_mov_b32 v79, 0
    v_mov_b32 v80, 0
    v_mov_b32 v81, 0
    v_mov_b32 v82, 0
    v_mov_b32 v83, 0
    v_mov_b32 v84, 0
    v_mov_b32 v85, 0
    v_mov_b32 v86, 0
    v_mov_b32 v87, 0
    v_mov_b32 v88, 0
    v_mov_b32 v89, 0
    v_mov_b32 v90, 0
    v_mov_b32 v91, 0
    s_mov_b32 s72, 0
    s_mov_b32 s73, 0
    s_mov_b32 s74, 0
    s_mov_b32 s75, 0
    s_mov_b32 s76, 0
    s_mov_b32 s77, 0
    s_mov_b32 s78, 0
    s_mov_b32 s79, 0
    s_mov_b32 s80, 0
    s_mov_b32 s81, 0
    s_mov_b32 s82, 0
    s_mov_b32 s83, 0
    s_mov_b32 s84, 0
    s_mov_b32 s85, 0
    s_mov_b32 s86, 0
    s_mov_b32 s87, 0
    v_mov_b32 v2, 0
    s_branch rec_ibq_8
rec_ibp_7:
    s_sleep 16
rec_ibq_8:
    global_load_dword v3, v2, s[92:93] offset:0 sc1
    s_add_u32 s41, s41, 1
    s_cmp_ge_u32 s41, 0x80000
    s_cbranch_scc1 rec_ib_6
    s_waitcnt vmcnt(0)
    v_readfirstlane_b32 s38, v3
    s_and_b32 s39, s38, 0xffff
    s_cmp_lt_u32 s39, 256
    s_cbranch_scc1 rec_ibp_7
rec_ib_6:
    s_cmp_ge_u32 s38, 4194304
    s_cselect_b32 s48, -1, 0
    s_xor_b32 s48, s48, 0xaaa
    s_and_b32 s33, s48, 1
    s_lshl_b32 s33, s33, 13
    s_add_u32 s33, s33, s49
    s_add_u32 s34, s33, 262144
    s_add_u32 s35, s33, 524288
    s_lshr_b32 s38, s28, 5
    s_lshl_b32 s38, s38, 4
    s_add_u32 s38, s38, s33
    s_add_u32 s38, s38, 163840
    v_lshrrev_b32 v132, 5, v1
    v_lshlrev_b32 v132, 14, v132
    v_and_b32 v4, 31, v1
    v_lshl_add_u32 v132, v4, 8, v132
    v_add_u32 v132, s38, v132
    s_and_b32 s39, s28, 95
    s_cmp_eq_u32 s39, 13
    s_cselect_b64 vcc, -1, 0
    v_mov_b32 v4, 2130706432
    v_cndmask_b32 v132, v4, v132, vcc
    v_add_u32 v133, 128, v132
    s_cmp_eq_u32 s31, 1
    s_cselect_b64 vcc, -1, 0
    v_mov_b32 v4, 2130706432
    v_cndmask_b32 v133, v4, v133, vcc
    s_mov_b32 s99, 32768
    s_lshr_b32 s55, s28, 5
    s_lshl_b32 s55, s55, 14
    s_and_b32 s40, s28, 31
    s_lshl_b32 s40, s40, 8
    s_add_u32 s55, s55, s40
    s_add_u32 s55, s55, s33
    s_add_u32 s55, s55, 163840
    s_cmp_eq_u32 s31, 3
    s_cselect_b32 s88, s35, 88080384
    s_barrier
    s_load_dwordx4 s[72:75], s[90:91], s97 offset:16 glc
    s_waitcnt lgkmcnt(0)
    s_xor_b32 s73, s73, s72
    s_xor_b32 s74, s74, s72
    s_xor_b32 s75, s75, s72
    s_or_b32 s73, s73, s74
    s_or_b32 s96, s73, s75
    s_mov_b32 s72, 0
    s_mov_b32 s73, 0
    s_mov_b32 s74, 0
    s_mov_b32 s75, 0
    s_cmp_gt_u32 s94, 0
    s_cbranch_scc0 rec_kv_9
rec_kvd_10:
    s_add_u32 m0, s51, s3
    s_nop 0
    buffer_load_dwordx4 v30, s[4:7], s37 offen sc1 lds
    s_waitcnt vmcnt(0)
    s_barrier
    s_branch rec_entry_11
rec_loop_12:
    s_barrier
    buffer_load_dwordx4 v[36:39], v7, s[4:7], s33 offen sc1
    s_nop 3
    buffer_load_dwordx4 v[40:43], v12, s[4:7], s33 offen sc1
    s_nop 3
    buffer_load_dwordx4 v[44:47], v142, s[4:7], s33 offen sc1
    s_nop 3
    buffer_load_dwordx4 v[48:51], v143, s[4:7], s33 offen sc1
rec_entry_11:
    v_add_u32 v2, s51, v16
    ds_read_b128 v[60:63], v2 offset:0
    ds_read_b128 v[64:67], v2 offset:1024
    ds_read_b128 v[52:55], v2 offset:2048
    ds_read_b128 v[56:59], v2 offset:3072
    s_waitcnt vmcnt(3)
    v_smfmac_f32_16x16x64_bf16 v[68:71], v[36:39], a[0:7], v5
    v_min_u32 v31, v36, v37
    v_smfmac_f32_16x16x64_bf16 v[72:75], v[36:39], a[8:15], v5
    v_min_u32 v4, v38, v39
    v_smfmac_f32_16x16x64_bf16 v[76:79], v[36:39], a[16:23], v5
    v_smfmac_f32_16x16x64_bf16 v[80:83], v[36:39], a[24:31], v5
    s_waitcnt vmcnt(2)
    v_smfmac_f32_16x16x64_bf16 v[68:71], v[40:43], a[48:55], v5
    v_min3_u32 v31, v31, v40, v41
    v_smfmac_f32_16x16x64_bf16 v[72:75], v[40:43], a[56:63], v5
    v_min3_u32 v4, v4, v42, v43
    v_smfmac_f32_16x16x64_bf16 v[76:79], v[40:43], a[64:71], v5
    v_smfmac_f32_16x16x64_bf16 v[80:83], v[40:43], a[72:79], v5
    s_waitcnt vmcnt(1)
    v_smfmac_f32_16x16x64_bf16 v[68:71], v[44:47], a[96:103], v5
    v_min3_u32 v31, v31, v44, v45
    v_smfmac_f32_16x16x64_bf16 v[72:75], v[44:47], a[104:111], v5
    v_min3_u32 v4, v4, v46, v47
    v_smfmac_f32_16x16x64_bf16 v[76:79], v[44:47], a[112:119], v5
    v_min_u32 v31, v31, v4
    v_smfmac_f32_16x16x64_bf16 v[80:83], v[44:47], a[120:127], v5
    s_waitcnt vmcnt(0)
    v_min3_u32 v31, v31, v48, v49
    v_smfmac_f32_16x16x64_bf16 v[68:71], v[48:51], a[144:151], v5
    v_min3_u32 v31, v31, v50, v51
    v_smfmac_f32_16x16x64_bf16 v[72:75], v[48:51], a[152:159], v5
    v_cmp_eq_u32 vcc, 0, v31
    v_smfmac_f32_16x16x64_bf16 v[76:79], v[48:51], a[160:167], v5
    v_smfmac_f32_16x16x64_bf16 v[80:83], v[48:51], a[168:175], v5
    s_cbranch_vccnz rec_gafix_15
rec_gaok_14:
    s_nop 3
    v_permlane16_swap_b32 v68, v72
    v_permlane16_swap_b32 v69, v73
    v_permlane16_swap_b32 v70, v74
    v_permlane16_swap_b32 v71, v75
    v_pk_add_f32 v[68:69], v[68:69], v[72:73]
    v_pk_add_f32 v[70:71], v[70:71], v[74:75]
    ds_write2_b32 v14, v68, v69 offset0:0 offset1:40
    ds_write2_b32 v14, v70, v71 offset0:80 offset1:120
    v_permlane16_swap_b32 v76, v80
    v_permlane16_swap_b32 v77, v81
    v_permlane16_swap_b32 v78, v82
    v_permlane16_swap_b32 v79, v83
    v_pk_add_f32 v[76:77], v[76:77], v[80:81]
    v_pk_add_f32 v[78:79], v[78:79], v[82:83]
    ds_write2_b32 v15, v76, v77 offset0:0 offset1:40
    ds_write2_b32 v15, v78, v79 offset0:80 offset1:120
    s_cmp_lg_u32 s31, 0
    s_cbranch_scc1 rec_w1_17
    s_waitcnt lgkmcnt(0)
    s_barrier
    ds_read_b128 v[100:103], v18 offset:0
    v_smfmac_f32_16x16x64_bf16 v[84:87], v[36:39], a[32:39], v5
    ds_read_b128 v[104:107], v18 offset:32
    v_smfmac_f32_16x16x64_bf16 v[88:91], v[36:39], a[40:47], v5
    ds_read_b128 v[108:111], v18 offset:2560
    v_smfmac_f32_16x16x64_bf16 v[84:87], v[40:43], a[80:87], v5
    ds_read_b128 v[112:115], v18 offset:2592
    v_smfmac_f32_16x16x64_bf16 v[88:91], v[40:43], a[88:95], v5
    ds_read_b128 v[116:119], v18 offset:5120
    v_smfmac_f32_16x16x64_bf16 v[84:87], v[44:47], a[128:135], v5
    ds_read_b128 v[120:123], v18 offset:5152
    v_smfmac_f32_16x16x64_bf16 v[88:91], v[44:47], a[136:143], v5
    ds_read_b128 v[124:127], v18 offset:7680
    v_smfmac_f32_16x16x64_bf16 v[84:87], v[48:51], a[176:183], v5
    ds_read_b128 v[128:131], v18 offset:7712
    v_smfmac_f32_16x16x64_bf16 v[88:91], v[48:51], a[184:191], v5
    s_waitcnt lgkmcnt(4)
    v_pk_add_f32 v[100:101], v[100:101], v[108:109]
    v_pk_add_f32 v[102:103], v[102:103], v[110:111]
    v_pk_add_f32 v[104:105], v[104:105], v[112:113]
    v_pk_add_f32 v[106:107], v[106:107], v[114:115]
    s_waitcnt lgkmcnt(2)
    v_pk_add_f32 v[100:101], v[100:101], v[116:117]
    v_pk_add_f32 v[102:103], v[102:103], v[118:119]
    v_pk_add_f32 v[104:105], v[104:105], v[120:121]
    v_pk_add_f32 v[106:107], v[106:107], v[122:123]
    s_waitcnt lgkmcnt(0)
    v_pk_add_f32 v[100:101], v[100:101], v[124:125]
    v_pk_add_f32 v[102:103], v[102:103], v[126:127]
    v_pk_add_f32 v[104:105], v[104:105], v[128:129]
    v_pk_add_f32 v[106:107], v[106:107], v[130:131]
    v_cvt_pk_bf16_f32 v96, v100, v101
    v_cvt_pk_bf16_f32 v97, v102, v103
    v_cvt_pk_bf16_f32 v98, v104, v105
    v_cvt_pk_bf16_f32 v99, v106, v107
    s_nop 1
    v_mfma_f32_16x16x32_bf16 v[68:71], v[60:63], v[96:99], 0
    v_mfma_f32_16x16x32_bf16 v[72:75], v[64:67], v[96:99], 0
    v_mfma_f32_16x16x32_bf16 v[76:79], v[96:99], v[96:99], 0
    s_cmp_lg_u32 s96, 0
    v_permlane16_swap_b32 v84, v88
    v_permlane16_swap_b32 v85, v89
    v_permlane16_swap_b32 v86, v90
    v_permlane16_swap_b32 v87, v91
    v_pk_add_f32 v[84:85], v[84:85], v[88:89]
    v_pk_add_f32 v[86:87], v[86:87], v[90:91]
    s_cbranch_scc1 rec_slow_18
    s_mov_b64 exec, s[42:43]
    buffer_store_dwordx4 v[68:71], v19, s[4:7], s36 offen
    buffer_store_dwordx4 v[72:75], v19, s[4:7], s36 offen offset:128
    s_mov_b64 exec, s[46:47]
    buffer_store_dwordx4 v[76:79], v20, s[4:7], s36 offen offset:1024
    s_mov_b64 exec, -1
rec_slowr_19:
    ds_write_b128 v17, v[84:87]
    ds_write_b128 v16, v[96:99] offset:15360
    s_waitcnt lgkmcnt(0)
    s_barrier
    ds_read2st64_b32 v[100:101], v25 offset0:0 offset1:2
    ds_read2st64_b32 v[102:103], v26 offset0:0 offset1:2
    ds_read2st64_b32 v[104:105], v25 offset0:4 offset1:6
    ds_read2st64_b32 v[106:107], v26 offset0:4 offset1:6
    ds_read2st64_b32 v[108:109], v25 offset0:8 offset1:10
    ds_read2st64_b32 v[110:111], v26 offset0:8 offset1:10
    ds_read2st64_b32 v[112:113], v25 offset0:12 offset1:14
    ds_read2st64_b32 v[114:115], v26 offset0:12 offset1:14
    v_mov_b32_dpp v68, v72 row_ror:8 row_mask:0xf bank_mask:0xc
    v_mov_b32_dpp v69, v73 row_ror:8 row_mask:0xf bank_mask:0xc
    v_mov_b32_dpp v70, v74 row_ror:8 row_mask:0xf bank_mask:0xc
    v_mov_b32_dpp v71, v75 row_ror:8 row_mask:0xf bank_mask:0xc
    buffer_load_dwordx4 v[176:179], v21, s[4:7], s36 offen offset:1024 sc1
    buffer_load_dwordx4 v[164:167], v22, s[4:7], s36 offen sc1
    buffer_load_dwordx4 v[168:171], v23, s[4:7], s36 offen sc1
    buffer_load_dwordx4 v[172:175], v24, s[4:7], s36 offen sc1
    s_waitcnt lgkmcnt(0)
    v_pk_add_f32 v[100:101], v[100:101], v[104:105]
    v_pk_add_f32 v[102:103], v[102:103], v[106:107]
    v_pk_add_f32 v[108:109], v[108:109], v[112:113]
    v_pk_add_f32 v[110:111], v[110:111], v[114:115]
    v_pk_add_f32 v[100:101], v[100:101], v[108:109]
    v_pk_add_f32 v[102:103], v[102:103], v[110:111]
    v_cvt_pk_bf16_f32 v138, v100, v101
    v_cvt_pk_bf16_f32 v140, v102, v103
    s_nop 15
    buffer_load_dwordx4 v[48:51], v21, s[4:7], s36 offen offset:1024 sc1
    buffer_load_dwordx4 v[36:39], v22, s[4:7], s36 offen sc1
    buffer_load_dwordx4 v[40:43], v23, s[4:7], s36 offen sc1
    buffer_load_dwordx4 v[44:47], v24, s[4:7], s36 offen sc1
    s_cmp_eq_u32 s32, 63
    s_cbranch_scc1 rec_b2_16
    s_waitcnt vmcnt(7)
    v_permlane32_swap_b32 v176, v178
    v_permlane32_swap_b32 v177, v179
    v_pk_add_f32 v[124:125], v[176:177], v[178:179]
    s_waitcnt vmcnt(6)
    v_pk_add_f32 v[120:121], v[68:69], v[164:165]
    v_pk_add_f32 v[122:123], v[70:71], v[166:167]
    v_permlane16_swap_b32 v124, v125
    s_waitcnt vmcnt(5)
    v_pk_add_f32 v[120:121], v[120:121], v[168:169]
    v_pk_add_f32 v[122:123], v[122:123], v[170:171]
    v_add_f32 v124, v124, v125
    s_waitcnt vmcnt(4)
    v_pk_add_f32 v[120:121], v[120:121], v[172:173]
    v_pk_add_f32 v[122:123], v[122:123], v[174:175]
    v_maximum3_f32 v135, v120, v121, v124
    v_maximum3_f32 v135, v135, v122, v123
    v_cmp_u_f32 vcc, v135, v135
    s_nop 0
    v_max_f32_dpp v135, v135, v135 row_ror:8 row_mask:0xf bank_mask:0xf
    v_mov_b32 v136, v135
    s_cbranch_vccnz rec_gbr_20
rec_gbo_21:
    buffer_store_dword v134, v132, s[4:7], 0 offen sc1
    buffer_store_dword v134, v132, s[4:7], s99 offen sc1
    v_permlane16_swap_b32 v135, v136
    v_max_f32 v135, v135, v136
    v_mov_b32 v136, v135
    s_nop 1
    v_permlane32_swap_b32 v135, v136
    v_max_f32 v135, v135, v136
    v_mul_f32 v135, s50, v135
    v_fma_f32 v124, v124, s50, -v135
    v_fma_f32 v120, v120, s50, -v135
    v_fma_f32 v121, v121, s50, -v135
    v_fma_f32 v122, v122, s50, -v135
    v_fma_f32 v123, v123, s50, -v135
    v_exp_f32 v124, v124
    v_exp_f32 v120, v120
    v_exp_f32 v121, v121
    v_exp_f32 v122, v122
    v_exp_f32 v123, v123
    v_mov_b32_dpp v125, v124 row_ror:8 row_mask:0xf bank_mask:0xf
    v_cvt_pk_bf16_f32 v156, v120, v121
    v_cvt_pk_bf16_f32 v157, v122, v123
    v_cvt_pk_bf16_f32 v160, v124, v125
    v_mov_b32_dpp v158, v156 row_ror:8 row_mask:0xf bank_mask:0xf
    v_mov_b32_dpp v159, v157 row_ror:8 row_mask:0xf bank_mask:0xf
    v_mfma_f32_16x16x32_bf16 v[116:119], v[32:35], v[160:163], 0
    s_nop 0
    v_mfma_f32_16x16x32_bf16 v[116:119], v[32:35], v[156:159], v[116:119]
    v_mfma_f32_16x16x32_bf16 v[108:111], v[52:55], v[156:159], 0
    v_mfma_f32_16x16x32_bf16 v[108:111], v[138:141], v[160:163], v[108:111]
    v_mfma_f32_16x16x32_bf16 v[112:115], v[56:59], v[156:159], 0
    v_mfma_f32_16x16x32_bf16 v[112:115], v[140:143], v[160:163], v[112:115]
    s_nop 3
    v_rcp_f32 v100, v116
    s_nop 0
    v_mov_b32 v101, v100
    v_pk_mul_f32 v[108:109], v[108:109], v[100:101]
    v_pk_mul_f32 v[110:111], v[110:111], v[100:101]
    v_pk_mul_f32 v[112:113], v[112:113], v[100:101]
    v_pk_mul_f32 v[114:115], v[114:115], v[100:101]
    v_cvt_pk_bf16_f32 v108, v108, v109
    v_cvt_pk_bf16_f32 v109, v110, v111
    v_cvt_pk_bf16_f32 v110, v112, v113
    v_cvt_pk_bf16_f32 v111, v114, v115
    v_max_u32 v108, 1, v108
    v_max_u32 v109, 1, v109
    v_max_u32 v110, 1, v110
    v_max_u32 v111, 1, v111
    s_mov_b64 exec, s[42:43]
    buffer_store_dwordx4 v[108:111], v27, s[4:7], s33 offen sc1
    s_mov_b64 exec, -1
    v_mov_b32 v68, 0
    v_mov_b32 v69, 0
    v_mov_b32 v70, 0
    v_mov_b32 v71, 0
    v_mov_b32 v72, 0
    v_mov_b32 v73, 0
    v_mov_b32 v74, 0
    v_mov_b32 v75, 0
rec_cs_23:
    s_barrier
    buffer_load_dwordx4 v[36:39], v13, s[4:7], s33 offen sc1
    s_nop 3
    buffer_load_dwordx4 v[40:43], v137, s[4:7], s33 offen sc1
    s_nop 3
    buffer_load_dwordx4 v[44:47], v184, s[4:7], s33 offen sc1
    s_nop 3
    buffer_load_dwordx4 v[48:51], v185, s[4:7], s33 offen sc1
    s_nop 3
    buffer_load_dwordx4 v[52:55], v186, s[4:7], s33 offen sc1
    s_nop 3
    buffer_load_dwordx4 v[56:59], v187, s[4:7], s33 offen sc1
    s_nop 3
    buffer_load_dwordx4 v[60:63], v190, s[4:7], s33 offen sc1
    s_nop 3
    buffer_load_dwordx4 v[64:67], v191, s[4:7], s33 offen sc1
    s_waitcnt vmcnt(7)
    v_smfmac_f32_16x16x64_bf16 v[68:71], v[36:39], a[192:199], v5
    v_min_u32 v31, v36, v37
    v_smfmac_f32_16x16x64_bf16 v[72:75], v[36:39], a[200:207], v5
    v_min_u32 v4, v38, v39
    s_add_u32 s38, s32, 1
    s_cmp_gt_u32 s94, s38
    s_cbranch_scc0 rec_kv_26
rec_kvd_27:
    s_xor_b32 s51, s51, 4096
    s_add_u32 m0, s51, s3
    s_add_u32 s37, s37, 262144
    buffer_load_dwordx4 v30, s[4:7], s37 offen sc1 lds
    s_waitcnt vmcnt(7)
    v_smfmac_f32_16x16x64_bf16 v[68:71], v[40:43], a[208:215], v5
    v_min3_u32 v31, v31, v40, v41
    v_smfmac_f32_16x16x64_bf16 v[72:75], v[40:43], a[216:223], v5
    v_min3_u32 v4, v4, v42, v43
    buffer_load_dword v3, v92, s[4:7], s36 offen sc1
    s_waitcnt vmcnt(7)
    v_smfmac_f32_16x16x64_bf16 v[68:71], v[44:47], a[224:231], v5
    v_min3_u32 v31, v31, v44, v45
    v_smfmac_f32_16x16x64_bf16 v[72:75], v[44:47], a[232:239], v5
    v_min3_u32 v4, v4, v46, v47
    s_waitcnt vmcnt(6)
    v_smfmac_f32_16x16x64_bf16 v[68:71], v[48:51], a[240:247], v5
    v_min3_u32 v31, v31, v48, v49
    v_smfmac_f32_16x16x64_bf16 v[72:75], v[48:51], a[248:255], v5
    v_min3_u32 v4, v4, v50, v51
    s_waitcnt vmcnt(5)
    v_smfmac_f32_16x16x64_bf16 v[68:71], v[52:55], v[192:199], v5
    v_min3_u32 v31, v31, v52, v53
    v_smfmac_f32_16x16x64_bf16 v[72:75], v[52:55], v[200:207], v5
    v_min3_u32 v4, v4, v54, v55
    s_waitcnt vmcnt(4)
    v_smfmac_f32_16x16x64_bf16 v[68:71], v[56:59], v[208:215], v5
    v_min3_u32 v31, v31, v56, v57
    v_smfmac_f32_16x16x64_bf16 v[72:75], v[56:59], v[216:223], v5
    v_min3_u32 v4, v4, v58, v59
    s_waitcnt vmcnt(3)
    v_smfmac_f32_16x16x64_bf16 v[68:71], v[60:63], v[224:231], v5
    v_min3_u32 v31, v31, v60, v61
    v_smfmac_f32_16x16x64_bf16 v[72:75], v[60:63], v[232:239], v5
    v_min3_u32 v4, v4, v62, v63
    v_min_u32 v31, v31, v4
    s_waitcnt vmcnt(2)
    v_min3_u32 v31, v31, v64, v65
    v_smfmac_f32_16x16x64_bf16 v[68:71], v[64:67], v[240:247], v5
    v_min3_u32 v31, v31, v66, v67
    v_smfmac_f32_16x16x64_bf16 v[72:75], v[64:67], v[248:255], v5
    v_cmp_eq_u32 vcc, 0, v31
    s_add_u32 s32, s32, 1
    s_add_u32 s38, s32, 2
    s_lshr_b32 s39, s38, 3
    s_lshr_b32 s39, s48, s39
    s_cbranch_vccnz rec_gcfix_25
rec_gcok_24:
    s_mov_b32 s33, s34
    s_mov_b32 s34, s35
    s_nop 2
    v_cndmask_b32 v68, v68, v72, s[44:45]
    v_cndmask_b32 v69, v69, v73, s[44:45]
    v_cndmask_b32 v70, v70, v74, s[44:45]
    v_cndmask_b32 v71, v71, v75, s[44:45]
    s_nop 0
    v_permlane32_swap_b32 v68, v70
    v_permlane32_swap_b32 v69, v71
    v_pk_add_f32 v[68:69], v[68:69], v[70:71]
    s_nop 1
    v_permlane16_swap_b32 v68, v69
    v_add_f32 v68, v68, v69
    ds_write_b32 v28, v68
    s_and_b32 s35, s39, 1
    s_lshl_b32 s35, s35, 13
    s_lshl_b32 s40, s38, 18
    s_add_u32 s35, s35, s40
    s_add_u32 s35, s35, s49
    s_add_u32 s36, s36, 262144
    s_cmp_lg_u32 s31, 0
    s_cbranch_scc1 rec_b4_28
    s_waitcnt lgkmcnt(0)
    s_barrier
    ds_read_b64 v[100:101], v29 offset:0
    ds_read_b64 v[102:103], v29 offset:256
    ds_read_b64 v[104:105], v29 offset:512
    ds_read_b64 v[106:107], v29 offset:768
    v_add_u32 v134, 2, v134
    s_waitcnt lgkmcnt(0)
    v_pk_add_f32 v[100:101], v[100:101], v[102:103]
    v_pk_add_f32 v[104:105], v[104:105], v[106:107]
    v_pk_add_f32 v[100:101], v[100:101], v[104:105]
    v_cvt_pk_bf16_f32 v100, v100, v101
    v_max_u32 v100, 1, v100
    s_nop 1
    v_mov_b32_dpp v101, v100 quad_perm:[1,1,1,1] row_mask:0xf bank_mask:0xf
    v_mov_b32_dpp v102, v100 quad_perm:[2,2,2,2] row_mask:0xf bank_mask:0xf
    v_mov_b32_dpp v103, v100 quad_perm:[3,3,3,3] row_mask:0xf bank_mask:0xf
    s_mov_b64 exec, 0x11111111
    buffer_store_dwordx4 v[100:103], v6, s[4:7], s33 offen sc1
    s_mov_b64 exec, -1
    s_barrier
    buffer_store_dword v189, v188, s[4:7], 0 offen sc1
    buffer_store_dwordx4 v[180:183], v93, s[4:7], s88 offen sc1
    buffer_store_dwordx4 v[144:147], v95, s[4:7], s34 offen sc1
    buffer_store_dwordx4 v[8:11], v94, s[4:7], s36 offen sc1
    v_add_u32 v189, 1, v189
    s_add_u32 s88, s88, 65536
    s_cmp_eq_u32 s31, 3
    s_cselect_b32 s88, s35, s88
    v_mov_b32 v68, 0
    v_mov_b32 v69, 0
    v_mov_b32 v70, 0
    v_mov_b32 v71, 0
    v_mov_b32 v72, 0
    v_mov_b32 v73, 0
    v_mov_b32 v74, 0
    v_mov_b32 v75, 0
    v_mov_b32 v76, 0
    v_mov_b32 v77, 0
    v_mov_b32 v78, 0
    v_mov_b32 v79, 0
    v_mov_b32 v80, 0
    v_mov_b32 v81, 0
    v_mov_b32 v82, 0
    v_mov_b32 v83, 0
    v_mov_b32 v84, 0
    v_mov_b32 v85, 0
    v_mov_b32 v86, 0
    v_mov_b32 v87, 0
    v_mov_b32 v88, 0
    v_mov_b32 v89, 0
    v_mov_b32 v90, 0
    v_mov_b32 v91, 0
    s_waitcnt vmcnt(5)
    s_branch rec_loop_12
rec_b4_28:
    s_waitcnt lgkmcnt(0)
    s_barrier
    buffer_store_dword v134, v133, s[4:7], 0 offen sc1
    buffer_store_dword v134, v133, s[4:7], s99 offen sc1
    v_add_u32 v134, 2, v134
    v_mov_b32 v68, 0
    v_mov_b32 v69, 0
    v_mov_b32 v70, 0
    v_mov_b32 v71, 0
    v_mov_b32 v72, 0
    v_mov_b32 v73, 0
    v_mov_b32 v74, 0
    v_mov_b32 v75, 0
    v_mov_b32 v76, 0
    v_mov_b32 v77, 0
    v_mov_b32 v78, 0
    v_mov_b32 v79, 0
    v_mov_b32 v80, 0
    v_mov_b32 v81, 0
    v_mov_b32 v82, 0
    v_mov_b32 v83, 0
    v_mov_b32 v84, 0
    v_mov_b32 v85, 0
    v_mov_b32 v86, 0
    v_mov_b32 v87, 0
    v_mov_b32 v88, 0
    v_mov_b32 v89, 0
    v_mov_b32 v90, 0
    v_mov_b32 v91, 0
    s_barrier
    buffer_store_dword v189, v188, s[4:7], 0 offen sc1
    buffer_store_dwordx4 v[180:183], v93, s[4:7], s88 offen sc1
    buffer_store_dwordx4 v[144:147], v95, s[4:7], s34 offen sc1
    buffer_store_dwordx4 v[8:11], v94, s[4:7], s36 offen sc1
    v_add_u32 v189, 1, v189
    s_add_u32 s88, s88, 65536
    s_cmp_eq_u32 s31, 3
    s_cselect_b32 s88, s35, s88
    s_waitcnt vmcnt(6)
    s_cmp_lg_u32 s31, 3
    s_cbranch_scc1 rec_loop_12
    s_add_u32 s40, s55, 128
rec_tk_29:
    s_load_dwordx8 s[72:79], s[90:91], s40 glc
    s_add_u32 s41, s41, 1
    s_cmp_ge_u32 s41, 0x80000
    s_cbranch_scc1 rec_tkd_30
    s_sleep 1
    s_min_u32 s38, s72, s76
    s_cmp_lt_u32 s38, s54
    s_cbranch_scc1 rec_tk_29
rec_tkd_30:
    s_add_u32 s54, s54, 1
    s_sleep 1
    s_branch rec_loop_12
rec_kv_9:
    s_load_dword s94, s[90:91], s95 glc
    s_add_u32 s41, s41, 1
    s_cmp_ge_u32 s41, 0x80000
    s_cbranch_scc1 rec_kvd_10
    s_waitcnt lgkmcnt(0)
    s_cmp_gt_u32 s94, 0
    s_cbranch_scc1 rec_kvd_10
    s_sleep 2
    s_branch rec_kv_9
rec_gafix_15:
    s_add_u32 s41, s41, 1
    s_cmp_ge_u32 s41, 0x80000
    s_cbranch_scc1 rec_gaok_14
    buffer_load_dwordx4 v[36:39], v7, s[4:7], s33 offen sc1
    buffer_load_dwordx4 v[40:43], v12, s[4:7], s33 offen sc1
    buffer_load_dwordx4 v[44:47], v142, s[4:7], s33 offen sc1
    buffer_load_dwordx4 v[48:51], v143, s[4:7], s33 offen sc1
    v_mov_b32 v68, 0
    v_mov_b32 v69, 0
    v_mov_b32 v70, 0
    v_mov_b32 v71, 0
    v_mov_b32 v72, 0
    v_mov_b32 v73, 0
    v_mov_b32 v74, 0
    v_mov_b32 v75, 0
    v_mov_b32 v76, 0
    v_mov_b32 v77, 0
    v_mov_b32 v78, 0
    v_mov_b32 v79, 0
    v_mov_b32 v80, 0
    v_mov_b32 v81, 0
    v_mov_b32 v82, 0
    v_mov_b32 v83, 0
    s_waitcnt vmcnt(3)
    v_smfmac_f32_16x16x64_bf16 v[68:71], v[36:39], a[0:7], v5
    v_min_u32 v31, v36, v37
    v_smfmac_f32_16x16x64_bf16 v[72:75], v[36:39], a[8:15], v5
    v_min_u32 v4, v38, v39
    v_smfmac_f32_16x16x64_bf16 v[76:79], v[36:39], a[16:23], v5
    v_smfmac_f32_16x16x64_bf16 v[80:83], v[36:39], a[24:31], v5
    s_waitcnt vmcnt(2)
    v_smfmac_f32_16x16x64_bf16 v[68:71], v[40:43], a[48:55], v5
    v_min3_u32 v31, v31, v40, v41
    v_smfmac_f32_16x16x64_bf16 v[72:75], v[40:43], a[56:63], v5
    v_min3_u32 v4, v4, v42, v43
    v_smfmac_f32_16x16x64_bf16 v[76:79], v[40:43], a[64:71], v5
    v_smfmac_f32_16x16x64_bf16 v[80:83], v[40:43], a[72:79], v5
    s_waitcnt vmcnt(1)
    v_smfmac_f32_16x16x64_bf16 v[68:71], v[44:47], a[96:103], v5
    v_min3_u32 v31, v31, v44, v45
    v_smfmac_f32_16x16x64_bf16 v[72:75], v[44:47], a[104:111], v5
    v_min3_u32 v4, v4, v46, v47
    v_smfmac_f32_16x16x64_bf16 v[76:79], v[44:47], a[112:119], v5
    v_min_u32 v31, v31, v4
    v_smfmac_f32_16x16x64_bf16 v[80:83], v[44:47], a[120:127], v5
    s_waitcnt vmcnt(0)
    v_min3_u32 v31, v31, v48, v49
    v_smfmac_f32_16x16x64_bf16 v[68:71], v[48:51], a[144:151], v5
    v_min3_u32 v31, v31, v50, v51
    v_smfmac_f32_16x16x64_bf16 v[72:75], v[48:51], a[152:159], v5
    v_cmp_eq_u32 vcc, 0, v31
    v_smfmac_f32_16x16x64_bf16 v[76:79], v[48:51], a[160:167], v5
    v_smfmac_f32_16x16x64_bf16 v[80:83], v[48:51], a[168:175], v5
    s_cbranch_vccnz rec_gafix_15
    s_branch rec_gaok_14
rec_slow_18:
    s_mov_b64 exec, s[42:43]
    buffer_store_dwordx4 v[68:71], v19, s[4:7], s36 offen sc1
    buffer_store_dwordx4 v[72:75], v19, s[4:7], s36 offen offset:128 sc1
    s_mov_b64 exec, s[46:47]
    buffer_store_dwordx4 v[76:79], v20, s[4:7], s36 offen offset:1024 sc1
    s_mov_b64 exec, -1
    s_branch rec_slowr_19
rec_gbr_20:
    v_max3_u32 v31, v164, v165, v166
    v_max3_u32 v31, v31, v167, v168
    v_max3_u32 v31, v31, v169, v170
    v_max3_u32 v31, v31, v171, v172
    v_max3_u32 v31, v31, v173, v174
    v_max3_u32 v31, v31, v175, v176
    v_max3_u32 v31, v31, v177, v178
    v_max_u32 v31, v31, v179
    buffer_load_dwordx4 v[176:179], v21, s[4:7], s36 offen offset:1024 sc1
    buffer_load_dwordx4 v[164:167], v22, s[4:7], s36 offen sc1
    buffer_load_dwordx4 v[168:171], v23, s[4:7], s36 offen sc1
    buffer_load_dwordx4 v[172:175], v24, s[4:7], s36 offen sc1
    v_cmp_eq_u32 vcc, -1, v31
    s_add_u32 s41, s41, 1
    s_cmp_ge_u32 s41, 0x80000
    s_cbranch_scc1 rec_gbo_21
    s_cbranch_vccz rec_gbo_21
    s_waitcnt vmcnt(7)
    v_permlane32_swap_b32 v48, v50
    v_permlane32_swap_b32 v49, v51
    v_pk_add_f32 v[124:125], v[48:49], v[50:51]
    s_waitcnt vmcnt(6)
    v_pk_add_f32 v[120:121], v[68:69], v[36:37]
    v_pk_add_f32 v[122:123], v[70:71], v[38:39]
    v_permlane16_swap_b32 v124, v125
    s_waitcnt vmcnt(5)
    v_pk_add_f32 v[120:121], v[120:121], v[40:41]
    v_pk_add_f32 v[122:123], v[122:123], v[42:43]
    v_add_f32 v124, v124, v125
    s_waitcnt vmcnt(4)
    v_pk_add_f32 v[120:121], v[120:121], v[44:45]
    v_pk_add_f32 v[122:123], v[122:123], v[46:47]
    v_maximum3_f32 v135, v120, v121, v124
    v_maximum3_f32 v135, v135, v122, v123
    v_cmp_u_f32 vcc, v135, v135
    s_nop 0
    v_max_f32_dpp v135, v135, v135 row_ror:8 row_mask:0xf bank_mask:0xf
    v_mov_b32 v136, v135
    s_cbranch_vccz rec_gbo_21
    v_max3_u32 v31, v36, v37, v38
    v_max3_u32 v31, v31, v39, v40
    v_max3_u32 v31, v31, v41, v42
    v_max3_u32 v31, v31, v43, v44
    v_max3_u32 v31, v31, v45, v46
    v_max3_u32 v31, v31, v47, v48
    v_max3_u32 v31, v31, v49, v50
    v_max_u32 v31, v31, v51
    buffer_load_dwordx4 v[48:51], v21, s[4:7], s36 offen offset:1024 sc1
    buffer_load_dwordx4 v[36:39], v22, s[4:7], s36 offen sc1
    buffer_load_dwordx4 v[40:43], v23, s[4:7], s36 offen sc1
    buffer_load_dwordx4 v[44:47], v24, s[4:7], s36 offen sc1
    v_cmp_eq_u32 vcc, -1, v31
    s_add_u32 s41, s41, 1
    s_cmp_ge_u32 s41, 0x80000
    s_cbranch_scc1 rec_gbo_21
    s_cbranch_vccz rec_gbo_21
    s_waitcnt vmcnt(7)
    v_permlane32_swap_b32 v176, v178
    v_permlane32_swap_b32 v177, v179
    v_pk_add_f32 v[124:125], v[176:177], v[178:179]
    s_waitcnt vmcnt(6)
    v_pk_add_f32 v[120:121], v[68:69], v[164:165]
    v_pk_add_f32 v[122:123], v[70:71], v[166:167]
    v_permlane16_swap_b32 v124, v125
    s_waitcnt vmcnt(5)
    v_pk_add_f32 v[120:121], v[120:121], v[168:169]
    v_pk_add_f32 v[122:123], v[122:123], v[170:171]
    v_add_f32 v124, v124, v125
    s_waitcnt vmcnt(4)
    v_pk_add_f32 v[120:121], v[120:121], v[172:173]
    v_pk_add_f32 v[122:123], v[122:123], v[174:175]
    v_maximum3_f32 v135, v120, v121, v124
    v_maximum3_f32 v135, v135, v122, v123
    v_cmp_u_f32 vcc, v135, v135
    s_nop 0
    v_max_f32_dpp v135, v135, v135 row_ror:8 row_mask:0xf bank_mask:0xf
    v_mov_b32 v136, v135
    s_cbranch_vccz rec_gbo_21
    s_branch rec_gbr_20
rec_w1_17:
    s_waitcnt lgkmcnt(0)
    s_barrier
    v_smfmac_f32_16x16x64_bf16 v[84:87], v[36:39], a[32:39], v5
    v_smfmac_f32_16x16x64_bf16 v[88:91], v[36:39], a[40:47], v5
    v_smfmac_f32_16x16x64_bf16 v[84:87], v[40:43], a[80:87], v5
    v_smfmac_f32_16x16x64_bf16 v[88:91], v[40:43], a[88:95], v5
    v_smfmac_f32_16x16x64_bf16 v[84:87], v[44:47], a[128:135], v5
    v_smfmac_f32_16x16x64_bf16 v[88:91], v[44:47], a[136:143], v5
    v_smfmac_f32_16x16x64_bf16 v[84:87], v[48:51], a[176:183], v5
    v_smfmac_f32_16x16x64_bf16 v[88:91], v[48:51], a[184:191], v5
    s_nop 7
    v_permlane16_swap_b32 v84, v88
    v_permlane16_swap_b32 v85, v89
    v_permlane16_swap_b32 v86, v90
    v_permlane16_swap_b32 v87, v91
    v_pk_add_f32 v[84:85], v[84:85], v[88:89]
    v_pk_add_f32 v[86:87], v[86:87], v[90:91]
    ds_write_b128 v17, v[84:87]
    s_waitcnt lgkmcnt(0)
    s_barrier
    v_mov_b32 v68, 0
    v_mov_b32 v69, 0
    v_mov_b32 v70, 0
    v_mov_b32 v71, 0
    v_mov_b32 v72, 0
    v_mov_b32 v73, 0
    v_mov_b32 v74, 0
    v_mov_b32 v75, 0
    s_cmp_eq_u32 s31, 3
    s_cbranch_scc1 rec_w3_32
    s_cmp_eq_u32 s31, 2
    s_cbranch_scc1 rec_w2_31
    ds_read_b128 v[180:183], v16 offset:15360
    s_branch rec_b2_16
rec_w2_31:
    ds_read_b128 v[100:103], v16 offset:10240
    ds_read_b128 v[104:107], v16 offset:11264
    ds_read_b128 v[108:111], v16 offset:12288
    ds_read_b128 v[112:115], v16 offset:13312
    s_waitcnt lgkmcnt(0)
    v_pk_add_f32 v[100:101], v[100:101], v[104:105]
    v_pk_add_f32 v[102:103], v[102:103], v[106:107]
    v_pk_add_f32 v[108:109], v[108:109], v[112:113]
    v_pk_add_f32 v[110:111], v[110:111], v[114:115]
    v_pk_add_f32 v[100:101], v[100:101], v[108:109]
    v_pk_add_f32 v[102:103], v[102:103], v[110:111]
    v_cvt_pk_bf16_f32 v180, v100, v101
    v_cvt_pk_bf16_f32 v181, v102, v103
    s_nop 0
    v_permlane32_swap_b32 v180, v182
    v_permlane32_swap_b32 v181, v183
rec_b2_16:
    s_waitcnt lgkmcnt(0)
    s_cmp_eq_u32 s32, 63
    s_cbranch_scc1 rec_done_13
    s_branch rec_cs_23
rec_w3_32:
    s_cmp_eq_u32 s32, 63
    s_cbranch_scc1 rec_done_13
rec_tk_33:
    s_load_dwordx8 s[72:79], s[90:91], s55 glc
    s_add_u32 s41, s41, 1
    s_cmp_ge_u32 s41, 0x80000
    s_cbranch_scc1 rec_tkd_34
    s_sleep 1
    s_min_u32 s38, s72, s76
    s_cmp_lt_u32 s38, s54
    s_cbranch_scc1 rec_tk_33
rec_tkd_34:
    s_add_u32 s54, s54, 1
    s_sleep 1
    s_branch rec_cs_23
rec_kv_26:
    s_load_dword s94, s[90:91], s95 glc
    s_add_u32 s41, s41, 1
    s_cmp_ge_u32 s41, 0x80000
    s_cbranch_scc1 rec_kvd_27
    s_waitcnt lgkmcnt(0)
    s_cmp_gt_u32 s94, s38
    s_cbranch_scc1 rec_kvd_27
    s_sleep 2
    s_branch rec_kv_26
rec_gcfix_25:
    s_add_u32 s41, s41, 1
    s_cmp_ge_u32 s41, 0x80000
    s_cbranch_scc1 rec_gcok_24
    buffer_load_dwordx4 v[36:39], v13, s[4:7], s33 offen sc1
    buffer_load_dwordx4 v[40:43], v137, s[4:7], s33 offen sc1
    buffer_load_dwordx4 v[44:47], v184, s[4:7], s33 offen sc1
    buffer_load_dwordx4 v[48:51], v185, s[4:7], s33 offen sc1
    buffer_load_dwordx4 v[52:55], v186, s[4:7], s33 offen sc1
    buffer_load_dwordx4 v[56:59], v187, s[4:7], s33 offen sc1
    buffer_load_dwordx4 v[60:63], v190, s[4:7], s33 offen sc1
    buffer_load_dwordx4 v[64:67], v191, s[4:7], s33 offen sc1
    v_mov_b32 v68, 0
    v_mov_b32 v69, 0
    v_mov_b32 v70, 0
    v_mov_b32 v71, 0
    v_mov_b32 v72, 0
    v_mov_b32 v73, 0
    v_mov_b32 v74, 0
    v_mov_b32 v75, 0
    s_waitcnt vmcnt(7)
    v_smfmac_f32_16x16x64_bf16 v[68:71], v[36:39], a[192:199], v5
    v_min_u32 v31, v36, v37
    v_smfmac_f32_16x16x64_bf16 v[72:75], v[36:39], a[200:207], v5
    v_min_u32 v4, v38, v39
    s_waitcnt vmcnt(6)
    v_smfmac_f32_16x16x64_bf16 v[68:71], v[40:43], a[208:215], v5
    v_min3_u32 v31, v31, v40, v41
    v_smfmac_f32_16x16x64_bf16 v[72:75], v[40:43], a[216:223], v5
    v_min3_u32 v4, v4, v42, v43
    s_waitcnt vmcnt(5)
    v_smfmac_f32_16x16x64_bf16 v[68:71], v[44:47], a[224:231], v5
    v_min3_u32 v31, v31, v44, v45
    v_smfmac_f32_16x16x64_bf16 v[72:75], v[44:47], a[232:239], v5
    v_min3_u32 v4, v4, v46, v47
    s_waitcnt vmcnt(4)
    v_smfmac_f32_16x16x64_bf16 v[68:71], v[48:51], a[240:247], v5
    v_min3_u32 v31, v31, v48, v49
    v_smfmac_f32_16x16x64_bf16 v[72:75], v[48:51], a[248:255], v5
    v_min3_u32 v4, v4, v50, v51
    s_waitcnt vmcnt(3)
    v_smfmac_f32_16x16x64_bf16 v[68:71], v[52:55], v[192:199], v5
    v_min3_u32 v31, v31, v52, v53
    v_smfmac_f32_16x16x64_bf16 v[72:75], v[52:55], v[200:207], v5
    v_min3_u32 v4, v4, v54, v55
    s_waitcnt vmcnt(2)
    v_smfmac_f32_16x16x64_bf16 v[68:71], v[56:59], v[208:215], v5
    v_min3_u32 v31, v31, v56, v57
    v_smfmac_f32_16x16x64_bf16 v[72:75], v[56:59], v[216:223], v5
    v_min3_u32 v4, v4, v58, v59
    s_waitcnt vmcnt(1)
    v_smfmac_f32_16x16x64_bf16 v[68:71], v[60:63], v[224:231], v5
    v_min3_u32 v31, v31, v60, v61
    v_smfmac_f32_16x16x64_bf16 v[72:75], v[60:63], v[232:239], v5
    v_min3_u32 v4, v4, v62, v63
    v_min_u32 v31, v31, v4
    s_waitcnt vmcnt(0)
    v_min3_u32 v31, v31, v64, v65
    v_smfmac_f32_16x16x64_bf16 v[68:71], v[64:67], v[240:247], v5
    v_min3_u32 v31, v31, v66, v67
    v_smfmac_f32_16x16x64_bf16 v[72:75], v[64:67], v[248:255], v5
    v_cmp_eq_u32 vcc, 0, v31
    s_cbranch_vccnz rec_gcfix_25
    s_branch rec_gcok_24
rec_done_13:
    buffer_store_dwordx4 v[180:183], v93, s[4:7], s88 offen sc1
    s_waitcnt vmcnt(0)
    s_barrier
    v_add_u32 v189, 1, v189
    buffer_store_dword v189, v188, s[4:7], 0 offen sc1
    s_endpgm
L_gem:
    s_load_dwordx2 s[90:91], s[0:1], 96
    s_load_dwordx2 s[92:93], s[0:1], 88
    v_and_b32 v1, 63, v0
    v_lshrrev_b32 v2, 6, v0
    s_nop 0
    v_readfirstlane_b32 s29, v2
    v_lshlrev_b32 v5, 4, v1
    s_mov_b32 s41, 0
    s_lshl_b32 s34, s29, 10
    s_waitcnt lgkmcnt(0)
    s_mov_b32 s4, s90
    s_and_b32 s5, s91, 0xffff
    s_mov_b32 s6, 268435456
    s_mov_b32 s7, 0x00020000
    s_cmp_ge_u32 s28, 120
    s_cbranch_scc1 L_att
    s_cmp_ge_u32 s28, 96
    s_cbranch_scc1 sl_b_35
    s_lshr_b32 s31, s28, 5
    s_add_u32 s31, s31, 1
    s_cmp_eq_u32 s31, 3
    s_cselect_b32 s44, 0, s31
    s_lshl_b32 s31, s44, 3
    s_add_u32 s31, s31, 16
    s_load_dwordx2 s[72:73], s[0:1], s31
    s_load_dwordx2 s[74:75], s[0:1], 0
    s_mov_b32 s76, 8388608
    s_mov_b32 s39, 8192
    s_and_b32 s31, s28, 31
    s_lshl_b32 s31, s31, 8
    s_lshl_b32 s36, s44, 24
    s_and_b32 s33, s28, 31
    s_lshl_b32 s33, s33, 13
    s_add_u32 s36, s36, s33
    s_mov_b32 s37, 262144
    s_and_b32 s50, s28, 31
    s_lshl_b32 s50, s50, 7
    s_lshl_b32 s33, s44, 2
    s_add_u32 s50, s50, s33
    s_add_u32 s50, s50, 115343360
    s_branch sl_c_36
sl_b_35:
    s_sub_u32 s32, s28, 96
    s_lshr_b32 s44, s32, 3
    s_load_dwordx2 s[72:73], s[0:1], 64
    s_load_dwordx2 s[74:75], s[0:1], 56
    s_mov_b32 s76, 6291456
    s_mov_b32 s39, 6144
    s_lshl_b32 s31, s32, 8
    s_lshl_b32 s36, s44, 22
    s_and_b32 s33, s32, 7
    s_lshl_b32 s33, s33, 13
    s_add_u32 s36, s36, s33
    s_add_u32 s36, s36, 50331648
    s_mov_b32 s37, 65536
    s_and_b32 s50, s32, 7
    s_lshl_b32 s50, s50, 7
    s_lshl_b32 s33, s44, 2
    s_add_u32 s50, s50, s33
    s_add_u32 s50, s50, 115347456
sl_c_36:
    s_waitcnt lgkmcnt(0)
    s_cmp_lg_u32 s29, 0
    s_cbranch_scc1 sl_i_37
    v_mov_b32 v2, 0
    s_mov_b64 exec, 1
    buffer_store_dword v2, v2, s[4:7], s50 offen sc1
    s_mov_b64 exec, -1
sl_i_37:
    s_mov_b32 s8, s72
    s_and_b32 s9, s73, 0xffff
    s_mov_b32 s10, s76
    s_mov_b32 s11, 0x00020000
    s_mov_b32 s12, s74
    s_and_b32 s13, s75, 0xffff
    s_mov_b32 s14, 4194304
    s_mov_b32 s15, 0x00020000
    s_mov_b64 s[80:81], s[72:73]
    s_mov_b32 s45, s31
    s_cmp_lt_u32 s28, 96
    s_cbranch_scc1 sl_go_38
    s_cmp_lg_u32 s29, 0
    s_cbranch_scc1 sl_a2_39
    s_mov_b64 exec, 1
    v_mov_b32 v2, 0
    v_mov_b32 v3, 1
    s_waitcnt vmcnt(0)
    global_atomic_add v2, v3, s[92:93] offset:0 sc1
    s_mov_b64 exec, -1
sl_a2_39:
    s_cmp_lt_u32 s28, 96
    s_cbranch_scc1 tw_skip_40
    s_load_dwordx2 s[72:73], s[0:1], 40
    s_and_b32 s31, s28, 31
    s_lshl_b32 s31, s31, 13
    s_lshl_b32 s33, s29, 21
    s_add_u32 s31, s31, s33
    v_lshl_add_u32 v2, v1, 7, s31
    s_waitcnt lgkmcnt(0)
    s_mov_b32 s8, s72
    s_and_b32 s9, s73, 0xffff
    s_mov_b32 s10, 8388608
    s_mov_b32 s11, 0x00020000
    s_mov_b32 s31, 0
    buffer_load_dword v128, v2, s[8:11], s31 offen
    s_mov_b32 s31, 262144
    buffer_load_dword v129, v2, s[8:11], s31 offen
    s_mov_b32 s31, 524288
    buffer_load_dword v130, v2, s[8:11], s31 offen
    s_mov_b32 s31, 786432
    buffer_load_dword v131, v2, s[8:11], s31 offen
    s_mov_b32 s31, 1048576
    buffer_load_dword v132, v2, s[8:11], s31 offen
    s_mov_b32 s31, 1310720
    buffer_load_dword v133, v2, s[8:11], s31 offen
    s_mov_b32 s31, 1572864
    buffer_load_dword v134, v2, s[8:11], s31 offen
    s_mov_b32 s31, 1835008
    buffer_load_dword v135, v2, s[8:11], s31 offen
tw_skip_40:
    s_mov_b32 s8, s80
    s_and_b32 s9, s81, 0xffff
    s_mov_b32 s10, s76
    s_mov_b32 s11, 0x00020000
    s_cmp_lg_u32 s29, 0
    s_cbranch_scc1 g_wdd_42
g_wd_41:
    s_load_dword s84, s[92:93], 128 glc
    s_add_u32 s41, s41, 1
    s_cmp_ge_u32 s41, 0x200000
    s_cbranch_scc1 g_wdd_42
    s_waitcnt lgkmcnt(0)
    s_and_b32 s84, s84, 0xffff
    s_cmp_ge_u32 s84, 96
    s_cbranch_scc1 g_wdd_42
    s_sleep 32
    s_branch g_wd_41
g_wdd_42:
    s_waitcnt lgkmcnt(0)
    s_barrier
sl_go_38:
    v_lshrrev_b32 v2, 2, v1
    v_mul_lo_u32 v6, v2, s39
    s_mov_b32 s31, s45
    s_lshl_b32 s33, s29, 6
    s_add_u32 s31, s31, s33
    v_and_b32 v2, 3, v1
    v_lshlrev_b32 v2, 4, v2
    v_add_u32 v2, s31, v2
    v_add_u32 v6, v6, v2
    s_lshl_b32 s39, s39, 4
    s_mov_b32 s30, 0
    s_mov_b32 s51, 64
    s_mov_b32 s52, 4128768
    s_lshl_b32 s31, s29, 15
    v_lshrrev_b32 v7, 4, v1
    v_lshlrev_b32 v7, 9, v7
    v_bfe_u32 v4, v1, 2, 2
    v_lshl_add_u32 v7, v4, 6, v7
    v_bfe_u32 v4, v1, 1, 1
    v_lshl_add_u32 v7, v4, 5, v7
    v_and_b32 v4, 1, v1
    v_lshl_add_u32 v7, v4, 3, v7
    v_add_u32 v7, s31, v7
    s_lshl_b32 s32, s29, 15
    s_add_u32 m0, s32, 0
    s_mov_b32 s38, 0
    buffer_load_dwordx4 v6, s[8:11], s38 offen lds
    s_add_u32 m0, s32, 1024
    s_add_u32 s38, s38, s39
    buffer_load_dwordx4 v6, s[8:11], s38 offen lds
    s_add_u32 m0, s32, 2048
    s_add_u32 s38, s38, s39
    buffer_load_dwordx4 v6, s[8:11], s38 offen lds
    s_add_u32 m0, s32, 3072
    s_add_u32 s38, s38, s39
    buffer_load_dwordx4 v6, s[8:11], s38 offen lds
    s_add_u32 m0, s32, 4096
    s_add_u32 s38, s38, s39
    buffer_load_dwordx4 v6, s[8:11], s38 offen lds
    s_add_u32 m0, s32, 5120
    s_add_u32 s38, s38, s39
    buffer_load_dwordx4 v6, s[8:11], s38 offen lds
    s_add_u32 m0, s32, 6144
    s_add_u32 s38, s38, s39
    buffer_load_dwordx4 v6, s[8:11], s38 offen lds
    s_add_u32 m0, s32, 7168
    s_add_u32 s38, s38, s39
    buffer_load_dwordx4 v6, s[8:11], s38 offen lds
    s_add_u32 m0, s32, 8192
    s_add_u32 s38, s38, s39
    buffer_load_dwordx4 v6, s[8:11], s38 offen lds
    s_add_u32 m0, s32, 9216
    s_add_u32 s38, s38, s39
    buffer_load_dwordx4 v6, s[8:11], s38 offen lds
    s_add_u32 m0, s32, 10240
    s_add_u32 s38, s38, s39
    buffer_load_dwordx4 v6, s[8:11], s38 offen lds
    s_add_u32 m0, s32, 11264
    s_add_u32 s38, s38, s39
    buffer_load_dwordx4 v6, s[8:11], s38 offen lds
    s_add_u32 m0, s32, 12288
    s_add_u32 s38, s38, s39
    buffer_load_dwordx4 v6, s[8:11], s38 offen lds
    s_add_u32 m0, s32, 13312
    s_add_u32 s38, s38, s39
    buffer_load_dwordx4 v6, s[8:11], s38 offen lds
    s_add_u32 m0, s32, 14336
    s_add_u32 s38, s38, s39
    buffer_load_dwordx4 v6, s[8:11], s38 offen lds
    s_add_u32 m0, s32, 15360
    s_add_u32 s38, s38, s39
    buffer_load_dwordx4 v6, s[8:11], s38 offen lds
    s_add_u32 m0, s32, 16384
    s_add_u32 s38, s38, s39
    buffer_load_dwordx4 v6, s[8:11], s38 offen lds
    s_add_u32 m0, s32, 17408
    s_add_u32 s38, s38, s39
    buffer_load_dwordx4 v6, s[8:11], s38 offen lds
    s_add_u32 m0, s32, 18432
    s_add_u32 s38, s38, s39
    buffer_load_dwordx4 v6, s[8:11], s38 offen lds
    s_add_u32 m0, s32, 19456
    s_add_u32 s38, s38, s39
    buffer_load_dwordx4 v6, s[8:11], s38 offen lds
    s_add_u32 m0, s32, 20480
    s_add_u32 s38, s38, s39
    buffer_load_dwordx4 v6, s[8:11], s38 offen lds
    s_add_u32 m0, s32, 21504
    s_add_u32 s38, s38, s39
    buffer_load_dwordx4 v6, s[8:11], s38 offen lds
    s_add_u32 m0, s32, 22528
    s_add_u32 s38, s38, s39
    buffer_load_dwordx4 v6, s[8:11], s38 offen lds
    s_add_u32 m0, s32, 23552
    s_add_u32 s38, s38, s39
    buffer_load_dwordx4 v6, s[8:11], s38 offen lds
    s_add_u32 m0, s32, 24576
    s_add_u32 s38, s38, s39
    buffer_load_dwordx4 v6, s[8:11], s38 offen lds
    s_add_u32 m0, s32, 25600
    s_add_u32 s38, s38, s39
    buffer_load_dwordx4 v6, s[8:11], s38 offen lds
    s_add_u32 m0, s32, 26624
    s_add_u32 s38, s38, s39
    buffer_load_dwordx4 v6, s[8:11], s38 offen lds
    s_add_u32 m0, s32, 27648
    s_add_u32 s38, s38, s39
    buffer_load_dwordx4 v6, s[8:11], s38 offen lds
    s_add_u32 m0, s32, 28672
    s_add_u32 s38, s38, s39
    buffer_load_dwordx4 v6, s[8:11], s38 offen lds
    s_add_u32 m0, s32, 29696
    s_add_u32 s38, s38, s39
    buffer_load_dwordx4 v6, s[8:11], s38 offen lds
    s_add_u32 m0, s32, 30720
    s_add_u32 s38, s38, s39
    buffer_load_dwordx4 v6, s[8:11], s38 offen lds
    s_add_u32 m0, s32, 31744
    s_add_u32 s38, s38, s39
    buffer_load_dwordx4 v6, s[8:11], s38 offen lds
    s_waitcnt vmcnt(30)
    s_cmp_lg_u32 s29, 0
    s_cbranch_scc1 sl_ar_43
    s_cmp_ge_u32 s28, 96
    s_cbranch_scc1 sl_ar_43
    s_mov_b64 exec, 1
    v_mov_b32 v2, 0
    v_mov_b32 v3, 1
    global_atomic_add v2, v3, s[92:93] offset:0 sc1
    s_mov_b64 exec, -1
sl_ar_43:
    ds_read_b64_tr_b16 a[0:1], v7 offset:0
    ds_read_b64_tr_b16 a[2:3], v7 offset:256
    ds_read_b64_tr_b16 a[4:5], v7 offset:16
    ds_read_b64_tr_b16 a[6:7], v7 offset:272
    s_waitcnt vmcnt(28)
    ds_read_b64_tr_b16 a[8:9], v7 offset:2048
    ds_read_b64_tr_b16 a[10:11], v7 offset:2304
    ds_read_b64_tr_b16 a[12:13], v7 offset:2064
    ds_read_b64_tr_b16 a[14:15], v7 offset:2320
    s_waitcnt lgkmcnt(4)
    s_add_u32 m0, s32, 0
    s_add_u32 s38, s38, s39
    buffer_load_dwordx4 v6, s[8:11], s38 offen lds
    s_add_u32 m0, s32, 1024
    s_add_u32 s38, s38, s39
    buffer_load_dwordx4 v6, s[8:11], s38 offen lds
    s_waitcnt vmcnt(28)
    ds_read_b64_tr_b16 a[16:17], v7 offset:4096
    ds_read_b64_tr_b16 a[18:19], v7 offset:4352
    ds_read_b64_tr_b16 a[20:21], v7 offset:4112
    ds_read_b64_tr_b16 a[22:23], v7 offset:4368
    s_waitcnt lgkmcnt(4)
    s_add_u32 m0, s32, 2048
    s_add_u32 s38, s38, s39
    buffer_load_dwordx4 v6, s[8:11], s38 offen lds
    s_add_u32 m0, s32, 3072
    s_add_u32 s38, s38, s39
    buffer_load_dwordx4 v6, s[8:11], s38 offen lds
    s_waitcnt vmcnt(28)
    ds_read_b64_tr_b16 a[24:25], v7 offset:6144
    ds_read_b64_tr_b16 a[26:27], v7 offset:6400
    ds_read_b64_tr_b16 a[28:29], v7 offset:6160
    ds_read_b64_tr_b16 a[30:31], v7 offset:6416
    s_waitcnt lgkmcnt(4)
    s_add_u32 m0, s32, 4096
    s_add_u32 s38, s38, s39
    buffer_load_dwordx4 v6, s[8:11], s38 offen lds
    s_add_u32 m0, s32, 5120
    s_add_u32 s38, s38, s39
    buffer_load_dwordx4 v6, s[8:11], s38 offen lds
    s_waitcnt vmcnt(28)
    ds_read_b64_tr_b16 a[32:33], v7 offset:8192
    ds_read_b64_tr_b16 a[34:35], v7 offset:8448
    ds_read_b64_tr_b16 a[36:37], v7 offset:8208
    ds_read_b64_tr_b16 a[38:39], v7 offset:8464
    s_waitcnt lgkmcnt(4)
    s_add_u32 m0, s32, 6144
    s_add_u32 s38, s38, s39
    buffer_load_dwordx4 v6, s[8:11], s38 offen lds
    s_add_u32 m0, s32, 7168
    s_add_u32 s38, s38, s39
    buffer_load_dwordx4 v6, s[8:11], s38 offen lds
    s_waitcnt vmcnt(28)
    ds_read_b64_tr_b16 a[40:41], v7 offset:10240
    ds_read_b64_tr_b16 a[42:43], v7 offset:10496
    ds_read_b64_tr_b16 a[44:45], v7 offset:10256
    ds_read_b64_tr_b16 a[46:47], v7 offset:10512
    s_waitcnt lgkmcnt(4)
    s_add_u32 m0, s32, 8192
    s_add_u32 s38, s38, s39
    buffer_load_dwordx4 v6, s[8:11], s38 offen lds
    s_add_u32 m0, s32, 9216
    s_add_u32 s38, s38, s39
    buffer_load_dwordx4 v6, s[8:11], s38 offen lds
    s_waitcnt vmcnt(28)
    ds_read_b64_tr_b16 a[48:49], v7 offset:12288
    ds_read_b64_tr_b16 a[50:51], v7 offset:12544
    ds_read_b64_tr_b16 a[52:53], v7 offset:12304
    ds_read_b64_tr_b16 a[54:55], v7 offset:12560
    s_waitcnt lgkmcnt(4)
    s_add_u32 m0, s32, 10240
    s_add_u32 s38, s38, s39
    buffer_load_dwordx4 v6, s[8:11], s38 offen lds
    s_add_u32 m0, s32, 11264
    s_add_u32 s38, s38, s39
    buffer_load_dwordx4 v6, s[8:11], s38 offen lds
    s_waitcnt vmcnt(28)
    ds_read_b64_tr_b16 a[56:57], v7 offset:14336
    ds_read_b64_tr_b16 a[58:59], v7 offset:14592
    ds_read_b64_tr_b16 a[60:61], v7 offset:14352
    ds_read_b64_tr_b16 a[62:63], v7 offset:14608
    s_waitcnt lgkmcnt(4)
    s_add_u32 m0, s32, 12288
    s_add_u32 s38, s38, s39
    buffer_load_dwordx4 v6, s[8:11], s38 offen lds
    s_add_u32 m0, s32, 13312
    s_add_u32 s38, s38, s39
    buffer_load_dwordx4 v6, s[8:11], s38 offen lds
    s_waitcnt vmcnt(28)
    ds_read_b64_tr_b16 a[64:65], v7 offset:16384
    ds_read_b64_tr_b16 a[66:67], v7 offset:16640
    ds_read_b64_tr_b16 a[68:69], v7 offset:16400
    ds_read_b64_tr_b16 a[70:71], v7 offset:16656
    s_waitcnt lgkmcnt(4)
    s_add_u32 m0, s32, 14336
    s_add_u32 s38, s38, s39
    buffer_load_dwordx4 v6, s[8:11], s38 offen lds
    s_add_u32 m0, s32, 15360
    s_add_u32 s38, s38, s39
    buffer_load_dwordx4 v6, s[8:11], s38 offen lds
    s_waitcnt vmcnt(28)
    ds_read_b64_tr_b16 a[72:73], v7 offset:18432
    ds_read_b64_tr_b16 a[74:75], v7 offset:18688
    ds_read_b64_tr_b16 a[76:77], v7 offset:18448
    ds_read_b64_tr_b16 a[78:79], v7 offset:18704
    s_waitcnt lgkmcnt(4)
    s_add_u32 m0, s32, 16384
    s_add_u32 s38, s38, s39
    buffer_load_dwordx4 v6, s[8:11], s38 offen lds
    s_add_u32 m0, s32, 17408
    s_add_u32 s38, s38, s39
    buffer_load_dwordx4 v6, s[8:11], s38 offen lds
    s_waitcnt vmcnt(28)
    ds_read_b64_tr_b16 a[80:81], v7 offset:20480
    ds_read_b64_tr_b16 a[82:83], v7 offset:20736
    ds_read_b64_tr_b16 a[84:85], v7 offset:20496
    ds_read_b64_tr_b16 a[86:87], v7 offset:20752
    s_waitcnt lgkmcnt(4)
    s_add_u32 m0, s32, 18432
    s_add_u32 s38, s38, s39
    buffer_load_dwordx4 v6, s[8:11], s38 offen lds
    s_add_u32 m0, s32, 19456
    s_add_u32 s38, s38, s39
    buffer_load_dwordx4 v6, s[8:11], s38 offen lds
    s_waitcnt vmcnt(28)
    ds_read_b64_tr_b16 a[88:89], v7 offset:22528
    ds_read_b64_tr_b16 a[90:91], v7 offset:22784
    ds_read_b64_tr_b16 a[92:93], v7 offset:22544
    ds_read_b64_tr_b16 a[94:95], v7 offset:22800
    s_waitcnt lgkmcnt(4)
    s_add_u32 m0, s32, 20480
    s_add_u32 s38, s38, s39
    buffer_load_dwordx4 v6, s[8:11], s38 offen lds
    s_add_u32 m0, s32, 21504
    s_add_u32 s38, s38, s39
    buffer_load_dwordx4 v6, s[8:11], s38 offen lds
    s_waitcnt vmcnt(28)
    ds_read_b64_tr_b16 a[96:97], v7 offset:24576
    ds_read_b64_tr_b16 a[98:99], v7 offset:24832
    ds_read_b64_tr_b16 a[100:101], v7 offset:24592
    ds_read_b64_tr_b16 a[102:103], v7 offset:24848
    s_waitcnt lgkmcnt(4)
    s_add_u32 m0, s32, 22528
    s_add_u32 s38, s38, s39
    buffer_load_dwordx4 v6, s[8:11], s38 offen lds
    s_add_u32 m0, s32, 23552
    s_add_u32 s38, s38, s39
    buffer_load_dwordx4 v6, s[8:11], s38 offen lds
    s_waitcnt vmcnt(28)
    ds_read_b64_tr_b16 a[104:105], v7 offset:26624
    ds_read_b64_tr_b16 a[106:107], v7 offset:26880
    ds_read_b64_tr_b16 a[108:109], v7 offset:26640
    ds_read_b64_tr_b16 a[110:111], v7 offset:26896
    s_waitcnt lgkmcnt(4)
    s_add_u32 m0, s32, 24576
    s_add_u32 s38, s38, s39
    buffer_load_dwordx4 v6, s[8:11], s38 offen lds
    s_add_u32 m0, s32, 25600
    s_add_u32 s38, s38, s39
    buffer_load_dwordx4 v6, s[8:11], s38 offen lds
    s_waitcnt vmcnt(28)
    ds_read_b64_tr_b16 a[112:113], v7 offset:28672
    ds_read_b64_tr_b16 a[114:115], v7 offset:28928
    ds_read_b64_tr_b16 a[116:117], v7 offset:28688
    ds_read_b64_tr_b16 a[118:119], v7 offset:28944
    s_waitcnt lgkmcnt(4)
    s_add_u32 m0, s32, 26624
    s_add_u32 s38, s38, s39
    buffer_load_dwordx4 v6, s[8:11], s38 offen lds
    s_add_u32 m0, s32, 27648
    s_add_u32 s38, s38, s39
    buffer_load_dwordx4 v6, s[8:11], s38 offen lds
    s_waitcnt vmcnt(28)
    ds_read_b64_tr_b16 a[120:121], v7 offset:30720
    ds_read_b64_tr_b16 a[122:123], v7 offset:30976
    ds_read_b64_tr_b16 a[124:125], v7 offset:30736
    ds_read_b64_tr_b16 a[126:127], v7 offset:30992
    s_waitcnt lgkmcnt(4)
    s_add_u32 m0, s32, 28672
    s_add_u32 s38, s38, s39
    buffer_load_dwordx4 v6, s[8:11], s38 offen lds
    s_add_u32 m0, s32, 29696
    s_add_u32 s38, s38, s39
    buffer_load_dwordx4 v6, s[8:11], s38 offen lds
    s_waitcnt vmcnt(28)
    ds_read_b64_tr_b16 a[128:129], v7 offset:0
    ds_read_b64_tr_b16 a[130:131], v7 offset:256
    ds_read_b64_tr_b16 a[132:133], v7 offset:16
    ds_read_b64_tr_b16 a[134:135], v7 offset:272
    s_waitcnt lgkmcnt(4)
    s_add_u32 m0, s32, 30720
    s_add_u32 s38, s38, s39
    buffer_load_dwordx4 v6, s[8:11], s38 offen lds
    s_add_u32 m0, s32, 31744
    s_add_u32 s38, s38, s39
    buffer_load_dwordx4 v6, s[8:11], s38 offen lds
    s_waitcnt vmcnt(28)
    ds_read_b64_tr_b16 a[136:137], v7 offset:2048
    ds_read_b64_tr_b16 a[138:139], v7 offset:2304
    ds_read_b64_tr_b16 a[140:141], v7 offset:2064
    ds_read_b64_tr_b16 a[142:143], v7 offset:2320
    s_waitcnt vmcnt(26)
    ds_read_b64_tr_b16 a[144:145], v7 offset:4096
    ds_read_b64_tr_b16 a[146:147], v7 offset:4352
    ds_read_b64_tr_b16 a[148:149], v7 offset:4112
    ds_read_b64_tr_b16 a[150:151], v7 offset:4368
    s_waitcnt vmcnt(24)
    ds_read_b64_tr_b16 a[152:153], v7 offset:6144
    ds_read_b64_tr_b16 a[154:155], v7 offset:6400
    ds_read_b64_tr_b16 a[156:157], v7 offset:6160
    ds_read_b64_tr_b16 a[158:159], v7 offset:6416
    s_waitcnt vmcnt(22)
    ds_read_b64_tr_b16 a[160:161], v7 offset:8192
    ds_read_b64_tr_b16 a[162:163], v7 offset:8448
    ds_read_b64_tr_b16 a[164:165], v7 offset:8208
    ds_read_b64_tr_b16 a[166:167], v7 offset:8464
    s_waitcnt vmcnt(20)
    ds_read_b64_tr_b16 a[168:169], v7 offset:10240
    ds_read_b64_tr_b16 a[170:171], v7 offset:10496
    ds_read_b64_tr_b16 a[172:173], v7 offset:10256
    ds_read_b64_tr_b16 a[174:175], v7 offset:10512
    s_waitcnt vmcnt(18)
    ds_read_b64_tr_b16 a[176:177], v7 offset:12288
    ds_read_b64_tr_b16 a[178:179], v7 offset:12544
    ds_read_b64_tr_b16 a[180:181], v7 offset:12304
    ds_read_b64_tr_b16 a[182:183], v7 offset:12560
    s_waitcnt vmcnt(16)
    ds_read_b64_tr_b16 a[184:185], v7 offset:14336
    ds_read_b64_tr_b16 a[186:187], v7 offset:14592
    ds_read_b64_tr_b16 a[188:189], v7 offset:14352
    ds_read_b64_tr_b16 a[190:191], v7 offset:14608
    s_waitcnt vmcnt(14)
    ds_read_b64_tr_b16 a[192:193], v7 offset:16384
    ds_read_b64_tr_b16 a[194:195], v7 offset:16640
    ds_read_b64_tr_b16 a[196:197], v7 offset:16400
    ds_read_b64_tr_b16 a[198:199], v7 offset:16656
    s_waitcnt vmcnt(12)
    ds_read_b64_tr_b16 a[200:201], v7 offset:18432
    ds_read_b64_tr_b16 a[202:203], v7 offset:18688
    ds_read_b64_tr_b16 a[204:205], v7 offset:18448
    ds_read_b64_tr_b16 a[206:207], v7 offset:18704
    s_waitcnt vmcnt(10)
    ds_read_b64_tr_b16 a[208:209], v7 offset:20480
    ds_read_b64_tr_b16 a[210:211], v7 offset:20736
    ds_read_b64_tr_b16 a[212:213], v7 offset:20496
    ds_read_b64_tr_b16 a[214:215], v7 offset:20752
    s_waitcnt vmcnt(8)
    ds_read_b64_tr_b16 a[216:217], v7 offset:22528
    ds_read_b64_tr_b16 a[218:219], v7 offset:22784
    ds_read_b64_tr_b16 a[220:221], v7 offset:22544
    ds_read_b64_tr_b16 a[222:223], v7 offset:22800
    s_waitcnt vmcnt(6)
    ds_read_b64_tr_b16 a[224:225], v7 offset:24576
    ds_read_b64_tr_b16 a[226:227], v7 offset:24832
    ds_read_b64_tr_b16 a[228:229], v7 offset:24592
    ds_read_b64_tr_b16 a[230:231], v7 offset:24848
    s_waitcnt vmcnt(4)
    ds_read_b64_tr_b16 a[232:233], v7 offset:26624
    ds_read_b64_tr_b16 a[234:235], v7 offset:26880
    ds_read_b64_tr_b16 a[236:237], v7 offset:26640
    ds_read_b64_tr_b16 a[238:239], v7 offset:26896
    s_waitcnt vmcnt(2)
    ds_read_b64_tr_b16 a[240:241], v7 offset:28672
    ds_read_b64_tr_b16 a[242:243], v7 offset:28928
    ds_read_b64_tr_b16 a[244:245], v7 offset:28688
    ds_read_b64_tr_b16 a[246:247], v7 offset:28944
    s_waitcnt vmcnt(0)
    ds_read_b64_tr_b16 a[248:249], v7 offset:30720
    ds_read_b64_tr_b16 a[250:251], v7 offset:30976
    ds_read_b64_tr_b16 a[252:253], v7 offset:30736
    ds_read_b64_tr_b16 a[254:255], v7 offset:30992
    s_waitcnt lgkmcnt(0)
    s_lshr_b32 s31, s29, 1
    s_and_b32 s31, s31, 1
    s_lshl_b32 s31, s31, 2
    v_lshrrev_b32 v2, 4, v1
    v_add_u32 v2, s31, v2
    v_and_b32 v3, 7, v1
    v_xor_b32 v2, v2, v3
    s_lshl_b32 s31, s29, 14
    v_lshrrev_b32 v8, 3, v1
    v_lshlrev_b32 v8, 11, v8
    v_add_u32 v8, s31, v8
    v_lshl_add_u32 v8, v2, 4, v8
    v_bfe_u32 v2, v1, 1, 3
    v_lshrrev_b32 v3, 4, v1
    v_xor_b32 v2, v2, v3
    v_bfe_u32 v3, v1, 3, 1
    v_lshlrev_b32 v3, 11, v3
    v_and_b32 v4, 7, v1
    v_lshl_add_u32 v3, v4, 7, v3
    v_xor_b32 v12, 0, v2
    v_lshl_add_u32 v12, v12, 4, v3
    v_add_u32 v14, 65536, v12
    v_xor_b32 v13, 4, v2
    v_lshl_add_u32 v13, v13, 4, v3
    v_add_u32 v15, 65536, v13
    s_lshl_b32 s31, s29, 11
    v_lshrrev_b32 v9, 4, v1
    v_lshlrev_b32 v9, 9, v9
    v_bfe_u32 v4, v1, 3, 1
    v_lshl_add_u32 v9, v4, 8, v9
    v_and_b32 v4, 7, v1
    v_lshl_add_u32 v9, v4, 4, v9
    v_add_u32 v9, s31, v9
    v_mov_b32 v10, s50
    s_cmp_eq_u32 s29, 0
    s_cselect_b64 vcc, 1, 0
    v_mov_b32 v4, 2130706432
    v_cndmask_b32 v10, v4, v10, vcc
    v_mov_b32 v11, 0
    s_lshl_b32 s35, s30, 16
    s_sub_u32 s36, s36, s37
    s_barrier
    s_add_u32 m0, s34, 0
    s_nop 0
    buffer_load_dwordx4 v8, s[12:15], s35 offen offset:0 lds
    s_add_u32 m0, s34, 3968
    s_nop 0
    buffer_load_dwordx4 v8, s[12:15], s35 offen offset:128 lds
    s_add_u32 m0, s34, 7936
    s_nop 0
    buffer_load_dwordx4 v8, s[12:15], s35 offen offset:256 lds
    s_add_u32 m0, s34, 11904
    s_nop 0
    buffer_load_dwordx4 v8, s[12:15], s35 offen offset:384 lds
    s_add_u32 m0, s34, 15872
    s_nop 0
    buffer_load_dwordx4 v8, s[12:15], s35 offen offset:512 lds
    s_add_u32 m0, s34, 19840
    s_nop 0
    buffer_load_dwordx4 v8, s[12:15], s35 offen offset:640 lds
    s_add_u32 m0, s34, 23808
    s_nop 0
    buffer_load_dwordx4 v8, s[12:15], s35 offen offset:768 lds
    s_add_u32 m0, s34, 27776
    s_nop 0
    buffer_load_dwordx4 v8, s[12:15], s35 offen offset:896 lds
    s_add_u32 m0, s34, 31744
    s_nop 0
    buffer_load_dwordx4 v8, s[12:15], s35 offen offset:1024 lds
    s_add_u32 m0, s34, 35712
    s_nop 0
    buffer_load_dwordx4 v8, s[12:15], s35 offen offset:1152 lds
    s_add_u32 m0, s34, 39680
    s_nop 0
    buffer_load_dwordx4 v8, s[12:15], s35 offen offset:1280 lds
    s_add_u32 m0, s34, 43648
    s_nop 0
    buffer_load_dwordx4 v8, s[12:15], s35 offen offset:1408 lds
    s_add_u32 m0, s34, 47616
    s_nop 0
    buffer_load_dwordx4 v8, s[12:15], s35 offen offset:1536 lds
    s_add_u32 m0, s34, 51584
    s_nop 0
    buffer_load_dwordx4 v8, s[12:15], s35 offen offset:1664 lds
    s_add_u32 m0, s34, 55552
    s_nop 0
    buffer_load_dwordx4 v8, s[12:15], s35 offen offset:1792 lds
    s_add_u32 m0, s34, 59520
    s_nop 0
    buffer_load_dwordx4 v8, s[12:15], s35 offen offset:1920 lds
    s_add_u32 s35, s35, 65536
    s_add_u32 m0, s34, 65536
    s_nop 0
    buffer_load_dwordx4 v8, s[12:15], s35 offen offset:0 lds
    s_add_u32 m0, s34, 69504
    s_nop 0
    buffer_load_dwordx4 v8, s[12:15], s35 offen offset:128 lds
    s_add_u32 m0, s34, 73472
    s_nop 0
    buffer_load_dwordx4 v8, s[12:15], s35 offen offset:256 lds
    s_add_u32 m0, s34, 77440
    s_nop 0
    buffer_load_dwordx4 v8, s[12:15], s35 offen offset:384 lds
    s_waitcnt vmcnt(12)
    s_barrier
    ds_read_b128 v[32:35], v12 offset:0
    ds_read_b128 v[36:39], v12 offset:1024
    ds_read_b128 v[40:43], v13 offset:0
    ds_read_b128 v[44:47], v13 offset:1024
    ds_read_b128 v[48:51], v12 offset:4096
    ds_read_b128 v[52:55], v12 offset:5120
    v_add_u32 v9, 2130706432, v9
    s_cmp_eq_u32 s44, 2
    s_cbranch_scc1 sl_v_44
sl_loop_46:
    s_waitcnt lgkmcnt(4)
    v_mfma_f32_16x16x32_bf16 v[64:67], a[0:3], v[32:35], 0
    ds_read_b128 v[56:59], v13 offset:4096
    v_mfma_f32_16x16x32_bf16 v[68:71], a[4:7], v[32:35], 0
    v_mfma_f32_16x16x32_bf16 v[72:75], a[0:3], v[36:39], 0
    ds_read_b128 v[60:63], v13 offset:5120
    s_add_u32 m0, s34, 81408
    v_mfma_f32_16x16x32_bf16 v[76:79], a[4:7], v[36:39], 0
    buffer_load_dwordx4 v8, s[12:15], s35 offen offset:512 lds
    s_waitcnt lgkmcnt(4)
    v_mfma_f32_16x16x32_bf16 v[64:67], a[8:11], v[40:43], v[64:67]
    ds_read_b128 v[32:35], v12 offset:8192
    v_mfma_f32_16x16x32_bf16 v[68:71], a[12:15], v[40:43], v[68:71]
    v_mfma_f32_16x16x32_bf16 v[72:75], a[8:11], v[44:47], v[72:75]
    ds_read_b128 v[36:39], v12 offset:9216
    v_mfma_f32_16x16x32_bf16 v[76:79], a[12:15], v[44:47], v[76:79]
    s_waitcnt lgkmcnt(4)
    v_mfma_f32_16x16x32_bf16 v[64:67], a[16:19], v[48:51], v[64:67]
    ds_read_b128 v[40:43], v13 offset:8192
    v_mfma_f32_16x16x32_bf16 v[68:71], a[20:23], v[48:51], v[68:71]
    v_cvt_pk_bf16_f32 v96, v80, v81
    v_mfma_f32_16x16x32_bf16 v[72:75], a[16:19], v[52:55], v[72:75]
    ds_read_b128 v[44:47], v13 offset:9216
    s_add_u32 m0, s34, 85376
    v_mfma_f32_16x16x32_bf16 v[76:79], a[20:23], v[52:55], v[76:79]
    buffer_load_dwordx4 v8, s[12:15], s35 offen offset:640 lds
    v_cvt_pk_bf16_f32 v97, v82, v83
    s_waitcnt lgkmcnt(4)
    v_mfma_f32_16x16x32_bf16 v[64:67], a[24:27], v[56:59], v[64:67]
    ds_read_b128 v[48:51], v12 offset:12288
    v_mfma_f32_16x16x32_bf16 v[68:71], a[28:31], v[56:59], v[68:71]
    v_cvt_pk_bf16_f32 v98, v84, v85
    v_mfma_f32_16x16x32_bf16 v[72:75], a[24:27], v[60:63], v[72:75]
    ds_read_b128 v[52:55], v12 offset:13312
    v_mfma_f32_16x16x32_bf16 v[76:79], a[28:31], v[60:63], v[76:79]
    v_cvt_pk_bf16_f32 v99, v86, v87
    s_waitcnt lgkmcnt(4)
    v_mfma_f32_16x16x32_bf16 v[64:67], a[32:35], v[32:35], v[64:67]
    ds_read_b128 v[56:59], v13 offset:12288
    v_mfma_f32_16x16x32_bf16 v[68:71], a[36:39], v[32:35], v[68:71]
    v_cvt_pk_bf16_f32 v100, v88, v89
    v_mfma_f32_16x16x32_bf16 v[72:75], a[32:35], v[36:39], v[72:75]
    ds_read_b128 v[60:63], v13 offset:13312
    s_add_u32 m0, s34, 89344
    v_mfma_f32_16x16x32_bf16 v[76:79], a[36:39], v[36:39], v[76:79]
    buffer_load_dwordx4 v8, s[12:15], s35 offen offset:768 lds
    v_cvt_pk_bf16_f32 v101, v90, v91
    s_waitcnt lgkmcnt(4)
    v_mfma_f32_16x16x32_bf16 v[64:67], a[40:43], v[40:43], v[64:67]
    ds_read_b128 v[32:35], v12 offset:16384
    v_mfma_f32_16x16x32_bf16 v[68:71], a[44:47], v[40:43], v[68:71]
    v_cvt_pk_bf16_f32 v102, v92, v93
    v_mfma_f32_16x16x32_bf16 v[72:75], a[40:43], v[44:47], v[72:75]
    ds_read_b128 v[36:39], v12 offset:17408
    v_mfma_f32_16x16x32_bf16 v[76:79], a[44:47], v[44:47], v[76:79]
    v_cvt_pk_bf16_f32 v103, v94, v95
    buffer_store_dwordx4 v[96:99], v9, s[4:7], s36 offen sc1
    s_waitcnt lgkmcnt(4)
    v_mfma_f32_16x16x32_bf16 v[64:67], a[48:51], v[48:51], v[64:67]
    ds_read_b128 v[40:43], v13 offset:16384
    v_mfma_f32_16x16x32_bf16 v[68:71], a[52:55], v[48:51], v[68:71]
    v_mfma_f32_16x16x32_bf16 v[72:75], a[48:51], v[52:55], v[72:75]
    ds_read_b128 v[44:47], v13 offset:17408
    s_add_u32 m0, s34, 93312
    v_mfma_f32_16x16x32_bf16 v[76:79], a[52:55], v[52:55], v[76:79]
    buffer_load_dwordx4 v8, s[12:15], s35 offen offset:896 lds
    s_waitcnt lgkmcnt(4)
    v_mfma_f32_16x16x32_bf16 v[64:67], a[56:59], v[56:59], v[64:67]
    ds_read_b128 v[48:51], v12 offset:20480
    v_mfma_f32_16x16x32_bf16 v[68:71], a[60:63], v[56:59], v[68:71]
    v_mfma_f32_16x16x32_bf16 v[72:75], a[56:59], v[60:63], v[72:75]
    ds_read_b128 v[52:55], v12 offset:21504
    v_mfma_f32_16x16x32_bf16 v[76:79], a[60:63], v[60:63], v[76:79]
    buffer_store_dwordx4 v[100:103], v9, s[4:7], s36 offen offset:128 sc1
    s_add_u32 s36, s36, s37
    s_waitcnt vmcnt(8)
    s_barrier
    s_waitcnt lgkmcnt(4)
    v_mfma_f32_16x16x32_bf16 v[64:67], a[64:67], v[32:35], v[64:67]
    ds_read_b128 v[56:59], v13 offset:20480
    v_mfma_f32_16x16x32_bf16 v[68:71], a[68:71], v[32:35], v[68:71]
    v_mfma_f32_16x16x32_bf16 v[72:75], a[64:67], v[36:39], v[72:75]
    ds_read_b128 v[60:63], v13 offset:21504
    s_add_u32 m0, s34, 97280
    v_mfma_f32_16x16x32_bf16 v[76:79], a[68:71], v[36:39], v[76:79]
    buffer_load_dwordx4 v8, s[12:15], s35 offen offset:1024 lds
    s_waitcnt lgkmcnt(4)
    v_mfma_f32_16x16x32_bf16 v[64:67], a[72:75], v[40:43], v[64:67]
    ds_read_b128 v[32:35], v12 offset:24576
    v_mfma_f32_16x16x32_bf16 v[68:71], a[76:79], v[40:43], v[68:71]
    v_mfma_f32_16x16x32_bf16 v[72:75], a[72:75], v[44:47], v[72:75]
    ds_read_b128 v[36:39], v12 offset:25600
    v_mfma_f32_16x16x32_bf16 v[76:79], a[76:79], v[44:47], v[76:79]
    s_waitcnt lgkmcnt(4)
    v_mfma_f32_16x16x32_bf16 v[64:67], a[80:83], v[48:51], v[64:67]
    ds_read_b128 v[40:43], v13 offset:24576
    v_mfma_f32_16x16x32_bf16 v[68:71], a[84:87], v[48:51], v[68:71]
    v_and_b32 v9, 0xffffff, v9
    v_mfma_f32_16x16x32_bf16 v[72:75], a[80:83], v[52:55], v[72:75]
    ds_read_b128 v[44:47], v13 offset:25600
    s_add_u32 m0, s34, 101248
    v_mfma_f32_16x16x32_bf16 v[76:79], a[84:87], v[52:55], v[76:79]
    buffer_load_dwordx4 v8, s[12:15], s35 offen offset:1152 lds
    s_waitcnt lgkmcnt(4)
    v_mfma_f32_16x16x32_bf16 v[64:67], a[88:91], v[56:59], v[64:67]
    ds_read_b128 v[48:51], v12 offset:28672
    v_mfma_f32_16x16x32_bf16 v[68:71], a[92:95], v[56:59], v[68:71]
    v_mfma_f32_16x16x32_bf16 v[72:75], a[88:91], v[60:63], v[72:75]
    ds_read_b128 v[52:55], v12 offset:29696
    v_mfma_f32_16x16x32_bf16 v[76:79], a[92:95], v[60:63], v[76:79]
    s_waitcnt lgkmcnt(4)
    v_mfma_f32_16x16x32_bf16 v[64:67], a[96:99], v[32:35], v[64:67]
    ds_read_b128 v[56:59], v13 offset:28672
    v_mfma_f32_16x16x32_bf16 v[68:71], a[100:103], v[32:35], v[68:71]
    v_mfma_f32_16x16x32_bf16 v[72:75], a[96:99], v[36:39], v[72:75]
    ds_read_b128 v[60:63], v13 offset:29696
    s_add_u32 m0, s34, 105216
    v_mfma_f32_16x16x32_bf16 v[76:79], a[100:103], v[36:39], v[76:79]
    buffer_load_dwordx4 v8, s[12:15], s35 offen offset:1280 lds
    s_waitcnt lgkmcnt(4)
    v_mfma_f32_16x16x32_bf16 v[64:67], a[104:107], v[40:43], v[64:67]
    ds_read_b128 v[32:35], v12 offset:32768
    v_mfma_f32_16x16x32_bf16 v[68:71], a[108:111], v[40:43], v[68:71]
    v_mfma_f32_16x16x32_bf16 v[72:75], a[104:107], v[44:47], v[72:75]
    ds_read_b128 v[36:39], v12 offset:33792
    v_mfma_f32_16x16x32_bf16 v[76:79], a[108:111], v[44:47], v[76:79]
    s_waitcnt lgkmcnt(4)
    v_mfma_f32_16x16x32_bf16 v[64:67], a[112:115], v[48:51], v[64:67]
    ds_read_b128 v[40:43], v13 offset:32768
    v_mfma_f32_16x16x32_bf16 v[68:71], a[116:119], v[48:51], v[68:71]
    v_mfma_f32_16x16x32_bf16 v[72:75], a[112:115], v[52:55], v[72:75]
    ds_read_b128 v[44:47], v13 offset:33792
    s_add_u32 m0, s34, 109184
    v_mfma_f32_16x16x32_bf16 v[76:79], a[116:119], v[52:55], v[76:79]
    buffer_load_dwordx4 v8, s[12:15], s35 offen offset:1408 lds
    s_waitcnt lgkmcnt(4)
    v_mfma_f32_16x16x32_bf16 v[64:67], a[120:123], v[56:59], v[64:67]
    ds_read_b128 v[48:51], v12 offset:36864
    v_mfma_f32_16x16x32_bf16 v[68:71], a[124:127], v[56:59], v[68:71]
    v_mfma_f32_16x16x32_bf16 v[72:75], a[120:123], v[60:63], v[72:75]
    ds_read_b128 v[52:55], v12 offset:37888
    v_mfma_f32_16x16x32_bf16 v[76:79], a[124:127], v[60:63], v[76:79]
    s_waitcnt lgkmcnt(4)
    v_mfma_f32_16x16x32_bf16 v[64:67], a[128:131], v[32:35], v[64:67]
    ds_read_b128 v[56:59], v13 offset:36864
    v_mfma_f32_16x16x32_bf16 v[68:71], a[132:135], v[32:35], v[68:71]
    v_mfma_f32_16x16x32_bf16 v[72:75], a[128:131], v[36:39], v[72:75]
    ds_read_b128 v[60:63], v13 offset:37888
    s_add_u32 m0, s34, 113152
    v_mfma_f32_16x16x32_bf16 v[76:79], a[132:135], v[36:39], v[76:79]
    buffer_load_dwordx4 v8, s[12:15], s35 offen offset:1536 lds
    s_waitcnt lgkmcnt(4)
    v_mfma_f32_16x16x32_bf16 v[64:67], a[136:139], v[40:43], v[64:67]
    ds_read_b128 v[32:35], v12 offset:40960
    v_mfma_f32_16x16x32_bf16 v[68:71], a[140:143], v[40:43], v[68:71]
    v_mfma_f32_16x16x32_bf16 v[72:75], a[136:139], v[44:47], v[72:75]
    ds_read_b128 v[36:39], v12 offset:41984
    v_mfma_f32_16x16x32_bf16 v[76:79], a[140:143], v[44:47], v[76:79]
    s_waitcnt lgkmcnt(4)
    v_mfma_f32_16x16x32_bf16 v[64:67], a[144:147], v[48:51], v[64:67]
    ds_read_b128 v[40:43], v13 offset:40960
    v_mfma_f32_16x16x32_bf16 v[68:71], a[148:151], v[48:51], v[68:71]
    v_mfma_f32_16x16x32_bf16 v[72:75], a[144:147], v[52:55], v[72:75]
    ds_read_b128 v[44:47], v13 offset:41984
    s_add_u32 m0, s34, 117120
    v_mfma_f32_16x16x32_bf16 v[76:79], a[148:151], v[52:55], v[76:79]
    buffer_load_dwordx4 v8, s[12:15], s35 offen offset:1664 lds
    s_waitcnt lgkmcnt(4)
    v_mfma_f32_16x16x32_bf16 v[64:67], a[152:155], v[56:59], v[64:67]
    ds_read_b128 v[48:51], v12 offset:45056
    v_mfma_f32_16x16x32_bf16 v[68:71], a[156:159], v[56:59], v[68:71]
    v_mfma_f32_16x16x32_bf16 v[72:75], a[152:155], v[60:63], v[72:75]
    ds_read_b128 v[52:55], v12 offset:46080
    v_mfma_f32_16x16x32_bf16 v[76:79], a[156:159], v[60:63], v[76:79]
    s_waitcnt lgkmcnt(4)
    v_mfma_f32_16x16x32_bf16 v[64:67], a[160:163], v[32:35], v[64:67]
    ds_read_b128 v[56:59], v13 offset:45056
    v_mfma_f32_16x16x32_bf16 v[68:71], a[164:167], v[32:35], v[68:71]
    v_mfma_f32_16x16x32_bf16 v[72:75], a[160:163], v[36:39], v[72:75]
    ds_read_b128 v[60:63], v13 offset:46080
    s_add_u32 m0, s34, 121088
    v_mfma_f32_16x16x32_bf16 v[76:79], a[164:167], v[36:39], v[76:79]
    buffer_load_dwordx4 v8, s[12:15], s35 offen offset:1792 lds
    s_waitcnt lgkmcnt(4)
    v_mfma_f32_16x16x32_bf16 v[64:67], a[168:171], v[40:43], v[64:67]
    ds_read_b128 v[32:35], v12 offset:49152
    v_mfma_f32_16x16x32_bf16 v[68:71], a[172:175], v[40:43], v[68:71]
    v_mfma_f32_16x16x32_bf16 v[72:75], a[168:171], v[44:47], v[72:75]
    ds_read_b128 v[36:39], v12 offset:50176
    v_mfma_f32_16x16x32_bf16 v[76:79], a[172:175], v[44:47], v[76:79]
    s_waitcnt lgkmcnt(4)
    v_mfma_f32_16x16x32_bf16 v[64:67], a[176:179], v[48:51], v[64:67]
    ds_read_b128 v[40:43], v13 offset:49152
    v_mfma_f32_16x16x32_bf16 v[68:71], a[180:183], v[48:51], v[68:71]
    v_mfma_f32_16x16x32_bf16 v[72:75], a[176:179], v[52:55], v[72:75]
    ds_read_b128 v[44:47], v13 offset:50176
    s_add_u32 m0, s34, 125056
    v_mfma_f32_16x16x32_bf16 v[76:79], a[180:183], v[52:55], v[76:79]
    buffer_load_dwordx4 v8, s[12:15], s35 offen offset:1920 lds
    s_add_u32 s35, s35, 65536
    s_min_u32 s35, s35, s52
    s_waitcnt lgkmcnt(4)
    v_mfma_f32_16x16x32_bf16 v[64:67], a[184:187], v[56:59], v[64:67]
    ds_read_b128 v[48:51], v12 offset:53248
    v_mfma_f32_16x16x32_bf16 v[68:71], a[188:191], v[56:59], v[68:71]
    v_mfma_f32_16x16x32_bf16 v[72:75], a[184:187], v[60:63], v[72:75]
    ds_read_b128 v[52:55], v12 offset:54272
    v_mfma_f32_16x16x32_bf16 v[76:79], a[188:191], v[60:63], v[76:79]
    s_waitcnt vmcnt(8)
    s_barrier
    s_waitcnt lgkmcnt(4)
    v_mfma_f32_16x16x32_bf16 v[64:67], a[192:195], v[32:35], v[64:67]
    ds_read_b128 v[56:59], v13 offset:53248
    v_mfma_f32_16x16x32_bf16 v[68:71], a[196:199], v[32:35], v[68:71]
    v_mfma_f32_16x16x32_bf16 v[72:75], a[192:195], v[36:39], v[72:75]
    ds_read_b128 v[60:63], v13 offset:54272
    s_add_u32 m0, s34, 0
    v_mfma_f32_16x16x32_bf16 v[76:79], a[196:199], v[36:39], v[76:79]
    buffer_load_dwordx4 v8, s[12:15], s35 offen offset:0 lds
    s_waitcnt lgkmcnt(4)
    v_mfma_f32_16x16x32_bf16 v[64:67], a[200:203], v[40:43], v[64:67]
    ds_read_b128 v[32:35], v12 offset:57344
    v_mfma_f32_16x16x32_bf16 v[68:71], a[204:207], v[40:43], v[68:71]
    buffer_store_dword v11, v10, s[4:7], 0 offen sc1
    v_add_u32 v11, 1, v11
    v_mfma_f32_16x16x32_bf16 v[72:75], a[200:203], v[44:47], v[72:75]
    ds_read_b128 v[36:39], v12 offset:58368
    v_mfma_f32_16x16x32_bf16 v[76:79], a[204:207], v[44:47], v[76:79]
    s_waitcnt lgkmcnt(4)
    v_mfma_f32_16x16x32_bf16 v[64:67], a[208:211], v[48:51], v[64:67]
    ds_read_b128 v[40:43], v13 offset:57344
    v_mfma_f32_16x16x32_bf16 v[68:71], a[212:215], v[48:51], v[68:71]
    v_mfma_f32_16x16x32_bf16 v[72:75], a[208:211], v[52:55], v[72:75]
    ds_read_b128 v[44:47], v13 offset:58368
    s_add_u32 m0, s34, 3968
    v_mfma_f32_16x16x32_bf16 v[76:79], a[212:215], v[52:55], v[76:79]
    buffer_load_dwordx4 v8, s[12:15], s35 offen offset:128 lds
    s_waitcnt lgkmcnt(4)
    v_mfma_f32_16x16x32_bf16 v[64:67], a[216:219], v[56:59], v[64:67]
    ds_read_b128 v[48:51], v12 offset:61440
    v_mfma_f32_16x16x32_bf16 v[68:71], a[220:223], v[56:59], v[68:71]
    v_mfma_f32_16x16x32_bf16 v[72:75], a[216:219], v[60:63], v[72:75]
    ds_read_b128 v[52:55], v12 offset:62464
    v_mfma_f32_16x16x32_bf16 v[76:79], a[220:223], v[60:63], v[76:79]
    s_waitcnt lgkmcnt(4)
    v_mfma_f32_16x16x32_bf16 v[64:67], a[224:227], v[32:35], v[64:67]
    ds_read_b128 v[56:59], v13 offset:61440
    v_mfma_f32_16x16x32_bf16 v[68:71], a[228:231], v[32:35], v[68:71]
    v_mfma_f32_16x16x32_bf16 v[72:75], a[224:227], v[36:39], v[72:75]
    ds_read_b128 v[60:63], v13 offset:62464
    s_add_u32 m0, s34, 7936
    v_mfma_f32_16x16x32_bf16 v[76:79], a[228:231], v[36:39], v[76:79]
    buffer_load_dwordx4 v8, s[12:15], s35 offen offset:256 lds
    s_waitcnt lgkmcnt(4)
    v_mfma_f32_16x16x32_bf16 v[64:67], a[232:235], v[40:43], v[64:67]
    ds_read_b128 v[32:35], v14 offset:0
    v_mfma_f32_16x16x32_bf16 v[68:71], a[236:239], v[40:43], v[68:71]
    v_mfma_f32_16x16x32_bf16 v[72:75], a[232:235], v[44:47], v[72:75]
    ds_read_b128 v[36:39], v14 offset:1024
    v_mfma_f32_16x16x32_bf16 v[76:79], a[236:239], v[44:47], v[76:79]
    s_waitcnt lgkmcnt(4)
    v_mfma_f32_16x16x32_bf16 v[64:67], a[240:243], v[48:51], v[64:67]
    ds_read_b128 v[40:43], v15 offset:0
    v_mfma_f32_16x16x32_bf16 v[68:71], a[244:247], v[48:51], v[68:71]
    v_mfma_f32_16x16x32_bf16 v[72:75], a[240:243], v[52:55], v[72:75]
    ds_read_b128 v[44:47], v15 offset:1024
    s_add_u32 m0, s34, 11904
    v_mfma_f32_16x16x32_bf16 v[76:79], a[244:247], v[52:55], v[76:79]
    buffer_load_dwordx4 v8, s[12:15], s35 offen offset:384 lds
    s_waitcnt lgkmcnt(4)
    v_mfma_f32_16x16x32_bf16 v[64:67], a[248:251], v[56:59], v[64:67]
    ds_read_b128 v[48:51], v14 offset:4096
    v_mfma_f32_16x16x32_bf16 v[68:71], a[252:255], v[56:59], v[68:71]
    v_mfma_f32_16x16x32_bf16 v[72:75], a[248:251], v[60:63], v[72:75]
    ds_read_b128 v[52:55], v14 offset:5120
    v_mfma_f32_16x16x32_bf16 v[76:79], a[252:255], v[60:63], v[76:79]
    s_waitcnt lgkmcnt(4)
    v_mfma_f32_16x16x32_bf16 v[80:83], a[0:3], v[32:35], 0
    ds_read_b128 v[56:59], v15 offset:4096
    v_mfma_f32_16x16x32_bf16 v[84:87], a[4:7], v[32:35], 0
    v_mfma_f32_16x16x32_bf16 v[88:91], a[0:3], v[36:39], 0
    ds_read_b128 v[60:63], v15 offset:5120
    s_add_u32 m0, s34, 15872
    v_mfma_f32_16x16x32_bf16 v[92:95], a[4:7], v[36:39], 0
    buffer_load_dwordx4 v8, s[12:15], s35 offen offset:512 lds
    s_waitcnt lgkmcnt(4)
    v_mfma_f32_16x16x32_bf16 v[80:83], a[8:11], v[40:43], v[80:83]
    ds_read_b128 v[32:35], v14 offset:8192
    v_mfma_f32_16x16x32_bf16 v[84:87], a[12:15], v[40:43], v[84:87]
    v_mfma_f32_16x16x32_bf16 v[88:91], a[8:11], v[44:47], v[88:91]
    ds_read_b128 v[36:39], v14 offset:9216
    v_mfma_f32_16x16x32_bf16 v[92:95], a[12:15], v[44:47], v[92:95]
    s_waitcnt lgkmcnt(4)
    v_mfma_f32_16x16x32_bf16 v[80:83], a[16:19], v[48:51], v[80:83]
    ds_read_b128 v[40:43], v15 offset:8192
    v_mfma_f32_16x16x32_bf16 v[84:87], a[20:23], v[48:51], v[84:87]
    v_cvt_pk_bf16_f32 v96, v64, v65
    v_mfma_f32_16x16x32_bf16 v[88:91], a[16:19], v[52:55], v[88:91]
    ds_read_b128 v[44:47], v15 offset:9216
    s_add_u32 m0, s34, 19840
    v_mfma_f32_16x16x32_bf16 v[92:95], a[20:23], v[52:55], v[92:95]
    buffer_load_dwordx4 v8, s[12:15], s35 offen offset:640 lds
    v_cvt_pk_bf16_f32 v97, v66, v67
    s_waitcnt lgkmcnt(4)
    v_mfma_f32_16x16x32_bf16 v[80:83], a[24:27], v[56:59], v[80:83]
    ds_read_b128 v[48:51], v14 offset:12288
    v_mfma_f32_16x16x32_bf16 v[84:87], a[28:31], v[56:59], v[84:87]
    v_cvt_pk_bf16_f32 v98, v68, v69
    v_mfma_f32_16x16x32_bf16 v[88:91], a[24:27], v[60:63], v[88:91]
    ds_read_b128 v[52:55], v14 offset:13312
    v_mfma_f32_16x16x32_bf16 v[92:95], a[28:31], v[60:63], v[92:95]
    v_cvt_pk_bf16_f32 v99, v70, v71
    s_waitcnt lgkmcnt(4)
    v_mfma_f32_16x16x32_bf16 v[80:83], a[32:35], v[32:35], v[80:83]
    ds_read_b128 v[56:59], v15 offset:12288
    v_mfma_f32_16x16x32_bf16 v[84:87], a[36:39], v[32:35], v[84:87]
    v_cvt_pk_bf16_f32 v100, v72, v73
    v_mfma_f32_16x16x32_bf16 v[88:91], a[32:35], v[36:39], v[88:91]
    ds_read_b128 v[60:63], v15 offset:13312
    s_add_u32 m0, s34, 23808
    v_mfma_f32_16x16x32_bf16 v[92:95], a[36:39], v[36:39], v[92:95]
    buffer_load_dwordx4 v8, s[12:15], s35 offen offset:768 lds
    v_cvt_pk_bf16_f32 v101, v74, v75
    s_waitcnt lgkmcnt(4)
    v_mfma_f32_16x16x32_bf16 v[80:83], a[40:43], v[40:43], v[80:83]
    ds_read_b128 v[32:35], v14 offset:16384
    v_mfma_f32_16x16x32_bf16 v[84:87], a[44:47], v[40:43], v[84:87]
    v_cvt_pk_bf16_f32 v102, v76, v77
    v_mfma_f32_16x16x32_bf16 v[88:91], a[40:43], v[44:47], v[88:91]
    ds_read_b128 v[36:39], v14 offset:17408
    v_mfma_f32_16x16x32_bf16 v[92:95], a[44:47], v[44:47], v[92:95]
    v_cvt_pk_bf16_f32 v103, v78, v79
    buffer_store_dwordx4 v[96:99], v9, s[4:7], s36 offen sc1
    s_waitcnt lgkmcnt(4)
    v_mfma_f32_16x16x32_bf16 v[80:83], a[48:51], v[48:51], v[80:83]
    ds_read_b128 v[40:43], v15 offset:16384
    v_mfma_f32_16x16x32_bf16 v[84:87], a[52:55], v[48:51], v[84:87]
    v_mfma_f32_16x16x32_bf16 v[88:91], a[48:51], v[52:55], v[88:91]
    ds_read_b128 v[44:47], v15 offset:17408
    s_add_u32 m0, s34, 27776
    v_mfma_f32_16x16x32_bf16 v[92:95], a[52:55], v[52:55], v[92:95]
    buffer_load_dwordx4 v8, s[12:15], s35 offen offset:896 lds
    s_waitcnt lgkmcnt(4)
    v_mfma_f32_16x16x32_bf16 v[80:83], a[56:59], v[56:59], v[80:83]
    ds_read_b128 v[48:51], v14 offset:20480
    v_mfma_f32_16x16x32_bf16 v[84:87], a[60:63], v[56:59], v[84:87]
    v_mfma_f32_16x16x32_bf16 v[88:91], a[56:59], v[60:63], v[88:91]
    ds_read_b128 v[52:55], v14 offset:21504
    v_mfma_f32_16x16x32_bf16 v[92:95], a[60:63], v[60:63], v[92:95]
    buffer_store_dwordx4 v[100:103], v9, s[4:7], s36 offen offset:128 sc1
    s_add_u32 s36, s36, s37
    s_waitcnt vmcnt(8)
    s_barrier
    s_waitcnt lgkmcnt(4)
    v_mfma_f32_16x16x32_bf16 v[80:83], a[64:67], v[32:35], v[80:83]
    ds_read_b128 v[56:59], v15 offset:20480
    v_mfma_f32_16x16x32_bf16 v[84:87], a[68:71], v[32:35], v[84:87]
    v_mfma_f32_16x16x32_bf16 v[88:91], a[64:67], v[36:39], v[88:91]
    ds_read_b128 v[60:63], v15 offset:21504
    s_add_u32 m0, s34, 31744
    v_mfma_f32_16x16x32_bf16 v[92:95], a[68:71], v[36:39], v[92:95]
    buffer_load_dwordx4 v8, s[12:15], s35 offen offset:1024 lds
    s_waitcnt lgkmcnt(4)
    v_mfma_f32_16x16x32_bf16 v[80:83], a[72:75], v[40:43], v[80:83]
    ds_read_b128 v[32:35], v14 offset:24576
    v_mfma_f32_16x16x32_bf16 v[84:87], a[76:79], v[40:43], v[84:87]
    v_mfma_f32_16x16x32_bf16 v[88:91], a[72:75], v[44:47], v[88:91]
    ds_read_b128 v[36:39], v14 offset:25600
    v_mfma_f32_16x16x32_bf16 v[92:95], a[76:79], v[44:47], v[92:95]
    s_waitcnt lgkmcnt(4)
    v_mfma_f32_16x16x32_bf16 v[80:83], a[80:83], v[48:51], v[80:83]
    ds_read_b128 v[40:43], v15 offset:24576
    v_mfma_f32_16x16x32_bf16 v[84:87], a[84:87], v[48:51], v[84:87]
    v_mfma_f32_16x16x32_bf16 v[88:91], a[80:83], v[52:55], v[88:91]
    ds_read_b128 v[44:47], v15 offset:25600
    s_add_u32 m0, s34, 35712
    v_mfma_f32_16x16x32_bf16 v[92:95], a[84:87], v[52:55], v[92:95]
    buffer_load_dwordx4 v8, s[12:15], s35 offen offset:1152 lds
    s_waitcnt lgkmcnt(4)
    v_mfma_f32_16x16x32_bf16 v[80:83], a[88:91], v[56:59], v[80:83]
    ds_read_b128 v[48:51], v14 offset:28672
    v_mfma_f32_16x16x32_bf16 v[84:87], a[92:95], v[56:59], v[84:87]
    v_mfma_f32_16x16x32_bf16 v[88:91], a[88:91], v[60:63], v[88:91]
    ds_read_b128 v[52:55], v14 offset:29696
    v_mfma_f32_16x16x32_bf16 v[92:95], a[92:95], v[60:63], v[92:95]
    s_waitcnt lgkmcnt(4)
    v_mfma_f32_16x16x32_bf16 v[80:83], a[96:99], v[32:35], v[80:83]
    ds_read_b128 v[56:59], v15 offset:28672
    v_mfma_f32_16x16x32_bf16 v[84:87], a[100:103], v[32:35], v[84:87]
    v_mfma_f32_16x16x32_bf16 v[88:91], a[96:99], v[36:39], v[88:91]
    ds_read_b128 v[60:63], v15 offset:29696
    s_add_u32 m0, s34, 39680
    v_mfma_f32_16x16x32_bf16 v[92:95], a[100:103], v[36:39], v[92:95]
    buffer_load_dwordx4 v8, s[12:15], s35 offen offset:1280 lds
    s_waitcnt lgkmcnt(4)
    v_mfma_f32_16x16x32_bf16 v[80:83], a[104:107], v[40:43], v[80:83]
    ds_read_b128 v[32:35], v14 offset:32768
    v_mfma_f32_16x16x32_bf16 v[84:87], a[108:111], v[40:43], v[84:87]
    v_mfma_f32_16x16x32_bf16 v[88:91], a[104:107], v[44:47], v[88:91]
    ds_read_b128 v[36:39], v14 offset:33792
    v_mfma_f32_16x16x32_bf16 v[92:95], a[108:111], v[44:47], v[92:95]
    s_waitcnt lgkmcnt(4)
    v_mfma_f32_16x16x32_bf16 v[80:83], a[112:115], v[48:51], v[80:83]
    ds_read_b128 v[40:43], v15 offset:32768
    v_mfma_f32_16x16x32_bf16 v[84:87], a[116:119], v[48:51], v[84:87]
    v_mfma_f32_16x16x32_bf16 v[88:91], a[112:115], v[52:55], v[88:91]
    ds_read_b128 v[44:47], v15 offset:33792
    s_add_u32 m0, s34, 43648
    v_mfma_f32_16x16x32_bf16 v[92:95], a[116:119], v[52:55], v[92:95]
    buffer_load_dwordx4 v8, s[12:15], s35 offen offset:1408 lds
    s_waitcnt lgkmcnt(4)
    v_mfma_f32_16x16x32_bf16 v[80:83], a[120:123], v[56:59], v[80:83]
    ds_read_b128 v[48:51], v14 offset:36864
    v_mfma_f32_16x16x32_bf16 v[84:87], a[124:127], v[56:59], v[84:87]
    v_mfma_f32_16x16x32_bf16 v[88:91], a[120:123], v[60:63], v[88:91]
    ds_read_b128 v[52:55], v14 offset:37888
    v_mfma_f32_16x16x32_bf16 v[92:95], a[124:127], v[60:63], v[92:95]
    s_waitcnt lgkmcnt(4)
    v_mfma_f32_16x16x32_bf16 v[80:83], a[128:131], v[32:35], v[80:83]
    ds_read_b128 v[56:59], v15 offset:36864
    v_mfma_f32_16x16x32_bf16 v[84:87], a[132:135], v[32:35], v[84:87]
    v_mfma_f32_16x16x32_bf16 v[88:91], a[128:131], v[36:39], v[88:91]
    ds_read_b128 v[60:63], v15 offset:37888
    s_add_u32 m0, s34, 47616
    v_mfma_f32_16x16x32_bf16 v[92:95], a[132:135], v[36:39], v[92:95]
    buffer_load_dwordx4 v8, s[12:15], s35 offen offset:1536 lds
    s_waitcnt lgkmcnt(4)
    v_mfma_f32_16x16x32_bf16 v[80:83], a[136:139], v[40:43], v[80:83]
    ds_read_b128 v[32:35], v14 offset:40960
    v_mfma_f32_16x16x32_bf16 v[84:87], a[140:143], v[40:43], v[84:87]
    v_mfma_f32_16x16x32_bf16 v[88:91], a[136:139], v[44:47], v[88:91]
    ds_read_b128 v[36:39], v14 offset:41984
    v_mfma_f32_16x16x32_bf16 v[92:95], a[140:143], v[44:47], v[92:95]
    s_waitcnt lgkmcnt(4)
    v_mfma_f32_16x16x32_bf16 v[80:83], a[144:147], v[48:51], v[80:83]
    ds_read_b128 v[40:43], v15 offset:40960
    v_mfma_f32_16x16x32_bf16 v[84:87], a[148:151], v[48:51], v[84:87]
    v_mfma_f32_16x16x32_bf16 v[88:91], a[144:147], v[52:55], v[88:91]
    ds_read_b128 v[44:47], v15 offset:41984
    s_add_u32 m0, s34, 51584
    v_mfma_f32_16x16x32_bf16 v[92:95], a[148:151], v[52:55], v[92:95]
    buffer_load_dwordx4 v8, s[12:15], s35 offen offset:1664 lds
    s_waitcnt lgkmcnt(4)
    v_mfma_f32_16x16x32_bf16 v[80:83], a[152:155], v[56:59], v[80:83]
    ds_read_b128 v[48:51], v14 offset:45056
    v_mfma_f32_16x16x32_bf16 v[84:87], a[156:159], v[56:59], v[84:87]
    v_mfma_f32_16x16x32_bf16 v[88:91], a[152:155], v[60:63], v[88:91]
    ds_read_b128 v[52:55], v14 offset:46080
    v_mfma_f32_16x16x32_bf16 v[92:95], a[156:159], v[60:63], v[92:95]
    s_waitcnt lgkmcnt(4)
    v_mfma_f32_16x16x32_bf16 v[80:83], a[160:163], v[32:35], v[80:83]
    ds_read_b128 v[56:59], v15 offset:45056
    v_mfma_f32_16x16x32_bf16 v[84:87], a[164:167], v[32:35], v[84:87]
    v_mfma_f32_16x16x32_bf16 v[88:91], a[160:163], v[36:39], v[88:91]
    ds_read_b128 v[60:63], v15 offset:46080
    s_add_u32 m0, s34, 55552
    v_mfma_f32_16x16x32_bf16 v[92:95], a[164:167], v[36:39], v[92:95]
    buffer_load_dwordx4 v8, s[12:15], s35 offen offset:1792 lds
    s_waitcnt lgkmcnt(4)
    v_mfma_f32_16x16x32_bf16 v[80:83], a[168:171], v[40:43], v[80:83]
    ds_read_b128 v[32:35], v14 offset:49152
    v_mfma_f32_16x16x32_bf16 v[84:87], a[172:175], v[40:43], v[84:87]
    v_mfma_f32_16x16x32_bf16 v[88:91], a[168:171], v[44:47], v[88:91]
    ds_read_b128 v[36:39], v14 offset:50176
    v_mfma_f32_16x16x32_bf16 v[92:95], a[172:175], v[44:47], v[92:95]
    s_waitcnt lgkmcnt(4)
    v_mfma_f32_16x16x32_bf16 v[80:83], a[176:179], v[48:51], v[80:83]
    ds_read_b128 v[40:43], v15 offset:49152
    v_mfma_f32_16x16x32_bf16 v[84:87], a[180:183], v[48:51], v[84:87]
    v_mfma_f32_16x16x32_bf16 v[88:91], a[176:179], v[52:55], v[88:91]
    ds_read_b128 v[44:47], v15 offset:50176
    s_add_u32 m0, s34, 59520
    v_mfma_f32_16x16x32_bf16 v[92:95], a[180:183], v[52:55], v[92:95]
    buffer_load_dwordx4 v8, s[12:15], s35 offen offset:1920 lds
    s_add_u32 s35, s35, 65536
    s_min_u32 s35, s35, s52
    s_waitcnt lgkmcnt(4)
    v_mfma_f32_16x16x32_bf16 v[80:83], a[184:187], v[56:59], v[80:83]
    ds_read_b128 v[48:51], v14 offset:53248
    v_mfma_f32_16x16x32_bf16 v[84:87], a[188:191], v[56:59], v[84:87]
    v_mfma_f32_16x16x32_bf16 v[88:91], a[184:187], v[60:63], v[88:91]
    ds_read_b128 v[52:55], v14 offset:54272
    v_mfma_f32_16x16x32_bf16 v[92:95], a[188:191], v[60:63], v[92:95]
    s_waitcnt vmcnt(8)
    s_barrier
    s_waitcnt lgkmcnt(4)
    v_mfma_f32_16x16x32_bf16 v[80:83], a[192:195], v[32:35], v[80:83]
    ds_read_b128 v[56:59], v15 offset:53248
    v_mfma_f32_16x16x32_bf16 v[84:87], a[196:199], v[32:35], v[84:87]
    v_mfma_f32_16x16x32_bf16 v[88:91], a[192:195], v[36:39], v[88:91]
    ds_read_b128 v[60:63], v15 offset:54272
    s_add_u32 m0, s34, 65536
    v_mfma_f32_16x16x32_bf16 v[92:95], a[196:199], v[36:39], v[92:95]
    buffer_load_dwordx4 v8, s[12:15], s35 offen offset:0 lds
    s_waitcnt lgkmcnt(4)
    v_mfma_f32_16x16x32_bf16 v[80:83], a[200:203], v[40:43], v[80:83]
    ds_read_b128 v[32:35], v14 offset:57344
    v_mfma_f32_16x16x32_bf16 v[84:87], a[204:207], v[40:43], v[84:87]
    buffer_store_dword v11, v10, s[4:7], 0 offen sc1
    v_add_u32 v11, 1, v11
    v_mfma_f32_16x16x32_bf16 v[88:91], a[200:203], v[44:47], v[88:91]
    ds_read_b128 v[36:39], v14 offset:58368
    v_mfma_f32_16x16x32_bf16 v[92:95], a[204:207], v[44:47], v[92:95]
    s_waitcnt lgkmcnt(4)
    v_mfma_f32_16x16x32_bf16 v[80:83], a[208:211], v[48:51], v[80:83]
    ds_read_b128 v[40:43], v15 offset:57344
    v_mfma_f32_16x16x32_bf16 v[84:87], a[212:215], v[48:51], v[84:87]
    v_mfma_f32_16x16x32_bf16 v[88:91], a[208:211], v[52:55], v[88:91]
    ds_read_b128 v[44:47], v15 offset:58368
    s_add_u32 m0, s34, 69504
    v_mfma_f32_16x16x32_bf16 v[92:95], a[212:215], v[52:55], v[92:95]
    buffer_load_dwordx4 v8, s[12:15], s35 offen offset:128 lds
    s_waitcnt lgkmcnt(4)
    v_mfma_f32_16x16x32_bf16 v[80:83], a[216:219], v[56:59], v[80:83]
    ds_read_b128 v[48:51], v14 offset:61440
    v_mfma_f32_16x16x32_bf16 v[84:87], a[220:223], v[56:59], v[84:87]
    v_mfma_f32_16x16x32_bf16 v[88:91], a[216:219], v[60:63], v[88:91]
    ds_read_b128 v[52:55], v14 offset:62464
    v_mfma_f32_16x16x32_bf16 v[92:95], a[220:223], v[60:63], v[92:95]
    s_waitcnt lgkmcnt(4)
    v_mfma_f32_16x16x32_bf16 v[80:83], a[224:227], v[32:35], v[80:83]
    ds_read_b128 v[56:59], v15 offset:61440
    v_mfma_f32_16x16x32_bf16 v[84:87], a[228:231], v[32:35], v[84:87]
    v_mfma_f32_16x16x32_bf16 v[88:91], a[224:227], v[36:39], v[88:91]
    ds_read_b128 v[60:63], v15 offset:62464
    s_add_u32 m0, s34, 73472
    v_mfma_f32_16x16x32_bf16 v[92:95], a[228:231], v[36:39], v[92:95]
    buffer_load_dwordx4 v8, s[12:15], s35 offen offset:256 lds
    s_waitcnt lgkmcnt(4)
    v_mfma_f32_16x16x32_bf16 v[80:83], a[232:235], v[40:43], v[80:83]
    ds_read_b128 v[32:35], v12 offset:0
    v_mfma_f32_16x16x32_bf16 v[84:87], a[236:239], v[40:43], v[84:87]
    v_mfma_f32_16x16x32_bf16 v[88:91], a[232:235], v[44:47], v[88:91]
    ds_read_b128 v[36:39], v12 offset:1024
    v_mfma_f32_16x16x32_bf16 v[92:95], a[236:239], v[44:47], v[92:95]
    s_waitcnt lgkmcnt(4)
    v_mfma_f32_16x16x32_bf16 v[80:83], a[240:243], v[48:51], v[80:83]
    ds_read_b128 v[40:43], v13 offset:0
    v_mfma_f32_16x16x32_bf16 v[84:87], a[244:247], v[48:51], v[84:87]
    v_mfma_f32_16x16x32_bf16 v[88:91], a[240:243], v[52:55], v[88:91]
    ds_read_b128 v[44:47], v13 offset:1024
    s_add_u32 m0, s34, 77440
    v_mfma_f32_16x16x32_bf16 v[92:95], a[244:247], v[52:55], v[92:95]
    buffer_load_dwordx4 v8, s[12:15], s35 offen offset:384 lds
    s_waitcnt lgkmcnt(4)
    v_mfma_f32_16x16x32_bf16 v[80:83], a[248:251], v[56:59], v[80:83]
    ds_read_b128 v[48:51], v12 offset:4096
    v_mfma_f32_16x16x32_bf16 v[84:87], a[252:255], v[56:59], v[84:87]
    v_mfma_f32_16x16x32_bf16 v[88:91], a[248:251], v[60:63], v[88:91]
    ds_read_b128 v[52:55], v12 offset:5120
    v_mfma_f32_16x16x32_bf16 v[92:95], a[252:255], v[60:63], v[92:95]
    s_add_u32 s30, s30, 2
    s_cmp_lt_u32 s30, s51
    s_cbranch_scc1 sl_loop_46
    v_cvt_pk_bf16_f32 v96, v80, v81
    v_cvt_pk_bf16_f32 v97, v82, v83
    v_cvt_pk_bf16_f32 v98, v84, v85
    v_cvt_pk_bf16_f32 v99, v86, v87
    v_cvt_pk_bf16_f32 v100, v88, v89
    v_cvt_pk_bf16_f32 v101, v90, v91
    v_cvt_pk_bf16_f32 v102, v92, v93
    v_cvt_pk_bf16_f32 v103, v94, v95
    s_branch sl_e_45
sl_v_44:
sl_loop_47:
    s_waitcnt lgkmcnt(4)
    v_mfma_f32_16x16x32_bf16 v[64:67], v[32:35], a[0:3], 0
    ds_read_b128 v[56:59], v13 offset:4096
    v_mfma_f32_16x16x32_bf16 v[68:71], v[32:35], a[4:7], 0
    v_mfma_f32_16x16x32_bf16 v[72:75], v[36:39], a[0:3], 0
    ds_read_b128 v[60:63], v13 offset:5120
    s_add_u32 m0, s34, 81408
    v_mfma_f32_16x16x32_bf16 v[76:79], v[36:39], a[4:7], 0
    buffer_load_dwordx4 v8, s[12:15], s35 offen offset:512 lds
    s_waitcnt lgkmcnt(4)
    v_mfma_f32_16x16x32_bf16 v[64:67], v[40:43], a[8:11], v[64:67]
    ds_read_b128 v[32:35], v12 offset:8192
    v_mfma_f32_16x16x32_bf16 v[68:71], v[40:43], a[12:15], v[68:71]
    v_mfma_f32_16x16x32_bf16 v[72:75], v[44:47], a[8:11], v[72:75]
    ds_read_b128 v[36:39], v12 offset:9216
    v_mfma_f32_16x16x32_bf16 v[76:79], v[44:47], a[12:15], v[76:79]
    s_waitcnt lgkmcnt(4)
    v_mfma_f32_16x16x32_bf16 v[64:67], v[48:51], a[16:19], v[64:67]
    ds_read_b128 v[40:43], v13 offset:8192
    v_mfma_f32_16x16x32_bf16 v[68:71], v[48:51], a[20:23], v[68:71]
    v_cvt_pk_bf16_f32 v96, v80, v81
    v_mfma_f32_16x16x32_bf16 v[72:75], v[52:55], a[16:19], v[72:75]
    ds_read_b128 v[44:47], v13 offset:9216
    s_add_u32 m0, s34, 85376
    v_mfma_f32_16x16x32_bf16 v[76:79], v[52:55], a[20:23], v[76:79]
    buffer_load_dwordx4 v8, s[12:15], s35 offen offset:640 lds
    v_cvt_pk_bf16_f32 v97, v82, v83
    s_waitcnt lgkmcnt(4)
    v_mfma_f32_16x16x32_bf16 v[64:67], v[56:59], a[24:27], v[64:67]
    ds_read_b128 v[48:51], v12 offset:12288
    v_mfma_f32_16x16x32_bf16 v[68:71], v[56:59], a[28:31], v[68:71]
    v_cvt_pk_bf16_f32 v98, v88, v89
    v_mfma_f32_16x16x32_bf16 v[72:75], v[60:63], a[24:27], v[72:75]
    ds_read_b128 v[52:55], v12 offset:13312
    v_mfma_f32_16x16x32_bf16 v[76:79], v[60:63], a[28:31], v[76:79]
    v_cvt_pk_bf16_f32 v99, v90, v91
    s_waitcnt lgkmcnt(4)
    v_mfma_f32_16x16x32_bf16 v[64:67], v[32:35], a[32:35], v[64:67]
    ds_read_b128 v[56:59], v13 offset:12288
    v_mfma_f32_16x16x32_bf16 v[68:71], v[32:35], a[36:39], v[68:71]
    v_cvt_pk_bf16_f32 v100, v84, v85
    v_mfma_f32_16x16x32_bf16 v[72:75], v[36:39], a[32:35], v[72:75]
    ds_read_b128 v[60:63], v13 offset:13312
    s_add_u32 m0, s34, 89344
    v_mfma_f32_16x16x32_bf16 v[76:79], v[36:39], a[36:39], v[76:79]
    buffer_load_dwordx4 v8, s[12:15], s35 offen offset:768 lds
    v_cvt_pk_bf16_f32 v101, v86, v87
    s_waitcnt lgkmcnt(4)
    v_mfma_f32_16x16x32_bf16 v[64:67], v[40:43], a[40:43], v[64:67]
    ds_read_b128 v[32:35], v12 offset:16384
    v_mfma_f32_16x16x32_bf16 v[68:71], v[40:43], a[44:47], v[68:71]
    v_cvt_pk_bf16_f32 v102, v92, v93
    v_mfma_f32_16x16x32_bf16 v[72:75], v[44:47], a[40:43], v[72:75]
    ds_read_b128 v[36:39], v12 offset:17408
    v_mfma_f32_16x16x32_bf16 v[76:79], v[44:47], a[44:47], v[76:79]
    v_cvt_pk_bf16_f32 v103, v94, v95
    buffer_store_dwordx4 v[96:99], v9, s[4:7], s36 offen sc1
    s_waitcnt lgkmcnt(4)
    v_mfma_f32_16x16x32_bf16 v[64:67], v[48:51], a[48:51], v[64:67]
    ds_read_b128 v[40:43], v13 offset:16384
    v_mfma_f32_16x16x32_bf16 v[68:71], v[48:51], a[52:55], v[68:71]
    v_mfma_f32_16x16x32_bf16 v[72:75], v[52:55], a[48:51], v[72:75]
    ds_read_b128 v[44:47], v13 offset:17408
    s_add_u32 m0, s34, 93312
    v_mfma_f32_16x16x32_bf16 v[76:79], v[52:55], a[52:55], v[76:79]
    buffer_load_dwordx4 v8, s[12:15], s35 offen offset:896 lds
    s_waitcnt lgkmcnt(4)
    v_mfma_f32_16x16x32_bf16 v[64:67], v[56:59], a[56:59], v[64:67]
    ds_read_b128 v[48:51], v12 offset:20480
    v_mfma_f32_16x16x32_bf16 v[68:71], v[56:59], a[60:63], v[68:71]
    v_mfma_f32_16x16x32_bf16 v[72:75], v[60:63], a[56:59], v[72:75]
    ds_read_b128 v[52:55], v12 offset:21504
    v_mfma_f32_16x16x32_bf16 v[76:79], v[60:63], a[60:63], v[76:79]
    buffer_store_dwordx4 v[100:103], v9, s[4:7], s36 offen offset:128 sc1
    s_add_u32 s36, s36, s37
    s_waitcnt vmcnt(8)
    s_barrier
    s_waitcnt lgkmcnt(4)
    v_mfma_f32_16x16x32_bf16 v[64:67], v[32:35], a[64:67], v[64:67]
    ds_read_b128 v[56:59], v13 offset:20480
    v_mfma_f32_16x16x32_bf16 v[68:71], v[32:35], a[68:71], v[68:71]
    v_mfma_f32_16x16x32_bf16 v[72:75], v[36:39], a[64:67], v[72:75]
    ds_read_b128 v[60:63], v13 offset:21504
    s_add_u32 m0, s34, 97280
    v_mfma_f32_16x16x32_bf16 v[76:79], v[36:39], a[68:71], v[76:79]
    buffer_load_dwordx4 v8, s[12:15], s35 offen offset:1024 lds
    s_waitcnt lgkmcnt(4)
    v_mfma_f32_16x16x32_bf16 v[64:67], v[40:43], a[72:75], v[64:67]
    ds_read_b128 v[32:35], v12 offset:24576
    v_mfma_f32_16x16x32_bf16 v[68:71], v[40:43], a[76:79], v[68:71]
    v_mfma_f32_16x16x32_bf16 v[72:75], v[44:47], a[72:75], v[72:75]
    ds_read_b128 v[36:39], v12 offset:25600
    v_mfma_f32_16x16x32_bf16 v[76:79], v[44:47], a[76:79], v[76:79]
    s_waitcnt lgkmcnt(4)
    v_mfma_f32_16x16x32_bf16 v[64:67], v[48:51], a[80:83], v[64:67]
    ds_read_b128 v[40:43], v13 offset:24576
    v_mfma_f32_16x16x32_bf16 v[68:71], v[48:51], a[84:87], v[68:71]
    v_and_b32 v9, 0xffffff, v9
    v_mfma_f32_16x16x32_bf16 v[72:75], v[52:55], a[80:83], v[72:75]
    ds_read_b128 v[44:47], v13 offset:25600
    s_add_u32 m0, s34, 101248
    v_mfma_f32_16x16x32_bf16 v[76:79], v[52:55], a[84:87], v[76:79]
    buffer_load_dwordx4 v8, s[12:15], s35 offen offset:1152 lds
    s_waitcnt lgkmcnt(4)
    v_mfma_f32_16x16x32_bf16 v[64:67], v[56:59], a[88:91], v[64:67]
    ds_read_b128 v[48:51], v12 offset:28672
    v_mfma_f32_16x16x32_bf16 v[68:71], v[56:59], a[92:95], v[68:71]
    v_mfma_f32_16x16x32_bf16 v[72:75], v[60:63], a[88:91], v[72:75]
    ds_read_b128 v[52:55], v12 offset:29696
    v_mfma_f32_16x16x32_bf16 v[76:79], v[60:63], a[92:95], v[76:79]
    s_waitcnt lgkmcnt(4)
    v_mfma_f32_16x16x32_bf16 v[64:67], v[32:35], a[96:99], v[64:67]
    ds_read_b128 v[56:59], v13 offset:28672
    v_mfma_f32_16x16x32_bf16 v[68:71], v[32:35], a[100:103], v[68:71]
    v_mfma_f32_16x16x32_bf16 v[72:75], v[36:39], a[96:99], v[72:75]
    ds_read_b128 v[60:63], v13 offset:29696
    s_add_u32 m0, s34, 105216
    v_mfma_f32_16x16x32_bf16 v[76:79], v[36:39], a[100:103], v[76:79]
    buffer_load_dwordx4 v8, s[12:15], s35 offen offset:1280 lds
    s_waitcnt lgkmcnt(4)
    v_mfma_f32_16x16x32_bf16 v[64:67], v[40:43], a[104:107], v[64:67]
    ds_read_b128 v[32:35], v12 offset:32768
    v_mfma_f32_16x16x32_bf16 v[68:71], v[40:43], a[108:111], v[68:71]
    v_mfma_f32_16x16x32_bf16 v[72:75], v[44:47], a[104:107], v[72:75]
    ds_read_b128 v[36:39], v12 offset:33792
    v_mfma_f32_16x16x32_bf16 v[76:79], v[44:47], a[108:111], v[76:79]
    s_waitcnt lgkmcnt(4)
    v_mfma_f32_16x16x32_bf16 v[64:67], v[48:51], a[112:115], v[64:67]
    ds_read_b128 v[40:43], v13 offset:32768
    v_mfma_f32_16x16x32_bf16 v[68:71], v[48:51], a[116:119], v[68:71]
    v_mfma_f32_16x16x32_bf16 v[72:75], v[52:55], a[112:115], v[72:75]
    ds_read_b128 v[44:47], v13 offset:33792
    s_add_u32 m0, s34, 109184
    v_mfma_f32_16x16x32_bf16 v[76:79], v[52:55], a[116:119], v[76:79]
    buffer_load_dwordx4 v8, s[12:15], s35 offen offset:1408 lds
    s_waitcnt lgkmcnt(4)
    v_mfma_f32_16x16x32_bf16 v[64:67], v[56:59], a[120:123], v[64:67]
    ds_read_b128 v[48:51], v12 offset:36864
    v_mfma_f32_16x16x32_bf16 v[68:71], v[56:59], a[124:127], v[68:71]
    v_mfma_f32_16x16x32_bf16 v[72:75], v[60:63], a[120:123], v[72:75]
    ds_read_b128 v[52:55], v12 offset:37888
    v_mfma_f32_16x16x32_bf16 v[76:79], v[60:63], a[124:127], v[76:79]
    s_waitcnt lgkmcnt(4)
    v_mfma_f32_16x16x32_bf16 v[64:67], v[32:35], a[128:131], v[64:67]
    ds_read_b128 v[56:59], v13 offset:36864
    v_mfma_f32_16x16x32_bf16 v[68:71], v[32:35], a[132:135], v[68:71]
    v_mfma_f32_16x16x32_bf16 v[72:75], v[36:39], a[128:131], v[72:75]
    ds_read_b128 v[60:63], v13 offset:37888
    s_add_u32 m0, s34, 113152
    v_mfma_f32_16x16x32_bf16 v[76:79], v[36:39], a[132:135], v[76:79]
    buffer_load_dwordx4 v8, s[12:15], s35 offen offset:1536 lds
    s_waitcnt lgkmcnt(4)
    v_mfma_f32_16x16x32_bf16 v[64:67], v[40:43], a[136:139], v[64:67]
    ds_read_b128 v[32:35], v12 offset:40960
    v_mfma_f32_16x16x32_bf16 v[68:71], v[40:43], a[140:143], v[68:71]
    v_mfma_f32_16x16x32_bf16 v[72:75], v[44:47], a[136:139], v[72:75]
    ds_read_b128 v[36:39], v12 offset:41984
    v_mfma_f32_16x16x32_bf16 v[76:79], v[44:47], a[140:143], v[76:79]
    s_waitcnt lgkmcnt(4)
    v_mfma_f32_16x16x32_bf16 v[64:67], v[48:51], a[144:147], v[64:67]
    ds_read_b128 v[40:43], v13 offset:40960
    v_mfma_f32_16x16x32_bf16 v[68:71], v[48:51], a[148:151], v[68:71]
    v_mfma_f32_16x16x32_bf16 v[72:75], v[52:55], a[144:147], v[72:75]
    ds_read_b128 v[44:47], v13 offset:41984
    s_add_u32 m0, s34, 117120
    v_mfma_f32_16x16x32_bf16 v[76:79], v[52:55], a[148:151], v[76:79]
    buffer_load_dwordx4 v8, s[12:15], s35 offen offset:1664 lds
    s_waitcnt lgkmcnt(4)
    v_mfma_f32_16x16x32_bf16 v[64:67], v[56:59], a[152:155], v[64:67]
    ds_read_b128 v[48:51], v12 offset:45056
    v_mfma_f32_16x16x32_bf16 v[68:71], v[56:59], a[156:159], v[68:71]
    v_mfma_f32_16x16x32_bf16 v[72:75], v[60:63], a[152:155], v[72:75]
    ds_read_b128 v[52:55], v12 offset:46080
    v_mfma_f32_16x16x32_bf16 v[76:79], v[60:63], a[156:159], v[76:79]
    s_waitcnt lgkmcnt(4)
    v_mfma_f32_16x16x32_bf16 v[64:67], v[32:35], a[160:163], v[64:67]
    ds_read_b128 v[56:59], v13 offset:45056
    v_mfma_f32_16x16x32_bf16 v[68:71], v[32:35], a[164:167], v[68:71]
    v_mfma_f32_16x16x32_bf16 v[72:75], v[36:39], a[160:163], v[72:75]
    ds_read_b128 v[60:63], v13 offset:46080
    s_add_u32 m0, s34, 121088
    v_mfma_f32_16x16x32_bf16 v[76:79], v[36:39], a[164:167], v[76:79]
    buffer_load_dwordx4 v8, s[12:15], s35 offen offset:1792 lds
    s_waitcnt lgkmcnt(4)
    v_mfma_f32_16x16x32_bf16 v[64:67], v[40:43], a[168:171], v[64:67]
    ds_read_b128 v[32:35], v12 offset:49152
    v_mfma_f32_16x16x32_bf16 v[68:71], v[40:43], a[172:175], v[68:71]
    v_mfma_f32_16x16x32_bf16 v[72:75], v[44:47], a[168:171], v[72:75]
    ds_read_b128 v[36:39], v12 offset:50176
    v_mfma_f32_16x16x32_bf16 v[76:79], v[44:47], a[172:175], v[76:79]
    s_waitcnt lgkmcnt(4)
    v_mfma_f32_16x16x32_bf16 v[64:67], v[48:51], a[176:179], v[64:67]
    ds_read_b128 v[40:43], v13 offset:49152
    v_mfma_f32_16x16x32_bf16 v[68:71], v[48:51], a[180:183], v[68:71]
    v_mfma_f32_16x16x32_bf16 v[72:75], v[52:55], a[176:179], v[72:75]
    ds_read_b128 v[44:47], v13 offset:50176
    s_add_u32 m0, s34, 125056
    v_mfma_f32_16x16x32_bf16 v[76:79], v[52:55], a[180:183], v[76:79]
    buffer_load_dwordx4 v8, s[12:15], s35 offen offset:1920 lds
    s_add_u32 s35, s35, 65536
    s_min_u32 s35, s35, s52
    s_waitcnt lgkmcnt(4)
    v_mfma_f32_16x16x32_bf16 v[64:67], v[56:59], a[184:187], v[64:67]
    ds_read_b128 v[48:51], v12 offset:53248
    v_mfma_f32_16x16x32_bf16 v[68:71], v[56:59], a[188:191], v[68:71]
    v_mfma_f32_16x16x32_bf16 v[72:75], v[60:63], a[184:187], v[72:75]
    ds_read_b128 v[52:55], v12 offset:54272
    v_mfma_f32_16x16x32_bf16 v[76:79], v[60:63], a[188:191], v[76:79]
    s_waitcnt vmcnt(8)
    s_barrier
    s_waitcnt lgkmcnt(4)
    v_mfma_f32_16x16x32_bf16 v[64:67], v[32:35], a[192:195], v[64:67]
    ds_read_b128 v[56:59], v13 offset:53248
    v_mfma_f32_16x16x32_bf16 v[68:71], v[32:35], a[196:199], v[68:71]
    v_mfma_f32_16x16x32_bf16 v[72:75], v[36:39], a[192:195], v[72:75]
    ds_read_b128 v[60:63], v13 offset:54272
    s_add_u32 m0, s34, 0
    v_mfma_f32_16x16x32_bf16 v[76:79], v[36:39], a[196:199], v[76:79]
    buffer_load_dwordx4 v8, s[12:15], s35 offen offset:0 lds
    s_waitcnt lgkmcnt(4)
    v_mfma_f32_16x16x32_bf16 v[64:67], v[40:43], a[200:203], v[64:67]
    ds_read_b128 v[32:35], v12 offset:57344
    v_mfma_f32_16x16x32_bf16 v[68:71], v[40:43], a[204:207], v[68:71]
    buffer_store_dword v11, v10, s[4:7], 0 offen sc1
    v_add_u32 v11, 1, v11
    v_mfma_f32_16x16x32_bf16 v[72:75], v[44:47], a[200:203], v[72:75]
    ds_read_b128 v[36:39], v12 offset:58368
    v_mfma_f32_16x16x32_bf16 v[76:79], v[44:47], a[204:207], v[76:79]
    s_waitcnt lgkmcnt(4)
    v_mfma_f32_16x16x32_bf16 v[64:67], v[48:51], a[208:211], v[64:67]
    ds_read_b128 v[40:43], v13 offset:57344
    v_mfma_f32_16x16x32_bf16 v[68:71], v[48:51], a[212:215], v[68:71]
    v_mfma_f32_16x16x32_bf16 v[72:75], v[52:55], a[208:211], v[72:75]
    ds_read_b128 v[44:47], v13 offset:58368
    s_add_u32 m0, s34, 3968
    v_mfma_f32_16x16x32_bf16 v[76:79], v[52:55], a[212:215], v[76:79]
    buffer_load_dwordx4 v8, s[12:15], s35 offen offset:128 lds
    s_waitcnt lgkmcnt(4)
    v_mfma_f32_16x16x32_bf16 v[64:67], v[56:59], a[216:219], v[64:67]
    ds_read_b128 v[48:51], v12 offset:61440
    v_mfma_f32_16x16x32_bf16 v[68:71], v[56:59], a[220:223], v[68:71]
    v_mfma_f32_16x16x32_bf16 v[72:75], v[60:63], a[216:219], v[72:75]
    ds_read_b128 v[52:55], v12 offset:62464
    v_mfma_f32_16x16x32_bf16 v[76:79], v[60:63], a[220:223], v[76:79]
    s_waitcnt lgkmcnt(4)
    v_mfma_f32_16x16x32_bf16 v[64:67], v[32:35], a[224:227], v[64:67]
    ds_read_b128 v[56:59], v13 offset:61440
    v_mfma_f32_16x16x32_bf16 v[68:71], v[32:35], a[228:231], v[68:71]
    v_mfma_f32_16x16x32_bf16 v[72:75], v[36:39], a[224:227], v[72:75]
    ds_read_b128 v[60:63], v13 offset:62464
    s_add_u32 m0, s34, 7936
    v_mfma_f32_16x16x32_bf16 v[76:79], v[36:39], a[228:231], v[76:79]
    buffer_load_dwordx4 v8, s[12:15], s35 offen offset:256 lds
    s_waitcnt lgkmcnt(4)
    v_mfma_f32_16x16x32_bf16 v[64:67], v[40:43], a[232:235], v[64:67]
    ds_read_b128 v[32:35], v14 offset:0
    v_mfma_f32_16x16x32_bf16 v[68:71], v[40:43], a[236:239], v[68:71]
    v_mfma_f32_16x16x32_bf16 v[72:75], v[44:47], a[232:235], v[72:75]
    ds_read_b128 v[36:39], v14 offset:1024
    v_mfma_f32_16x16x32_bf16 v[76:79], v[44:47], a[236:239], v[76:79]
    s_waitcnt lgkmcnt(4)
    v_mfma_f32_16x16x32_bf16 v[64:67], v[48:51], a[240:243], v[64:67]
    ds_read_b128 v[40:43], v15 offset:0
    v_mfma_f32_16x16x32_bf16 v[68:71], v[48:51], a[244:247], v[68:71]
    v_mfma_f32_16x16x32_bf16 v[72:75], v[52:55], a[240:243], v[72:75]
    ds_read_b128 v[44:47], v15 offset:1024
    s_add_u32 m0, s34, 11904
    v_mfma_f32_16x16x32_bf16 v[76:79], v[52:55], a[244:247], v[76:79]
    buffer_load_dwordx4 v8, s[12:15], s35 offen offset:384 lds
    s_waitcnt lgkmcnt(4)
    v_mfma_f32_16x16x32_bf16 v[64:67], v[56:59], a[248:251], v[64:67]
    ds_read_b128 v[48:51], v14 offset:4096
    v_mfma_f32_16x16x32_bf16 v[68:71], v[56:59], a[252:255], v[68:71]
    v_mfma_f32_16x16x32_bf16 v[72:75], v[60:63], a[248:251], v[72:75]
    ds_read_b128 v[52:55], v14 offset:5120
    v_mfma_f32_16x16x32_bf16 v[76:79], v[60:63], a[252:255], v[76:79]
    s_waitcnt lgkmcnt(4)
    v_mfma_f32_16x16x32_bf16 v[80:83], v[32:35], a[0:3], 0
    ds_read_b128 v[56:59], v15 offset:4096
    v_mfma_f32_16x16x32_bf16 v[84:87], v[32:35], a[4:7], 0
    v_mfma_f32_16x16x32_bf16 v[88:91], v[36:39], a[0:3], 0
    ds_read_b128 v[60:63], v15 offset:5120
    s_add_u32 m0, s34, 15872
    v_mfma_f32_16x16x32_bf16 v[92:95], v[36:39], a[4:7], 0
    buffer_load_dwordx4 v8, s[12:15], s35 offen offset:512 lds
    s_waitcnt lgkmcnt(4)
    v_mfma_f32_16x16x32_bf16 v[80:83], v[40:43], a[8:11], v[80:83]
    ds_read_b128 v[32:35], v14 offset:8192
    v_mfma_f32_16x16x32_bf16 v[84:87], v[40:43], a[12:15], v[84:87]
    v_mfma_f32_16x16x32_bf16 v[88:91], v[44:47], a[8:11], v[88:91]
    ds_read_b128 v[36:39], v14 offset:9216
    v_mfma_f32_16x16x32_bf16 v[92:95], v[44:47], a[12:15], v[92:95]
    s_waitcnt lgkmcnt(4)
    v_mfma_f32_16x16x32_bf16 v[80:83], v[48:51], a[16:19], v[80:83]
    ds_read_b128 v[40:43], v15 offset:8192
    v_mfma_f32_16x16x32_bf16 v[84:87], v[48:51], a[20:23], v[84:87]
    v_cvt_pk_bf16_f32 v96, v64, v65
    v_mfma_f32_16x16x32_bf16 v[88:91], v[52:55], a[16:19], v[88:91]
    ds_read_b128 v[44:47], v15 offset:9216
    s_add_u32 m0, s34, 19840
    v_mfma_f32_16x16x32_bf16 v[92:95], v[52:55], a[20:23], v[92:95]
    buffer_load_dwordx4 v8, s[12:15], s35 offen offset:640 lds
    v_cvt_pk_bf16_f32 v97, v66, v67
    s_waitcnt lgkmcnt(4)
    v_mfma_f32_16x16x32_bf16 v[80:83], v[56:59], a[24:27], v[80:83]
    ds_read_b128 v[48:51], v14 offset:12288
    v_mfma_f32_16x16x32_bf16 v[84:87], v[56:59], a[28:31], v[84:87]
    v_cvt_pk_bf16_f32 v98, v72, v73
    v_mfma_f32_16x16x32_bf16 v[88:91], v[60:63], a[24:27], v[88:91]
    ds_read_b128 v[52:55], v14 offset:13312
    v_mfma_f32_16x16x32_bf16 v[92:95], v[60:63], a[28:31], v[92:95]
    v_cvt_pk_bf16_f32 v99, v74, v75
    s_waitcnt lgkmcnt(4)
    v_mfma_f32_16x16x32_bf16 v[80:83], v[32:35], a[32:35], v[80:83]
    ds_read_b128 v[56:59], v15 offset:12288
    v_mfma_f32_16x16x32_bf16 v[84:87], v[32:35], a[36:39], v[84:87]
    v_cvt_pk_bf16_f32 v100, v68, v69
    v_mfma_f32_16x16x32_bf16 v[88:91], v[36:39], a[32:35], v[88:91]
    ds_read_b128 v[60:63], v15 offset:13312
    s_add_u32 m0, s34, 23808
    v_mfma_f32_16x16x32_bf16 v[92:95], v[36:39], a[36:39], v[92:95]
    buffer_load_dwordx4 v8, s[12:15], s35 offen offset:768 lds
    v_cvt_pk_bf16_f32 v101, v70, v71
    s_waitcnt lgkmcnt(4)
    v_mfma_f32_16x16x32_bf16 v[80:83], v[40:43], a[40:43], v[80:83]
    ds_read_b128 v[32:35], v14 offset:16384
    v_mfma_f32_16x16x32_bf16 v[84:87], v[40:43], a[44:47], v[84:87]
    v_cvt_pk_bf16_f32 v102, v76, v77
    v_mfma_f32_16x16x32_bf16 v[88:91], v[44:47], a[40:43], v[88:91]
    ds_read_b128 v[36:39], v14 offset:17408
    v_mfma_f32_16x16x32_bf16 v[92:95], v[44:47], a[44:47], v[92:95]
    v_cvt_pk_bf16_f32 v103, v78, v79
    buffer_store_dwordx4 v[96:99], v9, s[4:7], s36 offen sc1
    s_waitcnt lgkmcnt(4)
    v_mfma_f32_16x16x32_bf16 v[80:83], v[48:51], a[48:51], v[80:83]
    ds_read_b128 v[40:43], v15 offset:16384
    v_mfma_f32_16x16x32_bf16 v[84:87], v[48:51], a[52:55], v[84:87]
    v_mfma_f32_16x16x32_bf16 v[88:91], v[52:55], a[48:51], v[88:91]
    ds_read_b128 v[44:47], v15 offset:17408
    s_add_u32 m0, s34, 27776
    v_mfma_f32_16x16x32_bf16 v[92:95], v[52:55], a[52:55], v[92:95]
    buffer_load_dwordx4 v8, s[12:15], s35 offen offset:896 lds
    s_waitcnt lgkmcnt(4)
    v_mfma_f32_16x16x32_bf16 v[80:83], v[56:59], a[56:59], v[80:83]
    ds_read_b128 v[48:51], v14 offset:20480
    v_mfma_f32_16x16x32_bf16 v[84:87], v[56:59], a[60:63], v[84:87]
    v_mfma_f32_16x16x32_bf16 v[88:91], v[60:63], a[56:59], v[88:91]
    ds_read_b128 v[52:55], v14 offset:21504
    v_mfma_f32_16x16x32_bf16 v[92:95], v[60:63], a[60:63], v[92:95]
    buffer_store_dwordx4 v[100:103], v9, s[4:7], s36 offen offset:128 sc1
    s_add_u32 s36, s36, s37
    s_waitcnt vmcnt(8)
    s_barrier
    s_waitcnt lgkmcnt(4)
    v_mfma_f32_16x16x32_bf16 v[80:83], v[32:35], a[64:67], v[80:83]
    ds_read_b128 v[56:59], v15 offset:20480
    v_mfma_f32_16x16x32_bf16 v[84:87], v[32:35], a[68:71], v[84:87]
    v_mfma_f32_16x16x32_bf16 v[88:91], v[36:39], a[64:67], v[88:91]
    ds_read_b128 v[60:63], v15 offset:21504
    s_add_u32 m0, s34, 31744
    v_mfma_f32_16x16x32_bf16 v[92:95], v[36:39], a[68:71], v[92:95]
    buffer_load_dwordx4 v8, s[12:15], s35 offen offset:1024 lds
    s_waitcnt lgkmcnt(4)
    v_mfma_f32_16x16x32_bf16 v[80:83], v[40:43], a[72:75], v[80:83]
    ds_read_b128 v[32:35], v14 offset:24576
    v_mfma_f32_16x16x32_bf16 v[84:87], v[40:43], a[76:79], v[84:87]
    v_mfma_f32_16x16x32_bf16 v[88:91], v[44:47], a[72:75], v[88:91]
    ds_read_b128 v[36:39], v14 offset:25600
    v_mfma_f32_16x16x32_bf16 v[92:95], v[44:47], a[76:79], v[92:95]
    s_waitcnt lgkmcnt(4)
    v_mfma_f32_16x16x32_bf16 v[80:83], v[48:51], a[80:83], v[80:83]
    ds_read_b128 v[40:43], v15 offset:24576
    v_mfma_f32_16x16x32_bf16 v[84:87], v[48:51], a[84:87], v[84:87]
    v_mfma_f32_16x16x32_bf16 v[88:91], v[52:55], a[80:83], v[88:91]
    ds_read_b128 v[44:47], v15 offset:25600
    s_add_u32 m0, s34, 35712
    v_mfma_f32_16x16x32_bf16 v[92:95], v[52:55], a[84:87], v[92:95]
    buffer_load_dwordx4 v8, s[12:15], s35 offen offset:1152 lds
    s_waitcnt lgkmcnt(4)
    v_mfma_f32_16x16x32_bf16 v[80:83], v[56:59], a[88:91], v[80:83]
    ds_read_b128 v[48:51], v14 offset:28672
    v_mfma_f32_16x16x32_bf16 v[84:87], v[56:59], a[92:95], v[84:87]
    v_mfma_f32_16x16x32_bf16 v[88:91], v[60:63], a[88:91], v[88:91]
    ds_read_b128 v[52:55], v14 offset:29696
    v_mfma_f32_16x16x32_bf16 v[92:95], v[60:63], a[92:95], v[92:95]
    s_waitcnt lgkmcnt(4)
    v_mfma_f32_16x16x32_bf16 v[80:83], v[32:35], a[96:99], v[80:83]
    ds_read_b128 v[56:59], v15 offset:28672
    v_mfma_f32_16x16x32_bf16 v[84:87], v[32:35], a[100:103], v[84:87]
    v_mfma_f32_16x16x32_bf16 v[88:91], v[36:39], a[96:99], v[88:91]
    ds_read_b128 v[60:63], v15 offset:29696
    s_add_u32 m0, s34, 39680
    v_mfma_f32_16x16x32_bf16 v[92:95], v[36:39], a[100:103], v[92:95]
    buffer_load_dwordx4 v8, s[12:15], s35 offen offset:1280 lds
    s_waitcnt lgkmcnt(4)
    v_mfma_f32_16x16x32_bf16 v[80:83], v[40:43], a[104:107], v[80:83]
    ds_read_b128 v[32:35], v14 offset:32768
    v_mfma_f32_16x16x32_bf16 v[84:87], v[40:43], a[108:111], v[84:87]
    v_mfma_f32_16x16x32_bf16 v[88:91], v[44:47], a[104:107], v[88:91]
    ds_read_b128 v[36:39], v14 offset:33792
    v_mfma_f32_16x16x32_bf16 v[92:95], v[44:47], a[108:111], v[92:95]
    s_waitcnt lgkmcnt(4)
    v_mfma_f32_16x16x32_bf16 v[80:83], v[48:51], a[112:115], v[80:83]
    ds_read_b128 v[40:43], v15 offset:32768
    v_mfma_f32_16x16x32_bf16 v[84:87], v[48:51], a[116:119], v[84:87]
    v_mfma_f32_16x16x32_bf16 v[88:91], v[52:55], a[112:115], v[88:91]
    ds_read_b128 v[44:47], v15 offset:33792
    s_add_u32 m0, s34, 43648
    v_mfma_f32_16x16x32_bf16 v[92:95], v[52:55], a[116:119], v[92:95]
    buffer_load_dwordx4 v8, s[12:15], s35 offen offset:1408 lds
    s_waitcnt lgkmcnt(4)
    v_mfma_f32_16x16x32_bf16 v[80:83], v[56:59], a[120:123], v[80:83]
    ds_read_b128 v[48:51], v14 offset:36864
    v_mfma_f32_16x16x32_bf16 v[84:87], v[56:59], a[124:127], v[84:87]
    v_mfma_f32_16x16x32_bf16 v[88:91], v[60:63], a[120:123], v[88:91]
    ds_read_b128 v[52:55], v14 offset:37888
    v_mfma_f32_16x16x32_bf16 v[92:95], v[60:63], a[124:127], v[92:95]
    s_waitcnt lgkmcnt(4)
    v_mfma_f32_16x16x32_bf16 v[80:83], v[32:35], a[128:131], v[80:83]
    ds_read_b128 v[56:59], v15 offset:36864
    v_mfma_f32_16x16x32_bf16 v[84:87], v[32:35], a[132:135], v[84:87]
    v_mfma_f32_16x16x32_bf16 v[88:91], v[36:39], a[128:131], v[88:91]
    ds_read_b128 v[60:63], v15 offset:37888
    s_add_u32 m0, s34, 47616
    v_mfma_f32_16x16x32_bf16 v[92:95], v[36:39], a[132:135], v[92:95]
    buffer_load_dwordx4 v8, s[12:15], s35 offen offset:1536 lds
    s_waitcnt lgkmcnt(4)
    v_mfma_f32_16x16x32_bf16 v[80:83], v[40:43], a[136:139], v[80:83]
    ds_read_b128 v[32:35], v14 offset:40960
    v_mfma_f32_16x16x32_bf16 v[84:87], v[40:43], a[140:143], v[84:87]
    v_mfma_f32_16x16x32_bf16 v[88:91], v[44:47], a[136:139], v[88:91]
    ds_read_b128 v[36:39], v14 offset:41984
    v_mfma_f32_16x16x32_bf16 v[92:95], v[44:47], a[140:143], v[92:95]
    s_waitcnt lgkmcnt(4)
    v_mfma_f32_16x16x32_bf16 v[80:83], v[48:51], a[144:147], v[80:83]
    ds_read_b128 v[40:43], v15 offset:40960
    v_mfma_f32_16x16x32_bf16 v[84:87], v[48:51], a[148:151], v[84:87]
    v_mfma_f32_16x16x32_bf16 v[88:91], v[52:55], a[144:147], v[88:91]
    ds_read_b128 v[44:47], v15 offset:41984
    s_add_u32 m0, s34, 51584
    v_mfma_f32_16x16x32_bf16 v[92:95], v[52:55], a[148:151], v[92:95]
    buffer_load_dwordx4 v8, s[12:15], s35 offen offset:1664 lds
    s_waitcnt lgkmcnt(4)
    v_mfma_f32_16x16x32_bf16 v[80:83], v[56:59], a[152:155], v[80:83]
    ds_read_b128 v[48:51], v14 offset:45056
    v_mfma_f32_16x16x32_bf16 v[84:87], v[56:59], a[156:159], v[84:87]
    v_mfma_f32_16x16x32_bf16 v[88:91], v[60:63], a[152:155], v[88:91]
    ds_read_b128 v[52:55], v14 offset:46080
    v_mfma_f32_16x16x32_bf16 v[92:95], v[60:63], a[156:159], v[92:95]
    s_waitcnt lgkmcnt(4)
    v_mfma_f32_16x16x32_bf16 v[80:83], v[32:35], a[160:163], v[80:83]
    ds_read_b128 v[56:59], v15 offset:45056
    v_mfma_f32_16x16x32_bf16 v[84:87], v[32:35], a[164:167], v[84:87]
    v_mfma_f32_16x16x32_bf16 v[88:91], v[36:39], a[160:163], v[88:91]
    ds_read_b128 v[60:63], v15 offset:46080
    s_add_u32 m0, s34, 55552
    v_mfma_f32_16x16x32_bf16 v[92:95], v[36:39], a[164:167], v[92:95]
    buffer_load_dwordx4 v8, s[12:15], s35 offen offset:1792 lds
    s_waitcnt lgkmcnt(4)
    v_mfma_f32_16x16x32_bf16 v[80:83], v[40:43], a[168:171], v[80:83]
    ds_read_b128 v[32:35], v14 offset:49152
    v_mfma_f32_16x16x32_bf16 v[84:87], v[40:43], a[172:175], v[84:87]
    v_mfma_f32_16x16x32_bf16 v[88:91], v[44:47], a[168:171], v[88:91]
    ds_read_b128 v[36:39], v14 offset:50176
    v_mfma_f32_16x16x32_bf16 v[92:95], v[44:47], a[172:175], v[92:95]
    s_waitcnt lgkmcnt(4)
    v_mfma_f32_16x16x32_bf16 v[80:83], v[48:51], a[176:179], v[80:83]
    ds_read_b128 v[40:43], v15 offset:49152
    v_mfma_f32_16x16x32_bf16 v[84:87], v[48:51], a[180:183], v[84:87]
    v_mfma_f32_16x16x32_bf16 v[88:91], v[52:55], a[176:179], v[88:91]
    ds_read_b128 v[44:47], v15 offset:50176
    s_add_u32 m0, s34, 59520
    v_mfma_f32_16x16x32_bf16 v[92:95], v[52:55], a[180:183], v[92:95]
    buffer_load_dwordx4 v8, s[12:15], s35 offen offset:1920 lds
    s_add_u32 s35, s35, 65536
    s_min_u32 s35, s35, s52
    s_waitcnt lgkmcnt(4)
    v_mfma_f32_16x16x32_bf16 v[80:83], v[56:59], a[184:187], v[80:83]
    ds_read_b128 v[48:51], v14 offset:53248
    v_mfma_f32_16x16x32_bf16 v[84:87], v[56:59], a[188:191], v[84:87]
    v_mfma_f32_16x16x32_bf16 v[88:91], v[60:63], a[184:187], v[88:91]
    ds_read_b128 v[52:55], v14 offset:54272
    v_mfma_f32_16x16x32_bf16 v[92:95], v[60:63], a[188:191], v[92:95]
    s_waitcnt vmcnt(8)
    s_barrier
    s_waitcnt lgkmcnt(4)
    v_mfma_f32_16x16x32_bf16 v[80:83], v[32:35], a[192:195], v[80:83]
    ds_read_b128 v[56:59], v15 offset:53248
    v_mfma_f32_16x16x32_bf16 v[84:87], v[32:35], a[196:199], v[84:87]
    v_mfma_f32_16x16x32_bf16 v[88:91], v[36:39], a[192:195], v[88:91]
    ds_read_b128 v[60:63], v15 offset:54272
    s_add_u32 m0, s34, 65536
    v_mfma_f32_16x16x32_bf16 v[92:95], v[36:39], a[196:199], v[92:95]
    buffer_load_dwordx4 v8, s[12:15], s35 offen offset:0 lds
    s_waitcnt lgkmcnt(4)
    v_mfma_f32_16x16x32_bf16 v[80:83], v[40:43], a[200:203], v[80:83]
    ds_read_b128 v[32:35], v14 offset:57344
    v_mfma_f32_16x16x32_bf16 v[84:87], v[40:43], a[204:207], v[84:87]
    buffer_store_dword v11, v10, s[4:7], 0 offen sc1
    v_add_u32 v11, 1, v11
    v_mfma_f32_16x16x32_bf16 v[88:91], v[44:47], a[200:203], v[88:91]
    ds_read_b128 v[36:39], v14 offset:58368
    v_mfma_f32_16x16x32_bf16 v[92:95], v[44:47], a[204:207], v[92:95]
    s_waitcnt lgkmcnt(4)
    v_mfma_f32_16x16x32_bf16 v[80:83], v[48:51], a[208:211], v[80:83]
    ds_read_b128 v[40:43], v15 offset:57344
    v_mfma_f32_16x16x32_bf16 v[84:87], v[48:51], a[212:215], v[84:87]
    v_mfma_f32_16x16x32_bf16 v[88:91], v[52:55], a[208:211], v[88:91]
    ds_read_b128 v[44:47], v15 offset:58368
    s_add_u32 m0, s34, 69504
    v_mfma_f32_16x16x32_bf16 v[92:95], v[52:55], a[212:215], v[92:95]
    buffer_load_dwordx4 v8, s[12:15], s35 offen offset:128 lds
    s_waitcnt lgkmcnt(4)
    v_mfma_f32_16x16x32_bf16 v[80:83], v[56:59], a[216:219], v[80:83]
    ds_read_b128 v[48:51], v14 offset:61440
    v_mfma_f32_16x16x32_bf16 v[84:87], v[56:59], a[220:223], v[84:87]
    v_mfma_f32_16x16x32_bf16 v[88:91], v[60:63], a[216:219], v[88:91]
    ds_read_b128 v[52:55], v14 offset:62464
    v_mfma_f32_16x16x32_bf16 v[92:95], v[60:63], a[220:223], v[92:95]
    s_waitcnt lgkmcnt(4)
    v_mfma_f32_16x16x32_bf16 v[80:83], v[32:35], a[224:227], v[80:83]
    ds_read_b128 v[56:59], v15 offset:61440
    v_mfma_f32_16x16x32_bf16 v[84:87], v[32:35], a[228:231], v[84:87]
    v_mfma_f32_16x16x32_bf16 v[88:91], v[36:39], a[224:227], v[88:91]
    ds_read_b128 v[60:63], v15 offset:62464
    s_add_u32 m0, s34, 73472
    v_mfma_f32_16x16x32_bf16 v[92:95], v[36:39], a[228:231], v[92:95]
    buffer_load_dwordx4 v8, s[12:15], s35 offen offset:256 lds
    s_waitcnt lgkmcnt(4)
    v_mfma_f32_16x16x32_bf16 v[80:83], v[40:43], a[232:235], v[80:83]
    ds_read_b128 v[32:35], v12 offset:0
    v_mfma_f32_16x16x32_bf16 v[84:87], v[40:43], a[236:239], v[84:87]
    v_mfma_f32_16x16x32_bf16 v[88:91], v[44:47], a[232:235], v[88:91]
    ds_read_b128 v[36:39], v12 offset:1024
    v_mfma_f32_16x16x32_bf16 v[92:95], v[44:47], a[236:239], v[92:95]
    s_waitcnt lgkmcnt(4)
    v_mfma_f32_16x16x32_bf16 v[80:83], v[48:51], a[240:243], v[80:83]
    ds_read_b128 v[40:43], v13 offset:0
    v_mfma_f32_16x16x32_bf16 v[84:87], v[48:51], a[244:247], v[84:87]
    v_mfma_f32_16x16x32_bf16 v[88:91], v[52:55], a[240:243], v[88:91]
    ds_read_b128 v[44:47], v13 offset:1024
    s_add_u32 m0, s34, 77440
    v_mfma_f32_16x16x32_bf16 v[92:95], v[52:55], a[244:247], v[92:95]
    buffer_load_dwordx4 v8, s[12:15], s35 offen offset:384 lds
    s_waitcnt lgkmcnt(4)
    v_mfma_f32_16x16x32_bf16 v[80:83], v[56:59], a[248:251], v[80:83]
    ds_read_b128 v[48:51], v12 offset:4096
    v_mfma_f32_16x16x32_bf16 v[84:87], v[56:59], a[252:255], v[84:87]
    v_mfma_f32_16x16x32_bf16 v[88:91], v[60:63], a[248:251], v[88:91]
    ds_read_b128 v[52:55], v12 offset:5120
    v_mfma_f32_16x16x32_bf16 v[92:95], v[60:63], a[252:255], v[92:95]
    s_add_u32 s30, s30, 2
    s_cmp_lt_u32 s30, s51
    s_cbranch_scc1 sl_loop_47
    v_cvt_pk_bf16_f32 v96, v80, v81
    v_cvt_pk_bf16_f32 v97, v82, v83
    s_nop 0
    v_cvt_pk_bf16_f32 v98, v88, v89
    v_cvt_pk_bf16_f32 v99, v90, v91
    v_cvt_pk_bf16_f32 v100, v84, v85
    v_cvt_pk_bf16_f32 v101, v86, v87
    v_cvt_pk_bf16_f32 v102, v92, v93
    v_cvt_pk_bf16_f32 v103, v94, v95
    s_branch sl_e_45
sl_e_45:
    buffer_store_dwordx4 v[96:99], v9, s[4:7], s36 offen sc1
    buffer_store_dwordx4 v[100:103], v9, s[4:7], s36 offen offset:128 sc1
    s_add_u32 s36, s36, s37
    s_waitcnt vmcnt(0) lgkmcnt(0)
    s_barrier
    buffer_store_dword v11, v10, s[4:7], 0 offen sc1
    s_branch L_ph2
L_ph2:
    s_cmp_ge_u32 s28, 96
    s_cbranch_scc1 L_ob
L_att:
    s_mov_b32 s42, 0x3e0293ee
    s_mov_b32 s58, 0x3e8293ee
    s_and_b32 s44, s28, 7
    s_lshl_b32 s44, s44, 2
    s_add_u32 s44, s44, s29
    s_lshl_b32 s31, s44, 11
    v_add_u32 v6, s31, v5
    v_lshrrev_b32 v9, 5, v1
    v_lshlrev_b32 v9, 7, v9
    v_and_b32 v4, 7, v1
    v_lshl_add_u32 v9, v4, 4, v9
    v_add_u32 v9, s31, v9
    s_add_u32 s31, s31, 4194304
    v_and_b32 v10, 31, v1
    v_lshlrev_b32 v10, 4, v10
    v_lshrrev_b32 v4, 5, v1
    v_lshl_add_u32 v10, v4, 3, v10
    v_add_u32 v10, s31, v10
    s_lshl_b32 s31, s44, 13
    v_add_u32 v8, s31, v5
    s_lshl_b32 s55, s44, 7
    s_add_u32 s55, s55, 115343360
    s_lshr_b32 s56, s44, 2
    s_lshl_b32 s56, s56, 7
    s_add_u32 s56, s56, 115347456
    s_lshl_b32 s57, s44, 7
    s_add_u32 s57, s57, 115351552
    s_lshl_b32 s31, s44, 7
    s_add_u32 s31, s31, 115343360
    v_mov_b32 v12, s31
    v_lshl_add_u32 v13, v1, 12, s31
    s_mov_b64 vcc, 1
    v_mov_b32 v4, 2130706432
    v_cndmask_b32 v12, v4, v12, vcc
    s_cmp_lt_u32 s28, 120
    s_cbranch_scc1 at_help_48
    s_mov_b32 s53, 0
    s_mov_b32 s54, 0
    s_mov_b32 s37, 1
    s_mov_b32 s38, 6
    s_mov_b32 s39, 32
    v_mov_b32 v2, 0
    s_mov_b32 s31, 16384
    buffer_store_dword v2, v12, s[4:7], s31 offen sc1
    s_mov_b32 s31, 32768
    buffer_store_dword v2, v13, s[4:7], s31 offen sc1
    s_waitcnt vmcnt(0)
    s_barrier
    s_cmp_lg_u32 s29, 0
    s_cbranch_scc1 at_i_50
    s_mov_b64 exec, 1
    v_mov_b32 v2, 0
    v_mov_b32 v3, 1
    s_waitcnt vmcnt(0)
    global_atomic_add v2, v3, s[92:93] offset:0 sc1
    s_mov_b64 exec, -1
at_i_50:
    s_cmp_lt_u32 s28, 96
    s_cbranch_scc1 tw_skip_51
    s_load_dwordx2 s[72:73], s[0:1], 40
    s_and_b32 s31, s28, 31
    s_lshl_b32 s31, s31, 13
    s_lshl_b32 s33, s29, 21
    s_add_u32 s31, s31, s33
    v_lshl_add_u32 v2, v1, 7, s31
    s_waitcnt lgkmcnt(0)
    s_mov_b32 s8, s72
    s_and_b32 s9, s73, 0xffff
    s_mov_b32 s10, 8388608
    s_mov_b32 s11, 0x00020000
    s_mov_b32 s31, 0
    buffer_load_dword v128, v2, s[8:11], s31 offen
    s_mov_b32 s31, 262144
    buffer_load_dword v129, v2, s[8:11], s31 offen
    s_mov_b32 s31, 524288
    buffer_load_dword v130, v2, s[8:11], s31 offen
    s_mov_b32 s31, 786432
    buffer_load_dword v131, v2, s[8:11], s31 offen
    s_mov_b32 s31, 1048576
    buffer_load_dword v132, v2, s[8:11], s31 offen
    s_mov_b32 s31, 1310720
    buffer_load_dword v133, v2, s[8:11], s31 offen
    s_mov_b32 s31, 1572864
    buffer_load_dword v134, v2, s[8:11], s31 offen
    s_mov_b32 s31, 1835008
    buffer_load_dword v135, v2, s[8:11], s31 offen
tw_skip_51:
    s_load_dwordx2 s[72:73], s[0:1], 0
    s_load_dwordx2 s[74:75], s[0:1], 56
    s_load_dwordx2 s[76:77], s[0:1], 72
    s_waitcnt lgkmcnt(0)
    s_mov_b32 s8, s72
    s_and_b32 s9, s73, 0xffff
    s_mov_b32 s10, 4194304
    s_mov_b32 s11, 0x00020000
    s_mov_b32 s12, s74
    s_and_b32 s13, s75, 0xffff
    s_mov_b32 s14, 4194304
    s_mov_b32 s15, 0x00020000
    s_mov_b32 s16, s76
    s_and_b32 s17, s77, 0xffff
    s_mov_b32 s18, 2097152
    s_mov_b32 s19, 0x00020000
    s_lshl_b32 s31, s44, 13
    v_lshl_add_u32 v11, v1, 7, s31
    buffer_load_dword v144, v11, s[8:11], 0 offen
    s_cmp_lg_u32 s29, 0
    s_cbranch_scc1 g_wdd_53
g_wd_52:
    s_load_dword s84, s[92:93], 128 glc
    s_add_u32 s41, s41, 1
    s_cmp_ge_u32 s41, 0x200000
    s_cbranch_scc1 g_wdd_53
    s_waitcnt lgkmcnt(0)
    s_and_b32 s84, s84, 0xffff
    s_cmp_ge_u32 s84, 96
    s_cbranch_scc1 g_wdd_53
    s_sleep 32
    s_branch g_wd_52
g_wdd_53:
    s_waitcnt lgkmcnt(0)
    s_barrier
    s_mov_b32 s31, 0
    buffer_load_dword v144, v11, s[8:11], s31 offen
    buffer_load_dword v145, v11, s[12:15], s31 offen
    s_mov_b32 s31, 262144
    buffer_load_dword v146, v11, s[8:11], s31 offen
    buffer_load_dword v147, v11, s[12:15], s31 offen
    s_mov_b32 s31, 524288
    buffer_load_dword v148, v11, s[8:11], s31 offen
    buffer_load_dword v149, v11, s[12:15], s31 offen
    s_mov_b32 s31, 786432
    buffer_load_dword v150, v11, s[8:11], s31 offen
    buffer_load_dword v151, v11, s[12:15], s31 offen
    s_mov_b32 s31, 1048576
    buffer_load_dword v152, v11, s[8:11], s31 offen
    buffer_load_dword v153, v11, s[12:15], s31 offen
    s_mov_b32 s31, 1310720
    buffer_load_dword v154, v11, s[8:11], s31 offen
    buffer_load_dword v155, v11, s[12:15], s31 offen
    s_mov_b32 s31, 1572864
    buffer_load_dword v156, v11, s[8:11], s31 offen
    buffer_load_dword v157, v11, s[12:15], s31 offen
    s_mov_b32 s31, 1835008
    buffer_load_dword v158, v11, s[8:11], s31 offen
    buffer_load_dword v159, v11, s[12:15], s31 offen
    s_mov_b32 s31, 2097152
    buffer_load_dword v160, v11, s[8:11], s31 offen
    buffer_load_dword v161, v11, s[12:15], s31 offen
    s_mov_b32 s31, 2359296
    buffer_load_dword v162, v11, s[8:11], s31 offen
    buffer_load_dword v163, v11, s[12:15], s31 offen
    s_mov_b32 s31, 2621440
    buffer_load_dword v164, v11, s[8:11], s31 offen
    buffer_load_dword v165, v11, s[12:15], s31 offen
    s_mov_b32 s31, 2883584
    buffer_load_dword v166, v11, s[8:11], s31 offen
    buffer_load_dword v167, v11, s[12:15], s31 offen
    s_mov_b32 s31, 3145728
    buffer_load_dword v168, v11, s[8:11], s31 offen
    buffer_load_dword v169, v11, s[12:15], s31 offen
    s_mov_b32 s31, 3407872
    buffer_load_dword v170, v11, s[8:11], s31 offen
    buffer_load_dword v171, v11, s[12:15], s31 offen
    s_mov_b32 s31, 3670016
    buffer_load_dword v172, v11, s[8:11], s31 offen
    buffer_load_dword v173, v11, s[12:15], s31 offen
    s_mov_b32 s31, 3932160
    buffer_load_dword v174, v11, s[8:11], s31 offen
    buffer_load_dword v175, v11, s[12:15], s31 offen
    s_mov_b32 s31, 0
    buffer_load_dword v176, v11, s[16:19], s31 offen
    s_mov_b32 s31, 262144
    buffer_load_dword v177, v11, s[16:19], s31 offen
    s_mov_b32 s31, 524288
    buffer_load_dword v178, v11, s[16:19], s31 offen
    s_mov_b32 s31, 786432
    buffer_load_dword v179, v11, s[16:19], s31 offen
    s_mov_b32 s31, 1048576
    buffer_load_dword v180, v11, s[16:19], s31 offen
    s_mov_b32 s31, 1310720
    buffer_load_dword v181, v11, s[16:19], s31 offen
    s_mov_b32 s31, 1572864
    buffer_load_dword v182, v11, s[16:19], s31 offen
    s_mov_b32 s31, 1835008
    buffer_load_dword v183, v11, s[16:19], s31 offen
    s_branch at_com_49
at_help_48:
    s_lshr_b32 s53, s28, 3
    s_add_u32 s53, s53, 6
    s_mov_b32 s54, 64
    s_mov_b32 s37, 12
    s_mov_b32 s38, 30
    s_lshr_b32 s39, s28, 3
    s_and_b32 s39, s39, 1
    s_add_u32 s39, s39, 30
    s_cmp_lt_u32 s28, 80
    s_cselect_b32 s39, 64, s39
at_com_49:
    v_and_b32 v11, 31, v1
    v_lshrrev_b32 v3, 5, v1
    v_lshlrev_b32 v3, 2, v3
    v_sub_u32 v11, v11, v3
    v_mov_b32 v14, 0xf149f2ca
    v_add_u32 v3, 0, v11
    v_and_b32 v3, 0xfffffff1, v3
    v_cmp_ne_u32 vcc, 0, v3
    s_nop 1
    v_cndmask_b32 v64, 0, v14, vcc
    v_add_u32 v3, -1, v11
    v_and_b32 v3, 0xfffffff1, v3
    v_cmp_ne_u32 vcc, 0, v3
    s_nop 1
    v_cndmask_b32 v65, 0, v14, vcc
    v_add_u32 v3, -2, v11
    v_and_b32 v3, 0xfffffff1, v3
    v_cmp_ne_u32 vcc, 0, v3
    s_nop 1
    v_cndmask_b32 v66, 0, v14, vcc
    v_add_u32 v3, -3, v11
    v_and_b32 v3, 0xfffffff1, v3
    v_cmp_ne_u32 vcc, 0, v3
    s_nop 1
    v_cndmask_b32 v67, 0, v14, vcc
    v_add_u32 v3, -8, v11
    v_and_b32 v3, 0xfffffff1, v3
    v_cmp_ne_u32 vcc, 0, v3
    s_nop 1
    v_cndmask_b32 v68, 0, v14, vcc
    v_add_u32 v3, -9, v11
    v_and_b32 v3, 0xfffffff1, v3
    v_cmp_ne_u32 vcc, 0, v3
    s_nop 1
    v_cndmask_b32 v69, 0, v14, vcc
    v_add_u32 v3, -10, v11
    v_and_b32 v3, 0xfffffff1, v3
    v_cmp_ne_u32 vcc, 0, v3
    s_nop 1
    v_cndmask_b32 v70, 0, v14, vcc
    v_add_u32 v3, -11, v11
    v_and_b32 v3, 0xfffffff1, v3
    v_cmp_ne_u32 vcc, 0, v3
    s_nop 1
    v_cndmask_b32 v71, 0, v14, vcc
    v_add_u32 v3, -16, v11
    v_and_b32 v3, 0xfffffff1, v3
    v_cmp_ne_u32 vcc, 0, v3
    s_nop 1
    v_cndmask_b32 v72, 0, v14, vcc
    v_add_u32 v3, -17, v11
    v_and_b32 v3, 0xfffffff1, v3
    v_cmp_ne_u32 vcc, 0, v3
    s_nop 1
    v_cndmask_b32 v73, 0, v14, vcc
    v_add_u32 v3, -18, v11
    v_and_b32 v3, 0xfffffff1, v3
    v_cmp_ne_u32 vcc, 0, v3
    s_nop 1
    v_cndmask_b32 v74, 0, v14, vcc
    v_add_u32 v3, -19, v11
    v_and_b32 v3, 0xfffffff1, v3
    v_cmp_ne_u32 vcc, 0, v3
    s_nop 1
    v_cndmask_b32 v75, 0, v14, vcc
    v_add_u32 v3, -24, v11
    v_and_b32 v3, 0xfffffff1, v3
    v_cmp_ne_u32 vcc, 0, v3
    s_nop 1
    v_cndmask_b32 v76, 0, v14, vcc
    v_add_u32 v3, -25, v11
    v_and_b32 v3, 0xfffffff1, v3
    v_cmp_ne_u32 vcc, 0, v3
    s_nop 1
    v_cndmask_b32 v77, 0, v14, vcc
    v_add_u32 v3, -26, v11
    v_and_b32 v3, 0xfffffff1, v3
    v_cmp_ne_u32 vcc, 0, v3
    s_nop 1
    v_cndmask_b32 v78, 0, v14, vcc
    v_add_u32 v3, -27, v11
    v_and_b32 v3, 0xfffffff1, v3
    v_cmp_ne_u32 vcc, 0, v3
    s_nop 1
    v_cndmask_b32 v79, 0, v14, vcc
    v_cmp_gt_i32 vcc, 0, v11
    s_nop 1
    v_cndmask_b32 v96, 0, v14, vcc
    v_cmp_gt_i32 vcc, 1, v11
    s_nop 1
    v_cndmask_b32 v97, 0, v14, vcc
    v_cmp_gt_i32 vcc, 2, v11
    s_nop 1
    v_cndmask_b32 v98, 0, v14, vcc
    v_cmp_gt_i32 vcc, 3, v11
    s_nop 1
    v_cndmask_b32 v99, 0, v14, vcc
    v_cmp_gt_i32 vcc, 8, v11
    s_nop 1
    v_cndmask_b32 v100, 0, v14, vcc
    v_cmp_gt_i32 vcc, 9, v11
    s_nop 1
    v_cndmask_b32 v101, 0, v14, vcc
    v_cmp_gt_i32 vcc, 10, v11
    s_nop 1
    v_cndmask_b32 v102, 0, v14, vcc
    v_cmp_gt_i32 vcc, 11, v11
    s_nop 1
    v_cndmask_b32 v103, 0, v14, vcc
    v_cmp_gt_i32 vcc, 16, v11
    s_nop 1
    v_cndmask_b32 v104, 0, v14, vcc
    v_cmp_gt_i32 vcc, 17, v11
    s_nop 1
    v_cndmask_b32 v105, 0, v14, vcc
    v_cmp_gt_i32 vcc, 18, v11
    s_nop 1
    v_cndmask_b32 v106, 0, v14, vcc
    v_cmp_gt_i32 vcc, 19, v11
    s_nop 1
    v_cndmask_b32 v107, 0, v14, vcc
    v_cmp_gt_i32 vcc, 24, v11
    s_nop 1
    v_cndmask_b32 v108, 0, v14, vcc
    v_cmp_gt_i32 vcc, 25, v11
    s_nop 1
    v_cndmask_b32 v109, 0, v14, vcc
    v_cmp_gt_i32 vcc, 26, v11
    s_nop 1
    v_cndmask_b32 v110, 0, v14, vcc
    v_cmp_gt_i32 vcc, 27, v11
    s_nop 1
    v_cndmask_b32 v111, 0, v14, vcc
    v_mov_b32 v80, 0xf149f2ca
    v_mov_b32 v81, 0xf149f2ca
    v_mov_b32 v82, 0xf149f2ca
    v_mov_b32 v83, 0xf149f2ca
    v_mov_b32 v84, 0xf149f2ca
    v_mov_b32 v85, 0xf149f2ca
    v_mov_b32 v86, 0xf149f2ca
    v_mov_b32 v87, 0xf149f2ca
    v_mov_b32 v88, 0xf149f2ca
    v_mov_b32 v89, 0xf149f2ca
    v_mov_b32 v90, 0xf149f2ca
    v_mov_b32 v91, 0xf149f2ca
    v_mov_b32 v92, 0xf149f2ca
    v_mov_b32 v93, 0xf149f2ca
    v_mov_b32 v94, 0xf149f2ca
    v_mov_b32 v95, 0xf149f2ca
    v_accvgpr_write_b32 a184, 0
    v_accvgpr_write_b32 a185, 0
    v_accvgpr_write_b32 a186, 0
    v_accvgpr_write_b32 a187, 0
    v_accvgpr_write_b32 a188, 0
    v_accvgpr_write_b32 a189, 0
    v_accvgpr_write_b32 a190, 0
    v_accvgpr_write_b32 a191, 0
    v_accvgpr_write_b32 a192, 0
    v_accvgpr_write_b32 a193, 0
    v_accvgpr_write_b32 a194, 0
    v_accvgpr_write_b32 a195, 0
    v_accvgpr_write_b32 a128, 0
    v_accvgpr_write_b32 a129, 0
    v_accvgpr_write_b32 a130, 0
    v_accvgpr_write_b32 a131, 0
    v_accvgpr_write_b32 a132, 0
    v_accvgpr_write_b32 a133, 0
    v_accvgpr_write_b32 a134, 0
    v_accvgpr_write_b32 a135, 0
    v_accvgpr_write_b32 a136, 0
    v_accvgpr_write_b32 a137, 0
    v_accvgpr_write_b32 a138, 0
    v_accvgpr_write_b32 a139, 0
    v_accvgpr_write_b32 a140, 0
    v_accvgpr_write_b32 a141, 0
    v_accvgpr_write_b32 a142, 0
    v_accvgpr_write_b32 a143, 0
    v_mov_b32 v40, 0
    v_mov_b32 v41, 0
    v_mov_b32 v42, 0
    v_mov_b32 v43, 0
    s_cmp_lg_u32 s29, 0
    s_cbranch_scc1 g_wdd_55
g_wd_54:
    s_load_dword s72, s[92:93], 0 glc
    s_add_u32 s41, s41, 1
    s_cmp_ge_u32 s41, 0x200000
    s_cbranch_scc1 g_wdd_55
    s_waitcnt lgkmcnt(0)
    s_and_b32 s72, s72, 0xffff
    s_cmp_ge_u32 s72, 256
    s_cbranch_scc1 g_wdd_55
    s_sleep 32
    s_branch g_wd_54
g_wdd_55:
    s_waitcnt lgkmcnt(0)
    s_barrier
    s_add_u32 s49, s53, s37
    s_cmp_lt_u32 s49, s38
    s_cbranch_scc1 at_nx_63
    s_max_u32 s49, s49, s39
    s_cmp_eq_u32 s38, 255
    s_cselect_b32 s49, s49, s39
    s_mov_b32 s37, 3
    s_mov_b32 s38, 255
at_nx_63:
g_wf_64:
    s_load_dwordx4 s[72:75], s[90:91], s56 glc
    s_add_u32 s41, s41, 1
    s_cmp_ge_u32 s41, 0x200000
    s_cbranch_scc1 g_wfd_65
    s_waitcnt lgkmcnt(0)
    s_min_u32 s76, s72, s73
    s_min_u32 s76, s76, s74
    s_cmp_ge_u32 s76, 1
    s_cbranch_scc1 g_wfd_65
    s_sleep 4
    s_branch g_wf_64
g_wfd_65:
    s_waitcnt lgkmcnt(0)
    s_mov_b32 s35, 0
    s_add_u32 s31, s35, 50331648
    buffer_load_dwordx4 a[160:163], v6, s[4:7], s31 offen offset:0 sc1
    buffer_load_dwordx4 a[164:167], v6, s[4:7], s31 offen offset:1024 sc1
    s_add_u32 s31, s35, 54525952
    buffer_load_dwordx4 a[168:171], v6, s[4:7], s31 offen offset:0 sc1
    buffer_load_dwordx4 a[172:175], v6, s[4:7], s31 offen offset:1024 sc1
    s_add_u32 s31, s35, 58720256
    buffer_load_dwordx4 a[176:179], v6, s[4:7], s31 offen offset:0 sc1
    buffer_load_dwordx4 a[180:183], v6, s[4:7], s31 offen offset:1024 sc1
    s_add_u32 s32, s53, 1
g_wf_66:
    s_load_dwordx4 s[72:75], s[90:91], s55 glc
    s_add_u32 s41, s41, 1
    s_cmp_ge_u32 s41, 0x200000
    s_cbranch_scc1 g_wfd_67
    s_waitcnt lgkmcnt(0)
    s_min_u32 s76, s72, s73
    s_min_u32 s76, s76, s74
    s_cmp_ge_u32 s76, s32
    s_cbranch_scc1 g_wfd_67
    s_sleep 4
    s_branch g_wf_66
g_wfd_67:
    s_waitcnt lgkmcnt(0)
    s_lshl_b32 s36, s53, 18
    s_add_u32 s31, s36, 0
    buffer_load_dwordx4 a[0:3], v8, s[4:7], s31 offen offset:0 sc1
    buffer_load_dwordx4 a[4:7], v8, s[4:7], s31 offen offset:1024 sc1
    buffer_load_dwordx4 a[8:11], v8, s[4:7], s31 offen offset:2048 sc1
    buffer_load_dwordx4 a[12:15], v8, s[4:7], s31 offen offset:3072 sc1
    s_add_u32 s31, s36, 4096
    buffer_load_dwordx4 a[16:19], v8, s[4:7], s31 offen offset:0 sc1
    buffer_load_dwordx4 a[20:23], v8, s[4:7], s31 offen offset:1024 sc1
    buffer_load_dwordx4 a[24:27], v8, s[4:7], s31 offen offset:2048 sc1
    buffer_load_dwordx4 a[28:31], v8, s[4:7], s31 offen offset:3072 sc1
    s_add_u32 s31, s36, 16777216
    buffer_load_dwordx4 a[32:35], v8, s[4:7], s31 offen offset:0 sc1
    buffer_load_dwordx4 a[36:39], v8, s[4:7], s31 offen offset:1024 sc1
    buffer_load_dwordx4 a[40:43], v8, s[4:7], s31 offen offset:2048 sc1
    buffer_load_dwordx4 a[44:47], v8, s[4:7], s31 offen offset:3072 sc1
    s_add_u32 s31, s36, 16781312
    buffer_load_dwordx4 a[48:51], v8, s[4:7], s31 offen offset:0 sc1
    buffer_load_dwordx4 a[52:55], v8, s[4:7], s31 offen offset:1024 sc1
    buffer_load_dwordx4 a[56:59], v8, s[4:7], s31 offen offset:2048 sc1
    buffer_load_dwordx4 a[60:63], v8, s[4:7], s31 offen offset:3072 sc1
    s_add_u32 s31, s36, 33554432
    buffer_load_dwordx4 a[96:99], v8, s[4:7], s31 offen offset:0 sc1
    buffer_load_dwordx4 a[100:103], v8, s[4:7], s31 offen offset:1024 sc1
    buffer_load_dwordx4 a[104:107], v8, s[4:7], s31 offen offset:2048 sc1
    buffer_load_dwordx4 a[108:111], v8, s[4:7], s31 offen offset:3072 sc1
    s_add_u32 s31, s36, 33558528
    buffer_load_dwordx4 a[112:115], v8, s[4:7], s31 offen offset:0 sc1
    buffer_load_dwordx4 a[116:119], v8, s[4:7], s31 offen offset:1024 sc1
    buffer_load_dwordx4 a[120:123], v8, s[4:7], s31 offen offset:2048 sc1
    buffer_load_dwordx4 a[124:127], v8, s[4:7], s31 offen offset:3072 sc1
    s_mov_b32 s43, 20480
    s_mov_b32 s45, 0
    s_mov_b32 s51, 0
    s_waitcnt vmcnt(0)
at_poll_61:
    s_load_dwordx4 s[72:75], s[90:91], s57 glc
    s_load_dwordx4 s[76:79], s[90:91], s55 glc
    s_load_dwordx4 s[80:83], s[90:91], s56 glc
at_top_56:
    s_waitcnt lgkmcnt(0)
    s_min_u32 s72, s72, s73
    s_min_u32 s72, s72, s74
    s_min_u32 s72, s72, s75
    s_min_u32 s76, s76, s77
    s_min_u32 s76, s76, s78
    s_min_u32 s80, s80, s81
    s_min_u32 s80, s80, s82
    s_min_u32 s77, s49, 63
    s_cmp_gt_u32 s76, s77
    s_cselect_b32 s72, s72, 0
    s_min_u32 s72, s72, 64
    s_sub_u32 s81, s80, 1
    s_cmp_ge_u32 s80, 64
    s_cselect_b32 s80, 64, s81
    s_cmp_lt_u32 s54, s80
    s_cbranch_scc1 at_b_58
    s_cmp_lt_u32 s53, s72
    s_cbranch_scc1 at_a_57
    s_cmp_eq_u32 s43, 20480
    s_cbranch_scc1 at_nf_62
    s_waitcnt vmcnt(0)
    v_mov_b32 v2, s45
    buffer_store_dword v2, v12, s[4:7], s43 offen sc1
    s_mov_b32 s43, 20480
at_nf_62:
    s_cmp_ge_u32 s53, 64
    s_cselect_b32 s31, s54, 0
    s_cmp_ge_u32 s31, 64
    s_cbranch_scc1 at_end_59
    s_add_u32 s41, s41, 1
    s_cmp_ge_u32 s41, 0x200000
    s_cbranch_scc1 at_end_59
    s_sleep 1
    s_branch at_poll_61
at_a_57:
    s_lshl_b32 s46, s53, 16
    s_add_u32 s46, s46, 88080384
    s_cmp_lg_u32 s51, 0
    s_cbranch_scc1 at_k1_68
    s_mov_b32 exec_lo, 0xff
    s_mov_b32 exec_hi, 0xff
    buffer_load_dwordx4 a[64:67], v9, s[4:7], s46 offen offset:0 sc1
    buffer_load_dwordx4 a[68:71], v9, s[4:7], s46 offen offset:256 sc1
    buffer_load_dwordx4 a[72:75], v9, s[4:7], s46 offen offset:512 sc1
    buffer_load_dwordx4 a[76:79], v9, s[4:7], s46 offen offset:768 sc1
    buffer_load_dwordx4 a[80:83], v9, s[4:7], s46 offen offset:1024 sc1
    buffer_load_dwordx4 a[84:87], v9, s[4:7], s46 offen offset:1280 sc1
    buffer_load_dwordx4 a[88:91], v9, s[4:7], s46 offen offset:1536 sc1
    buffer_load_dwordx4 a[92:95], v9, s[4:7], s46 offen offset:1792 sc1
    s_mov_b64 exec, -1
    buffer_load_dwordx2 a[128:129], v10, s[4:7], s46 offen offset:0 sc1
    buffer_load_dwordx2 a[132:133], v10, s[4:7], s46 offen offset:512 sc1
    buffer_load_dwordx2 a[136:137], v10, s[4:7], s46 offen offset:1024 sc1
    buffer_load_dwordx2 a[140:141], v10, s[4:7], s46 offen offset:1536 sc1
at_k1_68:
    s_lshl_b32 s47, s53, 18
    s_add_u32 s47, s47, 67108864
    s_cmp_lt_u32 s49, s72
    s_cselect_b32 s52, 1, 0
    s_cmp_lt_u32 s49, 64
    s_cselect_b32 s32, s49, s53
    s_lshl_b32 s36, s32, 18
    s_lshl_b32 s46, s32, 16
    s_add_u32 s46, s46, 88080384
    s_load_dwordx4 s[72:75], s[90:91], s57 glc
    s_load_dwordx4 s[76:79], s[90:91], s55 glc
    s_load_dwordx4 s[80:83], s[90:91], s56 glc
    v_mfma_f32_32x32x16_bf16 v[112:127], a[32:35], a[0:3], v[96:111]
    v_mfma_f32_32x32x16_bf16 v[112:127], a[36:39], a[4:7], v[112:127]
    v_mfma_f32_32x32x16_bf16 v[112:127], a[40:43], a[8:11], v[112:127]
    v_mfma_f32_32x32x16_bf16 v[112:127], a[44:47], a[12:15], v[112:127]
    v_mfma_f32_32x32x16_bf16 v[112:127], a[48:51], a[16:19], v[112:127]
    v_mfma_f32_32x32x16_bf16 v[112:127], a[52:55], a[20:23], v[112:127]
    v_mfma_f32_32x32x16_bf16 v[112:127], a[56:59], a[24:27], v[112:127]
    v_mfma_f32_32x32x16_bf16 v[112:127], a[60:63], a[28:31], v[112:127]
    s_cmp_lg_u32 s51, 0
    s_cbranch_scc1 at_k2_69
    s_waitcnt vmcnt(4)
at_k2_69:
    s_add_u32 s31, s36, 16777216
    buffer_load_dwordx4 a[32:35], v8, s[4:7], s31 offen offset:0 sc1
    buffer_load_dwordx4 a[36:39], v8, s[4:7], s31 offen offset:1024 sc1
    buffer_load_dwordx4 a[40:43], v8, s[4:7], s31 offen offset:2048 sc1
    buffer_load_dwordx4 a[44:47], v8, s[4:7], s31 offen offset:3072 sc1
    s_add_u32 s31, s36, 16781312
    buffer_load_dwordx4 a[48:51], v8, s[4:7], s31 offen offset:0 sc1
    buffer_load_dwordx4 a[52:55], v8, s[4:7], s31 offen offset:1024 sc1
    buffer_load_dwordx4 a[56:59], v8, s[4:7], s31 offen offset:2048 sc1
    buffer_load_dwordx4 a[60:63], v8, s[4:7], s31 offen offset:3072 sc1
    v_mfma_f32_32x32x16_bf16 v[128:143], a[64:67], a[0:3], 0
    v_mfma_f32_32x32x16_bf16 v[128:143], a[68:71], a[4:7], v[128:143]
    v_mfma_f32_32x32x16_bf16 v[128:143], a[72:75], a[8:11], v[128:143]
    v_mfma_f32_32x32x16_bf16 v[128:143], a[76:79], a[12:15], v[128:143]
    v_mfma_f32_32x32x16_bf16 v[128:143], a[80:83], a[16:19], v[128:143]
    v_mfma_f32_32x32x16_bf16 v[128:143], a[84:87], a[20:23], v[128:143]
    v_mfma_f32_32x32x16_bf16 v[128:143], a[88:91], a[24:27], v[128:143]
    v_mfma_f32_32x32x16_bf16 v[128:143], a[92:95], a[28:31], v[128:143]
    s_mov_b32 s51, s52
    s_add_u32 s31, s36, 0
    buffer_load_dwordx4 a[0:3], v8, s[4:7], s31 offen offset:0 sc1
    buffer_load_dwordx4 a[4:7], v8, s[4:7], s31 offen offset:1024 sc1
    buffer_load_dwordx4 a[8:11], v8, s[4:7], s31 offen offset:2048 sc1
    buffer_load_dwordx4 a[12:15], v8, s[4:7], s31 offen offset:3072 sc1
    s_add_u32 s31, s36, 4096
    buffer_load_dwordx4 a[16:19], v8, s[4:7], s31 offen offset:0 sc1
    buffer_load_dwordx4 a[20:23], v8, s[4:7], s31 offen offset:1024 sc1
    buffer_load_dwordx4 a[24:27], v8, s[4:7], s31 offen offset:2048 sc1
    buffer_load_dwordx4 a[28:31], v8, s[4:7], s31 offen offset:3072 sc1
    s_cmp_eq_u32 s51, 0
    s_cbranch_scc1 at_k3_70
    s_mov_b32 exec_lo, 0xff
    s_mov_b32 exec_hi, 0xff
    buffer_load_dwordx4 a[64:67], v9, s[4:7], s46 offen offset:0 sc1
    buffer_load_dwordx4 a[68:71], v9, s[4:7], s46 offen offset:256 sc1
    buffer_load_dwordx4 a[72:75], v9, s[4:7], s46 offen offset:512 sc1
    buffer_load_dwordx4 a[76:79], v9, s[4:7], s46 offen offset:768 sc1
    buffer_load_dwordx4 a[80:83], v9, s[4:7], s46 offen offset:1024 sc1
    buffer_load_dwordx4 a[84:87], v9, s[4:7], s46 offen offset:1280 sc1
    buffer_load_dwordx4 a[88:91], v9, s[4:7], s46 offen offset:1536 sc1
    buffer_load_dwordx4 a[92:95], v9, s[4:7], s46 offen offset:1792 sc1
    s_mov_b64 exec, -1
at_k3_70:
    v_max3_f32 v14, v112, v113, v114
    v_max3_f32 v14, v14, v115, v116
    v_max3_f32 v14, v14, v117, v118
    v_max3_f32 v14, v14, v119, v120
    v_max3_f32 v14, v14, v121, v122
    v_max3_f32 v14, v14, v123, v124
    v_max3_f32 v14, v14, v125, v126
    v_max3_f32 v14, v14, v127, v128
    v_max3_f32 v14, v14, v129, v130
    v_max_f32 v14, v14, v131
    v_mov_b32 v15, v14
    s_nop 1
    v_permlane32_swap_b32 v14, v15
    v_max_f32 v14, v14, v15
    v_mul_f32 v14, s42, v14
    v_fma_f32 v112, v112, s42, -v14
    v_fma_f32 v113, v113, s42, -v14
    v_fma_f32 v114, v114, s42, -v14
    v_fma_f32 v115, v115, s42, -v14
    v_fma_f32 v116, v116, s42, -v14
    v_fma_f32 v117, v117, s42, -v14
    v_fma_f32 v118, v118, s42, -v14
    v_fma_f32 v119, v119, s42, -v14
    v_fma_f32 v120, v120, s42, -v14
    v_fma_f32 v121, v121, s42, -v14
    v_fma_f32 v122, v122, s42, -v14
    v_fma_f32 v123, v123, s42, -v14
    v_fma_f32 v124, v124, s42, -v14
    v_fma_f32 v125, v125, s42, -v14
    v_fma_f32 v126, v126, s42, -v14
    v_fma_f32 v127, v127, s42, -v14
    v_fma_f32 v128, v128, s42, -v14
    v_fma_f32 v129, v129, s42, -v14
    v_fma_f32 v130, v130, s42, -v14
    v_fma_f32 v131, v131, s42, -v14
    v_exp_f32 v112, v112
    v_exp_f32 v113, v113
    v_exp_f32 v114, v114
    v_exp_f32 v115, v115
    v_exp_f32 v116, v116
    v_exp_f32 v117, v117
    v_exp_f32 v118, v118
    v_exp_f32 v119, v119
    v_exp_f32 v120, v120
    v_exp_f32 v121, v121
    v_exp_f32 v122, v122
    v_exp_f32 v123, v123
    v_exp_f32 v124, v124
    v_exp_f32 v125, v125
    v_exp_f32 v126, v126
    v_exp_f32 v127, v127
    v_exp_f32 v128, v128
    v_exp_f32 v129, v129
    v_exp_f32 v130, v130
    v_exp_f32 v131, v131
    v_add_f32 v26, v112, v113
    v_add_f32 v15, v114, v115
    v_add_f32 v26, v26, v116
    v_add_f32 v15, v15, v117
    v_add_f32 v26, v26, v118
    v_add_f32 v15, v15, v119
    v_add_f32 v26, v26, v120
    v_add_f32 v15, v15, v121
    v_add_f32 v26, v26, v122
    v_add_f32 v15, v15, v123
    v_add_f32 v26, v26, v124
    v_add_f32 v15, v15, v125
    v_add_f32 v26, v26, v126
    v_add_f32 v15, v15, v127
    v_add_f32 v26, v26, v128
    v_add_f32 v15, v15, v129
    v_add_f32 v26, v26, v130
    v_add_f32 v15, v15, v131
    v_add_f32 v26, v26, v15
    v_mov_b32 v15, v26
    s_nop 1
    v_permlane32_swap_b32 v26, v15
    v_add_f32 v26, v26, v15
    v_rcp_f32 v26, v26
    v_cvt_pk_bf16_f32 v28, v112, v113
    v_cvt_pk_bf16_f32 v29, v114, v115
    v_cvt_pk_bf16_f32 v30, v116, v117
    v_cvt_pk_bf16_f32 v31, v118, v119
    v_cvt_pk_bf16_f32 v32, v120, v121
    v_cvt_pk_bf16_f32 v33, v122, v123
    v_cvt_pk_bf16_f32 v34, v124, v125
    v_cvt_pk_bf16_f32 v35, v126, v127
    v_cvt_pk_bf16_f32 v40, v128, v129
    v_cvt_pk_bf16_f32 v41, v130, v131
    s_waitcnt vmcnt(16)
    v_mov_b32 v2, s45
    buffer_store_dword v2, v12, s[4:7], s43 offen sc1
    v_mfma_f32_32x32x16_bf16 v[144:159], a[96:99], v[28:31], 0
    v_mfma_f32_32x32x16_bf16 v[144:159], a[100:103], v[32:35], v[144:159]
    v_mfma_f32_32x32x16_bf16 v[144:159], a[128:131], v[40:43], v[144:159]
    v_mfma_f32_32x32x16_bf16 v[160:175], a[104:107], v[28:31], 0
    v_mfma_f32_32x32x16_bf16 v[160:175], a[108:111], v[32:35], v[160:175]
    v_mfma_f32_32x32x16_bf16 v[160:175], a[132:135], v[40:43], v[160:175]
    v_mfma_f32_32x32x16_bf16 v[176:191], a[112:115], v[28:31], 0
    s_nop 7
    v_mul_f32 v144, v144, v26
    v_mul_f32 v145, v145, v26
    v_mul_f32 v146, v146, v26
    v_mul_f32 v147, v147, v26
    v_mul_f32 v148, v148, v26
    v_mul_f32 v149, v149, v26
    v_mfma_f32_32x32x16_bf16 v[176:191], a[116:119], v[32:35], v[176:191]
    v_mul_f32 v150, v150, v26
    v_mul_f32 v151, v151, v26
    v_mul_f32 v152, v152, v26
    v_mul_f32 v153, v153, v26
    v_mul_f32 v154, v154, v26
    v_mul_f32 v155, v155, v26
    v_mfma_f32_32x32x16_bf16 v[176:191], a[136:139], v[40:43], v[176:191]
    v_mul_f32 v156, v156, v26
    v_mul_f32 v157, v157, v26
    v_mul_f32 v158, v158, v26
    v_mul_f32 v159, v159, v26
    v_cvt_pk_bf16_f32 v208, v144, v145
    v_cvt_pk_bf16_f32 v209, v146, v147
    v_mfma_f32_32x32x16_bf16 v[192:207], a[120:123], v[28:31], 0
    v_cvt_pk_bf16_f32 v210, v148, v149
    v_cvt_pk_bf16_f32 v211, v150, v151
    v_cvt_pk_bf16_f32 v212, v152, v153
    v_cvt_pk_bf16_f32 v213, v154, v155
    v_cvt_pk_bf16_f32 v214, v156, v157
    v_cvt_pk_bf16_f32 v215, v158, v159
    v_mfma_f32_32x32x16_bf16 v[192:207], a[124:127], v[32:35], v[192:207]
    v_mul_f32 v160, v160, v26
    v_mul_f32 v161, v161, v26
    v_mul_f32 v162, v162, v26
    v_mul_f32 v163, v163, v26
    v_mul_f32 v164, v164, v26
    v_mul_f32 v165, v165, v26
    v_mfma_f32_32x32x16_bf16 v[192:207], a[140:143], v[40:43], v[192:207]
    v_mul_f32 v166, v166, v26
    v_mul_f32 v167, v167, v26
    v_mul_f32 v168, v168, v26
    v_mul_f32 v169, v169, v26
    v_mul_f32 v170, v170, v26
    v_mul_f32 v171, v171, v26
    s_add_u32 s31, s36, 33554432
    buffer_load_dwordx4 a[96:99], v8, s[4:7], s31 offen offset:0 sc1
    buffer_load_dwordx4 a[100:103], v8, s[4:7], s31 offen offset:1024 sc1
    buffer_load_dwordx4 a[104:107], v8, s[4:7], s31 offen offset:2048 sc1
    buffer_load_dwordx4 a[108:111], v8, s[4:7], s31 offen offset:3072 sc1
    s_add_u32 s31, s36, 33558528
    buffer_load_dwordx4 a[112:115], v8, s[4:7], s31 offen offset:0 sc1
    buffer_load_dwordx4 a[116:119], v8, s[4:7], s31 offen offset:1024 sc1
    buffer_load_dwordx4 a[120:123], v8, s[4:7], s31 offen offset:2048 sc1
    buffer_load_dwordx4 a[124:127], v8, s[4:7], s31 offen offset:3072 sc1
    s_cmp_eq_u32 s51, 0
    s_cbranch_scc1 at_k4_71
    buffer_load_dwordx2 a[128:129], v10, s[4:7], s46 offen offset:0 sc1
    buffer_load_dwordx2 a[132:133], v10, s[4:7], s46 offen offset:512 sc1
    buffer_load_dwordx2 a[136:137], v10, s[4:7], s46 offen offset:1024 sc1
    buffer_load_dwordx2 a[140:141], v10, s[4:7], s46 offen offset:1536 sc1
at_k4_71:
    v_mul_f32 v172, v172, v26
    v_mul_f32 v173, v173, v26
    v_mul_f32 v174, v174, v26
    v_mul_f32 v175, v175, v26
    v_cvt_pk_bf16_f32 v216, v160, v161
    v_cvt_pk_bf16_f32 v217, v162, v163
    v_cvt_pk_bf16_f32 v218, v164, v165
    v_cvt_pk_bf16_f32 v219, v166, v167
    v_cvt_pk_bf16_f32 v220, v168, v169
    v_cvt_pk_bf16_f32 v221, v170, v171
    v_cvt_pk_bf16_f32 v222, v172, v173
    v_cvt_pk_bf16_f32 v223, v174, v175
    v_mul_f32 v176, v176, v26
    v_mul_f32 v177, v177, v26
    v_mul_f32 v178, v178, v26
    v_mul_f32 v179, v179, v26
    v_mul_f32 v180, v180, v26
    v_mul_f32 v181, v181, v26
    v_mul_f32 v182, v182, v26
    v_mul_f32 v183, v183, v26
    v_mul_f32 v184, v184, v26
    v_mul_f32 v185, v185, v26
    v_mul_f32 v186, v186, v26
    v_mul_f32 v187, v187, v26
    v_mul_f32 v188, v188, v26
    v_mul_f32 v189, v189, v26
    v_mul_f32 v190, v190, v26
    v_mul_f32 v191, v191, v26
    v_cvt_pk_bf16_f32 v224, v176, v177
    v_cvt_pk_bf16_f32 v225, v178, v179
    v_cvt_pk_bf16_f32 v226, v180, v181
    v_cvt_pk_bf16_f32 v227, v182, v183
    v_cvt_pk_bf16_f32 v228, v184, v185
    v_cvt_pk_bf16_f32 v229, v186, v187
    v_cvt_pk_bf16_f32 v230, v188, v189
    v_cvt_pk_bf16_f32 v231, v190, v191
    v_mul_f32 v192, v192, v26
    v_mul_f32 v193, v193, v26
    v_mul_f32 v194, v194, v26
    v_mul_f32 v195, v195, v26
    v_mul_f32 v196, v196, v26
    v_mul_f32 v197, v197, v26
    v_mul_f32 v198, v198, v26
    v_mul_f32 v199, v199, v26
    v_mul_f32 v200, v200, v26
    v_mul_f32 v201, v201, v26
    v_mul_f32 v202, v202, v26
    v_mul_f32 v203, v203, v26
    v_mul_f32 v204, v204, v26
    v_mul_f32 v205, v205, v26
    v_mul_f32 v206, v206, v26
    v_mul_f32 v207, v207, v26
    v_cvt_pk_bf16_f32 v232, v192, v193
    v_cvt_pk_bf16_f32 v233, v194, v195
    v_cvt_pk_bf16_f32 v234, v196, v197
    v_cvt_pk_bf16_f32 v235, v198, v199
    v_cvt_pk_bf16_f32 v236, v200, v201
    v_cvt_pk_bf16_f32 v237, v202, v203
    v_cvt_pk_bf16_f32 v238, v204, v205
    v_cvt_pk_bf16_f32 v239, v206, v207
    s_add_u32 s31, s47, 0
    buffer_store_dwordx4 v[208:211], v8, s[4:7], s31 offen offset:0 sc1
    buffer_store_dwordx4 v[212:215], v8, s[4:7], s31 offen offset:1024 sc1
    buffer_store_dwordx4 v[216:219], v8, s[4:7], s31 offen offset:2048 sc1
    buffer_store_dwordx4 v[220:223], v8, s[4:7], s31 offen offset:3072 sc1
    s_add_u32 s31, s47, 4096
    buffer_store_dwordx4 v[224:227], v8, s[4:7], s31 offen offset:0 sc1
    buffer_store_dwordx4 v[228:231], v8, s[4:7], s31 offen offset:1024 sc1
    buffer_store_dwordx4 v[232:235], v8, s[4:7], s31 offen offset:2048 sc1
    buffer_store_dwordx4 v[236:239], v8, s[4:7], s31 offen offset:3072 sc1
    s_mov_b32 s45, 1
    s_lshl_b32 s43, s53, 12
    s_add_u32 s43, s43, 32768
    s_mov_b32 s53, s49
    s_add_u32 s49, s53, s37
    s_cmp_lt_u32 s49, s38
    s_cbranch_scc1 at_nx_72
    s_max_u32 s49, s49, s39
    s_cmp_eq_u32 s38, 255
    s_cselect_b32 s49, s49, s39
    s_mov_b32 s37, 3
    s_mov_b32 s38, 255
at_nx_72:
    s_waitcnt vmcnt(17)
    s_branch at_top_56
at_b_58:
    s_load_dwordx4 s[72:75], s[90:91], s57 glc
    s_load_dwordx4 s[76:79], s[90:91], s55 glc
    s_load_dwordx4 s[80:83], s[90:91], s56 glc
    s_lshl_b32 s48, s54, 16
    s_add_u32 s48, s48, 83886080
    s_add_u32 s32, s54, 1
    s_min_u32 s32, s32, 63
    s_lshl_b32 s35, s32, 16
    v_mfma_f32_32x32x16_bf16 v[128:143], a[184:187], a[160:163], v[80:95]
    v_mfma_f32_32x32x16_bf16 v[128:143], a[188:191], a[164:167], v[128:143]
    v_mfma_f32_32x32x16_bf16 v[112:127], a[168:171], a[160:163], v[64:79]
    v_mfma_f32_32x32x16_bf16 v[112:127], a[172:175], a[164:167], v[112:127]
    v_accvgpr_mov_b32 a184, a168
    v_accvgpr_mov_b32 a185, a169
    v_accvgpr_mov_b32 a186, a170
    v_accvgpr_mov_b32 a187, a171
    v_accvgpr_mov_b32 a188, a172
    v_accvgpr_mov_b32 a189, a173
    v_accvgpr_mov_b32 a190, a174
    v_accvgpr_mov_b32 a191, a175
    v_accvgpr_mov_b32 a196, a176
    v_accvgpr_mov_b32 a197, a177
    v_accvgpr_mov_b32 a198, a178
    v_accvgpr_mov_b32 a199, a179
    v_accvgpr_mov_b32 a200, a180
    v_accvgpr_mov_b32 a201, a181
    v_accvgpr_mov_b32 a202, a182
    v_accvgpr_mov_b32 a203, a183
    s_add_u32 s31, s35, 50331648
    buffer_load_dwordx4 a[160:163], v6, s[4:7], s31 offen offset:0 sc1
    buffer_load_dwordx4 a[164:167], v6, s[4:7], s31 offen offset:1024 sc1
    s_add_u32 s31, s35, 54525952
    buffer_load_dwordx4 a[168:171], v6, s[4:7], s31 offen offset:0 sc1
    buffer_load_dwordx4 a[172:175], v6, s[4:7], s31 offen offset:1024 sc1
    s_add_u32 s31, s35, 58720256
    buffer_load_dwordx4 a[176:179], v6, s[4:7], s31 offen offset:0 sc1
    buffer_load_dwordx4 a[180:183], v6, s[4:7], s31 offen offset:1024 sc1
    v_max3_f32 v14, v136, v137, v138
    v_max3_f32 v14, v14, v139, v140
    v_max3_f32 v14, v14, v141, v142
    v_max3_f32 v14, v14, v143, v112
    v_max3_f32 v14, v14, v113, v114
    v_max3_f32 v14, v14, v115, v116
    v_max3_f32 v14, v14, v117, v118
    v_max3_f32 v14, v14, v119, v120
    v_max3_f32 v14, v14, v121, v122
    v_max3_f32 v14, v14, v123, v124
    v_max3_f32 v14, v14, v125, v126
    v_max_f32 v14, v14, v127
    v_mov_b32 v15, v14
    s_nop 1
    v_permlane32_swap_b32 v14, v15
    v_max_f32 v14, v14, v15
    v_mul_f32 v14, s58, v14
    v_fma_f32 v136, v136, s58, -v14
    v_fma_f32 v137, v137, s58, -v14
    v_fma_f32 v138, v138, s58, -v14
    v_fma_f32 v139, v139, s58, -v14
    v_fma_f32 v140, v140, s58, -v14
    v_fma_f32 v141, v141, s58, -v14
    v_fma_f32 v142, v142, s58, -v14
    v_fma_f32 v143, v143, s58, -v14
    v_fma_f32 v112, v112, s58, -v14
    v_fma_f32 v113, v113, s58, -v14
    v_fma_f32 v114, v114, s58, -v14
    v_fma_f32 v115, v115, s58, -v14
    v_fma_f32 v116, v116, s58, -v14
    v_fma_f32 v117, v117, s58, -v14
    v_fma_f32 v118, v118, s58, -v14
    v_fma_f32 v119, v119, s58, -v14
    v_fma_f32 v120, v120, s58, -v14
    v_fma_f32 v121, v121, s58, -v14
    v_fma_f32 v122, v122, s58, -v14
    v_fma_f32 v123, v123, s58, -v14
    v_fma_f32 v124, v124, s58, -v14
    v_fma_f32 v125, v125, s58, -v14
    v_fma_f32 v126, v126, s58, -v14
    v_fma_f32 v127, v127, s58, -v14
    v_exp_f32 v136, v136
    v_exp_f32 v137, v137
    v_exp_f32 v138, v138
    v_exp_f32 v139, v139
    v_exp_f32 v140, v140
    v_exp_f32 v141, v141
    v_exp_f32 v142, v142
    v_exp_f32 v143, v143
    v_exp_f32 v112, v112
    v_exp_f32 v113, v113
    v_exp_f32 v114, v114
    v_exp_f32 v115, v115
    v_exp_f32 v116, v116
    v_exp_f32 v117, v117
    v_exp_f32 v118, v118
    v_exp_f32 v119, v119
    v_exp_f32 v120, v120
    v_exp_f32 v121, v121
    v_exp_f32 v122, v122
    v_exp_f32 v123, v123
    v_exp_f32 v124, v124
    v_exp_f32 v125, v125
    v_exp_f32 v126, v126
    v_exp_f32 v127, v127
    v_add_f32 v26, v136, v137
    v_add_f32 v15, v138, v139
    v_add_f32 v26, v26, v140
    v_add_f32 v15, v15, v141
    v_add_f32 v26, v26, v142
    v_add_f32 v15, v15, v143
    v_add_f32 v26, v26, v112
    v_add_f32 v15, v15, v113
    v_add_f32 v26, v26, v114
    v_add_f32 v15, v15, v115
    v_add_f32 v26, v26, v116
    v_add_f32 v15, v15, v117
    v_add_f32 v26, v26, v118
    v_add_f32 v15, v15, v119
    v_add_f32 v26, v26, v120
    v_add_f32 v15, v15, v121
    v_add_f32 v26, v26, v122
    v_add_f32 v15, v15, v123
    v_add_f32 v26, v26, v124
    v_add_f32 v15, v15, v125
    v_add_f32 v26, v26, v126
    v_add_f32 v15, v15, v127
    v_add_f32 v26, v26, v15
    v_mov_b32 v15, v26
    s_nop 1
    v_permlane32_swap_b32 v26, v15
    v_add_f32 v26, v26, v15
    v_rcp_f32 v26, v26
    v_cvt_pk_bf16_f32 v28, v112, v113
    v_cvt_pk_bf16_f32 v29, v114, v115
    v_cvt_pk_bf16_f32 v30, v116, v117
    v_cvt_pk_bf16_f32 v31, v118, v119
    v_cvt_pk_bf16_f32 v32, v120, v121
    v_cvt_pk_bf16_f32 v33, v122, v123
    v_cvt_pk_bf16_f32 v34, v124, v125
    v_cvt_pk_bf16_f32 v35, v126, v127
    v_cvt_pk_bf16_f32 v36, v136, v137
    v_cvt_pk_bf16_f32 v37, v138, v139
    v_cvt_pk_bf16_f32 v38, v140, v141
    v_cvt_pk_bf16_f32 v39, v142, v143
    v_mfma_f32_32x32x16_bf16 v[144:159], a[196:199], v[28:31], 0
    v_mfma_f32_32x32x16_bf16 v[144:159], a[200:203], v[32:35], v[144:159]
    v_mfma_f32_32x32x16_bf16 v[144:159], a[192:195], v[36:39], v[144:159]
    v_accvgpr_mov_b32 a192, a200
    v_accvgpr_mov_b32 a193, a201
    v_accvgpr_mov_b32 a194, a202
    v_accvgpr_mov_b32 a195, a203
    s_waitcnt vmcnt(6)
    v_mov_b32 v2, s45
    buffer_store_dword v2, v12, s[4:7], s43 offen sc1
    s_cmp_lg_u32 s54, 0
    s_cbranch_scc1 at_nb_60
    v_mov_b32 v14, 0xf149f2ca
    v_add_u32 v3, 32, v11
    v_and_b32 v3, 0xfffffff1, v3
    v_cmp_ne_u32 vcc, 0, v3
    s_nop 1
    v_cndmask_b32 v80, 0, v14, vcc
    v_add_u32 v3, 31, v11
    v_and_b32 v3, 0xfffffff1, v3
    v_cmp_ne_u32 vcc, 0, v3
    s_nop 1
    v_cndmask_b32 v81, 0, v14, vcc
    v_add_u32 v3, 30, v11
    v_and_b32 v3, 0xfffffff1, v3
    v_cmp_ne_u32 vcc, 0, v3
    s_nop 1
    v_cndmask_b32 v82, 0, v14, vcc
    v_add_u32 v3, 29, v11
    v_and_b32 v3, 0xfffffff1, v3
    v_cmp_ne_u32 vcc, 0, v3
    s_nop 1
    v_cndmask_b32 v83, 0, v14, vcc
    v_add_u32 v3, 24, v11
    v_and_b32 v3, 0xfffffff1, v3
    v_cmp_ne_u32 vcc, 0, v3
    s_nop 1
    v_cndmask_b32 v84, 0, v14, vcc
    v_add_u32 v3, 23, v11
    v_and_b32 v3, 0xfffffff1, v3
    v_cmp_ne_u32 vcc, 0, v3
    s_nop 1
    v_cndmask_b32 v85, 0, v14, vcc
    v_add_u32 v3, 22, v11
    v_and_b32 v3, 0xfffffff1, v3
    v_cmp_ne_u32 vcc, 0, v3
    s_nop 1
    v_cndmask_b32 v86, 0, v14, vcc
    v_add_u32 v3, 21, v11
    v_and_b32 v3, 0xfffffff1, v3
    v_cmp_ne_u32 vcc, 0, v3
    s_nop 1
    v_cndmask_b32 v87, 0, v14, vcc
    v_add_u32 v3, 16, v11
    v_and_b32 v3, 0xfffffff1, v3
    v_cmp_ne_u32 vcc, 0, v3
    s_nop 1
    v_cndmask_b32 v88, 0, v14, vcc
    v_add_u32 v3, 15, v11
    v_and_b32 v3, 0xfffffff1, v3
    v_cmp_ne_u32 vcc, 0, v3
    s_nop 1
    v_cndmask_b32 v89, 0, v14, vcc
    v_add_u32 v3, 14, v11
    v_and_b32 v3, 0xfffffff1, v3
    v_cmp_ne_u32 vcc, 0, v3
    s_nop 1
    v_cndmask_b32 v90, 0, v14, vcc
    v_add_u32 v3, 13, v11
    v_and_b32 v3, 0xfffffff1, v3
    v_cmp_ne_u32 vcc, 0, v3
    s_nop 1
    v_cndmask_b32 v91, 0, v14, vcc
    v_add_u32 v3, 8, v11
    v_and_b32 v3, 0xfffffff1, v3
    v_cmp_ne_u32 vcc, 0, v3
    s_nop 1
    v_cndmask_b32 v92, 0, v14, vcc
    v_add_u32 v3, 7, v11
    v_and_b32 v3, 0xfffffff1, v3
    v_cmp_ne_u32 vcc, 0, v3
    s_nop 1
    v_cndmask_b32 v93, 0, v14, vcc
    v_add_u32 v3, 6, v11
    v_and_b32 v3, 0xfffffff1, v3
    v_cmp_ne_u32 vcc, 0, v3
    s_nop 1
    v_cndmask_b32 v94, 0, v14, vcc
    v_add_u32 v3, 5, v11
    v_and_b32 v3, 0xfffffff1, v3
    v_cmp_ne_u32 vcc, 0, v3
    s_nop 1
    v_cndmask_b32 v95, 0, v14, vcc
at_nb_60:
    s_nop 2
    v_mul_f32 v144, v144, v26
    v_mul_f32 v145, v145, v26
    v_mul_f32 v146, v146, v26
    v_mul_f32 v147, v147, v26
    v_mul_f32 v148, v148, v26
    v_mul_f32 v149, v149, v26
    v_mul_f32 v150, v150, v26
    v_mul_f32 v151, v151, v26
    v_mul_f32 v152, v152, v26
    v_mul_f32 v153, v153, v26
    v_mul_f32 v154, v154, v26
    v_mul_f32 v155, v155, v26
    v_mul_f32 v156, v156, v26
    v_mul_f32 v157, v157, v26
    v_mul_f32 v158, v158, v26
    v_mul_f32 v159, v159, v26
    v_cvt_pk_bf16_f32 v208, v144, v145
    v_cvt_pk_bf16_f32 v209, v146, v147
    v_cvt_pk_bf16_f32 v210, v148, v149
    v_cvt_pk_bf16_f32 v211, v150, v151
    v_cvt_pk_bf16_f32 v212, v152, v153
    v_cvt_pk_bf16_f32 v213, v154, v155
    v_cvt_pk_bf16_f32 v214, v156, v157
    v_cvt_pk_bf16_f32 v215, v158, v159
    v_permlane32_swap_b32 v208, v210
    v_permlane32_swap_b32 v209, v211
    v_permlane32_swap_b32 v212, v214
    v_permlane32_swap_b32 v213, v215
    buffer_store_dwordx4 v[208:211], v6, s[4:7], s48 offen offset:0 sc1
    buffer_store_dwordx4 v[212:215], v6, s[4:7], s48 offen offset:1024 sc1
    s_add_u32 s54, s54, 1
    s_mov_b32 s43, 16384
    s_mov_b32 s45, s54
    s_waitcnt vmcnt(3)
    s_branch at_top_56
at_end_59:
    s_waitcnt vmcnt(0) lgkmcnt(0)
    s_branch L_o64
L_o64:
    s_cmp_ge_u32 s28, 80
    s_cbranch_scc1 L_dump
    s_load_dwordx2 s[72:73], s[0:1], 40
    s_load_dwordx2 s[74:75], s[0:1], 80
    s_mul_i32 s44, s28, 205
    s_lshr_b32 s44, s44, 10
    s_mul_i32 s31, s44, 5
    s_sub_u32 s30, s28, s31
    s_waitcnt lgkmcnt(0)
    s_mov_b32 s8, s72
    s_and_b32 s9, s73, 0xffff
    s_mov_b32 s10, 8388608
    s_mov_b32 s11, 0x00020000
    s_mov_b32 s20, s74
    s_and_b32 s21, s75, 0xffff
    s_mov_b32 s22, 8388608
    s_mov_b32 s23, 0x00020000
    s_lshl_b32 s31, s29, 21
    s_lshl_b32 s33, s44, 7
    s_add_u32 s31, s31, s33
    v_lshrrev_b32 v6, 3, v1
    v_lshlrev_b32 v6, 11, v6
    v_and_b32 v4, 7, v1
    v_lshl_add_u32 v6, v4, 4, v6
    v_add_u32 v6, s31, v6
    s_lshl_b32 s31, s29, 15
    v_lshrrev_b32 v7, 5, v1
    v_lshlrev_b32 v7, 9, v7
    v_bfe_u32 v4, v1, 2, 2
    v_lshl_add_u32 v7, v4, 7, v7
    v_bfe_u32 v4, v1, 4, 1
    v_lshl_add_u32 v7, v4, 5, v7
    v_and_b32 v4, 3, v1
    v_lshl_add_u32 v7, v4, 3, v7
    v_add_u32 v7, s31, v7
    s_lshl_b32 s32, s29, 15
    s_add_u32 m0, s32, 0
    s_mov_b32 s38, 0
    buffer_load_dwordx4 v6, s[8:11], s38 offen lds
    s_add_u32 m0, s32, 1024
    s_add_u32 s38, s38, 16384
    buffer_load_dwordx4 v6, s[8:11], s38 offen lds
    s_add_u32 m0, s32, 2048
    s_add_u32 s38, s38, 16384
    buffer_load_dwordx4 v6, s[8:11], s38 offen lds
    s_add_u32 m0, s32, 3072
    s_add_u32 s38, s38, 16384
    buffer_load_dwordx4 v6, s[8:11], s38 offen lds
    s_add_u32 m0, s32, 4096
    s_add_u32 s38, s38, 16384
    buffer_load_dwordx4 v6, s[8:11], s38 offen lds
    s_add_u32 m0, s32, 5120
    s_add_u32 s38, s38, 16384
    buffer_load_dwordx4 v6, s[8:11], s38 offen lds
    s_add_u32 m0, s32, 6144
    s_add_u32 s38, s38, 16384
    buffer_load_dwordx4 v6, s[8:11], s38 offen lds
    s_add_u32 m0, s32, 7168
    s_add_u32 s38, s38, 16384
    buffer_load_dwordx4 v6, s[8:11], s38 offen lds
    s_add_u32 m0, s32, 8192
    s_add_u32 s38, s38, 16384
    buffer_load_dwordx4 v6, s[8:11], s38 offen lds
    s_add_u32 m0, s32, 9216
    s_add_u32 s38, s38, 16384
    buffer_load_dwordx4 v6, s[8:11], s38 offen lds
    s_add_u32 m0, s32, 10240
    s_add_u32 s38, s38, 16384
    buffer_load_dwordx4 v6, s[8:11], s38 offen lds
    s_add_u32 m0, s32, 11264
    s_add_u32 s38, s38, 16384
    buffer_load_dwordx4 v6, s[8:11], s38 offen lds
    s_add_u32 m0, s32, 12288
    s_add_u32 s38, s38, 16384
    buffer_load_dwordx4 v6, s[8:11], s38 offen lds
    s_add_u32 m0, s32, 13312
    s_add_u32 s38, s38, 16384
    buffer_load_dwordx4 v6, s[8:11], s38 offen lds
    s_add_u32 m0, s32, 14336
    s_add_u32 s38, s38, 16384
    buffer_load_dwordx4 v6, s[8:11], s38 offen lds
    s_add_u32 m0, s32, 15360
    s_add_u32 s38, s38, 16384
    buffer_load_dwordx4 v6, s[8:11], s38 offen lds
    s_add_u32 m0, s32, 16384
    s_add_u32 s38, s38, 16384
    buffer_load_dwordx4 v6, s[8:11], s38 offen lds
    s_add_u32 m0, s32, 17408
    s_add_u32 s38, s38, 16384
    buffer_load_dwordx4 v6, s[8:11], s38 offen lds
    s_add_u32 m0, s32, 18432
    s_add_u32 s38, s38, 16384
    buffer_load_dwordx4 v6, s[8:11], s38 offen lds
    s_add_u32 m0, s32, 19456
    s_add_u32 s38, s38, 16384
    buffer_load_dwordx4 v6, s[8:11], s38 offen lds
    s_add_u32 m0, s32, 20480
    s_add_u32 s38, s38, 16384
    buffer_load_dwordx4 v6, s[8:11], s38 offen lds
    s_add_u32 m0, s32, 21504
    s_add_u32 s38, s38, 16384
    buffer_load_dwordx4 v6, s[8:11], s38 offen lds
    s_add_u32 m0, s32, 22528
    s_add_u32 s38, s38, 16384
    buffer_load_dwordx4 v6, s[8:11], s38 offen lds
    s_add_u32 m0, s32, 23552
    s_add_u32 s38, s38, 16384
    buffer_load_dwordx4 v6, s[8:11], s38 offen lds
    s_add_u32 m0, s32, 24576
    s_add_u32 s38, s38, 16384
    buffer_load_dwordx4 v6, s[8:11], s38 offen lds
    s_add_u32 m0, s32, 25600
    s_add_u32 s38, s38, 16384
    buffer_load_dwordx4 v6, s[8:11], s38 offen lds
    s_add_u32 m0, s32, 26624
    s_add_u32 s38, s38, 16384
    buffer_load_dwordx4 v6, s[8:11], s38 offen lds
    s_add_u32 m0, s32, 27648
    s_add_u32 s38, s38, 16384
    buffer_load_dwordx4 v6, s[8:11], s38 offen lds
    s_add_u32 m0, s32, 28672
    s_add_u32 s38, s38, 16384
    buffer_load_dwordx4 v6, s[8:11], s38 offen lds
    s_add_u32 m0, s32, 29696
    s_add_u32 s38, s38, 16384
    buffer_load_dwordx4 v6, s[8:11], s38 offen lds
    s_add_u32 m0, s32, 30720
    s_add_u32 s38, s38, 16384
    buffer_load_dwordx4 v6, s[8:11], s38 offen lds
    s_add_u32 m0, s32, 31744
    s_add_u32 s38, s38, 16384
    buffer_load_dwordx4 v6, s[8:11], s38 offen lds
    s_waitcnt vmcnt(30)
    ds_read_b64_tr_b16 a[0:1], v7 offset:0
    ds_read_b64_tr_b16 a[2:3], v7 offset:1024
    ds_read_b64_tr_b16 a[4:5], v7 offset:64
    ds_read_b64_tr_b16 a[6:7], v7 offset:1088
    s_waitcnt vmcnt(28)
    ds_read_b64_tr_b16 a[8:9], v7 offset:2048
    ds_read_b64_tr_b16 a[10:11], v7 offset:3072
    ds_read_b64_tr_b16 a[12:13], v7 offset:2112
    ds_read_b64_tr_b16 a[14:15], v7 offset:3136
    s_waitcnt lgkmcnt(4)
    s_add_u32 m0, s32, 0
    s_add_u32 s38, s38, 16384
    buffer_load_dwordx4 v6, s[8:11], s38 offen lds
    s_add_u32 m0, s32, 1024
    s_add_u32 s38, s38, 16384
    buffer_load_dwordx4 v6, s[8:11], s38 offen lds
    s_waitcnt vmcnt(28)
    ds_read_b64_tr_b16 a[16:17], v7 offset:4096
    ds_read_b64_tr_b16 a[18:19], v7 offset:5120
    ds_read_b64_tr_b16 a[20:21], v7 offset:4160
    ds_read_b64_tr_b16 a[22:23], v7 offset:5184
    s_waitcnt lgkmcnt(4)
    s_add_u32 m0, s32, 2048
    s_add_u32 s38, s38, 16384
    buffer_load_dwordx4 v6, s[8:11], s38 offen lds
    s_add_u32 m0, s32, 3072
    s_add_u32 s38, s38, 16384
    buffer_load_dwordx4 v6, s[8:11], s38 offen lds
    s_waitcnt vmcnt(28)
    ds_read_b64_tr_b16 a[24:25], v7 offset:6144
    ds_read_b64_tr_b16 a[26:27], v7 offset:7168
    ds_read_b64_tr_b16 a[28:29], v7 offset:6208
    ds_read_b64_tr_b16 a[30:31], v7 offset:7232
    s_waitcnt lgkmcnt(4)
    s_add_u32 m0, s32, 4096
    s_add_u32 s38, s38, 16384
    buffer_load_dwordx4 v6, s[8:11], s38 offen lds
    s_add_u32 m0, s32, 5120
    s_add_u32 s38, s38, 16384
    buffer_load_dwordx4 v6, s[8:11], s38 offen lds
    s_waitcnt vmcnt(28)
    ds_read_b64_tr_b16 a[32:33], v7 offset:8192
    ds_read_b64_tr_b16 a[34:35], v7 offset:9216
    ds_read_b64_tr_b16 a[36:37], v7 offset:8256
    ds_read_b64_tr_b16 a[38:39], v7 offset:9280
    s_waitcnt lgkmcnt(4)
    s_add_u32 m0, s32, 6144
    s_add_u32 s38, s38, 16384
    buffer_load_dwordx4 v6, s[8:11], s38 offen lds
    s_add_u32 m0, s32, 7168
    s_add_u32 s38, s38, 16384
    buffer_load_dwordx4 v6, s[8:11], s38 offen lds
    s_waitcnt vmcnt(28)
    ds_read_b64_tr_b16 a[40:41], v7 offset:10240
    ds_read_b64_tr_b16 a[42:43], v7 offset:11264
    ds_read_b64_tr_b16 a[44:45], v7 offset:10304
    ds_read_b64_tr_b16 a[46:47], v7 offset:11328
    s_waitcnt lgkmcnt(4)
    s_add_u32 m0, s32, 8192
    s_add_u32 s38, s38, 16384
    buffer_load_dwordx4 v6, s[8:11], s38 offen lds
    s_add_u32 m0, s32, 9216
    s_add_u32 s38, s38, 16384
    buffer_load_dwordx4 v6, s[8:11], s38 offen lds
    s_waitcnt vmcnt(28)
    ds_read_b64_tr_b16 a[48:49], v7 offset:12288
    ds_read_b64_tr_b16 a[50:51], v7 offset:13312
    ds_read_b64_tr_b16 a[52:53], v7 offset:12352
    ds_read_b64_tr_b16 a[54:55], v7 offset:13376
    s_waitcnt lgkmcnt(4)
    s_add_u32 m0, s32, 10240
    s_add_u32 s38, s38, 16384
    buffer_load_dwordx4 v6, s[8:11], s38 offen lds
    s_add_u32 m0, s32, 11264
    s_add_u32 s38, s38, 16384
    buffer_load_dwordx4 v6, s[8:11], s38 offen lds
    s_waitcnt vmcnt(28)
    ds_read_b64_tr_b16 a[56:57], v7 offset:14336
    ds_read_b64_tr_b16 a[58:59], v7 offset:15360
    ds_read_b64_tr_b16 a[60:61], v7 offset:14400
    ds_read_b64_tr_b16 a[62:63], v7 offset:15424
    s_waitcnt lgkmcnt(4)
    s_add_u32 m0, s32, 12288
    s_add_u32 s38, s38, 16384
    buffer_load_dwordx4 v6, s[8:11], s38 offen lds
    s_add_u32 m0, s32, 13312
    s_add_u32 s38, s38, 16384
    buffer_load_dwordx4 v6, s[8:11], s38 offen lds
    s_waitcnt vmcnt(28)
    ds_read_b64_tr_b16 a[64:65], v7 offset:16384
    ds_read_b64_tr_b16 a[66:67], v7 offset:17408
    ds_read_b64_tr_b16 a[68:69], v7 offset:16448
    ds_read_b64_tr_b16 a[70:71], v7 offset:17472
    s_waitcnt lgkmcnt(4)
    s_add_u32 m0, s32, 14336
    s_add_u32 s38, s38, 16384
    buffer_load_dwordx4 v6, s[8:11], s38 offen lds
    s_add_u32 m0, s32, 15360
    s_add_u32 s38, s38, 16384
    buffer_load_dwordx4 v6, s[8:11], s38 offen lds
    s_waitcnt vmcnt(28)
    ds_read_b64_tr_b16 a[72:73], v7 offset:18432
    ds_read_b64_tr_b16 a[74:75], v7 offset:19456
    ds_read_b64_tr_b16 a[76:77], v7 offset:18496
    ds_read_b64_tr_b16 a[78:79], v7 offset:19520
    s_waitcnt lgkmcnt(4)
    s_add_u32 m0, s32, 16384
    s_add_u32 s38, s38, 16384
    buffer_load_dwordx4 v6, s[8:11], s38 offen lds
    s_add_u32 m0, s32, 17408
    s_add_u32 s38, s38, 16384
    buffer_load_dwordx4 v6, s[8:11], s38 offen lds
    s_waitcnt vmcnt(28)
    ds_read_b64_tr_b16 a[80:81], v7 offset:20480
    ds_read_b64_tr_b16 a[82:83], v7 offset:21504
    ds_read_b64_tr_b16 a[84:85], v7 offset:20544
    ds_read_b64_tr_b16 a[86:87], v7 offset:21568
    s_waitcnt lgkmcnt(4)
    s_add_u32 m0, s32, 18432
    s_add_u32 s38, s38, 16384
    buffer_load_dwordx4 v6, s[8:11], s38 offen lds
    s_add_u32 m0, s32, 19456
    s_add_u32 s38, s38, 16384
    buffer_load_dwordx4 v6, s[8:11], s38 offen lds
    s_waitcnt vmcnt(28)
    ds_read_b64_tr_b16 a[88:89], v7 offset:22528
    ds_read_b64_tr_b16 a[90:91], v7 offset:23552
    ds_read_b64_tr_b16 a[92:93], v7 offset:22592
    ds_read_b64_tr_b16 a[94:95], v7 offset:23616
    s_waitcnt lgkmcnt(4)
    s_add_u32 m0, s32, 20480
    s_add_u32 s38, s38, 16384
    buffer_load_dwordx4 v6, s[8:11], s38 offen lds
    s_add_u32 m0, s32, 21504
    s_add_u32 s38, s38, 16384
    buffer_load_dwordx4 v6, s[8:11], s38 offen lds
    s_waitcnt vmcnt(28)
    ds_read_b64_tr_b16 a[96:97], v7 offset:24576
    ds_read_b64_tr_b16 a[98:99], v7 offset:25600
    ds_read_b64_tr_b16 a[100:101], v7 offset:24640
    ds_read_b64_tr_b16 a[102:103], v7 offset:25664
    s_waitcnt lgkmcnt(4)
    s_add_u32 m0, s32, 22528
    s_add_u32 s38, s38, 16384
    buffer_load_dwordx4 v6, s[8:11], s38 offen lds
    s_add_u32 m0, s32, 23552
    s_add_u32 s38, s38, 16384
    buffer_load_dwordx4 v6, s[8:11], s38 offen lds
    s_waitcnt vmcnt(28)
    ds_read_b64_tr_b16 a[104:105], v7 offset:26624
    ds_read_b64_tr_b16 a[106:107], v7 offset:27648
    ds_read_b64_tr_b16 a[108:109], v7 offset:26688
    ds_read_b64_tr_b16 a[110:111], v7 offset:27712
    s_waitcnt lgkmcnt(4)
    s_add_u32 m0, s32, 24576
    s_add_u32 s38, s38, 16384
    buffer_load_dwordx4 v6, s[8:11], s38 offen lds
    s_add_u32 m0, s32, 25600
    s_add_u32 s38, s38, 16384
    buffer_load_dwordx4 v6, s[8:11], s38 offen lds
    s_waitcnt vmcnt(28)
    ds_read_b64_tr_b16 a[112:113], v7 offset:28672
    ds_read_b64_tr_b16 a[114:115], v7 offset:29696
    ds_read_b64_tr_b16 a[116:117], v7 offset:28736
    ds_read_b64_tr_b16 a[118:119], v7 offset:29760
    s_waitcnt lgkmcnt(4)
    s_add_u32 m0, s32, 26624
    s_add_u32 s38, s38, 16384
    buffer_load_dwordx4 v6, s[8:11], s38 offen lds
    s_add_u32 m0, s32, 27648
    s_add_u32 s38, s38, 16384
    buffer_load_dwordx4 v6, s[8:11], s38 offen lds
    s_waitcnt vmcnt(28)
    ds_read_b64_tr_b16 a[120:121], v7 offset:30720
    ds_read_b64_tr_b16 a[122:123], v7 offset:31744
    ds_read_b64_tr_b16 a[124:125], v7 offset:30784
    ds_read_b64_tr_b16 a[126:127], v7 offset:31808
    s_waitcnt lgkmcnt(4)
    s_add_u32 m0, s32, 28672
    s_add_u32 s38, s38, 16384
    buffer_load_dwordx4 v6, s[8:11], s38 offen lds
    s_add_u32 m0, s32, 29696
    s_add_u32 s38, s38, 16384
    buffer_load_dwordx4 v6, s[8:11], s38 offen lds
    s_waitcnt vmcnt(28)
    ds_read_b64_tr_b16 a[128:129], v7 offset:0
    ds_read_b64_tr_b16 a[130:131], v7 offset:1024
    ds_read_b64_tr_b16 a[132:133], v7 offset:64
    ds_read_b64_tr_b16 a[134:135], v7 offset:1088
    s_waitcnt lgkmcnt(4)
    s_add_u32 m0, s32, 30720
    s_add_u32 s38, s38, 16384
    buffer_load_dwordx4 v6, s[8:11], s38 offen lds
    s_add_u32 m0, s32, 31744
    s_add_u32 s38, s38, 16384
    buffer_load_dwordx4 v6, s[8:11], s38 offen lds
    s_waitcnt vmcnt(28)
    ds_read_b64_tr_b16 a[136:137], v7 offset:2048
    ds_read_b64_tr_b16 a[138:139], v7 offset:3072
    ds_read_b64_tr_b16 a[140:141], v7 offset:2112
    ds_read_b64_tr_b16 a[142:143], v7 offset:3136
    s_waitcnt lgkmcnt(4)
    s_add_u32 m0, s32, 0
    s_add_u32 s38, s38, 16384
    buffer_load_dwordx4 v6, s[8:11], s38 offen lds
    s_add_u32 m0, s32, 1024
    s_add_u32 s38, s38, 16384
    buffer_load_dwordx4 v6, s[8:11], s38 offen lds
    s_waitcnt vmcnt(28)
    ds_read_b64_tr_b16 a[144:145], v7 offset:4096
    ds_read_b64_tr_b16 a[146:147], v7 offset:5120
    ds_read_b64_tr_b16 a[148:149], v7 offset:4160
    ds_read_b64_tr_b16 a[150:151], v7 offset:5184
    s_waitcnt lgkmcnt(4)
    s_add_u32 m0, s32, 2048
    s_add_u32 s38, s38, 16384
    buffer_load_dwordx4 v6, s[8:11], s38 offen lds
    s_add_u32 m0, s32, 3072
    s_add_u32 s38, s38, 16384
    buffer_load_dwordx4 v6, s[8:11], s38 offen lds
    s_waitcnt vmcnt(28)
    ds_read_b64_tr_b16 a[152:153], v7 offset:6144
    ds_read_b64_tr_b16 a[154:155], v7 offset:7168
    ds_read_b64_tr_b16 a[156:157], v7 offset:6208
    ds_read_b64_tr_b16 a[158:159], v7 offset:7232
    s_waitcnt lgkmcnt(4)
    s_add_u32 m0, s32, 4096
    s_add_u32 s38, s38, 16384
    buffer_load_dwordx4 v6, s[8:11], s38 offen lds
    s_add_u32 m0, s32, 5120
    s_add_u32 s38, s38, 16384
    buffer_load_dwordx4 v6, s[8:11], s38 offen lds
    s_waitcnt vmcnt(28)
    ds_read_b64_tr_b16 a[160:161], v7 offset:8192
    ds_read_b64_tr_b16 a[162:163], v7 offset:9216
    ds_read_b64_tr_b16 a[164:165], v7 offset:8256
    ds_read_b64_tr_b16 a[166:167], v7 offset:9280
    s_waitcnt lgkmcnt(4)
    s_add_u32 m0, s32, 6144
    s_add_u32 s38, s38, 16384
    buffer_load_dwordx4 v6, s[8:11], s38 offen lds
    s_add_u32 m0, s32, 7168
    s_add_u32 s38, s38, 16384
    buffer_load_dwordx4 v6, s[8:11], s38 offen lds
    s_waitcnt vmcnt(28)
    ds_read_b64_tr_b16 a[168:169], v7 offset:10240
    ds_read_b64_tr_b16 a[170:171], v7 offset:11264
    ds_read_b64_tr_b16 a[172:173], v7 offset:10304
    ds_read_b64_tr_b16 a[174:175], v7 offset:11328
    s_waitcnt lgkmcnt(4)
    s_add_u32 m0, s32, 8192
    s_add_u32 s38, s38, 16384
    buffer_load_dwordx4 v6, s[8:11], s38 offen lds
    s_add_u32 m0, s32, 9216
    s_add_u32 s38, s38, 16384
    buffer_load_dwordx4 v6, s[8:11], s38 offen lds
    s_waitcnt vmcnt(28)
    ds_read_b64_tr_b16 a[176:177], v7 offset:12288
    ds_read_b64_tr_b16 a[178:179], v7 offset:13312
    ds_read_b64_tr_b16 a[180:181], v7 offset:12352
    ds_read_b64_tr_b16 a[182:183], v7 offset:13376
    s_waitcnt lgkmcnt(4)
    s_add_u32 m0, s32, 10240
    s_add_u32 s38, s38, 16384
    buffer_load_dwordx4 v6, s[8:11], s38 offen lds
    s_add_u32 m0, s32, 11264
    s_add_u32 s38, s38, 16384
    buffer_load_dwordx4 v6, s[8:11], s38 offen lds
    s_waitcnt vmcnt(28)
    ds_read_b64_tr_b16 a[184:185], v7 offset:14336
    ds_read_b64_tr_b16 a[186:187], v7 offset:15360
    ds_read_b64_tr_b16 a[188:189], v7 offset:14400
    ds_read_b64_tr_b16 a[190:191], v7 offset:15424
    s_waitcnt lgkmcnt(4)
    s_add_u32 m0, s32, 12288
    s_add_u32 s38, s38, 16384
    buffer_load_dwordx4 v6, s[8:11], s38 offen lds
    s_add_u32 m0, s32, 13312
    s_add_u32 s38, s38, 16384
    buffer_load_dwordx4 v6, s[8:11], s38 offen lds
    s_waitcnt vmcnt(28)
    ds_read_b64_tr_b16 a[192:193], v7 offset:16384
    ds_read_b64_tr_b16 a[194:195], v7 offset:17408
    ds_read_b64_tr_b16 a[196:197], v7 offset:16448
    ds_read_b64_tr_b16 a[198:199], v7 offset:17472
    s_waitcnt lgkmcnt(4)
    s_add_u32 m0, s32, 14336
    s_add_u32 s38, s38, 16384
    buffer_load_dwordx4 v6, s[8:11], s38 offen lds
    s_add_u32 m0, s32, 15360
    s_add_u32 s38, s38, 16384
    buffer_load_dwordx4 v6, s[8:11], s38 offen lds
    s_waitcnt vmcnt(28)
    ds_read_b64_tr_b16 a[200:201], v7 offset:18432
    ds_read_b64_tr_b16 a[202:203], v7 offset:19456
    ds_read_b64_tr_b16 a[204:205], v7 offset:18496
    ds_read_b64_tr_b16 a[206:207], v7 offset:19520
    s_waitcnt lgkmcnt(4)
    s_add_u32 m0, s32, 16384
    s_add_u32 s38, s38, 16384
    buffer_load_dwordx4 v6, s[8:11], s38 offen lds
    s_add_u32 m0, s32, 17408
    s_add_u32 s38, s38, 16384
    buffer_load_dwordx4 v6, s[8:11], s38 offen lds
    s_waitcnt vmcnt(28)
    ds_read_b64_tr_b16 a[208:209], v7 offset:20480
    ds_read_b64_tr_b16 a[210:211], v7 offset:21504
    ds_read_b64_tr_b16 a[212:213], v7 offset:20544
    ds_read_b64_tr_b16 a[214:215], v7 offset:21568
    s_waitcnt lgkmcnt(4)
    s_add_u32 m0, s32, 18432
    s_add_u32 s38, s38, 16384
    buffer_load_dwordx4 v6, s[8:11], s38 offen lds
    s_add_u32 m0, s32, 19456
    s_add_u32 s38, s38, 16384
    buffer_load_dwordx4 v6, s[8:11], s38 offen lds
    s_waitcnt vmcnt(28)
    ds_read_b64_tr_b16 a[216:217], v7 offset:22528
    ds_read_b64_tr_b16 a[218:219], v7 offset:23552
    ds_read_b64_tr_b16 a[220:221], v7 offset:22592
    ds_read_b64_tr_b16 a[222:223], v7 offset:23616
    s_waitcnt lgkmcnt(4)
    s_add_u32 m0, s32, 20480
    s_add_u32 s38, s38, 16384
    buffer_load_dwordx4 v6, s[8:11], s38 offen lds
    s_add_u32 m0, s32, 21504
    s_add_u32 s38, s38, 16384
    buffer_load_dwordx4 v6, s[8:11], s38 offen lds
    s_waitcnt vmcnt(28)
    ds_read_b64_tr_b16 a[224:225], v7 offset:24576
    ds_read_b64_tr_b16 a[226:227], v7 offset:25600
    ds_read_b64_tr_b16 a[228:229], v7 offset:24640
    ds_read_b64_tr_b16 a[230:231], v7 offset:25664
    s_waitcnt lgkmcnt(4)
    s_add_u32 m0, s32, 22528
    s_add_u32 s38, s38, 16384
    buffer_load_dwordx4 v6, s[8:11], s38 offen lds
    s_add_u32 m0, s32, 23552
    s_add_u32 s38, s38, 16384
    buffer_load_dwordx4 v6, s[8:11], s38 offen lds
    s_waitcnt vmcnt(28)
    ds_read_b64_tr_b16 a[232:233], v7 offset:26624
    ds_read_b64_tr_b16 a[234:235], v7 offset:27648
    ds_read_b64_tr_b16 a[236:237], v7 offset:26688
    ds_read_b64_tr_b16 a[238:239], v7 offset:27712
    s_waitcnt lgkmcnt(4)
    s_add_u32 m0, s32, 24576
    s_add_u32 s38, s38, 16384
    buffer_load_dwordx4 v6, s[8:11], s38 offen lds
    s_add_u32 m0, s32, 25600
    s_add_u32 s38, s38, 16384
    buffer_load_dwordx4 v6, s[8:11], s38 offen lds
    s_waitcnt vmcnt(28)
    ds_read_b64_tr_b16 a[240:241], v7 offset:28672
    ds_read_b64_tr_b16 a[242:243], v7 offset:29696
    ds_read_b64_tr_b16 a[244:245], v7 offset:28736
    ds_read_b64_tr_b16 a[246:247], v7 offset:29760
    s_waitcnt lgkmcnt(4)
    s_add_u32 m0, s32, 26624
    s_add_u32 s38, s38, 16384
    buffer_load_dwordx4 v6, s[8:11], s38 offen lds
    s_add_u32 m0, s32, 27648
    s_add_u32 s38, s38, 16384
    buffer_load_dwordx4 v6, s[8:11], s38 offen lds
    s_waitcnt vmcnt(28)
    ds_read_b64_tr_b16 a[248:249], v7 offset:30720
    ds_read_b64_tr_b16 a[250:251], v7 offset:31744
    ds_read_b64_tr_b16 a[252:253], v7 offset:30784
    ds_read_b64_tr_b16 a[254:255], v7 offset:31808
    s_waitcnt lgkmcnt(4)
    s_add_u32 m0, s32, 28672
    s_add_u32 s38, s38, 16384
    buffer_load_dwordx4 v6, s[8:11], s38 offen lds
    s_add_u32 m0, s32, 29696
    s_add_u32 s38, s38, 16384
    buffer_load_dwordx4 v6, s[8:11], s38 offen lds
    s_waitcnt vmcnt(28)
    ds_read_b64_tr_b16 v[128:129], v7 offset:0
    ds_read_b64_tr_b16 v[130:131], v7 offset:1024
    ds_read_b64_tr_b16 v[132:133], v7 offset:64
    ds_read_b64_tr_b16 v[134:135], v7 offset:1088
    s_waitcnt lgkmcnt(4)
    s_add_u32 m0, s32, 30720
    s_add_u32 s38, s38, 16384
    buffer_load_dwordx4 v6, s[8:11], s38 offen lds
    s_add_u32 m0, s32, 31744
    s_add_u32 s38, s38, 16384
    buffer_load_dwordx4 v6, s[8:11], s38 offen lds
    s_waitcnt vmcnt(28)
    ds_read_b64_tr_b16 v[136:137], v7 offset:2048
    ds_read_b64_tr_b16 v[138:139], v7 offset:3072
    ds_read_b64_tr_b16 v[140:141], v7 offset:2112
    ds_read_b64_tr_b16 v[142:143], v7 offset:3136
    s_waitcnt lgkmcnt(4)
    s_add_u32 m0, s32, 0
    s_add_u32 s38, s38, 16384
    buffer_load_dwordx4 v6, s[8:11], s38 offen lds
    s_add_u32 m0, s32, 1024
    s_add_u32 s38, s38, 16384
    buffer_load_dwordx4 v6, s[8:11], s38 offen lds
    s_waitcnt vmcnt(28)
    ds_read_b64_tr_b16 v[144:145], v7 offset:4096
    ds_read_b64_tr_b16 v[146:147], v7 offset:5120
    ds_read_b64_tr_b16 v[148:149], v7 offset:4160
    ds_read_b64_tr_b16 v[150:151], v7 offset:5184
    s_waitcnt lgkmcnt(4)
    s_add_u32 m0, s32, 2048
    s_add_u32 s38, s38, 16384
    buffer_load_dwordx4 v6, s[8:11], s38 offen lds
    s_add_u32 m0, s32, 3072
    s_add_u32 s38, s38, 16384
    buffer_load_dwordx4 v6, s[8:11], s38 offen lds
    s_waitcnt vmcnt(28)
    ds_read_b64_tr_b16 v[152:153], v7 offset:6144
    ds_read_b64_tr_b16 v[154:155], v7 offset:7168
    ds_read_b64_tr_b16 v[156:157], v7 offset:6208
    ds_read_b64_tr_b16 v[158:159], v7 offset:7232
    s_waitcnt lgkmcnt(4)
    s_add_u32 m0, s32, 4096
    s_add_u32 s38, s38, 16384
    buffer_load_dwordx4 v6, s[8:11], s38 offen lds
    s_add_u32 m0, s32, 5120
    s_add_u32 s38, s38, 16384
    buffer_load_dwordx4 v6, s[8:11], s38 offen lds
    s_waitcnt vmcnt(28)
    ds_read_b64_tr_b16 v[160:161], v7 offset:8192
    ds_read_b64_tr_b16 v[162:163], v7 offset:9216
    ds_read_b64_tr_b16 v[164:165], v7 offset:8256
    ds_read_b64_tr_b16 v[166:167], v7 offset:9280
    s_waitcnt lgkmcnt(4)
    s_add_u32 m0, s32, 6144
    s_add_u32 s38, s38, 16384
    buffer_load_dwordx4 v6, s[8:11], s38 offen lds
    s_add_u32 m0, s32, 7168
    s_add_u32 s38, s38, 16384
    buffer_load_dwordx4 v6, s[8:11], s38 offen lds
    s_waitcnt vmcnt(28)
    ds_read_b64_tr_b16 v[168:169], v7 offset:10240
    ds_read_b64_tr_b16 v[170:171], v7 offset:11264
    ds_read_b64_tr_b16 v[172:173], v7 offset:10304
    ds_read_b64_tr_b16 v[174:175], v7 offset:11328
    s_waitcnt lgkmcnt(4)
    s_add_u32 m0, s32, 8192
    s_add_u32 s38, s38, 16384
    buffer_load_dwordx4 v6, s[8:11], s38 offen lds
    s_add_u32 m0, s32, 9216
    s_add_u32 s38, s38, 16384
    buffer_load_dwordx4 v6, s[8:11], s38 offen lds
    s_waitcnt vmcnt(28)
    ds_read_b64_tr_b16 v[176:177], v7 offset:12288
    ds_read_b64_tr_b16 v[178:179], v7 offset:13312
    ds_read_b64_tr_b16 v[180:181], v7 offset:12352
    ds_read_b64_tr_b16 v[182:183], v7 offset:13376
    s_waitcnt lgkmcnt(4)
    s_add_u32 m0, s32, 10240
    s_add_u32 s38, s38, 16384
    buffer_load_dwordx4 v6, s[8:11], s38 offen lds
    s_add_u32 m0, s32, 11264
    s_add_u32 s38, s38, 16384
    buffer_load_dwordx4 v6, s[8:11], s38 offen lds
    s_waitcnt vmcnt(28)
    ds_read_b64_tr_b16 v[184:185], v7 offset:14336
    ds_read_b64_tr_b16 v[186:187], v7 offset:15360
    ds_read_b64_tr_b16 v[188:189], v7 offset:14400
    ds_read_b64_tr_b16 v[190:191], v7 offset:15424
    s_waitcnt lgkmcnt(4)
    s_add_u32 m0, s32, 12288
    s_add_u32 s38, s38, 16384
    buffer_load_dwordx4 v6, s[8:11], s38 offen lds
    s_add_u32 m0, s32, 13312
    s_add_u32 s38, s38, 16384
    buffer_load_dwordx4 v6, s[8:11], s38 offen lds
    s_waitcnt vmcnt(28)
    ds_read_b64_tr_b16 v[192:193], v7 offset:16384
    ds_read_b64_tr_b16 v[194:195], v7 offset:17408
    ds_read_b64_tr_b16 v[196:197], v7 offset:16448
    ds_read_b64_tr_b16 v[198:199], v7 offset:17472
    s_waitcnt lgkmcnt(4)
    s_add_u32 m0, s32, 14336
    s_add_u32 s38, s38, 16384
    buffer_load_dwordx4 v6, s[8:11], s38 offen lds
    s_add_u32 m0, s32, 15360
    s_add_u32 s38, s38, 16384
    buffer_load_dwordx4 v6, s[8:11], s38 offen lds
    s_waitcnt vmcnt(28)
    ds_read_b64_tr_b16 v[200:201], v7 offset:18432
    ds_read_b64_tr_b16 v[202:203], v7 offset:19456
    ds_read_b64_tr_b16 v[204:205], v7 offset:18496
    ds_read_b64_tr_b16 v[206:207], v7 offset:19520
    s_waitcnt lgkmcnt(4)
    s_add_u32 m0, s32, 16384
    s_add_u32 s38, s38, 16384
    buffer_load_dwordx4 v6, s[8:11], s38 offen lds
    s_add_u32 m0, s32, 17408
    s_add_u32 s38, s38, 16384
    buffer_load_dwordx4 v6, s[8:11], s38 offen lds
    s_waitcnt vmcnt(28)
    ds_read_b64_tr_b16 v[208:209], v7 offset:20480
    ds_read_b64_tr_b16 v[210:211], v7 offset:21504
    ds_read_b64_tr_b16 v[212:213], v7 offset:20544
    ds_read_b64_tr_b16 v[214:215], v7 offset:21568
    s_waitcnt lgkmcnt(4)
    s_add_u32 m0, s32, 18432
    s_add_u32 s38, s38, 16384
    buffer_load_dwordx4 v6, s[8:11], s38 offen lds
    s_add_u32 m0, s32, 19456
    s_add_u32 s38, s38, 16384
    buffer_load_dwordx4 v6, s[8:11], s38 offen lds
    s_waitcnt vmcnt(28)
    ds_read_b64_tr_b16 v[216:217], v7 offset:22528
    ds_read_b64_tr_b16 v[218:219], v7 offset:23552
    ds_read_b64_tr_b16 v[220:221], v7 offset:22592
    ds_read_b64_tr_b16 v[222:223], v7 offset:23616
    s_waitcnt lgkmcnt(4)
    s_add_u32 m0, s32, 20480
    s_add_u32 s38, s38, 16384
    buffer_load_dwordx4 v6, s[8:11], s38 offen lds
    s_add_u32 m0, s32, 21504
    s_add_u32 s38, s38, 16384
    buffer_load_dwordx4 v6, s[8:11], s38 offen lds
    s_waitcnt vmcnt(28)
    ds_read_b64_tr_b16 v[224:225], v7 offset:24576
    ds_read_b64_tr_b16 v[226:227], v7 offset:25600
    ds_read_b64_tr_b16 v[228:229], v7 offset:24640
    ds_read_b64_tr_b16 v[230:231], v7 offset:25664
    s_waitcnt lgkmcnt(4)
    s_add_u32 m0, s32, 22528
    s_add_u32 s38, s38, 16384
    buffer_load_dwordx4 v6, s[8:11], s38 offen lds
    s_add_u32 m0, s32, 23552
    s_add_u32 s38, s38, 16384
    buffer_load_dwordx4 v6, s[8:11], s38 offen lds
    s_waitcnt vmcnt(28)
    ds_read_b64_tr_b16 v[232:233], v7 offset:26624
    ds_read_b64_tr_b16 v[234:235], v7 offset:27648
    ds_read_b64_tr_b16 v[236:237], v7 offset:26688
    ds_read_b64_tr_b16 v[238:239], v7 offset:27712
    s_waitcnt lgkmcnt(4)
    s_add_u32 m0, s32, 24576
    s_add_u32 s38, s38, 16384
    buffer_load_dwordx4 v6, s[8:11], s38 offen lds
    s_add_u32 m0, s32, 25600
    s_add_u32 s38, s38, 16384
    buffer_load_dwordx4 v6, s[8:11], s38 offen lds
    s_waitcnt vmcnt(28)
    ds_read_b64_tr_b16 v[240:241], v7 offset:28672
    ds_read_b64_tr_b16 v[242:243], v7 offset:29696
    ds_read_b64_tr_b16 v[244:245], v7 offset:28736
    ds_read_b64_tr_b16 v[246:247], v7 offset:29760
    s_waitcnt lgkmcnt(4)
    s_add_u32 m0, s32, 26624
    s_add_u32 s38, s38, 16384
    buffer_load_dwordx4 v6, s[8:11], s38 offen lds
    s_add_u32 m0, s32, 27648
    s_add_u32 s38, s38, 16384
    buffer_load_dwordx4 v6, s[8:11], s38 offen lds
    s_waitcnt vmcnt(28)
    ds_read_b64_tr_b16 v[248:249], v7 offset:30720
    ds_read_b64_tr_b16 v[250:251], v7 offset:31744
    ds_read_b64_tr_b16 v[252:253], v7 offset:30784
    ds_read_b64_tr_b16 v[254:255], v7 offset:31808
    s_waitcnt lgkmcnt(4)
    s_add_u32 m0, s32, 28672
    s_add_u32 s38, s38, 16384
    buffer_load_dwordx4 v6, s[8:11], s38 offen lds
    s_add_u32 m0, s32, 29696
    s_add_u32 s38, s38, 16384
    buffer_load_dwordx4 v6, s[8:11], s38 offen lds
    s_waitcnt vmcnt(28)
    s_waitcnt lgkmcnt(0)
    s_add_u32 m0, s32, 30720
    s_add_u32 s38, s38, 16384
    buffer_load_dwordx4 v6, s[8:11], s38 offen lds
    s_add_u32 m0, s32, 31744
    s_add_u32 s38, s38, 16384
    buffer_load_dwordx4 v6, s[8:11], s38 offen lds
    s_waitcnt vmcnt(28)
    s_waitcnt vmcnt(26)
    s_waitcnt vmcnt(24)
    s_waitcnt vmcnt(22)
    s_waitcnt vmcnt(20)
    s_waitcnt vmcnt(18)
    s_waitcnt vmcnt(16)
    s_waitcnt vmcnt(14)
    s_waitcnt vmcnt(12)
    s_waitcnt vmcnt(10)
    s_waitcnt vmcnt(8)
    s_waitcnt vmcnt(6)
    s_waitcnt vmcnt(4)
    s_waitcnt vmcnt(2)
    s_waitcnt vmcnt(0)
    s_waitcnt lgkmcnt(0)
    s_lshl_b32 s31, s29, 16
    v_add_u32 v8, s31, v5
    s_lshl_b32 s31, s29, 13
    s_add_u32 s31, s31, 131072
    v_add_u32 v9, s31, v5
    s_lshl_b32 s31, s29, 7
    s_add_u32 s31, s31, 131072
    v_bfe_u32 v10, v1, 1, 2
    v_lshlrev_b32 v10, 10, v10
    v_and_b32 v4, 1, v1
    v_lshl_add_u32 v10, v4, 9, v10
    v_lshrrev_b32 v4, 3, v1
    v_lshl_add_u32 v10, v4, 4, v10
    v_add_u32 v10, s31, v10
    s_lshl_b32 s31, s29, 15
    s_lshl_b32 s33, s44, 7
    s_add_u32 s31, s31, s33
    v_lshrrev_b32 v11, 3, v1
    v_lshlrev_b32 v11, 12, v11
    v_and_b32 v4, 7, v1
    v_lshl_add_u32 v11, v4, 3, v11
    v_add_u32 v11, s31, v11
    v_and_b32 v12, 31, v1
    v_lshlrev_b32 v12, 7, v12
    v_add_u32 v12, 115343360, v12
    s_cmp_lg_u32 s29, 0
    s_cbranch_scc1 g_wdd_74
g_wd_73:
    s_load_dword s72, s[92:93], 0 glc
    s_add_u32 s41, s41, 1
    s_cmp_ge_u32 s41, 0x200000
    s_cbranch_scc1 g_wdd_74
    s_waitcnt lgkmcnt(0)
    s_and_b32 s72, s72, 0xffff
    s_cmp_ge_u32 s72, 256
    s_cbranch_scc1 g_wdd_74
    s_sleep 32
    s_branch g_wd_73
g_wdd_74:
    s_waitcnt lgkmcnt(0)
    s_barrier
o6_loop_75:
    s_lshl_b32 s47, s30, 18
    s_add_u32 s47, s47, 67108864
    s_and_b32 s52, s30, 63
    s_lshl_b32 s52, s52, 12
    s_add_u32 s52, s52, 32768
o6_w_77:
    buffer_load_dword v13, v12, s[4:7], s52 offen sc1
    s_add_u32 s41, s41, 1
    s_cmp_ge_u32 s41, 0x200000
    s_cbranch_scc1 o6_wd_78
    s_waitcnt vmcnt(0)
    v_cmp_eq_u32 vcc, 0, v13
    s_cbranch_vccz o6_wd_78
    s_sleep 10
    s_branch o6_w_77
o6_wd_78:
    s_add_u32 s31, s47, 0
    buffer_load_dwordx4 v[64:67], v8, s[4:7], s31 offen sc1
    s_add_u32 s31, s47, 1024
    buffer_load_dwordx4 v[68:71], v8, s[4:7], s31 offen sc1
    s_add_u32 s31, s47, 2048
    buffer_load_dwordx4 v[72:75], v8, s[4:7], s31 offen sc1
    s_add_u32 s31, s47, 49152
    buffer_load_dwordx4 v[76:79], v8, s[4:7], s31 offen sc1
    s_add_u32 s31, s47, 3072
    buffer_load_dwordx4 v[80:83], v8, s[4:7], s31 offen sc1
    s_add_u32 s31, s47, 4096
    buffer_load_dwordx4 v[84:87], v8, s[4:7], s31 offen sc1
    s_add_u32 s31, s47, 5120
    buffer_load_dwordx4 v[88:91], v8, s[4:7], s31 offen sc1
    s_add_u32 s31, s47, 50176
    buffer_load_dwordx4 v[92:95], v8, s[4:7], s31 offen sc1
    s_add_u32 s31, s47, 6144
    buffer_load_dwordx4 v[96:99], v8, s[4:7], s31 offen sc1
    s_add_u32 s31, s47, 7168
    buffer_load_dwordx4 v[100:103], v8, s[4:7], s31 offen sc1
    s_add_u32 s31, s47, 8192
    buffer_load_dwordx4 v[104:107], v8, s[4:7], s31 offen sc1
    s_add_u32 s31, s47, 51200
    buffer_load_dwordx4 v[108:111], v8, s[4:7], s31 offen sc1
    s_add_u32 s31, s47, 9216
    buffer_load_dwordx4 v[112:115], v8, s[4:7], s31 offen sc1
    s_add_u32 s31, s47, 10240
    buffer_load_dwordx4 v[116:119], v8, s[4:7], s31 offen sc1
    s_add_u32 s31, s47, 11264
    buffer_load_dwordx4 v[120:123], v8, s[4:7], s31 offen sc1
o6_go_76:
    s_lshl_b32 s49, s30, 17
    s_add_u32 s35, s30, 5
    s_and_b32 s52, s35, 63
    s_lshl_b32 s52, s52, 12
    s_add_u32 s52, s52, 32768
    ds_read_b64_tr_b16 v[16:17], v7 offset:0
    ds_read_b64_tr_b16 v[18:19], v7 offset:1024
    ds_read_b64_tr_b16 v[20:21], v7 offset:64
    ds_read_b64_tr_b16 v[22:23], v7 offset:1088
    s_waitcnt vmcnt(14)
    v_mfma_f32_32x32x16_bf16 v[32:47], a[0:3], v[64:67], 0
    s_add_u32 s31, s47, 52224
    buffer_load_dwordx4 v[124:127], v8, s[4:7], s31 offen sc1
    v_mfma_f32_32x32x16_bf16 v[48:63], a[4:7], v[64:67], 0
    s_waitcnt vmcnt(14)
    v_mfma_f32_32x32x16_bf16 v[32:47], a[8:11], v[68:71], v[32:47]
    s_add_u32 s31, s47, 12288
    buffer_load_dwordx4 v[64:67], v8, s[4:7], s31 offen sc1
    v_mfma_f32_32x32x16_bf16 v[48:63], a[12:15], v[68:71], v[48:63]
    s_waitcnt vmcnt(14)
    v_mfma_f32_32x32x16_bf16 v[32:47], a[16:19], v[72:75], v[32:47]
    s_add_u32 s31, s47, 13312
    buffer_load_dwordx4 v[68:71], v8, s[4:7], s31 offen sc1
    v_mfma_f32_32x32x16_bf16 v[48:63], a[20:23], v[72:75], v[48:63]
    s_waitcnt vmcnt(14)
    s_waitcnt lgkmcnt(0)
    v_mfma_f32_32x32x16_bf16 v[32:47], v[16:19], v[76:79], v[32:47]
    s_add_u32 s31, s47, 14336
    buffer_load_dwordx4 v[72:75], v8, s[4:7], s31 offen sc1
    v_mfma_f32_32x32x16_bf16 v[48:63], v[20:23], v[76:79], v[48:63]
    ds_read_b64_tr_b16 v[24:25], v7 offset:2048
    ds_read_b64_tr_b16 v[26:27], v7 offset:3072
    ds_read_b64_tr_b16 v[28:29], v7 offset:2112
    ds_read_b64_tr_b16 v[30:31], v7 offset:3136
    s_waitcnt vmcnt(14)
    v_mfma_f32_32x32x16_bf16 v[32:47], a[24:27], v[80:83], v[32:47]
    s_add_u32 s31, s47, 53248
    buffer_load_dwordx4 v[76:79], v8, s[4:7], s31 offen sc1
    v_mfma_f32_32x32x16_bf16 v[48:63], a[28:31], v[80:83], v[48:63]
    s_waitcnt vmcnt(14)
    v_mfma_f32_32x32x16_bf16 v[32:47], a[32:35], v[84:87], v[32:47]
    s_add_u32 s31, s47, 15360
    buffer_load_dwordx4 v[80:83], v8, s[4:7], s31 offen sc1
    v_mfma_f32_32x32x16_bf16 v[48:63], a[36:39], v[84:87], v[48:63]
    s_waitcnt vmcnt(14)
    v_mfma_f32_32x32x16_bf16 v[32:47], a[40:43], v[88:91], v[32:47]
    s_add_u32 s31, s47, 16384
    buffer_load_dwordx4 v[84:87], v8, s[4:7], s31 offen sc1
    v_mfma_f32_32x32x16_bf16 v[48:63], a[44:47], v[88:91], v[48:63]
    s_waitcnt vmcnt(14)
    s_waitcnt lgkmcnt(0)
    v_mfma_f32_32x32x16_bf16 v[32:47], v[24:27], v[92:95], v[32:47]
    s_add_u32 s31, s47, 17408
    buffer_load_dwordx4 v[88:91], v8, s[4:7], s31 offen sc1
    v_mfma_f32_32x32x16_bf16 v[48:63], v[28:31], v[92:95], v[48:63]
    ds_read_b64_tr_b16 v[16:17], v7 offset:4096
    ds_read_b64_tr_b16 v[18:19], v7 offset:5120
    ds_read_b64_tr_b16 v[20:21], v7 offset:4160
    ds_read_b64_tr_b16 v[22:23], v7 offset:5184
    s_waitcnt vmcnt(14)
    v_mfma_f32_32x32x16_bf16 v[32:47], a[48:51], v[96:99], v[32:47]
    s_add_u32 s31, s47, 54272
    buffer_load_dwordx4 v[92:95], v8, s[4:7], s31 offen sc1
    v_mfma_f32_32x32x16_bf16 v[48:63], a[52:55], v[96:99], v[48:63]
    s_waitcnt vmcnt(14)
    v_mfma_f32_32x32x16_bf16 v[32:47], a[56:59], v[100:103], v[32:47]
    s_add_u32 s31, s47, 18432
    buffer_load_dwordx4 v[96:99], v8, s[4:7], s31 offen sc1
    v_mfma_f32_32x32x16_bf16 v[48:63], a[60:63], v[100:103], v[48:63]
    s_waitcnt vmcnt(14)
    v_mfma_f32_32x32x16_bf16 v[32:47], a[64:67], v[104:107], v[32:47]
    s_add_u32 s31, s47, 19456
    buffer_load_dwordx4 v[100:103], v8, s[4:7], s31 offen sc1
    v_mfma_f32_32x32x16_bf16 v[48:63], a[68:71], v[104:107], v[48:63]
    s_waitcnt vmcnt(14)
    s_waitcnt lgkmcnt(0)
    v_mfma_f32_32x32x16_bf16 v[32:47], v[16:19], v[108:111], v[32:47]
    s_add_u32 s31, s47, 20480
    buffer_load_dwordx4 v[104:107], v8, s[4:7], s31 offen sc1
    v_mfma_f32_32x32x16_bf16 v[48:63], v[20:23], v[108:111], v[48:63]
    ds_read_b64_tr_b16 v[24:25], v7 offset:6144
    ds_read_b64_tr_b16 v[26:27], v7 offset:7168
    ds_read_b64_tr_b16 v[28:29], v7 offset:6208
    ds_read_b64_tr_b16 v[30:31], v7 offset:7232
    s_waitcnt vmcnt(14)
    v_mfma_f32_32x32x16_bf16 v[32:47], a[72:75], v[112:115], v[32:47]
    s_add_u32 s31, s47, 55296
    buffer_load_dwordx4 v[108:111], v8, s[4:7], s31 offen sc1
    v_mfma_f32_32x32x16_bf16 v[48:63], a[76:79], v[112:115], v[48:63]
    s_waitcnt vmcnt(14)
    v_mfma_f32_32x32x16_bf16 v[32:47], a[80:83], v[116:119], v[32:47]
    s_add_u32 s31, s47, 21504
    buffer_load_dwordx4 v[112:115], v8, s[4:7], s31 offen sc1
    v_mfma_f32_32x32x16_bf16 v[48:63], a[84:87], v[116:119], v[48:63]
    s_waitcnt vmcnt(14)
    v_mfma_f32_32x32x16_bf16 v[32:47], a[88:91], v[120:123], v[32:47]
    s_add_u32 s31, s47, 22528
    buffer_load_dwordx4 v[116:119], v8, s[4:7], s31 offen sc1
    v_mfma_f32_32x32x16_bf16 v[48:63], a[92:95], v[120:123], v[48:63]
    s_waitcnt vmcnt(14)
    s_waitcnt lgkmcnt(0)
    v_mfma_f32_32x32x16_bf16 v[32:47], v[24:27], v[124:127], v[32:47]
    s_add_u32 s31, s47, 23552
    buffer_load_dwordx4 v[120:123], v8, s[4:7], s31 offen sc1
    v_mfma_f32_32x32x16_bf16 v[48:63], v[28:31], v[124:127], v[48:63]
    ds_read_b64_tr_b16 v[16:17], v7 offset:8192
    ds_read_b64_tr_b16 v[18:19], v7 offset:9216
    ds_read_b64_tr_b16 v[20:21], v7 offset:8256
    ds_read_b64_tr_b16 v[22:23], v7 offset:9280
    s_waitcnt vmcnt(14)
    v_mfma_f32_32x32x16_bf16 v[32:47], a[96:99], v[64:67], v[32:47]
    s_add_u32 s31, s47, 56320
    buffer_load_dwordx4 v[124:127], v8, s[4:7], s31 offen sc1
    v_mfma_f32_32x32x16_bf16 v[48:63], a[100:103], v[64:67], v[48:63]
    s_waitcnt vmcnt(14)
    v_mfma_f32_32x32x16_bf16 v[32:47], a[104:107], v[68:71], v[32:47]
    s_add_u32 s31, s47, 24576
    buffer_load_dwordx4 v[64:67], v8, s[4:7], s31 offen sc1
    v_mfma_f32_32x32x16_bf16 v[48:63], a[108:111], v[68:71], v[48:63]
    s_waitcnt vmcnt(14)
    v_mfma_f32_32x32x16_bf16 v[32:47], a[112:115], v[72:75], v[32:47]
    s_add_u32 s31, s47, 25600
    buffer_load_dwordx4 v[68:71], v8, s[4:7], s31 offen sc1
    v_mfma_f32_32x32x16_bf16 v[48:63], a[116:119], v[72:75], v[48:63]
    s_waitcnt vmcnt(14)
    s_waitcnt lgkmcnt(0)
    v_mfma_f32_32x32x16_bf16 v[32:47], v[16:19], v[76:79], v[32:47]
    s_add_u32 s31, s47, 26624
    buffer_load_dwordx4 v[72:75], v8, s[4:7], s31 offen sc1
    v_mfma_f32_32x32x16_bf16 v[48:63], v[20:23], v[76:79], v[48:63]
    ds_read_b64_tr_b16 v[24:25], v7 offset:10240
    ds_read_b64_tr_b16 v[26:27], v7 offset:11264
    ds_read_b64_tr_b16 v[28:29], v7 offset:10304
    ds_read_b64_tr_b16 v[30:31], v7 offset:11328
    s_waitcnt vmcnt(14)
    v_mfma_f32_32x32x16_bf16 v[32:47], a[120:123], v[80:83], v[32:47]
    s_add_u32 s31, s47, 57344
    buffer_load_dwordx4 v[76:79], v8, s[4:7], s31 offen sc1
    v_mfma_f32_32x32x16_bf16 v[48:63], a[124:127], v[80:83], v[48:63]
    s_waitcnt vmcnt(14)
    v_mfma_f32_32x32x16_bf16 v[32:47], a[128:131], v[84:87], v[32:47]
    s_add_u32 s31, s47, 27648
    buffer_load_dwordx4 v[80:83], v8, s[4:7], s31 offen sc1
    v_mfma_f32_32x32x16_bf16 v[48:63], a[132:135], v[84:87], v[48:63]
    s_waitcnt vmcnt(14)
    v_mfma_f32_32x32x16_bf16 v[32:47], a[136:139], v[88:91], v[32:47]
    s_add_u32 s31, s47, 28672
    buffer_load_dwordx4 v[84:87], v8, s[4:7], s31 offen sc1
    v_mfma_f32_32x32x16_bf16 v[48:63], a[140:143], v[88:91], v[48:63]
    s_waitcnt vmcnt(14)
    s_waitcnt lgkmcnt(0)
    v_mfma_f32_32x32x16_bf16 v[32:47], v[24:27], v[92:95], v[32:47]
    s_add_u32 s31, s47, 29696
    buffer_load_dwordx4 v[88:91], v8, s[4:7], s31 offen sc1
    v_mfma_f32_32x32x16_bf16 v[48:63], v[28:31], v[92:95], v[48:63]
    ds_read_b64_tr_b16 v[16:17], v7 offset:12288
    ds_read_b64_tr_b16 v[18:19], v7 offset:13312
    ds_read_b64_tr_b16 v[20:21], v7 offset:12352
    ds_read_b64_tr_b16 v[22:23], v7 offset:13376
    s_waitcnt vmcnt(14)
    v_mfma_f32_32x32x16_bf16 v[32:47], a[144:147], v[96:99], v[32:47]
    s_add_u32 s31, s47, 58368
    buffer_load_dwordx4 v[92:95], v8, s[4:7], s31 offen sc1
    buffer_load_dword v13, v12, s[4:7], s52 offen sc1
    v_mfma_f32_32x32x16_bf16 v[48:63], a[148:151], v[96:99], v[48:63]
    s_waitcnt vmcnt(15)
    v_mfma_f32_32x32x16_bf16 v[32:47], a[152:155], v[100:103], v[32:47]
    s_add_u32 s31, s47, 30720
    buffer_load_dwordx4 v[96:99], v8, s[4:7], s31 offen sc1
    v_mfma_f32_32x32x16_bf16 v[48:63], a[156:159], v[100:103], v[48:63]
    s_waitcnt vmcnt(15)
    v_mfma_f32_32x32x16_bf16 v[32:47], a[160:163], v[104:107], v[32:47]
    s_add_u32 s31, s47, 31744
    buffer_load_dwordx4 v[100:103], v8, s[4:7], s31 offen sc1
    v_mfma_f32_32x32x16_bf16 v[48:63], a[164:167], v[104:107], v[48:63]
    s_waitcnt vmcnt(15)
    s_waitcnt lgkmcnt(0)
    v_mfma_f32_32x32x16_bf16 v[32:47], v[16:19], v[108:111], v[32:47]
    s_add_u32 s31, s47, 32768
    buffer_load_dwordx4 v[104:107], v8, s[4:7], s31 offen sc1
    v_mfma_f32_32x32x16_bf16 v[48:63], v[20:23], v[108:111], v[48:63]
    ds_read_b64_tr_b16 v[24:25], v7 offset:14336
    ds_read_b64_tr_b16 v[26:27], v7 offset:15360
    ds_read_b64_tr_b16 v[28:29], v7 offset:14400
    ds_read_b64_tr_b16 v[30:31], v7 offset:15424
    s_waitcnt vmcnt(15)
    v_mfma_f32_32x32x16_bf16 v[32:47], a[168:171], v[112:115], v[32:47]
    s_add_u32 s31, s47, 59392
    buffer_load_dwordx4 v[108:111], v8, s[4:7], s31 offen sc1
    v_mfma_f32_32x32x16_bf16 v[48:63], a[172:175], v[112:115], v[48:63]
    s_waitcnt vmcnt(15)
    v_mfma_f32_32x32x16_bf16 v[32:47], a[176:179], v[116:119], v[32:47]
    s_add_u32 s31, s47, 33792
    buffer_load_dwordx4 v[112:115], v8, s[4:7], s31 offen sc1
    v_mfma_f32_32x32x16_bf16 v[48:63], a[180:183], v[116:119], v[48:63]
    s_waitcnt vmcnt(15)
    v_mfma_f32_32x32x16_bf16 v[32:47], a[184:187], v[120:123], v[32:47]
    s_add_u32 s31, s47, 34816
    buffer_load_dwordx4 v[116:119], v8, s[4:7], s31 offen sc1
    v_mfma_f32_32x32x16_bf16 v[48:63], a[188:191], v[120:123], v[48:63]
    s_waitcnt vmcnt(15)
    s_waitcnt lgkmcnt(0)
    v_mfma_f32_32x32x16_bf16 v[32:47], v[24:27], v[124:127], v[32:47]
    s_add_u32 s31, s47, 35840
    buffer_load_dwordx4 v[120:123], v8, s[4:7], s31 offen sc1
    v_mfma_f32_32x32x16_bf16 v[48:63], v[28:31], v[124:127], v[48:63]
    ds_read_b64_tr_b16 v[16:17], v7 offset:16384
    ds_read_b64_tr_b16 v[18:19], v7 offset:17408
    ds_read_b64_tr_b16 v[20:21], v7 offset:16448
    ds_read_b64_tr_b16 v[22:23], v7 offset:17472
    s_waitcnt vmcnt(15)
    v_mfma_f32_32x32x16_bf16 v[32:47], a[192:195], v[64:67], v[32:47]
    s_add_u32 s31, s47, 60416
    buffer_load_dwordx4 v[124:127], v8, s[4:7], s31 offen sc1
    v_mfma_f32_32x32x16_bf16 v[48:63], a[196:199], v[64:67], v[48:63]
    s_waitcnt vmcnt(15)
    v_mfma_f32_32x32x16_bf16 v[32:47], a[200:203], v[68:71], v[32:47]
    s_add_u32 s31, s47, 36864
    buffer_load_dwordx4 v[64:67], v8, s[4:7], s31 offen sc1
    v_mfma_f32_32x32x16_bf16 v[48:63], a[204:207], v[68:71], v[48:63]
    s_waitcnt vmcnt(15)
    v_mfma_f32_32x32x16_bf16 v[32:47], a[208:211], v[72:75], v[32:47]
    s_add_u32 s31, s47, 37888
    buffer_load_dwordx4 v[68:71], v8, s[4:7], s31 offen sc1
    v_mfma_f32_32x32x16_bf16 v[48:63], a[212:215], v[72:75], v[48:63]
    s_waitcnt vmcnt(15)
    s_waitcnt lgkmcnt(0)
    v_mfma_f32_32x32x16_bf16 v[32:47], v[16:19], v[76:79], v[32:47]
    s_add_u32 s31, s47, 38912
    buffer_load_dwordx4 v[72:75], v8, s[4:7], s31 offen sc1
    v_mfma_f32_32x32x16_bf16 v[48:63], v[20:23], v[76:79], v[48:63]
    ds_read_b64_tr_b16 v[24:25], v7 offset:18432
    ds_read_b64_tr_b16 v[26:27], v7 offset:19456
    ds_read_b64_tr_b16 v[28:29], v7 offset:18496
    ds_read_b64_tr_b16 v[30:31], v7 offset:19520
    s_waitcnt vmcnt(15)
    v_mfma_f32_32x32x16_bf16 v[32:47], a[216:219], v[80:83], v[32:47]
    s_add_u32 s31, s47, 61440
    buffer_load_dwordx4 v[76:79], v8, s[4:7], s31 offen sc1
    v_mfma_f32_32x32x16_bf16 v[48:63], a[220:223], v[80:83], v[48:63]
    s_waitcnt vmcnt(15)
    v_mfma_f32_32x32x16_bf16 v[32:47], a[224:227], v[84:87], v[32:47]
    s_add_u32 s31, s47, 39936
    buffer_load_dwordx4 v[80:83], v8, s[4:7], s31 offen sc1
    v_mfma_f32_32x32x16_bf16 v[48:63], a[228:231], v[84:87], v[48:63]
    s_waitcnt vmcnt(15)
    v_mfma_f32_32x32x16_bf16 v[32:47], a[232:235], v[88:91], v[32:47]
    s_add_u32 s31, s47, 40960
    buffer_load_dwordx4 v[84:87], v8, s[4:7], s31 offen sc1
    v_mfma_f32_32x32x16_bf16 v[48:63], a[236:239], v[88:91], v[48:63]
    s_waitcnt vmcnt(15)
    s_waitcnt lgkmcnt(0)
    v_mfma_f32_32x32x16_bf16 v[32:47], v[24:27], v[92:95], v[32:47]
    s_add_u32 s31, s47, 41984
    buffer_load_dwordx4 v[88:91], v8, s[4:7], s31 offen sc1
    v_mfma_f32_32x32x16_bf16 v[48:63], v[28:31], v[92:95], v[48:63]
    ds_read_b64_tr_b16 v[16:17], v7 offset:20480
    ds_read_b64_tr_b16 v[18:19], v7 offset:21504
    ds_read_b64_tr_b16 v[20:21], v7 offset:20544
    ds_read_b64_tr_b16 v[22:23], v7 offset:21568
    s_waitcnt vmcnt(14)
    v_mfma_f32_32x32x16_bf16 v[32:47], a[240:243], v[96:99], v[32:47]
    s_add_u32 s31, s47, 62464
    buffer_load_dwordx4 v[92:95], v8, s[4:7], s31 offen sc1
    v_mfma_f32_32x32x16_bf16 v[48:63], a[244:247], v[96:99], v[48:63]
    s_waitcnt vmcnt(14)
    v_mfma_f32_32x32x16_bf16 v[32:47], a[248:251], v[100:103], v[32:47]
    s_add_u32 s31, s47, 43008
    buffer_load_dwordx4 v[96:99], v8, s[4:7], s31 offen sc1
    v_mfma_f32_32x32x16_bf16 v[48:63], a[252:255], v[100:103], v[48:63]
    s_waitcnt vmcnt(14)
    v_mfma_f32_32x32x16_bf16 v[32:47], v[128:131], v[104:107], v[32:47]
    s_add_u32 s31, s47, 44032
    buffer_load_dwordx4 v[100:103], v8, s[4:7], s31 offen sc1
    v_mfma_f32_32x32x16_bf16 v[48:63], v[132:135], v[104:107], v[48:63]
    s_waitcnt vmcnt(14)
    s_waitcnt lgkmcnt(0)
    v_mfma_f32_32x32x16_bf16 v[32:47], v[16:19], v[108:111], v[32:47]
    s_add_u32 s31, s47, 45056
    buffer_load_dwordx4 v[104:107], v8, s[4:7], s31 offen sc1
    v_mfma_f32_32x32x16_bf16 v[48:63], v[20:23], v[108:111], v[48:63]
    ds_read_b64_tr_b16 v[24:25], v7 offset:22528
    ds_read_b64_tr_b16 v[26:27], v7 offset:23552
    ds_read_b64_tr_b16 v[28:29], v7 offset:22592
    ds_read_b64_tr_b16 v[30:31], v7 offset:23616
    s_waitcnt vmcnt(14)
    v_mfma_f32_32x32x16_bf16 v[32:47], v[136:139], v[112:115], v[32:47]
    s_add_u32 s31, s47, 63488
    buffer_load_dwordx4 v[108:111], v8, s[4:7], s31 offen sc1
    v_mfma_f32_32x32x16_bf16 v[48:63], v[140:143], v[112:115], v[48:63]
    s_waitcnt vmcnt(14)
    v_mfma_f32_32x32x16_bf16 v[32:47], v[144:147], v[116:119], v[32:47]
    s_add_u32 s31, s47, 46080
    buffer_load_dwordx4 v[112:115], v8, s[4:7], s31 offen sc1
    v_mfma_f32_32x32x16_bf16 v[48:63], v[148:151], v[116:119], v[48:63]
    s_waitcnt vmcnt(14)
    v_mfma_f32_32x32x16_bf16 v[32:47], v[152:155], v[120:123], v[32:47]
    s_add_u32 s31, s47, 47104
    buffer_load_dwordx4 v[116:119], v8, s[4:7], s31 offen sc1
    v_mfma_f32_32x32x16_bf16 v[48:63], v[156:159], v[120:123], v[48:63]
    s_waitcnt vmcnt(14)
    s_waitcnt lgkmcnt(0)
    v_mfma_f32_32x32x16_bf16 v[32:47], v[24:27], v[124:127], v[32:47]
    s_add_u32 s31, s47, 48128
    buffer_load_dwordx4 v[120:123], v8, s[4:7], s31 offen sc1
    v_mfma_f32_32x32x16_bf16 v[48:63], v[28:31], v[124:127], v[48:63]
    ds_read_b64_tr_b16 v[16:17], v7 offset:24576
    ds_read_b64_tr_b16 v[18:19], v7 offset:25600
    ds_read_b64_tr_b16 v[20:21], v7 offset:24640
    ds_read_b64_tr_b16 v[22:23], v7 offset:25664
    s_waitcnt vmcnt(14)
    v_mfma_f32_32x32x16_bf16 v[32:47], v[160:163], v[64:67], v[32:47]
    s_add_u32 s31, s47, 64512
    buffer_load_dwordx4 v[124:127], v8, s[4:7], s31 offen sc1
    v_mfma_f32_32x32x16_bf16 v[48:63], v[164:167], v[64:67], v[48:63]
    s_waitcnt vmcnt(14)
    v_mfma_f32_32x32x16_bf16 v[32:47], v[168:171], v[68:71], v[32:47]
    v_cmp_eq_u32 vcc, 0, v13
    s_lshl_b32 s46, s35, 18
    s_add_u32 s46, s46, 67108864
    s_cmp_eq_u64 vcc, 0
    s_cselect_b32 s51, 1, 0
    s_cmp_ge_u32 s35, 64
    s_cselect_b32 s51, 0, s51
    s_cmp_eq_u32 s51, 0
    s_cselect_b32 s46, s47, s46
    s_add_u32 s31, s46, 0
    buffer_load_dwordx4 v[64:67], v8, s[4:7], s31 offen sc1
    v_mfma_f32_32x32x16_bf16 v[48:63], v[172:175], v[68:71], v[48:63]
    s_waitcnt vmcnt(14)
    v_mfma_f32_32x32x16_bf16 v[32:47], v[176:179], v[72:75], v[32:47]
    s_add_u32 s31, s46, 1024
    buffer_load_dwordx4 v[68:71], v8, s[4:7], s31 offen sc1
    v_mfma_f32_32x32x16_bf16 v[48:63], v[180:183], v[72:75], v[48:63]
    s_waitcnt vmcnt(14)
    s_waitcnt lgkmcnt(0)
    v_mfma_f32_32x32x16_bf16 v[32:47], v[16:19], v[76:79], v[32:47]
    s_add_u32 s31, s46, 2048
    buffer_load_dwordx4 v[72:75], v8, s[4:7], s31 offen sc1
    v_mfma_f32_32x32x16_bf16 v[48:63], v[20:23], v[76:79], v[48:63]
    ds_read_b64_tr_b16 v[24:25], v7 offset:26624
    ds_read_b64_tr_b16 v[26:27], v7 offset:27648
    ds_read_b64_tr_b16 v[28:29], v7 offset:26688
    ds_read_b64_tr_b16 v[30:31], v7 offset:27712
    s_waitcnt vmcnt(14)
    v_mfma_f32_32x32x16_bf16 v[32:47], v[184:187], v[80:83], v[32:47]
    s_add_u32 s31, s46, 49152
    buffer_load_dwordx4 v[76:79], v8, s[4:7], s31 offen sc1
    v_mfma_f32_32x32x16_bf16 v[48:63], v[188:191], v[80:83], v[48:63]
    s_waitcnt vmcnt(14)
    v_mfma_f32_32x32x16_bf16 v[32:47], v[192:195], v[84:87], v[32:47]
    s_add_u32 s31, s46, 3072
    buffer_load_dwordx4 v[80:83], v8, s[4:7], s31 offen sc1
    v_mfma_f32_32x32x16_bf16 v[48:63], v[196:199], v[84:87], v[48:63]
    s_waitcnt vmcnt(14)
    v_mfma_f32_32x32x16_bf16 v[32:47], v[200:203], v[88:91], v[32:47]
    s_add_u32 s31, s46, 4096
    buffer_load_dwordx4 v[84:87], v8, s[4:7], s31 offen sc1
    v_mfma_f32_32x32x16_bf16 v[48:63], v[204:207], v[88:91], v[48:63]
    s_waitcnt vmcnt(14)
    s_waitcnt lgkmcnt(0)
    v_mfma_f32_32x32x16_bf16 v[32:47], v[24:27], v[92:95], v[32:47]
    s_add_u32 s31, s46, 5120
    buffer_load_dwordx4 v[88:91], v8, s[4:7], s31 offen sc1
    v_mfma_f32_32x32x16_bf16 v[48:63], v[28:31], v[92:95], v[48:63]
    ds_read_b64_tr_b16 v[16:17], v7 offset:28672
    ds_read_b64_tr_b16 v[18:19], v7 offset:29696
    ds_read_b64_tr_b16 v[20:21], v7 offset:28736
    ds_read_b64_tr_b16 v[22:23], v7 offset:29760
    s_waitcnt vmcnt(14)
    v_mfma_f32_32x32x16_bf16 v[32:47], v[208:211], v[96:99], v[32:47]
    s_add_u32 s31, s46, 50176
    buffer_load_dwordx4 v[92:95], v8, s[4:7], s31 offen sc1
    v_mfma_f32_32x32x16_bf16 v[48:63], v[212:215], v[96:99], v[48:63]
    s_waitcnt vmcnt(14)
    v_mfma_f32_32x32x16_bf16 v[32:47], v[216:219], v[100:103], v[32:47]
    s_add_u32 s31, s46, 6144
    buffer_load_dwordx4 v[96:99], v8, s[4:7], s31 offen sc1
    v_mfma_f32_32x32x16_bf16 v[48:63], v[220:223], v[100:103], v[48:63]
    s_waitcnt vmcnt(14)
    v_mfma_f32_32x32x16_bf16 v[32:47], v[224:227], v[104:107], v[32:47]
    s_add_u32 s31, s46, 7168
    buffer_load_dwordx4 v[100:103], v8, s[4:7], s31 offen sc1
    v_mfma_f32_32x32x16_bf16 v[48:63], v[228:231], v[104:107], v[48:63]
    s_waitcnt vmcnt(14)
    s_waitcnt lgkmcnt(0)
    v_mfma_f32_32x32x16_bf16 v[32:47], v[16:19], v[108:111], v[32:47]
    s_add_u32 s31, s46, 8192
    buffer_load_dwordx4 v[104:107], v8, s[4:7], s31 offen sc1
    v_mfma_f32_32x32x16_bf16 v[48:63], v[20:23], v[108:111], v[48:63]
    ds_read_b64_tr_b16 v[24:25], v7 offset:30720
    ds_read_b64_tr_b16 v[26:27], v7 offset:31744
    ds_read_b64_tr_b16 v[28:29], v7 offset:30784
    ds_read_b64_tr_b16 v[30:31], v7 offset:31808
    s_waitcnt vmcnt(14)
    v_mfma_f32_32x32x16_bf16 v[32:47], v[232:235], v[112:115], v[32:47]
    s_add_u32 s31, s46, 51200
    buffer_load_dwordx4 v[108:111], v8, s[4:7], s31 offen sc1
    v_mfma_f32_32x32x16_bf16 v[48:63], v[236:239], v[112:115], v[48:63]
    s_waitcnt vmcnt(14)
    v_mfma_f32_32x32x16_bf16 v[32:47], v[240:243], v[116:119], v[32:47]
    s_add_u32 s31, s46, 9216
    buffer_load_dwordx4 v[112:115], v8, s[4:7], s31 offen sc1
    v_mfma_f32_32x32x16_bf16 v[48:63], v[244:247], v[116:119], v[48:63]
    s_waitcnt vmcnt(14)
    v_mfma_f32_32x32x16_bf16 v[32:47], v[248:251], v[120:123], v[32:47]
    s_add_u32 s31, s46, 10240
    buffer_load_dwordx4 v[116:119], v8, s[4:7], s31 offen sc1
    v_mfma_f32_32x32x16_bf16 v[48:63], v[252:255], v[120:123], v[48:63]
    s_waitcnt vmcnt(14)
    s_waitcnt lgkmcnt(0)
    v_mfma_f32_32x32x16_bf16 v[32:47], v[24:27], v[124:127], v[32:47]
    s_add_u32 s31, s46, 11264
    buffer_load_dwordx4 v[120:123], v8, s[4:7], s31 offen sc1
    v_mfma_f32_32x32x16_bf16 v[48:63], v[28:31], v[124:127], v[48:63]
    s_barrier
    s_nop 7
    ds_write_b128 v9, v[32:35] offset:0
    ds_write_b128 v9, v[36:39] offset:1024
    ds_write_b128 v9, v[40:43] offset:2048
    ds_write_b128 v9, v[44:47] offset:3072
    ds_write_b128 v9, v[48:51] offset:4096
    ds_write_b128 v9, v[52:55] offset:5120
    ds_write_b128 v9, v[56:59] offset:6144
    ds_write_b128 v9, v[60:63] offset:7168
    s_waitcnt lgkmcnt(0)
    s_barrier
    ds_read_b128 v[32:35], v10 offset:0
    ds_read_b128 v[36:39], v10 offset:8192
    ds_read_b128 v[40:43], v10 offset:16384
    ds_read_b128 v[44:47], v10 offset:24576
    ds_read_b128 v[48:51], v10 offset:4096
    ds_read_b128 v[52:55], v10 offset:12288
    ds_read_b128 v[56:59], v10 offset:20480
    ds_read_b128 v[60:63], v10 offset:28672
    s_waitcnt lgkmcnt(4)
    v_pk_add_f32 v[32:33], v[32:33], v[36:37]
    v_pk_add_f32 v[34:35], v[34:35], v[38:39]
    v_pk_add_f32 v[40:41], v[40:41], v[44:45]
    v_pk_add_f32 v[42:43], v[42:43], v[46:47]
    v_pk_add_f32 v[32:33], v[32:33], v[40:41]
    v_pk_add_f32 v[34:35], v[34:35], v[42:43]
    v_cvt_pk_bf16_f32 v24, v32, v33
    v_cvt_pk_bf16_f32 v25, v34, v35
    buffer_store_dwordx2 v[24:25], v11, s[20:23], s49 offen offset:0
    s_waitcnt lgkmcnt(0)
    v_pk_add_f32 v[48:49], v[48:49], v[52:53]
    v_pk_add_f32 v[50:51], v[50:51], v[54:55]
    v_pk_add_f32 v[56:57], v[56:57], v[60:61]
    v_pk_add_f32 v[58:59], v[58:59], v[62:63]
    v_pk_add_f32 v[48:49], v[48:49], v[56:57]
    v_pk_add_f32 v[50:51], v[50:51], v[58:59]
    v_cvt_pk_bf16_f32 v26, v48, v49
    v_cvt_pk_bf16_f32 v27, v50, v51
    buffer_store_dwordx2 v[26:27], v11, s[20:23], s49 offen offset:64
    s_mov_b32 s30, s35
    s_mov_b32 s47, s46
    s_cmp_lg_u32 s51, 0
    s_cbranch_scc1 o6_go_76
    s_cmp_lt_u32 s30, 64
    s_cbranch_scc1 o6_loop_75
    s_branch L_dump
L_ob:
    s_load_dwordx4 s[72:75], s[0:1], 72
    s_add_u32 s76, s90, 83886080
    s_addc_u32 s77, s91, 0
    s_sub_u32 s32, s28, 96
    s_lshr_b32 s32, s32, 3
    s_mul_i32 s30, s32, 22
    s_add_u32 s51, s30, 22
    s_min_u32 s51, s51, 64
    s_sub_u32 s52, s51, 1
    s_lshl_b32 s52, s52, 16
    s_waitcnt lgkmcnt(0)
    s_mov_b32 s8, s72
    s_and_b32 s9, s73, 0xffff
    s_mov_b32 s10, 2097152
    s_mov_b32 s11, 0x00020000
    s_mov_b32 s20, s74
    s_and_b32 s21, s75, 0xffff
    s_mov_b32 s22, 8388608
    s_mov_b32 s23, 0x00020000
    s_mov_b32 s12, s76
    s_and_b32 s13, s77, 0xffff
    s_mov_b32 s14, 4194304
    s_mov_b32 s15, 0x00020000
    s_and_b32 s31, s28, 7
    s_lshl_b32 s31, s31, 8
    s_lshl_b32 s33, s29, 6
    s_add_u32 s31, s31, s33
    v_lshrrev_b32 v6, 2, v1
    v_lshlrev_b32 v6, 11, v6
    v_and_b32 v4, 3, v1
    v_lshl_add_u32 v6, v4, 4, v6
    v_add_u32 v6, s31, v6
    s_mov_b32 s39, 32768
    s_lshl_b32 s36, s30, 17
    s_and_b32 s33, s28, 7
    s_lshl_b32 s33, s33, 8
    s_add_u32 s36, s36, s33
    s_add_u32 s36, s36, 2048
    s_mov_b32 s37, 131072
    s_lshl_b32 s31, s29, 15
    v_lshrrev_b32 v7, 4, v1
    v_lshlrev_b32 v7, 9, v7
    v_bfe_u32 v4, v1, 2, 2
    v_lshl_add_u32 v7, v4, 6, v7
    v_and_b32 v4, 3, v1
    v_lshl_add_u32 v7, v4, 4, v7
    v_add_u32 v7, s31, v7
    s_lshl_b32 s32, s29, 15
    s_add_u32 m0, s32, 0
    s_mov_b32 s38, 0
    buffer_load_dwordx4 v6, s[8:11], s38 offen lds
    s_add_u32 m0, s32, 1024
    s_add_u32 s38, s38, s39
    buffer_load_dwordx4 v6, s[8:11], s38 offen lds
    s_add_u32 m0, s32, 2048
    s_add_u32 s38, s38, s39
    buffer_load_dwordx4 v6, s[8:11], s38 offen lds
    s_add_u32 m0, s32, 3072
    s_add_u32 s38, s38, s39
    buffer_load_dwordx4 v6, s[8:11], s38 offen lds
    s_add_u32 m0, s32, 4096
    s_add_u32 s38, s38, s39
    buffer_load_dwordx4 v6, s[8:11], s38 offen lds
    s_add_u32 m0, s32, 5120
    s_add_u32 s38, s38, s39
    buffer_load_dwordx4 v6, s[8:11], s38 offen lds
    s_add_u32 m0, s32, 6144
    s_add_u32 s38, s38, s39
    buffer_load_dwordx4 v6, s[8:11], s38 offen lds
    s_add_u32 m0, s32, 7168
    s_add_u32 s38, s38, s39
    buffer_load_dwordx4 v6, s[8:11], s38 offen lds
    s_add_u32 m0, s32, 8192
    s_add_u32 s38, s38, s39
    buffer_load_dwordx4 v6, s[8:11], s38 offen lds
    s_add_u32 m0, s32, 9216
    s_add_u32 s38, s38, s39
    buffer_load_dwordx4 v6, s[8:11], s38 offen lds
    s_add_u32 m0, s32, 10240
    s_add_u32 s38, s38, s39
    buffer_load_dwordx4 v6, s[8:11], s38 offen lds
    s_add_u32 m0, s32, 11264
    s_add_u32 s38, s38, s39
    buffer_load_dwordx4 v6, s[8:11], s38 offen lds
    s_add_u32 m0, s32, 12288
    s_add_u32 s38, s38, s39
    buffer_load_dwordx4 v6, s[8:11], s38 offen lds
    s_add_u32 m0, s32, 13312
    s_add_u32 s38, s38, s39
    buffer_load_dwordx4 v6, s[8:11], s38 offen lds
    s_add_u32 m0, s32, 14336
    s_add_u32 s38, s38, s39
    buffer_load_dwordx4 v6, s[8:11], s38 offen lds
    s_add_u32 m0, s32, 15360
    s_add_u32 s38, s38, s39
    buffer_load_dwordx4 v6, s[8:11], s38 offen lds
    s_add_u32 m0, s32, 16384
    s_add_u32 s38, s38, s39
    buffer_load_dwordx4 v6, s[8:11], s38 offen lds
    s_add_u32 m0, s32, 17408
    s_add_u32 s38, s38, s39
    buffer_load_dwordx4 v6, s[8:11], s38 offen lds
    s_add_u32 m0, s32, 18432
    s_add_u32 s38, s38, s39
    buffer_load_dwordx4 v6, s[8:11], s38 offen lds
    s_add_u32 m0, s32, 19456
    s_add_u32 s38, s38, s39
    buffer_load_dwordx4 v6, s[8:11], s38 offen lds
    s_add_u32 m0, s32, 20480
    s_add_u32 s38, s38, s39
    buffer_load_dwordx4 v6, s[8:11], s38 offen lds
    s_add_u32 m0, s32, 21504
    s_add_u32 s38, s38, s39
    buffer_load_dwordx4 v6, s[8:11], s38 offen lds
    s_add_u32 m0, s32, 22528
    s_add_u32 s38, s38, s39
    buffer_load_dwordx4 v6, s[8:11], s38 offen lds
    s_add_u32 m0, s32, 23552
    s_add_u32 s38, s38, s39
    buffer_load_dwordx4 v6, s[8:11], s38 offen lds
    s_add_u32 m0, s32, 24576
    s_add_u32 s38, s38, s39
    buffer_load_dwordx4 v6, s[8:11], s38 offen lds
    s_add_u32 m0, s32, 25600
    s_add_u32 s38, s38, s39
    buffer_load_dwordx4 v6, s[8:11], s38 offen lds
    s_add_u32 m0, s32, 26624
    s_add_u32 s38, s38, s39
    buffer_load_dwordx4 v6, s[8:11], s38 offen lds
    s_add_u32 m0, s32, 27648
    s_add_u32 s38, s38, s39
    buffer_load_dwordx4 v6, s[8:11], s38 offen lds
    s_add_u32 m0, s32, 28672
    s_add_u32 s38, s38, s39
    buffer_load_dwordx4 v6, s[8:11], s38 offen lds
    s_add_u32 m0, s32, 29696
    s_add_u32 s38, s38, s39
    buffer_load_dwordx4 v6, s[8:11], s38 offen lds
    s_add_u32 m0, s32, 30720
    s_add_u32 s38, s38, s39
    buffer_load_dwordx4 v6, s[8:11], s38 offen lds
    s_add_u32 m0, s32, 31744
    s_add_u32 s38, s38, s39
    buffer_load_dwordx4 v6, s[8:11], s38 offen lds
    s_waitcnt vmcnt(30)
    ds_read_b64_tr_b16 a[0:1], v7 offset:0
    ds_read_b64_tr_b16 a[2:3], v7 offset:256
    ds_read_b64_tr_b16 a[4:5], v7 offset:8
    ds_read_b64_tr_b16 a[6:7], v7 offset:264
    s_waitcnt vmcnt(28)
    ds_read_b64_tr_b16 a[8:9], v7 offset:2048
    ds_read_b64_tr_b16 a[10:11], v7 offset:2304
    ds_read_b64_tr_b16 a[12:13], v7 offset:2056
    ds_read_b64_tr_b16 a[14:15], v7 offset:2312
    s_waitcnt lgkmcnt(4)
    s_add_u32 m0, s32, 0
    s_add_u32 s38, s38, s39
    buffer_load_dwordx4 v6, s[8:11], s38 offen lds
    s_add_u32 m0, s32, 1024
    s_add_u32 s38, s38, s39
    buffer_load_dwordx4 v6, s[8:11], s38 offen lds
    s_waitcnt vmcnt(28)
    ds_read_b64_tr_b16 a[16:17], v7 offset:4096
    ds_read_b64_tr_b16 a[18:19], v7 offset:4352
    ds_read_b64_tr_b16 a[20:21], v7 offset:4104
    ds_read_b64_tr_b16 a[22:23], v7 offset:4360
    s_waitcnt lgkmcnt(4)
    s_add_u32 m0, s32, 2048
    s_add_u32 s38, s38, s39
    buffer_load_dwordx4 v6, s[8:11], s38 offen lds
    s_add_u32 m0, s32, 3072
    s_add_u32 s38, s38, s39
    buffer_load_dwordx4 v6, s[8:11], s38 offen lds
    s_waitcnt vmcnt(28)
    ds_read_b64_tr_b16 a[24:25], v7 offset:6144
    ds_read_b64_tr_b16 a[26:27], v7 offset:6400
    ds_read_b64_tr_b16 a[28:29], v7 offset:6152
    ds_read_b64_tr_b16 a[30:31], v7 offset:6408
    s_waitcnt lgkmcnt(4)
    s_add_u32 m0, s32, 4096
    s_add_u32 s38, s38, s39
    buffer_load_dwordx4 v6, s[8:11], s38 offen lds
    s_add_u32 m0, s32, 5120
    s_add_u32 s38, s38, s39
    buffer_load_dwordx4 v6, s[8:11], s38 offen lds
    s_waitcnt vmcnt(28)
    ds_read_b64_tr_b16 a[32:33], v7 offset:8192
    ds_read_b64_tr_b16 a[34:35], v7 offset:8448
    ds_read_b64_tr_b16 a[36:37], v7 offset:8200
    ds_read_b64_tr_b16 a[38:39], v7 offset:8456
    s_waitcnt lgkmcnt(4)
    s_add_u32 m0, s32, 6144
    s_add_u32 s38, s38, s39
    buffer_load_dwordx4 v6, s[8:11], s38 offen lds
    s_add_u32 m0, s32, 7168
    s_add_u32 s38, s38, s39
    buffer_load_dwordx4 v6, s[8:11], s38 offen lds
    s_waitcnt vmcnt(28)
    ds_read_b64_tr_b16 a[40:41], v7 offset:10240
    ds_read_b64_tr_b16 a[42:43], v7 offset:10496
    ds_read_b64_tr_b16 a[44:45], v7 offset:10248
    ds_read_b64_tr_b16 a[46:47], v7 offset:10504
    s_waitcnt lgkmcnt(4)
    s_add_u32 m0, s32, 8192
    s_add_u32 s38, s38, s39
    buffer_load_dwordx4 v6, s[8:11], s38 offen lds
    s_add_u32 m0, s32, 9216
    s_add_u32 s38, s38, s39
    buffer_load_dwordx4 v6, s[8:11], s38 offen lds
    s_waitcnt vmcnt(28)
    ds_read_b64_tr_b16 a[48:49], v7 offset:12288
    ds_read_b64_tr_b16 a[50:51], v7 offset:12544
    ds_read_b64_tr_b16 a[52:53], v7 offset:12296
    ds_read_b64_tr_b16 a[54:55], v7 offset:12552
    s_waitcnt lgkmcnt(4)
    s_add_u32 m0, s32, 10240
    s_add_u32 s38, s38, s39
    buffer_load_dwordx4 v6, s[8:11], s38 offen lds
    s_add_u32 m0, s32, 11264
    s_add_u32 s38, s38, s39
    buffer_load_dwordx4 v6, s[8:11], s38 offen lds
    s_waitcnt vmcnt(28)
    ds_read_b64_tr_b16 a[56:57], v7 offset:14336
    ds_read_b64_tr_b16 a[58:59], v7 offset:14592
    ds_read_b64_tr_b16 a[60:61], v7 offset:14344
    ds_read_b64_tr_b16 a[62:63], v7 offset:14600
    s_waitcnt lgkmcnt(4)
    s_add_u32 m0, s32, 12288
    s_add_u32 s38, s38, s39
    buffer_load_dwordx4 v6, s[8:11], s38 offen lds
    s_add_u32 m0, s32, 13312
    s_add_u32 s38, s38, s39
    buffer_load_dwordx4 v6, s[8:11], s38 offen lds
    s_waitcnt vmcnt(28)
    ds_read_b64_tr_b16 a[64:65], v7 offset:16384
    ds_read_b64_tr_b16 a[66:67], v7 offset:16640
    ds_read_b64_tr_b16 a[68:69], v7 offset:16392
    ds_read_b64_tr_b16 a[70:71], v7 offset:16648
    s_waitcnt lgkmcnt(4)
    s_add_u32 m0, s32, 14336
    s_add_u32 s38, s38, s39
    buffer_load_dwordx4 v6, s[8:11], s38 offen lds
    s_add_u32 m0, s32, 15360
    s_add_u32 s38, s38, s39
    buffer_load_dwordx4 v6, s[8:11], s38 offen lds
    s_waitcnt vmcnt(28)
    ds_read_b64_tr_b16 a[72:73], v7 offset:18432
    ds_read_b64_tr_b16 a[74:75], v7 offset:18688
    ds_read_b64_tr_b16 a[76:77], v7 offset:18440
    ds_read_b64_tr_b16 a[78:79], v7 offset:18696
    s_waitcnt lgkmcnt(4)
    s_add_u32 m0, s32, 16384
    s_add_u32 s38, s38, s39
    buffer_load_dwordx4 v6, s[8:11], s38 offen lds
    s_add_u32 m0, s32, 17408
    s_add_u32 s38, s38, s39
    buffer_load_dwordx4 v6, s[8:11], s38 offen lds
    s_waitcnt vmcnt(28)
    ds_read_b64_tr_b16 a[80:81], v7 offset:20480
    ds_read_b64_tr_b16 a[82:83], v7 offset:20736
    ds_read_b64_tr_b16 a[84:85], v7 offset:20488
    ds_read_b64_tr_b16 a[86:87], v7 offset:20744
    s_waitcnt lgkmcnt(4)
    s_add_u32 m0, s32, 18432
    s_add_u32 s38, s38, s39
    buffer_load_dwordx4 v6, s[8:11], s38 offen lds
    s_add_u32 m0, s32, 19456
    s_add_u32 s38, s38, s39
    buffer_load_dwordx4 v6, s[8:11], s38 offen lds
    s_waitcnt vmcnt(28)
    ds_read_b64_tr_b16 a[88:89], v7 offset:22528
    ds_read_b64_tr_b16 a[90:91], v7 offset:22784
    ds_read_b64_tr_b16 a[92:93], v7 offset:22536
    ds_read_b64_tr_b16 a[94:95], v7 offset:22792
    s_waitcnt lgkmcnt(4)
    s_add_u32 m0, s32, 20480
    s_add_u32 s38, s38, s39
    buffer_load_dwordx4 v6, s[8:11], s38 offen lds
    s_add_u32 m0, s32, 21504
    s_add_u32 s38, s38, s39
    buffer_load_dwordx4 v6, s[8:11], s38 offen lds
    s_waitcnt vmcnt(28)
    ds_read_b64_tr_b16 a[96:97], v7 offset:24576
    ds_read_b64_tr_b16 a[98:99], v7 offset:24832
    ds_read_b64_tr_b16 a[100:101], v7 offset:24584
    ds_read_b64_tr_b16 a[102:103], v7 offset:24840
    s_waitcnt lgkmcnt(4)
    s_add_u32 m0, s32, 22528
    s_add_u32 s38, s38, s39
    buffer_load_dwordx4 v6, s[8:11], s38 offen lds
    s_add_u32 m0, s32, 23552
    s_add_u32 s38, s38, s39
    buffer_load_dwordx4 v6, s[8:11], s38 offen lds
    s_waitcnt vmcnt(28)
    ds_read_b64_tr_b16 a[104:105], v7 offset:26624
    ds_read_b64_tr_b16 a[106:107], v7 offset:26880
    ds_read_b64_tr_b16 a[108:109], v7 offset:26632
    ds_read_b64_tr_b16 a[110:111], v7 offset:26888
    s_waitcnt lgkmcnt(4)
    s_add_u32 m0, s32, 24576
    s_add_u32 s38, s38, s39
    buffer_load_dwordx4 v6, s[8:11], s38 offen lds
    s_add_u32 m0, s32, 25600
    s_add_u32 s38, s38, s39
    buffer_load_dwordx4 v6, s[8:11], s38 offen lds
    s_waitcnt vmcnt(28)
    ds_read_b64_tr_b16 a[112:113], v7 offset:28672
    ds_read_b64_tr_b16 a[114:115], v7 offset:28928
    ds_read_b64_tr_b16 a[116:117], v7 offset:28680
    ds_read_b64_tr_b16 a[118:119], v7 offset:28936
    s_waitcnt lgkmcnt(4)
    s_add_u32 m0, s32, 26624
    s_add_u32 s38, s38, s39
    buffer_load_dwordx4 v6, s[8:11], s38 offen lds
    s_add_u32 m0, s32, 27648
    s_add_u32 s38, s38, s39
    buffer_load_dwordx4 v6, s[8:11], s38 offen lds
    s_waitcnt vmcnt(28)
    ds_read_b64_tr_b16 a[120:121], v7 offset:30720
    ds_read_b64_tr_b16 a[122:123], v7 offset:30976
    ds_read_b64_tr_b16 a[124:125], v7 offset:30728
    ds_read_b64_tr_b16 a[126:127], v7 offset:30984
    s_waitcnt lgkmcnt(4)
    s_add_u32 m0, s32, 28672
    s_add_u32 s38, s38, s39
    buffer_load_dwordx4 v6, s[8:11], s38 offen lds
    s_add_u32 m0, s32, 29696
    s_add_u32 s38, s38, s39
    buffer_load_dwordx4 v6, s[8:11], s38 offen lds
    s_waitcnt vmcnt(28)
    ds_read_b64_tr_b16 a[128:129], v7 offset:0
    ds_read_b64_tr_b16 a[130:131], v7 offset:256
    ds_read_b64_tr_b16 a[132:133], v7 offset:8
    ds_read_b64_tr_b16 a[134:135], v7 offset:264
    s_waitcnt lgkmcnt(4)
    s_add_u32 m0, s32, 30720
    s_add_u32 s38, s38, s39
    buffer_load_dwordx4 v6, s[8:11], s38 offen lds
    s_add_u32 m0, s32, 31744
    s_add_u32 s38, s38, s39
    buffer_load_dwordx4 v6, s[8:11], s38 offen lds
    s_waitcnt vmcnt(28)
    ds_read_b64_tr_b16 a[136:137], v7 offset:2048
    ds_read_b64_tr_b16 a[138:139], v7 offset:2304
    ds_read_b64_tr_b16 a[140:141], v7 offset:2056
    ds_read_b64_tr_b16 a[142:143], v7 offset:2312
    s_waitcnt vmcnt(26)
    ds_read_b64_tr_b16 a[144:145], v7 offset:4096
    ds_read_b64_tr_b16 a[146:147], v7 offset:4352
    ds_read_b64_tr_b16 a[148:149], v7 offset:4104
    ds_read_b64_tr_b16 a[150:151], v7 offset:4360
    s_waitcnt vmcnt(24)
    ds_read_b64_tr_b16 a[152:153], v7 offset:6144
    ds_read_b64_tr_b16 a[154:155], v7 offset:6400
    ds_read_b64_tr_b16 a[156:157], v7 offset:6152
    ds_read_b64_tr_b16 a[158:159], v7 offset:6408
    s_waitcnt vmcnt(22)
    ds_read_b64_tr_b16 a[160:161], v7 offset:8192
    ds_read_b64_tr_b16 a[162:163], v7 offset:8448
    ds_read_b64_tr_b16 a[164:165], v7 offset:8200
    ds_read_b64_tr_b16 a[166:167], v7 offset:8456
    s_waitcnt vmcnt(20)
    ds_read_b64_tr_b16 a[168:169], v7 offset:10240
    ds_read_b64_tr_b16 a[170:171], v7 offset:10496
    ds_read_b64_tr_b16 a[172:173], v7 offset:10248
    ds_read_b64_tr_b16 a[174:175], v7 offset:10504
    s_waitcnt vmcnt(18)
    ds_read_b64_tr_b16 a[176:177], v7 offset:12288
    ds_read_b64_tr_b16 a[178:179], v7 offset:12544
    ds_read_b64_tr_b16 a[180:181], v7 offset:12296
    ds_read_b64_tr_b16 a[182:183], v7 offset:12552
    s_waitcnt vmcnt(16)
    ds_read_b64_tr_b16 a[184:185], v7 offset:14336
    ds_read_b64_tr_b16 a[186:187], v7 offset:14592
    ds_read_b64_tr_b16 a[188:189], v7 offset:14344
    ds_read_b64_tr_b16 a[190:191], v7 offset:14600
    s_waitcnt vmcnt(14)
    ds_read_b64_tr_b16 a[192:193], v7 offset:16384
    ds_read_b64_tr_b16 a[194:195], v7 offset:16640
    ds_read_b64_tr_b16 a[196:197], v7 offset:16392
    ds_read_b64_tr_b16 a[198:199], v7 offset:16648
    s_waitcnt vmcnt(12)
    ds_read_b64_tr_b16 a[200:201], v7 offset:18432
    ds_read_b64_tr_b16 a[202:203], v7 offset:18688
    ds_read_b64_tr_b16 a[204:205], v7 offset:18440
    ds_read_b64_tr_b16 a[206:207], v7 offset:18696
    s_waitcnt vmcnt(10)
    ds_read_b64_tr_b16 a[208:209], v7 offset:20480
    ds_read_b64_tr_b16 a[210:211], v7 offset:20736
    ds_read_b64_tr_b16 a[212:213], v7 offset:20488
    ds_read_b64_tr_b16 a[214:215], v7 offset:20744
    s_waitcnt vmcnt(8)
    ds_read_b64_tr_b16 a[216:217], v7 offset:22528
    ds_read_b64_tr_b16 a[218:219], v7 offset:22784
    ds_read_b64_tr_b16 a[220:221], v7 offset:22536
    ds_read_b64_tr_b16 a[222:223], v7 offset:22792
    s_waitcnt vmcnt(6)
    ds_read_b64_tr_b16 a[224:225], v7 offset:24576
    ds_read_b64_tr_b16 a[226:227], v7 offset:24832
    ds_read_b64_tr_b16 a[228:229], v7 offset:24584
    ds_read_b64_tr_b16 a[230:231], v7 offset:24840
    s_waitcnt vmcnt(4)
    ds_read_b64_tr_b16 a[232:233], v7 offset:26624
    ds_read_b64_tr_b16 a[234:235], v7 offset:26880
    ds_read_b64_tr_b16 a[236:237], v7 offset:26632
    ds_read_b64_tr_b16 a[238:239], v7 offset:26888
    s_waitcnt vmcnt(2)
    ds_read_b64_tr_b16 a[240:241], v7 offset:28672
    ds_read_b64_tr_b16 a[242:243], v7 offset:28928
    ds_read_b64_tr_b16 a[244:245], v7 offset:28680
    ds_read_b64_tr_b16 a[246:247], v7 offset:28936
    s_waitcnt vmcnt(0)
    ds_read_b64_tr_b16 a[248:249], v7 offset:30720
    ds_read_b64_tr_b16 a[250:251], v7 offset:30976
    ds_read_b64_tr_b16 a[252:253], v7 offset:30728
    ds_read_b64_tr_b16 a[254:255], v7 offset:30984
    s_waitcnt lgkmcnt(0)
    s_lshr_b32 s31, s29, 1
    s_and_b32 s31, s31, 1
    s_lshl_b32 s31, s31, 2
    v_lshrrev_b32 v2, 4, v1
    v_add_u32 v2, s31, v2
    v_and_b32 v3, 7, v1
    v_xor_b32 v2, v2, v3
    s_lshl_b32 s31, s29, 14
    v_lshrrev_b32 v8, 3, v1
    v_lshlrev_b32 v8, 11, v8
    v_add_u32 v8, s31, v8
    v_lshl_add_u32 v8, v2, 4, v8
    v_bfe_u32 v2, v1, 1, 3
    v_lshrrev_b32 v3, 4, v1
    v_xor_b32 v2, v2, v3
    v_bfe_u32 v3, v1, 3, 1
    v_lshlrev_b32 v3, 11, v3
    v_and_b32 v4, 7, v1
    v_lshl_add_u32 v3, v4, 7, v3
    v_xor_b32 v12, 0, v2
    v_lshl_add_u32 v12, v12, 4, v3
    v_add_u32 v14, 65536, v12
    v_xor_b32 v13, 4, v2
    v_lshl_add_u32 v13, v13, 4, v3
    v_add_u32 v15, 65536, v13
    s_lshl_b32 s31, s29, 6
    v_and_b32 v9, 15, v1
    v_lshlrev_b32 v9, 12, v9
    v_lshrrev_b32 v4, 4, v1
    v_lshl_add_u32 v9, v4, 4, v9
    v_add_u32 v9, s31, v9
    v_add_u32 v8, s34, v5
    v_lshrrev_b32 v12, 4, v1
    v_lshlrev_b32 v12, 9, v12
    v_and_b32 v4, 15, v1
    v_lshl_add_u32 v12, v4, 4, v12
    v_add_u32 v14, 65536, v12
    s_cmp_lg_u32 s29, 0
    s_cbranch_scc1 g_wdd_80
g_wd_79:
    s_load_dword s72, s[92:93], 0 glc
    s_add_u32 s41, s41, 1
    s_cmp_ge_u32 s41, 0x200000
    s_cbranch_scc1 g_wdd_80
    s_waitcnt lgkmcnt(0)
    s_and_b32 s72, s72, 0xffff
    s_cmp_ge_u32 s72, 256
    s_cbranch_scc1 g_wdd_80
    s_sleep 32
    s_branch g_wd_79
g_wdd_80:
    s_waitcnt lgkmcnt(0)
    s_barrier
    v_and_b32 v2, 31, v1
    v_lshlrev_b32 v2, 7, v2
    v_add_u32 v2, 115359744, v2
    s_cmp_lg_u32 s29, 0
    s_cbranch_scc1 g_wld_82
g_wl_81:
    buffer_load_dword v3, v2, s[4:7], 0 offen sc1
    s_add_u32 s41, s41, 1
    s_cmp_ge_u32 s41, 0x200000
    s_cbranch_scc1 g_wld_82
    s_waitcnt vmcnt(0)
    v_cmp_gt_u32 vcc, s51, v3
    s_cbranch_vccz g_wld_82
    s_sleep 8
    s_branch g_wl_81
g_wld_82:
    s_barrier
    s_lshl_b32 s35, s30, 16
    s_sub_u32 s36, s36, s37
    s_barrier
    s_add_u32 m0, s34, 0
    s_add_u32 s32, s35, 0
    buffer_load_dwordx4 v8, s[12:15], s32 offen sc1 lds
    s_add_u32 m0, s34, 4096
    s_add_u32 s32, s35, 4096
    buffer_load_dwordx4 v8, s[12:15], s32 offen sc1 lds
    s_add_u32 m0, s34, 8192
    s_add_u32 s32, s35, 8192
    buffer_load_dwordx4 v8, s[12:15], s32 offen sc1 lds
    s_add_u32 m0, s34, 12288
    s_add_u32 s32, s35, 12288
    buffer_load_dwordx4 v8, s[12:15], s32 offen sc1 lds
    s_add_u32 m0, s34, 16384
    s_add_u32 s32, s35, 16384
    buffer_load_dwordx4 v8, s[12:15], s32 offen sc1 lds
    s_add_u32 m0, s34, 20480
    s_add_u32 s32, s35, 20480
    buffer_load_dwordx4 v8, s[12:15], s32 offen sc1 lds
    s_add_u32 m0, s34, 24576
    s_add_u32 s32, s35, 24576
    buffer_load_dwordx4 v8, s[12:15], s32 offen sc1 lds
    s_add_u32 m0, s34, 28672
    s_add_u32 s32, s35, 28672
    buffer_load_dwordx4 v8, s[12:15], s32 offen sc1 lds
    s_add_u32 m0, s34, 32768
    s_add_u32 s32, s35, 32768
    buffer_load_dwordx4 v8, s[12:15], s32 offen sc1 lds
    s_add_u32 m0, s34, 36864
    s_add_u32 s32, s35, 36864
    buffer_load_dwordx4 v8, s[12:15], s32 offen sc1 lds
    s_add_u32 m0, s34, 40960
    s_add_u32 s32, s35, 40960
    buffer_load_dwordx4 v8, s[12:15], s32 offen sc1 lds
    s_add_u32 m0, s34, 45056
    s_add_u32 s32, s35, 45056
    buffer_load_dwordx4 v8, s[12:15], s32 offen sc1 lds
    s_add_u32 m0, s34, 49152
    s_add_u32 s32, s35, 49152
    buffer_load_dwordx4 v8, s[12:15], s32 offen sc1 lds
    s_add_u32 m0, s34, 53248
    s_add_u32 s32, s35, 53248
    buffer_load_dwordx4 v8, s[12:15], s32 offen sc1 lds
    s_add_u32 m0, s34, 57344
    s_add_u32 s32, s35, 57344
    buffer_load_dwordx4 v8, s[12:15], s32 offen sc1 lds
    s_add_u32 m0, s34, 61440
    s_add_u32 s32, s35, 61440
    buffer_load_dwordx4 v8, s[12:15], s32 offen sc1 lds
    s_add_u32 s35, s35, 65536
    s_add_u32 m0, s34, 65536
    s_add_u32 s32, s35, 0
    buffer_load_dwordx4 v8, s[12:15], s32 offen sc1 lds
    s_add_u32 m0, s34, 69632
    s_add_u32 s32, s35, 4096
    buffer_load_dwordx4 v8, s[12:15], s32 offen sc1 lds
    s_add_u32 m0, s34, 73728
    s_add_u32 s32, s35, 8192
    buffer_load_dwordx4 v8, s[12:15], s32 offen sc1 lds
    s_add_u32 m0, s34, 77824
    s_add_u32 s32, s35, 12288
    buffer_load_dwordx4 v8, s[12:15], s32 offen sc1 lds
    s_waitcnt vmcnt(12)
    s_barrier
    ds_read_b128 v[32:35], v12 offset:0
    ds_read_b128 v[36:39], v12 offset:256
    ds_read_b128 v[40:43], v12 offset:2048
    ds_read_b128 v[44:47], v12 offset:2304
    ds_read_b128 v[48:51], v12 offset:4096
    ds_read_b128 v[52:55], v12 offset:4352
    v_add_u32 v9, 2130706432, v9
sl_loop_85:
    s_waitcnt lgkmcnt(4)
    v_mfma_f32_16x16x32_bf16 v[64:67], a[0:3], v[32:35], 0
    ds_read_b128 v[56:59], v12 offset:6144
    v_mfma_f32_16x16x32_bf16 v[68:71], a[4:7], v[32:35], 0
    v_mfma_f32_16x16x32_bf16 v[72:75], a[0:3], v[36:39], 0
    ds_read_b128 v[60:63], v12 offset:6400
    s_add_u32 m0, s34, 81920
    s_add_u32 s32, s35, 16384
    v_mfma_f32_16x16x32_bf16 v[76:79], a[4:7], v[36:39], 0
    buffer_load_dwordx4 v8, s[12:15], s32 offen sc1 lds
    s_waitcnt lgkmcnt(4)
    v_mfma_f32_16x16x32_bf16 v[64:67], a[8:11], v[40:43], v[64:67]
    ds_read_b128 v[32:35], v12 offset:8192
    v_mfma_f32_16x16x32_bf16 v[68:71], a[12:15], v[40:43], v[68:71]
    v_mfma_f32_16x16x32_bf16 v[72:75], a[8:11], v[44:47], v[72:75]
    ds_read_b128 v[36:39], v12 offset:8448
    v_mfma_f32_16x16x32_bf16 v[76:79], a[12:15], v[44:47], v[76:79]
    s_waitcnt lgkmcnt(4)
    v_mfma_f32_16x16x32_bf16 v[64:67], a[16:19], v[48:51], v[64:67]
    ds_read_b128 v[40:43], v12 offset:10240
    v_mfma_f32_16x16x32_bf16 v[68:71], a[20:23], v[48:51], v[68:71]
    v_cvt_pk_bf16_f32 v96, v80, v81
    v_mfma_f32_16x16x32_bf16 v[72:75], a[16:19], v[52:55], v[72:75]
    ds_read_b128 v[44:47], v12 offset:10496
    s_add_u32 m0, s34, 86016
    s_add_u32 s32, s35, 20480
    v_mfma_f32_16x16x32_bf16 v[76:79], a[20:23], v[52:55], v[76:79]
    buffer_load_dwordx4 v8, s[12:15], s32 offen sc1 lds
    v_cvt_pk_bf16_f32 v97, v82, v83
    s_waitcnt lgkmcnt(4)
    v_mfma_f32_16x16x32_bf16 v[64:67], a[24:27], v[56:59], v[64:67]
    ds_read_b128 v[48:51], v12 offset:12288
    v_mfma_f32_16x16x32_bf16 v[68:71], a[28:31], v[56:59], v[68:71]
    v_cvt_pk_bf16_f32 v98, v84, v85
    v_mfma_f32_16x16x32_bf16 v[72:75], a[24:27], v[60:63], v[72:75]
    ds_read_b128 v[52:55], v12 offset:12544
    v_mfma_f32_16x16x32_bf16 v[76:79], a[28:31], v[60:63], v[76:79]
    v_cvt_pk_bf16_f32 v99, v86, v87
    s_waitcnt lgkmcnt(4)
    v_mfma_f32_16x16x32_bf16 v[64:67], a[32:35], v[32:35], v[64:67]
    ds_read_b128 v[56:59], v12 offset:14336
    v_mfma_f32_16x16x32_bf16 v[68:71], a[36:39], v[32:35], v[68:71]
    v_cvt_pk_bf16_f32 v100, v88, v89
    v_mfma_f32_16x16x32_bf16 v[72:75], a[32:35], v[36:39], v[72:75]
    ds_read_b128 v[60:63], v12 offset:14592
    s_add_u32 m0, s34, 90112
    s_add_u32 s32, s35, 24576
    v_mfma_f32_16x16x32_bf16 v[76:79], a[36:39], v[36:39], v[76:79]
    buffer_load_dwordx4 v8, s[12:15], s32 offen sc1 lds
    v_cvt_pk_bf16_f32 v101, v90, v91
    s_waitcnt lgkmcnt(4)
    v_mfma_f32_16x16x32_bf16 v[64:67], a[40:43], v[40:43], v[64:67]
    ds_read_b128 v[32:35], v12 offset:16384
    v_mfma_f32_16x16x32_bf16 v[68:71], a[44:47], v[40:43], v[68:71]
    v_cvt_pk_bf16_f32 v102, v92, v93
    v_mfma_f32_16x16x32_bf16 v[72:75], a[40:43], v[44:47], v[72:75]
    ds_read_b128 v[36:39], v12 offset:16640
    v_mfma_f32_16x16x32_bf16 v[76:79], a[44:47], v[44:47], v[76:79]
    v_cvt_pk_bf16_f32 v103, v94, v95
    buffer_store_dwordx4 v[96:99], v9, s[20:23], s36 offen
    s_add_u32 s31, s36, 65536
    s_waitcnt lgkmcnt(4)
    v_mfma_f32_16x16x32_bf16 v[64:67], a[48:51], v[48:51], v[64:67]
    ds_read_b128 v[40:43], v12 offset:18432
    v_mfma_f32_16x16x32_bf16 v[68:71], a[52:55], v[48:51], v[68:71]
    v_mfma_f32_16x16x32_bf16 v[72:75], a[48:51], v[52:55], v[72:75]
    ds_read_b128 v[44:47], v12 offset:18688
    s_add_u32 m0, s34, 94208
    s_add_u32 s32, s35, 28672
    v_mfma_f32_16x16x32_bf16 v[76:79], a[52:55], v[52:55], v[76:79]
    buffer_load_dwordx4 v8, s[12:15], s32 offen sc1 lds
    s_waitcnt lgkmcnt(4)
    v_mfma_f32_16x16x32_bf16 v[64:67], a[56:59], v[56:59], v[64:67]
    ds_read_b128 v[48:51], v12 offset:20480
    v_mfma_f32_16x16x32_bf16 v[68:71], a[60:63], v[56:59], v[68:71]
    v_mfma_f32_16x16x32_bf16 v[72:75], a[56:59], v[60:63], v[72:75]
    ds_read_b128 v[52:55], v12 offset:20736
    v_mfma_f32_16x16x32_bf16 v[76:79], a[60:63], v[60:63], v[76:79]
    buffer_store_dwordx4 v[100:103], v9, s[20:23], s31 offen
    s_add_u32 s36, s36, s37
    s_waitcnt vmcnt(8)
    s_barrier
    s_waitcnt lgkmcnt(4)
    v_mfma_f32_16x16x32_bf16 v[64:67], a[64:67], v[32:35], v[64:67]
    ds_read_b128 v[56:59], v12 offset:22528
    v_mfma_f32_16x16x32_bf16 v[68:71], a[68:71], v[32:35], v[68:71]
    v_mfma_f32_16x16x32_bf16 v[72:75], a[64:67], v[36:39], v[72:75]
    ds_read_b128 v[60:63], v12 offset:22784
    s_add_u32 m0, s34, 98304
    s_add_u32 s32, s35, 32768
    v_mfma_f32_16x16x32_bf16 v[76:79], a[68:71], v[36:39], v[76:79]
    buffer_load_dwordx4 v8, s[12:15], s32 offen sc1 lds
    s_waitcnt lgkmcnt(4)
    v_mfma_f32_16x16x32_bf16 v[64:67], a[72:75], v[40:43], v[64:67]
    ds_read_b128 v[32:35], v12 offset:24576
    v_mfma_f32_16x16x32_bf16 v[68:71], a[76:79], v[40:43], v[68:71]
    v_mfma_f32_16x16x32_bf16 v[72:75], a[72:75], v[44:47], v[72:75]
    ds_read_b128 v[36:39], v12 offset:24832
    v_mfma_f32_16x16x32_bf16 v[76:79], a[76:79], v[44:47], v[76:79]
    s_waitcnt lgkmcnt(4)
    v_mfma_f32_16x16x32_bf16 v[64:67], a[80:83], v[48:51], v[64:67]
    ds_read_b128 v[40:43], v12 offset:26624
    v_mfma_f32_16x16x32_bf16 v[68:71], a[84:87], v[48:51], v[68:71]
    v_and_b32 v9, 0xffffff, v9
    v_mfma_f32_16x16x32_bf16 v[72:75], a[80:83], v[52:55], v[72:75]
    ds_read_b128 v[44:47], v12 offset:26880
    s_add_u32 m0, s34, 102400
    s_add_u32 s32, s35, 36864
    v_mfma_f32_16x16x32_bf16 v[76:79], a[84:87], v[52:55], v[76:79]
    buffer_load_dwordx4 v8, s[12:15], s32 offen sc1 lds
    s_waitcnt lgkmcnt(4)
    v_mfma_f32_16x16x32_bf16 v[64:67], a[88:91], v[56:59], v[64:67]
    ds_read_b128 v[48:51], v12 offset:28672
    v_mfma_f32_16x16x32_bf16 v[68:71], a[92:95], v[56:59], v[68:71]
    v_mfma_f32_16x16x32_bf16 v[72:75], a[88:91], v[60:63], v[72:75]
    ds_read_b128 v[52:55], v12 offset:28928
    v_mfma_f32_16x16x32_bf16 v[76:79], a[92:95], v[60:63], v[76:79]
    s_waitcnt lgkmcnt(4)
    v_mfma_f32_16x16x32_bf16 v[64:67], a[96:99], v[32:35], v[64:67]
    ds_read_b128 v[56:59], v12 offset:30720
    v_mfma_f32_16x16x32_bf16 v[68:71], a[100:103], v[32:35], v[68:71]
    v_mfma_f32_16x16x32_bf16 v[72:75], a[96:99], v[36:39], v[72:75]
    ds_read_b128 v[60:63], v12 offset:30976
    s_add_u32 m0, s34, 106496
    s_add_u32 s32, s35, 40960
    v_mfma_f32_16x16x32_bf16 v[76:79], a[100:103], v[36:39], v[76:79]
    buffer_load_dwordx4 v8, s[12:15], s32 offen sc1 lds
    s_waitcnt lgkmcnt(4)
    v_mfma_f32_16x16x32_bf16 v[64:67], a[104:107], v[40:43], v[64:67]
    ds_read_b128 v[32:35], v12 offset:32768
    v_mfma_f32_16x16x32_bf16 v[68:71], a[108:111], v[40:43], v[68:71]
    v_mfma_f32_16x16x32_bf16 v[72:75], a[104:107], v[44:47], v[72:75]
    ds_read_b128 v[36:39], v12 offset:33024
    v_mfma_f32_16x16x32_bf16 v[76:79], a[108:111], v[44:47], v[76:79]
    s_waitcnt lgkmcnt(4)
    v_mfma_f32_16x16x32_bf16 v[64:67], a[112:115], v[48:51], v[64:67]
    ds_read_b128 v[40:43], v12 offset:34816
    v_mfma_f32_16x16x32_bf16 v[68:71], a[116:119], v[48:51], v[68:71]
    v_mfma_f32_16x16x32_bf16 v[72:75], a[112:115], v[52:55], v[72:75]
    ds_read_b128 v[44:47], v12 offset:35072
    s_add_u32 m0, s34, 110592
    s_add_u32 s32, s35, 45056
    v_mfma_f32_16x16x32_bf16 v[76:79], a[116:119], v[52:55], v[76:79]
    buffer_load_dwordx4 v8, s[12:15], s32 offen sc1 lds
    s_waitcnt lgkmcnt(4)
    v_mfma_f32_16x16x32_bf16 v[64:67], a[120:123], v[56:59], v[64:67]
    ds_read_b128 v[48:51], v12 offset:36864
    v_mfma_f32_16x16x32_bf16 v[68:71], a[124:127], v[56:59], v[68:71]
    v_mfma_f32_16x16x32_bf16 v[72:75], a[120:123], v[60:63], v[72:75]
    ds_read_b128 v[52:55], v12 offset:37120
    v_mfma_f32_16x16x32_bf16 v[76:79], a[124:127], v[60:63], v[76:79]
    s_waitcnt lgkmcnt(4)
    v_mfma_f32_16x16x32_bf16 v[64:67], a[128:131], v[32:35], v[64:67]
    ds_read_b128 v[56:59], v12 offset:38912
    v_mfma_f32_16x16x32_bf16 v[68:71], a[132:135], v[32:35], v[68:71]
    v_mfma_f32_16x16x32_bf16 v[72:75], a[128:131], v[36:39], v[72:75]
    ds_read_b128 v[60:63], v12 offset:39168
    s_add_u32 m0, s34, 114688
    s_add_u32 s32, s35, 49152
    v_mfma_f32_16x16x32_bf16 v[76:79], a[132:135], v[36:39], v[76:79]
    buffer_load_dwordx4 v8, s[12:15], s32 offen sc1 lds
    s_waitcnt lgkmcnt(4)
    v_mfma_f32_16x16x32_bf16 v[64:67], a[136:139], v[40:43], v[64:67]
    ds_read_b128 v[32:35], v12 offset:40960
    v_mfma_f32_16x16x32_bf16 v[68:71], a[140:143], v[40:43], v[68:71]
    v_mfma_f32_16x16x32_bf16 v[72:75], a[136:139], v[44:47], v[72:75]
    ds_read_b128 v[36:39], v12 offset:41216
    v_mfma_f32_16x16x32_bf16 v[76:79], a[140:143], v[44:47], v[76:79]
    s_waitcnt lgkmcnt(4)
    v_mfma_f32_16x16x32_bf16 v[64:67], a[144:147], v[48:51], v[64:67]
    ds_read_b128 v[40:43], v12 offset:43008
    v_mfma_f32_16x16x32_bf16 v[68:71], a[148:151], v[48:51], v[68:71]
    v_mfma_f32_16x16x32_bf16 v[72:75], a[144:147], v[52:55], v[72:75]
    ds_read_b128 v[44:47], v12 offset:43264
    s_add_u32 m0, s34, 118784
    s_add_u32 s32, s35, 53248
    v_mfma_f32_16x16x32_bf16 v[76:79], a[148:151], v[52:55], v[76:79]
    buffer_load_dwordx4 v8, s[12:15], s32 offen sc1 lds
    s_waitcnt lgkmcnt(4)
    v_mfma_f32_16x16x32_bf16 v[64:67], a[152:155], v[56:59], v[64:67]
    ds_read_b128 v[48:51], v12 offset:45056
    v_mfma_f32_16x16x32_bf16 v[68:71], a[156:159], v[56:59], v[68:71]
    v_mfma_f32_16x16x32_bf16 v[72:75], a[152:155], v[60:63], v[72:75]
    ds_read_b128 v[52:55], v12 offset:45312
    v_mfma_f32_16x16x32_bf16 v[76:79], a[156:159], v[60:63], v[76:79]
    s_waitcnt lgkmcnt(4)
    v_mfma_f32_16x16x32_bf16 v[64:67], a[160:163], v[32:35], v[64:67]
    ds_read_b128 v[56:59], v12 offset:47104
    v_mfma_f32_16x16x32_bf16 v[68:71], a[164:167], v[32:35], v[68:71]
    v_mfma_f32_16x16x32_bf16 v[72:75], a[160:163], v[36:39], v[72:75]
    ds_read_b128 v[60:63], v12 offset:47360
    s_add_u32 m0, s34, 122880
    s_add_u32 s32, s35, 57344
    v_mfma_f32_16x16x32_bf16 v[76:79], a[164:167], v[36:39], v[76:79]
    buffer_load_dwordx4 v8, s[12:15], s32 offen sc1 lds
    s_waitcnt lgkmcnt(4)
    v_mfma_f32_16x16x32_bf16 v[64:67], a[168:171], v[40:43], v[64:67]
    ds_read_b128 v[32:35], v12 offset:49152
    v_mfma_f32_16x16x32_bf16 v[68:71], a[172:175], v[40:43], v[68:71]
    v_mfma_f32_16x16x32_bf16 v[72:75], a[168:171], v[44:47], v[72:75]
    ds_read_b128 v[36:39], v12 offset:49408
    v_mfma_f32_16x16x32_bf16 v[76:79], a[172:175], v[44:47], v[76:79]
    s_waitcnt lgkmcnt(4)
    v_mfma_f32_16x16x32_bf16 v[64:67], a[176:179], v[48:51], v[64:67]
    ds_read_b128 v[40:43], v12 offset:51200
    v_mfma_f32_16x16x32_bf16 v[68:71], a[180:183], v[48:51], v[68:71]
    v_mfma_f32_16x16x32_bf16 v[72:75], a[176:179], v[52:55], v[72:75]
    ds_read_b128 v[44:47], v12 offset:51456
    s_add_u32 m0, s34, 126976
    s_add_u32 s32, s35, 61440
    v_mfma_f32_16x16x32_bf16 v[76:79], a[180:183], v[52:55], v[76:79]
    buffer_load_dwordx4 v8, s[12:15], s32 offen sc1 lds
    s_add_u32 s35, s35, 65536
    s_min_u32 s35, s35, s52
    s_waitcnt lgkmcnt(4)
    v_mfma_f32_16x16x32_bf16 v[64:67], a[184:187], v[56:59], v[64:67]
    ds_read_b128 v[48:51], v12 offset:53248
    v_mfma_f32_16x16x32_bf16 v[68:71], a[188:191], v[56:59], v[68:71]
    v_mfma_f32_16x16x32_bf16 v[72:75], a[184:187], v[60:63], v[72:75]
    ds_read_b128 v[52:55], v12 offset:53504
    v_mfma_f32_16x16x32_bf16 v[76:79], a[188:191], v[60:63], v[76:79]
    s_waitcnt vmcnt(8)
    s_barrier
    s_waitcnt lgkmcnt(4)
    v_mfma_f32_16x16x32_bf16 v[64:67], a[192:195], v[32:35], v[64:67]
    ds_read_b128 v[56:59], v12 offset:55296
    v_mfma_f32_16x16x32_bf16 v[68:71], a[196:199], v[32:35], v[68:71]
    v_mfma_f32_16x16x32_bf16 v[72:75], a[192:195], v[36:39], v[72:75]
    ds_read_b128 v[60:63], v12 offset:55552
    s_add_u32 m0, s34, 0
    s_add_u32 s32, s35, 0
    v_mfma_f32_16x16x32_bf16 v[76:79], a[196:199], v[36:39], v[76:79]
    buffer_load_dwordx4 v8, s[12:15], s32 offen sc1 lds
    s_waitcnt lgkmcnt(4)
    v_mfma_f32_16x16x32_bf16 v[64:67], a[200:203], v[40:43], v[64:67]
    ds_read_b128 v[32:35], v12 offset:57344
    v_mfma_f32_16x16x32_bf16 v[68:71], a[204:207], v[40:43], v[68:71]
    v_mfma_f32_16x16x32_bf16 v[72:75], a[200:203], v[44:47], v[72:75]
    ds_read_b128 v[36:39], v12 offset:57600
    v_mfma_f32_16x16x32_bf16 v[76:79], a[204:207], v[44:47], v[76:79]
    s_waitcnt lgkmcnt(4)
    v_mfma_f32_16x16x32_bf16 v[64:67], a[208:211], v[48:51], v[64:67]
    ds_read_b128 v[40:43], v12 offset:59392
    v_mfma_f32_16x16x32_bf16 v[68:71], a[212:215], v[48:51], v[68:71]
    v_mfma_f32_16x16x32_bf16 v[72:75], a[208:211], v[52:55], v[72:75]
    ds_read_b128 v[44:47], v12 offset:59648
    s_add_u32 m0, s34, 4096
    s_add_u32 s32, s35, 4096
    v_mfma_f32_16x16x32_bf16 v[76:79], a[212:215], v[52:55], v[76:79]
    buffer_load_dwordx4 v8, s[12:15], s32 offen sc1 lds
    s_waitcnt lgkmcnt(4)
    v_mfma_f32_16x16x32_bf16 v[64:67], a[216:219], v[56:59], v[64:67]
    ds_read_b128 v[48:51], v12 offset:61440
    v_mfma_f32_16x16x32_bf16 v[68:71], a[220:223], v[56:59], v[68:71]
    v_mfma_f32_16x16x32_bf16 v[72:75], a[216:219], v[60:63], v[72:75]
    ds_read_b128 v[52:55], v12 offset:61696
    v_mfma_f32_16x16x32_bf16 v[76:79], a[220:223], v[60:63], v[76:79]
    s_waitcnt lgkmcnt(4)
    v_mfma_f32_16x16x32_bf16 v[64:67], a[224:227], v[32:35], v[64:67]
    ds_read_b128 v[56:59], v12 offset:63488
    v_mfma_f32_16x16x32_bf16 v[68:71], a[228:231], v[32:35], v[68:71]
    v_mfma_f32_16x16x32_bf16 v[72:75], a[224:227], v[36:39], v[72:75]
    ds_read_b128 v[60:63], v12 offset:63744
    s_add_u32 m0, s34, 8192
    s_add_u32 s32, s35, 8192
    v_mfma_f32_16x16x32_bf16 v[76:79], a[228:231], v[36:39], v[76:79]
    buffer_load_dwordx4 v8, s[12:15], s32 offen sc1 lds
    s_waitcnt lgkmcnt(4)
    v_mfma_f32_16x16x32_bf16 v[64:67], a[232:235], v[40:43], v[64:67]
    ds_read_b128 v[32:35], v14 offset:0
    v_mfma_f32_16x16x32_bf16 v[68:71], a[236:239], v[40:43], v[68:71]
    v_mfma_f32_16x16x32_bf16 v[72:75], a[232:235], v[44:47], v[72:75]
    ds_read_b128 v[36:39], v14 offset:256
    v_mfma_f32_16x16x32_bf16 v[76:79], a[236:239], v[44:47], v[76:79]
    s_waitcnt lgkmcnt(4)
    v_mfma_f32_16x16x32_bf16 v[64:67], a[240:243], v[48:51], v[64:67]
    ds_read_b128 v[40:43], v14 offset:2048
    v_mfma_f32_16x16x32_bf16 v[68:71], a[244:247], v[48:51], v[68:71]
    v_mfma_f32_16x16x32_bf16 v[72:75], a[240:243], v[52:55], v[72:75]
    ds_read_b128 v[44:47], v14 offset:2304
    s_add_u32 m0, s34, 12288
    s_add_u32 s32, s35, 12288
    v_mfma_f32_16x16x32_bf16 v[76:79], a[244:247], v[52:55], v[76:79]
    buffer_load_dwordx4 v8, s[12:15], s32 offen sc1 lds
    s_waitcnt lgkmcnt(4)
    v_mfma_f32_16x16x32_bf16 v[64:67], a[248:251], v[56:59], v[64:67]
    ds_read_b128 v[48:51], v14 offset:4096
    v_mfma_f32_16x16x32_bf16 v[68:71], a[252:255], v[56:59], v[68:71]
    v_mfma_f32_16x16x32_bf16 v[72:75], a[248:251], v[60:63], v[72:75]
    ds_read_b128 v[52:55], v14 offset:4352
    v_mfma_f32_16x16x32_bf16 v[76:79], a[252:255], v[60:63], v[76:79]
    s_waitcnt lgkmcnt(4)
    v_mfma_f32_16x16x32_bf16 v[80:83], a[0:3], v[32:35], 0
    ds_read_b128 v[56:59], v14 offset:6144
    v_mfma_f32_16x16x32_bf16 v[84:87], a[4:7], v[32:35], 0
    v_mfma_f32_16x16x32_bf16 v[88:91], a[0:3], v[36:39], 0
    ds_read_b128 v[60:63], v14 offset:6400
    s_add_u32 m0, s34, 16384
    s_add_u32 s32, s35, 16384
    v_mfma_f32_16x16x32_bf16 v[92:95], a[4:7], v[36:39], 0
    buffer_load_dwordx4 v8, s[12:15], s32 offen sc1 lds
    s_waitcnt lgkmcnt(4)
    v_mfma_f32_16x16x32_bf16 v[80:83], a[8:11], v[40:43], v[80:83]
    ds_read_b128 v[32:35], v14 offset:8192
    v_mfma_f32_16x16x32_bf16 v[84:87], a[12:15], v[40:43], v[84:87]
    v_mfma_f32_16x16x32_bf16 v[88:91], a[8:11], v[44:47], v[88:91]
    ds_read_b128 v[36:39], v14 offset:8448
    v_mfma_f32_16x16x32_bf16 v[92:95], a[12:15], v[44:47], v[92:95]
    s_waitcnt lgkmcnt(4)
    v_mfma_f32_16x16x32_bf16 v[80:83], a[16:19], v[48:51], v[80:83]
    ds_read_b128 v[40:43], v14 offset:10240
    v_mfma_f32_16x16x32_bf16 v[84:87], a[20:23], v[48:51], v[84:87]
    v_cvt_pk_bf16_f32 v96, v64, v65
    v_mfma_f32_16x16x32_bf16 v[88:91], a[16:19], v[52:55], v[88:91]
    ds_read_b128 v[44:47], v14 offset:10496
    s_add_u32 m0, s34, 20480
    s_add_u32 s32, s35, 20480
    v_mfma_f32_16x16x32_bf16 v[92:95], a[20:23], v[52:55], v[92:95]
    buffer_load_dwordx4 v8, s[12:15], s32 offen sc1 lds
    v_cvt_pk_bf16_f32 v97, v66, v67
    s_waitcnt lgkmcnt(4)
    v_mfma_f32_16x16x32_bf16 v[80:83], a[24:27], v[56:59], v[80:83]
    ds_read_b128 v[48:51], v14 offset:12288
    v_mfma_f32_16x16x32_bf16 v[84:87], a[28:31], v[56:59], v[84:87]
    v_cvt_pk_bf16_f32 v98, v68, v69
    v_mfma_f32_16x16x32_bf16 v[88:91], a[24:27], v[60:63], v[88:91]
    ds_read_b128 v[52:55], v14 offset:12544
    v_mfma_f32_16x16x32_bf16 v[92:95], a[28:31], v[60:63], v[92:95]
    v_cvt_pk_bf16_f32 v99, v70, v71
    s_waitcnt lgkmcnt(4)
    v_mfma_f32_16x16x32_bf16 v[80:83], a[32:35], v[32:35], v[80:83]
    ds_read_b128 v[56:59], v14 offset:14336
    v_mfma_f32_16x16x32_bf16 v[84:87], a[36:39], v[32:35], v[84:87]
    v_cvt_pk_bf16_f32 v100, v72, v73
    v_mfma_f32_16x16x32_bf16 v[88:91], a[32:35], v[36:39], v[88:91]
    ds_read_b128 v[60:63], v14 offset:14592
    s_add_u32 m0, s34, 24576
    s_add_u32 s32, s35, 24576
    v_mfma_f32_16x16x32_bf16 v[92:95], a[36:39], v[36:39], v[92:95]
    buffer_load_dwordx4 v8, s[12:15], s32 offen sc1 lds
    v_cvt_pk_bf16_f32 v101, v74, v75
    s_waitcnt lgkmcnt(4)
    v_mfma_f32_16x16x32_bf16 v[80:83], a[40:43], v[40:43], v[80:83]
    ds_read_b128 v[32:35], v14 offset:16384
    v_mfma_f32_16x16x32_bf16 v[84:87], a[44:47], v[40:43], v[84:87]
    v_cvt_pk_bf16_f32 v102, v76, v77
    v_mfma_f32_16x16x32_bf16 v[88:91], a[40:43], v[44:47], v[88:91]
    ds_read_b128 v[36:39], v14 offset:16640
    v_mfma_f32_16x16x32_bf16 v[92:95], a[44:47], v[44:47], v[92:95]
    v_cvt_pk_bf16_f32 v103, v78, v79
    buffer_store_dwordx4 v[96:99], v9, s[20:23], s36 offen
    s_add_u32 s31, s36, 65536
    s_waitcnt lgkmcnt(4)
    v_mfma_f32_16x16x32_bf16 v[80:83], a[48:51], v[48:51], v[80:83]
    ds_read_b128 v[40:43], v14 offset:18432
    v_mfma_f32_16x16x32_bf16 v[84:87], a[52:55], v[48:51], v[84:87]
    v_mfma_f32_16x16x32_bf16 v[88:91], a[48:51], v[52:55], v[88:91]
    ds_read_b128 v[44:47], v14 offset:18688
    s_add_u32 m0, s34, 28672
    s_add_u32 s32, s35, 28672
    v_mfma_f32_16x16x32_bf16 v[92:95], a[52:55], v[52:55], v[92:95]
    buffer_load_dwordx4 v8, s[12:15], s32 offen sc1 lds
    s_waitcnt lgkmcnt(4)
    v_mfma_f32_16x16x32_bf16 v[80:83], a[56:59], v[56:59], v[80:83]
    ds_read_b128 v[48:51], v14 offset:20480
    v_mfma_f32_16x16x32_bf16 v[84:87], a[60:63], v[56:59], v[84:87]
    v_mfma_f32_16x16x32_bf16 v[88:91], a[56:59], v[60:63], v[88:91]
    ds_read_b128 v[52:55], v14 offset:20736
    v_mfma_f32_16x16x32_bf16 v[92:95], a[60:63], v[60:63], v[92:95]
    buffer_store_dwordx4 v[100:103], v9, s[20:23], s31 offen
    s_add_u32 s36, s36, s37
    s_waitcnt vmcnt(8)
    s_barrier
    s_waitcnt lgkmcnt(4)
    v_mfma_f32_16x16x32_bf16 v[80:83], a[64:67], v[32:35], v[80:83]
    ds_read_b128 v[56:59], v14 offset:22528
    v_mfma_f32_16x16x32_bf16 v[84:87], a[68:71], v[32:35], v[84:87]
    v_mfma_f32_16x16x32_bf16 v[88:91], a[64:67], v[36:39], v[88:91]
    ds_read_b128 v[60:63], v14 offset:22784
    s_add_u32 m0, s34, 32768
    s_add_u32 s32, s35, 32768
    v_mfma_f32_16x16x32_bf16 v[92:95], a[68:71], v[36:39], v[92:95]
    buffer_load_dwordx4 v8, s[12:15], s32 offen sc1 lds
    s_waitcnt lgkmcnt(4)
    v_mfma_f32_16x16x32_bf16 v[80:83], a[72:75], v[40:43], v[80:83]
    ds_read_b128 v[32:35], v14 offset:24576
    v_mfma_f32_16x16x32_bf16 v[84:87], a[76:79], v[40:43], v[84:87]
    v_mfma_f32_16x16x32_bf16 v[88:91], a[72:75], v[44:47], v[88:91]
    ds_read_b128 v[36:39], v14 offset:24832
    v_mfma_f32_16x16x32_bf16 v[92:95], a[76:79], v[44:47], v[92:95]
    s_waitcnt lgkmcnt(4)
    v_mfma_f32_16x16x32_bf16 v[80:83], a[80:83], v[48:51], v[80:83]
    ds_read_b128 v[40:43], v14 offset:26624
    v_mfma_f32_16x16x32_bf16 v[84:87], a[84:87], v[48:51], v[84:87]
    v_mfma_f32_16x16x32_bf16 v[88:91], a[80:83], v[52:55], v[88:91]
    ds_read_b128 v[44:47], v14 offset:26880
    s_add_u32 m0, s34, 36864
    s_add_u32 s32, s35, 36864
    v_mfma_f32_16x16x32_bf16 v[92:95], a[84:87], v[52:55], v[92:95]
    buffer_load_dwordx4 v8, s[12:15], s32 offen sc1 lds
    s_waitcnt lgkmcnt(4)
    v_mfma_f32_16x16x32_bf16 v[80:83], a[88:91], v[56:59], v[80:83]
    ds_read_b128 v[48:51], v14 offset:28672
    v_mfma_f32_16x16x32_bf16 v[84:87], a[92:95], v[56:59], v[84:87]
    v_mfma_f32_16x16x32_bf16 v[88:91], a[88:91], v[60:63], v[88:91]
    ds_read_b128 v[52:55], v14 offset:28928
    v_mfma_f32_16x16x32_bf16 v[92:95], a[92:95], v[60:63], v[92:95]
    s_waitcnt lgkmcnt(4)
    v_mfma_f32_16x16x32_bf16 v[80:83], a[96:99], v[32:35], v[80:83]
    ds_read_b128 v[56:59], v14 offset:30720
    v_mfma_f32_16x16x32_bf16 v[84:87], a[100:103], v[32:35], v[84:87]
    v_mfma_f32_16x16x32_bf16 v[88:91], a[96:99], v[36:39], v[88:91]
    ds_read_b128 v[60:63], v14 offset:30976
    s_add_u32 m0, s34, 40960
    s_add_u32 s32, s35, 40960
    v_mfma_f32_16x16x32_bf16 v[92:95], a[100:103], v[36:39], v[92:95]
    buffer_load_dwordx4 v8, s[12:15], s32 offen sc1 lds
    s_waitcnt lgkmcnt(4)
    v_mfma_f32_16x16x32_bf16 v[80:83], a[104:107], v[40:43], v[80:83]
    ds_read_b128 v[32:35], v14 offset:32768
    v_mfma_f32_16x16x32_bf16 v[84:87], a[108:111], v[40:43], v[84:87]
    v_mfma_f32_16x16x32_bf16 v[88:91], a[104:107], v[44:47], v[88:91]
    ds_read_b128 v[36:39], v14 offset:33024
    v_mfma_f32_16x16x32_bf16 v[92:95], a[108:111], v[44:47], v[92:95]
    s_waitcnt lgkmcnt(4)
    v_mfma_f32_16x16x32_bf16 v[80:83], a[112:115], v[48:51], v[80:83]
    ds_read_b128 v[40:43], v14 offset:34816
    v_mfma_f32_16x16x32_bf16 v[84:87], a[116:119], v[48:51], v[84:87]
    v_mfma_f32_16x16x32_bf16 v[88:91], a[112:115], v[52:55], v[88:91]
    ds_read_b128 v[44:47], v14 offset:35072
    s_add_u32 m0, s34, 45056
    s_add_u32 s32, s35, 45056
    v_mfma_f32_16x16x32_bf16 v[92:95], a[116:119], v[52:55], v[92:95]
    buffer_load_dwordx4 v8, s[12:15], s32 offen sc1 lds
    s_waitcnt lgkmcnt(4)
    v_mfma_f32_16x16x32_bf16 v[80:83], a[120:123], v[56:59], v[80:83]
    ds_read_b128 v[48:51], v14 offset:36864
    v_mfma_f32_16x16x32_bf16 v[84:87], a[124:127], v[56:59], v[84:87]
    v_mfma_f32_16x16x32_bf16 v[88:91], a[120:123], v[60:63], v[88:91]
    ds_read_b128 v[52:55], v14 offset:37120
    v_mfma_f32_16x16x32_bf16 v[92:95], a[124:127], v[60:63], v[92:95]
    s_waitcnt lgkmcnt(4)
    v_mfma_f32_16x16x32_bf16 v[80:83], a[128:131], v[32:35], v[80:83]
    ds_read_b128 v[56:59], v14 offset:38912
    v_mfma_f32_16x16x32_bf16 v[84:87], a[132:135], v[32:35], v[84:87]
    v_mfma_f32_16x16x32_bf16 v[88:91], a[128:131], v[36:39], v[88:91]
    ds_read_b128 v[60:63], v14 offset:39168
    s_add_u32 m0, s34, 49152
    s_add_u32 s32, s35, 49152
    v_mfma_f32_16x16x32_bf16 v[92:95], a[132:135], v[36:39], v[92:95]
    buffer_load_dwordx4 v8, s[12:15], s32 offen sc1 lds
    s_waitcnt lgkmcnt(4)
    v_mfma_f32_16x16x32_bf16 v[80:83], a[136:139], v[40:43], v[80:83]
    ds_read_b128 v[32:35], v14 offset:40960
    v_mfma_f32_16x16x32_bf16 v[84:87], a[140:143], v[40:43], v[84:87]
    v_mfma_f32_16x16x32_bf16 v[88:91], a[136:139], v[44:47], v[88:91]
    ds_read_b128 v[36:39], v14 offset:41216
    v_mfma_f32_16x16x32_bf16 v[92:95], a[140:143], v[44:47], v[92:95]
    s_waitcnt lgkmcnt(4)
    v_mfma_f32_16x16x32_bf16 v[80:83], a[144:147], v[48:51], v[80:83]
    ds_read_b128 v[40:43], v14 offset:43008
    v_mfma_f32_16x16x32_bf16 v[84:87], a[148:151], v[48:51], v[84:87]
    v_mfma_f32_16x16x32_bf16 v[88:91], a[144:147], v[52:55], v[88:91]
    ds_read_b128 v[44:47], v14 offset:43264
    s_add_u32 m0, s34, 53248
    s_add_u32 s32, s35, 53248
    v_mfma_f32_16x16x32_bf16 v[92:95], a[148:151], v[52:55], v[92:95]
    buffer_load_dwordx4 v8, s[12:15], s32 offen sc1 lds
    s_waitcnt lgkmcnt(4)
    v_mfma_f32_16x16x32_bf16 v[80:83], a[152:155], v[56:59], v[80:83]
    ds_read_b128 v[48:51], v14 offset:45056
    v_mfma_f32_16x16x32_bf16 v[84:87], a[156:159], v[56:59], v[84:87]
    v_mfma_f32_16x16x32_bf16 v[88:91], a[152:155], v[60:63], v[88:91]
    ds_read_b128 v[52:55], v14 offset:45312
    v_mfma_f32_16x16x32_bf16 v[92:95], a[156:159], v[60:63], v[92:95]
    s_waitcnt lgkmcnt(4)
    v_mfma_f32_16x16x32_bf16 v[80:83], a[160:163], v[32:35], v[80:83]
    ds_read_b128 v[56:59], v14 offset:47104
    v_mfma_f32_16x16x32_bf16 v[84:87], a[164:167], v[32:35], v[84:87]
    v_mfma_f32_16x16x32_bf16 v[88:91], a[160:163], v[36:39], v[88:91]
    ds_read_b128 v[60:63], v14 offset:47360
    s_add_u32 m0, s34, 57344
    s_add_u32 s32, s35, 57344
    v_mfma_f32_16x16x32_bf16 v[92:95], a[164:167], v[36:39], v[92:95]
    buffer_load_dwordx4 v8, s[12:15], s32 offen sc1 lds
    s_waitcnt lgkmcnt(4)
    v_mfma_f32_16x16x32_bf16 v[80:83], a[168:171], v[40:43], v[80:83]
    ds_read_b128 v[32:35], v14 offset:49152
    v_mfma_f32_16x16x32_bf16 v[84:87], a[172:175], v[40:43], v[84:87]
    v_mfma_f32_16x16x32_bf16 v[88:91], a[168:171], v[44:47], v[88:91]
    ds_read_b128 v[36:39], v14 offset:49408
    v_mfma_f32_16x16x32_bf16 v[92:95], a[172:175], v[44:47], v[92:95]
    s_waitcnt lgkmcnt(4)
    v_mfma_f32_16x16x32_bf16 v[80:83], a[176:179], v[48:51], v[80:83]
    ds_read_b128 v[40:43], v14 offset:51200
    v_mfma_f32_16x16x32_bf16 v[84:87], a[180:183], v[48:51], v[84:87]
    v_mfma_f32_16x16x32_bf16 v[88:91], a[176:179], v[52:55], v[88:91]
    ds_read_b128 v[44:47], v14 offset:51456
    s_add_u32 m0, s34, 61440
    s_add_u32 s32, s35, 61440
    v_mfma_f32_16x16x32_bf16 v[92:95], a[180:183], v[52:55], v[92:95]
    buffer_load_dwordx4 v8, s[12:15], s32 offen sc1 lds
    s_add_u32 s35, s35, 65536
    s_min_u32 s35, s35, s52
    s_waitcnt lgkmcnt(4)
    v_mfma_f32_16x16x32_bf16 v[80:83], a[184:187], v[56:59], v[80:83]
    ds_read_b128 v[48:51], v14 offset:53248
    v_mfma_f32_16x16x32_bf16 v[84:87], a[188:191], v[56:59], v[84:87]
    v_mfma_f32_16x16x32_bf16 v[88:91], a[184:187], v[60:63], v[88:91]
    ds_read_b128 v[52:55], v14 offset:53504
    v_mfma_f32_16x16x32_bf16 v[92:95], a[188:191], v[60:63], v[92:95]
    s_waitcnt vmcnt(8)
    s_barrier
    s_waitcnt lgkmcnt(4)
    v_mfma_f32_16x16x32_bf16 v[80:83], a[192:195], v[32:35], v[80:83]
    ds_read_b128 v[56:59], v14 offset:55296
    v_mfma_f32_16x16x32_bf16 v[84:87], a[196:199], v[32:35], v[84:87]
    v_mfma_f32_16x16x32_bf16 v[88:91], a[192:195], v[36:39], v[88:91]
    ds_read_b128 v[60:63], v14 offset:55552
    s_add_u32 m0, s34, 65536
    s_add_u32 s32, s35, 0
    v_mfma_f32_16x16x32_bf16 v[92:95], a[196:199], v[36:39], v[92:95]
    buffer_load_dwordx4 v8, s[12:15], s32 offen sc1 lds
    s_waitcnt lgkmcnt(4)
    v_mfma_f32_16x16x32_bf16 v[80:83], a[200:203], v[40:43], v[80:83]
    ds_read_b128 v[32:35], v14 offset:57344
    v_mfma_f32_16x16x32_bf16 v[84:87], a[204:207], v[40:43], v[84:87]
    v_mfma_f32_16x16x32_bf16 v[88:91], a[200:203], v[44:47], v[88:91]
    ds_read_b128 v[36:39], v14 offset:57600
    v_mfma_f32_16x16x32_bf16 v[92:95], a[204:207], v[44:47], v[92:95]
    s_waitcnt lgkmcnt(4)
    v_mfma_f32_16x16x32_bf16 v[80:83], a[208:211], v[48:51], v[80:83]
    ds_read_b128 v[40:43], v14 offset:59392
    v_mfma_f32_16x16x32_bf16 v[84:87], a[212:215], v[48:51], v[84:87]
    v_mfma_f32_16x16x32_bf16 v[88:91], a[208:211], v[52:55], v[88:91]
    ds_read_b128 v[44:47], v14 offset:59648
    s_add_u32 m0, s34, 69632
    s_add_u32 s32, s35, 4096
    v_mfma_f32_16x16x32_bf16 v[92:95], a[212:215], v[52:55], v[92:95]
    buffer_load_dwordx4 v8, s[12:15], s32 offen sc1 lds
    s_waitcnt lgkmcnt(4)
    v_mfma_f32_16x16x32_bf16 v[80:83], a[216:219], v[56:59], v[80:83]
    ds_read_b128 v[48:51], v14 offset:61440
    v_mfma_f32_16x16x32_bf16 v[84:87], a[220:223], v[56:59], v[84:87]
    v_mfma_f32_16x16x32_bf16 v[88:91], a[216:219], v[60:63], v[88:91]
    ds_read_b128 v[52:55], v14 offset:61696
    v_mfma_f32_16x16x32_bf16 v[92:95], a[220:223], v[60:63], v[92:95]
    s_waitcnt lgkmcnt(4)
    v_mfma_f32_16x16x32_bf16 v[80:83], a[224:227], v[32:35], v[80:83]
    ds_read_b128 v[56:59], v14 offset:63488
    v_mfma_f32_16x16x32_bf16 v[84:87], a[228:231], v[32:35], v[84:87]
    v_mfma_f32_16x16x32_bf16 v[88:91], a[224:227], v[36:39], v[88:91]
    ds_read_b128 v[60:63], v14 offset:63744
    s_add_u32 m0, s34, 73728
    s_add_u32 s32, s35, 8192
    v_mfma_f32_16x16x32_bf16 v[92:95], a[228:231], v[36:39], v[92:95]
    buffer_load_dwordx4 v8, s[12:15], s32 offen sc1 lds
    s_waitcnt lgkmcnt(4)
    v_mfma_f32_16x16x32_bf16 v[80:83], a[232:235], v[40:43], v[80:83]
    ds_read_b128 v[32:35], v12 offset:0
    v_mfma_f32_16x16x32_bf16 v[84:87], a[236:239], v[40:43], v[84:87]
    v_mfma_f32_16x16x32_bf16 v[88:91], a[232:235], v[44:47], v[88:91]
    ds_read_b128 v[36:39], v12 offset:256
    v_mfma_f32_16x16x32_bf16 v[92:95], a[236:239], v[44:47], v[92:95]
    s_waitcnt lgkmcnt(4)
    v_mfma_f32_16x16x32_bf16 v[80:83], a[240:243], v[48:51], v[80:83]
    ds_read_b128 v[40:43], v12 offset:2048
    v_mfma_f32_16x16x32_bf16 v[84:87], a[244:247], v[48:51], v[84:87]
    v_mfma_f32_16x16x32_bf16 v[88:91], a[240:243], v[52:55], v[88:91]
    ds_read_b128 v[44:47], v12 offset:2304
    s_add_u32 m0, s34, 77824
    s_add_u32 s32, s35, 12288
    v_mfma_f32_16x16x32_bf16 v[92:95], a[244:247], v[52:55], v[92:95]
    buffer_load_dwordx4 v8, s[12:15], s32 offen sc1 lds
    s_waitcnt lgkmcnt(4)
    v_mfma_f32_16x16x32_bf16 v[80:83], a[248:251], v[56:59], v[80:83]
    ds_read_b128 v[48:51], v12 offset:4096
    v_mfma_f32_16x16x32_bf16 v[84:87], a[252:255], v[56:59], v[84:87]
    v_mfma_f32_16x16x32_bf16 v[88:91], a[248:251], v[60:63], v[88:91]
    ds_read_b128 v[52:55], v12 offset:4352
    v_mfma_f32_16x16x32_bf16 v[92:95], a[252:255], v[60:63], v[92:95]
    s_add_u32 s30, s30, 2
    s_cmp_lt_u32 s30, s51
    s_cbranch_scc1 sl_loop_85
    v_cvt_pk_bf16_f32 v96, v80, v81
    v_cvt_pk_bf16_f32 v97, v82, v83
    v_cvt_pk_bf16_f32 v98, v84, v85
    v_cvt_pk_bf16_f32 v99, v86, v87
    v_cvt_pk_bf16_f32 v100, v88, v89
    v_cvt_pk_bf16_f32 v101, v90, v91
    v_cvt_pk_bf16_f32 v102, v92, v93
    v_cvt_pk_bf16_f32 v103, v94, v95
    s_branch sl_e_84
sl_e_84:
    buffer_store_dwordx4 v[96:99], v9, s[20:23], s36 offen
    s_add_u32 s31, s36, 65536
    buffer_store_dwordx4 v[100:103], v9, s[20:23], s31 offen
    s_add_u32 s36, s36, s37
    s_waitcnt vmcnt(0) lgkmcnt(0)
    s_barrier
    s_branch L_dump
L_dump:
L_end:
    s_endpgm
.section .rodata,"a"
.p2align 6
.amdhsa_kernel concat_heads__memory_aug_recurrent_mem_tr__sliding_local_dilated__prompt_kernel
  .amdhsa_next_free_vgpr 512
  .amdhsa_next_free_sgpr 102
  .amdhsa_accum_offset 256
  .amdhsa_group_segment_fixed_size 0
  .amdhsa_kernarg_size 104
  .amdhsa_user_sgpr_count 2
  .amdhsa_user_sgpr_kernarg_segment_ptr 1
  .amdhsa_system_sgpr_workgroup_id_x 1
.end_amdhsa_kernel
```

```asm
; @launch grid=(256,1,1) block=(256,1,1) lds=163840
.amdgcn_target "amdgcn-amd-amdhsa--gfx950"
.text
.globl concat_heads__memory_aug_recurrent_mem_tr__sliding_local_dilated__prompt_kernel
.p2align 8
.type concat_heads__memory_aug_recurrent_mem_tr__sliding_local_dilated__prompt_kernel,@function
concat_heads__memory_aug_recurrent_mem_tr__sliding_local_dilated__prompt_kernel:
    s_cmp_ge_u32 s2, 256
    s_cbranch_scc1 L_end
    s_mov_b32 s7, s2
    s_and_b32 s3, s7, 3
    s_lshl_b32 s3, s3, 5
    s_lshr_b32 s28, s2, 3
    s_add_u32 s28, s28, s3
    s_bitcmp1_b32 s7, 2
    s_cbranch_scc1 L_gem
L_rec:
    s_mov_b32 s6, L_gem - L_rec - 16
    s_getpc_b64 s[4:5]
    v_lshlrev_b32 v1, 7, v0
    v_min_u32 v2, s6, v1
    global_load_dword v250, v2, s[4:5]
    v_add_u32 v1, 32768, v1
    s_load_dwordx2 s[72:73], s[0:1], 8
    s_load_dwordx4 s[76:79], s[0:1], 16
    s_load_dwordx4 s[80:83], s[0:1], 32
    s_load_dwordx2 s[90:91], s[0:1], 96
    s_load_dwordx2 s[92:93], s[0:1], 88
    v_and_b32 v1, 63, v0
    v_lshrrev_b32 v2, 6, v0
    s_nop 0
    v_readfirstlane_b32 s31, v2
    s_lshr_b32 s29, s28, 2
    s_and_b32 s30, s28, 3
    s_mov_b32 s41, 0
    s_waitcnt lgkmcnt(0)
    s_mov_b32 s24, s72
    s_and_b32 s25, s73, 0xffff
    s_mov_b32 s26, 16384
    s_mov_b32 s27, 0x00020000
    s_mov_b32 s8, s76
    s_and_b32 s9, s77, 0xffff
    s_mov_b32 s10, 8388608
    s_mov_b32 s11, 0x00020000
    s_mov_b32 s12, s78
    s_and_b32 s13, s79, 0xffff
    s_mov_b32 s14, 8388608
    s_mov_b32 s15, 0x00020000
    s_mov_b32 s16, s80
    s_and_b32 s17, s81, 0xffff
    s_mov_b32 s18, 8388608
    s_mov_b32 s19, 0x00020000
    s_mov_b32 s20, s82
    s_and_b32 s21, s83, 0xffff
    s_mov_b32 s22, 8388608
    s_mov_b32 s23, 0x00020000
    s_mov_b32 s4, s90
    s_and_b32 s5, s91, 0xffff
    s_mov_b32 s6, 268435456
    s_mov_b32 s7, 0x00020000
    s_sub_u32 s49, 0, s90
    s_and_b32 s49, s49, 2097151
    s_add_u32 s49, s49, 117440512
    s_mov_b32 s48, 1
    s_cmp_lg_u32 s31, 3
    s_cbranch_scc1 rec_cal_1
    s_and_b32 s38, s28, 7
    s_lshl_b32 s38, s38, 21
    s_lshr_b32 s40, s28, 3
    s_and_b32 s40, s40, 1
    s_lshl_b32 s40, s40, 13
    s_add_u32 s38, s38, s40
    s_lshr_b32 s40, s28, 4
    s_and_b32 s40, s40, 7
    s_lshl_b32 s40, s40, 8
    s_add_u32 s38, s38, s40
    s_add_u32 s38, s38, s49
    s_add_u32 s38, s38, 245760
    s_lshr_b32 s39, s28, 3
    s_and_b32 s39, s39, 1
    s_lshl_b32 s39, s39, 14
    s_sub_u32 s39, s38, s39
    s_add_u32 s39, s39, 8192
    s_load_dword s80, s[90:91], s38 glc
    s_load_dword s81, s[90:91], s39 glc
    s_waitcnt lgkmcnt(0)
    s_memtime s[76:77]
    s_waitcnt lgkmcnt(0)
    s_load_dword s80, s[90:91], s38 glc
    s_waitcnt lgkmcnt(0)
    s_memtime s[78:79]
    s_waitcnt lgkmcnt(0)
    s_sub_u32 s72, s78, s76
    s_waitcnt lgkmcnt(0)
    s_memtime s[76:77]
    s_waitcnt lgkmcnt(0)
    s_load_dword s80, s[90:91], s39 glc
    s_waitcnt lgkmcnt(0)
    s_memtime s[78:79]
    s_waitcnt lgkmcnt(0)
    s_sub_u32 s73, s78, s76
    s_cmp_lt_u32 s73, s72
    s_cselect_b32 s38, 1, 0
    s_lshr_b32 s39, s28, 3
    s_xor_b32 s38, s38, s39
    s_xor_b32 s38, s38, s28
    s_and_b32 s48, s38, 1
    s_lshl_b32 s48, s48, 16
    s_add_u32 s48, s48, 1
rec_cal_1:
    s_lshl_b32 s38, s31, 21
    s_lshl_b32 s40, s28, 6
    s_add_u32 s38, s38, s40
    v_lshrrev_b32 v184, 2, v1
    v_lshlrev_b32 v184, 13, v184
    v_and_b32 v4, 3, v1
    v_lshl_add_u32 v184, v4, 4, v184
    v_add_u32 v184, s38, v184
    s_lshl_b32 s38, s31, 21
    s_lshr_b32 s40, s28, 1
    s_lshl_b32 s40, s40, 5
    s_add_u32 s38, s38, s40
    v_lshrrev_b32 v185, 1, v1
    v_lshlrev_b32 v185, 11, v185
    v_and_b32 v4, 1, v1
    v_lshl_add_u32 v185, v4, 4, v185
    v_add_u32 v185, s38, v185
    s_lshl_b32 s33, s31, 15
    v_lshrrev_b32 v186, 4, v1
    v_lshlrev_b32 v186, 9, v186
    v_bfe_u32 v4, v1, 2, 2
    v_lshl_add_u32 v186, v4, 6, v186
    v_and_b32 v4, 3, v1
    v_lshl_add_u32 v186, v4, 3, v186
    v_add_u32 v186, s33, v186
    v_lshrrev_b32 v187, 4, v1
    v_lshlrev_b32 v187, 8, v187
    v_bfe_u32 v4, v1, 2, 2
    v_lshl_add_u32 v187, v4, 5, v187
    v_and_b32 v4, 3, v1
    v_lshl_add_u32 v187, v4, 3, v187
    v_add_u32 v187, s33, v187
    s_add_u32 m0, s33, 0
    s_mov_b32 s38, 0
    buffer_load_dwordx4 v184, s[8:11], s38 offen lds
    s_add_u32 m0, s33, 1024
    s_mov_b32 s38, 131072
    buffer_load_dwordx4 v184, s[8:11], s38 offen lds
    s_add_u32 m0, s33, 2048
    s_mov_b32 s38, 0
    buffer_load_dwordx4 v184, s[12:15], s38 offen lds
    s_add_u32 m0, s33, 3072
    s_mov_b32 s38, 131072
    buffer_load_dwordx4 v184, s[12:15], s38 offen lds
    s_add_u32 m0, s33, 4096
    s_mov_b32 s38, 0
    buffer_load_dwordx4 v184, s[16:19], s38 offen lds
    s_add_u32 m0, s33, 5120
    s_mov_b32 s38, 131072
    buffer_load_dwordx4 v184, s[16:19], s38 offen lds
    s_add_u32 m0, s33, 6144
    s_mov_b32 s38, 262144
    buffer_load_dwordx4 v184, s[8:11], s38 offen lds
    s_add_u32 m0, s33, 7168
    s_mov_b32 s38, 393216
    buffer_load_dwordx4 v184, s[8:11], s38 offen lds
    s_add_u32 m0, s33, 8192
    s_mov_b32 s38, 262144
    buffer_load_dwordx4 v184, s[12:15], s38 offen lds
    s_add_u32 m0, s33, 9216
    s_mov_b32 s38, 393216
    buffer_load_dwordx4 v184, s[12:15], s38 offen lds
    s_add_u32 m0, s33, 10240
    s_mov_b32 s38, 262144
    buffer_load_dwordx4 v184, s[16:19], s38 offen lds
    s_add_u32 m0, s33, 11264
    s_mov_b32 s38, 393216
    buffer_load_dwordx4 v184, s[16:19], s38 offen lds
    v_bfe_u32 v2, v1, 1, 1
    v_mov_b32 v3, 0xaaaa
    v_mul_u32_u24 v2, v2, v3
    v_add_u32 v5, 0x4444, v2
    v_lshlrev_b32 v16, 4, v1
    s_lshr_b32 s38, s28, 6
    s_lshl_b32 s38, s38, 14
    s_and_b32 s40, s28, 63
    s_lshl_b32 s40, s40, 7
    s_add_u32 s38, s38, s40
    s_add_u32 s38, s38, 131072
    v_lshl_add_u32 v6, v1, 2, s38
    s_lshr_b32 s38, s31, 1
    s_lshl_b32 s38, s38, 14
    s_and_b32 s40, s31, 1
    s_lshl_b32 s40, s40, 12
    s_add_u32 s38, s38, s40
    s_add_u32 s38, s38, 131072
    v_add_u32 v7, s38, v16
    s_and_b32 s38, s28, 1
    s_lshl_b32 s38, s38, 16
    s_lshl_b32 s40, s31, 14
    s_add_u32 s38, s38, s40
    v_add_u32 v12, s38, v16
    v_add_u32 v13, 4096, v12
    v_lshrrev_b32 v2, 4, v1
    v_mul_u32_u24 v2, 320, v2
    v_and_b32 v3, 15, v1
    v_lshl_add_u32 v2, v3, 2, v2
    s_mul_i32 s38, s31, 2560
    v_add_u32 v14, s38, v2
    v_add_u32 v15, 1280, v14
    s_lshl_b32 s38, s31, 10
    s_add_u32 s38, s38, 10240
    v_add_u32 v17, s38, v16
    v_and_b32 v2, 3, v1
    v_lshlrev_b32 v2, 1, v2
    v_bfe_u32 v4, v1, 2, 1
    v_lshl_add_u32 v2, v4, 0, v2
    v_add_u32 v2, 8, v2
    v_and_b32 v3, 15, v1
    v_cmp_gt_u32 vcc, 8, v3
    s_nop 1
    v_cndmask_b32 v3, v2, v3, vcc
    v_mul_u32_u24 v3, 160, v3
    v_lshrrev_b32 v2, 5, v1
    v_lshlrev_b32 v2, 6, v2
    v_bfe_u32 v4, v1, 4, 1
    v_lshl_add_u32 v2, v4, 4, v2
    v_add_u32 v18, v2, v3
    s_lshl_b32 s38, s28, 11
    v_add_u32 v19, s38, v16
    v_bfe_u32 v20, v1, 4, 1
    v_lshlrev_b32 v20, 7, v20
    v_and_b32 v4, 7, v1
    v_lshl_add_u32 v20, v4, 4, v20
    v_add_u32 v20, s38, v20
    s_add_u32 s39, s30, 1
    s_and_b32 s38, s39, 3
    s_lshl_b32 s38, s38, 11
    s_lshl_b32 s40, s29, 13
    s_add_u32 s38, s38, s40
    v_add_u32 v22, s38, v16
    s_add_u32 s39, s30, 2
    s_and_b32 s38, s39, 3
    s_lshl_b32 s38, s38, 11
    s_lshl_b32 s40, s29, 13
    s_add_u32 s38, s38, s40
    v_add_u32 v23, s38, v16
    s_add_u32 s39, s30, 3
    s_and_b32 s38, s39, 3
    s_lshl_b32 s38, s38, 11
    s_lshl_b32 s40, s29, 13
    s_add_u32 s38, s38, s40
    v_add_u32 v24, s38, v16
    s_lshl_b32 s38, s29, 13
    v_lshrrev_b32 v21, 4, v1
    v_lshlrev_b32 v21, 11, v21
    v_and_b32 v4, 15, v1
    v_lshl_add_u32 v21, v4, 4, v21
    v_add_u32 v21, s38, v21
    v_lshrrev_b32 v25, 4, v1
    v_lshlrev_b32 v25, 8, v25
    v_bfe_u32 v4, v1, 3, 1
    v_lshl_add_u32 v25, v4, 3, v25
    v_bfe_u32 v4, v1, 1, 1
    v_lshl_add_u32 v25, v4, 6, v25
    v_bfe_u32 v4, v1, 2, 1
    v_lshl_add_u32 v25, v4, 5, v25
    v_and_b32 v4, 1, v1
    v_lshl_add_u32 v25, v4, 4, v25
    v_add_u32 v25, 10240, v25
    s_lshl_b32 s38, s28, 11
    s_and_b32 s40, s31, 1
    s_lshl_b32 s40, s40, 7
    s_add_u32 s38, s38, s40
    s_add_u32 s38, s38, 16777216
    v_bfe_u32 v2, v1, 3, 1
    v_lshlrev_b32 v2, 8, v2
    v_and_b32 v4, 7, v1
    v_lshl_add_u32 v2, v4, 4, v2
    v_bfe_u32 v4, v1, 4, 1
    v_lshl_add_u32 v2, v4, 9, v2
    v_lshrrev_b32 v4, 5, v1
    v_lshl_add_u32 v2, v4, 10, v2
    v_add_u32 v2, s38, v2
    s_add_u32 s38, s38, 16777216
    v_bfe_u32 v3, v1, 3, 1
    v_lshlrev_b32 v3, 8, v3
    v_bfe_u32 v4, v1, 1, 1
    v_lshl_add_u32 v3, v4, 6, v3
    v_bfe_u32 v4, v1, 2, 1
    v_lshl_add_u32 v3, v4, 5, v3
    v_and_b32 v4, 1, v1
    v_lshl_add_u32 v3, v4, 4, v3
    v_bfe_u32 v4, v1, 4, 1
    v_lshl_add_u32 v3, v4, 9, v3
    v_lshrrev_b32 v4, 5, v1
    v_lshl_add_u32 v3, v4, 10, v3
    v_add_u32 v3, s38, v3
    s_cmp_lt_u32 s31, 2
    s_cselect_b64 vcc, -1, 0
    v_cndmask_b32 v30, v3, v2, vcc
    s_lshl_b32 s3, s31, 10
    s_lshr_b32 s38, s29, 3
    s_lshl_b32 s38, s38, 14
    s_and_b32 s40, s29, 7
    s_lshl_b32 s40, s40, 10
    s_add_u32 s38, s38, s40
    s_and_b32 s40, s30, 1
    s_lshl_b32 s40, s40, 9
    s_add_u32 s38, s38, s40
    s_lshr_b32 s40, s30, 1
    s_lshl_b32 s40, s40, 7
    s_add_u32 s38, s38, s40
    v_bfe_u32 v27, v1, 2, 1
    v_lshlrev_b32 v27, 16, v27
    v_lshrrev_b32 v4, 5, v1
    v_lshl_add_u32 v27, v4, 8, v27
    v_bfe_u32 v4, v1, 1, 1
    v_lshl_add_u32 v27, v4, 6, v27
    v_bfe_u32 v4, v1, 4, 1
    v_lshl_add_u32 v27, v4, 5, v27
    v_and_b32 v4, 1, v1
    v_lshl_add_u32 v27, v4, 4, v27
    v_add_u32 v27, s38, v27
    s_lshr_b32 s39, s31, 1
    s_lshl_b32 s39, s39, 16
    s_and_b32 s40, s31, 1
    s_lshl_b32 s40, s40, 8
    s_add_u32 s39, s39, s40
    s_add_u32 s39, s39, s38
    v_add_u32 v95, s39, v16
    v_cmp_gt_u32 vcc, 8, v1
    v_mov_b32 v4, 2130706432
    s_nop 0
    v_cndmask_b32 v95, v4, v95, vcc
    s_lshl_b32 s38, s31, 8
    s_add_u32 s38, s38, 14336
    v_lshl_add_u32 v28, v1, 2, s38
    v_bfe_u32 v29, v1, 2, 1
    v_lshlrev_b32 v29, 7, v29
    v_bfe_u32 v4, v1, 4, 1
    v_lshl_add_u32 v29, v4, 6, v29
    v_and_b32 v4, 3, v1
    v_lshl_add_u32 v29, v4, 4, v29
    v_bfe_u32 v4, v1, 3, 1
    v_lshl_add_u32 v29, v4, 3, v29
    v_add_u32 v29, 14336, v29
    s_mul_i32 s39, s31, 320
    s_lshl_b32 s38, s28, 11
    s_add_u32 s38, s38, s39
    v_add_u32 v94, s38, v16
    v_cmp_gt_u32 vcc, 20, v1
    v_mov_b32 v4, 2130706432
    s_nop 0
    v_cndmask_b32 v94, v4, v94, vcc
    s_mul_i32 s38, s31, 3
    v_min_u32 v2, 2, v1
    v_add_u32 v2, s38, v2
    v_min_u32 v2, 9, v2
    s_lshl_b32 s38, s28, 11
    s_add_u32 s38, s38, 262144
    v_lshl_add_u32 v92, v2, 7, s38
    s_lshl_b32 s38, s28, 9
    v_lshrrev_b32 v93, 4, v1
    v_lshlrev_b32 v93, 7, v93
    v_and_b32 v4, 3, v1
    v_lshl_add_u32 v93, v4, 5, v93
    v_bfe_u32 v4, v1, 2, 1
    v_lshl_add_u32 v93, v4, 4, v93
    v_add_u32 v93, s38, v93
    s_mov_b32 vcc_lo, 0xff00ff00
    s_mov_b32 vcc_hi, 0xff00ff00
    s_cmp_eq_u32 s31, 1
    s_cbranch_scc1 rec_ns_2
    s_add_u32 s38, s38, 4194304
    v_add_u32 v93, s38, v16
    s_mov_b32 vcc_lo, -1
    s_mov_b32 vcc_hi, 0
    s_cmp_eq_u32 s31, 2
    s_cbranch_scc1 rec_ns_2
    s_lshr_b32 s38, s28, 6
    s_lshl_b32 s38, s38, 14
    s_and_b32 s40, s28, 63
    s_lshl_b32 s40, s40, 7
    s_add_u32 s38, s38, s40
    s_add_u32 s38, s38, 131072
    v_add_u32 v93, s38, v16
    s_cmp_eq_u32 s31, 3
    s_cselect_b32 vcc_lo, 0xff, 0
rec_ns_2:
    s_nop 0
    v_mov_b32 v4, 2130706432
    v_cndmask_b32 v93, v4, v93, vcc
    v_mov_b32 v32, 0x3f803f80
    v_mov_b32 v33, 0x3f803f80
    v_mov_b32 v34, 0x3f803f80
    v_mov_b32 v35, 0x3f803f80
    v_mov_b32 v8, -1
    v_mov_b32 v9, -1
    v_mov_b32 v10, -1
    v_mov_b32 v11, -1
    v_mov_b32 v144, 0
    v_mov_b32 v145, 0
    v_mov_b32 v146, 0
    v_mov_b32 v147, 0
    v_mov_b32 v180, 0
    v_mov_b32 v181, 0
    v_mov_b32 v182, 0
    v_mov_b32 v183, 0
    v_mov_b32 v161, 0
    v_mov_b32 v162, 0
    v_mov_b32 v163, 0
    v_mov_b32 v138, 0
    v_mov_b32 v139, 0
    v_mov_b32 v140, 0
    v_mov_b32 v141, 0
    v_mov_b32 v142, 0
    v_mov_b32 v143, 0
    s_mov_b32 s42, 0x00ff00ff
    s_mov_b32 s43, 0x00ff00ff
    s_mov_b32 s44, 0
    s_mov_b32 s45, -1
    s_mov_b32 s46, 0
    s_mov_b32 s47, 0x00ff00ff
    s_mov_b32 s50, 0x3e0293ee
    s_mov_b32 s36, 96468992
    s_mov_b32 s37, 0
    s_mov_b32 s32, 0
    s_mov_b32 s51, 16384
    s_mov_b32 s54, 1
    s_min_u32 s38, s31, 1
    s_add_u32 s38, s38, 1
    v_mov_b32 v134, s38
    s_lshl_b32 s95, s29, 7
    s_lshr_b32 s40, s31, 1
    s_lshl_b32 s40, s40, 2
    s_add_u32 s95, s95, s40
    s_add_u32 s95, s95, 115343364
    s_lshl_b32 s97, s29, 7
    s_add_u32 s97, s97, 115351552
    s_lshl_b32 s38, s30, 2
    s_add_u32 s38, s38, s97
    v_mov_b32 v188, s38
    s_cmp_eq_u32 s31, 2
    s_cselect_b64 vcc, 1, 0
    v_mov_b32 v4, 2130706432
    v_cndmask_b32 v188, v4, v188, vcc
    v_mov_b32 v189, 0
    s_mov_b32 s94, 0
    s_add_u32 s38, s49, 0
    buffer_store_dwordx4 v[144:147], v95, s[4:7], s38 offen sc1
    s_add_u32 s38, s49, 262144
    buffer_store_dwordx4 v[144:147], v95, s[4:7], s38 offen sc1
    s_add_u32 s38, s49, 8192
    buffer_store_dwordx4 v[144:147], v95, s[4:7], s38 offen sc1
    s_add_u32 s38, s49, 270336
    buffer_store_dwordx4 v[144:147], v95, s[4:7], s38 offen sc1
    buffer_store_dwordx4 v[8:11], v94, s[4:7], s36 offen sc1
    v_add_u32 v94, 262144, v94
    buffer_store_dwordx4 v[8:11], v94, s[4:7], s36 offen sc1
    v_add_u32 v94, 262144, v94
    buffer_store_dwordx4 v[8:11], v94, s[4:7], s36 offen sc1
    buffer_store_dword v189, v188, s[4:7], 0 offen sc1
    s_getreg_b32 s38, hwreg(HW_REG_XCC_ID)
    v_mov_b32 v2, s38
    buffer_store_dword v2, v188, s[4:7], 0 offen offset:16 sc1
    s_cmp_lg_u32 s31, 3
    s_cbranch_scc1 rec_i3_3
    s_add_u32 s38, s49, 262144
    buffer_store_dwordx4 v[144:147], v93, s[4:7], s38 offen sc1
    s_add_u32 s38, s49, 270336
    buffer_store_dwordx4 v[144:147], v93, s[4:7], s38 offen sc1
    s_lshr_b32 s39, s28, 5
    s_lshl_b32 s39, s39, 14
    s_and_b32 s40, s28, 31
    s_lshl_b32 s40, s40, 8
    s_add_u32 s39, s39, s40
    s_add_u32 s39, s39, s49
    s_add_u32 s39, s39, 163840
    s_mov_b64 exec, 0xffff
    s_add_u32 s38, s39, 0
    buffer_store_dwordx4 v[144:147], v16, s[4:7], s38 offen sc1
    s_add_u32 s38, s39, 8192
    buffer_store_dwordx4 v[144:147], v16, s[4:7], s38 offen sc1
    s_mov_b64 exec, -1
rec_i3_3:
    s_lshl_b32 s38, s31, 9
    v_bfe_u32 v2, v1, 2, 2
    v_lshlrev_b32 v2, 12, v2
    v_and_b32 v4, 1, v1
    v_lshl_add_u32 v2, v4, 11, v2
    v_lshrrev_b32 v4, 4, v1
    v_lshl_add_u32 v2, v4, 5, v2
    v_bfe_u32 v4, v1, 1, 1
    v_lshl_add_u32 v2, v4, 2, v2
    v_add_u32 v2, s38, v2
    buffer_load_dword v36, v2, s[24:27], 0 offen offset:0
    buffer_load_dword v37, v2, s[24:27], 0 offen offset:8
    buffer_load_dword v38, v2, s[24:27], 0 offen offset:16
    buffer_load_dword v39, v2, s[24:27], 0 offen offset:24
    buffer_load_dword v40, v2, s[24:27], 0 offen offset:128
    buffer_load_dword v41, v2, s[24:27], 0 offen offset:136
    buffer_load_dword v42, v2, s[24:27], 0 offen offset:144
    buffer_load_dword v43, v2, s[24:27], 0 offen offset:152
    buffer_load_dword v44, v2, s[24:27], 0 offen offset:256
    buffer_load_dword v45, v2, s[24:27], 0 offen offset:264
    buffer_load_dword v46, v2, s[24:27], 0 offen offset:272
    buffer_load_dword v47, v2, s[24:27], 0 offen offset:280
    buffer_load_dword v48, v2, s[24:27], 0 offen offset:384
    buffer_load_dword v49, v2, s[24:27], 0 offen offset:392
    buffer_load_dword v50, v2, s[24:27], 0 offen offset:400
    buffer_load_dword v51, v2, s[24:27], 0 offen offset:408
    s_add_u32 m0, s33, 12288
    s_mov_b32 s38, 524288
    buffer_load_dwordx4 v184, s[8:11], s38 offen lds
    s_add_u32 m0, s33, 13312
    s_mov_b32 s38, 655360
    buffer_load_dwordx4 v184, s[8:11], s38 offen lds
    s_add_u32 m0, s33, 14336
    s_mov_b32 s38, 524288
    buffer_load_dwordx4 v184, s[12:15], s38 offen lds
    s_add_u32 m0, s33, 15360
    s_mov_b32 s38, 655360
    buffer_load_dwordx4 v184, s[12:15], s38 offen lds
    s_add_u32 m0, s33, 16384
    s_mov_b32 s38, 524288
    buffer_load_dwordx4 v184, s[16:19], s38 offen lds
    s_add_u32 m0, s33, 17408
    s_mov_b32 s38, 655360
    buffer_load_dwordx4 v184, s[16:19], s38 offen lds
    s_add_u32 m0, s33, 18432
    s_mov_b32 s38, 786432
    buffer_load_dwordx4 v184, s[8:11], s38 offen lds
    s_add_u32 m0, s33, 19456
    s_mov_b32 s38, 917504
    buffer_load_dwordx4 v184, s[8:11], s38 offen lds
    s_add_u32 m0, s33, 20480
    s_mov_b32 s38, 786432
    buffer_load_dwordx4 v184, s[12:15], s38 offen lds
    s_add_u32 m0, s33, 21504
    s_mov_b32 s38, 917504
    buffer_load_dwordx4 v184, s[12:15], s38 offen lds
    s_add_u32 m0, s33, 22528
    s_mov_b32 s38, 786432
    buffer_load_dwordx4 v184, s[16:19], s38 offen lds
    s_add_u32 m0, s33, 23552
    s_mov_b32 s38, 917504
    buffer_load_dwordx4 v184, s[16:19], s38 offen lds
    s_add_u32 m0, s33, 24576
    s_mov_b32 s38, 1048576
    buffer_load_dwordx4 v184, s[8:11], s38 offen lds
    s_add_u32 m0, s33, 25600
    s_mov_b32 s38, 1179648
    buffer_load_dwordx4 v184, s[8:11], s38 offen lds
    s_add_u32 m0, s33, 26624
    s_mov_b32 s38, 1048576
    buffer_load_dwordx4 v184, s[12:15], s38 offen lds
    s_add_u32 m0, s33, 27648
    s_mov_b32 s38, 1179648
    buffer_load_dwordx4 v184, s[12:15], s38 offen lds
    s_add_u32 m0, s33, 28672
    s_mov_b32 s38, 1048576
    buffer_load_dwordx4 v184, s[16:19], s38 offen lds
    s_add_u32 m0, s33, 29696
    s_mov_b32 s38, 1179648
    buffer_load_dwordx4 v184, s[16:19], s38 offen lds
    s_add_u32 m0, s33, 30720
    s_mov_b32 s38, 1310720
    buffer_load_dwordx4 v184, s[8:11], s38 offen lds
    s_add_u32 m0, s33, 31744
    s_mov_b32 s38, 1441792
    buffer_load_dwordx4 v184, s[8:11], s38 offen lds
    s_waitcnt vmcnt(54)
    ds_read_b64_tr_b16 a[0:1], v186 offset:0
    ds_read_b64_tr_b16 a[2:3], v186 offset:256
    ds_read_b64_tr_b16 a[8:9], v186 offset:32
    ds_read_b64_tr_b16 a[10:11], v186 offset:288
    s_waitcnt vmcnt(52)
    ds_read_b64_tr_b16 a[16:17], v186 offset:2048
    ds_read_b64_tr_b16 a[18:19], v186 offset:2304
    ds_read_b64_tr_b16 a[24:25], v186 offset:2080
    ds_read_b64_tr_b16 a[26:27], v186 offset:2336
    s_waitcnt lgkmcnt(4)
    s_add_u32 m0, s33, 0
    s_mov_b32 s38, 1310720
    buffer_load_dwordx4 v184, s[12:15], s38 offen lds
    s_add_u32 m0, s33, 1024
    s_mov_b32 s38, 1441792
    buffer_load_dwordx4 v184, s[12:15], s38 offen lds
    s_waitcnt vmcnt(52)
    ds_read_b64_tr_b16 a[32:33], v186 offset:4096
    ds_read_b64_tr_b16 a[34:35], v186 offset:4352
    ds_read_b64_tr_b16 a[40:41], v186 offset:4128
    ds_read_b64_tr_b16 a[42:43], v186 offset:4384
    s_waitcnt lgkmcnt(4)
    s_add_u32 m0, s33, 2048
    s_mov_b32 s38, 1310720
    buffer_load_dwordx4 v184, s[16:19], s38 offen lds
    s_add_u32 m0, s33, 3072
    s_mov_b32 s38, 1441792
    buffer_load_dwordx4 v184, s[16:19], s38 offen lds
    s_waitcnt vmcnt(52)
    ds_read_b64_tr_b16 a[4:5], v186 offset:6144
    ds_read_b64_tr_b16 a[6:7], v186 offset:6400
    ds_read_b64_tr_b16 a[12:13], v186 offset:6176
    ds_read_b64_tr_b16 a[14:15], v186 offset:6432
    s_waitcnt lgkmcnt(4)
    s_add_u32 m0, s33, 4096
    s_mov_b32 s38, 1572864
    buffer_load_dwordx4 v184, s[8:11], s38 offen lds
    s_add_u32 m0, s33, 5120
    s_mov_b32 s38, 1703936
    buffer_load_dwordx4 v184, s[8:11], s38 offen lds
    s_waitcnt vmcnt(52)
    ds_read_b64_tr_b16 a[20:21], v186 offset:8192
    ds_read_b64_tr_b16 a[22:23], v186 offset:8448
    ds_read_b64_tr_b16 a[28:29], v186 offset:8224
    ds_read_b64_tr_b16 a[30:31], v186 offset:8480
    s_waitcnt lgkmcnt(4)
    s_add_u32 m0, s33, 6144
    s_mov_b32 s38, 1572864
    buffer_load_dwordx4 v184, s[12:15], s38 offen lds
    s_add_u32 m0, s33, 7168
    s_mov_b32 s38, 1703936
    buffer_load_dwordx4 v184, s[12:15], s38 offen lds
    s_waitcnt vmcnt(52)
    ds_read_b64_tr_b16 a[36:37], v186 offset:10240
    ds_read_b64_tr_b16 a[38:39], v186 offset:10496
    ds_read_b64_tr_b16 a[44:45], v186 offset:10272
    ds_read_b64_tr_b16 a[46:47], v186 offset:10528
    s_waitcnt lgkmcnt(4)
    s_add_u32 m0, s33, 8192
    s_mov_b32 s38, 1572864
    buffer_load_dwordx4 v184, s[16:19], s38 offen lds
    s_add_u32 m0, s33, 9216
    s_mov_b32 s38, 1703936
    buffer_load_dwordx4 v184, s[16:19], s38 offen lds
    s_waitcnt vmcnt(28)
    s_barrier
    s_cmp_lg_u32 s31, 3
    s_cbranch_scc1 rec_arr_4
    v_mov_b32 v2, 0
    v_mov_b32 v3, s48
    s_mov_b64 exec, 1
    global_atomic_add v2, v3, s[92:93] offset:0 sc1
    s_mov_b64 exec, -1
rec_arr_4:
    ds_read_b64_tr_b16 a[48:49], v186 offset:12288
    ds_read_b64_tr_b16 a[50:51], v186 offset:12544
    ds_read_b64_tr_b16 a[56:57], v186 offset:12320
    ds_read_b64_tr_b16 a[58:59], v186 offset:12576
    s_waitcnt lgkmcnt(4)
    s_add_u32 m0, s33, 10240
    s_mov_b32 s38, 1835008
    buffer_load_dwordx4 v184, s[8:11], s38 offen lds
    s_add_u32 m0, s33, 11264
    s_mov_b32 s38, 1966080
    buffer_load_dwordx4 v184, s[8:11], s38 offen lds
    s_waitcnt vmcnt(28)
    ds_read_b64_tr_b16 a[64:65], v186 offset:14336
    ds_read_b64_tr_b16 a[66:67], v186 offset:14592
    ds_read_b64_tr_b16 a[72:73], v186 offset:14368
    ds_read_b64_tr_b16 a[74:75], v186 offset:14624
    s_waitcnt lgkmcnt(4)
    s_add_u32 m0, s33, 12288
    s_mov_b32 s38, 1835008
    buffer_load_dwordx4 v184, s[12:15], s38 offen lds
    s_add_u32 m0, s33, 13312
    s_mov_b32 s38, 1966080
    buffer_load_dwordx4 v184, s[12:15], s38 offen lds
    s_waitcnt vmcnt(28)
    ds_read_b64_tr_b16 a[80:81], v186 offset:16384
    ds_read_b64_tr_b16 a[82:83], v186 offset:16640
    ds_read_b64_tr_b16 a[88:89], v186 offset:16416
    ds_read_b64_tr_b16 a[90:91], v186 offset:16672
    s_waitcnt lgkmcnt(4)
    s_add_u32 m0, s33, 14336
    s_mov_b32 s38, 1835008
    buffer_load_dwordx4 v184, s[16:19], s38 offen lds
    s_add_u32 m0, s33, 15360
    s_mov_b32 s38, 1966080
    buffer_load_dwordx4 v184, s[16:19], s38 offen lds
    s_waitcnt vmcnt(28)
    ds_read_b64_tr_b16 a[52:53], v186 offset:18432
    ds_read_b64_tr_b16 a[54:55], v186 offset:18688
    ds_read_b64_tr_b16 a[60:61], v186 offset:18464
    ds_read_b64_tr_b16 a[62:63], v186 offset:18720
    s_waitcnt lgkmcnt(4)
    s_add_u32 m0, s33, 16384
    s_mov_b32 s38, 0
    buffer_load_dwordx4 v185, s[20:23], s38 offen lds
    s_add_u32 m0, s33, 17408
    s_mov_b32 s38, 65536
    buffer_load_dwordx4 v185, s[20:23], s38 offen lds
    s_waitcnt vmcnt(28)
    ds_read_b64_tr_b16 a[68:69], v186 offset:20480
    ds_read_b64_tr_b16 a[70:71], v186 offset:20736
    ds_read_b64_tr_b16 a[76:77], v186 offset:20512
    ds_read_b64_tr_b16 a[78:79], v186 offset:20768
    s_waitcnt lgkmcnt(4)
    s_add_u32 m0, s33, 18432
    s_mov_b32 s38, 131072
    buffer_load_dwordx4 v185, s[20:23], s38 offen lds
    s_add_u32 m0, s33, 19456
    s_mov_b32 s38, 196608
    buffer_load_dwordx4 v185, s[20:23], s38 offen lds
    s_waitcnt vmcnt(28)
    ds_read_b64_tr_b16 a[84:85], v186 offset:22528
    ds_read_b64_tr_b16 a[86:87], v186 offset:22784
    ds_read_b64_tr_b16 a[92:93], v186 offset:22560
    ds_read_b64_tr_b16 a[94:95], v186 offset:22816
    s_waitcnt lgkmcnt(4)
    s_add_u32 m0, s33, 20480
    s_mov_b32 s38, 262144
    buffer_load_dwordx4 v185, s[20:23], s38 offen lds
    s_add_u32 m0, s33, 21504
    s_mov_b32 s38, 327680
    buffer_load_dwordx4 v185, s[20:23], s38 offen lds
    s_waitcnt vmcnt(28)
    ds_read_b64_tr_b16 a[96:97], v186 offset:24576
    ds_read_b64_tr_b16 a[98:99], v186 offset:24832
    ds_read_b64_tr_b16 a[104:105], v186 offset:24608
    ds_read_b64_tr_b16 a[106:107], v186 offset:24864
    s_waitcnt lgkmcnt(4)
    s_add_u32 m0, s33, 22528
    s_mov_b32 s38, 393216
    buffer_load_dwordx4 v185, s[20:23], s38 offen lds
    s_add_u32 m0, s33, 23552
    s_mov_b32 s38, 458752
    buffer_load_dwordx4 v185, s[20:23], s38 offen lds
    s_waitcnt vmcnt(28)
    ds_read_b64_tr_b16 a[112:113], v186 offset:26624
    ds_read_b64_tr_b16 a[114:115], v186 offset:26880
    ds_read_b64_tr_b16 a[120:121], v186 offset:26656
    ds_read_b64_tr_b16 a[122:123], v186 offset:26912
    s_waitcnt lgkmcnt(4)
    s_add_u32 m0, s33, 24576
    s_mov_b32 s38, 524288
    buffer_load_dwordx4 v185, s[20:23], s38 offen lds
    s_add_u32 m0, s33, 25600
    s_mov_b32 s38, 589824
    buffer_load_dwordx4 v185, s[20:23], s38 offen lds
    s_waitcnt vmcnt(28)
    ds_read_b64_tr_b16 a[128:129], v186 offset:28672
    ds_read_b64_tr_b16 a[130:131], v186 offset:28928
    ds_read_b64_tr_b16 a[136:137], v186 offset:28704
    ds_read_b64_tr_b16 a[138:139], v186 offset:28960
    s_waitcnt lgkmcnt(4)
    s_add_u32 m0, s33, 26624
    s_mov_b32 s38, 655360
    buffer_load_dwordx4 v185, s[20:23], s38 offen lds
    s_add_u32 m0, s33, 27648
    s_mov_b32 s38, 720896
    buffer_load_dwordx4 v185, s[20:23], s38 offen lds
    s_waitcnt vmcnt(28)
    ds_read_b64_tr_b16 a[100:101], v186 offset:30720
    ds_read_b64_tr_b16 a[102:103], v186 offset:30976
    ds_read_b64_tr_b16 a[108:109], v186 offset:30752
    ds_read_b64_tr_b16 a[110:111], v186 offset:31008
    s_waitcnt lgkmcnt(4)
    s_add_u32 m0, s33, 28672
    s_mov_b32 s38, 786432
    buffer_load_dwordx4 v185, s[20:23], s38 offen lds
    s_add_u32 m0, s33, 29696
    s_mov_b32 s38, 851968
    buffer_load_dwordx4 v185, s[20:23], s38 offen lds
    s_waitcnt vmcnt(28)
    ds_read_b64_tr_b16 a[116:117], v186 offset:0
    ds_read_b64_tr_b16 a[118:119], v186 offset:256
    ds_read_b64_tr_b16 a[124:125], v186 offset:32
    ds_read_b64_tr_b16 a[126:127], v186 offset:288
    s_waitcnt lgkmcnt(4)
    s_add_u32 m0, s33, 30720
    s_mov_b32 s38, 917504
    buffer_load_dwordx4 v185, s[20:23], s38 offen lds
    s_add_u32 m0, s33, 31744
    s_mov_b32 s38, 983040
    buffer_load_dwordx4 v185, s[20:23], s38 offen lds
    s_waitcnt vmcnt(28)
    ds_read_b64_tr_b16 a[132:133], v186 offset:2048
    ds_read_b64_tr_b16 a[134:135], v186 offset:2304
    ds_read_b64_tr_b16 a[140:141], v186 offset:2080
    ds_read_b64_tr_b16 a[142:143], v186 offset:2336
    s_waitcnt lgkmcnt(4)
    s_add_u32 m0, s33, 0
    s_mov_b32 s38, 1048576
    buffer_load_dwordx4 v185, s[20:23], s38 offen lds
    s_add_u32 m0, s33, 1024
    s_mov_b32 s38, 1114112
    buffer_load_dwordx4 v185, s[20:23], s38 offen lds
    s_waitcnt vmcnt(28)
    ds_read_b64_tr_b16 a[144:145], v186 offset:4096
    ds_read_b64_tr_b16 a[146:147], v186 offset:4352
    ds_read_b64_tr_b16 a[152:153], v186 offset:4128
    ds_read_b64_tr_b16 a[154:155], v186 offset:4384
    s_waitcnt lgkmcnt(4)
    s_add_u32 m0, s33, 2048
    s_mov_b32 s38, 1179648
    buffer_load_dwordx4 v185, s[20:23], s38 offen lds
    s_add_u32 m0, s33, 3072
    s_mov_b32 s38, 1245184
    buffer_load_dwordx4 v185, s[20:23], s38 offen lds
    s_waitcnt vmcnt(28)
    ds_read_b64_tr_b16 a[160:161], v186 offset:6144
    ds_read_b64_tr_b16 a[162:163], v186 offset:6400
    ds_read_b64_tr_b16 a[168:169], v186 offset:6176
    ds_read_b64_tr_b16 a[170:171], v186 offset:6432
    s_waitcnt lgkmcnt(4)
    s_add_u32 m0, s33, 4096
    s_mov_b32 s38, 1310720
    buffer_load_dwordx4 v185, s[20:23], s38 offen lds
    s_add_u32 m0, s33, 5120
    s_mov_b32 s38, 1376256
    buffer_load_dwordx4 v185, s[20:23], s38 offen lds
    s_waitcnt vmcnt(28)
    ds_read_b64_tr_b16 a[176:177], v186 offset:8192
    ds_read_b64_tr_b16 a[178:179], v186 offset:8448
    ds_read_b64_tr_b16 a[184:185], v186 offset:8224
    ds_read_b64_tr_b16 a[186:187], v186 offset:8480
    s_waitcnt lgkmcnt(4)
    s_add_u32 m0, s33, 6144
    s_mov_b32 s38, 1441792
    buffer_load_dwordx4 v185, s[20:23], s38 offen lds
    s_add_u32 m0, s33, 7168
    s_mov_b32 s38, 1507328
    buffer_load_dwordx4 v185, s[20:23], s38 offen lds
    s_waitcnt vmcnt(28)
    ds_read_b64_tr_b16 a[148:149], v186 offset:10240
    ds_read_b64_tr_b16 a[150:151], v186 offset:10496
    ds_read_b64_tr_b16 a[156:157], v186 offset:10272
    ds_read_b64_tr_b16 a[158:159], v186 offset:10528
    s_waitcnt lgkmcnt(4)
    s_add_u32 m0, s33, 8192
    s_mov_b32 s38, 1572864
    buffer_load_dwordx4 v185, s[20:23], s38 offen lds
    s_add_u32 m0, s33, 9216
    s_mov_b32 s38, 1638400
    buffer_load_dwordx4 v185, s[20:23], s38 offen lds
    s_waitcnt vmcnt(28)
    ds_read_b64_tr_b16 a[164:165], v186 offset:12288
    ds_read_b64_tr_b16 a[166:167], v186 offset:12544
    ds_read_b64_tr_b16 a[172:173], v186 offset:12320
    ds_read_b64_tr_b16 a[174:175], v186 offset:12576
    s_waitcnt lgkmcnt(4)
    s_add_u32 m0, s33, 10240
    s_mov_b32 s38, 1703936
    buffer_load_dwordx4 v185, s[20:23], s38 offen lds
    s_add_u32 m0, s33, 11264
    s_mov_b32 s38, 1769472
    buffer_load_dwordx4 v185, s[20:23], s38 offen lds
    s_waitcnt vmcnt(28)
    ds_read_b64_tr_b16 a[180:181], v186 offset:14336
    ds_read_b64_tr_b16 a[182:183], v186 offset:14592
    ds_read_b64_tr_b16 a[188:189], v186 offset:14368
    ds_read_b64_tr_b16 a[190:191], v186 offset:14624
    s_waitcnt lgkmcnt(4)
    s_add_u32 m0, s33, 12288
    s_mov_b32 s38, 1835008
    buffer_load_dwordx4 v185, s[20:23], s38 offen lds
    s_add_u32 m0, s33, 13312
    s_mov_b32 s38, 1900544
    buffer_load_dwordx4 v185, s[20:23], s38 offen lds
    s_waitcnt vmcnt(28)
    ds_read_b64_tr_b16 a[192:193], v187 offset:16384
    ds_read_b64_tr_b16 a[194:195], v187 offset:16512
    ds_read_b64_tr_b16 a[196:197], v187 offset:17408
    ds_read_b64_tr_b16 a[198:199], v187 offset:17536
    s_waitcnt lgkmcnt(4)
    s_add_u32 m0, s33, 14336
    s_mov_b32 s38, 1966080
    buffer_load_dwordx4 v185, s[20:23], s38 offen lds
    s_add_u32 m0, s33, 15360
    s_mov_b32 s38, 2031616
    buffer_load_dwordx4 v185, s[20:23], s38 offen lds
    s_waitcnt vmcnt(28)
    ds_read_b64_tr_b16 a[200:201], v187 offset:18432
    ds_read_b64_tr_b16 a[202:203], v187 offset:18560
    ds_read_b64_tr_b16 a[204:205], v187 offset:19456
    ds_read_b64_tr_b16 a[206:207], v187 offset:19584
    s_waitcnt vmcnt(26)
    s_cmp_lg_u32 s31, 0
    s_cbranch_scc1 rec_rdy_5
    v_mov_b32 v2, 0
    v_mov_b32 v3, 1
    s_mov_b64 exec, 1
    global_atomic_add v2, v3, s[92:93] offset:128 sc1
    s_mov_b64 exec, -1
rec_rdy_5:
    ds_read_b64_tr_b16 a[208:209], v187 offset:20480
    ds_read_b64_tr_b16 a[210:211], v187 offset:20608
    ds_read_b64_tr_b16 a[212:213], v187 offset:21504
    ds_read_b64_tr_b16 a[214:215], v187 offset:21632
    s_waitcnt vmcnt(24)
    ds_read_b64_tr_b16 a[216:217], v187 offset:22528
    ds_read_b64_tr_b16 a[218:219], v187 offset:22656
    ds_read_b64_tr_b16 a[220:221], v187 offset:23552
    ds_read_b64_tr_b16 a[222:223], v187 offset:23680
    s_waitcnt vmcnt(22)
    ds_read_b64_tr_b16 a[224:225], v187 offset:24576
    ds_read_b64_tr_b16 a[226:227], v187 offset:24704
    ds_read_b64_tr_b16 a[228:229], v187 offset:25600
    ds_read_b64_tr_b16 a[230:231], v187 offset:25728
    s_waitcnt vmcnt(20)
    ds_read_b64_tr_b16 a[232:233], v187 offset:26624
    ds_read_b64_tr_b16 a[234:235], v187 offset:26752
    ds_read_b64_tr_b16 a[236:237], v187 offset:27648
    ds_read_b64_tr_b16 a[238:239], v187 offset:27776
    s_waitcnt vmcnt(18)
    ds_read_b64_tr_b16 a[240:241], v187 offset:28672
    ds_read_b64_tr_b16 a[242:243], v187 offset:28800
    ds_read_b64_tr_b16 a[244:245], v187 offset:29696
    ds_read_b64_tr_b16 a[246:247], v187 offset:29824
    s_waitcnt vmcnt(16)
    ds_read_b64_tr_b16 a[248:249], v187 offset:30720
    ds_read_b64_tr_b16 a[250:251], v187 offset:30848
    ds_read_b64_tr_b16 a[252:253], v187 offset:31744
    ds_read_b64_tr_b16 a[254:255], v187 offset:31872
    s_waitcnt vmcnt(14)
    ds_read_b64_tr_b16 v[192:193], v187 offset:0
    ds_read_b64_tr_b16 v[194:195], v187 offset:128
    ds_read_b64_tr_b16 v[196:197], v187 offset:1024
    ds_read_b64_tr_b16 v[198:199], v187 offset:1152
    s_waitcnt vmcnt(12)
    ds_read_b64_tr_b16 v[200:201], v187 offset:2048
    ds_read_b64_tr_b16 v[202:203], v187 offset:2176
    ds_read_b64_tr_b16 v[204:205], v187 offset:3072
    ds_read_b64_tr_b16 v[206:207], v187 offset:3200
    s_waitcnt vmcnt(10)
    ds_read_b64_tr_b16 v[208:209], v187 offset:4096
    ds_read_b64_tr_b16 v[210:211], v187 offset:4224
    ds_read_b64_tr_b16 v[212:213], v187 offset:5120
    ds_read_b64_tr_b16 v[214:215], v187 offset:5248
    s_waitcnt vmcnt(8)
    ds_read_b64_tr_b16 v[216:217], v187 offset:6144
    ds_read_b64_tr_b16 v[218:219], v187 offset:6272
    ds_read_b64_tr_b16 v[220:221], v187 offset:7168
    ds_read_b64_tr_b16 v[222:223], v187 offset:7296
    s_waitcnt vmcnt(6)
    ds_read_b64_tr_b16 v[224:225], v187 offset:8192
    ds_read_b64_tr_b16 v[226:227], v187 offset:8320
    ds_read_b64_tr_b16 v[228:229], v187 offset:9216
    ds_read_b64_tr_b16 v[230:231], v187 offset:9344
    s_waitcnt vmcnt(4)
    ds_read_b64_tr_b16 v[232:233], v187 offset:10240
    ds_read_b64_tr_b16 v[234:235], v187 offset:10368
    ds_read_b64_tr_b16 v[236:237], v187 offset:11264
    ds_read_b64_tr_b16 v[238:239], v187 offset:11392
    s_waitcnt vmcnt(2)
    ds_read_b64_tr_b16 v[240:241], v187 offset:12288
    ds_read_b64_tr_b16 v[242:243], v187 offset:12416
    ds_read_b64_tr_b16 v[244:245], v187 offset:13312
    ds_read_b64_tr_b16 v[246:247], v187 offset:13440
    s_waitcnt vmcnt(0)
    ds_read_b64_tr_b16 v[248:249], v187 offset:14336
    ds_read_b64_tr_b16 v[250:251], v187 offset:14464
    ds_read_b64_tr_b16 v[252:253], v187 offset:15360
    ds_read_b64_tr_b16 v[254:255], v187 offset:15488
    s_waitcnt lgkmcnt(0)
    v_max_u32 v36, 1, v36
    v_max_u32 v37, 1, v37
    v_max_u32 v38, 1, v38
    v_max_u32 v39, 1, v39
    v_max_u32 v40, 1, v40
    v_max_u32 v41, 1, v41
    v_max_u32 v42, 1, v42
    v_max_u32 v43, 1, v43
    v_max_u32 v44, 1, v44
    v_max_u32 v45, 1, v45
    v_max_u32 v46, 1, v46
    v_max_u32 v47, 1, v47
    v_max_u32 v48, 1, v48
    v_max_u32 v49, 1, v49
    v_max_u32 v50, 1, v50
    v_max_u32 v51, 1, v51
    v_mov_b32 v68, 0
    v_mov_b32 v69, 0
    v_mov_b32 v70, 0
    v_mov_b32 v71, 0
    v_mov_b32 v72, 0
    v_mov_b32 v73, 0
    v_mov_b32 v74, 0
    v_mov_b32 v75, 0
    v_mov_b32 v76, 0
    v_mov_b32 v77, 0
    v_mov_b32 v78, 0
    v_mov_b32 v79, 0
    v_mov_b32 v80, 0
    v_mov_b32 v81, 0
    v_mov_b32 v82, 0
    v_mov_b32 v83, 0
    v_mov_b32 v84, 0
    v_mov_b32 v85, 0
    v_mov_b32 v86, 0
    v_mov_b32 v87, 0
    v_mov_b32 v88, 0
    v_mov_b32 v89, 0
    v_mov_b32 v90, 0
    v_mov_b32 v91, 0
    s_mov_b32 s72, 0
    s_mov_b32 s73, 0
    s_mov_b32 s74, 0
    s_mov_b32 s75, 0
    s_mov_b32 s76, 0
    s_mov_b32 s77, 0
    s_mov_b32 s78, 0
    s_mov_b32 s79, 0
    s_mov_b32 s80, 0
    s_mov_b32 s81, 0
    s_mov_b32 s82, 0
    s_mov_b32 s83, 0
    s_mov_b32 s84, 0
    s_mov_b32 s85, 0
    s_mov_b32 s86, 0
    s_mov_b32 s87, 0
    v_mov_b32 v2, 0
    s_branch rec_ibq_8
rec_ibp_7:
    s_sleep 16
rec_ibq_8:
    global_load_dword v3, v2, s[92:93] offset:0 sc1
    s_add_u32 s41, s41, 1
    s_cmp_ge_u32 s41, 0x80000
    s_cbranch_scc1 rec_ib_6
    s_waitcnt vmcnt(0)
    v_readfirstlane_b32 s38, v3
    s_and_b32 s39, s38, 0xffff
    s_cmp_lt_u32 s39, 256
    s_cbranch_scc1 rec_ibp_7
rec_ib_6:
    s_cmp_ge_u32 s38, 4194304
    s_cselect_b32 s48, -1, 0
    s_xor_b32 s48, s48, 0xaaa
    s_and_b32 s33, s48, 1
    s_lshl_b32 s33, s33, 13
    s_add_u32 s33, s33, s49
    s_add_u32 s34, s33, 262144
    s_add_u32 s35, s33, 524288
    s_lshr_b32 s38, s28, 5
    s_lshl_b32 s38, s38, 4
    s_lshl_b32 s40, s30, 14
    s_add_u32 s38, s38, s40
    s_add_u32 s38, s38, s33
    s_add_u32 s38, s38, 163840
    v_and_b32 v132, 31, v1
    v_lshlrev_b32 v132, 8, v132
    v_add_u32 v132, s38, v132
    s_and_b32 s39, s29, 23
    s_cmp_eq_u32 s39, 3
    s_mov_b32 vcc_hi, 0
    s_cselect_b32 vcc_lo, -1, 0
    v_mov_b32 v4, 2130706432
    v_cndmask_b32 v132, v4, v132, vcc
    v_add_u32 v133, 128, v132
    s_cmp_eq_u32 s31, 1
    s_cselect_b64 vcc, -1, 0
    v_mov_b32 v4, 2130706432
    v_cndmask_b32 v133, v4, v133, vcc
    s_lshr_b32 s55, s28, 5
    s_lshl_b32 s55, s55, 14
    s_and_b32 s40, s28, 31
    s_lshl_b32 s40, s40, 8
    s_add_u32 s55, s55, s40
    s_add_u32 s55, s55, s33
    s_add_u32 s55, s55, 163840
    s_cmp_eq_u32 s31, 3
    s_cselect_b32 s88, s35, 88080384
    s_barrier
    s_load_dwordx4 s[72:75], s[90:91], s97 offset:16 glc
    s_waitcnt lgkmcnt(0)
    s_xor_b32 s73, s73, s72
    s_xor_b32 s74, s74, s72
    s_xor_b32 s75, s75, s72
    s_or_b32 s73, s73, s74
    s_or_b32 s96, s73, s75
    s_mov_b32 s72, 0
    s_mov_b32 s73, 0
    s_mov_b32 s74, 0
    s_mov_b32 s75, 0
    s_cmp_gt_u32 s94, 0
    s_cbranch_scc0 rec_kv_9
rec_kvd_10:
    s_add_u32 m0, s51, s3
    s_nop 0
    buffer_load_dwordx4 v30, s[4:7], s37 offen sc1 lds
    s_waitcnt vmcnt(0)
    s_barrier
    s_branch rec_entry_11
rec_loop_12:
    s_barrier
    buffer_load_dwordx4 v[36:39], v7, s[4:7], s33 offen offset:0 sc1
    s_nop 3
    buffer_load_dwordx4 v[40:43], v7, s[4:7], s33 offen offset:1024 sc1
    s_nop 3
    buffer_load_dwordx4 v[44:47], v7, s[4:7], s33 offen offset:2048 sc1
    s_nop 3
    buffer_load_dwordx4 v[48:51], v7, s[4:7], s33 offen offset:3072 sc1
rec_entry_11:
    v_add_u32 v2, s51, v16
    ds_read_b128 v[60:63], v2 offset:0
    ds_read_b128 v[64:67], v2 offset:1024
    ds_read_b128 v[52:55], v2 offset:2048
    ds_read_b128 v[56:59], v2 offset:3072
    s_waitcnt vmcnt(3)
    v_smfmac_f32_16x16x64_bf16 v[68:71], v[36:39], a[0:7], v5
    v_min_u32 v31, v36, v37
    v_smfmac_f32_16x16x64_bf16 v[72:75], v[36:39], a[8:15], v5
    v_min_u32 v4, v38, v39
    v_smfmac_f32_16x16x64_bf16 v[76:79], v[36:39], a[16:23], v5
    v_smfmac_f32_16x16x64_bf16 v[80:83], v[36:39], a[24:31], v5
    s_waitcnt vmcnt(2)
    v_smfmac_f32_16x16x64_bf16 v[68:71], v[40:43], a[48:55], v5
    v_min3_u32 v31, v31, v40, v41
    v_smfmac_f32_16x16x64_bf16 v[72:75], v[40:43], a[56:63], v5
    v_min3_u32 v4, v4, v42, v43
    v_smfmac_f32_16x16x64_bf16 v[76:79], v[40:43], a[64:71], v5
    v_smfmac_f32_16x16x64_bf16 v[80:83], v[40:43], a[72:79], v5
    s_waitcnt vmcnt(1)
    v_smfmac_f32_16x16x64_bf16 v[68:71], v[44:47], a[96:103], v5
    v_min3_u32 v31, v31, v44, v45
    v_smfmac_f32_16x16x64_bf16 v[72:75], v[44:47], a[104:111], v5
    v_min3_u32 v4, v4, v46, v47
    v_smfmac_f32_16x16x64_bf16 v[76:79], v[44:47], a[112:119], v5
    v_min_u32 v31, v31, v4
    v_smfmac_f32_16x16x64_bf16 v[80:83], v[44:47], a[120:127], v5
    s_waitcnt vmcnt(0)
    v_min3_u32 v31, v31, v48, v49
    v_smfmac_f32_16x16x64_bf16 v[68:71], v[48:51], a[144:151], v5
    v_min3_u32 v31, v31, v50, v51
    v_smfmac_f32_16x16x64_bf16 v[72:75], v[48:51], a[152:159], v5
    v_cmp_eq_u32 vcc, 0, v31
    v_smfmac_f32_16x16x64_bf16 v[76:79], v[48:51], a[160:167], v5
    v_smfmac_f32_16x16x64_bf16 v[80:83], v[48:51], a[168:175], v5
    s_cbranch_vccnz rec_gafix_15
rec_gaok_14:
    s_nop 1
    v_pk_add_f32 v[68:69], v[68:69], v[70:71]
    s_nop 0
    v_pk_add_f32 v[70:71], v[72:73], v[74:75]
    ds_write2_b32 v14, v68, v69 offset0:0 offset1:40
    ds_write2_b32 v14, v70, v71 offset0:16 offset1:56
    v_pk_add_f32 v[76:77], v[76:77], v[78:79]
    v_pk_add_f32 v[78:79], v[80:81], v[82:83]
    ds_write2_b32 v15, v76, v77 offset0:0 offset1:40
    ds_write2_b32 v15, v78, v79 offset0:16 offset1:56
    s_cmp_lg_u32 s31, 0
    s_cbranch_scc1 rec_w1_17
    s_waitcnt lgkmcnt(0)
    s_barrier
    ds_read_b128 v[100:103], v18 offset:0
    v_smfmac_f32_16x16x64_bf16 v[84:87], v[36:39], a[32:39], v5
    ds_read_b128 v[104:107], v18 offset:32
    v_smfmac_f32_16x16x64_bf16 v[88:91], v[36:39], a[40:47], v5
    ds_read_b128 v[108:111], v18 offset:2560
    v_smfmac_f32_16x16x64_bf16 v[84:87], v[40:43], a[80:87], v5
    ds_read_b128 v[112:115], v18 offset:2592
    v_smfmac_f32_16x16x64_bf16 v[88:91], v[40:43], a[88:95], v5
    ds_read_b128 v[116:119], v18 offset:5120
    v_smfmac_f32_16x16x64_bf16 v[84:87], v[44:47], a[128:135], v5
    ds_read_b128 v[120:123], v18 offset:5152
    v_smfmac_f32_16x16x64_bf16 v[88:91], v[44:47], a[136:143], v5
    ds_read_b128 v[124:127], v18 offset:7680
    v_smfmac_f32_16x16x64_bf16 v[84:87], v[48:51], a[176:183], v5
    ds_read_b128 v[128:131], v18 offset:7712
    v_smfmac_f32_16x16x64_bf16 v[88:91], v[48:51], a[184:191], v5
    s_waitcnt lgkmcnt(4)
    v_pk_add_f32 v[100:101], v[100:101], v[108:109]
    v_pk_add_f32 v[102:103], v[102:103], v[110:111]
    v_pk_add_f32 v[104:105], v[104:105], v[112:113]
    v_pk_add_f32 v[106:107], v[106:107], v[114:115]
    s_waitcnt lgkmcnt(2)
    v_pk_add_f32 v[100:101], v[100:101], v[116:117]
    v_pk_add_f32 v[102:103], v[102:103], v[118:119]
    v_pk_add_f32 v[104:105], v[104:105], v[120:121]
    v_pk_add_f32 v[106:107], v[106:107], v[122:123]
    s_waitcnt lgkmcnt(0)
    v_pk_add_f32 v[100:101], v[100:101], v[124:125]
    v_pk_add_f32 v[102:103], v[102:103], v[126:127]
    v_pk_add_f32 v[104:105], v[104:105], v[128:129]
    v_pk_add_f32 v[106:107], v[106:107], v[130:131]
    v_cvt_pk_bf16_f32 v96, v100, v101
    v_cvt_pk_bf16_f32 v97, v102, v103
    v_cvt_pk_bf16_f32 v98, v104, v105
    v_cvt_pk_bf16_f32 v99, v106, v107
    s_nop 1
    v_mfma_f32_16x16x32_bf16 v[68:71], v[60:63], v[96:99], 0
    v_mfma_f32_16x16x32_bf16 v[72:75], v[64:67], v[96:99], 0
    v_mfma_f32_16x16x32_bf16 v[76:79], v[96:99], v[96:99], 0
    s_cmp_lg_u32 s96, 0
    v_pk_add_f32 v[84:85], v[84:85], v[86:87]
    v_pk_add_f32 v[86:87], v[88:89], v[90:91]
    s_cbranch_scc1 rec_slow_18
    s_mov_b64 exec, s[42:43]
    s_nop 0
    buffer_store_dwordx4 v[68:71], v19, s[4:7], s36 offen
    buffer_store_dwordx4 v[72:75], v19, s[4:7], s36 offen offset:128
    s_mov_b64 exec, s[46:47]
    buffer_store_dwordx4 v[76:79], v20, s[4:7], s36 offen offset:1024
    s_mov_b64 exec, -1
rec_slowr_19:
    ds_write_b128 v17, v[84:87]
    ds_write_b128 v16, v[96:99] offset:15360
    s_waitcnt lgkmcnt(0)
    s_barrier
    ds_read_b64 v[100:101], v25 offset:0
    ds_read_b64 v[102:103], v25 offset:128
    ds_read_b64 v[104:105], v25 offset:1024
    ds_read_b64 v[106:107], v25 offset:1152
    ds_read_b64 v[108:109], v25 offset:2048
    ds_read_b64 v[110:111], v25 offset:2176
    ds_read_b64 v[112:113], v25 offset:3072
    ds_read_b64 v[114:115], v25 offset:3200
    v_mov_b32_dpp v68, v72 row_ror:8 row_mask:0xf bank_mask:0xc
    v_mov_b32_dpp v69, v73 row_ror:8 row_mask:0xf bank_mask:0xc
    v_mov_b32_dpp v70, v74 row_ror:8 row_mask:0xf bank_mask:0xc
    v_mov_b32_dpp v71, v75 row_ror:8 row_mask:0xf bank_mask:0xc
    buffer_load_dwordx4 v[176:179], v21, s[4:7], s36 offen offset:1024 sc1
    buffer_load_dwordx4 v[164:167], v22, s[4:7], s36 offen sc1
    buffer_load_dwordx4 v[168:171], v23, s[4:7], s36 offen sc1
    buffer_load_dwordx4 v[172:175], v24, s[4:7], s36 offen sc1
    s_waitcnt lgkmcnt(0)
    v_pk_add_f32 v[100:101], v[100:101], v[104:105]
    v_pk_add_f32 v[102:103], v[102:103], v[106:107]
    v_pk_add_f32 v[108:109], v[108:109], v[112:113]
    v_pk_add_f32 v[110:111], v[110:111], v[114:115]
    v_pk_add_f32 v[100:101], v[100:101], v[108:109]
    v_pk_add_f32 v[102:103], v[102:103], v[110:111]
    v_cvt_pk_bf16_f32 v138, v100, v101
    v_cvt_pk_bf16_f32 v140, v102, v103
    s_nop 15
    buffer_load_dwordx4 v[48:51], v21, s[4:7], s36 offen offset:1024 sc1
    buffer_load_dwordx4 v[36:39], v22, s[4:7], s36 offen sc1
    buffer_load_dwordx4 v[40:43], v23, s[4:7], s36 offen sc1
    buffer_load_dwordx4 v[44:47], v24, s[4:7], s36 offen sc1
    s_cmp_eq_u32 s32, 63
    s_cbranch_scc1 rec_b2_16
    s_waitcnt vmcnt(7)
    v_permlane32_swap_b32 v176, v178
    v_permlane32_swap_b32 v177, v179
    v_pk_add_f32 v[124:125], v[176:177], v[178:179]
    s_waitcnt vmcnt(6)
    v_pk_add_f32 v[120:121], v[68:69], v[164:165]
    v_pk_add_f32 v[122:123], v[70:71], v[166:167]
    v_permlane16_swap_b32 v124, v125
    s_waitcnt vmcnt(5)
    v_pk_add_f32 v[120:121], v[120:121], v[168:169]
    v_pk_add_f32 v[122:123], v[122:123], v[170:171]
    v_add_f32 v124, v124, v125
    s_waitcnt vmcnt(4)
    v_pk_add_f32 v[120:121], v[120:121], v[172:173]
    v_pk_add_f32 v[122:123], v[122:123], v[174:175]
    v_maximum3_f32 v135, v120, v121, v124
    v_maximum3_f32 v135, v135, v122, v123
    v_cmp_u_f32 vcc, v135, v135
    s_nop 0
    v_max_f32_dpp v135, v135, v135 row_ror:8 row_mask:0xf bank_mask:0xf
    v_mov_b32 v136, v135
    s_cbranch_vccnz rec_gbr_20
rec_gbo_21:
    buffer_store_dword v134, v132, s[4:7], 0 offen sc1
    v_permlane16_swap_b32 v135, v136
    v_max_f32 v135, v135, v136
    v_mov_b32 v136, v135
    s_nop 1
    v_permlane32_swap_b32 v135, v136
    v_max_f32 v135, v135, v136
    v_mul_f32 v135, s50, v135
    v_fma_f32 v124, v124, s50, -v135
    v_fma_f32 v120, v120, s50, -v135
    v_fma_f32 v121, v121, s50, -v135
    v_fma_f32 v122, v122, s50, -v135
    v_fma_f32 v123, v123, s50, -v135
    v_exp_f32 v124, v124
    v_exp_f32 v120, v120
    v_exp_f32 v121, v121
    v_exp_f32 v122, v122
    v_exp_f32 v123, v123
    v_mov_b32_dpp v125, v124 row_ror:8 row_mask:0xf bank_mask:0xf
    v_cvt_pk_bf16_f32 v156, v120, v121
    v_cvt_pk_bf16_f32 v157, v122, v123
    v_cvt_pk_bf16_f32 v160, v124, v125
    v_mov_b32_dpp v158, v156 row_ror:8 row_mask:0xf bank_mask:0xf
    v_mov_b32_dpp v159, v157 row_ror:8 row_mask:0xf bank_mask:0xf
    v_mfma_f32_16x16x32_bf16 v[116:119], v[32:35], v[160:163], 0
    s_nop 0
    v_mfma_f32_16x16x32_bf16 v[116:119], v[32:35], v[156:159], v[116:119]
    v_mfma_f32_16x16x32_bf16 v[108:111], v[52:55], v[156:159], 0
    v_mfma_f32_16x16x32_bf16 v[108:111], v[138:141], v[160:163], v[108:111]
    v_mfma_f32_16x16x32_bf16 v[112:115], v[56:59], v[156:159], 0
    v_mfma_f32_16x16x32_bf16 v[112:115], v[140:143], v[160:163], v[112:115]
    s_nop 3
    v_rcp_f32 v100, v116
    s_nop 0
    v_mov_b32 v101, v100
    v_pk_mul_f32 v[108:109], v[108:109], v[100:101]
    v_pk_mul_f32 v[110:111], v[110:111], v[100:101]
    v_pk_mul_f32 v[112:113], v[112:113], v[100:101]
    v_pk_mul_f32 v[114:115], v[114:115], v[100:101]
    v_cvt_pk_bf16_f32 v108, v108, v109
    v_cvt_pk_bf16_f32 v109, v110, v111
    v_cvt_pk_bf16_f32 v110, v112, v113
    v_cvt_pk_bf16_f32 v111, v114, v115
    v_max_u32 v108, 1, v108
    v_max_u32 v109, 1, v109
    v_max_u32 v110, 1, v110
    v_max_u32 v111, 1, v111
    s_mov_b64 exec, s[42:43]
    buffer_store_dwordx4 v[108:111], v27, s[4:7], s33 offen sc1
    s_mov_b64 exec, -1
    v_mov_b32 v68, 0
    v_mov_b32 v69, 0
    v_mov_b32 v70, 0
    v_mov_b32 v71, 0
    v_mov_b32 v72, 0
    v_mov_b32 v73, 0
    v_mov_b32 v74, 0
    v_mov_b32 v75, 0
rec_cs_23:
    s_barrier
    buffer_load_dwordx4 v[36:39], v12, s[4:7], s33 offen offset:0 sc1
    s_nop 3
    buffer_load_dwordx4 v[40:43], v12, s[4:7], s33 offen offset:1024 sc1
    s_nop 3
    buffer_load_dwordx4 v[44:47], v12, s[4:7], s33 offen offset:2048 sc1
    s_nop 3
    buffer_load_dwordx4 v[48:51], v12, s[4:7], s33 offen offset:3072 sc1
    s_nop 3
    buffer_load_dwordx4 v[52:55], v13, s[4:7], s33 offen offset:0 sc1
    s_nop 3
    buffer_load_dwordx4 v[56:59], v13, s[4:7], s33 offen offset:1024 sc1
    s_nop 3
    buffer_load_dwordx4 v[60:63], v13, s[4:7], s33 offen offset:2048 sc1
    s_nop 3
    buffer_load_dwordx4 v[64:67], v13, s[4:7], s33 offen offset:3072 sc1
    s_waitcnt vmcnt(7)
    v_smfmac_f32_16x16x64_bf16 v[68:71], v[36:39], a[192:199], v5
    v_min_u32 v31, v36, v37
    v_smfmac_f32_16x16x64_bf16 v[72:75], v[36:39], a[200:207], v5
    v_min_u32 v4, v38, v39
    s_add_u32 s38, s32, 1
    s_cmp_gt_u32 s94, s38
    s_cbranch_scc0 rec_kv_26
rec_kvd_27:
    s_xor_b32 s51, s51, 4096
    s_add_u32 m0, s51, s3
    s_add_u32 s37, s37, 262144
    buffer_load_dwordx4 v30, s[4:7], s37 offen sc1 lds
    s_waitcnt vmcnt(7)
    v_smfmac_f32_16x16x64_bf16 v[68:71], v[40:43], a[208:215], v5
    v_min3_u32 v31, v31, v40, v41
    v_smfmac_f32_16x16x64_bf16 v[72:75], v[40:43], a[216:223], v5
    v_min3_u32 v4, v4, v42, v43
    buffer_load_dword v3, v92, s[4:7], s36 offen sc1
    s_waitcnt vmcnt(7)
    v_smfmac_f32_16x16x64_bf16 v[68:71], v[44:47], a[224:231], v5
    v_min3_u32 v31, v31, v44, v45
    v_smfmac_f32_16x16x64_bf16 v[72:75], v[44:47], a[232:239], v5
    v_min3_u32 v4, v4, v46, v47
    s_waitcnt vmcnt(6)
    v_smfmac_f32_16x16x64_bf16 v[68:71], v[48:51], a[240:247], v5
    v_min3_u32 v31, v31, v48, v49
    v_smfmac_f32_16x16x64_bf16 v[72:75], v[48:51], a[248:255], v5
    v_min3_u32 v4, v4, v50, v51
    s_waitcnt vmcnt(5)
    v_smfmac_f32_16x16x64_bf16 v[68:71], v[52:55], v[192:199], v5
    v_min3_u32 v31, v31, v52, v53
    v_smfmac_f32_16x16x64_bf16 v[72:75], v[52:55], v[200:207], v5
    v_min3_u32 v4, v4, v54, v55
    s_waitcnt vmcnt(4)
    v_smfmac_f32_16x16x64_bf16 v[68:71], v[56:59], v[208:215], v5
    v_min3_u32 v31, v31, v56, v57
    v_smfmac_f32_16x16x64_bf16 v[72:75], v[56:59], v[216:223], v5
    v_min3_u32 v4, v4, v58, v59
    s_waitcnt vmcnt(3)
    v_smfmac_f32_16x16x64_bf16 v[68:71], v[60:63], v[224:231], v5
    v_min3_u32 v31, v31, v60, v61
    v_smfmac_f32_16x16x64_bf16 v[72:75], v[60:63], v[232:239], v5
    v_min3_u32 v4, v4, v62, v63
    v_min_u32 v31, v31, v4
    s_waitcnt vmcnt(2)
    v_min3_u32 v31, v31, v64, v65
    v_smfmac_f32_16x16x64_bf16 v[68:71], v[64:67], v[240:247], v5
    v_min3_u32 v31, v31, v66, v67
    v_smfmac_f32_16x16x64_bf16 v[72:75], v[64:67], v[248:255], v5
    v_cmp_eq_u32 vcc, 0, v31
    s_add_u32 s32, s32, 1
    s_add_u32 s38, s32, 2
    s_lshr_b32 s39, s38, 3
    s_lshr_b32 s39, s48, s39
    s_cbranch_vccnz rec_gcfix_25
rec_gcok_24:
    s_mov_b32 s33, s34
    s_mov_b32 s34, s35
    s_nop 0
    v_pk_add_f32 v[68:69], v[68:69], v[70:71]
    s_nop 1
    v_add_f32_dpp v68, v72, v74 quad_perm:[0,1,2,3] row_mask:0xc bank_mask:0xf
    v_add_f32_dpp v69, v73, v75 quad_perm:[0,1,2,3] row_mask:0xc bank_mask:0xf
    s_nop 1
    v_permlane32_swap_b32 v68, v69
    v_add_f32 v68, v68, v69
    ds_write_b32 v28, v68
    s_and_b32 s35, s39, 1
    s_lshl_b32 s35, s35, 13
    s_lshl_b32 s40, s38, 18
    s_add_u32 s35, s35, s40
    s_add_u32 s35, s35, s49
    s_add_u32 s36, s36, 262144
    s_cmp_lg_u32 s31, 0
    s_cbranch_scc1 rec_b4_28
    s_waitcnt lgkmcnt(0)
    s_barrier
    ds_read_b64 v[100:101], v29 offset:0
    ds_read_b64 v[102:103], v29 offset:256
    ds_read_b64 v[104:105], v29 offset:512
    ds_read_b64 v[106:107], v29 offset:768
    v_add_u32 v134, 2, v134
    s_waitcnt lgkmcnt(0)
    v_pk_add_f32 v[100:101], v[100:101], v[102:103]
    v_pk_add_f32 v[104:105], v[104:105], v[106:107]
    v_pk_add_f32 v[100:101], v[100:101], v[104:105]
    v_cvt_pk_bf16_f32 v100, v100, v101
    v_max_u32 v100, 1, v100
    s_nop 1
    v_mov_b32_dpp v101, v100 quad_perm:[1,1,1,1] row_mask:0xf bank_mask:0xf
    v_mov_b32_dpp v102, v100 quad_perm:[2,2,2,2] row_mask:0xf bank_mask:0xf
    v_mov_b32_dpp v103, v100 quad_perm:[3,3,3,3] row_mask:0xf bank_mask:0xf
    s_mov_b64 exec, 0x11111111
    buffer_store_dwordx4 v[100:103], v6, s[4:7], s33 offen sc1
    s_mov_b64 exec, -1
    s_barrier
    buffer_store_dword v189, v188, s[4:7], 0 offen sc1
    buffer_store_dwordx4 v[180:183], v93, s[4:7], s88 offen sc1
    buffer_store_dwordx4 v[144:147], v95, s[4:7], s34 offen sc1
    buffer_store_dwordx4 v[8:11], v94, s[4:7], s36 offen sc1
    v_add_u32 v189, 1, v189
    s_add_u32 s88, s88, 65536
    s_cmp_eq_u32 s31, 3
    s_cselect_b32 s88, s35, s88
    v_mov_b32 v68, 0
    v_mov_b32 v69, 0
    v_mov_b32 v70, 0
    v_mov_b32 v71, 0
    v_mov_b32 v72, 0
    v_mov_b32 v73, 0
    v_mov_b32 v74, 0
    v_mov_b32 v75, 0
    v_mov_b32 v76, 0
    v_mov_b32 v77, 0
    v_mov_b32 v78, 0
    v_mov_b32 v79, 0
    v_mov_b32 v80, 0
    v_mov_b32 v81, 0
    v_mov_b32 v82, 0
    v_mov_b32 v83, 0
    v_mov_b32 v84, 0
    v_mov_b32 v85, 0
    v_mov_b32 v86, 0
    v_mov_b32 v87, 0
    v_mov_b32 v88, 0
    v_mov_b32 v89, 0
    v_mov_b32 v90, 0
    v_mov_b32 v91, 0
    s_waitcnt vmcnt(5)
    s_branch rec_loop_12
rec_b4_28:
    s_waitcnt lgkmcnt(0)
    s_barrier
    buffer_store_dword v134, v133, s[4:7], 0 offen sc1
    v_add_u32 v134, 2, v134
    v_mov_b32 v68, 0
    v_mov_b32 v69, 0
    v_mov_b32 v70, 0
    v_mov_b32 v71, 0
    v_mov_b32 v72, 0
    v_mov_b32 v73, 0
    v_mov_b32 v74, 0
    v_mov_b32 v75, 0
    v_mov_b32 v76, 0
    v_mov_b32 v77, 0
    v_mov_b32 v78, 0
    v_mov_b32 v79, 0
    v_mov_b32 v80, 0
    v_mov_b32 v81, 0
    v_mov_b32 v82, 0
    v_mov_b32 v83, 0
    v_mov_b32 v84, 0
    v_mov_b32 v85, 0
    v_mov_b32 v86, 0
    v_mov_b32 v87, 0
    v_mov_b32 v88, 0
    v_mov_b32 v89, 0
    v_mov_b32 v90, 0
    v_mov_b32 v91, 0
    s_barrier
    buffer_store_dword v189, v188, s[4:7], 0 offen sc1
    buffer_store_dwordx4 v[180:183], v93, s[4:7], s88 offen sc1
    buffer_store_dwordx4 v[144:147], v95, s[4:7], s34 offen sc1
    buffer_store_dwordx4 v[8:11], v94, s[4:7], s36 offen sc1
    v_add_u32 v189, 1, v189
    s_add_u32 s88, s88, 65536
    s_cmp_eq_u32 s31, 3
    s_cselect_b32 s88, s35, s88
    s_waitcnt vmcnt(5)
    s_cmp_lg_u32 s31, 3
    s_cbranch_scc1 rec_loop_12
    s_add_u32 s40, s55, 128
rec_tk_29:
    s_load_dwordx8 s[72:79], s[90:91], s40 glc
    s_add_u32 s41, s41, 1
    s_cmp_ge_u32 s41, 0x80000
    s_cbranch_scc1 rec_tkd_30
    s_sleep 1
    s_min_u32 s38, s72, s76
    s_cmp_lt_u32 s38, s54
    s_cbranch_scc1 rec_tk_29
rec_tkd_30:
    s_add_u32 s54, s54, 1
    s_branch rec_loop_12
rec_kv_9:
    s_load_dword s94, s[90:91], s95 glc
    s_add_u32 s41, s41, 1
    s_cmp_ge_u32 s41, 0x80000
    s_cbranch_scc1 rec_kvd_10
    s_waitcnt lgkmcnt(0)
    s_cmp_gt_u32 s94, 0
    s_cbranch_scc1 rec_kvd_10
    s_sleep 2
    s_branch rec_kv_9
rec_gafix_15:
    s_add_u32 s41, s41, 1
    s_cmp_ge_u32 s41, 0x80000
    s_cbranch_scc1 rec_gaok_14
    buffer_load_dwordx4 v[36:39], v7, s[4:7], s33 offen offset:0 sc1
    buffer_load_dwordx4 v[40:43], v7, s[4:7], s33 offen offset:1024 sc1
    buffer_load_dwordx4 v[44:47], v7, s[4:7], s33 offen offset:2048 sc1
    buffer_load_dwordx4 v[48:51], v7, s[4:7], s33 offen offset:3072 sc1
    v_mov_b32 v68, 0
    v_mov_b32 v69, 0
    v_mov_b32 v70, 0
    v_mov_b32 v71, 0
    v_mov_b32 v72, 0
    v_mov_b32 v73, 0
    v_mov_b32 v74, 0
    v_mov_b32 v75, 0
    v_mov_b32 v76, 0
    v_mov_b32 v77, 0
    v_mov_b32 v78, 0
    v_mov_b32 v79, 0
    v_mov_b32 v80, 0
    v_mov_b32 v81, 0
    v_mov_b32 v82, 0
    v_mov_b32 v83, 0
    s_waitcnt vmcnt(3)
    v_smfmac_f32_16x16x64_bf16 v[68:71], v[36:39], a[0:7], v5
    v_min_u32 v31, v36, v37
    v_smfmac_f32_16x16x64_bf16 v[72:75], v[36:39], a[8:15], v5
    v_min_u32 v4, v38, v39
    v_smfmac_f32_16x16x64_bf16 v[76:79], v[36:39], a[16:23], v5
    v_smfmac_f32_16x16x64_bf16 v[80:83], v[36:39], a[24:31], v5
    s_waitcnt vmcnt(2)
    v_smfmac_f32_16x16x64_bf16 v[68:71], v[40:43], a[48:55], v5
    v_min3_u32 v31, v31, v40, v41
    v_smfmac_f32_16x16x64_bf16 v[72:75], v[40:43], a[56:63], v5
    v_min3_u32 v4, v4, v42, v43
    v_smfmac_f32_16x16x64_bf16 v[76:79], v[40:43], a[64:71], v5
    v_smfmac_f32_16x16x64_bf16 v[80:83], v[40:43], a[72:79], v5
    s_waitcnt vmcnt(1)
    v_smfmac_f32_16x16x64_bf16 v[68:71], v[44:47], a[96:103], v5
    v_min3_u32 v31, v31, v44, v45
    v_smfmac_f32_16x16x64_bf16 v[72:75], v[44:47], a[104:111], v5
    v_min3_u32 v4, v4, v46, v47
    v_smfmac_f32_16x16x64_bf16 v[76:79], v[44:47], a[112:119], v5
    v_min_u32 v31, v31, v4
    v_smfmac_f32_16x16x64_bf16 v[80:83], v[44:47], a[120:127], v5
    s_waitcnt vmcnt(0)
    v_min3_u32 v31, v31, v48, v49
    v_smfmac_f32_16x16x64_bf16 v[68:71], v[48:51], a[144:151], v5
    v_min3_u32 v31, v31, v50, v51
    v_smfmac_f32_16x16x64_bf16 v[72:75], v[48:51], a[152:159], v5
    v_cmp_eq_u32 vcc, 0, v31
    v_smfmac_f32_16x16x64_bf16 v[76:79], v[48:51], a[160:167], v5
    v_smfmac_f32_16x16x64_bf16 v[80:83], v[48:51], a[168:175], v5
    s_cbranch_vccnz rec_gafix_15
    s_branch rec_gaok_14
rec_slow_18:
    s_mov_b64 exec, s[42:43]
    s_nop 0
    buffer_store_dwordx4 v[68:71], v19, s[4:7], s36 offen sc1
    buffer_store_dwordx4 v[72:75], v19, s[4:7], s36 offen offset:128 sc1
    s_mov_b64 exec, s[46:47]
    buffer_store_dwordx4 v[76:79], v20, s[4:7], s36 offen offset:1024 sc1
    s_mov_b64 exec, -1
    s_branch rec_slowr_19
rec_gbr_20:
    v_max3_u32 v31, v164, v165, v166
    v_max3_u32 v31, v31, v167, v168
    v_max3_u32 v31, v31, v169, v170
    v_max3_u32 v31, v31, v171, v172
    v_max3_u32 v31, v31, v173, v174
    v_max3_u32 v31, v31, v175, v176
    v_max3_u32 v31, v31, v177, v178
    v_max_u32 v31, v31, v179
    buffer_load_dwordx4 v[176:179], v21, s[4:7], s36 offen offset:1024 sc1
    buffer_load_dwordx4 v[164:167], v22, s[4:7], s36 offen sc1
    buffer_load_dwordx4 v[168:171], v23, s[4:7], s36 offen sc1
    buffer_load_dwordx4 v[172:175], v24, s[4:7], s36 offen sc1
    v_cmp_eq_u32 vcc, -1, v31
    s_add_u32 s41, s41, 1
    s_cmp_ge_u32 s41, 0x80000
    s_cbranch_scc1 rec_gbo_21
    s_cbranch_vccz rec_gbo_21
    s_waitcnt vmcnt(7)
    v_permlane32_swap_b32 v48, v50
    v_permlane32_swap_b32 v49, v51
    v_pk_add_f32 v[124:125], v[48:49], v[50:51]
    s_waitcnt vmcnt(6)
    v_pk_add_f32 v[120:121], v[68:69], v[36:37]
    v_pk_add_f32 v[122:123], v[70:71], v[38:39]
    v_permlane16_swap_b32 v124, v125
    s_waitcnt vmcnt(5)
    v_pk_add_f32 v[120:121], v[120:121], v[40:41]
    v_pk_add_f32 v[122:123], v[122:123], v[42:43]
    v_add_f32 v124, v124, v125
    s_waitcnt vmcnt(4)
    v_pk_add_f32 v[120:121], v[120:121], v[44:45]
    v_pk_add_f32 v[122:123], v[122:123], v[46:47]
    v_maximum3_f32 v135, v120, v121, v124
    v_maximum3_f32 v135, v135, v122, v123
    v_cmp_u_f32 vcc, v135, v135
    s_nop 0
    v_max_f32_dpp v135, v135, v135 row_ror:8 row_mask:0xf bank_mask:0xf
    v_mov_b32 v136, v135
    s_cbranch_vccz rec_gbo_21
    v_max3_u32 v31, v36, v37, v38
    v_max3_u32 v31, v31, v39, v40
    v_max3_u32 v31, v31, v41, v42
    v_max3_u32 v31, v31, v43, v44
    v_max3_u32 v31, v31, v45, v46
    v_max3_u32 v31, v31, v47, v48
    v_max3_u32 v31, v31, v49, v50
    v_max_u32 v31, v31, v51
    buffer_load_dwordx4 v[48:51], v21, s[4:7], s36 offen offset:1024 sc1
    buffer_load_dwordx4 v[36:39], v22, s[4:7], s36 offen sc1
    buffer_load_dwordx4 v[40:43], v23, s[4:7], s36 offen sc1
    buffer_load_dwordx4 v[44:47], v24, s[4:7], s36 offen sc1
    v_cmp_eq_u32 vcc, -1, v31
    s_add_u32 s41, s41, 1
    s_cmp_ge_u32 s41, 0x80000
    s_cbranch_scc1 rec_gbo_21
    s_cbranch_vccz rec_gbo_21
    s_waitcnt vmcnt(7)
    v_permlane32_swap_b32 v176, v178
    v_permlane32_swap_b32 v177, v179
    v_pk_add_f32 v[124:125], v[176:177], v[178:179]
    s_waitcnt vmcnt(6)
    v_pk_add_f32 v[120:121], v[68:69], v[164:165]
    v_pk_add_f32 v[122:123], v[70:71], v[166:167]
    v_permlane16_swap_b32 v124, v125
    s_waitcnt vmcnt(5)
    v_pk_add_f32 v[120:121], v[120:121], v[168:169]
    v_pk_add_f32 v[122:123], v[122:123], v[170:171]
    v_add_f32 v124, v124, v125
    s_waitcnt vmcnt(4)
    v_pk_add_f32 v[120:121], v[120:121], v[172:173]
    v_pk_add_f32 v[122:123], v[122:123], v[174:175]
    v_maximum3_f32 v135, v120, v121, v124
    v_maximum3_f32 v135, v135, v122, v123
    v_cmp_u_f32 vcc, v135, v135
    s_nop 0
    v_max_f32_dpp v135, v135, v135 row_ror:8 row_mask:0xf bank_mask:0xf
    v_mov_b32 v136, v135
    s_cbranch_vccz rec_gbo_21
    s_branch rec_gbr_20
rec_w1_17:
    s_waitcnt lgkmcnt(0)
    s_barrier
    v_smfmac_f32_16x16x64_bf16 v[84:87], v[36:39], a[32:39], v5
    v_smfmac_f32_16x16x64_bf16 v[88:91], v[36:39], a[40:47], v5
    v_smfmac_f32_16x16x64_bf16 v[84:87], v[40:43], a[80:87], v5
    v_smfmac_f32_16x16x64_bf16 v[88:91], v[40:43], a[88:95], v5
    v_smfmac_f32_16x16x64_bf16 v[84:87], v[44:47], a[128:135], v5
    v_smfmac_f32_16x16x64_bf16 v[88:91], v[44:47], a[136:143], v5
    v_smfmac_f32_16x16x64_bf16 v[84:87], v[48:51], a[176:183], v5
    v_smfmac_f32_16x16x64_bf16 v[88:91], v[48:51], a[184:191], v5
    s_nop 6
    v_pk_add_f32 v[84:85], v[84:85], v[86:87]
    v_pk_add_f32 v[86:87], v[88:89], v[90:91]
    ds_write_b128 v17, v[84:87]
    s_waitcnt lgkmcnt(0)
    s_barrier
    v_mov_b32 v68, 0
    v_mov_b32 v69, 0
    v_mov_b32 v70, 0
    v_mov_b32 v71, 0
    v_mov_b32 v72, 0
    v_mov_b32 v73, 0
    v_mov_b32 v74, 0
    v_mov_b32 v75, 0
    s_cmp_eq_u32 s31, 3
    s_cbranch_scc1 rec_w3_32
    s_cmp_eq_u32 s31, 2
    s_cbranch_scc1 rec_w2_31
    ds_read_b128 v[180:183], v16 offset:15360
    s_branch rec_b2_16
rec_w2_31:
    ds_read_b128 v[100:103], v16 offset:10240
    ds_read_b128 v[104:107], v16 offset:11264
    ds_read_b128 v[108:111], v16 offset:12288
    ds_read_b128 v[112:115], v16 offset:13312
    s_waitcnt lgkmcnt(0)
    v_pk_add_f32 v[100:101], v[100:101], v[104:105]
    v_pk_add_f32 v[102:103], v[102:103], v[106:107]
    v_pk_add_f32 v[108:109], v[108:109], v[112:113]
    v_pk_add_f32 v[110:111], v[110:111], v[114:115]
    v_pk_add_f32 v[100:101], v[100:101], v[108:109]
    v_pk_add_f32 v[102:103], v[102:103], v[110:111]
    v_cvt_pk_bf16_f32 v180, v100, v101
    v_cvt_pk_bf16_f32 v181, v102, v103
    s_nop 0
    v_permlane32_swap_b32 v180, v182
    v_permlane32_swap_b32 v181, v183
    s_nop 1
    v_permlane16_swap_b32 v180, v181
    v_permlane16_swap_b32 v182, v183
rec_b2_16:
    s_waitcnt lgkmcnt(0)
    s_cmp_eq_u32 s32, 63
    s_cbranch_scc1 rec_done_13
    s_branch rec_cs_23
rec_w3_32:
    s_cmp_eq_u32 s32, 63
    s_cbranch_scc1 rec_done_13
rec_tk_33:
    s_load_dwordx8 s[72:79], s[90:91], s55 glc
    s_add_u32 s41, s41, 1
    s_cmp_ge_u32 s41, 0x80000
    s_cbranch_scc1 rec_tkd_34
    s_sleep 1
    s_min_u32 s38, s72, s76
    s_cmp_lt_u32 s38, s54
    s_cbranch_scc1 rec_tk_33
rec_tkd_34:
    s_add_u32 s54, s54, 1
    s_branch rec_cs_23
rec_kv_26:
    s_load_dword s94, s[90:91], s95 glc
    s_add_u32 s41, s41, 1
    s_cmp_ge_u32 s41, 0x80000
    s_cbranch_scc1 rec_kvd_27
    s_waitcnt lgkmcnt(0)
    s_cmp_gt_u32 s94, s38
    s_cbranch_scc1 rec_kvd_27
    s_sleep 2
    s_branch rec_kv_26
rec_gcfix_25:
    s_add_u32 s41, s41, 1
    s_cmp_ge_u32 s41, 0x80000
    s_cbranch_scc1 rec_gcok_24
    buffer_load_dwordx4 v[36:39], v12, s[4:7], s33 offen offset:0 sc1
    buffer_load_dwordx4 v[40:43], v12, s[4:7], s33 offen offset:1024 sc1
    buffer_load_dwordx4 v[44:47], v12, s[4:7], s33 offen offset:2048 sc1
    buffer_load_dwordx4 v[48:51], v12, s[4:7], s33 offen offset:3072 sc1
    buffer_load_dwordx4 v[52:55], v13, s[4:7], s33 offen offset:0 sc1
    buffer_load_dwordx4 v[56:59], v13, s[4:7], s33 offen offset:1024 sc1
    buffer_load_dwordx4 v[60:63], v13, s[4:7], s33 offen offset:2048 sc1
    buffer_load_dwordx4 v[64:67], v13, s[4:7], s33 offen offset:3072 sc1
    v_mov_b32 v68, 0
    v_mov_b32 v69, 0
    v_mov_b32 v70, 0
    v_mov_b32 v71, 0
    v_mov_b32 v72, 0
    v_mov_b32 v73, 0
    v_mov_b32 v74, 0
    v_mov_b32 v75, 0
    s_waitcnt vmcnt(7)
    v_smfmac_f32_16x16x64_bf16 v[68:71], v[36:39], a[192:199], v5
    v_min_u32 v31, v36, v37
    v_smfmac_f32_16x16x64_bf16 v[72:75], v[36:39], a[200:207], v5
    v_min_u32 v4, v38, v39
    s_waitcnt vmcnt(6)
    v_smfmac_f32_16x16x64_bf16 v[68:71], v[40:43], a[208:215], v5
    v_min3_u32 v31, v31, v40, v41
    v_smfmac_f32_16x16x64_bf16 v[72:75], v[40:43], a[216:223], v5
    v_min3_u32 v4, v4, v42, v43
    s_waitcnt vmcnt(5)
    v_smfmac_f32_16x16x64_bf16 v[68:71], v[44:47], a[224:231], v5
    v_min3_u32 v31, v31, v44, v45
    v_smfmac_f32_16x16x64_bf16 v[72:75], v[44:47], a[232:239], v5
    v_min3_u32 v4, v4, v46, v47
    s_waitcnt vmcnt(4)
    v_smfmac_f32_16x16x64_bf16 v[68:71], v[48:51], a[240:247], v5
    v_min3_u32 v31, v31, v48, v49
    v_smfmac_f32_16x16x64_bf16 v[72:75], v[48:51], a[248:255], v5
    v_min3_u32 v4, v4, v50, v51
    s_waitcnt vmcnt(3)
    v_smfmac_f32_16x16x64_bf16 v[68:71], v[52:55], v[192:199], v5
    v_min3_u32 v31, v31, v52, v53
    v_smfmac_f32_16x16x64_bf16 v[72:75], v[52:55], v[200:207], v5
    v_min3_u32 v4, v4, v54, v55
    s_waitcnt vmcnt(2)
    v_smfmac_f32_16x16x64_bf16 v[68:71], v[56:59], v[208:215], v5
    v_min3_u32 v31, v31, v56, v57
    v_smfmac_f32_16x16x64_bf16 v[72:75], v[56:59], v[216:223], v5
    v_min3_u32 v4, v4, v58, v59
    s_waitcnt vmcnt(1)
    v_smfmac_f32_16x16x64_bf16 v[68:71], v[60:63], v[224:231], v5
    v_min3_u32 v31, v31, v60, v61
    v_smfmac_f32_16x16x64_bf16 v[72:75], v[60:63], v[232:239], v5
    v_min3_u32 v4, v4, v62, v63
    v_min_u32 v31, v31, v4
    s_waitcnt vmcnt(0)
    v_min3_u32 v31, v31, v64, v65
    v_smfmac_f32_16x16x64_bf16 v[68:71], v[64:67], v[240:247], v5
    v_min3_u32 v31, v31, v66, v67
    v_smfmac_f32_16x16x64_bf16 v[72:75], v[64:67], v[248:255], v5
    v_cmp_eq_u32 vcc, 0, v31
    s_cbranch_vccnz rec_gcfix_25
    s_branch rec_gcok_24
rec_done_13:
    buffer_store_dwordx4 v[180:183], v93, s[4:7], s88 offen sc1
    s_waitcnt vmcnt(0)
    s_barrier
    v_add_u32 v189, 1, v189
    buffer_store_dword v189, v188, s[4:7], 0 offen sc1
    s_endpgm
L_gem:
    s_mov_b32 s6, L_end - L_gem - 16
    s_getpc_b64 s[4:5]
    v_lshlrev_b32 v1, 7, v0
    v_min_u32 v2, s6, v1
    global_load_dword v250, v2, s[4:5]
    v_add_u32 v1, 32768, v1
    v_min_u32 v2, s6, v1
    global_load_dword v251, v2, s[4:5]
    v_add_u32 v1, 32768, v1
    s_load_dwordx2 s[90:91], s[0:1], 96
    s_load_dwordx2 s[92:93], s[0:1], 88
    v_and_b32 v1, 63, v0
    v_lshrrev_b32 v2, 6, v0
    s_nop 0
    v_readfirstlane_b32 s29, v2
    v_lshlrev_b32 v5, 4, v1
    s_mov_b32 s41, 0
    s_lshl_b32 s34, s29, 10
    s_waitcnt lgkmcnt(0)
    s_mov_b32 s4, s90
    s_and_b32 s5, s91, 0xffff
    s_mov_b32 s6, 268435456
    s_mov_b32 s7, 0x00020000
    s_cmp_ge_u32 s28, 120
    s_cbranch_scc1 L_att
    s_cmp_ge_u32 s28, 96
    s_cbranch_scc1 sl_b_35
    s_lshr_b32 s31, s28, 5
    s_add_u32 s31, s31, 1
    s_cmp_eq_u32 s31, 3
    s_cselect_b32 s44, 0, s31
    s_lshl_b32 s31, s44, 3
    s_add_u32 s31, s31, 16
    s_load_dwordx2 s[72:73], s[0:1], s31
    s_load_dwordx2 s[74:75], s[0:1], 0
    s_mov_b32 s76, 8388608
    s_mov_b32 s39, 8192
    s_and_b32 s31, s28, 31
    s_lshl_b32 s31, s31, 8
    s_lshl_b32 s36, s44, 24
    s_and_b32 s33, s28, 31
    s_lshl_b32 s33, s33, 13
    s_add_u32 s36, s36, s33
    s_mov_b32 s37, 262144
    s_and_b32 s50, s28, 31
    s_lshl_b32 s50, s50, 7
    s_lshl_b32 s33, s44, 2
    s_add_u32 s50, s50, s33
    s_add_u32 s50, s50, 115343360
    s_branch sl_c_36
sl_b_35:
    s_sub_u32 s32, s28, 96
    s_lshr_b32 s44, s32, 3
    s_load_dwordx2 s[72:73], s[0:1], 64
    s_load_dwordx2 s[74:75], s[0:1], 56
    s_mov_b32 s76, 6291456
    s_mov_b32 s39, 6144
    s_lshl_b32 s31, s32, 8
    s_lshl_b32 s36, s44, 22
    s_and_b32 s33, s32, 7
    s_lshl_b32 s33, s33, 13
    s_add_u32 s36, s36, s33
    s_add_u32 s36, s36, 50331648
    s_mov_b32 s37, 65536
    s_and_b32 s50, s32, 7
    s_lshl_b32 s50, s50, 7
    s_lshl_b32 s33, s44, 2
    s_add_u32 s50, s50, s33
    s_add_u32 s50, s50, 115347456
sl_c_36:
    s_waitcnt lgkmcnt(0)
    s_cmp_lg_u32 s29, 0
    s_cbranch_scc1 sl_i_37
    v_mov_b32 v2, 0
    s_mov_b64 exec, 1
    buffer_store_dword v2, v2, s[4:7], s50 offen sc1
    s_mov_b64 exec, -1
sl_i_37:
    s_mov_b32 s8, s72
    s_and_b32 s9, s73, 0xffff
    s_mov_b32 s10, s76
    s_mov_b32 s11, 0x00020000
    s_mov_b32 s12, s74
    s_and_b32 s13, s75, 0xffff
    s_mov_b32 s14, 4194304
    s_mov_b32 s15, 0x00020000
    s_mov_b64 s[80:81], s[72:73]
    s_mov_b32 s45, s31
    s_cmp_lt_u32 s28, 96
    s_cbranch_scc1 sl_go_38
    s_cmp_lg_u32 s29, 0
    s_cbranch_scc1 sl_a2_39
    s_mov_b64 exec, 1
    v_mov_b32 v2, 0
    v_mov_b32 v3, 1
    s_waitcnt vmcnt(0)
    global_atomic_add v2, v3, s[92:93] offset:0 sc1
    s_mov_b64 exec, -1
sl_a2_39:
    s_cmp_lt_u32 s28, 96
    s_cbranch_scc1 tw_skip_40
    s_load_dwordx2 s[72:73], s[0:1], 40
    s_and_b32 s31, s28, 31
    s_lshl_b32 s31, s31, 13
    s_lshl_b32 s33, s29, 21
    s_add_u32 s31, s31, s33
    v_lshl_add_u32 v2, v1, 7, s31
    s_waitcnt lgkmcnt(0)
    s_mov_b32 s8, s72
    s_and_b32 s9, s73, 0xffff
    s_mov_b32 s10, 8388608
    s_mov_b32 s11, 0x00020000
    s_mov_b32 s31, 0
    buffer_load_dword v128, v2, s[8:11], s31 offen
    s_mov_b32 s31, 262144
    buffer_load_dword v129, v2, s[8:11], s31 offen
    s_mov_b32 s31, 524288
    buffer_load_dword v130, v2, s[8:11], s31 offen
    s_mov_b32 s31, 786432
    buffer_load_dword v131, v2, s[8:11], s31 offen
    s_mov_b32 s31, 1048576
    buffer_load_dword v132, v2, s[8:11], s31 offen
    s_mov_b32 s31, 1310720
    buffer_load_dword v133, v2, s[8:11], s31 offen
    s_mov_b32 s31, 1572864
    buffer_load_dword v134, v2, s[8:11], s31 offen
    s_mov_b32 s31, 1835008
    buffer_load_dword v135, v2, s[8:11], s31 offen
tw_skip_40:
    s_mov_b32 s8, s80
    s_and_b32 s9, s81, 0xffff
    s_mov_b32 s10, s76
    s_mov_b32 s11, 0x00020000
    s_cmp_lg_u32 s29, 0
    s_cbranch_scc1 g_wdd_42
g_wd_41:
    s_load_dword s84, s[92:93], 128 glc
    s_add_u32 s41, s41, 1
    s_cmp_ge_u32 s41, 0x200000
    s_cbranch_scc1 g_wdd_42
    s_waitcnt lgkmcnt(0)
    s_and_b32 s84, s84, 0xffff
    s_cmp_ge_u32 s84, 96
    s_cbranch_scc1 g_wdd_42
    s_sleep 32
    s_branch g_wd_41
g_wdd_42:
    s_waitcnt lgkmcnt(0)
    s_barrier
sl_go_38:
    v_lshrrev_b32 v2, 2, v1
    v_mul_lo_u32 v6, v2, s39
    s_mov_b32 s31, s45
    s_lshl_b32 s33, s29, 6
    s_add_u32 s31, s31, s33
    v_and_b32 v2, 3, v1
    v_lshlrev_b32 v2, 4, v2
    v_add_u32 v2, s31, v2
    v_add_u32 v6, v6, v2
    s_lshl_b32 s39, s39, 4
    s_mov_b32 s30, 0
    s_mov_b32 s51, 64
    s_mov_b32 s52, 4128768
    s_lshl_b32 s31, s29, 15
    v_lshrrev_b32 v7, 4, v1
    v_lshlrev_b32 v7, 9, v7
    v_bfe_u32 v4, v1, 2, 2
    v_lshl_add_u32 v7, v4, 6, v7
    v_bfe_u32 v4, v1, 1, 1
    v_lshl_add_u32 v7, v4, 5, v7
    v_and_b32 v4, 1, v1
    v_lshl_add_u32 v7, v4, 3, v7
    v_add_u32 v7, s31, v7
    s_lshl_b32 s32, s29, 15
    s_add_u32 m0, s32, 0
    s_mov_b32 s38, 0
    buffer_load_dwordx4 v6, s[8:11], s38 offen lds
    s_add_u32 m0, s32, 1024
    s_add_u32 s38, s38, s39
    buffer_load_dwordx4 v6, s[8:11], s38 offen lds
    s_add_u32 m0, s32, 2048
    s_add_u32 s38, s38, s39
    buffer_load_dwordx4 v6, s[8:11], s38 offen lds
    s_add_u32 m0, s32, 3072
    s_add_u32 s38, s38, s39
    buffer_load_dwordx4 v6, s[8:11], s38 offen lds
    s_add_u32 m0, s32, 4096
    s_add_u32 s38, s38, s39
    buffer_load_dwordx4 v6, s[8:11], s38 offen lds
    s_add_u32 m0, s32, 5120
    s_add_u32 s38, s38, s39
    buffer_load_dwordx4 v6, s[8:11], s38 offen lds
    s_add_u32 m0, s32, 6144
    s_add_u32 s38, s38, s39
    buffer_load_dwordx4 v6, s[8:11], s38 offen lds
    s_add_u32 m0, s32, 7168
    s_add_u32 s38, s38, s39
    buffer_load_dwordx4 v6, s[8:11], s38 offen lds
    s_add_u32 m0, s32, 8192
    s_add_u32 s38, s38, s39
    buffer_load_dwordx4 v6, s[8:11], s38 offen lds
    s_add_u32 m0, s32, 9216
    s_add_u32 s38, s38, s39
    buffer_load_dwordx4 v6, s[8:11], s38 offen lds
    s_add_u32 m0, s32, 10240
    s_add_u32 s38, s38, s39
    buffer_load_dwordx4 v6, s[8:11], s38 offen lds
    s_add_u32 m0, s32, 11264
    s_add_u32 s38, s38, s39
    buffer_load_dwordx4 v6, s[8:11], s38 offen lds
    s_add_u32 m0, s32, 12288
    s_add_u32 s38, s38, s39
    buffer_load_dwordx4 v6, s[8:11], s38 offen lds
    s_add_u32 m0, s32, 13312
    s_add_u32 s38, s38, s39
    buffer_load_dwordx4 v6, s[8:11], s38 offen lds
    s_add_u32 m0, s32, 14336
    s_add_u32 s38, s38, s39
    buffer_load_dwordx4 v6, s[8:11], s38 offen lds
    s_add_u32 m0, s32, 15360
    s_add_u32 s38, s38, s39
    buffer_load_dwordx4 v6, s[8:11], s38 offen lds
    s_add_u32 m0, s32, 16384
    s_add_u32 s38, s38, s39
    buffer_load_dwordx4 v6, s[8:11], s38 offen lds
    s_add_u32 m0, s32, 17408
    s_add_u32 s38, s38, s39
    buffer_load_dwordx4 v6, s[8:11], s38 offen lds
    s_add_u32 m0, s32, 18432
    s_add_u32 s38, s38, s39
    buffer_load_dwordx4 v6, s[8:11], s38 offen lds
    s_add_u32 m0, s32, 19456
    s_add_u32 s38, s38, s39
    buffer_load_dwordx4 v6, s[8:11], s38 offen lds
    s_add_u32 m0, s32, 20480
    s_add_u32 s38, s38, s39
    buffer_load_dwordx4 v6, s[8:11], s38 offen lds
    s_add_u32 m0, s32, 21504
    s_add_u32 s38, s38, s39
    buffer_load_dwordx4 v6, s[8:11], s38 offen lds
    s_add_u32 m0, s32, 22528
    s_add_u32 s38, s38, s39
    buffer_load_dwordx4 v6, s[8:11], s38 offen lds
    s_add_u32 m0, s32, 23552
    s_add_u32 s38, s38, s39
    buffer_load_dwordx4 v6, s[8:11], s38 offen lds
    s_add_u32 m0, s32, 24576
    s_add_u32 s38, s38, s39
    buffer_load_dwordx4 v6, s[8:11], s38 offen lds
    s_add_u32 m0, s32, 25600
    s_add_u32 s38, s38, s39
    buffer_load_dwordx4 v6, s[8:11], s38 offen lds
    s_add_u32 m0, s32, 26624
    s_add_u32 s38, s38, s39
    buffer_load_dwordx4 v6, s[8:11], s38 offen lds
    s_add_u32 m0, s32, 27648
    s_add_u32 s38, s38, s39
    buffer_load_dwordx4 v6, s[8:11], s38 offen lds
    s_add_u32 m0, s32, 28672
    s_add_u32 s38, s38, s39
    buffer_load_dwordx4 v6, s[8:11], s38 offen lds
    s_add_u32 m0, s32, 29696
    s_add_u32 s38, s38, s39
    buffer_load_dwordx4 v6, s[8:11], s38 offen lds
    s_add_u32 m0, s32, 30720
    s_add_u32 s38, s38, s39
    buffer_load_dwordx4 v6, s[8:11], s38 offen lds
    s_add_u32 m0, s32, 31744
    s_add_u32 s38, s38, s39
    buffer_load_dwordx4 v6, s[8:11], s38 offen lds
    s_waitcnt vmcnt(30)
    s_cmp_lg_u32 s29, 0
    s_cbranch_scc1 sl_ar_43
    s_cmp_ge_u32 s28, 96
    s_cbranch_scc1 sl_ar_43
    s_mov_b64 exec, 1
    v_mov_b32 v2, 0
    v_mov_b32 v3, 1
    global_atomic_add v2, v3, s[92:93] offset:0 sc1
    s_mov_b64 exec, -1
sl_ar_43:
    ds_read_b64_tr_b16 a[0:1], v7 offset:0
    ds_read_b64_tr_b16 a[2:3], v7 offset:256
    ds_read_b64_tr_b16 a[4:5], v7 offset:16
    ds_read_b64_tr_b16 a[6:7], v7 offset:272
    s_waitcnt vmcnt(28)
    ds_read_b64_tr_b16 a[8:9], v7 offset:2048
    ds_read_b64_tr_b16 a[10:11], v7 offset:2304
    ds_read_b64_tr_b16 a[12:13], v7 offset:2064
    ds_read_b64_tr_b16 a[14:15], v7 offset:2320
    s_waitcnt lgkmcnt(4)
    s_add_u32 m0, s32, 0
    s_add_u32 s38, s38, s39
    buffer_load_dwordx4 v6, s[8:11], s38 offen lds
    s_add_u32 m0, s32, 1024
    s_add_u32 s38, s38, s39
    buffer_load_dwordx4 v6, s[8:11], s38 offen lds
    s_waitcnt vmcnt(28)
    ds_read_b64_tr_b16 a[16:17], v7 offset:4096
    ds_read_b64_tr_b16 a[18:19], v7 offset:4352
    ds_read_b64_tr_b16 a[20:21], v7 offset:4112
    ds_read_b64_tr_b16 a[22:23], v7 offset:4368
    s_waitcnt lgkmcnt(4)
    s_add_u32 m0, s32, 2048
    s_add_u32 s38, s38, s39
    buffer_load_dwordx4 v6, s[8:11], s38 offen lds
    s_add_u32 m0, s32, 3072
    s_add_u32 s38, s38, s39
    buffer_load_dwordx4 v6, s[8:11], s38 offen lds
    s_waitcnt vmcnt(28)
    ds_read_b64_tr_b16 a[24:25], v7 offset:6144
    ds_read_b64_tr_b16 a[26:27], v7 offset:6400
    ds_read_b64_tr_b16 a[28:29], v7 offset:6160
    ds_read_b64_tr_b16 a[30:31], v7 offset:6416
    s_waitcnt lgkmcnt(4)
    s_add_u32 m0, s32, 4096
    s_add_u32 s38, s38, s39
    buffer_load_dwordx4 v6, s[8:11], s38 offen lds
    s_add_u32 m0, s32, 5120
    s_add_u32 s38, s38, s39
    buffer_load_dwordx4 v6, s[8:11], s38 offen lds
    s_waitcnt vmcnt(28)
    ds_read_b64_tr_b16 a[32:33], v7 offset:8192
    ds_read_b64_tr_b16 a[34:35], v7 offset:8448
    ds_read_b64_tr_b16 a[36:37], v7 offset:8208
    ds_read_b64_tr_b16 a[38:39], v7 offset:8464
    s_waitcnt lgkmcnt(4)
    s_add_u32 m0, s32, 6144
    s_add_u32 s38, s38, s39
    buffer_load_dwordx4 v6, s[8:11], s38 offen lds
    s_add_u32 m0, s32, 7168
    s_add_u32 s38, s38, s39
    buffer_load_dwordx4 v6, s[8:11], s38 offen lds
    s_waitcnt vmcnt(28)
    ds_read_b64_tr_b16 a[40:41], v7 offset:10240
    ds_read_b64_tr_b16 a[42:43], v7 offset:10496
    ds_read_b64_tr_b16 a[44:45], v7 offset:10256
    ds_read_b64_tr_b16 a[46:47], v7 offset:10512
    s_waitcnt lgkmcnt(4)
    s_add_u32 m0, s32, 8192
    s_add_u32 s38, s38, s39
    buffer_load_dwordx4 v6, s[8:11], s38 offen lds
    s_add_u32 m0, s32, 9216
    s_add_u32 s38, s38, s39
    buffer_load_dwordx4 v6, s[8:11], s38 offen lds
    s_waitcnt vmcnt(28)
    ds_read_b64_tr_b16 a[48:49], v7 offset:12288
    ds_read_b64_tr_b16 a[50:51], v7 offset:12544
    ds_read_b64_tr_b16 a[52:53], v7 offset:12304
    ds_read_b64_tr_b16 a[54:55], v7 offset:12560
    s_waitcnt lgkmcnt(4)
    s_add_u32 m0, s32, 10240
    s_add_u32 s38, s38, s39
    buffer_load_dwordx4 v6, s[8:11], s38 offen lds
    s_add_u32 m0, s32, 11264
    s_add_u32 s38, s38, s39
    buffer_load_dwordx4 v6, s[8:11], s38 offen lds
    s_waitcnt vmcnt(28)
    ds_read_b64_tr_b16 a[56:57], v7 offset:14336
    ds_read_b64_tr_b16 a[58:59], v7 offset:14592
    ds_read_b64_tr_b16 a[60:61], v7 offset:14352
    ds_read_b64_tr_b16 a[62:63], v7 offset:14608
    s_waitcnt lgkmcnt(4)
    s_add_u32 m0, s32, 12288
    s_add_u32 s38, s38, s39
    buffer_load_dwordx4 v6, s[8:11], s38 offen lds
    s_add_u32 m0, s32, 13312
    s_add_u32 s38, s38, s39
    buffer_load_dwordx4 v6, s[8:11], s38 offen lds
    s_waitcnt vmcnt(28)
    ds_read_b64_tr_b16 a[64:65], v7 offset:16384
    ds_read_b64_tr_b16 a[66:67], v7 offset:16640
    ds_read_b64_tr_b16 a[68:69], v7 offset:16400
    ds_read_b64_tr_b16 a[70:71], v7 offset:16656
    s_waitcnt lgkmcnt(4)
    s_add_u32 m0, s32, 14336
    s_add_u32 s38, s38, s39
    buffer_load_dwordx4 v6, s[8:11], s38 offen lds
    s_add_u32 m0, s32, 15360
    s_add_u32 s38, s38, s39
    buffer_load_dwordx4 v6, s[8:11], s38 offen lds
    s_waitcnt vmcnt(28)
    ds_read_b64_tr_b16 a[72:73], v7 offset:18432
    ds_read_b64_tr_b16 a[74:75], v7 offset:18688
    ds_read_b64_tr_b16 a[76:77], v7 offset:18448
    ds_read_b64_tr_b16 a[78:79], v7 offset:18704
    s_waitcnt lgkmcnt(4)
    s_add_u32 m0, s32, 16384
    s_add_u32 s38, s38, s39
    buffer_load_dwordx4 v6, s[8:11], s38 offen lds
    s_add_u32 m0, s32, 17408
    s_add_u32 s38, s38, s39
    buffer_load_dwordx4 v6, s[8:11], s38 offen lds
    s_waitcnt vmcnt(28)
    ds_read_b64_tr_b16 a[80:81], v7 offset:20480
    ds_read_b64_tr_b16 a[82:83], v7 offset:20736
    ds_read_b64_tr_b16 a[84:85], v7 offset:20496
    ds_read_b64_tr_b16 a[86:87], v7 offset:20752
    s_waitcnt lgkmcnt(4)
    s_add_u32 m0, s32, 18432
    s_add_u32 s38, s38, s39
    buffer_load_dwordx4 v6, s[8:11], s38 offen lds
    s_add_u32 m0, s32, 19456
    s_add_u32 s38, s38, s39
    buffer_load_dwordx4 v6, s[8:11], s38 offen lds
    s_waitcnt vmcnt(28)
    ds_read_b64_tr_b16 a[88:89], v7 offset:22528
    ds_read_b64_tr_b16 a[90:91], v7 offset:22784
    ds_read_b64_tr_b16 a[92:93], v7 offset:22544
    ds_read_b64_tr_b16 a[94:95], v7 offset:22800
    s_waitcnt lgkmcnt(4)
    s_add_u32 m0, s32, 20480
    s_add_u32 s38, s38, s39
    buffer_load_dwordx4 v6, s[8:11], s38 offen lds
    s_add_u32 m0, s32, 21504
    s_add_u32 s38, s38, s39
    buffer_load_dwordx4 v6, s[8:11], s38 offen lds
    s_waitcnt vmcnt(28)
    ds_read_b64_tr_b16 a[96:97], v7 offset:24576
    ds_read_b64_tr_b16 a[98:99], v7 offset:24832
    ds_read_b64_tr_b16 a[100:101], v7 offset:24592
    ds_read_b64_tr_b16 a[102:103], v7 offset:24848
    s_waitcnt lgkmcnt(4)
    s_add_u32 m0, s32, 22528
    s_add_u32 s38, s38, s39
    buffer_load_dwordx4 v6, s[8:11], s38 offen lds
    s_add_u32 m0, s32, 23552
    s_add_u32 s38, s38, s39
    buffer_load_dwordx4 v6, s[8:11], s38 offen lds
    s_waitcnt vmcnt(28)
    ds_read_b64_tr_b16 a[104:105], v7 offset:26624
    ds_read_b64_tr_b16 a[106:107], v7 offset:26880
    ds_read_b64_tr_b16 a[108:109], v7 offset:26640
    ds_read_b64_tr_b16 a[110:111], v7 offset:26896
    s_waitcnt lgkmcnt(4)
    s_add_u32 m0, s32, 24576
    s_add_u32 s38, s38, s39
    buffer_load_dwordx4 v6, s[8:11], s38 offen lds
    s_add_u32 m0, s32, 25600
    s_add_u32 s38, s38, s39
    buffer_load_dwordx4 v6, s[8:11], s38 offen lds
    s_waitcnt vmcnt(28)
    ds_read_b64_tr_b16 a[112:113], v7 offset:28672
    ds_read_b64_tr_b16 a[114:115], v7 offset:28928
    ds_read_b64_tr_b16 a[116:117], v7 offset:28688
    ds_read_b64_tr_b16 a[118:119], v7 offset:28944
    s_waitcnt lgkmcnt(4)
    s_add_u32 m0, s32, 26624
    s_add_u32 s38, s38, s39
    buffer_load_dwordx4 v6, s[8:11], s38 offen lds
    s_add_u32 m0, s32, 27648
    s_add_u32 s38, s38, s39
    buffer_load_dwordx4 v6, s[8:11], s38 offen lds
    s_waitcnt vmcnt(28)
    ds_read_b64_tr_b16 a[120:121], v7 offset:30720
    ds_read_b64_tr_b16 a[122:123], v7 offset:30976
    ds_read_b64_tr_b16 a[124:125], v7 offset:30736
    ds_read_b64_tr_b16 a[126:127], v7 offset:30992
    s_waitcnt lgkmcnt(4)
    s_add_u32 m0, s32, 28672
    s_add_u32 s38, s38, s39
    buffer_load_dwordx4 v6, s[8:11], s38 offen lds
    s_add_u32 m0, s32, 29696
    s_add_u32 s38, s38, s39
    buffer_load_dwordx4 v6, s[8:11], s38 offen lds
    s_waitcnt vmcnt(28)
    ds_read_b64_tr_b16 a[128:129], v7 offset:0
    ds_read_b64_tr_b16 a[130:131], v7 offset:256
    ds_read_b64_tr_b16 a[132:133], v7 offset:16
    ds_read_b64_tr_b16 a[134:135], v7 offset:272
    s_waitcnt lgkmcnt(4)
    s_add_u32 m0, s32, 30720
    s_add_u32 s38, s38, s39
    buffer_load_dwordx4 v6, s[8:11], s38 offen lds
    s_add_u32 m0, s32, 31744
    s_add_u32 s38, s38, s39
    buffer_load_dwordx4 v6, s[8:11], s38 offen lds
    s_waitcnt vmcnt(28)
    ds_read_b64_tr_b16 a[136:137], v7 offset:2048
    ds_read_b64_tr_b16 a[138:139], v7 offset:2304
    ds_read_b64_tr_b16 a[140:141], v7 offset:2064
    ds_read_b64_tr_b16 a[142:143], v7 offset:2320
    s_waitcnt vmcnt(26)
    ds_read_b64_tr_b16 a[144:145], v7 offset:4096
    ds_read_b64_tr_b16 a[146:147], v7 offset:4352
    ds_read_b64_tr_b16 a[148:149], v7 offset:4112
    ds_read_b64_tr_b16 a[150:151], v7 offset:4368
    s_waitcnt vmcnt(24)
    ds_read_b64_tr_b16 a[152:153], v7 offset:6144
    ds_read_b64_tr_b16 a[154:155], v7 offset:6400
    ds_read_b64_tr_b16 a[156:157], v7 offset:6160
    ds_read_b64_tr_b16 a[158:159], v7 offset:6416
    s_waitcnt vmcnt(22)
    ds_read_b64_tr_b16 a[160:161], v7 offset:8192
    ds_read_b64_tr_b16 a[162:163], v7 offset:8448
    ds_read_b64_tr_b16 a[164:165], v7 offset:8208
    ds_read_b64_tr_b16 a[166:167], v7 offset:8464
    s_waitcnt vmcnt(20)
    ds_read_b64_tr_b16 a[168:169], v7 offset:10240
    ds_read_b64_tr_b16 a[170:171], v7 offset:10496
    ds_read_b64_tr_b16 a[172:173], v7 offset:10256
    ds_read_b64_tr_b16 a[174:175], v7 offset:10512
    s_waitcnt vmcnt(18)
    ds_read_b64_tr_b16 a[176:177], v7 offset:12288
    ds_read_b64_tr_b16 a[178:179], v7 offset:12544
    ds_read_b64_tr_b16 a[180:181], v7 offset:12304
    ds_read_b64_tr_b16 a[182:183], v7 offset:12560
    s_waitcnt vmcnt(16)
    ds_read_b64_tr_b16 a[184:185], v7 offset:14336
    ds_read_b64_tr_b16 a[186:187], v7 offset:14592
    ds_read_b64_tr_b16 a[188:189], v7 offset:14352
    ds_read_b64_tr_b16 a[190:191], v7 offset:14608
    s_waitcnt vmcnt(14)
    ds_read_b64_tr_b16 a[192:193], v7 offset:16384
    ds_read_b64_tr_b16 a[194:195], v7 offset:16640
    ds_read_b64_tr_b16 a[196:197], v7 offset:16400
    ds_read_b64_tr_b16 a[198:199], v7 offset:16656
    s_waitcnt vmcnt(12)
    ds_read_b64_tr_b16 a[200:201], v7 offset:18432
    ds_read_b64_tr_b16 a[202:203], v7 offset:18688
    ds_read_b64_tr_b16 a[204:205], v7 offset:18448
    ds_read_b64_tr_b16 a[206:207], v7 offset:18704
    s_waitcnt vmcnt(10)
    ds_read_b64_tr_b16 a[208:209], v7 offset:20480
    ds_read_b64_tr_b16 a[210:211], v7 offset:20736
    ds_read_b64_tr_b16 a[212:213], v7 offset:20496
    ds_read_b64_tr_b16 a[214:215], v7 offset:20752
    s_waitcnt vmcnt(8)
    ds_read_b64_tr_b16 a[216:217], v7 offset:22528
    ds_read_b64_tr_b16 a[218:219], v7 offset:22784
    ds_read_b64_tr_b16 a[220:221], v7 offset:22544
    ds_read_b64_tr_b16 a[222:223], v7 offset:22800
    s_waitcnt vmcnt(6)
    ds_read_b64_tr_b16 a[224:225], v7 offset:24576
    ds_read_b64_tr_b16 a[226:227], v7 offset:24832
    ds_read_b64_tr_b16 a[228:229], v7 offset:24592
    ds_read_b64_tr_b16 a[230:231], v7 offset:24848
    s_waitcnt vmcnt(4)
    ds_read_b64_tr_b16 a[232:233], v7 offset:26624
    ds_read_b64_tr_b16 a[234:235], v7 offset:26880
    ds_read_b64_tr_b16 a[236:237], v7 offset:26640
    ds_read_b64_tr_b16 a[238:239], v7 offset:26896
    s_waitcnt vmcnt(2)
    ds_read_b64_tr_b16 a[240:241], v7 offset:28672
    ds_read_b64_tr_b16 a[242:243], v7 offset:28928
    ds_read_b64_tr_b16 a[244:245], v7 offset:28688
    ds_read_b64_tr_b16 a[246:247], v7 offset:28944
    s_waitcnt vmcnt(0)
    ds_read_b64_tr_b16 a[248:249], v7 offset:30720
    ds_read_b64_tr_b16 a[250:251], v7 offset:30976
    ds_read_b64_tr_b16 a[252:253], v7 offset:30736
    ds_read_b64_tr_b16 a[254:255], v7 offset:30992
    s_waitcnt lgkmcnt(0)
    s_lshr_b32 s31, s29, 1
    s_and_b32 s31, s31, 1
    s_lshl_b32 s31, s31, 2
    v_lshrrev_b32 v2, 4, v1
    v_add_u32 v2, s31, v2
    v_and_b32 v3, 7, v1
    v_xor_b32 v2, v2, v3
    s_lshl_b32 s31, s29, 14
    v_lshrrev_b32 v8, 3, v1
    v_lshlrev_b32 v8, 11, v8
    v_add_u32 v8, s31, v8
    v_lshl_add_u32 v8, v2, 4, v8
    v_bfe_u32 v2, v1, 1, 3
    v_lshrrev_b32 v3, 4, v1
    v_xor_b32 v2, v2, v3
    v_bfe_u32 v3, v1, 3, 1
    v_lshlrev_b32 v3, 11, v3
    v_and_b32 v4, 7, v1
    v_lshl_add_u32 v3, v4, 7, v3
    v_xor_b32 v12, 0, v2
    v_lshl_add_u32 v12, v12, 4, v3
    v_add_u32 v14, 65536, v12
    v_xor_b32 v13, 4, v2
    v_lshl_add_u32 v13, v13, 4, v3
    v_add_u32 v15, 65536, v13
    s_lshl_b32 s31, s29, 11
    v_lshrrev_b32 v9, 4, v1
    v_lshlrev_b32 v9, 9, v9
    v_bfe_u32 v4, v1, 3, 1
    v_lshl_add_u32 v9, v4, 8, v9
    v_and_b32 v4, 7, v1
    v_lshl_add_u32 v9, v4, 4, v9
    v_add_u32 v9, s31, v9
    v_mov_b32 v10, s50
    s_cmp_eq_u32 s29, 0
    s_cselect_b64 vcc, 1, 0
    v_mov_b32 v4, 2130706432
    v_cndmask_b32 v10, v4, v10, vcc
    v_mov_b32 v11, 0
    s_lshl_b32 s35, s30, 16
    s_sub_u32 s36, s36, s37
    s_barrier
    s_add_u32 m0, s34, 0
    s_nop 0
    buffer_load_dwordx4 v8, s[12:15], s35 offen offset:0 lds
    s_add_u32 m0, s34, 3968
    s_nop 0
    buffer_load_dwordx4 v8, s[12:15], s35 offen offset:128 lds
    s_add_u32 m0, s34, 7936
    s_nop 0
    buffer_load_dwordx4 v8, s[12:15], s35 offen offset:256 lds
    s_add_u32 m0, s34, 11904
    s_nop 0
    buffer_load_dwordx4 v8, s[12:15], s35 offen offset:384 lds
    s_add_u32 m0, s34, 15872
    s_nop 0
    buffer_load_dwordx4 v8, s[12:15], s35 offen offset:512 lds
    s_add_u32 m0, s34, 19840
    s_nop 0
    buffer_load_dwordx4 v8, s[12:15], s35 offen offset:640 lds
    s_add_u32 m0, s34, 23808
    s_nop 0
    buffer_load_dwordx4 v8, s[12:15], s35 offen offset:768 lds
    s_add_u32 m0, s34, 27776
    s_nop 0
    buffer_load_dwordx4 v8, s[12:15], s35 offen offset:896 lds
    s_add_u32 m0, s34, 31744
    s_nop 0
    buffer_load_dwordx4 v8, s[12:15], s35 offen offset:1024 lds
    s_add_u32 m0, s34, 35712
    s_nop 0
    buffer_load_dwordx4 v8, s[12:15], s35 offen offset:1152 lds
    s_add_u32 m0, s34, 39680
    s_nop 0
    buffer_load_dwordx4 v8, s[12:15], s35 offen offset:1280 lds
    s_add_u32 m0, s34, 43648
    s_nop 0
    buffer_load_dwordx4 v8, s[12:15], s35 offen offset:1408 lds
    s_add_u32 m0, s34, 47616
    s_nop 0
    buffer_load_dwordx4 v8, s[12:15], s35 offen offset:1536 lds
    s_add_u32 m0, s34, 51584
    s_nop 0
    buffer_load_dwordx4 v8, s[12:15], s35 offen offset:1664 lds
    s_add_u32 m0, s34, 55552
    s_nop 0
    buffer_load_dwordx4 v8, s[12:15], s35 offen offset:1792 lds
    s_add_u32 m0, s34, 59520
    s_nop 0
    buffer_load_dwordx4 v8, s[12:15], s35 offen offset:1920 lds
    s_add_u32 s35, s35, 65536
    s_add_u32 m0, s34, 65536
    s_nop 0
    buffer_load_dwordx4 v8, s[12:15], s35 offen offset:0 lds
    s_add_u32 m0, s34, 69504
    s_nop 0
    buffer_load_dwordx4 v8, s[12:15], s35 offen offset:128 lds
    s_add_u32 m0, s34, 73472
    s_nop 0
    buffer_load_dwordx4 v8, s[12:15], s35 offen offset:256 lds
    s_add_u32 m0, s34, 77440
    s_nop 0
    buffer_load_dwordx4 v8, s[12:15], s35 offen offset:384 lds
    s_waitcnt vmcnt(12)
    s_barrier
    ds_read_b128 v[32:35], v12 offset:0
    ds_read_b128 v[36:39], v12 offset:1024
    ds_read_b128 v[40:43], v13 offset:0
    ds_read_b128 v[44:47], v13 offset:1024
    ds_read_b128 v[48:51], v12 offset:4096
    ds_read_b128 v[52:55], v12 offset:5120
    v_add_u32 v9, 2130706432, v9
    s_cmp_eq_u32 s44, 2
    s_cbranch_scc1 sl_v_44
sl_loop_46:
    s_waitcnt lgkmcnt(4)
    v_mfma_f32_16x16x32_bf16 v[64:67], a[0:3], v[32:35], 0
    ds_read_b128 v[56:59], v13 offset:4096
    v_mfma_f32_16x16x32_bf16 v[68:71], a[4:7], v[32:35], 0
    v_mfma_f32_16x16x32_bf16 v[72:75], a[0:3], v[36:39], 0
    ds_read_b128 v[60:63], v13 offset:5120
    s_add_u32 m0, s34, 81408
    v_mfma_f32_16x16x32_bf16 v[76:79], a[4:7], v[36:39], 0
    buffer_load_dwordx4 v8, s[12:15], s35 offen offset:512 lds
    s_waitcnt lgkmcnt(4)
    v_mfma_f32_16x16x32_bf16 v[64:67], a[8:11], v[40:43], v[64:67]
    ds_read_b128 v[32:35], v12 offset:8192
    v_mfma_f32_16x16x32_bf16 v[68:71], a[12:15], v[40:43], v[68:71]
    v_mfma_f32_16x16x32_bf16 v[72:75], a[8:11], v[44:47], v[72:75]
    ds_read_b128 v[36:39], v12 offset:9216
    v_mfma_f32_16x16x32_bf16 v[76:79], a[12:15], v[44:47], v[76:79]
    s_waitcnt lgkmcnt(4)
    v_mfma_f32_16x16x32_bf16 v[64:67], a[16:19], v[48:51], v[64:67]
    ds_read_b128 v[40:43], v13 offset:8192
    v_mfma_f32_16x16x32_bf16 v[68:71], a[20:23], v[48:51], v[68:71]
    v_cvt_pk_bf16_f32 v96, v80, v81
    v_mfma_f32_16x16x32_bf16 v[72:75], a[16:19], v[52:55], v[72:75]
    ds_read_b128 v[44:47], v13 offset:9216
    s_add_u32 m0, s34, 85376
    v_mfma_f32_16x16x32_bf16 v[76:79], a[20:23], v[52:55], v[76:79]
    buffer_load_dwordx4 v8, s[12:15], s35 offen offset:640 lds
    v_cvt_pk_bf16_f32 v97, v82, v83
    s_waitcnt lgkmcnt(4)
    v_mfma_f32_16x16x32_bf16 v[64:67], a[24:27], v[56:59], v[64:67]
    ds_read_b128 v[48:51], v12 offset:12288
    v_mfma_f32_16x16x32_bf16 v[68:71], a[28:31], v[56:59], v[68:71]
    v_cvt_pk_bf16_f32 v98, v84, v85
    v_mfma_f32_16x16x32_bf16 v[72:75], a[24:27], v[60:63], v[72:75]
    ds_read_b128 v[52:55], v12 offset:13312
    v_mfma_f32_16x16x32_bf16 v[76:79], a[28:31], v[60:63], v[76:79]
    v_cvt_pk_bf16_f32 v99, v86, v87
    s_waitcnt lgkmcnt(4)
    v_mfma_f32_16x16x32_bf16 v[64:67], a[32:35], v[32:35], v[64:67]
    ds_read_b128 v[56:59], v13 offset:12288
    v_mfma_f32_16x16x32_bf16 v[68:71], a[36:39], v[32:35], v[68:71]
    v_cvt_pk_bf16_f32 v100, v88, v89
    v_mfma_f32_16x16x32_bf16 v[72:75], a[32:35], v[36:39], v[72:75]
    ds_read_b128 v[60:63], v13 offset:13312
    s_add_u32 m0, s34, 89344
    v_mfma_f32_16x16x32_bf16 v[76:79], a[36:39], v[36:39], v[76:79]
    buffer_load_dwordx4 v8, s[12:15], s35 offen offset:768 lds
    v_cvt_pk_bf16_f32 v101, v90, v91
    s_waitcnt lgkmcnt(4)
    v_mfma_f32_16x16x32_bf16 v[64:67], a[40:43], v[40:43], v[64:67]
    ds_read_b128 v[32:35], v12 offset:16384
    v_mfma_f32_16x16x32_bf16 v[68:71], a[44:47], v[40:43], v[68:71]
    v_cvt_pk_bf16_f32 v102, v92, v93
    v_mfma_f32_16x16x32_bf16 v[72:75], a[40:43], v[44:47], v[72:75]
    ds_read_b128 v[36:39], v12 offset:17408
    v_mfma_f32_16x16x32_bf16 v[76:79], a[44:47], v[44:47], v[76:79]
    v_cvt_pk_bf16_f32 v103, v94, v95
    buffer_store_dwordx4 v[96:99], v9, s[4:7], s36 offen sc1
    s_waitcnt lgkmcnt(4)
    v_mfma_f32_16x16x32_bf16 v[64:67], a[48:51], v[48:51], v[64:67]
    ds_read_b128 v[40:43], v13 offset:16384
    v_mfma_f32_16x16x32_bf16 v[68:71], a[52:55], v[48:51], v[68:71]
    v_mfma_f32_16x16x32_bf16 v[72:75], a[48:51], v[52:55], v[72:75]
    ds_read_b128 v[44:47], v13 offset:17408
    s_add_u32 m0, s34, 93312
    v_mfma_f32_16x16x32_bf16 v[76:79], a[52:55], v[52:55], v[76:79]
    buffer_load_dwordx4 v8, s[12:15], s35 offen offset:896 lds
    s_waitcnt lgkmcnt(4)
    v_mfma_f32_16x16x32_bf16 v[64:67], a[56:59], v[56:59], v[64:67]
    ds_read_b128 v[48:51], v12 offset:20480
    v_mfma_f32_16x16x32_bf16 v[68:71], a[60:63], v[56:59], v[68:71]
    v_mfma_f32_16x16x32_bf16 v[72:75], a[56:59], v[60:63], v[72:75]
    ds_read_b128 v[52:55], v12 offset:21504
    v_mfma_f32_16x16x32_bf16 v[76:79], a[60:63], v[60:63], v[76:79]
    buffer_store_dwordx4 v[100:103], v9, s[4:7], s36 offen offset:128 sc1
    s_add_u32 s36, s36, s37
    s_waitcnt vmcnt(8)
    s_barrier
    s_waitcnt lgkmcnt(4)
    v_mfma_f32_16x16x32_bf16 v[64:67], a[64:67], v[32:35], v[64:67]
    ds_read_b128 v[56:59], v13 offset:20480
    v_mfma_f32_16x16x32_bf16 v[68:71], a[68:71], v[32:35], v[68:71]
    v_mfma_f32_16x16x32_bf16 v[72:75], a[64:67], v[36:39], v[72:75]
    ds_read_b128 v[60:63], v13 offset:21504
    s_add_u32 m0, s34, 97280
    v_mfma_f32_16x16x32_bf16 v[76:79], a[68:71], v[36:39], v[76:79]
    buffer_load_dwordx4 v8, s[12:15], s35 offen offset:1024 lds
    s_waitcnt lgkmcnt(4)
    v_mfma_f32_16x16x32_bf16 v[64:67], a[72:75], v[40:43], v[64:67]
    ds_read_b128 v[32:35], v12 offset:24576
    v_mfma_f32_16x16x32_bf16 v[68:71], a[76:79], v[40:43], v[68:71]
    v_mfma_f32_16x16x32_bf16 v[72:75], a[72:75], v[44:47], v[72:75]
    ds_read_b128 v[36:39], v12 offset:25600
    v_mfma_f32_16x16x32_bf16 v[76:79], a[76:79], v[44:47], v[76:79]
    s_waitcnt lgkmcnt(4)
    v_mfma_f32_16x16x32_bf16 v[64:67], a[80:83], v[48:51], v[64:67]
    ds_read_b128 v[40:43], v13 offset:24576
    v_mfma_f32_16x16x32_bf16 v[68:71], a[84:87], v[48:51], v[68:71]
    v_and_b32 v9, 0xffffff, v9
    v_mfma_f32_16x16x32_bf16 v[72:75], a[80:83], v[52:55], v[72:75]
    ds_read_b128 v[44:47], v13 offset:25600
    s_add_u32 m0, s34, 101248
    v_mfma_f32_16x16x32_bf16 v[76:79], a[84:87], v[52:55], v[76:79]
    buffer_load_dwordx4 v8, s[12:15], s35 offen offset:1152 lds
    s_waitcnt lgkmcnt(4)
    v_mfma_f32_16x16x32_bf16 v[64:67], a[88:91], v[56:59], v[64:67]
    ds_read_b128 v[48:51], v12 offset:28672
    v_mfma_f32_16x16x32_bf16 v[68:71], a[92:95], v[56:59], v[68:71]
    v_mfma_f32_16x16x32_bf16 v[72:75], a[88:91], v[60:63], v[72:75]
    ds_read_b128 v[52:55], v12 offset:29696
    v_mfma_f32_16x16x32_bf16 v[76:79], a[92:95], v[60:63], v[76:79]
    s_waitcnt lgkmcnt(4)
    v_mfma_f32_16x16x32_bf16 v[64:67], a[96:99], v[32:35], v[64:67]
    ds_read_b128 v[56:59], v13 offset:28672
    v_mfma_f32_16x16x32_bf16 v[68:71], a[100:103], v[32:35], v[68:71]
    v_mfma_f32_16x16x32_bf16 v[72:75], a[96:99], v[36:39], v[72:75]
    ds_read_b128 v[60:63], v13 offset:29696
    s_add_u32 m0, s34, 105216
    v_mfma_f32_16x16x32_bf16 v[76:79], a[100:103], v[36:39], v[76:79]
    buffer_load_dwordx4 v8, s[12:15], s35 offen offset:1280 lds
    s_waitcnt lgkmcnt(4)
    v_mfma_f32_16x16x32_bf16 v[64:67], a[104:107], v[40:43], v[64:67]
    ds_read_b128 v[32:35], v12 offset:32768
    v_mfma_f32_16x16x32_bf16 v[68:71], a[108:111], v[40:43], v[68:71]
    v_mfma_f32_16x16x32_bf16 v[72:75], a[104:107], v[44:47], v[72:75]
    ds_read_b128 v[36:39], v12 offset:33792
    v_mfma_f32_16x16x32_bf16 v[76:79], a[108:111], v[44:47], v[76:79]
    s_waitcnt lgkmcnt(4)
    v_mfma_f32_16x16x32_bf16 v[64:67], a[112:115], v[48:51], v[64:67]
    ds_read_b128 v[40:43], v13 offset:32768
    v_mfma_f32_16x16x32_bf16 v[68:71], a[116:119], v[48:51], v[68:71]
    v_mfma_f32_16x16x32_bf16 v[72:75], a[112:115], v[52:55], v[72:75]
    ds_read_b128 v[44:47], v13 offset:33792
    s_add_u32 m0, s34, 109184
    v_mfma_f32_16x16x32_bf16 v[76:79], a[116:119], v[52:55], v[76:79]
    buffer_load_dwordx4 v8, s[12:15], s35 offen offset:1408 lds
    s_waitcnt lgkmcnt(4)
    v_mfma_f32_16x16x32_bf16 v[64:67], a[120:123], v[56:59], v[64:67]
    ds_read_b128 v[48:51], v12 offset:36864
    v_mfma_f32_16x16x32_bf16 v[68:71], a[124:127], v[56:59], v[68:71]
    v_mfma_f32_16x16x32_bf16 v[72:75], a[120:123], v[60:63], v[72:75]
    ds_read_b128 v[52:55], v12 offset:37888
    v_mfma_f32_16x16x32_bf16 v[76:79], a[124:127], v[60:63], v[76:79]
    s_waitcnt lgkmcnt(4)
    v_mfma_f32_16x16x32_bf16 v[64:67], a[128:131], v[32:35], v[64:67]
    ds_read_b128 v[56:59], v13 offset:36864
    v_mfma_f32_16x16x32_bf16 v[68:71], a[132:135], v[32:35], v[68:71]
    v_mfma_f32_16x16x32_bf16 v[72:75], a[128:131], v[36:39], v[72:75]
    ds_read_b128 v[60:63], v13 offset:37888
    s_add_u32 m0, s34, 113152
    v_mfma_f32_16x16x32_bf16 v[76:79], a[132:135], v[36:39], v[76:79]
    buffer_load_dwordx4 v8, s[12:15], s35 offen offset:1536 lds
    s_waitcnt lgkmcnt(4)
    v_mfma_f32_16x16x32_bf16 v[64:67], a[136:139], v[40:43], v[64:67]
    ds_read_b128 v[32:35], v12 offset:40960
    v_mfma_f32_16x16x32_bf16 v[68:71], a[140:143], v[40:43], v[68:71]
    v_mfma_f32_16x16x32_bf16 v[72:75], a[136:139], v[44:47], v[72:75]
    ds_read_b128 v[36:39], v12 offset:41984
    v_mfma_f32_16x16x32_bf16 v[76:79], a[140:143], v[44:47], v[76:79]
    s_waitcnt lgkmcnt(4)
    v_mfma_f32_16x16x32_bf16 v[64:67], a[144:147], v[48:51], v[64:67]
    ds_read_b128 v[40:43], v13 offset:40960
    v_mfma_f32_16x16x32_bf16 v[68:71], a[148:151], v[48:51], v[68:71]
    v_mfma_f32_16x16x32_bf16 v[72:75], a[144:147], v[52:55], v[72:75]
    ds_read_b128 v[44:47], v13 offset:41984
    s_add_u32 m0, s34, 117120
    v_mfma_f32_16x16x32_bf16 v[76:79], a[148:151], v[52:55], v[76:79]
    buffer_load_dwordx4 v8, s[12:15], s35 offen offset:1664 lds
    s_waitcnt lgkmcnt(4)
    v_mfma_f32_16x16x32_bf16 v[64:67], a[152:155], v[56:59], v[64:67]
    ds_read_b128 v[48:51], v12 offset:45056
    v_mfma_f32_16x16x32_bf16 v[68:71], a[156:159], v[56:59], v[68:71]
    v_mfma_f32_16x16x32_bf16 v[72:75], a[152:155], v[60:63], v[72:75]
    ds_read_b128 v[52:55], v12 offset:46080
    v_mfma_f32_16x16x32_bf16 v[76:79], a[156:159], v[60:63], v[76:79]
    s_waitcnt lgkmcnt(4)
    v_mfma_f32_16x16x32_bf16 v[64:67], a[160:163], v[32:35], v[64:67]
    ds_read_b128 v[56:59], v13 offset:45056
    v_mfma_f32_16x16x32_bf16 v[68:71], a[164:167], v[32:35], v[68:71]
    v_mfma_f32_16x16x32_bf16 v[72:75], a[160:163], v[36:39], v[72:75]
    ds_read_b128 v[60:63], v13 offset:46080
    s_add_u32 m0, s34, 121088
    v_mfma_f32_16x16x32_bf16 v[76:79], a[164:167], v[36:39], v[76:79]
    buffer_load_dwordx4 v8, s[12:15], s35 offen offset:1792 lds
    s_waitcnt lgkmcnt(4)
    v_mfma_f32_16x16x32_bf16 v[64:67], a[168:171], v[40:43], v[64:67]
    ds_read_b128 v[32:35], v12 offset:49152
    v_mfma_f32_16x16x32_bf16 v[68:71], a[172:175], v[40:43], v[68:71]
    v_mfma_f32_16x16x32_bf16 v[72:75], a[168:171], v[44:47], v[72:75]
    ds_read_b128 v[36:39], v12 offset:50176
    v_mfma_f32_16x16x32_bf16 v[76:79], a[172:175], v[44:47], v[76:79]
    s_waitcnt lgkmcnt(4)
    v_mfma_f32_16x16x32_bf16 v[64:67], a[176:179], v[48:51], v[64:67]
    ds_read_b128 v[40:43], v13 offset:49152
    v_mfma_f32_16x16x32_bf16 v[68:71], a[180:183], v[48:51], v[68:71]
    v_mfma_f32_16x16x32_bf16 v[72:75], a[176:179], v[52:55], v[72:75]
    ds_read_b128 v[44:47], v13 offset:50176
    s_add_u32 m0, s34, 125056
    v_mfma_f32_16x16x32_bf16 v[76:79], a[180:183], v[52:55], v[76:79]
    buffer_load_dwordx4 v8, s[12:15], s35 offen offset:1920 lds
    s_add_u32 s35, s35, 65536
    s_min_u32 s35, s35, s52
    s_waitcnt lgkmcnt(4)
    v_mfma_f32_16x16x32_bf16 v[64:67], a[184:187], v[56:59], v[64:67]
    ds_read_b128 v[48:51], v12 offset:53248
    v_mfma_f32_16x16x32_bf16 v[68:71], a[188:191], v[56:59], v[68:71]
    v_mfma_f32_16x16x32_bf16 v[72:75], a[184:187], v[60:63], v[72:75]
    ds_read_b128 v[52:55], v12 offset:54272
    v_mfma_f32_16x16x32_bf16 v[76:79], a[188:191], v[60:63], v[76:79]
    s_waitcnt vmcnt(8)
    s_barrier
    s_waitcnt lgkmcnt(4)
    v_mfma_f32_16x16x32_bf16 v[64:67], a[192:195], v[32:35], v[64:67]
    ds_read_b128 v[56:59], v13 offset:53248
    v_mfma_f32_16x16x32_bf16 v[68:71], a[196:199], v[32:35], v[68:71]
    v_mfma_f32_16x16x32_bf16 v[72:75], a[192:195], v[36:39], v[72:75]
    ds_read_b128 v[60:63], v13 offset:54272
    s_add_u32 m0, s34, 0
    v_mfma_f32_16x16x32_bf16 v[76:79], a[196:199], v[36:39], v[76:79]
    buffer_load_dwordx4 v8, s[12:15], s35 offen offset:0 lds
    s_waitcnt lgkmcnt(4)
    v_mfma_f32_16x16x32_bf16 v[64:67], a[200:203], v[40:43], v[64:67]
    ds_read_b128 v[32:35], v12 offset:57344
    v_mfma_f32_16x16x32_bf16 v[68:71], a[204:207], v[40:43], v[68:71]
    buffer_store_dword v11, v10, s[4:7], 0 offen sc1
    v_add_u32 v11, 1, v11
    v_mfma_f32_16x16x32_bf16 v[72:75], a[200:203], v[44:47], v[72:75]
    ds_read_b128 v[36:39], v12 offset:58368
    v_mfma_f32_16x16x32_bf16 v[76:79], a[204:207], v[44:47], v[76:79]
    s_waitcnt lgkmcnt(4)
    v_mfma_f32_16x16x32_bf16 v[64:67], a[208:211], v[48:51], v[64:67]
    ds_read_b128 v[40:43], v13 offset:57344
    v_mfma_f32_16x16x32_bf16 v[68:71], a[212:215], v[48:51], v[68:71]
    v_mfma_f32_16x16x32_bf16 v[72:75], a[208:211], v[52:55], v[72:75]
    ds_read_b128 v[44:47], v13 offset:58368
    s_add_u32 m0, s34, 3968
    v_mfma_f32_16x16x32_bf16 v[76:79], a[212:215], v[52:55], v[76:79]
    buffer_load_dwordx4 v8, s[12:15], s35 offen offset:128 lds
    s_waitcnt lgkmcnt(4)
    v_mfma_f32_16x16x32_bf16 v[64:67], a[216:219], v[56:59], v[64:67]
    ds_read_b128 v[48:51], v12 offset:61440
    v_mfma_f32_16x16x32_bf16 v[68:71], a[220:223], v[56:59], v[68:71]
    v_mfma_f32_16x16x32_bf16 v[72:75], a[216:219], v[60:63], v[72:75]
    ds_read_b128 v[52:55], v12 offset:62464
    v_mfma_f32_16x16x32_bf16 v[76:79], a[220:223], v[60:63], v[76:79]
    s_waitcnt lgkmcnt(4)
    v_mfma_f32_16x16x32_bf16 v[64:67], a[224:227], v[32:35], v[64:67]
    ds_read_b128 v[56:59], v13 offset:61440
    v_mfma_f32_16x16x32_bf16 v[68:71], a[228:231], v[32:35], v[68:71]
    v_mfma_f32_16x16x32_bf16 v[72:75], a[224:227], v[36:39], v[72:75]
    ds_read_b128 v[60:63], v13 offset:62464
    s_add_u32 m0, s34, 7936
    v_mfma_f32_16x16x32_bf16 v[76:79], a[228:231], v[36:39], v[76:79]
    buffer_load_dwordx4 v8, s[12:15], s35 offen offset:256 lds
    s_waitcnt lgkmcnt(4)
    v_mfma_f32_16x16x32_bf16 v[64:67], a[232:235], v[40:43], v[64:67]
    ds_read_b128 v[32:35], v14 offset:0
    v_mfma_f32_16x16x32_bf16 v[68:71], a[236:239], v[40:43], v[68:71]
    v_mfma_f32_16x16x32_bf16 v[72:75], a[232:235], v[44:47], v[72:75]
    ds_read_b128 v[36:39], v14 offset:1024
    v_mfma_f32_16x16x32_bf16 v[76:79], a[236:239], v[44:47], v[76:79]
    s_waitcnt lgkmcnt(4)
    v_mfma_f32_16x16x32_bf16 v[64:67], a[240:243], v[48:51], v[64:67]
    ds_read_b128 v[40:43], v15 offset:0
    v_mfma_f32_16x16x32_bf16 v[68:71], a[244:247], v[48:51], v[68:71]
    v_mfma_f32_16x16x32_bf16 v[72:75], a[240:243], v[52:55], v[72:75]
    ds_read_b128 v[44:47], v15 offset:1024
    s_add_u32 m0, s34, 11904
    v_mfma_f32_16x16x32_bf16 v[76:79], a[244:247], v[52:55], v[76:79]
    buffer_load_dwordx4 v8, s[12:15], s35 offen offset:384 lds
    s_waitcnt lgkmcnt(4)
    v_mfma_f32_16x16x32_bf16 v[64:67], a[248:251], v[56:59], v[64:67]
    ds_read_b128 v[48:51], v14 offset:4096
    v_mfma_f32_16x16x32_bf16 v[68:71], a[252:255], v[56:59], v[68:71]
    v_mfma_f32_16x16x32_bf16 v[72:75], a[248:251], v[60:63], v[72:75]
    ds_read_b128 v[52:55], v14 offset:5120
    v_mfma_f32_16x16x32_bf16 v[76:79], a[252:255], v[60:63], v[76:79]
    s_waitcnt lgkmcnt(4)
    v_mfma_f32_16x16x32_bf16 v[80:83], a[0:3], v[32:35], 0
    ds_read_b128 v[56:59], v15 offset:4096
    v_mfma_f32_16x16x32_bf16 v[84:87], a[4:7], v[32:35], 0
    v_mfma_f32_16x16x32_bf16 v[88:91], a[0:3], v[36:39], 0
    ds_read_b128 v[60:63], v15 offset:5120
    s_add_u32 m0, s34, 15872
    v_mfma_f32_16x16x32_bf16 v[92:95], a[4:7], v[36:39], 0
    buffer_load_dwordx4 v8, s[12:15], s35 offen offset:512 lds
    s_waitcnt lgkmcnt(4)
    v_mfma_f32_16x16x32_bf16 v[80:83], a[8:11], v[40:43], v[80:83]
    ds_read_b128 v[32:35], v14 offset:8192
    v_mfma_f32_16x16x32_bf16 v[84:87], a[12:15], v[40:43], v[84:87]
    v_mfma_f32_16x16x32_bf16 v[88:91], a[8:11], v[44:47], v[88:91]
    ds_read_b128 v[36:39], v14 offset:9216
    v_mfma_f32_16x16x32_bf16 v[92:95], a[12:15], v[44:47], v[92:95]
    s_waitcnt lgkmcnt(4)
    v_mfma_f32_16x16x32_bf16 v[80:83], a[16:19], v[48:51], v[80:83]
    ds_read_b128 v[40:43], v15 offset:8192
    v_mfma_f32_16x16x32_bf16 v[84:87], a[20:23], v[48:51], v[84:87]
    v_cvt_pk_bf16_f32 v96, v64, v65
    v_mfma_f32_16x16x32_bf16 v[88:91], a[16:19], v[52:55], v[88:91]
    ds_read_b128 v[44:47], v15 offset:9216
    s_add_u32 m0, s34, 19840
    v_mfma_f32_16x16x32_bf16 v[92:95], a[20:23], v[52:55], v[92:95]
    buffer_load_dwordx4 v8, s[12:15], s35 offen offset:640 lds
    v_cvt_pk_bf16_f32 v97, v66, v67
    s_waitcnt lgkmcnt(4)
    v_mfma_f32_16x16x32_bf16 v[80:83], a[24:27], v[56:59], v[80:83]
    ds_read_b128 v[48:51], v14 offset:12288
    v_mfma_f32_16x16x32_bf16 v[84:87], a[28:31], v[56:59], v[84:87]
    v_cvt_pk_bf16_f32 v98, v68, v69
    v_mfma_f32_16x16x32_bf16 v[88:91], a[24:27], v[60:63], v[88:91]
    ds_read_b128 v[52:55], v14 offset:13312
    v_mfma_f32_16x16x32_bf16 v[92:95], a[28:31], v[60:63], v[92:95]
    v_cvt_pk_bf16_f32 v99, v70, v71
    s_waitcnt lgkmcnt(4)
    v_mfma_f32_16x16x32_bf16 v[80:83], a[32:35], v[32:35], v[80:83]
    ds_read_b128 v[56:59], v15 offset:12288
    v_mfma_f32_16x16x32_bf16 v[84:87], a[36:39], v[32:35], v[84:87]
    v_cvt_pk_bf16_f32 v100, v72, v73
    v_mfma_f32_16x16x32_bf16 v[88:91], a[32:35], v[36:39], v[88:91]
    ds_read_b128 v[60:63], v15 offset:13312
    s_add_u32 m0, s34, 23808
    v_mfma_f32_16x16x32_bf16 v[92:95], a[36:39], v[36:39], v[92:95]
    buffer_load_dwordx4 v8, s[12:15], s35 offen offset:768 lds
    v_cvt_pk_bf16_f32 v101, v74, v75
    s_waitcnt lgkmcnt(4)
    v_mfma_f32_16x16x32_bf16 v[80:83], a[40:43], v[40:43], v[80:83]
    ds_read_b128 v[32:35], v14 offset:16384
    v_mfma_f32_16x16x32_bf16 v[84:87], a[44:47], v[40:43], v[84:87]
    v_cvt_pk_bf16_f32 v102, v76, v77
    v_mfma_f32_16x16x32_bf16 v[88:91], a[40:43], v[44:47], v[88:91]
    ds_read_b128 v[36:39], v14 offset:17408
    v_mfma_f32_16x16x32_bf16 v[92:95], a[44:47], v[44:47], v[92:95]
    v_cvt_pk_bf16_f32 v103, v78, v79
    buffer_store_dwordx4 v[96:99], v9, s[4:7], s36 offen sc1
    s_waitcnt lgkmcnt(4)
    v_mfma_f32_16x16x32_bf16 v[80:83], a[48:51], v[48:51], v[80:83]
    ds_read_b128 v[40:43], v15 offset:16384
    v_mfma_f32_16x16x32_bf16 v[84:87], a[52:55], v[48:51], v[84:87]
    v_mfma_f32_16x16x32_bf16 v[88:91], a[48:51], v[52:55], v[88:91]
    ds_read_b128 v[44:47], v15 offset:17408
    s_add_u32 m0, s34, 27776
    v_mfma_f32_16x16x32_bf16 v[92:95], a[52:55], v[52:55], v[92:95]
    buffer_load_dwordx4 v8, s[12:15], s35 offen offset:896 lds
    s_waitcnt lgkmcnt(4)
    v_mfma_f32_16x16x32_bf16 v[80:83], a[56:59], v[56:59], v[80:83]
    ds_read_b128 v[48:51], v14 offset:20480
    v_mfma_f32_16x16x32_bf16 v[84:87], a[60:63], v[56:59], v[84:87]
    v_mfma_f32_16x16x32_bf16 v[88:91], a[56:59], v[60:63], v[88:91]
    ds_read_b128 v[52:55], v14 offset:21504
    v_mfma_f32_16x16x32_bf16 v[92:95], a[60:63], v[60:63], v[92:95]
    buffer_store_dwordx4 v[100:103], v9, s[4:7], s36 offen offset:128 sc1
    s_add_u32 s36, s36, s37
    s_waitcnt vmcnt(8)
    s_barrier
    s_waitcnt lgkmcnt(4)
    v_mfma_f32_16x16x32_bf16 v[80:83], a[64:67], v[32:35], v[80:83]
    ds_read_b128 v[56:59], v15 offset:20480
    v_mfma_f32_16x16x32_bf16 v[84:87], a[68:71], v[32:35], v[84:87]
    v_mfma_f32_16x16x32_bf16 v[88:91], a[64:67], v[36:39], v[88:91]
    ds_read_b128 v[60:63], v15 offset:21504
    s_add_u32 m0, s34, 31744
    v_mfma_f32_16x16x32_bf16 v[92:95], a[68:71], v[36:39], v[92:95]
    buffer_load_dwordx4 v8, s[12:15], s35 offen offset:1024 lds
    s_waitcnt lgkmcnt(4)
    v_mfma_f32_16x16x32_bf16 v[80:83], a[72:75], v[40:43], v[80:83]
    ds_read_b128 v[32:35], v14 offset:24576
    v_mfma_f32_16x16x32_bf16 v[84:87], a[76:79], v[40:43], v[84:87]
    v_mfma_f32_16x16x32_bf16 v[88:91], a[72:75], v[44:47], v[88:91]
    ds_read_b128 v[36:39], v14 offset:25600
    v_mfma_f32_16x16x32_bf16 v[92:95], a[76:79], v[44:47], v[92:95]
    s_waitcnt lgkmcnt(4)
    v_mfma_f32_16x16x32_bf16 v[80:83], a[80:83], v[48:51], v[80:83]
    ds_read_b128 v[40:43], v15 offset:24576
    v_mfma_f32_16x16x32_bf16 v[84:87], a[84:87], v[48:51], v[84:87]
    v_mfma_f32_16x16x32_bf16 v[88:91], a[80:83], v[52:55], v[88:91]
    ds_read_b128 v[44:47], v15 offset:25600
    s_add_u32 m0, s34, 35712
    v_mfma_f32_16x16x32_bf16 v[92:95], a[84:87], v[52:55], v[92:95]
    buffer_load_dwordx4 v8, s[12:15], s35 offen offset:1152 lds
    s_waitcnt lgkmcnt(4)
    v_mfma_f32_16x16x32_bf16 v[80:83], a[88:91], v[56:59], v[80:83]
    ds_read_b128 v[48:51], v14 offset:28672
    v_mfma_f32_16x16x32_bf16 v[84:87], a[92:95], v[56:59], v[84:87]
    v_mfma_f32_16x16x32_bf16 v[88:91], a[88:91], v[60:63], v[88:91]
    ds_read_b128 v[52:55], v14 offset:29696
    v_mfma_f32_16x16x32_bf16 v[92:95], a[92:95], v[60:63], v[92:95]
    s_waitcnt lgkmcnt(4)
    v_mfma_f32_16x16x32_bf16 v[80:83], a[96:99], v[32:35], v[80:83]
    ds_read_b128 v[56:59], v15 offset:28672
    v_mfma_f32_16x16x32_bf16 v[84:87], a[100:103], v[32:35], v[84:87]
    v_mfma_f32_16x16x32_bf16 v[88:91], a[96:99], v[36:39], v[88:91]
    ds_read_b128 v[60:63], v15 offset:29696
    s_add_u32 m0, s34, 39680
    v_mfma_f32_16x16x32_bf16 v[92:95], a[100:103], v[36:39], v[92:95]
    buffer_load_dwordx4 v8, s[12:15], s35 offen offset:1280 lds
    s_waitcnt lgkmcnt(4)
    v_mfma_f32_16x16x32_bf16 v[80:83], a[104:107], v[40:43], v[80:83]
    ds_read_b128 v[32:35], v14 offset:32768
    v_mfma_f32_16x16x32_bf16 v[84:87], a[108:111], v[40:43], v[84:87]
    v_mfma_f32_16x16x32_bf16 v[88:91], a[104:107], v[44:47], v[88:91]
    ds_read_b128 v[36:39], v14 offset:33792
    v_mfma_f32_16x16x32_bf16 v[92:95], a[108:111], v[44:47], v[92:95]
    s_waitcnt lgkmcnt(4)
    v_mfma_f32_16x16x32_bf16 v[80:83], a[112:115], v[48:51], v[80:83]
    ds_read_b128 v[40:43], v15 offset:32768
    v_mfma_f32_16x16x32_bf16 v[84:87], a[116:119], v[48:51], v[84:87]
    v_mfma_f32_16x16x32_bf16 v[88:91], a[112:115], v[52:55], v[88:91]
    ds_read_b128 v[44:47], v15 offset:33792
    s_add_u32 m0, s34, 43648
    v_mfma_f32_16x16x32_bf16 v[92:95], a[116:119], v[52:55], v[92:95]
    buffer_load_dwordx4 v8, s[12:15], s35 offen offset:1408 lds
    s_waitcnt lgkmcnt(4)
    v_mfma_f32_16x16x32_bf16 v[80:83], a[120:123], v[56:59], v[80:83]
    ds_read_b128 v[48:51], v14 offset:36864
    v_mfma_f32_16x16x32_bf16 v[84:87], a[124:127], v[56:59], v[84:87]
    v_mfma_f32_16x16x32_bf16 v[88:91], a[120:123], v[60:63], v[88:91]
    ds_read_b128 v[52:55], v14 offset:37888
    v_mfma_f32_16x16x32_bf16 v[92:95], a[124:127], v[60:63], v[92:95]
    s_waitcnt lgkmcnt(4)
    v_mfma_f32_16x16x32_bf16 v[80:83], a[128:131], v[32:35], v[80:83]
    ds_read_b128 v[56:59], v15 offset:36864
    v_mfma_f32_16x16x32_bf16 v[84:87], a[132:135], v[32:35], v[84:87]
    v_mfma_f32_16x16x32_bf16 v[88:91], a[128:131], v[36:39], v[88:91]
    ds_read_b128 v[60:63], v15 offset:37888
    s_add_u32 m0, s34, 47616
    v_mfma_f32_16x16x32_bf16 v[92:95], a[132:135], v[36:39], v[92:95]
    buffer_load_dwordx4 v8, s[12:15], s35 offen offset:1536 lds
    s_waitcnt lgkmcnt(4)
    v_mfma_f32_16x16x32_bf16 v[80:83], a[136:139], v[40:43], v[80:83]
    ds_read_b128 v[32:35], v14 offset:40960
    v_mfma_f32_16x16x32_bf16 v[84:87], a[140:143], v[40:43], v[84:87]
    v_mfma_f32_16x16x32_bf16 v[88:91], a[136:139], v[44:47], v[88:91]
    ds_read_b128 v[36:39], v14 offset:41984
    v_mfma_f32_16x16x32_bf16 v[92:95], a[140:143], v[44:47], v[92:95]
    s_waitcnt lgkmcnt(4)
    v_mfma_f32_16x16x32_bf16 v[80:83], a[144:147], v[48:51], v[80:83]
    ds_read_b128 v[40:43], v15 offset:40960
    v_mfma_f32_16x16x32_bf16 v[84:87], a[148:151], v[48:51], v[84:87]
    v_mfma_f32_16x16x32_bf16 v[88:91], a[144:147], v[52:55], v[88:91]
    ds_read_b128 v[44:47], v15 offset:41984
    s_add_u32 m0, s34, 51584
    v_mfma_f32_16x16x32_bf16 v[92:95], a[148:151], v[52:55], v[92:95]
    buffer_load_dwordx4 v8, s[12:15], s35 offen offset:1664 lds
    s_waitcnt lgkmcnt(4)
    v_mfma_f32_16x16x32_bf16 v[80:83], a[152:155], v[56:59], v[80:83]
    ds_read_b128 v[48:51], v14 offset:45056
    v_mfma_f32_16x16x32_bf16 v[84:87], a[156:159], v[56:59], v[84:87]
    v_mfma_f32_16x16x32_bf16 v[88:91], a[152:155], v[60:63], v[88:91]
    ds_read_b128 v[52:55], v14 offset:46080
    v_mfma_f32_16x16x32_bf16 v[92:95], a[156:159], v[60:63], v[92:95]
    s_waitcnt lgkmcnt(4)
    v_mfma_f32_16x16x32_bf16 v[80:83], a[160:163], v[32:35], v[80:83]
    ds_read_b128 v[56:59], v15 offset:45056
    v_mfma_f32_16x16x32_bf16 v[84:87], a[164:167], v[32:35], v[84:87]
    v_mfma_f32_16x16x32_bf16 v[88:91], a[160:163], v[36:39], v[88:91]
    ds_read_b128 v[60:63], v15 offset:46080
    s_add_u32 m0, s34, 55552
    v_mfma_f32_16x16x32_bf16 v[92:95], a[164:167], v[36:39], v[92:95]
    buffer_load_dwordx4 v8, s[12:15], s35 offen offset:1792 lds
    s_waitcnt lgkmcnt(4)
    v_mfma_f32_16x16x32_bf16 v[80:83], a[168:171], v[40:43], v[80:83]
    ds_read_b128 v[32:35], v14 offset:49152
    v_mfma_f32_16x16x32_bf16 v[84:87], a[172:175], v[40:43], v[84:87]
    v_mfma_f32_16x16x32_bf16 v[88:91], a[168:171], v[44:47], v[88:91]
    ds_read_b128 v[36:39], v14 offset:50176
    v_mfma_f32_16x16x32_bf16 v[92:95], a[172:175], v[44:47], v[92:95]
    s_waitcnt lgkmcnt(4)
    v_mfma_f32_16x16x32_bf16 v[80:83], a[176:179], v[48:51], v[80:83]
    ds_read_b128 v[40:43], v15 offset:49152
    v_mfma_f32_16x16x32_bf16 v[84:87], a[180:183], v[48:51], v[84:87]
    v_mfma_f32_16x16x32_bf16 v[88:91], a[176:179], v[52:55], v[88:91]
    ds_read_b128 v[44:47], v15 offset:50176
    s_add_u32 m0, s34, 59520
    v_mfma_f32_16x16x32_bf16 v[92:95], a[180:183], v[52:55], v[92:95]
    buffer_load_dwordx4 v8, s[12:15], s35 offen offset:1920 lds
    s_add_u32 s35, s35, 65536
    s_min_u32 s35, s35, s52
    s_waitcnt lgkmcnt(4)
    v_mfma_f32_16x16x32_bf16 v[80:83], a[184:187], v[56:59], v[80:83]
    ds_read_b128 v[48:51], v14 offset:53248
    v_mfma_f32_16x16x32_bf16 v[84:87], a[188:191], v[56:59], v[84:87]
    v_mfma_f32_16x16x32_bf16 v[88:91], a[184:187], v[60:63], v[88:91]
    ds_read_b128 v[52:55], v14 offset:54272
    v_mfma_f32_16x16x32_bf16 v[92:95], a[188:191], v[60:63], v[92:95]
    s_waitcnt vmcnt(8)
    s_barrier
    s_waitcnt lgkmcnt(4)
    v_mfma_f32_16x16x32_bf16 v[80:83], a[192:195], v[32:35], v[80:83]
    ds_read_b128 v[56:59], v15 offset:53248
    v_mfma_f32_16x16x32_bf16 v[84:87], a[196:199], v[32:35], v[84:87]
    v_mfma_f32_16x16x32_bf16 v[88:91], a[192:195], v[36:39], v[88:91]
    ds_read_b128 v[60:63], v15 offset:54272
    s_add_u32 m0, s34, 65536
    v_mfma_f32_16x16x32_bf16 v[92:95], a[196:199], v[36:39], v[92:95]
    buffer_load_dwordx4 v8, s[12:15], s35 offen offset:0 lds
    s_waitcnt lgkmcnt(4)
    v_mfma_f32_16x16x32_bf16 v[80:83], a[200:203], v[40:43], v[80:83]
    ds_read_b128 v[32:35], v14 offset:57344
    v_mfma_f32_16x16x32_bf16 v[84:87], a[204:207], v[40:43], v[84:87]
    buffer_store_dword v11, v10, s[4:7], 0 offen sc1
    v_add_u32 v11, 1, v11
    v_mfma_f32_16x16x32_bf16 v[88:91], a[200:203], v[44:47], v[88:91]
    ds_read_b128 v[36:39], v14 offset:58368
    v_mfma_f32_16x16x32_bf16 v[92:95], a[204:207], v[44:47], v[92:95]
    s_waitcnt lgkmcnt(4)
    v_mfma_f32_16x16x32_bf16 v[80:83], a[208:211], v[48:51], v[80:83]
    ds_read_b128 v[40:43], v15 offset:57344
    v_mfma_f32_16x16x32_bf16 v[84:87], a[212:215], v[48:51], v[84:87]
    v_mfma_f32_16x16x32_bf16 v[88:91], a[208:211], v[52:55], v[88:91]
    ds_read_b128 v[44:47], v15 offset:58368
    s_add_u32 m0, s34, 69504
    v_mfma_f32_16x16x32_bf16 v[92:95], a[212:215], v[52:55], v[92:95]
    buffer_load_dwordx4 v8, s[12:15], s35 offen offset:128 lds
    s_waitcnt lgkmcnt(4)
    v_mfma_f32_16x16x32_bf16 v[80:83], a[216:219], v[56:59], v[80:83]
    ds_read_b128 v[48:51], v14 offset:61440
    v_mfma_f32_16x16x32_bf16 v[84:87], a[220:223], v[56:59], v[84:87]
    v_mfma_f32_16x16x32_bf16 v[88:91], a[216:219], v[60:63], v[88:91]
    ds_read_b128 v[52:55], v14 offset:62464
    v_mfma_f32_16x16x32_bf16 v[92:95], a[220:223], v[60:63], v[92:95]
    s_waitcnt lgkmcnt(4)
    v_mfma_f32_16x16x32_bf16 v[80:83], a[224:227], v[32:35], v[80:83]
    ds_read_b128 v[56:59], v15 offset:61440
    v_mfma_f32_16x16x32_bf16 v[84:87], a[228:231], v[32:35], v[84:87]
    v_mfma_f32_16x16x32_bf16 v[88:91], a[224:227], v[36:39], v[88:91]
    ds_read_b128 v[60:63], v15 offset:62464
    s_add_u32 m0, s34, 73472
    v_mfma_f32_16x16x32_bf16 v[92:95], a[228:231], v[36:39], v[92:95]
    buffer_load_dwordx4 v8, s[12:15], s35 offen offset:256 lds
    s_waitcnt lgkmcnt(4)
    v_mfma_f32_16x16x32_bf16 v[80:83], a[232:235], v[40:43], v[80:83]
    ds_read_b128 v[32:35], v12 offset:0
    v_mfma_f32_16x16x32_bf16 v[84:87], a[236:239], v[40:43], v[84:87]
    v_mfma_f32_16x16x32_bf16 v[88:91], a[232:235], v[44:47], v[88:91]
    ds_read_b128 v[36:39], v12 offset:1024
    v_mfma_f32_16x16x32_bf16 v[92:95], a[236:239], v[44:47], v[92:95]
    s_waitcnt lgkmcnt(4)
    v_mfma_f32_16x16x32_bf16 v[80:83], a[240:243], v[48:51], v[80:83]
    ds_read_b128 v[40:43], v13 offset:0
    v_mfma_f32_16x16x32_bf16 v[84:87], a[244:247], v[48:51], v[84:87]
    v_mfma_f32_16x16x32_bf16 v[88:91], a[240:243], v[52:55], v[88:91]
    ds_read_b128 v[44:47], v13 offset:1024
    s_add_u32 m0, s34, 77440
    v_mfma_f32_16x16x32_bf16 v[92:95], a[244:247], v[52:55], v[92:95]
    buffer_load_dwordx4 v8, s[12:15], s35 offen offset:384 lds
    s_waitcnt lgkmcnt(4)
    v_mfma_f32_16x16x32_bf16 v[80:83], a[248:251], v[56:59], v[80:83]
    ds_read_b128 v[48:51], v12 offset:4096
    v_mfma_f32_16x16x32_bf16 v[84:87], a[252:255], v[56:59], v[84:87]
    v_mfma_f32_16x16x32_bf16 v[88:91], a[248:251], v[60:63], v[88:91]
    ds_read_b128 v[52:55], v12 offset:5120
    v_mfma_f32_16x16x32_bf16 v[92:95], a[252:255], v[60:63], v[92:95]
    s_add_u32 s30, s30, 2
    s_cmp_lt_u32 s30, s51
    s_cbranch_scc1 sl_loop_46
    v_cvt_pk_bf16_f32 v96, v80, v81
    v_cvt_pk_bf16_f32 v97, v82, v83
    v_cvt_pk_bf16_f32 v98, v84, v85
    v_cvt_pk_bf16_f32 v99, v86, v87
    v_cvt_pk_bf16_f32 v100, v88, v89
    v_cvt_pk_bf16_f32 v101, v90, v91
    v_cvt_pk_bf16_f32 v102, v92, v93
    v_cvt_pk_bf16_f32 v103, v94, v95
    s_branch sl_e_45
sl_v_44:
sl_loop_47:
    s_waitcnt lgkmcnt(4)
    v_mfma_f32_16x16x32_bf16 v[64:67], v[32:35], a[0:3], 0
    ds_read_b128 v[56:59], v13 offset:4096
    v_mfma_f32_16x16x32_bf16 v[68:71], v[32:35], a[4:7], 0
    v_mfma_f32_16x16x32_bf16 v[72:75], v[36:39], a[0:3], 0
    ds_read_b128 v[60:63], v13 offset:5120
    s_add_u32 m0, s34, 81408
    v_mfma_f32_16x16x32_bf16 v[76:79], v[36:39], a[4:7], 0
    buffer_load_dwordx4 v8, s[12:15], s35 offen offset:512 lds
    s_waitcnt lgkmcnt(4)
    v_mfma_f32_16x16x32_bf16 v[64:67], v[40:43], a[8:11], v[64:67]
    ds_read_b128 v[32:35], v12 offset:8192
    v_mfma_f32_16x16x32_bf16 v[68:71], v[40:43], a[12:15], v[68:71]
    v_mfma_f32_16x16x32_bf16 v[72:75], v[44:47], a[8:11], v[72:75]
    ds_read_b128 v[36:39], v12 offset:9216
    v_mfma_f32_16x16x32_bf16 v[76:79], v[44:47], a[12:15], v[76:79]
    s_waitcnt lgkmcnt(4)
    v_mfma_f32_16x16x32_bf16 v[64:67], v[48:51], a[16:19], v[64:67]
    ds_read_b128 v[40:43], v13 offset:8192
    v_mfma_f32_16x16x32_bf16 v[68:71], v[48:51], a[20:23], v[68:71]
    v_cvt_pk_bf16_f32 v96, v80, v81
    v_mfma_f32_16x16x32_bf16 v[72:75], v[52:55], a[16:19], v[72:75]
    ds_read_b128 v[44:47], v13 offset:9216
    s_add_u32 m0, s34, 85376
    v_mfma_f32_16x16x32_bf16 v[76:79], v[52:55], a[20:23], v[76:79]
    buffer_load_dwordx4 v8, s[12:15], s35 offen offset:640 lds
    v_cvt_pk_bf16_f32 v97, v82, v83
    s_waitcnt lgkmcnt(4)
    v_mfma_f32_16x16x32_bf16 v[64:67], v[56:59], a[24:27], v[64:67]
    ds_read_b128 v[48:51], v12 offset:12288
    v_mfma_f32_16x16x32_bf16 v[68:71], v[56:59], a[28:31], v[68:71]
    v_cvt_pk_bf16_f32 v98, v88, v89
    v_mfma_f32_16x16x32_bf16 v[72:75], v[60:63], a[24:27], v[72:75]
    ds_read_b128 v[52:55], v12 offset:13312
    v_mfma_f32_16x16x32_bf16 v[76:79], v[60:63], a[28:31], v[76:79]
    v_cvt_pk_bf16_f32 v99, v90, v91
    s_waitcnt lgkmcnt(4)
    v_mfma_f32_16x16x32_bf16 v[64:67], v[32:35], a[32:35], v[64:67]
    ds_read_b128 v[56:59], v13 offset:12288
    v_mfma_f32_16x16x32_bf16 v[68:71], v[32:35], a[36:39], v[68:71]
    v_cvt_pk_bf16_f32 v100, v84, v85
    v_mfma_f32_16x16x32_bf16 v[72:75], v[36:39], a[32:35], v[72:75]
    ds_read_b128 v[60:63], v13 offset:13312
    s_add_u32 m0, s34, 89344
    v_mfma_f32_16x16x32_bf16 v[76:79], v[36:39], a[36:39], v[76:79]
    buffer_load_dwordx4 v8, s[12:15], s35 offen offset:768 lds
    v_cvt_pk_bf16_f32 v101, v86, v87
    s_waitcnt lgkmcnt(4)
    v_mfma_f32_16x16x32_bf16 v[64:67], v[40:43], a[40:43], v[64:67]
    ds_read_b128 v[32:35], v12 offset:16384
    v_mfma_f32_16x16x32_bf16 v[68:71], v[40:43], a[44:47], v[68:71]
    v_cvt_pk_bf16_f32 v102, v92, v93
    v_mfma_f32_16x16x32_bf16 v[72:75], v[44:47], a[40:43], v[72:75]
    ds_read_b128 v[36:39], v12 offset:17408
    v_mfma_f32_16x16x32_bf16 v[76:79], v[44:47], a[44:47], v[76:79]
    v_cvt_pk_bf16_f32 v103, v94, v95
    buffer_store_dwordx4 v[96:99], v9, s[4:7], s36 offen sc1
    s_waitcnt lgkmcnt(4)
    v_mfma_f32_16x16x32_bf16 v[64:67], v[48:51], a[48:51], v[64:67]
    ds_read_b128 v[40:43], v13 offset:16384
    v_mfma_f32_16x16x32_bf16 v[68:71], v[48:51], a[52:55], v[68:71]
    v_mfma_f32_16x16x32_bf16 v[72:75], v[52:55], a[48:51], v[72:75]
    ds_read_b128 v[44:47], v13 offset:17408
    s_add_u32 m0, s34, 93312
    v_mfma_f32_16x16x32_bf16 v[76:79], v[52:55], a[52:55], v[76:79]
    buffer_load_dwordx4 v8, s[12:15], s35 offen offset:896 lds
    s_waitcnt lgkmcnt(4)
    v_mfma_f32_16x16x32_bf16 v[64:67], v[56:59], a[56:59], v[64:67]
    ds_read_b128 v[48:51], v12 offset:20480
    v_mfma_f32_16x16x32_bf16 v[68:71], v[56:59], a[60:63], v[68:71]
    v_mfma_f32_16x16x32_bf16 v[72:75], v[60:63], a[56:59], v[72:75]
    ds_read_b128 v[52:55], v12 offset:21504
    v_mfma_f32_16x16x32_bf16 v[76:79], v[60:63], a[60:63], v[76:79]
    buffer_store_dwordx4 v[100:103], v9, s[4:7], s36 offen offset:128 sc1
    s_add_u32 s36, s36, s37
    s_waitcnt vmcnt(8)
    s_barrier
    s_waitcnt lgkmcnt(4)
    v_mfma_f32_16x16x32_bf16 v[64:67], v[32:35], a[64:67], v[64:67]
    ds_read_b128 v[56:59], v13 offset:20480
    v_mfma_f32_16x16x32_bf16 v[68:71], v[32:35], a[68:71], v[68:71]
    v_mfma_f32_16x16x32_bf16 v[72:75], v[36:39], a[64:67], v[72:75]
    ds_read_b128 v[60:63], v13 offset:21504
    s_add_u32 m0, s34, 97280
    v_mfma_f32_16x16x32_bf16 v[76:79], v[36:39], a[68:71], v[76:79]
    buffer_load_dwordx4 v8, s[12:15], s35 offen offset:1024 lds
    s_waitcnt lgkmcnt(4)
    v_mfma_f32_16x16x32_bf16 v[64:67], v[40:43], a[72:75], v[64:67]
    ds_read_b128 v[32:35], v12 offset:24576
    v_mfma_f32_16x16x32_bf16 v[68:71], v[40:43], a[76:79], v[68:71]
    v_mfma_f32_16x16x32_bf16 v[72:75], v[44:47], a[72:75], v[72:75]
    ds_read_b128 v[36:39], v12 offset:25600
    v_mfma_f32_16x16x32_bf16 v[76:79], v[44:47], a[76:79], v[76:79]
    s_waitcnt lgkmcnt(4)
    v_mfma_f32_16x16x32_bf16 v[64:67], v[48:51], a[80:83], v[64:67]
    ds_read_b128 v[40:43], v13 offset:24576
    v_mfma_f32_16x16x32_bf16 v[68:71], v[48:51], a[84:87], v[68:71]
    v_and_b32 v9, 0xffffff, v9
    v_mfma_f32_16x16x32_bf16 v[72:75], v[52:55], a[80:83], v[72:75]
    ds_read_b128 v[44:47], v13 offset:25600
    s_add_u32 m0, s34, 101248
    v_mfma_f32_16x16x32_bf16 v[76:79], v[52:55], a[84:87], v[76:79]
    buffer_load_dwordx4 v8, s[12:15], s35 offen offset:1152 lds
    s_waitcnt lgkmcnt(4)
    v_mfma_f32_16x16x32_bf16 v[64:67], v[56:59], a[88:91], v[64:67]
    ds_read_b128 v[48:51], v12 offset:28672
    v_mfma_f32_16x16x32_bf16 v[68:71], v[56:59], a[92:95], v[68:71]
    v_mfma_f32_16x16x32_bf16 v[72:75], v[60:63], a[88:91], v[72:75]
    ds_read_b128 v[52:55], v12 offset:29696
    v_mfma_f32_16x16x32_bf16 v[76:79], v[60:63], a[92:95], v[76:79]
    s_waitcnt lgkmcnt(4)
    v_mfma_f32_16x16x32_bf16 v[64:67], v[32:35], a[96:99], v[64:67]
    ds_read_b128 v[56:59], v13 offset:28672
    v_mfma_f32_16x16x32_bf16 v[68:71], v[32:35], a[100:103], v[68:71]
    v_mfma_f32_16x16x32_bf16 v[72:75], v[36:39], a[96:99], v[72:75]
    ds_read_b128 v[60:63], v13 offset:29696
    s_add_u32 m0, s34, 105216
    v_mfma_f32_16x16x32_bf16 v[76:79], v[36:39], a[100:103], v[76:79]
    buffer_load_dwordx4 v8, s[12:15], s35 offen offset:1280 lds
    s_waitcnt lgkmcnt(4)
    v_mfma_f32_16x16x32_bf16 v[64:67], v[40:43], a[104:107], v[64:67]
    ds_read_b128 v[32:35], v12 offset:32768
    v_mfma_f32_16x16x32_bf16 v[68:71], v[40:43], a[108:111], v[68:71]
    v_mfma_f32_16x16x32_bf16 v[72:75], v[44:47], a[104:107], v[72:75]
    ds_read_b128 v[36:39], v12 offset:33792
    v_mfma_f32_16x16x32_bf16 v[76:79], v[44:47], a[108:111], v[76:79]
    s_waitcnt lgkmcnt(4)
    v_mfma_f32_16x16x32_bf16 v[64:67], v[48:51], a[112:115], v[64:67]
    ds_read_b128 v[40:43], v13 offset:32768
    v_mfma_f32_16x16x32_bf16 v[68:71], v[48:51], a[116:119], v[68:71]
    v_mfma_f32_16x16x32_bf16 v[72:75], v[52:55], a[112:115], v[72:75]
    ds_read_b128 v[44:47], v13 offset:33792
    s_add_u32 m0, s34, 109184
    v_mfma_f32_16x16x32_bf16 v[76:79], v[52:55], a[116:119], v[76:79]
    buffer_load_dwordx4 v8, s[12:15], s35 offen offset:1408 lds
    s_waitcnt lgkmcnt(4)
    v_mfma_f32_16x16x32_bf16 v[64:67], v[56:59], a[120:123], v[64:67]
    ds_read_b128 v[48:51], v12 offset:36864
    v_mfma_f32_16x16x32_bf16 v[68:71], v[56:59], a[124:127], v[68:71]
    v_mfma_f32_16x16x32_bf16 v[72:75], v[60:63], a[120:123], v[72:75]
    ds_read_b128 v[52:55], v12 offset:37888
    v_mfma_f32_16x16x32_bf16 v[76:79], v[60:63], a[124:127], v[76:79]
    s_waitcnt lgkmcnt(4)
    v_mfma_f32_16x16x32_bf16 v[64:67], v[32:35], a[128:131], v[64:67]
    ds_read_b128 v[56:59], v13 offset:36864
    v_mfma_f32_16x16x32_bf16 v[68:71], v[32:35], a[132:135], v[68:71]
    v_mfma_f32_16x16x32_bf16 v[72:75], v[36:39], a[128:131], v[72:75]
    ds_read_b128 v[60:63], v13 offset:37888
    s_add_u32 m0, s34, 113152
    v_mfma_f32_16x16x32_bf16 v[76:79], v[36:39], a[132:135], v[76:79]
    buffer_load_dwordx4 v8, s[12:15], s35 offen offset:1536 lds
    s_waitcnt lgkmcnt(4)
    v_mfma_f32_16x16x32_bf16 v[64:67], v[40:43], a[136:139], v[64:67]
    ds_read_b128 v[32:35], v12 offset:40960
    v_mfma_f32_16x16x32_bf16 v[68:71], v[40:43], a[140:143], v[68:71]
    v_mfma_f32_16x16x32_bf16 v[72:75], v[44:47], a[136:139], v[72:75]
    ds_read_b128 v[36:39], v12 offset:41984
    v_mfma_f32_16x16x32_bf16 v[76:79], v[44:47], a[140:143], v[76:79]
    s_waitcnt lgkmcnt(4)
    v_mfma_f32_16x16x32_bf16 v[64:67], v[48:51], a[144:147], v[64:67]
    ds_read_b128 v[40:43], v13 offset:40960
    v_mfma_f32_16x16x32_bf16 v[68:71], v[48:51], a[148:151], v[68:71]
    v_mfma_f32_16x16x32_bf16 v[72:75], v[52:55], a[144:147], v[72:75]
    ds_read_b128 v[44:47], v13 offset:41984
    s_add_u32 m0, s34, 117120
    v_mfma_f32_16x16x32_bf16 v[76:79], v[52:55], a[148:151], v[76:79]
    buffer_load_dwordx4 v8, s[12:15], s35 offen offset:1664 lds
    s_waitcnt lgkmcnt(4)
    v_mfma_f32_16x16x32_bf16 v[64:67], v[56:59], a[152:155], v[64:67]
    ds_read_b128 v[48:51], v12 offset:45056
    v_mfma_f32_16x16x32_bf16 v[68:71], v[56:59], a[156:159], v[68:71]
    v_mfma_f32_16x16x32_bf16 v[72:75], v[60:63], a[152:155], v[72:75]
    ds_read_b128 v[52:55], v12 offset:46080
    v_mfma_f32_16x16x32_bf16 v[76:79], v[60:63], a[156:159], v[76:79]
    s_waitcnt lgkmcnt(4)
    v_mfma_f32_16x16x32_bf16 v[64:67], v[32:35], a[160:163], v[64:67]
    ds_read_b128 v[56:59], v13 offset:45056
    v_mfma_f32_16x16x32_bf16 v[68:71], v[32:35], a[164:167], v[68:71]
    v_mfma_f32_16x16x32_bf16 v[72:75], v[36:39], a[160:163], v[72:75]
    ds_read_b128 v[60:63], v13 offset:46080
    s_add_u32 m0, s34, 121088
    v_mfma_f32_16x16x32_bf16 v[76:79], v[36:39], a[164:167], v[76:79]
    buffer_load_dwordx4 v8, s[12:15], s35 offen offset:1792 lds
    s_waitcnt lgkmcnt(4)
    v_mfma_f32_16x16x32_bf16 v[64:67], v[40:43], a[168:171], v[64:67]
    ds_read_b128 v[32:35], v12 offset:49152
    v_mfma_f32_16x16x32_bf16 v[68:71], v[40:43], a[172:175], v[68:71]
    v_mfma_f32_16x16x32_bf16 v[72:75], v[44:47], a[168:171], v[72:75]
    ds_read_b128 v[36:39], v12 offset:50176
    v_mfma_f32_16x16x32_bf16 v[76:79], v[44:47], a[172:175], v[76:79]
    s_waitcnt lgkmcnt(4)
    v_mfma_f32_16x16x32_bf16 v[64:67], v[48:51], a[176:179], v[64:67]
    ds_read_b128 v[40:43], v13 offset:49152
    v_mfma_f32_16x16x32_bf16 v[68:71], v[48:51], a[180:183], v[68:71]
    v_mfma_f32_16x16x32_bf16 v[72:75], v[52:55], a[176:179], v[72:75]
    ds_read_b128 v[44:47], v13 offset:50176
    s_add_u32 m0, s34, 125056
    v_mfma_f32_16x16x32_bf16 v[76:79], v[52:55], a[180:183], v[76:79]
    buffer_load_dwordx4 v8, s[12:15], s35 offen offset:1920 lds
    s_add_u32 s35, s35, 65536
    s_min_u32 s35, s35, s52
    s_waitcnt lgkmcnt(4)
    v_mfma_f32_16x16x32_bf16 v[64:67], v[56:59], a[184:187], v[64:67]
    ds_read_b128 v[48:51], v12 offset:53248
    v_mfma_f32_16x16x32_bf16 v[68:71], v[56:59], a[188:191], v[68:71]
    v_mfma_f32_16x16x32_bf16 v[72:75], v[60:63], a[184:187], v[72:75]
    ds_read_b128 v[52:55], v12 offset:54272
    v_mfma_f32_16x16x32_bf16 v[76:79], v[60:63], a[188:191], v[76:79]
    s_waitcnt vmcnt(8)
    s_barrier
    s_waitcnt lgkmcnt(4)
    v_mfma_f32_16x16x32_bf16 v[64:67], v[32:35], a[192:195], v[64:67]
    ds_read_b128 v[56:59], v13 offset:53248
    v_mfma_f32_16x16x32_bf16 v[68:71], v[32:35], a[196:199], v[68:71]
    v_mfma_f32_16x16x32_bf16 v[72:75], v[36:39], a[192:195], v[72:75]
    ds_read_b128 v[60:63], v13 offset:54272
    s_add_u32 m0, s34, 0
    v_mfma_f32_16x16x32_bf16 v[76:79], v[36:39], a[196:199], v[76:79]
    buffer_load_dwordx4 v8, s[12:15], s35 offen offset:0 lds
    s_waitcnt lgkmcnt(4)
    v_mfma_f32_16x16x32_bf16 v[64:67], v[40:43], a[200:203], v[64:67]
    ds_read_b128 v[32:35], v12 offset:57344
    v_mfma_f32_16x16x32_bf16 v[68:71], v[40:43], a[204:207], v[68:71]
    buffer_store_dword v11, v10, s[4:7], 0 offen sc1
    v_add_u32 v11, 1, v11
    v_mfma_f32_16x16x32_bf16 v[72:75], v[44:47], a[200:203], v[72:75]
    ds_read_b128 v[36:39], v12 offset:58368
    v_mfma_f32_16x16x32_bf16 v[76:79], v[44:47], a[204:207], v[76:79]
    s_waitcnt lgkmcnt(4)
    v_mfma_f32_16x16x32_bf16 v[64:67], v[48:51], a[208:211], v[64:67]
    ds_read_b128 v[40:43], v13 offset:57344
    v_mfma_f32_16x16x32_bf16 v[68:71], v[48:51], a[212:215], v[68:71]
    v_mfma_f32_16x16x32_bf16 v[72:75], v[52:55], a[208:211], v[72:75]
    ds_read_b128 v[44:47], v13 offset:58368
    s_add_u32 m0, s34, 3968
    v_mfma_f32_16x16x32_bf16 v[76:79], v[52:55], a[212:215], v[76:79]
    buffer_load_dwordx4 v8, s[12:15], s35 offen offset:128 lds
    s_waitcnt lgkmcnt(4)
    v_mfma_f32_16x16x32_bf16 v[64:67], v[56:59], a[216:219], v[64:67]
    ds_read_b128 v[48:51], v12 offset:61440
    v_mfma_f32_16x16x32_bf16 v[68:71], v[56:59], a[220:223], v[68:71]
    v_mfma_f32_16x16x32_bf16 v[72:75], v[60:63], a[216:219], v[72:75]
    ds_read_b128 v[52:55], v12 offset:62464
    v_mfma_f32_16x16x32_bf16 v[76:79], v[60:63], a[220:223], v[76:79]
    s_waitcnt lgkmcnt(4)
    v_mfma_f32_16x16x32_bf16 v[64:67], v[32:35], a[224:227], v[64:67]
    ds_read_b128 v[56:59], v13 offset:61440
    v_mfma_f32_16x16x32_bf16 v[68:71], v[32:35], a[228:231], v[68:71]
    v_mfma_f32_16x16x32_bf16 v[72:75], v[36:39], a[224:227], v[72:75]
    ds_read_b128 v[60:63], v13 offset:62464
    s_add_u32 m0, s34, 7936
    v_mfma_f32_16x16x32_bf16 v[76:79], v[36:39], a[228:231], v[76:79]
    buffer_load_dwordx4 v8, s[12:15], s35 offen offset:256 lds
    s_waitcnt lgkmcnt(4)
    v_mfma_f32_16x16x32_bf16 v[64:67], v[40:43], a[232:235], v[64:67]
    ds_read_b128 v[32:35], v14 offset:0
    v_mfma_f32_16x16x32_bf16 v[68:71], v[40:43], a[236:239], v[68:71]
    v_mfma_f32_16x16x32_bf16 v[72:75], v[44:47], a[232:235], v[72:75]
    ds_read_b128 v[36:39], v14 offset:1024
    v_mfma_f32_16x16x32_bf16 v[76:79], v[44:47], a[236:239], v[76:79]
    s_waitcnt lgkmcnt(4)
    v_mfma_f32_16x16x32_bf16 v[64:67], v[48:51], a[240:243], v[64:67]
    ds_read_b128 v[40:43], v15 offset:0
    v_mfma_f32_16x16x32_bf16 v[68:71], v[48:51], a[244:247], v[68:71]
    v_mfma_f32_16x16x32_bf16 v[72:75], v[52:55], a[240:243], v[72:75]
    ds_read_b128 v[44:47], v15 offset:1024
    s_add_u32 m0, s34, 11904
    v_mfma_f32_16x16x32_bf16 v[76:79], v[52:55], a[244:247], v[76:79]
    buffer_load_dwordx4 v8, s[12:15], s35 offen offset:384 lds
    s_waitcnt lgkmcnt(4)
    v_mfma_f32_16x16x32_bf16 v[64:67], v[56:59], a[248:251], v[64:67]
    ds_read_b128 v[48:51], v14 offset:4096
    v_mfma_f32_16x16x32_bf16 v[68:71], v[56:59], a[252:255], v[68:71]
    v_mfma_f32_16x16x32_bf16 v[72:75], v[60:63], a[248:251], v[72:75]
    ds_read_b128 v[52:55], v14 offset:5120
    v_mfma_f32_16x16x32_bf16 v[76:79], v[60:63], a[252:255], v[76:79]
    s_waitcnt lgkmcnt(4)
    v_mfma_f32_16x16x32_bf16 v[80:83], v[32:35], a[0:3], 0
    ds_read_b128 v[56:59], v15 offset:4096
    v_mfma_f32_16x16x32_bf16 v[84:87], v[32:35], a[4:7], 0
    v_mfma_f32_16x16x32_bf16 v[88:91], v[36:39], a[0:3], 0
    ds_read_b128 v[60:63], v15 offset:5120
    s_add_u32 m0, s34, 15872
    v_mfma_f32_16x16x32_bf16 v[92:95], v[36:39], a[4:7], 0
    buffer_load_dwordx4 v8, s[12:15], s35 offen offset:512 lds
    s_waitcnt lgkmcnt(4)
    v_mfma_f32_16x16x32_bf16 v[80:83], v[40:43], a[8:11], v[80:83]
    ds_read_b128 v[32:35], v14 offset:8192
    v_mfma_f32_16x16x32_bf16 v[84:87], v[40:43], a[12:15], v[84:87]
    v_mfma_f32_16x16x32_bf16 v[88:91], v[44:47], a[8:11], v[88:91]
    ds_read_b128 v[36:39], v14 offset:9216
    v_mfma_f32_16x16x32_bf16 v[92:95], v[44:47], a[12:15], v[92:95]
    s_waitcnt lgkmcnt(4)
    v_mfma_f32_16x16x32_bf16 v[80:83], v[48:51], a[16:19], v[80:83]
    ds_read_b128 v[40:43], v15 offset:8192
    v_mfma_f32_16x16x32_bf16 v[84:87], v[48:51], a[20:23], v[84:87]
    v_cvt_pk_bf16_f32 v96, v64, v65
    v_mfma_f32_16x16x32_bf16 v[88:91], v[52:55], a[16:19], v[88:91]
    ds_read_b128 v[44:47], v15 offset:9216
    s_add_u32 m0, s34, 19840
    v_mfma_f32_16x16x32_bf16 v[92:95], v[52:55], a[20:23], v[92:95]
    buffer_load_dwordx4 v8, s[12:15], s35 offen offset:640 lds
    v_cvt_pk_bf16_f32 v97, v66, v67
    s_waitcnt lgkmcnt(4)
    v_mfma_f32_16x16x32_bf16 v[80:83], v[56:59], a[24:27], v[80:83]
    ds_read_b128 v[48:51], v14 offset:12288
    v_mfma_f32_16x16x32_bf16 v[84:87], v[56:59], a[28:31], v[84:87]
    v_cvt_pk_bf16_f32 v98, v72, v73
    v_mfma_f32_16x16x32_bf16 v[88:91], v[60:63], a[24:27], v[88:91]
    ds_read_b128 v[52:55], v14 offset:13312
    v_mfma_f32_16x16x32_bf16 v[92:95], v[60:63], a[28:31], v[92:95]
    v_cvt_pk_bf16_f32 v99, v74, v75
    s_waitcnt lgkmcnt(4)
    v_mfma_f32_16x16x32_bf16 v[80:83], v[32:35], a[32:35], v[80:83]
    ds_read_b128 v[56:59], v15 offset:12288
    v_mfma_f32_16x16x32_bf16 v[84:87], v[32:35], a[36:39], v[84:87]
    v_cvt_pk_bf16_f32 v100, v68, v69
    v_mfma_f32_16x16x32_bf16 v[88:91], v[36:39], a[32:35], v[88:91]
    ds_read_b128 v[60:63], v15 offset:13312
    s_add_u32 m0, s34, 23808
    v_mfma_f32_16x16x32_bf16 v[92:95], v[36:39], a[36:39], v[92:95]
    buffer_load_dwordx4 v8, s[12:15], s35 offen offset:768 lds
    v_cvt_pk_bf16_f32 v101, v70, v71
    s_waitcnt lgkmcnt(4)
    v_mfma_f32_16x16x32_bf16 v[80:83], v[40:43], a[40:43], v[80:83]
    ds_read_b128 v[32:35], v14 offset:16384
    v_mfma_f32_16x16x32_bf16 v[84:87], v[40:43], a[44:47], v[84:87]
    v_cvt_pk_bf16_f32 v102, v76, v77
    v_mfma_f32_16x16x32_bf16 v[88:91], v[44:47], a[40:43], v[88:91]
    ds_read_b128 v[36:39], v14 offset:17408
    v_mfma_f32_16x16x32_bf16 v[92:95], v[44:47], a[44:47], v[92:95]
    v_cvt_pk_bf16_f32 v103, v78, v79
    buffer_store_dwordx4 v[96:99], v9, s[4:7], s36 offen sc1
    s_waitcnt lgkmcnt(4)
    v_mfma_f32_16x16x32_bf16 v[80:83], v[48:51], a[48:51], v[80:83]
    ds_read_b128 v[40:43], v15 offset:16384
    v_mfma_f32_16x16x32_bf16 v[84:87], v[48:51], a[52:55], v[84:87]
    v_mfma_f32_16x16x32_bf16 v[88:91], v[52:55], a[48:51], v[88:91]
    ds_read_b128 v[44:47], v15 offset:17408
    s_add_u32 m0, s34, 27776
    v_mfma_f32_16x16x32_bf16 v[92:95], v[52:55], a[52:55], v[92:95]
    buffer_load_dwordx4 v8, s[12:15], s35 offen offset:896 lds
    s_waitcnt lgkmcnt(4)
    v_mfma_f32_16x16x32_bf16 v[80:83], v[56:59], a[56:59], v[80:83]
    ds_read_b128 v[48:51], v14 offset:20480
    v_mfma_f32_16x16x32_bf16 v[84:87], v[56:59], a[60:63], v[84:87]
    v_mfma_f32_16x16x32_bf16 v[88:91], v[60:63], a[56:59], v[88:91]
    ds_read_b128 v[52:55], v14 offset:21504
    v_mfma_f32_16x16x32_bf16 v[92:95], v[60:63], a[60:63], v[92:95]
    buffer_store_dwordx4 v[100:103], v9, s[4:7], s36 offen offset:128 sc1
    s_add_u32 s36, s36, s37
    s_waitcnt vmcnt(8)
    s_barrier
    s_waitcnt lgkmcnt(4)
    v_mfma_f32_16x16x32_bf16 v[80:83], v[32:35], a[64:67], v[80:83]
    ds_read_b128 v[56:59], v15 offset:20480
    v_mfma_f32_16x16x32_bf16 v[84:87], v[32:35], a[68:71], v[84:87]
    v_mfma_f32_16x16x32_bf16 v[88:91], v[36:39], a[64:67], v[88:91]
    ds_read_b128 v[60:63], v15 offset:21504
    s_add_u32 m0, s34, 31744
    v_mfma_f32_16x16x32_bf16 v[92:95], v[36:39], a[68:71], v[92:95]
    buffer_load_dwordx4 v8, s[12:15], s35 offen offset:1024 lds
    s_waitcnt lgkmcnt(4)
    v_mfma_f32_16x16x32_bf16 v[80:83], v[40:43], a[72:75], v[80:83]
    ds_read_b128 v[32:35], v14 offset:24576
    v_mfma_f32_16x16x32_bf16 v[84:87], v[40:43], a[76:79], v[84:87]
    v_mfma_f32_16x16x32_bf16 v[88:91], v[44:47], a[72:75], v[88:91]
    ds_read_b128 v[36:39], v14 offset:25600
    v_mfma_f32_16x16x32_bf16 v[92:95], v[44:47], a[76:79], v[92:95]
    s_waitcnt lgkmcnt(4)
    v_mfma_f32_16x16x32_bf16 v[80:83], v[48:51], a[80:83], v[80:83]
    ds_read_b128 v[40:43], v15 offset:24576
    v_mfma_f32_16x16x32_bf16 v[84:87], v[48:51], a[84:87], v[84:87]
    v_mfma_f32_16x16x32_bf16 v[88:91], v[52:55], a[80:83], v[88:91]
    ds_read_b128 v[44:47], v15 offset:25600
    s_add_u32 m0, s34, 35712
    v_mfma_f32_16x16x32_bf16 v[92:95], v[52:55], a[84:87], v[92:95]
    buffer_load_dwordx4 v8, s[12:15], s35 offen offset:1152 lds
    s_waitcnt lgkmcnt(4)
    v_mfma_f32_16x16x32_bf16 v[80:83], v[56:59], a[88:91], v[80:83]
    ds_read_b128 v[48:51], v14 offset:28672
    v_mfma_f32_16x16x32_bf16 v[84:87], v[56:59], a[92:95], v[84:87]
    v_mfma_f32_16x16x32_bf16 v[88:91], v[60:63], a[88:91], v[88:91]
    ds_read_b128 v[52:55], v14 offset:29696
    v_mfma_f32_16x16x32_bf16 v[92:95], v[60:63], a[92:95], v[92:95]
    s_waitcnt lgkmcnt(4)
    v_mfma_f32_16x16x32_bf16 v[80:83], v[32:35], a[96:99], v[80:83]
    ds_read_b128 v[56:59], v15 offset:28672
    v_mfma_f32_16x16x32_bf16 v[84:87], v[32:35], a[100:103], v[84:87]
    v_mfma_f32_16x16x32_bf16 v[88:91], v[36:39], a[96:99], v[88:91]
    ds_read_b128 v[60:63], v15 offset:29696
    s_add_u32 m0, s34, 39680
    v_mfma_f32_16x16x32_bf16 v[92:95], v[36:39], a[100:103], v[92:95]
    buffer_load_dwordx4 v8, s[12:15], s35 offen offset:1280 lds
    s_waitcnt lgkmcnt(4)
    v_mfma_f32_16x16x32_bf16 v[80:83], v[40:43], a[104:107], v[80:83]
    ds_read_b128 v[32:35], v14 offset:32768
    v_mfma_f32_16x16x32_bf16 v[84:87], v[40:43], a[108:111], v[84:87]
    v_mfma_f32_16x16x32_bf16 v[88:91], v[44:47], a[104:107], v[88:91]
    ds_read_b128 v[36:39], v14 offset:33792
    v_mfma_f32_16x16x32_bf16 v[92:95], v[44:47], a[108:111], v[92:95]
    s_waitcnt lgkmcnt(4)
    v_mfma_f32_16x16x32_bf16 v[80:83], v[48:51], a[112:115], v[80:83]
    ds_read_b128 v[40:43], v15 offset:32768
    v_mfma_f32_16x16x32_bf16 v[84:87], v[48:51], a[116:119], v[84:87]
    v_mfma_f32_16x16x32_bf16 v[88:91], v[52:55], a[112:115], v[88:91]
    ds_read_b128 v[44:47], v15 offset:33792
    s_add_u32 m0, s34, 43648
    v_mfma_f32_16x16x32_bf16 v[92:95], v[52:55], a[116:119], v[92:95]
    buffer_load_dwordx4 v8, s[12:15], s35 offen offset:1408 lds
    s_waitcnt lgkmcnt(4)
    v_mfma_f32_16x16x32_bf16 v[80:83], v[56:59], a[120:123], v[80:83]
    ds_read_b128 v[48:51], v14 offset:36864
    v_mfma_f32_16x16x32_bf16 v[84:87], v[56:59], a[124:127], v[84:87]
    v_mfma_f32_16x16x32_bf16 v[88:91], v[60:63], a[120:123], v[88:91]
    ds_read_b128 v[52:55], v14 offset:37888
    v_mfma_f32_16x16x32_bf16 v[92:95], v[60:63], a[124:127], v[92:95]
    s_waitcnt lgkmcnt(4)
    v_mfma_f32_16x16x32_bf16 v[80:83], v[32:35], a[128:131], v[80:83]
    ds_read_b128 v[56:59], v15 offset:36864
    v_mfma_f32_16x16x32_bf16 v[84:87], v[32:35], a[132:135], v[84:87]
    v_mfma_f32_16x16x32_bf16 v[88:91], v[36:39], a[128:131], v[88:91]
    ds_read_b128 v[60:63], v15 offset:37888
    s_add_u32 m0, s34, 47616
    v_mfma_f32_16x16x32_bf16 v[92:95], v[36:39], a[132:135], v[92:95]
    buffer_load_dwordx4 v8, s[12:15], s35 offen offset:1536 lds
    s_waitcnt lgkmcnt(4)
    v_mfma_f32_16x16x32_bf16 v[80:83], v[40:43], a[136:139], v[80:83]
    ds_read_b128 v[32:35], v14 offset:40960
    v_mfma_f32_16x16x32_bf16 v[84:87], v[40:43], a[140:143], v[84:87]
    v_mfma_f32_16x16x32_bf16 v[88:91], v[44:47], a[136:139], v[88:91]
    ds_read_b128 v[36:39], v14 offset:41984
    v_mfma_f32_16x16x32_bf16 v[92:95], v[44:47], a[140:143], v[92:95]
    s_waitcnt lgkmcnt(4)
    v_mfma_f32_16x16x32_bf16 v[80:83], v[48:51], a[144:147], v[80:83]
    ds_read_b128 v[40:43], v15 offset:40960
    v_mfma_f32_16x16x32_bf16 v[84:87], v[48:51], a[148:151], v[84:87]
    v_mfma_f32_16x16x32_bf16 v[88:91], v[52:55], a[144:147], v[88:91]
    ds_read_b128 v[44:47], v15 offset:41984
    s_add_u32 m0, s34, 51584
    v_mfma_f32_16x16x32_bf16 v[92:95], v[52:55], a[148:151], v[92:95]
    buffer_load_dwordx4 v8, s[12:15], s35 offen offset:1664 lds
    s_waitcnt lgkmcnt(4)
    v_mfma_f32_16x16x32_bf16 v[80:83], v[56:59], a[152:155], v[80:83]
    ds_read_b128 v[48:51], v14 offset:45056
    v_mfma_f32_16x16x32_bf16 v[84:87], v[56:59], a[156:159], v[84:87]
    v_mfma_f32_16x16x32_bf16 v[88:91], v[60:63], a[152:155], v[88:91]
    ds_read_b128 v[52:55], v14 offset:46080
    v_mfma_f32_16x16x32_bf16 v[92:95], v[60:63], a[156:159], v[92:95]
    s_waitcnt lgkmcnt(4)
    v_mfma_f32_16x16x32_bf16 v[80:83], v[32:35], a[160:163], v[80:83]
    ds_read_b128 v[56:59], v15 offset:45056
    v_mfma_f32_16x16x32_bf16 v[84:87], v[32:35], a[164:167], v[84:87]
    v_mfma_f32_16x16x32_bf16 v[88:91], v[36:39], a[160:163], v[88:91]
    ds_read_b128 v[60:63], v15 offset:46080
    s_add_u32 m0, s34, 55552
    v_mfma_f32_16x16x32_bf16 v[92:95], v[36:39], a[164:167], v[92:95]
    buffer_load_dwordx4 v8, s[12:15], s35 offen offset:1792 lds
    s_waitcnt lgkmcnt(4)
    v_mfma_f32_16x16x32_bf16 v[80:83], v[40:43], a[168:171], v[80:83]
    ds_read_b128 v[32:35], v14 offset:49152
    v_mfma_f32_16x16x32_bf16 v[84:87], v[40:43], a[172:175], v[84:87]
    v_mfma_f32_16x16x32_bf16 v[88:91], v[44:47], a[168:171], v[88:91]
    ds_read_b128 v[36:39], v14 offset:50176
    v_mfma_f32_16x16x32_bf16 v[92:95], v[44:47], a[172:175], v[92:95]
    s_waitcnt lgkmcnt(4)
    v_mfma_f32_16x16x32_bf16 v[80:83], v[48:51], a[176:179], v[80:83]
    ds_read_b128 v[40:43], v15 offset:49152
    v_mfma_f32_16x16x32_bf16 v[84:87], v[48:51], a[180:183], v[84:87]
    v_mfma_f32_16x16x32_bf16 v[88:91], v[52:55], a[176:179], v[88:91]
    ds_read_b128 v[44:47], v15 offset:50176
    s_add_u32 m0, s34, 59520
    v_mfma_f32_16x16x32_bf16 v[92:95], v[52:55], a[180:183], v[92:95]
    buffer_load_dwordx4 v8, s[12:15], s35 offen offset:1920 lds
    s_add_u32 s35, s35, 65536
    s_min_u32 s35, s35, s52
    s_waitcnt lgkmcnt(4)
    v_mfma_f32_16x16x32_bf16 v[80:83], v[56:59], a[184:187], v[80:83]
    ds_read_b128 v[48:51], v14 offset:53248
    v_mfma_f32_16x16x32_bf16 v[84:87], v[56:59], a[188:191], v[84:87]
    v_mfma_f32_16x16x32_bf16 v[88:91], v[60:63], a[184:187], v[88:91]
    ds_read_b128 v[52:55], v14 offset:54272
    v_mfma_f32_16x16x32_bf16 v[92:95], v[60:63], a[188:191], v[92:95]
    s_waitcnt vmcnt(8)
    s_barrier
    s_waitcnt lgkmcnt(4)
    v_mfma_f32_16x16x32_bf16 v[80:83], v[32:35], a[192:195], v[80:83]
    ds_read_b128 v[56:59], v15 offset:53248
    v_mfma_f32_16x16x32_bf16 v[84:87], v[32:35], a[196:199], v[84:87]
    v_mfma_f32_16x16x32_bf16 v[88:91], v[36:39], a[192:195], v[88:91]
    ds_read_b128 v[60:63], v15 offset:54272
    s_add_u32 m0, s34, 65536
    v_mfma_f32_16x16x32_bf16 v[92:95], v[36:39], a[196:199], v[92:95]
    buffer_load_dwordx4 v8, s[12:15], s35 offen offset:0 lds
    s_waitcnt lgkmcnt(4)
    v_mfma_f32_16x16x32_bf16 v[80:83], v[40:43], a[200:203], v[80:83]
    ds_read_b128 v[32:35], v14 offset:57344
    v_mfma_f32_16x16x32_bf16 v[84:87], v[40:43], a[204:207], v[84:87]
    buffer_store_dword v11, v10, s[4:7], 0 offen sc1
    v_add_u32 v11, 1, v11
    v_mfma_f32_16x16x32_bf16 v[88:91], v[44:47], a[200:203], v[88:91]
    ds_read_b128 v[36:39], v14 offset:58368
    v_mfma_f32_16x16x32_bf16 v[92:95], v[44:47], a[204:207], v[92:95]
    s_waitcnt lgkmcnt(4)
    v_mfma_f32_16x16x32_bf16 v[80:83], v[48:51], a[208:211], v[80:83]
    ds_read_b128 v[40:43], v15 offset:57344
    v_mfma_f32_16x16x32_bf16 v[84:87], v[48:51], a[212:215], v[84:87]
    v_mfma_f32_16x16x32_bf16 v[88:91], v[52:55], a[208:211], v[88:91]
    ds_read_b128 v[44:47], v15 offset:58368
    s_add_u32 m0, s34, 69504
    v_mfma_f32_16x16x32_bf16 v[92:95], v[52:55], a[212:215], v[92:95]
    buffer_load_dwordx4 v8, s[12:15], s35 offen offset:128 lds
    s_waitcnt lgkmcnt(4)
    v_mfma_f32_16x16x32_bf16 v[80:83], v[56:59], a[216:219], v[80:83]
    ds_read_b128 v[48:51], v14 offset:61440
    v_mfma_f32_16x16x32_bf16 v[84:87], v[56:59], a[220:223], v[84:87]
    v_mfma_f32_16x16x32_bf16 v[88:91], v[60:63], a[216:219], v[88:91]
    ds_read_b128 v[52:55], v14 offset:62464
    v_mfma_f32_16x16x32_bf16 v[92:95], v[60:63], a[220:223], v[92:95]
    s_waitcnt lgkmcnt(4)
    v_mfma_f32_16x16x32_bf16 v[80:83], v[32:35], a[224:227], v[80:83]
    ds_read_b128 v[56:59], v15 offset:61440
    v_mfma_f32_16x16x32_bf16 v[84:87], v[32:35], a[228:231], v[84:87]
    v_mfma_f32_16x16x32_bf16 v[88:91], v[36:39], a[224:227], v[88:91]
    ds_read_b128 v[60:63], v15 offset:62464
    s_add_u32 m0, s34, 73472
    v_mfma_f32_16x16x32_bf16 v[92:95], v[36:39], a[228:231], v[92:95]
    buffer_load_dwordx4 v8, s[12:15], s35 offen offset:256 lds
    s_waitcnt lgkmcnt(4)
    v_mfma_f32_16x16x32_bf16 v[80:83], v[40:43], a[232:235], v[80:83]
    ds_read_b128 v[32:35], v12 offset:0
    v_mfma_f32_16x16x32_bf16 v[84:87], v[40:43], a[236:239], v[84:87]
    v_mfma_f32_16x16x32_bf16 v[88:91], v[44:47], a[232:235], v[88:91]
    ds_read_b128 v[36:39], v12 offset:1024
    v_mfma_f32_16x16x32_bf16 v[92:95], v[44:47], a[236:239], v[92:95]
    s_waitcnt lgkmcnt(4)
    v_mfma_f32_16x16x32_bf16 v[80:83], v[48:51], a[240:243], v[80:83]
    ds_read_b128 v[40:43], v13 offset:0
    v_mfma_f32_16x16x32_bf16 v[84:87], v[48:51], a[244:247], v[84:87]
    v_mfma_f32_16x16x32_bf16 v[88:91], v[52:55], a[240:243], v[88:91]
    ds_read_b128 v[44:47], v13 offset:1024
    s_add_u32 m0, s34, 77440
    v_mfma_f32_16x16x32_bf16 v[92:95], v[52:55], a[244:247], v[92:95]
    buffer_load_dwordx4 v8, s[12:15], s35 offen offset:384 lds
    s_waitcnt lgkmcnt(4)
    v_mfma_f32_16x16x32_bf16 v[80:83], v[56:59], a[248:251], v[80:83]
    ds_read_b128 v[48:51], v12 offset:4096
    v_mfma_f32_16x16x32_bf16 v[84:87], v[56:59], a[252:255], v[84:87]
    v_mfma_f32_16x16x32_bf16 v[88:91], v[60:63], a[248:251], v[88:91]
    ds_read_b128 v[52:55], v12 offset:5120
    v_mfma_f32_16x16x32_bf16 v[92:95], v[60:63], a[252:255], v[92:95]
    s_add_u32 s30, s30, 2
    s_cmp_lt_u32 s30, s51
    s_cbranch_scc1 sl_loop_47
    v_cvt_pk_bf16_f32 v96, v80, v81
    v_cvt_pk_bf16_f32 v97, v82, v83
    s_nop 0
    v_cvt_pk_bf16_f32 v98, v88, v89
    v_cvt_pk_bf16_f32 v99, v90, v91
    v_cvt_pk_bf16_f32 v100, v84, v85
    v_cvt_pk_bf16_f32 v101, v86, v87
    v_cvt_pk_bf16_f32 v102, v92, v93
    v_cvt_pk_bf16_f32 v103, v94, v95
    s_branch sl_e_45
sl_e_45:
    buffer_store_dwordx4 v[96:99], v9, s[4:7], s36 offen sc1
    buffer_store_dwordx4 v[100:103], v9, s[4:7], s36 offen offset:128 sc1
    s_add_u32 s36, s36, s37
    s_waitcnt vmcnt(0) lgkmcnt(0)
    s_barrier
    buffer_store_dword v11, v10, s[4:7], 0 offen sc1
    s_branch L_ph2
L_ph2:
    s_cmp_ge_u32 s28, 96
    s_cbranch_scc1 L_ob
L_att:
    s_mov_b32 s42, 0x3e0293ee
    s_mov_b32 s58, 0x3e8293ee
    s_and_b32 s44, s28, 7
    s_lshl_b32 s44, s44, 2
    s_add_u32 s44, s44, s29
    s_lshl_b32 s31, s44, 11
    v_add_u32 v6, s31, v5
    v_lshrrev_b32 v9, 5, v1
    v_lshlrev_b32 v9, 7, v9
    v_and_b32 v4, 7, v1
    v_lshl_add_u32 v9, v4, 4, v9
    v_add_u32 v9, s31, v9
    s_add_u32 s31, s31, 4194304
    v_and_b32 v10, 31, v1
    v_lshlrev_b32 v10, 4, v10
    v_lshrrev_b32 v4, 5, v1
    v_lshl_add_u32 v10, v4, 3, v10
    v_add_u32 v10, s31, v10
    s_lshl_b32 s31, s44, 13
    v_add_u32 v8, s31, v5
    v_mov_b32 v7, v8
    s_lshl_b32 s55, s44, 7
    s_add_u32 s55, s55, 115343360
    s_lshr_b32 s56, s44, 2
    s_lshl_b32 s56, s56, 7
    s_add_u32 s56, s56, 115347456
    s_lshl_b32 s57, s44, 7
    s_add_u32 s57, s57, 115351552
    s_lshl_b32 s31, s44, 7
    s_add_u32 s31, s31, 115343360
    v_mov_b32 v12, s31
    v_lshl_add_u32 v13, v1, 12, s31
    s_mov_b64 vcc, 1
    v_mov_b32 v4, 2130706432
    v_cndmask_b32 v12, v4, v12, vcc
    s_cmp_lt_u32 s28, 120
    s_cbranch_scc1 at_help_48
    s_mov_b32 s53, 0
    s_mov_b32 s54, 0
    s_mov_b32 s37, 1
    s_mov_b32 s38, 6
    s_mov_b32 s39, 32
    v_mov_b32 v2, 0
    s_mov_b32 s31, 16384
    buffer_store_dword v2, v12, s[4:7], s31 offen sc1
    s_mov_b32 s31, 32768
    buffer_store_dword v2, v13, s[4:7], s31 offen sc1
    s_waitcnt vmcnt(0)
    s_barrier
    s_cmp_lg_u32 s29, 0
    s_cbranch_scc1 at_i_50
    s_mov_b64 exec, 1
    v_mov_b32 v2, 0
    v_mov_b32 v3, 1
    s_waitcnt vmcnt(0)
    global_atomic_add v2, v3, s[92:93] offset:0 sc1
    s_mov_b64 exec, -1
at_i_50:
    s_cmp_lt_u32 s28, 96
    s_cbranch_scc1 tw_skip_51
    s_load_dwordx2 s[72:73], s[0:1], 40
    s_and_b32 s31, s28, 31
    s_lshl_b32 s31, s31, 13
    s_lshl_b32 s33, s29, 21
    s_add_u32 s31, s31, s33
    v_lshl_add_u32 v2, v1, 7, s31
    s_waitcnt lgkmcnt(0)
    s_mov_b32 s8, s72
    s_and_b32 s9, s73, 0xffff
    s_mov_b32 s10, 8388608
    s_mov_b32 s11, 0x00020000
    s_mov_b32 s31, 0
    buffer_load_dword v128, v2, s[8:11], s31 offen
    s_mov_b32 s31, 262144
    buffer_load_dword v129, v2, s[8:11], s31 offen
    s_mov_b32 s31, 524288
    buffer_load_dword v130, v2, s[8:11], s31 offen
    s_mov_b32 s31, 786432
    buffer_load_dword v131, v2, s[8:11], s31 offen
    s_mov_b32 s31, 1048576
    buffer_load_dword v132, v2, s[8:11], s31 offen
    s_mov_b32 s31, 1310720
    buffer_load_dword v133, v2, s[8:11], s31 offen
    s_mov_b32 s31, 1572864
    buffer_load_dword v134, v2, s[8:11], s31 offen
    s_mov_b32 s31, 1835008
    buffer_load_dword v135, v2, s[8:11], s31 offen
tw_skip_51:
    s_load_dwordx2 s[72:73], s[0:1], 0
    s_load_dwordx2 s[74:75], s[0:1], 56
    s_load_dwordx2 s[76:77], s[0:1], 72
    s_waitcnt lgkmcnt(0)
    s_mov_b32 s8, s72
    s_and_b32 s9, s73, 0xffff
    s_mov_b32 s10, 4194304
    s_mov_b32 s11, 0x00020000
    s_mov_b32 s12, s74
    s_and_b32 s13, s75, 0xffff
    s_mov_b32 s14, 4194304
    s_mov_b32 s15, 0x00020000
    s_mov_b32 s16, s76
    s_and_b32 s17, s77, 0xffff
    s_mov_b32 s18, 2097152
    s_mov_b32 s19, 0x00020000
    s_lshl_b32 s31, s44, 13
    v_lshl_add_u32 v11, v1, 7, s31
    buffer_load_dword v144, v11, s[8:11], 0 offen
    s_cmp_lg_u32 s29, 0
    s_cbranch_scc1 g_wdd_53
g_wd_52:
    s_load_dword s84, s[92:93], 128 glc
    s_add_u32 s41, s41, 1
    s_cmp_ge_u32 s41, 0x200000
    s_cbranch_scc1 g_wdd_53
    s_waitcnt lgkmcnt(0)
    s_and_b32 s84, s84, 0xffff
    s_cmp_ge_u32 s84, 96
    s_cbranch_scc1 g_wdd_53
    s_sleep 32
    s_branch g_wd_52
g_wdd_53:
    s_waitcnt lgkmcnt(0)
    s_barrier
    s_mov_b32 s31, 0
    buffer_load_dword v144, v11, s[8:11], s31 offen
    buffer_load_dword v145, v11, s[12:15], s31 offen
    s_mov_b32 s31, 262144
    buffer_load_dword v146, v11, s[8:11], s31 offen
    buffer_load_dword v147, v11, s[12:15], s31 offen
    s_mov_b32 s31, 524288
    buffer_load_dword v148, v11, s[8:11], s31 offen
    buffer_load_dword v149, v11, s[12:15], s31 offen
    s_mov_b32 s31, 786432
    buffer_load_dword v150, v11, s[8:11], s31 offen
    buffer_load_dword v151, v11, s[12:15], s31 offen
    s_mov_b32 s31, 1048576
    buffer_load_dword v152, v11, s[8:11], s31 offen
    buffer_load_dword v153, v11, s[12:15], s31 offen
    s_mov_b32 s31, 1310720
    buffer_load_dword v154, v11, s[8:11], s31 offen
    buffer_load_dword v155, v11, s[12:15], s31 offen
    s_mov_b32 s31, 1572864
    buffer_load_dword v156, v11, s[8:11], s31 offen
    buffer_load_dword v157, v11, s[12:15], s31 offen
    s_mov_b32 s31, 1835008
    buffer_load_dword v158, v11, s[8:11], s31 offen
    buffer_load_dword v159, v11, s[12:15], s31 offen
    s_mov_b32 s31, 2097152
    buffer_load_dword v160, v11, s[8:11], s31 offen
    buffer_load_dword v161, v11, s[12:15], s31 offen
    s_mov_b32 s31, 2359296
    buffer_load_dword v162, v11, s[8:11], s31 offen
    buffer_load_dword v163, v11, s[12:15], s31 offen
    s_mov_b32 s31, 2621440
    buffer_load_dword v164, v11, s[8:11], s31 offen
    buffer_load_dword v165, v11, s[12:15], s31 offen
    s_mov_b32 s31, 2883584
    buffer_load_dword v166, v11, s[8:11], s31 offen
    buffer_load_dword v167, v11, s[12:15], s31 offen
    s_mov_b32 s31, 3145728
    buffer_load_dword v168, v11, s[8:11], s31 offen
    buffer_load_dword v169, v11, s[12:15], s31 offen
    s_mov_b32 s31, 3407872
    buffer_load_dword v170, v11, s[8:11], s31 offen
    buffer_load_dword v171, v11, s[12:15], s31 offen
    s_mov_b32 s31, 3670016
    buffer_load_dword v172, v11, s[8:11], s31 offen
    buffer_load_dword v173, v11, s[12:15], s31 offen
    s_mov_b32 s31, 3932160
    buffer_load_dword v174, v11, s[8:11], s31 offen
    buffer_load_dword v175, v11, s[12:15], s31 offen
    s_mov_b32 s31, 0
    buffer_load_dword v176, v11, s[16:19], s31 offen
    s_mov_b32 s31, 262144
    buffer_load_dword v177, v11, s[16:19], s31 offen
    s_mov_b32 s31, 524288
    buffer_load_dword v178, v11, s[16:19], s31 offen
    s_mov_b32 s31, 786432
    buffer_load_dword v179, v11, s[16:19], s31 offen
    s_mov_b32 s31, 1048576
    buffer_load_dword v180, v11, s[16:19], s31 offen
    s_mov_b32 s31, 1310720
    buffer_load_dword v181, v11, s[16:19], s31 offen
    s_mov_b32 s31, 1572864
    buffer_load_dword v182, v11, s[16:19], s31 offen
    s_mov_b32 s31, 1835008
    buffer_load_dword v183, v11, s[16:19], s31 offen
    s_branch at_com_49
at_help_48:
    s_lshr_b32 s53, s28, 3
    s_add_u32 s53, s53, 6
    s_mov_b32 s54, 64
    s_mov_b32 s37, 12
    s_mov_b32 s38, 30
    s_lshr_b32 s39, s28, 3
    s_and_b32 s39, s39, 1
    s_add_u32 s39, s39, 30
    s_cmp_lt_u32 s28, 80
    s_cselect_b32 s39, 64, s39
at_com_49:
    v_and_b32 v11, 31, v1
    v_lshrrev_b32 v3, 5, v1
    v_lshlrev_b32 v3, 2, v3
    v_sub_u32 v11, v11, v3
    v_mov_b32 v14, 0xf149f2ca
    v_add_u32 v3, 0, v11
    v_and_b32 v3, 0xfffffff1, v3
    v_cmp_ne_u32 vcc, 0, v3
    s_nop 1
    v_cndmask_b32 v64, 0, v14, vcc
    v_add_u32 v3, -1, v11
    v_and_b32 v3, 0xfffffff1, v3
    v_cmp_ne_u32 vcc, 0, v3
    s_nop 1
    v_cndmask_b32 v65, 0, v14, vcc
    v_add_u32 v3, -2, v11
    v_and_b32 v3, 0xfffffff1, v3
    v_cmp_ne_u32 vcc, 0, v3
    s_nop 1
    v_cndmask_b32 v66, 0, v14, vcc
    v_add_u32 v3, -3, v11
    v_and_b32 v3, 0xfffffff1, v3
    v_cmp_ne_u32 vcc, 0, v3
    s_nop 1
    v_cndmask_b32 v67, 0, v14, vcc
    v_add_u32 v3, -8, v11
    v_and_b32 v3, 0xfffffff1, v3
    v_cmp_ne_u32 vcc, 0, v3
    s_nop 1
    v_cndmask_b32 v68, 0, v14, vcc
    v_add_u32 v3, -9, v11
    v_and_b32 v3, 0xfffffff1, v3
    v_cmp_ne_u32 vcc, 0, v3
    s_nop 1
    v_cndmask_b32 v69, 0, v14, vcc
    v_add_u32 v3, -10, v11
    v_and_b32 v3, 0xfffffff1, v3
    v_cmp_ne_u32 vcc, 0, v3
    s_nop 1
    v_cndmask_b32 v70, 0, v14, vcc
    v_add_u32 v3, -11, v11
    v_and_b32 v3, 0xfffffff1, v3
    v_cmp_ne_u32 vcc, 0, v3
    s_nop 1
    v_cndmask_b32 v71, 0, v14, vcc
    v_add_u32 v3, -16, v11
    v_and_b32 v3, 0xfffffff1, v3
    v_cmp_ne_u32 vcc, 0, v3
    s_nop 1
    v_cndmask_b32 v72, 0, v14, vcc
    v_add_u32 v3, -17, v11
    v_and_b32 v3, 0xfffffff1, v3
    v_cmp_ne_u32 vcc, 0, v3
    s_nop 1
    v_cndmask_b32 v73, 0, v14, vcc
    v_add_u32 v3, -18, v11
    v_and_b32 v3, 0xfffffff1, v3
    v_cmp_ne_u32 vcc, 0, v3
    s_nop 1
    v_cndmask_b32 v74, 0, v14, vcc
    v_add_u32 v3, -19, v11
    v_and_b32 v3, 0xfffffff1, v3
    v_cmp_ne_u32 vcc, 0, v3
    s_nop 1
    v_cndmask_b32 v75, 0, v14, vcc
    v_add_u32 v3, -24, v11
    v_and_b32 v3, 0xfffffff1, v3
    v_cmp_ne_u32 vcc, 0, v3
    s_nop 1
    v_cndmask_b32 v76, 0, v14, vcc
    v_add_u32 v3, -25, v11
    v_and_b32 v3, 0xfffffff1, v3
    v_cmp_ne_u32 vcc, 0, v3
    s_nop 1
    v_cndmask_b32 v77, 0, v14, vcc
    v_add_u32 v3, -26, v11
    v_and_b32 v3, 0xfffffff1, v3
    v_cmp_ne_u32 vcc, 0, v3
    s_nop 1
    v_cndmask_b32 v78, 0, v14, vcc
    v_add_u32 v3, -27, v11
    v_and_b32 v3, 0xfffffff1, v3
    v_cmp_ne_u32 vcc, 0, v3
    s_nop 1
    v_cndmask_b32 v79, 0, v14, vcc
    v_cmp_gt_i32 vcc, 0, v11
    s_nop 1
    v_cndmask_b32 v96, 0, v14, vcc
    v_cmp_gt_i32 vcc, 1, v11
    s_nop 1
    v_cndmask_b32 v97, 0, v14, vcc
    v_cmp_gt_i32 vcc, 2, v11
    s_nop 1
    v_cndmask_b32 v98, 0, v14, vcc
    v_cmp_gt_i32 vcc, 3, v11
    s_nop 1
    v_cndmask_b32 v99, 0, v14, vcc
    v_cmp_gt_i32 vcc, 8, v11
    s_nop 1
    v_cndmask_b32 v100, 0, v14, vcc
    v_cmp_gt_i32 vcc, 9, v11
    s_nop 1
    v_cndmask_b32 v101, 0, v14, vcc
    v_cmp_gt_i32 vcc, 10, v11
    s_nop 1
    v_cndmask_b32 v102, 0, v14, vcc
    v_cmp_gt_i32 vcc, 11, v11
    s_nop 1
    v_cndmask_b32 v103, 0, v14, vcc
    v_cmp_gt_i32 vcc, 16, v11
    s_nop 1
    v_cndmask_b32 v104, 0, v14, vcc
    v_cmp_gt_i32 vcc, 17, v11
    s_nop 1
    v_cndmask_b32 v105, 0, v14, vcc
    v_cmp_gt_i32 vcc, 18, v11
    s_nop 1
    v_cndmask_b32 v106, 0, v14, vcc
    v_cmp_gt_i32 vcc, 19, v11
    s_nop 1
    v_cndmask_b32 v107, 0, v14, vcc
    v_cmp_gt_i32 vcc, 24, v11
    s_nop 1
    v_cndmask_b32 v108, 0, v14, vcc
    v_cmp_gt_i32 vcc, 25, v11
    s_nop 1
    v_cndmask_b32 v109, 0, v14, vcc
    v_cmp_gt_i32 vcc, 26, v11
    s_nop 1
    v_cndmask_b32 v110, 0, v14, vcc
    v_cmp_gt_i32 vcc, 27, v11
    s_nop 1
    v_cndmask_b32 v111, 0, v14, vcc
    v_mov_b32 v80, 0xf149f2ca
    v_mov_b32 v81, 0xf149f2ca
    v_mov_b32 v82, 0xf149f2ca
    v_mov_b32 v83, 0xf149f2ca
    v_mov_b32 v84, 0xf149f2ca
    v_mov_b32 v85, 0xf149f2ca
    v_mov_b32 v86, 0xf149f2ca
    v_mov_b32 v87, 0xf149f2ca
    v_mov_b32 v88, 0xf149f2ca
    v_mov_b32 v89, 0xf149f2ca
    v_mov_b32 v90, 0xf149f2ca
    v_mov_b32 v91, 0xf149f2ca
    v_mov_b32 v92, 0xf149f2ca
    v_mov_b32 v93, 0xf149f2ca
    v_mov_b32 v94, 0xf149f2ca
    v_mov_b32 v95, 0xf149f2ca
    v_accvgpr_write_b32 a184, 0
    v_accvgpr_write_b32 a185, 0
    v_accvgpr_write_b32 a186, 0
    v_accvgpr_write_b32 a187, 0
    v_accvgpr_write_b32 a188, 0
    v_accvgpr_write_b32 a189, 0
    v_accvgpr_write_b32 a190, 0
    v_accvgpr_write_b32 a191, 0
    v_accvgpr_write_b32 a192, 0
    v_accvgpr_write_b32 a193, 0
    v_accvgpr_write_b32 a194, 0
    v_accvgpr_write_b32 a195, 0
    v_accvgpr_write_b32 a128, 0
    v_accvgpr_write_b32 a129, 0
    v_accvgpr_write_b32 a130, 0
    v_accvgpr_write_b32 a131, 0
    v_accvgpr_write_b32 a132, 0
    v_accvgpr_write_b32 a133, 0
    v_accvgpr_write_b32 a134, 0
    v_accvgpr_write_b32 a135, 0
    v_accvgpr_write_b32 a136, 0
    v_accvgpr_write_b32 a137, 0
    v_accvgpr_write_b32 a138, 0
    v_accvgpr_write_b32 a139, 0
    v_accvgpr_write_b32 a140, 0
    v_accvgpr_write_b32 a141, 0
    v_accvgpr_write_b32 a142, 0
    v_accvgpr_write_b32 a143, 0
    v_mov_b32 v40, 0
    v_mov_b32 v41, 0
    v_mov_b32 v42, 0
    v_mov_b32 v43, 0
    s_cmp_lg_u32 s29, 0
    s_cbranch_scc1 g_wdd_55
g_wd_54:
    s_load_dword s72, s[92:93], 0 glc
    s_add_u32 s41, s41, 1
    s_cmp_ge_u32 s41, 0x200000
    s_cbranch_scc1 g_wdd_55
    s_waitcnt lgkmcnt(0)
    s_and_b32 s72, s72, 0xffff
    s_cmp_ge_u32 s72, 256
    s_cbranch_scc1 g_wdd_55
    s_sleep 32
    s_branch g_wd_54
g_wdd_55:
    s_waitcnt lgkmcnt(0)
    s_barrier
    s_add_u32 s49, s53, s37
    s_cmp_lt_u32 s49, s38
    s_cbranch_scc1 at_nx_63
    s_max_u32 s49, s49, s39
    s_cmp_eq_u32 s38, 255
    s_cselect_b32 s49, s49, s39
    s_mov_b32 s37, 3
    s_mov_b32 s38, 255
at_nx_63:
g_wf_64:
    s_load_dwordx4 s[72:75], s[90:91], s56 glc
    s_add_u32 s41, s41, 1
    s_cmp_ge_u32 s41, 0x200000
    s_cbranch_scc1 g_wfd_65
    s_waitcnt lgkmcnt(0)
    s_min_u32 s76, s72, s73
    s_min_u32 s76, s76, s74
    s_cmp_ge_u32 s76, 1
    s_cbranch_scc1 g_wfd_65
    s_sleep 4
    s_branch g_wf_64
g_wfd_65:
    s_waitcnt lgkmcnt(0)
    s_mov_b32 s35, 0
    s_add_u32 s31, s35, 50331648
    buffer_load_dwordx4 a[160:163], v6, s[4:7], s31 offen offset:0 sc1
    buffer_load_dwordx4 a[164:167], v6, s[4:7], s31 offen offset:1024 sc1
    s_add_u32 s31, s35, 54525952
    buffer_load_dwordx4 a[168:171], v6, s[4:7], s31 offen offset:0 sc1
    buffer_load_dwordx4 a[172:175], v6, s[4:7], s31 offen offset:1024 sc1
    s_add_u32 s31, s35, 58720256
    buffer_load_dwordx4 a[176:179], v6, s[4:7], s31 offen offset:0 sc1
    buffer_load_dwordx4 a[180:183], v6, s[4:7], s31 offen offset:1024 sc1
    s_add_u32 s32, s53, 1
g_wf_66:
    s_load_dwordx4 s[72:75], s[90:91], s55 glc
    s_add_u32 s41, s41, 1
    s_cmp_ge_u32 s41, 0x200000
    s_cbranch_scc1 g_wfd_67
    s_waitcnt lgkmcnt(0)
    s_min_u32 s76, s72, s73
    s_min_u32 s76, s76, s74
    s_cmp_ge_u32 s76, s32
    s_cbranch_scc1 g_wfd_67
    s_sleep 4
    s_branch g_wf_66
g_wfd_67:
    s_waitcnt lgkmcnt(0)
    s_lshl_b32 s36, s53, 18
    s_add_u32 s31, s36, 0
    buffer_load_dwordx4 a[0:3], v7, s[4:7], s31 offen offset:0 sc1
    buffer_load_dwordx4 a[4:7], v7, s[4:7], s31 offen offset:1024 sc1
    buffer_load_dwordx4 a[8:11], v7, s[4:7], s31 offen offset:2048 sc1
    buffer_load_dwordx4 a[12:15], v7, s[4:7], s31 offen offset:3072 sc1
    s_add_u32 s31, s36, 4096
    buffer_load_dwordx4 a[16:19], v7, s[4:7], s31 offen offset:0 sc1
    buffer_load_dwordx4 a[20:23], v7, s[4:7], s31 offen offset:1024 sc1
    buffer_load_dwordx4 a[24:27], v7, s[4:7], s31 offen offset:2048 sc1
    buffer_load_dwordx4 a[28:31], v7, s[4:7], s31 offen offset:3072 sc1
    s_add_u32 s31, s36, 16777216
    buffer_load_dwordx4 a[32:35], v7, s[4:7], s31 offen offset:0 sc1
    buffer_load_dwordx4 a[36:39], v7, s[4:7], s31 offen offset:1024 sc1
    buffer_load_dwordx4 a[40:43], v7, s[4:7], s31 offen offset:2048 sc1
    buffer_load_dwordx4 a[44:47], v7, s[4:7], s31 offen offset:3072 sc1
    s_add_u32 s31, s36, 16781312
    buffer_load_dwordx4 a[48:51], v7, s[4:7], s31 offen offset:0 sc1
    buffer_load_dwordx4 a[52:55], v7, s[4:7], s31 offen offset:1024 sc1
    buffer_load_dwordx4 a[56:59], v7, s[4:7], s31 offen offset:2048 sc1
    buffer_load_dwordx4 a[60:63], v7, s[4:7], s31 offen offset:3072 sc1
    s_add_u32 s31, s36, 33554432
    buffer_load_dwordx4 a[96:99], v7, s[4:7], s31 offen offset:0 sc1
    buffer_load_dwordx4 a[100:103], v7, s[4:7], s31 offen offset:1024 sc1
    buffer_load_dwordx4 a[104:107], v7, s[4:7], s31 offen offset:2048 sc1
    buffer_load_dwordx4 a[108:111], v7, s[4:7], s31 offen offset:3072 sc1
    s_add_u32 s31, s36, 33558528
    buffer_load_dwordx4 a[112:115], v7, s[4:7], s31 offen offset:0 sc1
    buffer_load_dwordx4 a[116:119], v7, s[4:7], s31 offen offset:1024 sc1
    buffer_load_dwordx4 a[120:123], v7, s[4:7], s31 offen offset:2048 sc1
    buffer_load_dwordx4 a[124:127], v7, s[4:7], s31 offen offset:3072 sc1
    s_mov_b32 s43, 20480
    s_mov_b32 s45, 0
    s_mov_b32 s51, 0
    s_waitcnt vmcnt(0)
at_poll_61:
    s_load_dwordx4 s[72:75], s[90:91], s57 glc
    s_load_dwordx4 s[76:79], s[90:91], s55 glc
    s_load_dwordx4 s[80:83], s[90:91], s56 glc
at_top_56:
    s_waitcnt lgkmcnt(0)
    s_min_u32 s72, s72, s73
    s_min_u32 s72, s72, s74
    s_min_u32 s72, s72, s75
    s_min_u32 s76, s76, s77
    s_min_u32 s76, s76, s78
    s_min_u32 s80, s80, s81
    s_min_u32 s80, s80, s82
    s_min_u32 s77, s49, 63
    s_cmp_gt_u32 s76, s77
    s_cselect_b32 s72, s72, 0
    s_min_u32 s72, s72, 64
    s_sub_u32 s81, s80, 1
    s_cmp_ge_u32 s80, 64
    s_cselect_b32 s80, 64, s81
    s_cmp_lt_u32 s54, s80
    s_cbranch_scc1 at_b_58
    s_cmp_lt_u32 s53, s72
    s_cbranch_scc1 at_a_57
    s_cmp_eq_u32 s43, 20480
    s_cbranch_scc1 at_nf_62
    s_waitcnt vmcnt(0)
    v_mov_b32 v2, s45
    buffer_store_dword v2, v12, s[4:7], s43 offen sc1
    s_mov_b32 s43, 20480
at_nf_62:
    s_cmp_ge_u32 s53, 64
    s_cselect_b32 s31, s54, 0
    s_cmp_ge_u32 s31, 64
    s_cbranch_scc1 at_end_59
    s_add_u32 s41, s41, 1
    s_cmp_ge_u32 s41, 0x200000
    s_cbranch_scc1 at_end_59
    s_sleep 1
    s_branch at_poll_61
at_a_57:
    s_lshl_b32 s46, s53, 16
    s_add_u32 s46, s46, 88080384
    s_cmp_lg_u32 s51, 0
    s_cbranch_scc1 at_k1_68
    s_mov_b32 exec_lo, 0xff
    s_mov_b32 exec_hi, 0xff
    buffer_load_dwordx4 a[64:67], v9, s[4:7], s46 offen offset:0 sc1
    buffer_load_dwordx4 a[68:71], v9, s[4:7], s46 offen offset:256 sc1
    buffer_load_dwordx4 a[72:75], v9, s[4:7], s46 offen offset:512 sc1
    buffer_load_dwordx4 a[76:79], v9, s[4:7], s46 offen offset:768 sc1
    buffer_load_dwordx4 a[80:83], v9, s[4:7], s46 offen offset:1024 sc1
    buffer_load_dwordx4 a[84:87], v9, s[4:7], s46 offen offset:1280 sc1
    buffer_load_dwordx4 a[88:91], v9, s[4:7], s46 offen offset:1536 sc1
    buffer_load_dwordx4 a[92:95], v9, s[4:7], s46 offen offset:1792 sc1
    s_mov_b64 exec, -1
    buffer_load_dwordx2 a[128:129], v10, s[4:7], s46 offen offset:0 sc1
    buffer_load_dwordx2 a[132:133], v10, s[4:7], s46 offen offset:512 sc1
    buffer_load_dwordx2 a[136:137], v10, s[4:7], s46 offen offset:1024 sc1
    buffer_load_dwordx2 a[140:141], v10, s[4:7], s46 offen offset:1536 sc1
at_k1_68:
    s_lshl_b32 s47, s53, 18
    s_add_u32 s47, s47, 67108864
    s_cmp_lt_u32 s49, s72
    s_cselect_b32 s52, 1, 0
    s_cmp_lt_u32 s49, 64
    s_cselect_b32 s32, s49, s53
    s_cselect_b32 s31, 0, 2130706432
    v_or_b32 v7, s31, v8
    s_lshl_b32 s36, s32, 18
    s_lshl_b32 s46, s32, 16
    s_add_u32 s46, s46, 88080384
    s_load_dwordx4 s[72:75], s[90:91], s57 glc
    s_load_dwordx4 s[76:79], s[90:91], s55 glc
    s_load_dwordx4 s[80:83], s[90:91], s56 glc
    v_mfma_f32_32x32x16_bf16 v[112:127], a[32:35], a[0:3], v[96:111]
    v_mfma_f32_32x32x16_bf16 v[112:127], a[36:39], a[4:7], v[112:127]
    v_mfma_f32_32x32x16_bf16 v[112:127], a[40:43], a[8:11], v[112:127]
    v_mfma_f32_32x32x16_bf16 v[112:127], a[44:47], a[12:15], v[112:127]
    v_mfma_f32_32x32x16_bf16 v[112:127], a[48:51], a[16:19], v[112:127]
    v_mfma_f32_32x32x16_bf16 v[112:127], a[52:55], a[20:23], v[112:127]
    v_mfma_f32_32x32x16_bf16 v[112:127], a[56:59], a[24:27], v[112:127]
    v_mfma_f32_32x32x16_bf16 v[112:127], a[60:63], a[28:31], v[112:127]
    s_cmp_lg_u32 s51, 0
    s_cbranch_scc1 at_k2_69
    s_waitcnt vmcnt(4)
at_k2_69:
    s_add_u32 s31, s36, 16777216
    buffer_load_dwordx4 a[32:35], v7, s[4:7], s31 offen offset:0 sc1
    buffer_load_dwordx4 a[36:39], v7, s[4:7], s31 offen offset:1024 sc1
    buffer_load_dwordx4 a[40:43], v7, s[4:7], s31 offen offset:2048 sc1
    buffer_load_dwordx4 a[44:47], v7, s[4:7], s31 offen offset:3072 sc1
    s_add_u32 s31, s36, 16781312
    buffer_load_dwordx4 a[48:51], v7, s[4:7], s31 offen offset:0 sc1
    buffer_load_dwordx4 a[52:55], v7, s[4:7], s31 offen offset:1024 sc1
    buffer_load_dwordx4 a[56:59], v7, s[4:7], s31 offen offset:2048 sc1
    buffer_load_dwordx4 a[60:63], v7, s[4:7], s31 offen offset:3072 sc1
    v_mfma_f32_32x32x16_bf16 v[128:143], a[64:67], a[0:3], 0
    v_mfma_f32_32x32x16_bf16 v[128:143], a[68:71], a[4:7], v[128:143]
    v_mfma_f32_32x32x16_bf16 v[128:143], a[72:75], a[8:11], v[128:143]
    v_mfma_f32_32x32x16_bf16 v[128:143], a[76:79], a[12:15], v[128:143]
    v_mfma_f32_32x32x16_bf16 v[128:143], a[80:83], a[16:19], v[128:143]
    v_mfma_f32_32x32x16_bf16 v[128:143], a[84:87], a[20:23], v[128:143]
    v_mfma_f32_32x32x16_bf16 v[128:143], a[88:91], a[24:27], v[128:143]
    v_mfma_f32_32x32x16_bf16 v[128:143], a[92:95], a[28:31], v[128:143]
    s_mov_b32 s51, s52
    s_add_u32 s31, s36, 0
    buffer_load_dwordx4 a[0:3], v7, s[4:7], s31 offen offset:0 sc1
    buffer_load_dwordx4 a[4:7], v7, s[4:7], s31 offen offset:1024 sc1
    buffer_load_dwordx4 a[8:11], v7, s[4:7], s31 offen offset:2048 sc1
    buffer_load_dwordx4 a[12:15], v7, s[4:7], s31 offen offset:3072 sc1
    s_add_u32 s31, s36, 4096
    buffer_load_dwordx4 a[16:19], v7, s[4:7], s31 offen offset:0 sc1
    buffer_load_dwordx4 a[20:23], v7, s[4:7], s31 offen offset:1024 sc1
    buffer_load_dwordx4 a[24:27], v7, s[4:7], s31 offen offset:2048 sc1
    buffer_load_dwordx4 a[28:31], v7, s[4:7], s31 offen offset:3072 sc1
    s_cmp_eq_u32 s51, 0
    s_cbranch_scc1 at_k3_70
    s_mov_b32 exec_lo, 0xff
    s_mov_b32 exec_hi, 0xff
    buffer_load_dwordx4 a[64:67], v9, s[4:7], s46 offen offset:0 sc1
    buffer_load_dwordx4 a[68:71], v9, s[4:7], s46 offen offset:256 sc1
    buffer_load_dwordx4 a[72:75], v9, s[4:7], s46 offen offset:512 sc1
    buffer_load_dwordx4 a[76:79], v9, s[4:7], s46 offen offset:768 sc1
    buffer_load_dwordx4 a[80:83], v9, s[4:7], s46 offen offset:1024 sc1
    buffer_load_dwordx4 a[84:87], v9, s[4:7], s46 offen offset:1280 sc1
    buffer_load_dwordx4 a[88:91], v9, s[4:7], s46 offen offset:1536 sc1
    buffer_load_dwordx4 a[92:95], v9, s[4:7], s46 offen offset:1792 sc1
    s_mov_b64 exec, -1
at_k3_70:
    v_max3_f32 v14, v112, v113, v114
    v_max3_f32 v14, v14, v115, v116
    v_max3_f32 v14, v14, v117, v118
    v_max3_f32 v14, v14, v119, v120
    v_max3_f32 v14, v14, v121, v122
    v_max3_f32 v14, v14, v123, v124
    v_max3_f32 v14, v14, v125, v126
    v_max3_f32 v14, v14, v127, v128
    v_max3_f32 v14, v14, v129, v130
    v_max_f32 v14, v14, v131
    v_mov_b32 v15, v14
    s_nop 1
    v_permlane32_swap_b32 v14, v15
    v_max_f32 v14, v14, v15
    v_mul_f32 v14, s42, v14
    v_fma_f32 v112, v112, s42, -v14
    v_fma_f32 v113, v113, s42, -v14
    v_fma_f32 v114, v114, s42, -v14
    v_fma_f32 v115, v115, s42, -v14
    v_fma_f32 v116, v116, s42, -v14
    v_fma_f32 v117, v117, s42, -v14
    v_fma_f32 v118, v118, s42, -v14
    v_fma_f32 v119, v119, s42, -v14
    v_fma_f32 v120, v120, s42, -v14
    v_fma_f32 v121, v121, s42, -v14
    v_fma_f32 v122, v122, s42, -v14
    v_fma_f32 v123, v123, s42, -v14
    v_fma_f32 v124, v124, s42, -v14
    v_fma_f32 v125, v125, s42, -v14
    v_fma_f32 v126, v126, s42, -v14
    v_fma_f32 v127, v127, s42, -v14
    v_fma_f32 v128, v128, s42, -v14
    v_fma_f32 v129, v129, s42, -v14
    v_fma_f32 v130, v130, s42, -v14
    v_fma_f32 v131, v131, s42, -v14
    v_exp_f32 v112, v112
    v_exp_f32 v113, v113
    v_exp_f32 v114, v114
    v_exp_f32 v115, v115
    v_exp_f32 v116, v116
    v_exp_f32 v117, v117
    v_exp_f32 v118, v118
    v_exp_f32 v119, v119
    v_exp_f32 v120, v120
    v_exp_f32 v121, v121
    v_exp_f32 v122, v122
    v_exp_f32 v123, v123
    v_exp_f32 v124, v124
    v_exp_f32 v125, v125
    v_exp_f32 v126, v126
    v_exp_f32 v127, v127
    v_exp_f32 v128, v128
    v_exp_f32 v129, v129
    v_exp_f32 v130, v130
    v_exp_f32 v131, v131
    v_add_f32 v26, v112, v113
    v_add_f32 v15, v114, v115
    v_add_f32 v26, v26, v116
    v_add_f32 v15, v15, v117
    v_add_f32 v26, v26, v118
    v_add_f32 v15, v15, v119
    v_add_f32 v26, v26, v120
    v_add_f32 v15, v15, v121
    v_add_f32 v26, v26, v122
    v_add_f32 v15, v15, v123
    v_add_f32 v26, v26, v124
    v_add_f32 v15, v15, v125
    v_add_f32 v26, v26, v126
    v_add_f32 v15, v15, v127
    v_add_f32 v26, v26, v128
    v_add_f32 v15, v15, v129
    v_add_f32 v26, v26, v130
    v_add_f32 v15, v15, v131
    v_add_f32 v26, v26, v15
    v_mov_b32 v15, v26
    s_nop 1
    v_permlane32_swap_b32 v26, v15
    v_add_f32 v26, v26, v15
    v_rcp_f32 v26, v26
    v_cvt_pk_bf16_f32 v28, v112, v113
    v_cvt_pk_bf16_f32 v29, v114, v115
    v_cvt_pk_bf16_f32 v30, v116, v117
    v_cvt_pk_bf16_f32 v31, v118, v119
    v_cvt_pk_bf16_f32 v32, v120, v121
    v_cvt_pk_bf16_f32 v33, v122, v123
    v_cvt_pk_bf16_f32 v34, v124, v125
    v_cvt_pk_bf16_f32 v35, v126, v127
    v_cvt_pk_bf16_f32 v40, v128, v129
    v_cvt_pk_bf16_f32 v41, v130, v131
    s_waitcnt vmcnt(16)
    v_mov_b32 v2, s45
    buffer_store_dword v2, v12, s[4:7], s43 offen sc1
    v_mfma_f32_32x32x16_bf16 v[144:159], a[96:99], v[28:31], 0
    v_mfma_f32_32x32x16_bf16 v[144:159], a[100:103], v[32:35], v[144:159]
    v_mfma_f32_32x32x16_bf16 v[144:159], a[128:131], v[40:43], v[144:159]
    v_mfma_f32_32x32x16_bf16 v[160:175], a[104:107], v[28:31], 0
    v_mfma_f32_32x32x16_bf16 v[160:175], a[108:111], v[32:35], v[160:175]
    v_mfma_f32_32x32x16_bf16 v[160:175], a[132:135], v[40:43], v[160:175]
    v_mfma_f32_32x32x16_bf16 v[176:191], a[112:115], v[28:31], 0
    s_nop 7
    v_mul_f32 v144, v144, v26
    v_mul_f32 v145, v145, v26
    v_mul_f32 v146, v146, v26
    v_mul_f32 v147, v147, v26
    v_mul_f32 v148, v148, v26
    v_mul_f32 v149, v149, v26
    v_mfma_f32_32x32x16_bf16 v[176:191], a[116:119], v[32:35], v[176:191]
    v_mul_f32 v150, v150, v26
    v_mul_f32 v151, v151, v26
    v_mul_f32 v152, v152, v26
    v_mul_f32 v153, v153, v26
    v_mul_f32 v154, v154, v26
    v_mul_f32 v155, v155, v26
    v_mfma_f32_32x32x16_bf16 v[176:191], a[136:139], v[40:43], v[176:191]
    v_mul_f32 v156, v156, v26
    v_mul_f32 v157, v157, v26
    v_mul_f32 v158, v158, v26
    v_mul_f32 v159, v159, v26
    v_cvt_pk_bf16_f32 v208, v144, v145
    v_cvt_pk_bf16_f32 v209, v146, v147
    v_mfma_f32_32x32x16_bf16 v[192:207], a[120:123], v[28:31], 0
    v_cvt_pk_bf16_f32 v210, v148, v149
    v_cvt_pk_bf16_f32 v211, v150, v151
    v_cvt_pk_bf16_f32 v212, v152, v153
    v_cvt_pk_bf16_f32 v213, v154, v155
    v_cvt_pk_bf16_f32 v214, v156, v157
    v_cvt_pk_bf16_f32 v215, v158, v159
    v_mfma_f32_32x32x16_bf16 v[192:207], a[124:127], v[32:35], v[192:207]
    v_mul_f32 v160, v160, v26
    v_mul_f32 v161, v161, v26
    v_mul_f32 v162, v162, v26
    v_mul_f32 v163, v163, v26
    v_mul_f32 v164, v164, v26
    v_mul_f32 v165, v165, v26
    v_mfma_f32_32x32x16_bf16 v[192:207], a[140:143], v[40:43], v[192:207]
    v_mul_f32 v166, v166, v26
    v_mul_f32 v167, v167, v26
    v_mul_f32 v168, v168, v26
    v_mul_f32 v169, v169, v26
    v_mul_f32 v170, v170, v26
    v_mul_f32 v171, v171, v26
    s_add_u32 s31, s36, 33554432
    buffer_load_dwordx4 a[96:99], v7, s[4:7], s31 offen offset:0 sc1
    buffer_load_dwordx4 a[100:103], v7, s[4:7], s31 offen offset:1024 sc1
    buffer_load_dwordx4 a[104:107], v7, s[4:7], s31 offen offset:2048 sc1
    buffer_load_dwordx4 a[108:111], v7, s[4:7], s31 offen offset:3072 sc1
    s_add_u32 s31, s36, 33558528
    buffer_load_dwordx4 a[112:115], v7, s[4:7], s31 offen offset:0 sc1
    buffer_load_dwordx4 a[116:119], v7, s[4:7], s31 offen offset:1024 sc1
    buffer_load_dwordx4 a[120:123], v7, s[4:7], s31 offen offset:2048 sc1
    buffer_load_dwordx4 a[124:127], v7, s[4:7], s31 offen offset:3072 sc1
    s_cmp_eq_u32 s51, 0
    s_cbranch_scc1 at_k4_71
    buffer_load_dwordx2 a[128:129], v10, s[4:7], s46 offen offset:0 sc1
    buffer_load_dwordx2 a[132:133], v10, s[4:7], s46 offen offset:512 sc1
    buffer_load_dwordx2 a[136:137], v10, s[4:7], s46 offen offset:1024 sc1
    buffer_load_dwordx2 a[140:141], v10, s[4:7], s46 offen offset:1536 sc1
at_k4_71:
    v_mul_f32 v172, v172, v26
    v_mul_f32 v173, v173, v26
    v_mul_f32 v174, v174, v26
    v_mul_f32 v175, v175, v26
    v_cvt_pk_bf16_f32 v216, v160, v161
    v_cvt_pk_bf16_f32 v217, v162, v163
    v_cvt_pk_bf16_f32 v218, v164, v165
    v_cvt_pk_bf16_f32 v219, v166, v167
    v_cvt_pk_bf16_f32 v220, v168, v169
    v_cvt_pk_bf16_f32 v221, v170, v171
    v_cvt_pk_bf16_f32 v222, v172, v173
    v_cvt_pk_bf16_f32 v223, v174, v175
    v_mul_f32 v176, v176, v26
    v_mul_f32 v177, v177, v26
    v_mul_f32 v178, v178, v26
    v_mul_f32 v179, v179, v26
    v_mul_f32 v180, v180, v26
    v_mul_f32 v181, v181, v26
    v_mul_f32 v182, v182, v26
    v_mul_f32 v183, v183, v26
    v_mul_f32 v184, v184, v26
    v_mul_f32 v185, v185, v26
    v_mul_f32 v186, v186, v26
    v_mul_f32 v187, v187, v26
    v_mul_f32 v188, v188, v26
    v_mul_f32 v189, v189, v26
    v_mul_f32 v190, v190, v26
    v_mul_f32 v191, v191, v26
    v_cvt_pk_bf16_f32 v224, v176, v177
    v_cvt_pk_bf16_f32 v225, v178, v179
    v_cvt_pk_bf16_f32 v226, v180, v181
    v_cvt_pk_bf16_f32 v227, v182, v183
    v_cvt_pk_bf16_f32 v228, v184, v185
    v_cvt_pk_bf16_f32 v229, v186, v187
    v_cvt_pk_bf16_f32 v230, v188, v189
    v_cvt_pk_bf16_f32 v231, v190, v191
    v_mul_f32 v192, v192, v26
    v_mul_f32 v193, v193, v26
    v_mul_f32 v194, v194, v26
    v_mul_f32 v195, v195, v26
    v_mul_f32 v196, v196, v26
    v_mul_f32 v197, v197, v26
    v_mul_f32 v198, v198, v26
    v_mul_f32 v199, v199, v26
    v_mul_f32 v200, v200, v26
    v_mul_f32 v201, v201, v26
    v_mul_f32 v202, v202, v26
    v_mul_f32 v203, v203, v26
    v_mul_f32 v204, v204, v26
    v_mul_f32 v205, v205, v26
    v_mul_f32 v206, v206, v26
    v_mul_f32 v207, v207, v26
    v_cvt_pk_bf16_f32 v232, v192, v193
    v_cvt_pk_bf16_f32 v233, v194, v195
    v_cvt_pk_bf16_f32 v234, v196, v197
    v_cvt_pk_bf16_f32 v235, v198, v199
    v_cvt_pk_bf16_f32 v236, v200, v201
    v_cvt_pk_bf16_f32 v237, v202, v203
    v_cvt_pk_bf16_f32 v238, v204, v205
    v_cvt_pk_bf16_f32 v239, v206, v207
    s_add_u32 s31, s47, 0
    buffer_store_dwordx4 v[208:211], v8, s[4:7], s31 offen offset:0 sc1
    buffer_store_dwordx4 v[212:215], v8, s[4:7], s31 offen offset:1024 sc1
    buffer_store_dwordx4 v[216:219], v8, s[4:7], s31 offen offset:2048 sc1
    buffer_store_dwordx4 v[220:223], v8, s[4:7], s31 offen offset:3072 sc1
    s_add_u32 s31, s47, 4096
    buffer_store_dwordx4 v[224:227], v8, s[4:7], s31 offen offset:0 sc1
    buffer_store_dwordx4 v[228:231], v8, s[4:7], s31 offen offset:1024 sc1
    buffer_store_dwordx4 v[232:235], v8, s[4:7], s31 offen offset:2048 sc1
    buffer_store_dwordx4 v[236:239], v8, s[4:7], s31 offen offset:3072 sc1
    s_mov_b32 s45, 1
    s_lshl_b32 s43, s53, 12
    s_add_u32 s43, s43, 32768
    s_mov_b32 s53, s49
    s_add_u32 s49, s53, s37
    s_cmp_lt_u32 s49, s38
    s_cbranch_scc1 at_nx_72
    s_max_u32 s49, s49, s39
    s_cmp_eq_u32 s38, 255
    s_cselect_b32 s49, s49, s39
    s_mov_b32 s37, 3
    s_mov_b32 s38, 255
at_nx_72:
    s_waitcnt vmcnt(17)
    s_branch at_top_56
at_b_58:
    s_load_dwordx4 s[72:75], s[90:91], s57 glc
    s_load_dwordx4 s[76:79], s[90:91], s55 glc
    s_load_dwordx4 s[80:83], s[90:91], s56 glc
    s_lshl_b32 s48, s54, 16
    s_add_u32 s48, s48, 83886080
    s_add_u32 s32, s54, 1
    s_min_u32 s32, s32, 63
    s_lshl_b32 s35, s32, 16
    v_mfma_f32_32x32x16_bf16 v[128:143], a[184:187], a[160:163], v[80:95]
    v_mfma_f32_32x32x16_bf16 v[128:143], a[188:191], a[164:167], v[128:143]
    v_mfma_f32_32x32x16_bf16 v[112:127], a[168:171], a[160:163], v[64:79]
    v_mfma_f32_32x32x16_bf16 v[112:127], a[172:175], a[164:167], v[112:127]
    v_accvgpr_mov_b32 a184, a168
    v_accvgpr_mov_b32 a185, a169
    v_accvgpr_mov_b32 a186, a170
    v_accvgpr_mov_b32 a187, a171
    v_accvgpr_mov_b32 a188, a172
    v_accvgpr_mov_b32 a189, a173
    v_accvgpr_mov_b32 a190, a174
    v_accvgpr_mov_b32 a191, a175
    v_accvgpr_mov_b32 a196, a176
    v_accvgpr_mov_b32 a197, a177
    v_accvgpr_mov_b32 a198, a178
    v_accvgpr_mov_b32 a199, a179
    v_accvgpr_mov_b32 a200, a180
    v_accvgpr_mov_b32 a201, a181
    v_accvgpr_mov_b32 a202, a182
    v_accvgpr_mov_b32 a203, a183
    s_add_u32 s31, s35, 50331648
    buffer_load_dwordx4 a[160:163], v6, s[4:7], s31 offen offset:0 sc1
    buffer_load_dwordx4 a[164:167], v6, s[4:7], s31 offen offset:1024 sc1
    s_add_u32 s31, s35, 54525952
    buffer_load_dwordx4 a[168:171], v6, s[4:7], s31 offen offset:0 sc1
    buffer_load_dwordx4 a[172:175], v6, s[4:7], s31 offen offset:1024 sc1
    s_add_u32 s31, s35, 58720256
    buffer_load_dwordx4 a[176:179], v6, s[4:7], s31 offen offset:0 sc1
    buffer_load_dwordx4 a[180:183], v6, s[4:7], s31 offen offset:1024 sc1
    v_max3_f32 v14, v136, v137, v138
    v_max3_f32 v14, v14, v139, v140
    v_max3_f32 v14, v14, v141, v142
    v_max3_f32 v14, v14, v143, v112
    v_max3_f32 v14, v14, v113, v114
    v_max3_f32 v14, v14, v115, v116
    v_max3_f32 v14, v14, v117, v118
    v_max3_f32 v14, v14, v119, v120
    v_max3_f32 v14, v14, v121, v122
    v_max3_f32 v14, v14, v123, v124
    v_max3_f32 v14, v14, v125, v126
    v_max_f32 v14, v14, v127
    v_mov_b32 v15, v14
    s_nop 1
    v_permlane32_swap_b32 v14, v15
    v_max_f32 v14, v14, v15
    v_mul_f32 v14, s58, v14
    v_fma_f32 v136, v136, s58, -v14
    v_fma_f32 v137, v137, s58, -v14
    v_fma_f32 v138, v138, s58, -v14
    v_fma_f32 v139, v139, s58, -v14
    v_fma_f32 v140, v140, s58, -v14
    v_fma_f32 v141, v141, s58, -v14
    v_fma_f32 v142, v142, s58, -v14
    v_fma_f32 v143, v143, s58, -v14
    v_fma_f32 v112, v112, s58, -v14
    v_fma_f32 v113, v113, s58, -v14
    v_fma_f32 v114, v114, s58, -v14
    v_fma_f32 v115, v115, s58, -v14
    v_fma_f32 v116, v116, s58, -v14
    v_fma_f32 v117, v117, s58, -v14
    v_fma_f32 v118, v118, s58, -v14
    v_fma_f32 v119, v119, s58, -v14
    v_fma_f32 v120, v120, s58, -v14
    v_fma_f32 v121, v121, s58, -v14
    v_fma_f32 v122, v122, s58, -v14
    v_fma_f32 v123, v123, s58, -v14
    v_fma_f32 v124, v124, s58, -v14
    v_fma_f32 v125, v125, s58, -v14
    v_fma_f32 v126, v126, s58, -v14
    v_fma_f32 v127, v127, s58, -v14
    v_exp_f32 v136, v136
    v_exp_f32 v137, v137
    v_exp_f32 v138, v138
    v_exp_f32 v139, v139
    v_exp_f32 v140, v140
    v_exp_f32 v141, v141
    v_exp_f32 v142, v142
    v_exp_f32 v143, v143
    v_exp_f32 v112, v112
    v_exp_f32 v113, v113
    v_exp_f32 v114, v114
    v_exp_f32 v115, v115
    v_exp_f32 v116, v116
    v_exp_f32 v117, v117
    v_exp_f32 v118, v118
    v_exp_f32 v119, v119
    v_exp_f32 v120, v120
    v_exp_f32 v121, v121
    v_exp_f32 v122, v122
    v_exp_f32 v123, v123
    v_exp_f32 v124, v124
    v_exp_f32 v125, v125
    v_exp_f32 v126, v126
    v_exp_f32 v127, v127
    v_add_f32 v26, v136, v137
    v_add_f32 v15, v138, v139
    v_add_f32 v26, v26, v140
    v_add_f32 v15, v15, v141
    v_add_f32 v26, v26, v142
    v_add_f32 v15, v15, v143
    v_add_f32 v26, v26, v112
    v_add_f32 v15, v15, v113
    v_add_f32 v26, v26, v114
    v_add_f32 v15, v15, v115
    v_add_f32 v26, v26, v116
    v_add_f32 v15, v15, v117
    v_add_f32 v26, v26, v118
    v_add_f32 v15, v15, v119
    v_add_f32 v26, v26, v120
    v_add_f32 v15, v15, v121
    v_add_f32 v26, v26, v122
    v_add_f32 v15, v15, v123
    v_add_f32 v26, v26, v124
    v_add_f32 v15, v15, v125
    v_add_f32 v26, v26, v126
    v_add_f32 v15, v15, v127
    v_add_f32 v26, v26, v15
    v_mov_b32 v15, v26
    s_nop 1
    v_permlane32_swap_b32 v26, v15
    v_add_f32 v26, v26, v15
    v_rcp_f32 v26, v26
    v_cvt_pk_bf16_f32 v28, v112, v113
    v_cvt_pk_bf16_f32 v29, v114, v115
    v_cvt_pk_bf16_f32 v30, v116, v117
    v_cvt_pk_bf16_f32 v31, v118, v119
    v_cvt_pk_bf16_f32 v32, v120, v121
    v_cvt_pk_bf16_f32 v33, v122, v123
    v_cvt_pk_bf16_f32 v34, v124, v125
    v_cvt_pk_bf16_f32 v35, v126, v127
    v_cvt_pk_bf16_f32 v36, v136, v137
    v_cvt_pk_bf16_f32 v37, v138, v139
    v_cvt_pk_bf16_f32 v38, v140, v141
    v_cvt_pk_bf16_f32 v39, v142, v143
    v_mfma_f32_32x32x16_bf16 v[144:159], a[196:199], v[28:31], 0
    v_mfma_f32_32x32x16_bf16 v[144:159], a[200:203], v[32:35], v[144:159]
    v_mfma_f32_32x32x16_bf16 v[144:159], a[192:195], v[36:39], v[144:159]
    v_accvgpr_mov_b32 a192, a200
    v_accvgpr_mov_b32 a193, a201
    v_accvgpr_mov_b32 a194, a202
    v_accvgpr_mov_b32 a195, a203
    s_waitcnt vmcnt(6)
    v_mov_b32 v2, s45
    buffer_store_dword v2, v12, s[4:7], s43 offen sc1
    s_cmp_lg_u32 s54, 0
    s_cbranch_scc1 at_nb_60
    v_mov_b32 v14, 0xf149f2ca
    v_add_u32 v3, 32, v11
    v_and_b32 v3, 0xfffffff1, v3
    v_cmp_ne_u32 vcc, 0, v3
    s_nop 1
    v_cndmask_b32 v80, 0, v14, vcc
    v_add_u32 v3, 31, v11
    v_and_b32 v3, 0xfffffff1, v3
    v_cmp_ne_u32 vcc, 0, v3
    s_nop 1
    v_cndmask_b32 v81, 0, v14, vcc
    v_add_u32 v3, 30, v11
    v_and_b32 v3, 0xfffffff1, v3
    v_cmp_ne_u32 vcc, 0, v3
    s_nop 1
    v_cndmask_b32 v82, 0, v14, vcc
    v_add_u32 v3, 29, v11
    v_and_b32 v3, 0xfffffff1, v3
    v_cmp_ne_u32 vcc, 0, v3
    s_nop 1
    v_cndmask_b32 v83, 0, v14, vcc
    v_add_u32 v3, 24, v11
    v_and_b32 v3, 0xfffffff1, v3
    v_cmp_ne_u32 vcc, 0, v3
    s_nop 1
    v_cndmask_b32 v84, 0, v14, vcc
    v_add_u32 v3, 23, v11
    v_and_b32 v3, 0xfffffff1, v3
    v_cmp_ne_u32 vcc, 0, v3
    s_nop 1
    v_cndmask_b32 v85, 0, v14, vcc
    v_add_u32 v3, 22, v11
    v_and_b32 v3, 0xfffffff1, v3
    v_cmp_ne_u32 vcc, 0, v3
    s_nop 1
    v_cndmask_b32 v86, 0, v14, vcc
    v_add_u32 v3, 21, v11
    v_and_b32 v3, 0xfffffff1, v3
    v_cmp_ne_u32 vcc, 0, v3
    s_nop 1
    v_cndmask_b32 v87, 0, v14, vcc
    v_add_u32 v3, 16, v11
    v_and_b32 v3, 0xfffffff1, v3
    v_cmp_ne_u32 vcc, 0, v3
    s_nop 1
    v_cndmask_b32 v88, 0, v14, vcc
    v_add_u32 v3, 15, v11
    v_and_b32 v3, 0xfffffff1, v3
    v_cmp_ne_u32 vcc, 0, v3
    s_nop 1
    v_cndmask_b32 v89, 0, v14, vcc
    v_add_u32 v3, 14, v11
    v_and_b32 v3, 0xfffffff1, v3
    v_cmp_ne_u32 vcc, 0, v3
    s_nop 1
    v_cndmask_b32 v90, 0, v14, vcc
    v_add_u32 v3, 13, v11
    v_and_b32 v3, 0xfffffff1, v3
    v_cmp_ne_u32 vcc, 0, v3
    s_nop 1
    v_cndmask_b32 v91, 0, v14, vcc
    v_add_u32 v3, 8, v11
    v_and_b32 v3, 0xfffffff1, v3
    v_cmp_ne_u32 vcc, 0, v3
    s_nop 1
    v_cndmask_b32 v92, 0, v14, vcc
    v_add_u32 v3, 7, v11
    v_and_b32 v3, 0xfffffff1, v3
    v_cmp_ne_u32 vcc, 0, v3
    s_nop 1
    v_cndmask_b32 v93, 0, v14, vcc
    v_add_u32 v3, 6, v11
    v_and_b32 v3, 0xfffffff1, v3
    v_cmp_ne_u32 vcc, 0, v3
    s_nop 1
    v_cndmask_b32 v94, 0, v14, vcc
    v_add_u32 v3, 5, v11
    v_and_b32 v3, 0xfffffff1, v3
    v_cmp_ne_u32 vcc, 0, v3
    s_nop 1
    v_cndmask_b32 v95, 0, v14, vcc
at_nb_60:
    s_nop 2
    v_mul_f32 v144, v144, v26
    v_mul_f32 v145, v145, v26
    v_mul_f32 v146, v146, v26
    v_mul_f32 v147, v147, v26
    v_mul_f32 v148, v148, v26
    v_mul_f32 v149, v149, v26
    v_mul_f32 v150, v150, v26
    v_mul_f32 v151, v151, v26
    v_mul_f32 v152, v152, v26
    v_mul_f32 v153, v153, v26
    v_mul_f32 v154, v154, v26
    v_mul_f32 v155, v155, v26
    v_mul_f32 v156, v156, v26
    v_mul_f32 v157, v157, v26
    v_mul_f32 v158, v158, v26
    v_mul_f32 v159, v159, v26
    v_cvt_pk_bf16_f32 v208, v144, v145
    v_cvt_pk_bf16_f32 v209, v146, v147
    v_cvt_pk_bf16_f32 v210, v148, v149
    v_cvt_pk_bf16_f32 v211, v150, v151
    v_cvt_pk_bf16_f32 v212, v152, v153
    v_cvt_pk_bf16_f32 v213, v154, v155
    v_cvt_pk_bf16_f32 v214, v156, v157
    v_cvt_pk_bf16_f32 v215, v158, v159
    v_permlane32_swap_b32 v208, v210
    v_permlane32_swap_b32 v209, v211
    v_permlane32_swap_b32 v212, v214
    v_permlane32_swap_b32 v213, v215
    buffer_store_dwordx4 v[208:211], v6, s[4:7], s48 offen offset:0 sc1
    buffer_store_dwordx4 v[212:215], v6, s[4:7], s48 offen offset:1024 sc1
    s_add_u32 s54, s54, 1
    s_mov_b32 s43, 16384
    s_mov_b32 s45, s54
    s_waitcnt vmcnt(3)
    s_branch at_top_56
at_end_59:
    s_waitcnt vmcnt(0) lgkmcnt(0)
    s_branch L_o64
L_o64:
    s_cmp_ge_u32 s28, 80
    s_cbranch_scc1 L_dump
    s_load_dwordx2 s[72:73], s[0:1], 40
    s_load_dwordx2 s[74:75], s[0:1], 80
    s_mul_i32 s44, s28, 205
    s_lshr_b32 s44, s44, 10
    s_mul_i32 s31, s44, 5
    s_sub_u32 s30, s28, s31
    s_waitcnt lgkmcnt(0)
    s_mov_b32 s8, s72
    s_and_b32 s9, s73, 0xffff
    s_mov_b32 s10, 8388608
    s_mov_b32 s11, 0x00020000
    s_mov_b32 s20, s74
    s_and_b32 s21, s75, 0xffff
    s_mov_b32 s22, 8388608
    s_mov_b32 s23, 0x00020000
    s_lshl_b32 s31, s29, 21
    s_lshl_b32 s33, s44, 7
    s_add_u32 s31, s31, s33
    v_lshrrev_b32 v6, 3, v1
    v_lshlrev_b32 v6, 11, v6
    v_and_b32 v4, 7, v1
    v_lshl_add_u32 v6, v4, 4, v6
    v_add_u32 v6, s31, v6
    s_lshl_b32 s31, s29, 15
    v_lshrrev_b32 v7, 5, v1
    v_lshlrev_b32 v7, 9, v7
    v_bfe_u32 v4, v1, 2, 2
    v_lshl_add_u32 v7, v4, 7, v7
    v_bfe_u32 v4, v1, 4, 1
    v_lshl_add_u32 v7, v4, 5, v7
    v_and_b32 v4, 3, v1
    v_lshl_add_u32 v7, v4, 3, v7
    v_add_u32 v7, s31, v7
    s_lshl_b32 s32, s29, 15
    s_add_u32 m0, s32, 0
    s_mov_b32 s38, 0
    buffer_load_dwordx4 v6, s[8:11], s38 offen lds
    s_add_u32 m0, s32, 1024
    s_add_u32 s38, s38, 16384
    buffer_load_dwordx4 v6, s[8:11], s38 offen lds
    s_add_u32 m0, s32, 2048
    s_add_u32 s38, s38, 16384
    buffer_load_dwordx4 v6, s[8:11], s38 offen lds
    s_add_u32 m0, s32, 3072
    s_add_u32 s38, s38, 16384
    buffer_load_dwordx4 v6, s[8:11], s38 offen lds
    s_add_u32 m0, s32, 4096
    s_add_u32 s38, s38, 16384
    buffer_load_dwordx4 v6, s[8:11], s38 offen lds
    s_add_u32 m0, s32, 5120
    s_add_u32 s38, s38, 16384
    buffer_load_dwordx4 v6, s[8:11], s38 offen lds
    s_add_u32 m0, s32, 6144
    s_add_u32 s38, s38, 16384
    buffer_load_dwordx4 v6, s[8:11], s38 offen lds
    s_add_u32 m0, s32, 7168
    s_add_u32 s38, s38, 16384
    buffer_load_dwordx4 v6, s[8:11], s38 offen lds
    s_add_u32 m0, s32, 8192
    s_add_u32 s38, s38, 16384
    buffer_load_dwordx4 v6, s[8:11], s38 offen lds
    s_add_u32 m0, s32, 9216
    s_add_u32 s38, s38, 16384
    buffer_load_dwordx4 v6, s[8:11], s38 offen lds
    s_add_u32 m0, s32, 10240
    s_add_u32 s38, s38, 16384
    buffer_load_dwordx4 v6, s[8:11], s38 offen lds
    s_add_u32 m0, s32, 11264
    s_add_u32 s38, s38, 16384
    buffer_load_dwordx4 v6, s[8:11], s38 offen lds
    s_add_u32 m0, s32, 12288
    s_add_u32 s38, s38, 16384
    buffer_load_dwordx4 v6, s[8:11], s38 offen lds
    s_add_u32 m0, s32, 13312
    s_add_u32 s38, s38, 16384
    buffer_load_dwordx4 v6, s[8:11], s38 offen lds
    s_add_u32 m0, s32, 14336
    s_add_u32 s38, s38, 16384
    buffer_load_dwordx4 v6, s[8:11], s38 offen lds
    s_add_u32 m0, s32, 15360
    s_add_u32 s38, s38, 16384
    buffer_load_dwordx4 v6, s[8:11], s38 offen lds
    s_add_u32 m0, s32, 16384
    s_add_u32 s38, s38, 16384
    buffer_load_dwordx4 v6, s[8:11], s38 offen lds
    s_add_u32 m0, s32, 17408
    s_add_u32 s38, s38, 16384
    buffer_load_dwordx4 v6, s[8:11], s38 offen lds
    s_add_u32 m0, s32, 18432
    s_add_u32 s38, s38, 16384
    buffer_load_dwordx4 v6, s[8:11], s38 offen lds
    s_add_u32 m0, s32, 19456
    s_add_u32 s38, s38, 16384
    buffer_load_dwordx4 v6, s[8:11], s38 offen lds
    s_add_u32 m0, s32, 20480
    s_add_u32 s38, s38, 16384
    buffer_load_dwordx4 v6, s[8:11], s38 offen lds
    s_add_u32 m0, s32, 21504
    s_add_u32 s38, s38, 16384
    buffer_load_dwordx4 v6, s[8:11], s38 offen lds
    s_add_u32 m0, s32, 22528
    s_add_u32 s38, s38, 16384
    buffer_load_dwordx4 v6, s[8:11], s38 offen lds
    s_add_u32 m0, s32, 23552
    s_add_u32 s38, s38, 16384
    buffer_load_dwordx4 v6, s[8:11], s38 offen lds
    s_add_u32 m0, s32, 24576
    s_add_u32 s38, s38, 16384
    buffer_load_dwordx4 v6, s[8:11], s38 offen lds
    s_add_u32 m0, s32, 25600
    s_add_u32 s38, s38, 16384
    buffer_load_dwordx4 v6, s[8:11], s38 offen lds
    s_add_u32 m0, s32, 26624
    s_add_u32 s38, s38, 16384
    buffer_load_dwordx4 v6, s[8:11], s38 offen lds
    s_add_u32 m0, s32, 27648
    s_add_u32 s38, s38, 16384
    buffer_load_dwordx4 v6, s[8:11], s38 offen lds
    s_add_u32 m0, s32, 28672
    s_add_u32 s38, s38, 16384
    buffer_load_dwordx4 v6, s[8:11], s38 offen lds
    s_add_u32 m0, s32, 29696
    s_add_u32 s38, s38, 16384
    buffer_load_dwordx4 v6, s[8:11], s38 offen lds
    s_add_u32 m0, s32, 30720
    s_add_u32 s38, s38, 16384
    buffer_load_dwordx4 v6, s[8:11], s38 offen lds
    s_add_u32 m0, s32, 31744
    s_add_u32 s38, s38, 16384
    buffer_load_dwordx4 v6, s[8:11], s38 offen lds
    s_waitcnt vmcnt(30)
    ds_read_b64_tr_b16 a[0:1], v7 offset:0
    ds_read_b64_tr_b16 a[2:3], v7 offset:1024
    ds_read_b64_tr_b16 a[4:5], v7 offset:64
    ds_read_b64_tr_b16 a[6:7], v7 offset:1088
    s_waitcnt vmcnt(28)
    ds_read_b64_tr_b16 a[8:9], v7 offset:2048
    ds_read_b64_tr_b16 a[10:11], v7 offset:3072
    ds_read_b64_tr_b16 a[12:13], v7 offset:2112
    ds_read_b64_tr_b16 a[14:15], v7 offset:3136
    s_waitcnt lgkmcnt(4)
    s_add_u32 m0, s32, 0
    s_add_u32 s38, s38, 16384
    buffer_load_dwordx4 v6, s[8:11], s38 offen lds
    s_add_u32 m0, s32, 1024
    s_add_u32 s38, s38, 16384
    buffer_load_dwordx4 v6, s[8:11], s38 offen lds
    s_waitcnt vmcnt(28)
    ds_read_b64_tr_b16 a[16:17], v7 offset:4096
    ds_read_b64_tr_b16 a[18:19], v7 offset:5120
    ds_read_b64_tr_b16 a[20:21], v7 offset:4160
    ds_read_b64_tr_b16 a[22:23], v7 offset:5184
    s_waitcnt lgkmcnt(4)
    s_add_u32 m0, s32, 2048
    s_add_u32 s38, s38, 16384
    buffer_load_dwordx4 v6, s[8:11], s38 offen lds
    s_add_u32 m0, s32, 3072
    s_add_u32 s38, s38, 16384
    buffer_load_dwordx4 v6, s[8:11], s38 offen lds
    s_waitcnt vmcnt(28)
    ds_read_b64_tr_b16 a[24:25], v7 offset:6144
    ds_read_b64_tr_b16 a[26:27], v7 offset:7168
    ds_read_b64_tr_b16 a[28:29], v7 offset:6208
    ds_read_b64_tr_b16 a[30:31], v7 offset:7232
    s_waitcnt lgkmcnt(4)
    s_add_u32 m0, s32, 4096
    s_add_u32 s38, s38, 16384
    buffer_load_dwordx4 v6, s[8:11], s38 offen lds
    s_add_u32 m0, s32, 5120
    s_add_u32 s38, s38, 16384
    buffer_load_dwordx4 v6, s[8:11], s38 offen lds
    s_waitcnt vmcnt(28)
    ds_read_b64_tr_b16 a[32:33], v7 offset:8192
    ds_read_b64_tr_b16 a[34:35], v7 offset:9216
    ds_read_b64_tr_b16 a[36:37], v7 offset:8256
    ds_read_b64_tr_b16 a[38:39], v7 offset:9280
    s_waitcnt lgkmcnt(4)
    s_add_u32 m0, s32, 6144
    s_add_u32 s38, s38, 16384
    buffer_load_dwordx4 v6, s[8:11], s38 offen lds
    s_add_u32 m0, s32, 7168
    s_add_u32 s38, s38, 16384
    buffer_load_dwordx4 v6, s[8:11], s38 offen lds
    s_waitcnt vmcnt(28)
    ds_read_b64_tr_b16 a[40:41], v7 offset:10240
    ds_read_b64_tr_b16 a[42:43], v7 offset:11264
    ds_read_b64_tr_b16 a[44:45], v7 offset:10304
    ds_read_b64_tr_b16 a[46:47], v7 offset:11328
    s_waitcnt lgkmcnt(4)
    s_add_u32 m0, s32, 8192
    s_add_u32 s38, s38, 16384
    buffer_load_dwordx4 v6, s[8:11], s38 offen lds
    s_add_u32 m0, s32, 9216
    s_add_u32 s38, s38, 16384
    buffer_load_dwordx4 v6, s[8:11], s38 offen lds
    s_waitcnt vmcnt(28)
    ds_read_b64_tr_b16 a[48:49], v7 offset:12288
    ds_read_b64_tr_b16 a[50:51], v7 offset:13312
    ds_read_b64_tr_b16 a[52:53], v7 offset:12352
    ds_read_b64_tr_b16 a[54:55], v7 offset:13376
    s_waitcnt lgkmcnt(4)
    s_add_u32 m0, s32, 10240
    s_add_u32 s38, s38, 16384
    buffer_load_dwordx4 v6, s[8:11], s38 offen lds
    s_add_u32 m0, s32, 11264
    s_add_u32 s38, s38, 16384
    buffer_load_dwordx4 v6, s[8:11], s38 offen lds
    s_waitcnt vmcnt(28)
    ds_read_b64_tr_b16 a[56:57], v7 offset:14336
    ds_read_b64_tr_b16 a[58:59], v7 offset:15360
    ds_read_b64_tr_b16 a[60:61], v7 offset:14400
    ds_read_b64_tr_b16 a[62:63], v7 offset:15424
    s_waitcnt lgkmcnt(4)
    s_add_u32 m0, s32, 12288
    s_add_u32 s38, s38, 16384
    buffer_load_dwordx4 v6, s[8:11], s38 offen lds
    s_add_u32 m0, s32, 13312
    s_add_u32 s38, s38, 16384
    buffer_load_dwordx4 v6, s[8:11], s38 offen lds
    s_waitcnt vmcnt(28)
    ds_read_b64_tr_b16 a[64:65], v7 offset:16384
    ds_read_b64_tr_b16 a[66:67], v7 offset:17408
    ds_read_b64_tr_b16 a[68:69], v7 offset:16448
    ds_read_b64_tr_b16 a[70:71], v7 offset:17472
    s_waitcnt lgkmcnt(4)
    s_add_u32 m0, s32, 14336
    s_add_u32 s38, s38, 16384
    buffer_load_dwordx4 v6, s[8:11], s38 offen lds
    s_add_u32 m0, s32, 15360
    s_add_u32 s38, s38, 16384
    buffer_load_dwordx4 v6, s[8:11], s38 offen lds
    s_waitcnt vmcnt(28)
    ds_read_b64_tr_b16 a[72:73], v7 offset:18432
    ds_read_b64_tr_b16 a[74:75], v7 offset:19456
    ds_read_b64_tr_b16 a[76:77], v7 offset:18496
    ds_read_b64_tr_b16 a[78:79], v7 offset:19520
    s_waitcnt lgkmcnt(4)
    s_add_u32 m0, s32, 16384
    s_add_u32 s38, s38, 16384
    buffer_load_dwordx4 v6, s[8:11], s38 offen lds
    s_add_u32 m0, s32, 17408
    s_add_u32 s38, s38, 16384
    buffer_load_dwordx4 v6, s[8:11], s38 offen lds
    s_waitcnt vmcnt(28)
    ds_read_b64_tr_b16 a[80:81], v7 offset:20480
    ds_read_b64_tr_b16 a[82:83], v7 offset:21504
    ds_read_b64_tr_b16 a[84:85], v7 offset:20544
    ds_read_b64_tr_b16 a[86:87], v7 offset:21568
    s_waitcnt lgkmcnt(4)
    s_add_u32 m0, s32, 18432
    s_add_u32 s38, s38, 16384
    buffer_load_dwordx4 v6, s[8:11], s38 offen lds
    s_add_u32 m0, s32, 19456
    s_add_u32 s38, s38, 16384
    buffer_load_dwordx4 v6, s[8:11], s38 offen lds
    s_waitcnt vmcnt(28)
    ds_read_b64_tr_b16 a[88:89], v7 offset:22528
    ds_read_b64_tr_b16 a[90:91], v7 offset:23552
    ds_read_b64_tr_b16 a[92:93], v7 offset:22592
    ds_read_b64_tr_b16 a[94:95], v7 offset:23616
    s_waitcnt lgkmcnt(4)
    s_add_u32 m0, s32, 20480
    s_add_u32 s38, s38, 16384
    buffer_load_dwordx4 v6, s[8:11], s38 offen lds
    s_add_u32 m0, s32, 21504
    s_add_u32 s38, s38, 16384
    buffer_load_dwordx4 v6, s[8:11], s38 offen lds
    s_waitcnt vmcnt(28)
    ds_read_b64_tr_b16 a[96:97], v7 offset:24576
    ds_read_b64_tr_b16 a[98:99], v7 offset:25600
    ds_read_b64_tr_b16 a[100:101], v7 offset:24640
    ds_read_b64_tr_b16 a[102:103], v7 offset:25664
    s_waitcnt lgkmcnt(4)
    s_add_u32 m0, s32, 22528
    s_add_u32 s38, s38, 16384
    buffer_load_dwordx4 v6, s[8:11], s38 offen lds
    s_add_u32 m0, s32, 23552
    s_add_u32 s38, s38, 16384
    buffer_load_dwordx4 v6, s[8:11], s38 offen lds
    s_waitcnt vmcnt(28)
    ds_read_b64_tr_b16 a[104:105], v7 offset:26624
    ds_read_b64_tr_b16 a[106:107], v7 offset:27648
    ds_read_b64_tr_b16 a[108:109], v7 offset:26688
    ds_read_b64_tr_b16 a[110:111], v7 offset:27712
    s_waitcnt lgkmcnt(4)
    s_add_u32 m0, s32, 24576
    s_add_u32 s38, s38, 16384
    buffer_load_dwordx4 v6, s[8:11], s38 offen lds
    s_add_u32 m0, s32, 25600
    s_add_u32 s38, s38, 16384
    buffer_load_dwordx4 v6, s[8:11], s38 offen lds
    s_waitcnt vmcnt(28)
    ds_read_b64_tr_b16 a[112:113], v7 offset:28672
    ds_read_b64_tr_b16 a[114:115], v7 offset:29696
    ds_read_b64_tr_b16 a[116:117], v7 offset:28736
    ds_read_b64_tr_b16 a[118:119], v7 offset:29760
    s_waitcnt lgkmcnt(4)
    s_add_u32 m0, s32, 26624
    s_add_u32 s38, s38, 16384
    buffer_load_dwordx4 v6, s[8:11], s38 offen lds
    s_add_u32 m0, s32, 27648
    s_add_u32 s38, s38, 16384
    buffer_load_dwordx4 v6, s[8:11], s38 offen lds
    s_waitcnt vmcnt(28)
    ds_read_b64_tr_b16 a[120:121], v7 offset:30720
    ds_read_b64_tr_b16 a[122:123], v7 offset:31744
    ds_read_b64_tr_b16 a[124:125], v7 offset:30784
    ds_read_b64_tr_b16 a[126:127], v7 offset:31808
    s_waitcnt lgkmcnt(4)
    s_add_u32 m0, s32, 28672
    s_add_u32 s38, s38, 16384
    buffer_load_dwordx4 v6, s[8:11], s38 offen lds
    s_add_u32 m0, s32, 29696
    s_add_u32 s38, s38, 16384
    buffer_load_dwordx4 v6, s[8:11], s38 offen lds
    s_waitcnt vmcnt(28)
    ds_read_b64_tr_b16 a[128:129], v7 offset:0
    ds_read_b64_tr_b16 a[130:131], v7 offset:1024
    ds_read_b64_tr_b16 a[132:133], v7 offset:64
    ds_read_b64_tr_b16 a[134:135], v7 offset:1088
    s_waitcnt lgkmcnt(4)
    s_add_u32 m0, s32, 30720
    s_add_u32 s38, s38, 16384
    buffer_load_dwordx4 v6, s[8:11], s38 offen lds
    s_add_u32 m0, s32, 31744
    s_add_u32 s38, s38, 16384
    buffer_load_dwordx4 v6, s[8:11], s38 offen lds
    s_waitcnt vmcnt(28)
    ds_read_b64_tr_b16 a[136:137], v7 offset:2048
    ds_read_b64_tr_b16 a[138:139], v7 offset:3072
    ds_read_b64_tr_b16 a[140:141], v7 offset:2112
    ds_read_b64_tr_b16 a[142:143], v7 offset:3136
    s_waitcnt lgkmcnt(4)
    s_add_u32 m0, s32, 0
    s_add_u32 s38, s38, 16384
    buffer_load_dwordx4 v6, s[8:11], s38 offen lds
    s_add_u32 m0, s32, 1024
    s_add_u32 s38, s38, 16384
    buffer_load_dwordx4 v6, s[8:11], s38 offen lds
    s_waitcnt vmcnt(28)
    ds_read_b64_tr_b16 a[144:145], v7 offset:4096
    ds_read_b64_tr_b16 a[146:147], v7 offset:5120
    ds_read_b64_tr_b16 a[148:149], v7 offset:4160
    ds_read_b64_tr_b16 a[150:151], v7 offset:5184
    s_waitcnt lgkmcnt(4)
    s_add_u32 m0, s32, 2048
    s_add_u32 s38, s38, 16384
    buffer_load_dwordx4 v6, s[8:11], s38 offen lds
    s_add_u32 m0, s32, 3072
    s_add_u32 s38, s38, 16384
    buffer_load_dwordx4 v6, s[8:11], s38 offen lds
    s_waitcnt vmcnt(28)
    ds_read_b64_tr_b16 a[152:153], v7 offset:6144
    ds_read_b64_tr_b16 a[154:155], v7 offset:7168
    ds_read_b64_tr_b16 a[156:157], v7 offset:6208
    ds_read_b64_tr_b16 a[158:159], v7 offset:7232
    s_waitcnt lgkmcnt(4)
    s_add_u32 m0, s32, 4096
    s_add_u32 s38, s38, 16384
    buffer_load_dwordx4 v6, s[8:11], s38 offen lds
    s_add_u32 m0, s32, 5120
    s_add_u32 s38, s38, 16384
    buffer_load_dwordx4 v6, s[8:11], s38 offen lds
    s_waitcnt vmcnt(28)
    ds_read_b64_tr_b16 a[160:161], v7 offset:8192
    ds_read_b64_tr_b16 a[162:163], v7 offset:9216
    ds_read_b64_tr_b16 a[164:165], v7 offset:8256
    ds_read_b64_tr_b16 a[166:167], v7 offset:9280
    s_waitcnt lgkmcnt(4)
    s_add_u32 m0, s32, 6144
    s_add_u32 s38, s38, 16384
    buffer_load_dwordx4 v6, s[8:11], s38 offen lds
    s_add_u32 m0, s32, 7168
    s_add_u32 s38, s38, 16384
    buffer_load_dwordx4 v6, s[8:11], s38 offen lds
    s_waitcnt vmcnt(28)
    ds_read_b64_tr_b16 a[168:169], v7 offset:10240
    ds_read_b64_tr_b16 a[170:171], v7 offset:11264
    ds_read_b64_tr_b16 a[172:173], v7 offset:10304
    ds_read_b64_tr_b16 a[174:175], v7 offset:11328
    s_waitcnt lgkmcnt(4)
    s_add_u32 m0, s32, 8192
    s_add_u32 s38, s38, 16384
    buffer_load_dwordx4 v6, s[8:11], s38 offen lds
    s_add_u32 m0, s32, 9216
    s_add_u32 s38, s38, 16384
    buffer_load_dwordx4 v6, s[8:11], s38 offen lds
    s_waitcnt vmcnt(28)
    ds_read_b64_tr_b16 a[176:177], v7 offset:12288
    ds_read_b64_tr_b16 a[178:179], v7 offset:13312
    ds_read_b64_tr_b16 a[180:181], v7 offset:12352
    ds_read_b64_tr_b16 a[182:183], v7 offset:13376
    s_waitcnt lgkmcnt(4)
    s_add_u32 m0, s32, 10240
    s_add_u32 s38, s38, 16384
    buffer_load_dwordx4 v6, s[8:11], s38 offen lds
    s_add_u32 m0, s32, 11264
    s_add_u32 s38, s38, 16384
    buffer_load_dwordx4 v6, s[8:11], s38 offen lds
    s_waitcnt vmcnt(28)
    ds_read_b64_tr_b16 a[184:185], v7 offset:14336
    ds_read_b64_tr_b16 a[186:187], v7 offset:15360
    ds_read_b64_tr_b16 a[188:189], v7 offset:14400
    ds_read_b64_tr_b16 a[190:191], v7 offset:15424
    s_waitcnt lgkmcnt(4)
    s_add_u32 m0, s32, 12288
    s_add_u32 s38, s38, 16384
    buffer_load_dwordx4 v6, s[8:11], s38 offen lds
    s_add_u32 m0, s32, 13312
    s_add_u32 s38, s38, 16384
    buffer_load_dwordx4 v6, s[8:11], s38 offen lds
    s_waitcnt vmcnt(28)
    ds_read_b64_tr_b16 a[192:193], v7 offset:16384
    ds_read_b64_tr_b16 a[194:195], v7 offset:17408
    ds_read_b64_tr_b16 a[196:197], v7 offset:16448
    ds_read_b64_tr_b16 a[198:199], v7 offset:17472
    s_waitcnt lgkmcnt(4)
    s_add_u32 m0, s32, 14336
    s_add_u32 s38, s38, 16384
    buffer_load_dwordx4 v6, s[8:11], s38 offen lds
    s_add_u32 m0, s32, 15360
    s_add_u32 s38, s38, 16384
    buffer_load_dwordx4 v6, s[8:11], s38 offen lds
    s_waitcnt vmcnt(28)
    ds_read_b64_tr_b16 a[200:201], v7 offset:18432
    ds_read_b64_tr_b16 a[202:203], v7 offset:19456
    ds_read_b64_tr_b16 a[204:205], v7 offset:18496
    ds_read_b64_tr_b16 a[206:207], v7 offset:19520
    s_waitcnt lgkmcnt(4)
    s_add_u32 m0, s32, 16384
    s_add_u32 s38, s38, 16384
    buffer_load_dwordx4 v6, s[8:11], s38 offen lds
    s_add_u32 m0, s32, 17408
    s_add_u32 s38, s38, 16384
    buffer_load_dwordx4 v6, s[8:11], s38 offen lds
    s_waitcnt vmcnt(28)
    ds_read_b64_tr_b16 a[208:209], v7 offset:20480
    ds_read_b64_tr_b16 a[210:211], v7 offset:21504
    ds_read_b64_tr_b16 a[212:213], v7 offset:20544
    ds_read_b64_tr_b16 a[214:215], v7 offset:21568
    s_waitcnt lgkmcnt(4)
    s_add_u32 m0, s32, 18432
    s_add_u32 s38, s38, 16384
    buffer_load_dwordx4 v6, s[8:11], s38 offen lds
    s_add_u32 m0, s32, 19456
    s_add_u32 s38, s38, 16384
    buffer_load_dwordx4 v6, s[8:11], s38 offen lds
    s_waitcnt vmcnt(28)
    ds_read_b64_tr_b16 a[216:217], v7 offset:22528
    ds_read_b64_tr_b16 a[218:219], v7 offset:23552
    ds_read_b64_tr_b16 a[220:221], v7 offset:22592
    ds_read_b64_tr_b16 a[222:223], v7 offset:23616
    s_waitcnt lgkmcnt(4)
    s_add_u32 m0, s32, 20480
    s_add_u32 s38, s38, 16384
    buffer_load_dwordx4 v6, s[8:11], s38 offen lds
    s_add_u32 m0, s32, 21504
    s_add_u32 s38, s38, 16384
    buffer_load_dwordx4 v6, s[8:11], s38 offen lds
    s_waitcnt vmcnt(28)
    ds_read_b64_tr_b16 a[224:225], v7 offset:24576
    ds_read_b64_tr_b16 a[226:227], v7 offset:25600
    ds_read_b64_tr_b16 a[228:229], v7 offset:24640
    ds_read_b64_tr_b16 a[230:231], v7 offset:25664
    s_waitcnt lgkmcnt(4)
    s_add_u32 m0, s32, 22528
    s_add_u32 s38, s38, 16384
    buffer_load_dwordx4 v6, s[8:11], s38 offen lds
    s_add_u32 m0, s32, 23552
    s_add_u32 s38, s38, 16384
    buffer_load_dwordx4 v6, s[8:11], s38 offen lds
    s_waitcnt vmcnt(28)
    ds_read_b64_tr_b16 a[232:233], v7 offset:26624
    ds_read_b64_tr_b16 a[234:235], v7 offset:27648
    ds_read_b64_tr_b16 a[236:237], v7 offset:26688
    ds_read_b64_tr_b16 a[238:239], v7 offset:27712
    s_waitcnt lgkmcnt(4)
    s_add_u32 m0, s32, 24576
    s_add_u32 s38, s38, 16384
    buffer_load_dwordx4 v6, s[8:11], s38 offen lds
    s_add_u32 m0, s32, 25600
    s_add_u32 s38, s38, 16384
    buffer_load_dwordx4 v6, s[8:11], s38 offen lds
    s_waitcnt vmcnt(28)
    ds_read_b64_tr_b16 a[240:241], v7 offset:28672
    ds_read_b64_tr_b16 a[242:243], v7 offset:29696
    ds_read_b64_tr_b16 a[244:245], v7 offset:28736
    ds_read_b64_tr_b16 a[246:247], v7 offset:29760
    s_waitcnt lgkmcnt(4)
    s_add_u32 m0, s32, 26624
    s_add_u32 s38, s38, 16384
    buffer_load_dwordx4 v6, s[8:11], s38 offen lds
    s_add_u32 m0, s32, 27648
    s_add_u32 s38, s38, 16384
    buffer_load_dwordx4 v6, s[8:11], s38 offen lds
    s_waitcnt vmcnt(28)
    ds_read_b64_tr_b16 a[248:249], v7 offset:30720
    ds_read_b64_tr_b16 a[250:251], v7 offset:31744
    ds_read_b64_tr_b16 a[252:253], v7 offset:30784
    ds_read_b64_tr_b16 a[254:255], v7 offset:31808
    s_waitcnt lgkmcnt(4)
    s_add_u32 m0, s32, 28672
    s_add_u32 s38, s38, 16384
    buffer_load_dwordx4 v6, s[8:11], s38 offen lds
    s_add_u32 m0, s32, 29696
    s_add_u32 s38, s38, 16384
    buffer_load_dwordx4 v6, s[8:11], s38 offen lds
    s_waitcnt vmcnt(28)
    ds_read_b64_tr_b16 v[128:129], v7 offset:0
    ds_read_b64_tr_b16 v[130:131], v7 offset:1024
    ds_read_b64_tr_b16 v[132:133], v7 offset:64
    ds_read_b64_tr_b16 v[134:135], v7 offset:1088
    s_waitcnt lgkmcnt(4)
    s_add_u32 m0, s32, 30720
    s_add_u32 s38, s38, 16384
    buffer_load_dwordx4 v6, s[8:11], s38 offen lds
    s_add_u32 m0, s32, 31744
    s_add_u32 s38, s38, 16384
    buffer_load_dwordx4 v6, s[8:11], s38 offen lds
    s_waitcnt vmcnt(28)
    ds_read_b64_tr_b16 v[136:137], v7 offset:2048
    ds_read_b64_tr_b16 v[138:139], v7 offset:3072
    ds_read_b64_tr_b16 v[140:141], v7 offset:2112
    ds_read_b64_tr_b16 v[142:143], v7 offset:3136
    s_waitcnt lgkmcnt(4)
    s_add_u32 m0, s32, 0
    s_add_u32 s38, s38, 16384
    buffer_load_dwordx4 v6, s[8:11], s38 offen lds
    s_add_u32 m0, s32, 1024
    s_add_u32 s38, s38, 16384
    buffer_load_dwordx4 v6, s[8:11], s38 offen lds
    s_waitcnt vmcnt(28)
    ds_read_b64_tr_b16 v[144:145], v7 offset:4096
    ds_read_b64_tr_b16 v[146:147], v7 offset:5120
    ds_read_b64_tr_b16 v[148:149], v7 offset:4160
    ds_read_b64_tr_b16 v[150:151], v7 offset:5184
    s_waitcnt lgkmcnt(4)
    s_add_u32 m0, s32, 2048
    s_add_u32 s38, s38, 16384
    buffer_load_dwordx4 v6, s[8:11], s38 offen lds
    s_add_u32 m0, s32, 3072
    s_add_u32 s38, s38, 16384
    buffer_load_dwordx4 v6, s[8:11], s38 offen lds
    s_waitcnt vmcnt(28)
    ds_read_b64_tr_b16 v[152:153], v7 offset:6144
    ds_read_b64_tr_b16 v[154:155], v7 offset:7168
    ds_read_b64_tr_b16 v[156:157], v7 offset:6208
    ds_read_b64_tr_b16 v[158:159], v7 offset:7232
    s_waitcnt lgkmcnt(4)
    s_add_u32 m0, s32, 4096
    s_add_u32 s38, s38, 16384
    buffer_load_dwordx4 v6, s[8:11], s38 offen lds
    s_add_u32 m0, s32, 5120
    s_add_u32 s38, s38, 16384
    buffer_load_dwordx4 v6, s[8:11], s38 offen lds
    s_waitcnt vmcnt(28)
    ds_read_b64_tr_b16 v[160:161], v7 offset:8192
    ds_read_b64_tr_b16 v[162:163], v7 offset:9216
    ds_read_b64_tr_b16 v[164:165], v7 offset:8256
    ds_read_b64_tr_b16 v[166:167], v7 offset:9280
    s_waitcnt lgkmcnt(4)
    s_add_u32 m0, s32, 6144
    s_add_u32 s38, s38, 16384
    buffer_load_dwordx4 v6, s[8:11], s38 offen lds
    s_add_u32 m0, s32, 7168
    s_add_u32 s38, s38, 16384
    buffer_load_dwordx4 v6, s[8:11], s38 offen lds
    s_waitcnt vmcnt(28)
    ds_read_b64_tr_b16 v[168:169], v7 offset:10240
    ds_read_b64_tr_b16 v[170:171], v7 offset:11264
    ds_read_b64_tr_b16 v[172:173], v7 offset:10304
    ds_read_b64_tr_b16 v[174:175], v7 offset:11328
    s_waitcnt lgkmcnt(4)
    s_add_u32 m0, s32, 8192
    s_add_u32 s38, s38, 16384
    buffer_load_dwordx4 v6, s[8:11], s38 offen lds
    s_add_u32 m0, s32, 9216
    s_add_u32 s38, s38, 16384
    buffer_load_dwordx4 v6, s[8:11], s38 offen lds
    s_waitcnt vmcnt(28)
    ds_read_b64_tr_b16 v[176:177], v7 offset:12288
    ds_read_b64_tr_b16 v[178:179], v7 offset:13312
    ds_read_b64_tr_b16 v[180:181], v7 offset:12352
    ds_read_b64_tr_b16 v[182:183], v7 offset:13376
    s_waitcnt lgkmcnt(4)
    s_add_u32 m0, s32, 10240
    s_add_u32 s38, s38, 16384
    buffer_load_dwordx4 v6, s[8:11], s38 offen lds
    s_add_u32 m0, s32, 11264
    s_add_u32 s38, s38, 16384
    buffer_load_dwordx4 v6, s[8:11], s38 offen lds
    s_waitcnt vmcnt(28)
    ds_read_b64_tr_b16 v[184:185], v7 offset:14336
    ds_read_b64_tr_b16 v[186:187], v7 offset:15360
    ds_read_b64_tr_b16 v[188:189], v7 offset:14400
    ds_read_b64_tr_b16 v[190:191], v7 offset:15424
    s_waitcnt lgkmcnt(4)
    s_add_u32 m0, s32, 12288
    s_add_u32 s38, s38, 16384
    buffer_load_dwordx4 v6, s[8:11], s38 offen lds
    s_add_u32 m0, s32, 13312
    s_add_u32 s38, s38, 16384
    buffer_load_dwordx4 v6, s[8:11], s38 offen lds
    s_waitcnt vmcnt(28)
    ds_read_b64_tr_b16 v[192:193], v7 offset:16384
    ds_read_b64_tr_b16 v[194:195], v7 offset:17408
    ds_read_b64_tr_b16 v[196:197], v7 offset:16448
    ds_read_b64_tr_b16 v[198:199], v7 offset:17472
    s_waitcnt lgkmcnt(4)
    s_add_u32 m0, s32, 14336
    s_add_u32 s38, s38, 16384
    buffer_load_dwordx4 v6, s[8:11], s38 offen lds
    s_add_u32 m0, s32, 15360
    s_add_u32 s38, s38, 16384
    buffer_load_dwordx4 v6, s[8:11], s38 offen lds
    s_waitcnt vmcnt(28)
    ds_read_b64_tr_b16 v[200:201], v7 offset:18432
    ds_read_b64_tr_b16 v[202:203], v7 offset:19456
    ds_read_b64_tr_b16 v[204:205], v7 offset:18496
    ds_read_b64_tr_b16 v[206:207], v7 offset:19520
    s_waitcnt lgkmcnt(4)
    s_add_u32 m0, s32, 16384
    s_add_u32 s38, s38, 16384
    buffer_load_dwordx4 v6, s[8:11], s38 offen lds
    s_add_u32 m0, s32, 17408
    s_add_u32 s38, s38, 16384
    buffer_load_dwordx4 v6, s[8:11], s38 offen lds
    s_waitcnt vmcnt(28)
    ds_read_b64_tr_b16 v[208:209], v7 offset:20480
    ds_read_b64_tr_b16 v[210:211], v7 offset:21504
    ds_read_b64_tr_b16 v[212:213], v7 offset:20544
    ds_read_b64_tr_b16 v[214:215], v7 offset:21568
    s_waitcnt lgkmcnt(4)
    s_add_u32 m0, s32, 18432
    s_add_u32 s38, s38, 16384
    buffer_load_dwordx4 v6, s[8:11], s38 offen lds
    s_add_u32 m0, s32, 19456
    s_add_u32 s38, s38, 16384
    buffer_load_dwordx4 v6, s[8:11], s38 offen lds
    s_waitcnt vmcnt(28)
    ds_read_b64_tr_b16 v[216:217], v7 offset:22528
    ds_read_b64_tr_b16 v[218:219], v7 offset:23552
    ds_read_b64_tr_b16 v[220:221], v7 offset:22592
    ds_read_b64_tr_b16 v[222:223], v7 offset:23616
    s_waitcnt lgkmcnt(4)
    s_add_u32 m0, s32, 20480
    s_add_u32 s38, s38, 16384
    buffer_load_dwordx4 v6, s[8:11], s38 offen lds
    s_add_u32 m0, s32, 21504
    s_add_u32 s38, s38, 16384
    buffer_load_dwordx4 v6, s[8:11], s38 offen lds
    s_waitcnt vmcnt(28)
    ds_read_b64_tr_b16 v[224:225], v7 offset:24576
    ds_read_b64_tr_b16 v[226:227], v7 offset:25600
    ds_read_b64_tr_b16 v[228:229], v7 offset:24640
    ds_read_b64_tr_b16 v[230:231], v7 offset:25664
    s_waitcnt lgkmcnt(4)
    s_add_u32 m0, s32, 22528
    s_add_u32 s38, s38, 16384
    buffer_load_dwordx4 v6, s[8:11], s38 offen lds
    s_add_u32 m0, s32, 23552
    s_add_u32 s38, s38, 16384
    buffer_load_dwordx4 v6, s[8:11], s38 offen lds
    s_waitcnt vmcnt(28)
    ds_read_b64_tr_b16 v[232:233], v7 offset:26624
    ds_read_b64_tr_b16 v[234:235], v7 offset:27648
    ds_read_b64_tr_b16 v[236:237], v7 offset:26688
    ds_read_b64_tr_b16 v[238:239], v7 offset:27712
    s_waitcnt lgkmcnt(4)
    s_add_u32 m0, s32, 24576
    s_add_u32 s38, s38, 16384
    buffer_load_dwordx4 v6, s[8:11], s38 offen lds
    s_add_u32 m0, s32, 25600
    s_add_u32 s38, s38, 16384
    buffer_load_dwordx4 v6, s[8:11], s38 offen lds
    s_waitcnt vmcnt(28)
    ds_read_b64_tr_b16 v[240:241], v7 offset:28672
    ds_read_b64_tr_b16 v[242:243], v7 offset:29696
    ds_read_b64_tr_b16 v[244:245], v7 offset:28736
    ds_read_b64_tr_b16 v[246:247], v7 offset:29760
    s_waitcnt lgkmcnt(4)
    s_add_u32 m0, s32, 26624
    s_add_u32 s38, s38, 16384
    buffer_load_dwordx4 v6, s[8:11], s38 offen lds
    s_add_u32 m0, s32, 27648
    s_add_u32 s38, s38, 16384
    buffer_load_dwordx4 v6, s[8:11], s38 offen lds
    s_waitcnt vmcnt(28)
    ds_read_b64_tr_b16 v[248:249], v7 offset:30720
    ds_read_b64_tr_b16 v[250:251], v7 offset:31744
    ds_read_b64_tr_b16 v[252:253], v7 offset:30784
    ds_read_b64_tr_b16 v[254:255], v7 offset:31808
    s_waitcnt lgkmcnt(4)
    s_add_u32 m0, s32, 28672
    s_add_u32 s38, s38, 16384
    buffer_load_dwordx4 v6, s[8:11], s38 offen lds
    s_add_u32 m0, s32, 29696
    s_add_u32 s38, s38, 16384
    buffer_load_dwordx4 v6, s[8:11], s38 offen lds
    s_waitcnt vmcnt(28)
    s_waitcnt lgkmcnt(0)
    s_add_u32 m0, s32, 30720
    s_add_u32 s38, s38, 16384
    buffer_load_dwordx4 v6, s[8:11], s38 offen lds
    s_add_u32 m0, s32, 31744
    s_add_u32 s38, s38, 16384
    buffer_load_dwordx4 v6, s[8:11], s38 offen lds
    s_waitcnt vmcnt(28)
    s_waitcnt vmcnt(26)
    s_waitcnt vmcnt(24)
    s_waitcnt vmcnt(22)
    s_waitcnt vmcnt(20)
    s_waitcnt vmcnt(18)
    s_waitcnt vmcnt(16)
    s_waitcnt vmcnt(14)
    s_waitcnt vmcnt(12)
    s_waitcnt vmcnt(10)
    s_waitcnt vmcnt(8)
    s_waitcnt vmcnt(6)
    s_waitcnt vmcnt(4)
    s_waitcnt vmcnt(2)
    s_waitcnt vmcnt(0)
    s_waitcnt lgkmcnt(0)
    s_lshl_b32 s31, s29, 16
    v_add_u32 v8, s31, v5
    s_lshl_b32 s31, s29, 13
    s_add_u32 s31, s31, 131072
    v_add_u32 v9, s31, v5
    s_lshl_b32 s31, s29, 7
    s_add_u32 s31, s31, 131072
    v_bfe_u32 v10, v1, 1, 2
    v_lshlrev_b32 v10, 10, v10
    v_and_b32 v4, 1, v1
    v_lshl_add_u32 v10, v4, 9, v10
    v_lshrrev_b32 v4, 3, v1
    v_lshl_add_u32 v10, v4, 4, v10
    v_add_u32 v10, s31, v10
    s_lshl_b32 s31, s29, 15
    s_lshl_b32 s33, s44, 7
    s_add_u32 s31, s31, s33
    v_lshrrev_b32 v11, 3, v1
    v_lshlrev_b32 v11, 12, v11
    v_and_b32 v4, 7, v1
    v_lshl_add_u32 v11, v4, 3, v11
    v_add_u32 v11, s31, v11
    v_and_b32 v12, 31, v1
    v_lshlrev_b32 v12, 7, v12
    v_add_u32 v12, 115343360, v12
    s_cmp_lg_u32 s29, 0
    s_cbranch_scc1 g_wdd_74
g_wd_73:
    s_load_dword s72, s[92:93], 0 glc
    s_add_u32 s41, s41, 1
    s_cmp_ge_u32 s41, 0x200000
    s_cbranch_scc1 g_wdd_74
    s_waitcnt lgkmcnt(0)
    s_and_b32 s72, s72, 0xffff
    s_cmp_ge_u32 s72, 256
    s_cbranch_scc1 g_wdd_74
    s_sleep 32
    s_branch g_wd_73
g_wdd_74:
    s_waitcnt lgkmcnt(0)
    s_barrier
o6_loop_75:
    s_lshl_b32 s47, s30, 18
    s_add_u32 s47, s47, 67108864
    s_and_b32 s52, s30, 63
    s_lshl_b32 s52, s52, 12
    s_add_u32 s52, s52, 32768
o6_w_77:
    buffer_load_dword v13, v12, s[4:7], s52 offen sc1
    s_add_u32 s41, s41, 1
    s_cmp_ge_u32 s41, 0x200000
    s_cbranch_scc1 o6_wd_78
    s_waitcnt vmcnt(0)
    v_cmp_eq_u32 vcc, 0, v13
    s_cbranch_vccz o6_wd_78
    s_sleep 10
    s_branch o6_w_77
o6_wd_78:
    s_add_u32 s31, s47, 0
    buffer_load_dwordx4 v[64:67], v8, s[4:7], s31 offen sc1
    s_add_u32 s31, s47, 1024
    buffer_load_dwordx4 v[68:71], v8, s[4:7], s31 offen sc1
    s_add_u32 s31, s47, 2048
    buffer_load_dwordx4 v[72:75], v8, s[4:7], s31 offen sc1
    s_add_u32 s31, s47, 49152
    buffer_load_dwordx4 v[76:79], v8, s[4:7], s31 offen sc1
    s_add_u32 s31, s47, 3072
    buffer_load_dwordx4 v[80:83], v8, s[4:7], s31 offen sc1
    s_add_u32 s31, s47, 4096
    buffer_load_dwordx4 v[84:87], v8, s[4:7], s31 offen sc1
    s_add_u32 s31, s47, 5120
    buffer_load_dwordx4 v[88:91], v8, s[4:7], s31 offen sc1
    s_add_u32 s31, s47, 50176
    buffer_load_dwordx4 v[92:95], v8, s[4:7], s31 offen sc1
    s_add_u32 s31, s47, 6144
    buffer_load_dwordx4 v[96:99], v8, s[4:7], s31 offen sc1
    s_add_u32 s31, s47, 7168
    buffer_load_dwordx4 v[100:103], v8, s[4:7], s31 offen sc1
    s_add_u32 s31, s47, 8192
    buffer_load_dwordx4 v[104:107], v8, s[4:7], s31 offen sc1
    s_add_u32 s31, s47, 51200
    buffer_load_dwordx4 v[108:111], v8, s[4:7], s31 offen sc1
    s_add_u32 s31, s47, 9216
    buffer_load_dwordx4 v[112:115], v8, s[4:7], s31 offen sc1
    s_add_u32 s31, s47, 10240
    buffer_load_dwordx4 v[116:119], v8, s[4:7], s31 offen sc1
    s_add_u32 s31, s47, 11264
    buffer_load_dwordx4 v[120:123], v8, s[4:7], s31 offen sc1
o6_go_76:
    s_lshl_b32 s49, s30, 17
    s_add_u32 s35, s30, 5
    s_and_b32 s52, s35, 63
    s_lshl_b32 s52, s52, 12
    s_add_u32 s52, s52, 32768
    ds_read_b64_tr_b16 v[16:17], v7 offset:0
    ds_read_b64_tr_b16 v[18:19], v7 offset:1024
    ds_read_b64_tr_b16 v[20:21], v7 offset:64
    ds_read_b64_tr_b16 v[22:23], v7 offset:1088
    s_waitcnt vmcnt(14)
    v_mfma_f32_32x32x16_bf16 v[32:47], a[0:3], v[64:67], 0
    s_add_u32 s31, s47, 52224
    buffer_load_dwordx4 v[124:127], v8, s[4:7], s31 offen sc1
    v_mfma_f32_32x32x16_bf16 v[48:63], a[4:7], v[64:67], 0
    s_waitcnt vmcnt(14)
    v_mfma_f32_32x32x16_bf16 v[32:47], a[8:11], v[68:71], v[32:47]
    s_add_u32 s31, s47, 12288
    buffer_load_dwordx4 v[64:67], v8, s[4:7], s31 offen sc1
    v_mfma_f32_32x32x16_bf16 v[48:63], a[12:15], v[68:71], v[48:63]
    s_waitcnt vmcnt(14)
    v_mfma_f32_32x32x16_bf16 v[32:47], a[16:19], v[72:75], v[32:47]
    s_add_u32 s31, s47, 13312
    buffer_load_dwordx4 v[68:71], v8, s[4:7], s31 offen sc1
    v_mfma_f32_32x32x16_bf16 v[48:63], a[20:23], v[72:75], v[48:63]
    s_waitcnt vmcnt(14)
    s_waitcnt lgkmcnt(0)
    v_mfma_f32_32x32x16_bf16 v[32:47], v[16:19], v[76:79], v[32:47]
    s_add_u32 s31, s47, 14336
    buffer_load_dwordx4 v[72:75], v8, s[4:7], s31 offen sc1
    v_mfma_f32_32x32x16_bf16 v[48:63], v[20:23], v[76:79], v[48:63]
    ds_read_b64_tr_b16 v[24:25], v7 offset:2048
    ds_read_b64_tr_b16 v[26:27], v7 offset:3072
    ds_read_b64_tr_b16 v[28:29], v7 offset:2112
    ds_read_b64_tr_b16 v[30:31], v7 offset:3136
    s_waitcnt vmcnt(14)
    v_mfma_f32_32x32x16_bf16 v[32:47], a[24:27], v[80:83], v[32:47]
    s_add_u32 s31, s47, 53248
    buffer_load_dwordx4 v[76:79], v8, s[4:7], s31 offen sc1
    v_mfma_f32_32x32x16_bf16 v[48:63], a[28:31], v[80:83], v[48:63]
    s_waitcnt vmcnt(14)
    v_mfma_f32_32x32x16_bf16 v[32:47], a[32:35], v[84:87], v[32:47]
    s_add_u32 s31, s47, 15360
    buffer_load_dwordx4 v[80:83], v8, s[4:7], s31 offen sc1
    v_mfma_f32_32x32x16_bf16 v[48:63], a[36:39], v[84:87], v[48:63]
    s_waitcnt vmcnt(14)
    v_mfma_f32_32x32x16_bf16 v[32:47], a[40:43], v[88:91], v[32:47]
    s_add_u32 s31, s47, 16384
    buffer_load_dwordx4 v[84:87], v8, s[4:7], s31 offen sc1
    v_mfma_f32_32x32x16_bf16 v[48:63], a[44:47], v[88:91], v[48:63]
    s_waitcnt vmcnt(14)
    s_waitcnt lgkmcnt(0)
    v_mfma_f32_32x32x16_bf16 v[32:47], v[24:27], v[92:95], v[32:47]
    s_add_u32 s31, s47, 17408
    buffer_load_dwordx4 v[88:91], v8, s[4:7], s31 offen sc1
    v_mfma_f32_32x32x16_bf16 v[48:63], v[28:31], v[92:95], v[48:63]
    ds_read_b64_tr_b16 v[16:17], v7 offset:4096
    ds_read_b64_tr_b16 v[18:19], v7 offset:5120
    ds_read_b64_tr_b16 v[20:21], v7 offset:4160
    ds_read_b64_tr_b16 v[22:23], v7 offset:5184
    s_waitcnt vmcnt(14)
    v_mfma_f32_32x32x16_bf16 v[32:47], a[48:51], v[96:99], v[32:47]
    s_add_u32 s31, s47, 54272
    buffer_load_dwordx4 v[92:95], v8, s[4:7], s31 offen sc1
    v_mfma_f32_32x32x16_bf16 v[48:63], a[52:55], v[96:99], v[48:63]
    s_waitcnt vmcnt(14)
    v_mfma_f32_32x32x16_bf16 v[32:47], a[56:59], v[100:103], v[32:47]
    s_add_u32 s31, s47, 18432
    buffer_load_dwordx4 v[96:99], v8, s[4:7], s31 offen sc1
    v_mfma_f32_32x32x16_bf16 v[48:63], a[60:63], v[100:103], v[48:63]
    s_waitcnt vmcnt(14)
    v_mfma_f32_32x32x16_bf16 v[32:47], a[64:67], v[104:107], v[32:47]
    s_add_u32 s31, s47, 19456
    buffer_load_dwordx4 v[100:103], v8, s[4:7], s31 offen sc1
    v_mfma_f32_32x32x16_bf16 v[48:63], a[68:71], v[104:107], v[48:63]
    s_waitcnt vmcnt(14)
    s_waitcnt lgkmcnt(0)
    v_mfma_f32_32x32x16_bf16 v[32:47], v[16:19], v[108:111], v[32:47]
    s_add_u32 s31, s47, 20480
    buffer_load_dwordx4 v[104:107], v8, s[4:7], s31 offen sc1
    v_mfma_f32_32x32x16_bf16 v[48:63], v[20:23], v[108:111], v[48:63]
    ds_read_b64_tr_b16 v[24:25], v7 offset:6144
    ds_read_b64_tr_b16 v[26:27], v7 offset:7168
    ds_read_b64_tr_b16 v[28:29], v7 offset:6208
    ds_read_b64_tr_b16 v[30:31], v7 offset:7232
    s_waitcnt vmcnt(14)
    v_mfma_f32_32x32x16_bf16 v[32:47], a[72:75], v[112:115], v[32:47]
    s_add_u32 s31, s47, 55296
    buffer_load_dwordx4 v[108:111], v8, s[4:7], s31 offen sc1
    v_mfma_f32_32x32x16_bf16 v[48:63], a[76:79], v[112:115], v[48:63]
    s_waitcnt vmcnt(14)
    v_mfma_f32_32x32x16_bf16 v[32:47], a[80:83], v[116:119], v[32:47]
    s_add_u32 s31, s47, 21504
    buffer_load_dwordx4 v[112:115], v8, s[4:7], s31 offen sc1
    v_mfma_f32_32x32x16_bf16 v[48:63], a[84:87], v[116:119], v[48:63]
    s_waitcnt vmcnt(14)
    v_mfma_f32_32x32x16_bf16 v[32:47], a[88:91], v[120:123], v[32:47]
    s_add_u32 s31, s47, 22528
    buffer_load_dwordx4 v[116:119], v8, s[4:7], s31 offen sc1
    v_mfma_f32_32x32x16_bf16 v[48:63], a[92:95], v[120:123], v[48:63]
    s_waitcnt vmcnt(14)
    s_waitcnt lgkmcnt(0)
    v_mfma_f32_32x32x16_bf16 v[32:47], v[24:27], v[124:127], v[32:47]
    s_add_u32 s31, s47, 23552
    buffer_load_dwordx4 v[120:123], v8, s[4:7], s31 offen sc1
    v_mfma_f32_32x32x16_bf16 v[48:63], v[28:31], v[124:127], v[48:63]
    ds_read_b64_tr_b16 v[16:17], v7 offset:8192
    ds_read_b64_tr_b16 v[18:19], v7 offset:9216
    ds_read_b64_tr_b16 v[20:21], v7 offset:8256
    ds_read_b64_tr_b16 v[22:23], v7 offset:9280
    s_waitcnt vmcnt(14)
    v_mfma_f32_32x32x16_bf16 v[32:47], a[96:99], v[64:67], v[32:47]
    s_add_u32 s31, s47, 56320
    buffer_load_dwordx4 v[124:127], v8, s[4:7], s31 offen sc1
    v_mfma_f32_32x32x16_bf16 v[48:63], a[100:103], v[64:67], v[48:63]
    s_waitcnt vmcnt(14)
    v_mfma_f32_32x32x16_bf16 v[32:47], a[104:107], v[68:71], v[32:47]
    s_add_u32 s31, s47, 24576
    buffer_load_dwordx4 v[64:67], v8, s[4:7], s31 offen sc1
    v_mfma_f32_32x32x16_bf16 v[48:63], a[108:111], v[68:71], v[48:63]
    s_waitcnt vmcnt(14)
    v_mfma_f32_32x32x16_bf16 v[32:47], a[112:115], v[72:75], v[32:47]
    s_add_u32 s31, s47, 25600
    buffer_load_dwordx4 v[68:71], v8, s[4:7], s31 offen sc1
    v_mfma_f32_32x32x16_bf16 v[48:63], a[116:119], v[72:75], v[48:63]
    s_waitcnt vmcnt(14)
    s_waitcnt lgkmcnt(0)
    v_mfma_f32_32x32x16_bf16 v[32:47], v[16:19], v[76:79], v[32:47]
    s_add_u32 s31, s47, 26624
    buffer_load_dwordx4 v[72:75], v8, s[4:7], s31 offen sc1
    v_mfma_f32_32x32x16_bf16 v[48:63], v[20:23], v[76:79], v[48:63]
    ds_read_b64_tr_b16 v[24:25], v7 offset:10240
    ds_read_b64_tr_b16 v[26:27], v7 offset:11264
    ds_read_b64_tr_b16 v[28:29], v7 offset:10304
    ds_read_b64_tr_b16 v[30:31], v7 offset:11328
    s_waitcnt vmcnt(14)
    v_mfma_f32_32x32x16_bf16 v[32:47], a[120:123], v[80:83], v[32:47]
    s_add_u32 s31, s47, 57344
    buffer_load_dwordx4 v[76:79], v8, s[4:7], s31 offen sc1
    v_mfma_f32_32x32x16_bf16 v[48:63], a[124:127], v[80:83], v[48:63]
    s_waitcnt vmcnt(14)
    v_mfma_f32_32x32x16_bf16 v[32:47], a[128:131], v[84:87], v[32:47]
    s_add_u32 s31, s47, 27648
    buffer_load_dwordx4 v[80:83], v8, s[4:7], s31 offen sc1
    v_mfma_f32_32x32x16_bf16 v[48:63], a[132:135], v[84:87], v[48:63]
    s_waitcnt vmcnt(14)
    v_mfma_f32_32x32x16_bf16 v[32:47], a[136:139], v[88:91], v[32:47]
    s_add_u32 s31, s47, 28672
    buffer_load_dwordx4 v[84:87], v8, s[4:7], s31 offen sc1
    v_mfma_f32_32x32x16_bf16 v[48:63], a[140:143], v[88:91], v[48:63]
    s_waitcnt vmcnt(14)
    s_waitcnt lgkmcnt(0)
    v_mfma_f32_32x32x16_bf16 v[32:47], v[24:27], v[92:95], v[32:47]
    s_add_u32 s31, s47, 29696
    buffer_load_dwordx4 v[88:91], v8, s[4:7], s31 offen sc1
    v_mfma_f32_32x32x16_bf16 v[48:63], v[28:31], v[92:95], v[48:63]
    ds_read_b64_tr_b16 v[16:17], v7 offset:12288
    ds_read_b64_tr_b16 v[18:19], v7 offset:13312
    ds_read_b64_tr_b16 v[20:21], v7 offset:12352
    ds_read_b64_tr_b16 v[22:23], v7 offset:13376
    s_waitcnt vmcnt(14)
    v_mfma_f32_32x32x16_bf16 v[32:47], a[144:147], v[96:99], v[32:47]
    s_add_u32 s31, s47, 58368
    buffer_load_dwordx4 v[92:95], v8, s[4:7], s31 offen sc1
    buffer_load_dword v13, v12, s[4:7], s52 offen sc1
    v_mfma_f32_32x32x16_bf16 v[48:63], a[148:151], v[96:99], v[48:63]
    s_waitcnt vmcnt(15)
    v_mfma_f32_32x32x16_bf16 v[32:47], a[152:155], v[100:103], v[32:47]
    s_add_u32 s31, s47, 30720
    buffer_load_dwordx4 v[96:99], v8, s[4:7], s31 offen sc1
    v_mfma_f32_32x32x16_bf16 v[48:63], a[156:159], v[100:103], v[48:63]
    s_waitcnt vmcnt(15)
    v_mfma_f32_32x32x16_bf16 v[32:47], a[160:163], v[104:107], v[32:47]
    s_add_u32 s31, s47, 31744
    buffer_load_dwordx4 v[100:103], v8, s[4:7], s31 offen sc1
    v_mfma_f32_32x32x16_bf16 v[48:63], a[164:167], v[104:107], v[48:63]
    s_waitcnt vmcnt(15)
    s_waitcnt lgkmcnt(0)
    v_mfma_f32_32x32x16_bf16 v[32:47], v[16:19], v[108:111], v[32:47]
    s_add_u32 s31, s47, 32768
    buffer_load_dwordx4 v[104:107], v8, s[4:7], s31 offen sc1
    v_mfma_f32_32x32x16_bf16 v[48:63], v[20:23], v[108:111], v[48:63]
    ds_read_b64_tr_b16 v[24:25], v7 offset:14336
    ds_read_b64_tr_b16 v[26:27], v7 offset:15360
    ds_read_b64_tr_b16 v[28:29], v7 offset:14400
    ds_read_b64_tr_b16 v[30:31], v7 offset:15424
    s_waitcnt vmcnt(15)
    v_mfma_f32_32x32x16_bf16 v[32:47], a[168:171], v[112:115], v[32:47]
    s_add_u32 s31, s47, 59392
    buffer_load_dwordx4 v[108:111], v8, s[4:7], s31 offen sc1
    v_mfma_f32_32x32x16_bf16 v[48:63], a[172:175], v[112:115], v[48:63]
    s_waitcnt vmcnt(15)
    v_mfma_f32_32x32x16_bf16 v[32:47], a[176:179], v[116:119], v[32:47]
    s_add_u32 s31, s47, 33792
    buffer_load_dwordx4 v[112:115], v8, s[4:7], s31 offen sc1
    v_mfma_f32_32x32x16_bf16 v[48:63], a[180:183], v[116:119], v[48:63]
    s_waitcnt vmcnt(15)
    v_mfma_f32_32x32x16_bf16 v[32:47], a[184:187], v[120:123], v[32:47]
    s_add_u32 s31, s47, 34816
    buffer_load_dwordx4 v[116:119], v8, s[4:7], s31 offen sc1
    v_mfma_f32_32x32x16_bf16 v[48:63], a[188:191], v[120:123], v[48:63]
    s_waitcnt vmcnt(15)
    s_waitcnt lgkmcnt(0)
    v_mfma_f32_32x32x16_bf16 v[32:47], v[24:27], v[124:127], v[32:47]
    s_add_u32 s31, s47, 35840
    buffer_load_dwordx4 v[120:123], v8, s[4:7], s31 offen sc1
    v_mfma_f32_32x32x16_bf16 v[48:63], v[28:31], v[124:127], v[48:63]
    ds_read_b64_tr_b16 v[16:17], v7 offset:16384
    ds_read_b64_tr_b16 v[18:19], v7 offset:17408
    ds_read_b64_tr_b16 v[20:21], v7 offset:16448
    ds_read_b64_tr_b16 v[22:23], v7 offset:17472
    s_waitcnt vmcnt(15)
    v_mfma_f32_32x32x16_bf16 v[32:47], a[192:195], v[64:67], v[32:47]
    s_add_u32 s31, s47, 60416
    buffer_load_dwordx4 v[124:127], v8, s[4:7], s31 offen sc1
    v_mfma_f32_32x32x16_bf16 v[48:63], a[196:199], v[64:67], v[48:63]
    s_waitcnt vmcnt(15)
    v_mfma_f32_32x32x16_bf16 v[32:47], a[200:203], v[68:71], v[32:47]
    s_add_u32 s31, s47, 36864
    buffer_load_dwordx4 v[64:67], v8, s[4:7], s31 offen sc1
    v_mfma_f32_32x32x16_bf16 v[48:63], a[204:207], v[68:71], v[48:63]
    s_waitcnt vmcnt(15)
    v_mfma_f32_32x32x16_bf16 v[32:47], a[208:211], v[72:75], v[32:47]
    s_add_u32 s31, s47, 37888
    buffer_load_dwordx4 v[68:71], v8, s[4:7], s31 offen sc1
    v_mfma_f32_32x32x16_bf16 v[48:63], a[212:215], v[72:75], v[48:63]
    s_waitcnt vmcnt(15)
    s_waitcnt lgkmcnt(0)
    v_mfma_f32_32x32x16_bf16 v[32:47], v[16:19], v[76:79], v[32:47]
    s_add_u32 s31, s47, 38912
    buffer_load_dwordx4 v[72:75], v8, s[4:7], s31 offen sc1
    v_mfma_f32_32x32x16_bf16 v[48:63], v[20:23], v[76:79], v[48:63]
    ds_read_b64_tr_b16 v[24:25], v7 offset:18432
    ds_read_b64_tr_b16 v[26:27], v7 offset:19456
    ds_read_b64_tr_b16 v[28:29], v7 offset:18496
    ds_read_b64_tr_b16 v[30:31], v7 offset:19520
    s_waitcnt vmcnt(15)
    v_mfma_f32_32x32x16_bf16 v[32:47], a[216:219], v[80:83], v[32:47]
    s_add_u32 s31, s47, 61440
    buffer_load_dwordx4 v[76:79], v8, s[4:7], s31 offen sc1
    v_mfma_f32_32x32x16_bf16 v[48:63], a[220:223], v[80:83], v[48:63]
    s_waitcnt vmcnt(15)
    v_mfma_f32_32x32x16_bf16 v[32:47], a[224:227], v[84:87], v[32:47]
    s_add_u32 s31, s47, 39936
    buffer_load_dwordx4 v[80:83], v8, s[4:7], s31 offen sc1
    v_mfma_f32_32x32x16_bf16 v[48:63], a[228:231], v[84:87], v[48:63]
    s_waitcnt vmcnt(15)
    v_mfma_f32_32x32x16_bf16 v[32:47], a[232:235], v[88:91], v[32:47]
    s_add_u32 s31, s47, 40960
    buffer_load_dwordx4 v[84:87], v8, s[4:7], s31 offen sc1
    v_mfma_f32_32x32x16_bf16 v[48:63], a[236:239], v[88:91], v[48:63]
    s_waitcnt vmcnt(15)
    s_waitcnt lgkmcnt(0)
    v_mfma_f32_32x32x16_bf16 v[32:47], v[24:27], v[92:95], v[32:47]
    s_add_u32 s31, s47, 41984
    buffer_load_dwordx4 v[88:91], v8, s[4:7], s31 offen sc1
    v_mfma_f32_32x32x16_bf16 v[48:63], v[28:31], v[92:95], v[48:63]
    ds_read_b64_tr_b16 v[16:17], v7 offset:20480
    ds_read_b64_tr_b16 v[18:19], v7 offset:21504
    ds_read_b64_tr_b16 v[20:21], v7 offset:20544
    ds_read_b64_tr_b16 v[22:23], v7 offset:21568
    s_waitcnt vmcnt(14)
    v_mfma_f32_32x32x16_bf16 v[32:47], a[240:243], v[96:99], v[32:47]
    s_add_u32 s31, s47, 62464
    buffer_load_dwordx4 v[92:95], v8, s[4:7], s31 offen sc1
    v_mfma_f32_32x32x16_bf16 v[48:63], a[244:247], v[96:99], v[48:63]
    s_waitcnt vmcnt(14)
    v_mfma_f32_32x32x16_bf16 v[32:47], a[248:251], v[100:103], v[32:47]
    s_add_u32 s31, s47, 43008
    buffer_load_dwordx4 v[96:99], v8, s[4:7], s31 offen sc1
    v_mfma_f32_32x32x16_bf16 v[48:63], a[252:255], v[100:103], v[48:63]
    s_waitcnt vmcnt(14)
    v_mfma_f32_32x32x16_bf16 v[32:47], v[128:131], v[104:107], v[32:47]
    s_add_u32 s31, s47, 44032
    buffer_load_dwordx4 v[100:103], v8, s[4:7], s31 offen sc1
    v_mfma_f32_32x32x16_bf16 v[48:63], v[132:135], v[104:107], v[48:63]
    s_waitcnt vmcnt(14)
    s_waitcnt lgkmcnt(0)
    v_mfma_f32_32x32x16_bf16 v[32:47], v[16:19], v[108:111], v[32:47]
    s_add_u32 s31, s47, 45056
    buffer_load_dwordx4 v[104:107], v8, s[4:7], s31 offen sc1
    v_mfma_f32_32x32x16_bf16 v[48:63], v[20:23], v[108:111], v[48:63]
    ds_read_b64_tr_b16 v[24:25], v7 offset:22528
    ds_read_b64_tr_b16 v[26:27], v7 offset:23552
    ds_read_b64_tr_b16 v[28:29], v7 offset:22592
    ds_read_b64_tr_b16 v[30:31], v7 offset:23616
    s_waitcnt vmcnt(14)
    v_mfma_f32_32x32x16_bf16 v[32:47], v[136:139], v[112:115], v[32:47]
    s_add_u32 s31, s47, 63488
    buffer_load_dwordx4 v[108:111], v8, s[4:7], s31 offen sc1
    v_mfma_f32_32x32x16_bf16 v[48:63], v[140:143], v[112:115], v[48:63]
    s_waitcnt vmcnt(14)
    v_mfma_f32_32x32x16_bf16 v[32:47], v[144:147], v[116:119], v[32:47]
    s_add_u32 s31, s47, 46080
    buffer_load_dwordx4 v[112:115], v8, s[4:7], s31 offen sc1
    v_mfma_f32_32x32x16_bf16 v[48:63], v[148:151], v[116:119], v[48:63]
    s_waitcnt vmcnt(14)
    v_mfma_f32_32x32x16_bf16 v[32:47], v[152:155], v[120:123], v[32:47]
    s_add_u32 s31, s47, 47104
    buffer_load_dwordx4 v[116:119], v8, s[4:7], s31 offen sc1
    v_mfma_f32_32x32x16_bf16 v[48:63], v[156:159], v[120:123], v[48:63]
    s_waitcnt vmcnt(14)
    s_waitcnt lgkmcnt(0)
    v_mfma_f32_32x32x16_bf16 v[32:47], v[24:27], v[124:127], v[32:47]
    s_add_u32 s31, s47, 48128
    buffer_load_dwordx4 v[120:123], v8, s[4:7], s31 offen sc1
    v_mfma_f32_32x32x16_bf16 v[48:63], v[28:31], v[124:127], v[48:63]
    ds_read_b64_tr_b16 v[16:17], v7 offset:24576
    ds_read_b64_tr_b16 v[18:19], v7 offset:25600
    ds_read_b64_tr_b16 v[20:21], v7 offset:24640
    ds_read_b64_tr_b16 v[22:23], v7 offset:25664
    s_waitcnt vmcnt(14)
    v_mfma_f32_32x32x16_bf16 v[32:47], v[160:163], v[64:67], v[32:47]
    s_add_u32 s31, s47, 64512
    buffer_load_dwordx4 v[124:127], v8, s[4:7], s31 offen sc1
    v_mfma_f32_32x32x16_bf16 v[48:63], v[164:167], v[64:67], v[48:63]
    s_waitcnt vmcnt(14)
    v_mfma_f32_32x32x16_bf16 v[32:47], v[168:171], v[68:71], v[32:47]
    v_cmp_eq_u32 vcc, 0, v13
    s_lshl_b32 s46, s35, 18
    s_add_u32 s46, s46, 67108864
    s_cmp_eq_u64 vcc, 0
    s_cselect_b32 s51, 1, 0
    s_cmp_ge_u32 s35, 64
    s_cselect_b32 s51, 0, s51
    s_cmp_eq_u32 s51, 0
    s_cselect_b32 s46, s47, s46
    s_add_u32 s31, s46, 0
    buffer_load_dwordx4 v[64:67], v8, s[4:7], s31 offen sc1
    v_mfma_f32_32x32x16_bf16 v[48:63], v[172:175], v[68:71], v[48:63]
    s_waitcnt vmcnt(14)
    v_mfma_f32_32x32x16_bf16 v[32:47], v[176:179], v[72:75], v[32:47]
    s_add_u32 s31, s46, 1024
    buffer_load_dwordx4 v[68:71], v8, s[4:7], s31 offen sc1
    v_mfma_f32_32x32x16_bf16 v[48:63], v[180:183], v[72:75], v[48:63]
    s_waitcnt vmcnt(14)
    s_waitcnt lgkmcnt(0)
    v_mfma_f32_32x32x16_bf16 v[32:47], v[16:19], v[76:79], v[32:47]
    s_add_u32 s31, s46, 2048
    buffer_load_dwordx4 v[72:75], v8, s[4:7], s31 offen sc1
    v_mfma_f32_32x32x16_bf16 v[48:63], v[20:23], v[76:79], v[48:63]
    ds_read_b64_tr_b16 v[24:25], v7 offset:26624
    ds_read_b64_tr_b16 v[26:27], v7 offset:27648
    ds_read_b64_tr_b16 v[28:29], v7 offset:26688
    ds_read_b64_tr_b16 v[30:31], v7 offset:27712
    s_waitcnt vmcnt(14)
    v_mfma_f32_32x32x16_bf16 v[32:47], v[184:187], v[80:83], v[32:47]
    s_add_u32 s31, s46, 49152
    buffer_load_dwordx4 v[76:79], v8, s[4:7], s31 offen sc1
    v_mfma_f32_32x32x16_bf16 v[48:63], v[188:191], v[80:83], v[48:63]
    s_waitcnt vmcnt(14)
    v_mfma_f32_32x32x16_bf16 v[32:47], v[192:195], v[84:87], v[32:47]
    s_add_u32 s31, s46, 3072
    buffer_load_dwordx4 v[80:83], v8, s[4:7], s31 offen sc1
    v_mfma_f32_32x32x16_bf16 v[48:63], v[196:199], v[84:87], v[48:63]
    s_waitcnt vmcnt(14)
    v_mfma_f32_32x32x16_bf16 v[32:47], v[200:203], v[88:91], v[32:47]
    s_add_u32 s31, s46, 4096
    buffer_load_dwordx4 v[84:87], v8, s[4:7], s31 offen sc1
    v_mfma_f32_32x32x16_bf16 v[48:63], v[204:207], v[88:91], v[48:63]
    s_waitcnt vmcnt(14)
    s_waitcnt lgkmcnt(0)
    v_mfma_f32_32x32x16_bf16 v[32:47], v[24:27], v[92:95], v[32:47]
    s_add_u32 s31, s46, 5120
    buffer_load_dwordx4 v[88:91], v8, s[4:7], s31 offen sc1
    v_mfma_f32_32x32x16_bf16 v[48:63], v[28:31], v[92:95], v[48:63]
    ds_read_b64_tr_b16 v[16:17], v7 offset:28672
    ds_read_b64_tr_b16 v[18:19], v7 offset:29696
    ds_read_b64_tr_b16 v[20:21], v7 offset:28736
    ds_read_b64_tr_b16 v[22:23], v7 offset:29760
    s_waitcnt vmcnt(14)
    v_mfma_f32_32x32x16_bf16 v[32:47], v[208:211], v[96:99], v[32:47]
    s_add_u32 s31, s46, 50176
    buffer_load_dwordx4 v[92:95], v8, s[4:7], s31 offen sc1
    v_mfma_f32_32x32x16_bf16 v[48:63], v[212:215], v[96:99], v[48:63]
    s_waitcnt vmcnt(14)
    v_mfma_f32_32x32x16_bf16 v[32:47], v[216:219], v[100:103], v[32:47]
    s_add_u32 s31, s46, 6144
    buffer_load_dwordx4 v[96:99], v8, s[4:7], s31 offen sc1
    v_mfma_f32_32x32x16_bf16 v[48:63], v[220:223], v[100:103], v[48:63]
    s_waitcnt vmcnt(14)
    v_mfma_f32_32x32x16_bf16 v[32:47], v[224:227], v[104:107], v[32:47]
    s_add_u32 s31, s46, 7168
    buffer_load_dwordx4 v[100:103], v8, s[4:7], s31 offen sc1
    v_mfma_f32_32x32x16_bf16 v[48:63], v[228:231], v[104:107], v[48:63]
    s_waitcnt vmcnt(14)
    s_waitcnt lgkmcnt(0)
    v_mfma_f32_32x32x16_bf16 v[32:47], v[16:19], v[108:111], v[32:47]
    s_add_u32 s31, s46, 8192
    buffer_load_dwordx4 v[104:107], v8, s[4:7], s31 offen sc1
    v_mfma_f32_32x32x16_bf16 v[48:63], v[20:23], v[108:111], v[48:63]
    ds_read_b64_tr_b16 v[24:25], v7 offset:30720
    ds_read_b64_tr_b16 v[26:27], v7 offset:31744
    ds_read_b64_tr_b16 v[28:29], v7 offset:30784
    ds_read_b64_tr_b16 v[30:31], v7 offset:31808
    s_waitcnt vmcnt(14)
    v_mfma_f32_32x32x16_bf16 v[32:47], v[232:235], v[112:115], v[32:47]
    s_add_u32 s31, s46, 51200
    buffer_load_dwordx4 v[108:111], v8, s[4:7], s31 offen sc1
    v_mfma_f32_32x32x16_bf16 v[48:63], v[236:239], v[112:115], v[48:63]
    s_waitcnt vmcnt(14)
    v_mfma_f32_32x32x16_bf16 v[32:47], v[240:243], v[116:119], v[32:47]
    s_add_u32 s31, s46, 9216
    buffer_load_dwordx4 v[112:115], v8, s[4:7], s31 offen sc1
    v_mfma_f32_32x32x16_bf16 v[48:63], v[244:247], v[116:119], v[48:63]
    s_waitcnt vmcnt(14)
    v_mfma_f32_32x32x16_bf16 v[32:47], v[248:251], v[120:123], v[32:47]
    s_add_u32 s31, s46, 10240
    buffer_load_dwordx4 v[116:119], v8, s[4:7], s31 offen sc1
    v_mfma_f32_32x32x16_bf16 v[48:63], v[252:255], v[120:123], v[48:63]
    s_waitcnt vmcnt(14)
    s_waitcnt lgkmcnt(0)
    v_mfma_f32_32x32x16_bf16 v[32:47], v[24:27], v[124:127], v[32:47]
    s_add_u32 s31, s46, 11264
    buffer_load_dwordx4 v[120:123], v8, s[4:7], s31 offen sc1
    v_mfma_f32_32x32x16_bf16 v[48:63], v[28:31], v[124:127], v[48:63]
    s_barrier
    s_nop 7
    ds_write_b128 v9, v[32:35] offset:0
    ds_write_b128 v9, v[36:39] offset:1024
    ds_write_b128 v9, v[40:43] offset:2048
    ds_write_b128 v9, v[44:47] offset:3072
    ds_write_b128 v9, v[48:51] offset:4096
    ds_write_b128 v9, v[52:55] offset:5120
    ds_write_b128 v9, v[56:59] offset:6144
    ds_write_b128 v9, v[60:63] offset:7168
    s_waitcnt lgkmcnt(0)
    s_barrier
    ds_read_b128 v[32:35], v10 offset:0
    ds_read_b128 v[36:39], v10 offset:8192
    ds_read_b128 v[40:43], v10 offset:16384
    ds_read_b128 v[44:47], v10 offset:24576
    ds_read_b128 v[48:51], v10 offset:4096
    ds_read_b128 v[52:55], v10 offset:12288
    ds_read_b128 v[56:59], v10 offset:20480
    ds_read_b128 v[60:63], v10 offset:28672
    s_waitcnt lgkmcnt(4)
    v_pk_add_f32 v[32:33], v[32:33], v[36:37]
    v_pk_add_f32 v[34:35], v[34:35], v[38:39]
    v_pk_add_f32 v[40:41], v[40:41], v[44:45]
    v_pk_add_f32 v[42:43], v[42:43], v[46:47]
    v_pk_add_f32 v[32:33], v[32:33], v[40:41]
    v_pk_add_f32 v[34:35], v[34:35], v[42:43]
    v_cvt_pk_bf16_f32 v24, v32, v33
    v_cvt_pk_bf16_f32 v25, v34, v35
    buffer_store_dwordx2 v[24:25], v11, s[20:23], s49 offen offset:0
    s_waitcnt lgkmcnt(0)
    v_pk_add_f32 v[48:49], v[48:49], v[52:53]
    v_pk_add_f32 v[50:51], v[50:51], v[54:55]
    v_pk_add_f32 v[56:57], v[56:57], v[60:61]
    v_pk_add_f32 v[58:59], v[58:59], v[62:63]
    v_pk_add_f32 v[48:49], v[48:49], v[56:57]
    v_pk_add_f32 v[50:51], v[50:51], v[58:59]
    v_cvt_pk_bf16_f32 v26, v48, v49
    v_cvt_pk_bf16_f32 v27, v50, v51
    buffer_store_dwordx2 v[26:27], v11, s[20:23], s49 offen offset:64
    s_mov_b32 s30, s35
    s_mov_b32 s47, s46
    s_cmp_lg_u32 s51, 0
    s_cbranch_scc1 o6_go_76
    s_cmp_lt_u32 s30, 64
    s_cbranch_scc1 o6_loop_75
    s_branch L_dump
L_ob:
    s_load_dwordx4 s[72:75], s[0:1], 72
    s_add_u32 s76, s90, 83886080
    s_addc_u32 s77, s91, 0
    s_sub_u32 s32, s28, 96
    s_lshr_b32 s32, s32, 3
    s_mul_i32 s30, s32, 22
    s_add_u32 s51, s30, 22
    s_min_u32 s51, s51, 64
    s_sub_u32 s52, s51, 1
    s_lshl_b32 s52, s52, 16
    s_waitcnt lgkmcnt(0)
    s_mov_b32 s8, s72
    s_and_b32 s9, s73, 0xffff
    s_mov_b32 s10, 2097152
    s_mov_b32 s11, 0x00020000
    s_mov_b32 s20, s74
    s_and_b32 s21, s75, 0xffff
    s_mov_b32 s22, 8388608
    s_mov_b32 s23, 0x00020000
    s_mov_b32 s12, s76
    s_and_b32 s13, s77, 0xffff
    s_mov_b32 s14, 4194304
    s_mov_b32 s15, 0x00020000
    s_and_b32 s31, s28, 7
    s_lshl_b32 s31, s31, 8
    s_lshl_b32 s33, s29, 6
    s_add_u32 s31, s31, s33
    v_lshrrev_b32 v6, 2, v1
    v_lshlrev_b32 v6, 11, v6
    v_and_b32 v4, 3, v1
    v_lshl_add_u32 v6, v4, 4, v6
    v_add_u32 v6, s31, v6
    s_mov_b32 s39, 32768
    s_lshl_b32 s36, s30, 17
    s_and_b32 s33, s28, 7
    s_lshl_b32 s33, s33, 8
    s_add_u32 s36, s36, s33
    s_add_u32 s36, s36, 2048
    s_mov_b32 s37, 131072
    s_lshl_b32 s31, s29, 15
    v_lshrrev_b32 v7, 4, v1
    v_lshlrev_b32 v7, 9, v7
    v_bfe_u32 v4, v1, 2, 2
    v_lshl_add_u32 v7, v4, 6, v7
    v_and_b32 v4, 3, v1
    v_lshl_add_u32 v7, v4, 4, v7
    v_add_u32 v7, s31, v7
    s_lshl_b32 s32, s29, 15
    s_add_u32 m0, s32, 0
    s_mov_b32 s38, 0
    buffer_load_dwordx4 v6, s[8:11], s38 offen lds
    s_add_u32 m0, s32, 1024
    s_add_u32 s38, s38, s39
    buffer_load_dwordx4 v6, s[8:11], s38 offen lds
    s_add_u32 m0, s32, 2048
    s_add_u32 s38, s38, s39
    buffer_load_dwordx4 v6, s[8:11], s38 offen lds
    s_add_u32 m0, s32, 3072
    s_add_u32 s38, s38, s39
    buffer_load_dwordx4 v6, s[8:11], s38 offen lds
    s_add_u32 m0, s32, 4096
    s_add_u32 s38, s38, s39
    buffer_load_dwordx4 v6, s[8:11], s38 offen lds
    s_add_u32 m0, s32, 5120
    s_add_u32 s38, s38, s39
    buffer_load_dwordx4 v6, s[8:11], s38 offen lds
    s_add_u32 m0, s32, 6144
    s_add_u32 s38, s38, s39
    buffer_load_dwordx4 v6, s[8:11], s38 offen lds
    s_add_u32 m0, s32, 7168
    s_add_u32 s38, s38, s39
    buffer_load_dwordx4 v6, s[8:11], s38 offen lds
    s_add_u32 m0, s32, 8192
    s_add_u32 s38, s38, s39
    buffer_load_dwordx4 v6, s[8:11], s38 offen lds
    s_add_u32 m0, s32, 9216
    s_add_u32 s38, s38, s39
    buffer_load_dwordx4 v6, s[8:11], s38 offen lds
    s_add_u32 m0, s32, 10240
    s_add_u32 s38, s38, s39
    buffer_load_dwordx4 v6, s[8:11], s38 offen lds
    s_add_u32 m0, s32, 11264
    s_add_u32 s38, s38, s39
    buffer_load_dwordx4 v6, s[8:11], s38 offen lds
    s_add_u32 m0, s32, 12288
    s_add_u32 s38, s38, s39
    buffer_load_dwordx4 v6, s[8:11], s38 offen lds
    s_add_u32 m0, s32, 13312
    s_add_u32 s38, s38, s39
    buffer_load_dwordx4 v6, s[8:11], s38 offen lds
    s_add_u32 m0, s32, 14336
    s_add_u32 s38, s38, s39
    buffer_load_dwordx4 v6, s[8:11], s38 offen lds
    s_add_u32 m0, s32, 15360
    s_add_u32 s38, s38, s39
    buffer_load_dwordx4 v6, s[8:11], s38 offen lds
    s_add_u32 m0, s32, 16384
    s_add_u32 s38, s38, s39
    buffer_load_dwordx4 v6, s[8:11], s38 offen lds
    s_add_u32 m0, s32, 17408
    s_add_u32 s38, s38, s39
    buffer_load_dwordx4 v6, s[8:11], s38 offen lds
    s_add_u32 m0, s32, 18432
    s_add_u32 s38, s38, s39
    buffer_load_dwordx4 v6, s[8:11], s38 offen lds
    s_add_u32 m0, s32, 19456
    s_add_u32 s38, s38, s39
    buffer_load_dwordx4 v6, s[8:11], s38 offen lds
    s_add_u32 m0, s32, 20480
    s_add_u32 s38, s38, s39
    buffer_load_dwordx4 v6, s[8:11], s38 offen lds
    s_add_u32 m0, s32, 21504
    s_add_u32 s38, s38, s39
    buffer_load_dwordx4 v6, s[8:11], s38 offen lds
    s_add_u32 m0, s32, 22528
    s_add_u32 s38, s38, s39
    buffer_load_dwordx4 v6, s[8:11], s38 offen lds
    s_add_u32 m0, s32, 23552
    s_add_u32 s38, s38, s39
    buffer_load_dwordx4 v6, s[8:11], s38 offen lds
    s_add_u32 m0, s32, 24576
    s_add_u32 s38, s38, s39
    buffer_load_dwordx4 v6, s[8:11], s38 offen lds
    s_add_u32 m0, s32, 25600
    s_add_u32 s38, s38, s39
    buffer_load_dwordx4 v6, s[8:11], s38 offen lds
    s_add_u32 m0, s32, 26624
    s_add_u32 s38, s38, s39
    buffer_load_dwordx4 v6, s[8:11], s38 offen lds
    s_add_u32 m0, s32, 27648
    s_add_u32 s38, s38, s39
    buffer_load_dwordx4 v6, s[8:11], s38 offen lds
    s_add_u32 m0, s32, 28672
    s_add_u32 s38, s38, s39
    buffer_load_dwordx4 v6, s[8:11], s38 offen lds
    s_add_u32 m0, s32, 29696
    s_add_u32 s38, s38, s39
    buffer_load_dwordx4 v6, s[8:11], s38 offen lds
    s_add_u32 m0, s32, 30720
    s_add_u32 s38, s38, s39
    buffer_load_dwordx4 v6, s[8:11], s38 offen lds
    s_add_u32 m0, s32, 31744
    s_add_u32 s38, s38, s39
    buffer_load_dwordx4 v6, s[8:11], s38 offen lds
    s_waitcnt vmcnt(30)
    ds_read_b64_tr_b16 a[0:1], v7 offset:0
    ds_read_b64_tr_b16 a[2:3], v7 offset:256
    ds_read_b64_tr_b16 a[4:5], v7 offset:8
    ds_read_b64_tr_b16 a[6:7], v7 offset:264
    s_waitcnt vmcnt(28)
    ds_read_b64_tr_b16 a[8:9], v7 offset:2048
    ds_read_b64_tr_b16 a[10:11], v7 offset:2304
    ds_read_b64_tr_b16 a[12:13], v7 offset:2056
    ds_read_b64_tr_b16 a[14:15], v7 offset:2312
    s_waitcnt lgkmcnt(4)
    s_add_u32 m0, s32, 0
    s_add_u32 s38, s38, s39
    buffer_load_dwordx4 v6, s[8:11], s38 offen lds
    s_add_u32 m0, s32, 1024
    s_add_u32 s38, s38, s39
    buffer_load_dwordx4 v6, s[8:11], s38 offen lds
    s_waitcnt vmcnt(28)
    ds_read_b64_tr_b16 a[16:17], v7 offset:4096
    ds_read_b64_tr_b16 a[18:19], v7 offset:4352
    ds_read_b64_tr_b16 a[20:21], v7 offset:4104
    ds_read_b64_tr_b16 a[22:23], v7 offset:4360
    s_waitcnt lgkmcnt(4)
    s_add_u32 m0, s32, 2048
    s_add_u32 s38, s38, s39
    buffer_load_dwordx4 v6, s[8:11], s38 offen lds
    s_add_u32 m0, s32, 3072
    s_add_u32 s38, s38, s39
    buffer_load_dwordx4 v6, s[8:11], s38 offen lds
    s_waitcnt vmcnt(28)
    ds_read_b64_tr_b16 a[24:25], v7 offset:6144
    ds_read_b64_tr_b16 a[26:27], v7 offset:6400
    ds_read_b64_tr_b16 a[28:29], v7 offset:6152
    ds_read_b64_tr_b16 a[30:31], v7 offset:6408
    s_waitcnt lgkmcnt(4)
    s_add_u32 m0, s32, 4096
    s_add_u32 s38, s38, s39
    buffer_load_dwordx4 v6, s[8:11], s38 offen lds
    s_add_u32 m0, s32, 5120
    s_add_u32 s38, s38, s39
    buffer_load_dwordx4 v6, s[8:11], s38 offen lds
    s_waitcnt vmcnt(28)
    ds_read_b64_tr_b16 a[32:33], v7 offset:8192
    ds_read_b64_tr_b16 a[34:35], v7 offset:8448
    ds_read_b64_tr_b16 a[36:37], v7 offset:8200
    ds_read_b64_tr_b16 a[38:39], v7 offset:8456
    s_waitcnt lgkmcnt(4)
    s_add_u32 m0, s32, 6144
    s_add_u32 s38, s38, s39
    buffer_load_dwordx4 v6, s[8:11], s38 offen lds
    s_add_u32 m0, s32, 7168
    s_add_u32 s38, s38, s39
    buffer_load_dwordx4 v6, s[8:11], s38 offen lds
    s_waitcnt vmcnt(28)
    ds_read_b64_tr_b16 a[40:41], v7 offset:10240
    ds_read_b64_tr_b16 a[42:43], v7 offset:10496
    ds_read_b64_tr_b16 a[44:45], v7 offset:10248
    ds_read_b64_tr_b16 a[46:47], v7 offset:10504
    s_waitcnt lgkmcnt(4)
    s_add_u32 m0, s32, 8192
    s_add_u32 s38, s38, s39
    buffer_load_dwordx4 v6, s[8:11], s38 offen lds
    s_add_u32 m0, s32, 9216
    s_add_u32 s38, s38, s39
    buffer_load_dwordx4 v6, s[8:11], s38 offen lds
    s_waitcnt vmcnt(28)
    ds_read_b64_tr_b16 a[48:49], v7 offset:12288
    ds_read_b64_tr_b16 a[50:51], v7 offset:12544
    ds_read_b64_tr_b16 a[52:53], v7 offset:12296
    ds_read_b64_tr_b16 a[54:55], v7 offset:12552
    s_waitcnt lgkmcnt(4)
    s_add_u32 m0, s32, 10240
    s_add_u32 s38, s38, s39
    buffer_load_dwordx4 v6, s[8:11], s38 offen lds
    s_add_u32 m0, s32, 11264
    s_add_u32 s38, s38, s39
    buffer_load_dwordx4 v6, s[8:11], s38 offen lds
    s_waitcnt vmcnt(28)
    ds_read_b64_tr_b16 a[56:57], v7 offset:14336
    ds_read_b64_tr_b16 a[58:59], v7 offset:14592
    ds_read_b64_tr_b16 a[60:61], v7 offset:14344
    ds_read_b64_tr_b16 a[62:63], v7 offset:14600
    s_waitcnt lgkmcnt(4)
    s_add_u32 m0, s32, 12288
    s_add_u32 s38, s38, s39
    buffer_load_dwordx4 v6, s[8:11], s38 offen lds
    s_add_u32 m0, s32, 13312
    s_add_u32 s38, s38, s39
    buffer_load_dwordx4 v6, s[8:11], s38 offen lds
    s_waitcnt vmcnt(28)
    ds_read_b64_tr_b16 a[64:65], v7 offset:16384
    ds_read_b64_tr_b16 a[66:67], v7 offset:16640
    ds_read_b64_tr_b16 a[68:69], v7 offset:16392
    ds_read_b64_tr_b16 a[70:71], v7 offset:16648
    s_waitcnt lgkmcnt(4)
    s_add_u32 m0, s32, 14336
    s_add_u32 s38, s38, s39
    buffer_load_dwordx4 v6, s[8:11], s38 offen lds
    s_add_u32 m0, s32, 15360
    s_add_u32 s38, s38, s39
    buffer_load_dwordx4 v6, s[8:11], s38 offen lds
    s_waitcnt vmcnt(28)
    ds_read_b64_tr_b16 a[72:73], v7 offset:18432
    ds_read_b64_tr_b16 a[74:75], v7 offset:18688
    ds_read_b64_tr_b16 a[76:77], v7 offset:18440
    ds_read_b64_tr_b16 a[78:79], v7 offset:18696
    s_waitcnt lgkmcnt(4)
    s_add_u32 m0, s32, 16384
    s_add_u32 s38, s38, s39
    buffer_load_dwordx4 v6, s[8:11], s38 offen lds
    s_add_u32 m0, s32, 17408
    s_add_u32 s38, s38, s39
    buffer_load_dwordx4 v6, s[8:11], s38 offen lds
    s_waitcnt vmcnt(28)
    ds_read_b64_tr_b16 a[80:81], v7 offset:20480
    ds_read_b64_tr_b16 a[82:83], v7 offset:20736
    ds_read_b64_tr_b16 a[84:85], v7 offset:20488
    ds_read_b64_tr_b16 a[86:87], v7 offset:20744
    s_waitcnt lgkmcnt(4)
    s_add_u32 m0, s32, 18432
    s_add_u32 s38, s38, s39
    buffer_load_dwordx4 v6, s[8:11], s38 offen lds
    s_add_u32 m0, s32, 19456
    s_add_u32 s38, s38, s39
    buffer_load_dwordx4 v6, s[8:11], s38 offen lds
    s_waitcnt vmcnt(28)
    ds_read_b64_tr_b16 a[88:89], v7 offset:22528
    ds_read_b64_tr_b16 a[90:91], v7 offset:22784
    ds_read_b64_tr_b16 a[92:93], v7 offset:22536
    ds_read_b64_tr_b16 a[94:95], v7 offset:22792
    s_waitcnt lgkmcnt(4)
    s_add_u32 m0, s32, 20480
    s_add_u32 s38, s38, s39
    buffer_load_dwordx4 v6, s[8:11], s38 offen lds
    s_add_u32 m0, s32, 21504
    s_add_u32 s38, s38, s39
    buffer_load_dwordx4 v6, s[8:11], s38 offen lds
    s_waitcnt vmcnt(28)
    ds_read_b64_tr_b16 a[96:97], v7 offset:24576
    ds_read_b64_tr_b16 a[98:99], v7 offset:24832
    ds_read_b64_tr_b16 a[100:101], v7 offset:24584
    ds_read_b64_tr_b16 a[102:103], v7 offset:24840
    s_waitcnt lgkmcnt(4)
    s_add_u32 m0, s32, 22528
    s_add_u32 s38, s38, s39
    buffer_load_dwordx4 v6, s[8:11], s38 offen lds
    s_add_u32 m0, s32, 23552
    s_add_u32 s38, s38, s39
    buffer_load_dwordx4 v6, s[8:11], s38 offen lds
    s_waitcnt vmcnt(28)
    ds_read_b64_tr_b16 a[104:105], v7 offset:26624
    ds_read_b64_tr_b16 a[106:107], v7 offset:26880
    ds_read_b64_tr_b16 a[108:109], v7 offset:26632
    ds_read_b64_tr_b16 a[110:111], v7 offset:26888
    s_waitcnt lgkmcnt(4)
    s_add_u32 m0, s32, 24576
    s_add_u32 s38, s38, s39
    buffer_load_dwordx4 v6, s[8:11], s38 offen lds
    s_add_u32 m0, s32, 25600
    s_add_u32 s38, s38, s39
    buffer_load_dwordx4 v6, s[8:11], s38 offen lds
    s_waitcnt vmcnt(28)
    ds_read_b64_tr_b16 a[112:113], v7 offset:28672
    ds_read_b64_tr_b16 a[114:115], v7 offset:28928
    ds_read_b64_tr_b16 a[116:117], v7 offset:28680
    ds_read_b64_tr_b16 a[118:119], v7 offset:28936
    s_waitcnt lgkmcnt(4)
    s_add_u32 m0, s32, 26624
    s_add_u32 s38, s38, s39
    buffer_load_dwordx4 v6, s[8:11], s38 offen lds
    s_add_u32 m0, s32, 27648
    s_add_u32 s38, s38, s39
    buffer_load_dwordx4 v6, s[8:11], s38 offen lds
    s_waitcnt vmcnt(28)
    ds_read_b64_tr_b16 a[120:121], v7 offset:30720
    ds_read_b64_tr_b16 a[122:123], v7 offset:30976
    ds_read_b64_tr_b16 a[124:125], v7 offset:30728
    ds_read_b64_tr_b16 a[126:127], v7 offset:30984
    s_waitcnt lgkmcnt(4)
    s_add_u32 m0, s32, 28672
    s_add_u32 s38, s38, s39
    buffer_load_dwordx4 v6, s[8:11], s38 offen lds
    s_add_u32 m0, s32, 29696
    s_add_u32 s38, s38, s39
    buffer_load_dwordx4 v6, s[8:11], s38 offen lds
    s_waitcnt vmcnt(28)
    ds_read_b64_tr_b16 a[128:129], v7 offset:0
    ds_read_b64_tr_b16 a[130:131], v7 offset:256
    ds_read_b64_tr_b16 a[132:133], v7 offset:8
    ds_read_b64_tr_b16 a[134:135], v7 offset:264
    s_waitcnt lgkmcnt(4)
    s_add_u32 m0, s32, 30720
    s_add_u32 s38, s38, s39
    buffer_load_dwordx4 v6, s[8:11], s38 offen lds
    s_add_u32 m0, s32, 31744
    s_add_u32 s38, s38, s39
    buffer_load_dwordx4 v6, s[8:11], s38 offen lds
    s_waitcnt vmcnt(28)
    ds_read_b64_tr_b16 a[136:137], v7 offset:2048
    ds_read_b64_tr_b16 a[138:139], v7 offset:2304
    ds_read_b64_tr_b16 a[140:141], v7 offset:2056
    ds_read_b64_tr_b16 a[142:143], v7 offset:2312
    s_waitcnt vmcnt(26)
    ds_read_b64_tr_b16 a[144:145], v7 offset:4096
    ds_read_b64_tr_b16 a[146:147], v7 offset:4352
    ds_read_b64_tr_b16 a[148:149], v7 offset:4104
    ds_read_b64_tr_b16 a[150:151], v7 offset:4360
    s_waitcnt vmcnt(24)
    ds_read_b64_tr_b16 a[152:153], v7 offset:6144
    ds_read_b64_tr_b16 a[154:155], v7 offset:6400
    ds_read_b64_tr_b16 a[156:157], v7 offset:6152
    ds_read_b64_tr_b16 a[158:159], v7 offset:6408
    s_waitcnt vmcnt(22)
    ds_read_b64_tr_b16 a[160:161], v7 offset:8192
    ds_read_b64_tr_b16 a[162:163], v7 offset:8448
    ds_read_b64_tr_b16 a[164:165], v7 offset:8200
    ds_read_b64_tr_b16 a[166:167], v7 offset:8456
    s_waitcnt vmcnt(20)
    ds_read_b64_tr_b16 a[168:169], v7 offset:10240
    ds_read_b64_tr_b16 a[170:171], v7 offset:10496
    ds_read_b64_tr_b16 a[172:173], v7 offset:10248
    ds_read_b64_tr_b16 a[174:175], v7 offset:10504
    s_waitcnt vmcnt(18)
    ds_read_b64_tr_b16 a[176:177], v7 offset:12288
    ds_read_b64_tr_b16 a[178:179], v7 offset:12544
    ds_read_b64_tr_b16 a[180:181], v7 offset:12296
    ds_read_b64_tr_b16 a[182:183], v7 offset:12552
    s_waitcnt vmcnt(16)
    ds_read_b64_tr_b16 a[184:185], v7 offset:14336
    ds_read_b64_tr_b16 a[186:187], v7 offset:14592
    ds_read_b64_tr_b16 a[188:189], v7 offset:14344
    ds_read_b64_tr_b16 a[190:191], v7 offset:14600
    s_waitcnt vmcnt(14)
    ds_read_b64_tr_b16 a[192:193], v7 offset:16384
    ds_read_b64_tr_b16 a[194:195], v7 offset:16640
    ds_read_b64_tr_b16 a[196:197], v7 offset:16392
    ds_read_b64_tr_b16 a[198:199], v7 offset:16648
    s_waitcnt vmcnt(12)
    ds_read_b64_tr_b16 a[200:201], v7 offset:18432
    ds_read_b64_tr_b16 a[202:203], v7 offset:18688
    ds_read_b64_tr_b16 a[204:205], v7 offset:18440
    ds_read_b64_tr_b16 a[206:207], v7 offset:18696
    s_waitcnt vmcnt(10)
    ds_read_b64_tr_b16 a[208:209], v7 offset:20480
    ds_read_b64_tr_b16 a[210:211], v7 offset:20736
    ds_read_b64_tr_b16 a[212:213], v7 offset:20488
    ds_read_b64_tr_b16 a[214:215], v7 offset:20744
    s_waitcnt vmcnt(8)
    ds_read_b64_tr_b16 a[216:217], v7 offset:22528
    ds_read_b64_tr_b16 a[218:219], v7 offset:22784
    ds_read_b64_tr_b16 a[220:221], v7 offset:22536
    ds_read_b64_tr_b16 a[222:223], v7 offset:22792
    s_waitcnt vmcnt(6)
    ds_read_b64_tr_b16 a[224:225], v7 offset:24576
    ds_read_b64_tr_b16 a[226:227], v7 offset:24832
    ds_read_b64_tr_b16 a[228:229], v7 offset:24584
    ds_read_b64_tr_b16 a[230:231], v7 offset:24840
    s_waitcnt vmcnt(4)
    ds_read_b64_tr_b16 a[232:233], v7 offset:26624
    ds_read_b64_tr_b16 a[234:235], v7 offset:26880
    ds_read_b64_tr_b16 a[236:237], v7 offset:26632
    ds_read_b64_tr_b16 a[238:239], v7 offset:26888
    s_waitcnt vmcnt(2)
    ds_read_b64_tr_b16 a[240:241], v7 offset:28672
    ds_read_b64_tr_b16 a[242:243], v7 offset:28928
    ds_read_b64_tr_b16 a[244:245], v7 offset:28680
    ds_read_b64_tr_b16 a[246:247], v7 offset:28936
    s_waitcnt vmcnt(0)
    ds_read_b64_tr_b16 a[248:249], v7 offset:30720
    ds_read_b64_tr_b16 a[250:251], v7 offset:30976
    ds_read_b64_tr_b16 a[252:253], v7 offset:30728
    ds_read_b64_tr_b16 a[254:255], v7 offset:30984
    s_waitcnt lgkmcnt(0)
    s_lshr_b32 s31, s29, 1
    s_and_b32 s31, s31, 1
    s_lshl_b32 s31, s31, 2
    v_lshrrev_b32 v2, 4, v1
    v_add_u32 v2, s31, v2
    v_and_b32 v3, 7, v1
    v_xor_b32 v2, v2, v3
    s_lshl_b32 s31, s29, 14
    v_lshrrev_b32 v8, 3, v1
    v_lshlrev_b32 v8, 11, v8
    v_add_u32 v8, s31, v8
    v_lshl_add_u32 v8, v2, 4, v8
    v_bfe_u32 v2, v1, 1, 3
    v_lshrrev_b32 v3, 4, v1
    v_xor_b32 v2, v2, v3
    v_bfe_u32 v3, v1, 3, 1
    v_lshlrev_b32 v3, 11, v3
    v_and_b32 v4, 7, v1
    v_lshl_add_u32 v3, v4, 7, v3
    v_xor_b32 v12, 0, v2
    v_lshl_add_u32 v12, v12, 4, v3
    v_add_u32 v14, 65536, v12
    v_xor_b32 v13, 4, v2
    v_lshl_add_u32 v13, v13, 4, v3
    v_add_u32 v15, 65536, v13
    s_lshl_b32 s31, s29, 6
    v_and_b32 v9, 15, v1
    v_lshlrev_b32 v9, 12, v9
    v_lshrrev_b32 v4, 4, v1
    v_lshl_add_u32 v9, v4, 4, v9
    v_add_u32 v9, s31, v9
    v_add_u32 v8, s34, v5
    v_lshrrev_b32 v12, 4, v1
    v_lshlrev_b32 v12, 9, v12
    v_and_b32 v4, 15, v1
    v_lshl_add_u32 v12, v4, 4, v12
    v_add_u32 v14, 65536, v12
    s_cmp_lg_u32 s29, 0
    s_cbranch_scc1 g_wdd_80
g_wd_79:
    s_load_dword s72, s[92:93], 0 glc
    s_add_u32 s41, s41, 1
    s_cmp_ge_u32 s41, 0x200000
    s_cbranch_scc1 g_wdd_80
    s_waitcnt lgkmcnt(0)
    s_and_b32 s72, s72, 0xffff
    s_cmp_ge_u32 s72, 256
    s_cbranch_scc1 g_wdd_80
    s_sleep 32
    s_branch g_wd_79
g_wdd_80:
    s_waitcnt lgkmcnt(0)
    s_barrier
    v_and_b32 v2, 31, v1
    v_lshlrev_b32 v2, 7, v2
    v_add_u32 v2, 115359744, v2
    s_cmp_lg_u32 s29, 0
    s_cbranch_scc1 g_wld_82
g_wl_81:
    buffer_load_dword v3, v2, s[4:7], 0 offen sc1
    s_add_u32 s41, s41, 1
    s_cmp_ge_u32 s41, 0x200000
    s_cbranch_scc1 g_wld_82
    s_waitcnt vmcnt(0)
    v_cmp_gt_u32 vcc, s51, v3
    s_cbranch_vccz g_wld_82
    s_sleep 8
    s_branch g_wl_81
g_wld_82:
    s_barrier
    s_lshl_b32 s35, s30, 16
    s_sub_u32 s36, s36, s37
    s_barrier
    s_add_u32 m0, s34, 0
    s_add_u32 s32, s35, 0
    buffer_load_dwordx4 v8, s[12:15], s32 offen sc1 lds
    s_add_u32 m0, s34, 4096
    s_add_u32 s32, s35, 4096
    buffer_load_dwordx4 v8, s[12:15], s32 offen sc1 lds
    s_add_u32 m0, s34, 8192
    s_add_u32 s32, s35, 8192
    buffer_load_dwordx4 v8, s[12:15], s32 offen sc1 lds
    s_add_u32 m0, s34, 12288
    s_add_u32 s32, s35, 12288
    buffer_load_dwordx4 v8, s[12:15], s32 offen sc1 lds
    s_add_u32 m0, s34, 16384
    s_add_u32 s32, s35, 16384
    buffer_load_dwordx4 v8, s[12:15], s32 offen sc1 lds
    s_add_u32 m0, s34, 20480
    s_add_u32 s32, s35, 20480
    buffer_load_dwordx4 v8, s[12:15], s32 offen sc1 lds
    s_add_u32 m0, s34, 24576
    s_add_u32 s32, s35, 24576
    buffer_load_dwordx4 v8, s[12:15], s32 offen sc1 lds
    s_add_u32 m0, s34, 28672
    s_add_u32 s32, s35, 28672
    buffer_load_dwordx4 v8, s[12:15], s32 offen sc1 lds
    s_add_u32 m0, s34, 32768
    s_add_u32 s32, s35, 32768
    buffer_load_dwordx4 v8, s[12:15], s32 offen sc1 lds
    s_add_u32 m0, s34, 36864
    s_add_u32 s32, s35, 36864
    buffer_load_dwordx4 v8, s[12:15], s32 offen sc1 lds
    s_add_u32 m0, s34, 40960
    s_add_u32 s32, s35, 40960
    buffer_load_dwordx4 v8, s[12:15], s32 offen sc1 lds
    s_add_u32 m0, s34, 45056
    s_add_u32 s32, s35, 45056
    buffer_load_dwordx4 v8, s[12:15], s32 offen sc1 lds
    s_add_u32 m0, s34, 49152
    s_add_u32 s32, s35, 49152
    buffer_load_dwordx4 v8, s[12:15], s32 offen sc1 lds
    s_add_u32 m0, s34, 53248
    s_add_u32 s32, s35, 53248
    buffer_load_dwordx4 v8, s[12:15], s32 offen sc1 lds
    s_add_u32 m0, s34, 57344
    s_add_u32 s32, s35, 57344
    buffer_load_dwordx4 v8, s[12:15], s32 offen sc1 lds
    s_add_u32 m0, s34, 61440
    s_add_u32 s32, s35, 61440
    buffer_load_dwordx4 v8, s[12:15], s32 offen sc1 lds
    s_add_u32 s35, s35, 65536
    s_add_u32 m0, s34, 65536
    s_add_u32 s32, s35, 0
    buffer_load_dwordx4 v8, s[12:15], s32 offen sc1 lds
    s_add_u32 m0, s34, 69632
    s_add_u32 s32, s35, 4096
    buffer_load_dwordx4 v8, s[12:15], s32 offen sc1 lds
    s_add_u32 m0, s34, 73728
    s_add_u32 s32, s35, 8192
    buffer_load_dwordx4 v8, s[12:15], s32 offen sc1 lds
    s_add_u32 m0, s34, 77824
    s_add_u32 s32, s35, 12288
    buffer_load_dwordx4 v8, s[12:15], s32 offen sc1 lds
    s_waitcnt vmcnt(12)
    s_barrier
    ds_read_b128 v[32:35], v12 offset:0
    ds_read_b128 v[36:39], v12 offset:256
    ds_read_b128 v[40:43], v12 offset:2048
    ds_read_b128 v[44:47], v12 offset:2304
    ds_read_b128 v[48:51], v12 offset:4096
    ds_read_b128 v[52:55], v12 offset:4352
    v_add_u32 v9, 2130706432, v9
sl_loop_85:
    s_waitcnt lgkmcnt(4)
    v_mfma_f32_16x16x32_bf16 v[64:67], a[0:3], v[32:35], 0
    ds_read_b128 v[56:59], v12 offset:6144
    v_mfma_f32_16x16x32_bf16 v[68:71], a[4:7], v[32:35], 0
    v_mfma_f32_16x16x32_bf16 v[72:75], a[0:3], v[36:39], 0
    ds_read_b128 v[60:63], v12 offset:6400
    s_add_u32 m0, s34, 81920
    s_add_u32 s32, s35, 16384
    v_mfma_f32_16x16x32_bf16 v[76:79], a[4:7], v[36:39], 0
    buffer_load_dwordx4 v8, s[12:15], s32 offen sc1 lds
    s_waitcnt lgkmcnt(4)
    v_mfma_f32_16x16x32_bf16 v[64:67], a[8:11], v[40:43], v[64:67]
    ds_read_b128 v[32:35], v12 offset:8192
    v_mfma_f32_16x16x32_bf16 v[68:71], a[12:15], v[40:43], v[68:71]
    v_mfma_f32_16x16x32_bf16 v[72:75], a[8:11], v[44:47], v[72:75]
    ds_read_b128 v[36:39], v12 offset:8448
    v_mfma_f32_16x16x32_bf16 v[76:79], a[12:15], v[44:47], v[76:79]
    s_waitcnt lgkmcnt(4)
    v_mfma_f32_16x16x32_bf16 v[64:67], a[16:19], v[48:51], v[64:67]
    ds_read_b128 v[40:43], v12 offset:10240
    v_mfma_f32_16x16x32_bf16 v[68:71], a[20:23], v[48:51], v[68:71]
    v_cvt_pk_bf16_f32 v96, v80, v81
    v_mfma_f32_16x16x32_bf16 v[72:75], a[16:19], v[52:55], v[72:75]
    ds_read_b128 v[44:47], v12 offset:10496
    s_add_u32 m0, s34, 86016
    s_add_u32 s32, s35, 20480
    v_mfma_f32_16x16x32_bf16 v[76:79], a[20:23], v[52:55], v[76:79]
    buffer_load_dwordx4 v8, s[12:15], s32 offen sc1 lds
    v_cvt_pk_bf16_f32 v97, v82, v83
    s_waitcnt lgkmcnt(4)
    v_mfma_f32_16x16x32_bf16 v[64:67], a[24:27], v[56:59], v[64:67]
    ds_read_b128 v[48:51], v12 offset:12288
    v_mfma_f32_16x16x32_bf16 v[68:71], a[28:31], v[56:59], v[68:71]
    v_cvt_pk_bf16_f32 v98, v84, v85
    v_mfma_f32_16x16x32_bf16 v[72:75], a[24:27], v[60:63], v[72:75]
    ds_read_b128 v[52:55], v12 offset:12544
    v_mfma_f32_16x16x32_bf16 v[76:79], a[28:31], v[60:63], v[76:79]
    v_cvt_pk_bf16_f32 v99, v86, v87
    s_waitcnt lgkmcnt(4)
    v_mfma_f32_16x16x32_bf16 v[64:67], a[32:35], v[32:35], v[64:67]
    ds_read_b128 v[56:59], v12 offset:14336
    v_mfma_f32_16x16x32_bf16 v[68:71], a[36:39], v[32:35], v[68:71]
    v_cvt_pk_bf16_f32 v100, v88, v89
    v_mfma_f32_16x16x32_bf16 v[72:75], a[32:35], v[36:39], v[72:75]
    ds_read_b128 v[60:63], v12 offset:14592
    s_add_u32 m0, s34, 90112
    s_add_u32 s32, s35, 24576
    v_mfma_f32_16x16x32_bf16 v[76:79], a[36:39], v[36:39], v[76:79]
    buffer_load_dwordx4 v8, s[12:15], s32 offen sc1 lds
    v_cvt_pk_bf16_f32 v101, v90, v91
    s_waitcnt lgkmcnt(4)
    v_mfma_f32_16x16x32_bf16 v[64:67], a[40:43], v[40:43], v[64:67]
    ds_read_b128 v[32:35], v12 offset:16384
    v_mfma_f32_16x16x32_bf16 v[68:71], a[44:47], v[40:43], v[68:71]
    v_cvt_pk_bf16_f32 v102, v92, v93
    v_mfma_f32_16x16x32_bf16 v[72:75], a[40:43], v[44:47], v[72:75]
    ds_read_b128 v[36:39], v12 offset:16640
    v_mfma_f32_16x16x32_bf16 v[76:79], a[44:47], v[44:47], v[76:79]
    v_cvt_pk_bf16_f32 v103, v94, v95
    buffer_store_dwordx4 v[96:99], v9, s[20:23], s36 offen
    s_add_u32 s31, s36, 65536
    s_waitcnt lgkmcnt(4)
    v_mfma_f32_16x16x32_bf16 v[64:67], a[48:51], v[48:51], v[64:67]
    ds_read_b128 v[40:43], v12 offset:18432
    v_mfma_f32_16x16x32_bf16 v[68:71], a[52:55], v[48:51], v[68:71]
    v_mfma_f32_16x16x32_bf16 v[72:75], a[48:51], v[52:55], v[72:75]
    ds_read_b128 v[44:47], v12 offset:18688
    s_add_u32 m0, s34, 94208
    s_add_u32 s32, s35, 28672
    v_mfma_f32_16x16x32_bf16 v[76:79], a[52:55], v[52:55], v[76:79]
    buffer_load_dwordx4 v8, s[12:15], s32 offen sc1 lds
    s_waitcnt lgkmcnt(4)
    v_mfma_f32_16x16x32_bf16 v[64:67], a[56:59], v[56:59], v[64:67]
    ds_read_b128 v[48:51], v12 offset:20480
    v_mfma_f32_16x16x32_bf16 v[68:71], a[60:63], v[56:59], v[68:71]
    v_mfma_f32_16x16x32_bf16 v[72:75], a[56:59], v[60:63], v[72:75]
    ds_read_b128 v[52:55], v12 offset:20736
    v_mfma_f32_16x16x32_bf16 v[76:79], a[60:63], v[60:63], v[76:79]
    buffer_store_dwordx4 v[100:103], v9, s[20:23], s31 offen
    s_add_u32 s36, s36, s37
    s_waitcnt vmcnt(8)
    s_barrier
    s_waitcnt lgkmcnt(4)
    v_mfma_f32_16x16x32_bf16 v[64:67], a[64:67], v[32:35], v[64:67]
    ds_read_b128 v[56:59], v12 offset:22528
    v_mfma_f32_16x16x32_bf16 v[68:71], a[68:71], v[32:35], v[68:71]
    v_mfma_f32_16x16x32_bf16 v[72:75], a[64:67], v[36:39], v[72:75]
    ds_read_b128 v[60:63], v12 offset:22784
    s_add_u32 m0, s34, 98304
    s_add_u32 s32, s35, 32768
    v_mfma_f32_16x16x32_bf16 v[76:79], a[68:71], v[36:39], v[76:79]
    buffer_load_dwordx4 v8, s[12:15], s32 offen sc1 lds
    s_waitcnt lgkmcnt(4)
    v_mfma_f32_16x16x32_bf16 v[64:67], a[72:75], v[40:43], v[64:67]
    ds_read_b128 v[32:35], v12 offset:24576
    v_mfma_f32_16x16x32_bf16 v[68:71], a[76:79], v[40:43], v[68:71]
    v_mfma_f32_16x16x32_bf16 v[72:75], a[72:75], v[44:47], v[72:75]
    ds_read_b128 v[36:39], v12 offset:24832
    v_mfma_f32_16x16x32_bf16 v[76:79], a[76:79], v[44:47], v[76:79]
    s_waitcnt lgkmcnt(4)
    v_mfma_f32_16x16x32_bf16 v[64:67], a[80:83], v[48:51], v[64:67]
    ds_read_b128 v[40:43], v12 offset:26624
    v_mfma_f32_16x16x32_bf16 v[68:71], a[84:87], v[48:51], v[68:71]
    v_and_b32 v9, 0xffffff, v9
    v_mfma_f32_16x16x32_bf16 v[72:75], a[80:83], v[52:55], v[72:75]
    ds_read_b128 v[44:47], v12 offset:26880
    s_add_u32 m0, s34, 102400
    s_add_u32 s32, s35, 36864
    v_mfma_f32_16x16x32_bf16 v[76:79], a[84:87], v[52:55], v[76:79]
    buffer_load_dwordx4 v8, s[12:15], s32 offen sc1 lds
    s_waitcnt lgkmcnt(4)
    v_mfma_f32_16x16x32_bf16 v[64:67], a[88:91], v[56:59], v[64:67]
    ds_read_b128 v[48:51], v12 offset:28672
    v_mfma_f32_16x16x32_bf16 v[68:71], a[92:95], v[56:59], v[68:71]
    v_mfma_f32_16x16x32_bf16 v[72:75], a[88:91], v[60:63], v[72:75]
    ds_read_b128 v[52:55], v12 offset:28928
    v_mfma_f32_16x16x32_bf16 v[76:79], a[92:95], v[60:63], v[76:79]
    s_waitcnt lgkmcnt(4)
    v_mfma_f32_16x16x32_bf16 v[64:67], a[96:99], v[32:35], v[64:67]
    ds_read_b128 v[56:59], v12 offset:30720
    v_mfma_f32_16x16x32_bf16 v[68:71], a[100:103], v[32:35], v[68:71]
    v_mfma_f32_16x16x32_bf16 v[72:75], a[96:99], v[36:39], v[72:75]
    ds_read_b128 v[60:63], v12 offset:30976
    s_add_u32 m0, s34, 106496
    s_add_u32 s32, s35, 40960
    v_mfma_f32_16x16x32_bf16 v[76:79], a[100:103], v[36:39], v[76:79]
    buffer_load_dwordx4 v8, s[12:15], s32 offen sc1 lds
    s_waitcnt lgkmcnt(4)
    v_mfma_f32_16x16x32_bf16 v[64:67], a[104:107], v[40:43], v[64:67]
    ds_read_b128 v[32:35], v12 offset:32768
    v_mfma_f32_16x16x32_bf16 v[68:71], a[108:111], v[40:43], v[68:71]
    v_mfma_f32_16x16x32_bf16 v[72:75], a[104:107], v[44:47], v[72:75]
    ds_read_b128 v[36:39], v12 offset:33024
    v_mfma_f32_16x16x32_bf16 v[76:79], a[108:111], v[44:47], v[76:79]
    s_waitcnt lgkmcnt(4)
    v_mfma_f32_16x16x32_bf16 v[64:67], a[112:115], v[48:51], v[64:67]
    ds_read_b128 v[40:43], v12 offset:34816
    v_mfma_f32_16x16x32_bf16 v[68:71], a[116:119], v[48:51], v[68:71]
    v_mfma_f32_16x16x32_bf16 v[72:75], a[112:115], v[52:55], v[72:75]
    ds_read_b128 v[44:47], v12 offset:35072
    s_add_u32 m0, s34, 110592
    s_add_u32 s32, s35, 45056
    v_mfma_f32_16x16x32_bf16 v[76:79], a[116:119], v[52:55], v[76:79]
    buffer_load_dwordx4 v8, s[12:15], s32 offen sc1 lds
    s_waitcnt lgkmcnt(4)
    v_mfma_f32_16x16x32_bf16 v[64:67], a[120:123], v[56:59], v[64:67]
    ds_read_b128 v[48:51], v12 offset:36864
    v_mfma_f32_16x16x32_bf16 v[68:71], a[124:127], v[56:59], v[68:71]
    v_mfma_f32_16x16x32_bf16 v[72:75], a[120:123], v[60:63], v[72:75]
    ds_read_b128 v[52:55], v12 offset:37120
    v_mfma_f32_16x16x32_bf16 v[76:79], a[124:127], v[60:63], v[76:79]
    s_waitcnt lgkmcnt(4)
    v_mfma_f32_16x16x32_bf16 v[64:67], a[128:131], v[32:35], v[64:67]
    ds_read_b128 v[56:59], v12 offset:38912
    v_mfma_f32_16x16x32_bf16 v[68:71], a[132:135], v[32:35], v[68:71]
    v_mfma_f32_16x16x32_bf16 v[72:75], a[128:131], v[36:39], v[72:75]
    ds_read_b128 v[60:63], v12 offset:39168
    s_add_u32 m0, s34, 114688
    s_add_u32 s32, s35, 49152
    v_mfma_f32_16x16x32_bf16 v[76:79], a[132:135], v[36:39], v[76:79]
    buffer_load_dwordx4 v8, s[12:15], s32 offen sc1 lds
    s_waitcnt lgkmcnt(4)
    v_mfma_f32_16x16x32_bf16 v[64:67], a[136:139], v[40:43], v[64:67]
    ds_read_b128 v[32:35], v12 offset:40960
    v_mfma_f32_16x16x32_bf16 v[68:71], a[140:143], v[40:43], v[68:71]
    v_mfma_f32_16x16x32_bf16 v[72:75], a[136:139], v[44:47], v[72:75]
    ds_read_b128 v[36:39], v12 offset:41216
    v_mfma_f32_16x16x32_bf16 v[76:79], a[140:143], v[44:47], v[76:79]
    s_waitcnt lgkmcnt(4)
    v_mfma_f32_16x16x32_bf16 v[64:67], a[144:147], v[48:51], v[64:67]
    ds_read_b128 v[40:43], v12 offset:43008
    v_mfma_f32_16x16x32_bf16 v[68:71], a[148:151], v[48:51], v[68:71]
    v_mfma_f32_16x16x32_bf16 v[72:75], a[144:147], v[52:55], v[72:75]
    ds_read_b128 v[44:47], v12 offset:43264
    s_add_u32 m0, s34, 118784
    s_add_u32 s32, s35, 53248
    v_mfma_f32_16x16x32_bf16 v[76:79], a[148:151], v[52:55], v[76:79]
    buffer_load_dwordx4 v8, s[12:15], s32 offen sc1 lds
    s_waitcnt lgkmcnt(4)
    v_mfma_f32_16x16x32_bf16 v[64:67], a[152:155], v[56:59], v[64:67]
    ds_read_b128 v[48:51], v12 offset:45056
    v_mfma_f32_16x16x32_bf16 v[68:71], a[156:159], v[56:59], v[68:71]
    v_mfma_f32_16x16x32_bf16 v[72:75], a[152:155], v[60:63], v[72:75]
    ds_read_b128 v[52:55], v12 offset:45312
    v_mfma_f32_16x16x32_bf16 v[76:79], a[156:159], v[60:63], v[76:79]
    s_waitcnt lgkmcnt(4)
    v_mfma_f32_16x16x32_bf16 v[64:67], a[160:163], v[32:35], v[64:67]
    ds_read_b128 v[56:59], v12 offset:47104
    v_mfma_f32_16x16x32_bf16 v[68:71], a[164:167], v[32:35], v[68:71]
    v_mfma_f32_16x16x32_bf16 v[72:75], a[160:163], v[36:39], v[72:75]
    ds_read_b128 v[60:63], v12 offset:47360
    s_add_u32 m0, s34, 122880
    s_add_u32 s32, s35, 57344
    v_mfma_f32_16x16x32_bf16 v[76:79], a[164:167], v[36:39], v[76:79]
    buffer_load_dwordx4 v8, s[12:15], s32 offen sc1 lds
    s_waitcnt lgkmcnt(4)
    v_mfma_f32_16x16x32_bf16 v[64:67], a[168:171], v[40:43], v[64:67]
    ds_read_b128 v[32:35], v12 offset:49152
    v_mfma_f32_16x16x32_bf16 v[68:71], a[172:175], v[40:43], v[68:71]
    v_mfma_f32_16x16x32_bf16 v[72:75], a[168:171], v[44:47], v[72:75]
    ds_read_b128 v[36:39], v12 offset:49408
    v_mfma_f32_16x16x32_bf16 v[76:79], a[172:175], v[44:47], v[76:79]
    s_waitcnt lgkmcnt(4)
    v_mfma_f32_16x16x32_bf16 v[64:67], a[176:179], v[48:51], v[64:67]
    ds_read_b128 v[40:43], v12 offset:51200
    v_mfma_f32_16x16x32_bf16 v[68:71], a[180:183], v[48:51], v[68:71]
    v_mfma_f32_16x16x32_bf16 v[72:75], a[176:179], v[52:55], v[72:75]
    ds_read_b128 v[44:47], v12 offset:51456
    s_add_u32 m0, s34, 126976
    s_add_u32 s32, s35, 61440
    v_mfma_f32_16x16x32_bf16 v[76:79], a[180:183], v[52:55], v[76:79]
    buffer_load_dwordx4 v8, s[12:15], s32 offen sc1 lds
    s_add_u32 s35, s35, 65536
    s_min_u32 s35, s35, s52
    s_waitcnt lgkmcnt(4)
    v_mfma_f32_16x16x32_bf16 v[64:67], a[184:187], v[56:59], v[64:67]
    ds_read_b128 v[48:51], v12 offset:53248
    v_mfma_f32_16x16x32_bf16 v[68:71], a[188:191], v[56:59], v[68:71]
    v_mfma_f32_16x16x32_bf16 v[72:75], a[184:187], v[60:63], v[72:75]
    ds_read_b128 v[52:55], v12 offset:53504
    v_mfma_f32_16x16x32_bf16 v[76:79], a[188:191], v[60:63], v[76:79]
    s_waitcnt vmcnt(8)
    s_barrier
    s_waitcnt lgkmcnt(4)
    v_mfma_f32_16x16x32_bf16 v[64:67], a[192:195], v[32:35], v[64:67]
    ds_read_b128 v[56:59], v12 offset:55296
    v_mfma_f32_16x16x32_bf16 v[68:71], a[196:199], v[32:35], v[68:71]
    v_mfma_f32_16x16x32_bf16 v[72:75], a[192:195], v[36:39], v[72:75]
    ds_read_b128 v[60:63], v12 offset:55552
    s_add_u32 m0, s34, 0
    s_add_u32 s32, s35, 0
    v_mfma_f32_16x16x32_bf16 v[76:79], a[196:199], v[36:39], v[76:79]
    buffer_load_dwordx4 v8, s[12:15], s32 offen sc1 lds
    s_waitcnt lgkmcnt(4)
    v_mfma_f32_16x16x32_bf16 v[64:67], a[200:203], v[40:43], v[64:67]
    ds_read_b128 v[32:35], v12 offset:57344
    v_mfma_f32_16x16x32_bf16 v[68:71], a[204:207], v[40:43], v[68:71]
    v_mfma_f32_16x16x32_bf16 v[72:75], a[200:203], v[44:47], v[72:75]
    ds_read_b128 v[36:39], v12 offset:57600
    v_mfma_f32_16x16x32_bf16 v[76:79], a[204:207], v[44:47], v[76:79]
    s_waitcnt lgkmcnt(4)
    v_mfma_f32_16x16x32_bf16 v[64:67], a[208:211], v[48:51], v[64:67]
    ds_read_b128 v[40:43], v12 offset:59392
    v_mfma_f32_16x16x32_bf16 v[68:71], a[212:215], v[48:51], v[68:71]
    v_mfma_f32_16x16x32_bf16 v[72:75], a[208:211], v[52:55], v[72:75]
    ds_read_b128 v[44:47], v12 offset:59648
    s_add_u32 m0, s34, 4096
    s_add_u32 s32, s35, 4096
    v_mfma_f32_16x16x32_bf16 v[76:79], a[212:215], v[52:55], v[76:79]
    buffer_load_dwordx4 v8, s[12:15], s32 offen sc1 lds
    s_waitcnt lgkmcnt(4)
    v_mfma_f32_16x16x32_bf16 v[64:67], a[216:219], v[56:59], v[64:67]
    ds_read_b128 v[48:51], v12 offset:61440
    v_mfma_f32_16x16x32_bf16 v[68:71], a[220:223], v[56:59], v[68:71]
    v_mfma_f32_16x16x32_bf16 v[72:75], a[216:219], v[60:63], v[72:75]
    ds_read_b128 v[52:55], v12 offset:61696
    v_mfma_f32_16x16x32_bf16 v[76:79], a[220:223], v[60:63], v[76:79]
    s_waitcnt lgkmcnt(4)
    v_mfma_f32_16x16x32_bf16 v[64:67], a[224:227], v[32:35], v[64:67]
    ds_read_b128 v[56:59], v12 offset:63488
    v_mfma_f32_16x16x32_bf16 v[68:71], a[228:231], v[32:35], v[68:71]
    v_mfma_f32_16x16x32_bf16 v[72:75], a[224:227], v[36:39], v[72:75]
    ds_read_b128 v[60:63], v12 offset:63744
    s_add_u32 m0, s34, 8192
    s_add_u32 s32, s35, 8192
    v_mfma_f32_16x16x32_bf16 v[76:79], a[228:231], v[36:39], v[76:79]
    buffer_load_dwordx4 v8, s[12:15], s32 offen sc1 lds
    s_waitcnt lgkmcnt(4)
    v_mfma_f32_16x16x32_bf16 v[64:67], a[232:235], v[40:43], v[64:67]
    ds_read_b128 v[32:35], v14 offset:0
    v_mfma_f32_16x16x32_bf16 v[68:71], a[236:239], v[40:43], v[68:71]
    v_mfma_f32_16x16x32_bf16 v[72:75], a[232:235], v[44:47], v[72:75]
    ds_read_b128 v[36:39], v14 offset:256
    v_mfma_f32_16x16x32_bf16 v[76:79], a[236:239], v[44:47], v[76:79]
    s_waitcnt lgkmcnt(4)
    v_mfma_f32_16x16x32_bf16 v[64:67], a[240:243], v[48:51], v[64:67]
    ds_read_b128 v[40:43], v14 offset:2048
    v_mfma_f32_16x16x32_bf16 v[68:71], a[244:247], v[48:51], v[68:71]
    v_mfma_f32_16x16x32_bf16 v[72:75], a[240:243], v[52:55], v[72:75]
    ds_read_b128 v[44:47], v14 offset:2304
    s_add_u32 m0, s34, 12288
    s_add_u32 s32, s35, 12288
    v_mfma_f32_16x16x32_bf16 v[76:79], a[244:247], v[52:55], v[76:79]
    buffer_load_dwordx4 v8, s[12:15], s32 offen sc1 lds
    s_waitcnt lgkmcnt(4)
    v_mfma_f32_16x16x32_bf16 v[64:67], a[248:251], v[56:59], v[64:67]
    ds_read_b128 v[48:51], v14 offset:4096
    v_mfma_f32_16x16x32_bf16 v[68:71], a[252:255], v[56:59], v[68:71]
    v_mfma_f32_16x16x32_bf16 v[72:75], a[248:251], v[60:63], v[72:75]
    ds_read_b128 v[52:55], v14 offset:4352
    v_mfma_f32_16x16x32_bf16 v[76:79], a[252:255], v[60:63], v[76:79]
    s_waitcnt lgkmcnt(4)
    v_mfma_f32_16x16x32_bf16 v[80:83], a[0:3], v[32:35], 0
    ds_read_b128 v[56:59], v14 offset:6144
    v_mfma_f32_16x16x32_bf16 v[84:87], a[4:7], v[32:35], 0
    v_mfma_f32_16x16x32_bf16 v[88:91], a[0:3], v[36:39], 0
    ds_read_b128 v[60:63], v14 offset:6400
    s_add_u32 m0, s34, 16384
    s_add_u32 s32, s35, 16384
    v_mfma_f32_16x16x32_bf16 v[92:95], a[4:7], v[36:39], 0
    buffer_load_dwordx4 v8, s[12:15], s32 offen sc1 lds
    s_waitcnt lgkmcnt(4)
    v_mfma_f32_16x16x32_bf16 v[80:83], a[8:11], v[40:43], v[80:83]
    ds_read_b128 v[32:35], v14 offset:8192
    v_mfma_f32_16x16x32_bf16 v[84:87], a[12:15], v[40:43], v[84:87]
    v_mfma_f32_16x16x32_bf16 v[88:91], a[8:11], v[44:47], v[88:91]
    ds_read_b128 v[36:39], v14 offset:8448
    v_mfma_f32_16x16x32_bf16 v[92:95], a[12:15], v[44:47], v[92:95]
    s_waitcnt lgkmcnt(4)
    v_mfma_f32_16x16x32_bf16 v[80:83], a[16:19], v[48:51], v[80:83]
    ds_read_b128 v[40:43], v14 offset:10240
    v_mfma_f32_16x16x32_bf16 v[84:87], a[20:23], v[48:51], v[84:87]
    v_cvt_pk_bf16_f32 v96, v64, v65
    v_mfma_f32_16x16x32_bf16 v[88:91], a[16:19], v[52:55], v[88:91]
    ds_read_b128 v[44:47], v14 offset:10496
    s_add_u32 m0, s34, 20480
    s_add_u32 s32, s35, 20480
    v_mfma_f32_16x16x32_bf16 v[92:95], a[20:23], v[52:55], v[92:95]
    buffer_load_dwordx4 v8, s[12:15], s32 offen sc1 lds
    v_cvt_pk_bf16_f32 v97, v66, v67
    s_waitcnt lgkmcnt(4)
    v_mfma_f32_16x16x32_bf16 v[80:83], a[24:27], v[56:59], v[80:83]
    ds_read_b128 v[48:51], v14 offset:12288
    v_mfma_f32_16x16x32_bf16 v[84:87], a[28:31], v[56:59], v[84:87]
    v_cvt_pk_bf16_f32 v98, v68, v69
    v_mfma_f32_16x16x32_bf16 v[88:91], a[24:27], v[60:63], v[88:91]
    ds_read_b128 v[52:55], v14 offset:12544
    v_mfma_f32_16x16x32_bf16 v[92:95], a[28:31], v[60:63], v[92:95]
    v_cvt_pk_bf16_f32 v99, v70, v71
    s_waitcnt lgkmcnt(4)
    v_mfma_f32_16x16x32_bf16 v[80:83], a[32:35], v[32:35], v[80:83]
    ds_read_b128 v[56:59], v14 offset:14336
    v_mfma_f32_16x16x32_bf16 v[84:87], a[36:39], v[32:35], v[84:87]
    v_cvt_pk_bf16_f32 v100, v72, v73
    v_mfma_f32_16x16x32_bf16 v[88:91], a[32:35], v[36:39], v[88:91]
    ds_read_b128 v[60:63], v14 offset:14592
    s_add_u32 m0, s34, 24576
    s_add_u32 s32, s35, 24576
    v_mfma_f32_16x16x32_bf16 v[92:95], a[36:39], v[36:39], v[92:95]
    buffer_load_dwordx4 v8, s[12:15], s32 offen sc1 lds
    v_cvt_pk_bf16_f32 v101, v74, v75
    s_waitcnt lgkmcnt(4)
    v_mfma_f32_16x16x32_bf16 v[80:83], a[40:43], v[40:43], v[80:83]
    ds_read_b128 v[32:35], v14 offset:16384
    v_mfma_f32_16x16x32_bf16 v[84:87], a[44:47], v[40:43], v[84:87]
    v_cvt_pk_bf16_f32 v102, v76, v77
    v_mfma_f32_16x16x32_bf16 v[88:91], a[40:43], v[44:47], v[88:91]
    ds_read_b128 v[36:39], v14 offset:16640
    v_mfma_f32_16x16x32_bf16 v[92:95], a[44:47], v[44:47], v[92:95]
    v_cvt_pk_bf16_f32 v103, v78, v79
    buffer_store_dwordx4 v[96:99], v9, s[20:23], s36 offen
    s_add_u32 s31, s36, 65536
    s_waitcnt lgkmcnt(4)
    v_mfma_f32_16x16x32_bf16 v[80:83], a[48:51], v[48:51], v[80:83]
    ds_read_b128 v[40:43], v14 offset:18432
    v_mfma_f32_16x16x32_bf16 v[84:87], a[52:55], v[48:51], v[84:87]
    v_mfma_f32_16x16x32_bf16 v[88:91], a[48:51], v[52:55], v[88:91]
    ds_read_b128 v[44:47], v14 offset:18688
    s_add_u32 m0, s34, 28672
    s_add_u32 s32, s35, 28672
    v_mfma_f32_16x16x32_bf16 v[92:95], a[52:55], v[52:55], v[92:95]
    buffer_load_dwordx4 v8, s[12:15], s32 offen sc1 lds
    s_waitcnt lgkmcnt(4)
    v_mfma_f32_16x16x32_bf16 v[80:83], a[56:59], v[56:59], v[80:83]
    ds_read_b128 v[48:51], v14 offset:20480
    v_mfma_f32_16x16x32_bf16 v[84:87], a[60:63], v[56:59], v[84:87]
    v_mfma_f32_16x16x32_bf16 v[88:91], a[56:59], v[60:63], v[88:91]
    ds_read_b128 v[52:55], v14 offset:20736
    v_mfma_f32_16x16x32_bf16 v[92:95], a[60:63], v[60:63], v[92:95]
    buffer_store_dwordx4 v[100:103], v9, s[20:23], s31 offen
    s_add_u32 s36, s36, s37
    s_waitcnt vmcnt(8)
    s_barrier
    s_waitcnt lgkmcnt(4)
    v_mfma_f32_16x16x32_bf16 v[80:83], a[64:67], v[32:35], v[80:83]
    ds_read_b128 v[56:59], v14 offset:22528
    v_mfma_f32_16x16x32_bf16 v[84:87], a[68:71], v[32:35], v[84:87]
    v_mfma_f32_16x16x32_bf16 v[88:91], a[64:67], v[36:39], v[88:91]
    ds_read_b128 v[60:63], v14 offset:22784
    s_add_u32 m0, s34, 32768
    s_add_u32 s32, s35, 32768
    v_mfma_f32_16x16x32_bf16 v[92:95], a[68:71], v[36:39], v[92:95]
    buffer_load_dwordx4 v8, s[12:15], s32 offen sc1 lds
    s_waitcnt lgkmcnt(4)
    v_mfma_f32_16x16x32_bf16 v[80:83], a[72:75], v[40:43], v[80:83]
    ds_read_b128 v[32:35], v14 offset:24576
    v_mfma_f32_16x16x32_bf16 v[84:87], a[76:79], v[40:43], v[84:87]
    v_mfma_f32_16x16x32_bf16 v[88:91], a[72:75], v[44:47], v[88:91]
    ds_read_b128 v[36:39], v14 offset:24832
    v_mfma_f32_16x16x32_bf16 v[92:95], a[76:79], v[44:47], v[92:95]
    s_waitcnt lgkmcnt(4)
    v_mfma_f32_16x16x32_bf16 v[80:83], a[80:83], v[48:51], v[80:83]
    ds_read_b128 v[40:43], v14 offset:26624
    v_mfma_f32_16x16x32_bf16 v[84:87], a[84:87], v[48:51], v[84:87]
    v_mfma_f32_16x16x32_bf16 v[88:91], a[80:83], v[52:55], v[88:91]
    ds_read_b128 v[44:47], v14 offset:26880
    s_add_u32 m0, s34, 36864
    s_add_u32 s32, s35, 36864
    v_mfma_f32_16x16x32_bf16 v[92:95], a[84:87], v[52:55], v[92:95]
    buffer_load_dwordx4 v8, s[12:15], s32 offen sc1 lds
    s_waitcnt lgkmcnt(4)
    v_mfma_f32_16x16x32_bf16 v[80:83], a[88:91], v[56:59], v[80:83]
    ds_read_b128 v[48:51], v14 offset:28672
    v_mfma_f32_16x16x32_bf16 v[84:87], a[92:95], v[56:59], v[84:87]
    v_mfma_f32_16x16x32_bf16 v[88:91], a[88:91], v[60:63], v[88:91]
    ds_read_b128 v[52:55], v14 offset:28928
    v_mfma_f32_16x16x32_bf16 v[92:95], a[92:95], v[60:63], v[92:95]
    s_waitcnt lgkmcnt(4)
    v_mfma_f32_16x16x32_bf16 v[80:83], a[96:99], v[32:35], v[80:83]
    ds_read_b128 v[56:59], v14 offset:30720
    v_mfma_f32_16x16x32_bf16 v[84:87], a[100:103], v[32:35], v[84:87]
    v_mfma_f32_16x16x32_bf16 v[88:91], a[96:99], v[36:39], v[88:91]
    ds_read_b128 v[60:63], v14 offset:30976
    s_add_u32 m0, s34, 40960
    s_add_u32 s32, s35, 40960
    v_mfma_f32_16x16x32_bf16 v[92:95], a[100:103], v[36:39], v[92:95]
    buffer_load_dwordx4 v8, s[12:15], s32 offen sc1 lds
    s_waitcnt lgkmcnt(4)
    v_mfma_f32_16x16x32_bf16 v[80:83], a[104:107], v[40:43], v[80:83]
    ds_read_b128 v[32:35], v14 offset:32768
    v_mfma_f32_16x16x32_bf16 v[84:87], a[108:111], v[40:43], v[84:87]
    v_mfma_f32_16x16x32_bf16 v[88:91], a[104:107], v[44:47], v[88:91]
    ds_read_b128 v[36:39], v14 offset:33024
    v_mfma_f32_16x16x32_bf16 v[92:95], a[108:111], v[44:47], v[92:95]
    s_waitcnt lgkmcnt(4)
    v_mfma_f32_16x16x32_bf16 v[80:83], a[112:115], v[48:51], v[80:83]
    ds_read_b128 v[40:43], v14 offset:34816
    v_mfma_f32_16x16x32_bf16 v[84:87], a[116:119], v[48:51], v[84:87]
    v_mfma_f32_16x16x32_bf16 v[88:91], a[112:115], v[52:55], v[88:91]
    ds_read_b128 v[44:47], v14 offset:35072
    s_add_u32 m0, s34, 45056
    s_add_u32 s32, s35, 45056
    v_mfma_f32_16x16x32_bf16 v[92:95], a[116:119], v[52:55], v[92:95]
    buffer_load_dwordx4 v8, s[12:15], s32 offen sc1 lds
    s_waitcnt lgkmcnt(4)
    v_mfma_f32_16x16x32_bf16 v[80:83], a[120:123], v[56:59], v[80:83]
    ds_read_b128 v[48:51], v14 offset:36864
    v_mfma_f32_16x16x32_bf16 v[84:87], a[124:127], v[56:59], v[84:87]
    v_mfma_f32_16x16x32_bf16 v[88:91], a[120:123], v[60:63], v[88:91]
    ds_read_b128 v[52:55], v14 offset:37120
    v_mfma_f32_16x16x32_bf16 v[92:95], a[124:127], v[60:63], v[92:95]
    s_waitcnt lgkmcnt(4)
    v_mfma_f32_16x16x32_bf16 v[80:83], a[128:131], v[32:35], v[80:83]
    ds_read_b128 v[56:59], v14 offset:38912
    v_mfma_f32_16x16x32_bf16 v[84:87], a[132:135], v[32:35], v[84:87]
    v_mfma_f32_16x16x32_bf16 v[88:91], a[128:131], v[36:39], v[88:91]
    ds_read_b128 v[60:63], v14 offset:39168
    s_add_u32 m0, s34, 49152
    s_add_u32 s32, s35, 49152
    v_mfma_f32_16x16x32_bf16 v[92:95], a[132:135], v[36:39], v[92:95]
    buffer_load_dwordx4 v8, s[12:15], s32 offen sc1 lds
    s_waitcnt lgkmcnt(4)
    v_mfma_f32_16x16x32_bf16 v[80:83], a[136:139], v[40:43], v[80:83]
    ds_read_b128 v[32:35], v14 offset:40960
    v_mfma_f32_16x16x32_bf16 v[84:87], a[140:143], v[40:43], v[84:87]
    v_mfma_f32_16x16x32_bf16 v[88:91], a[136:139], v[44:47], v[88:91]
    ds_read_b128 v[36:39], v14 offset:41216
    v_mfma_f32_16x16x32_bf16 v[92:95], a[140:143], v[44:47], v[92:95]
    s_waitcnt lgkmcnt(4)
    v_mfma_f32_16x16x32_bf16 v[80:83], a[144:147], v[48:51], v[80:83]
    ds_read_b128 v[40:43], v14 offset:43008
    v_mfma_f32_16x16x32_bf16 v[84:87], a[148:151], v[48:51], v[84:87]
    v_mfma_f32_16x16x32_bf16 v[88:91], a[144:147], v[52:55], v[88:91]
    ds_read_b128 v[44:47], v14 offset:43264
    s_add_u32 m0, s34, 53248
    s_add_u32 s32, s35, 53248
    v_mfma_f32_16x16x32_bf16 v[92:95], a[148:151], v[52:55], v[92:95]
    buffer_load_dwordx4 v8, s[12:15], s32 offen sc1 lds
    s_waitcnt lgkmcnt(4)
    v_mfma_f32_16x16x32_bf16 v[80:83], a[152:155], v[56:59], v[80:83]
    ds_read_b128 v[48:51], v14 offset:45056
    v_mfma_f32_16x16x32_bf16 v[84:87], a[156:159], v[56:59], v[84:87]
    v_mfma_f32_16x16x32_bf16 v[88:91], a[152:155], v[60:63], v[88:91]
    ds_read_b128 v[52:55], v14 offset:45312
    v_mfma_f32_16x16x32_bf16 v[92:95], a[156:159], v[60:63], v[92:95]
    s_waitcnt lgkmcnt(4)
    v_mfma_f32_16x16x32_bf16 v[80:83], a[160:163], v[32:35], v[80:83]
    ds_read_b128 v[56:59], v14 offset:47104
    v_mfma_f32_16x16x32_bf16 v[84:87], a[164:167], v[32:35], v[84:87]
    v_mfma_f32_16x16x32_bf16 v[88:91], a[160:163], v[36:39], v[88:91]
    ds_read_b128 v[60:63], v14 offset:47360
    s_add_u32 m0, s34, 57344
    s_add_u32 s32, s35, 57344
    v_mfma_f32_16x16x32_bf16 v[92:95], a[164:167], v[36:39], v[92:95]
    buffer_load_dwordx4 v8, s[12:15], s32 offen sc1 lds
    s_waitcnt lgkmcnt(4)
    v_mfma_f32_16x16x32_bf16 v[80:83], a[168:171], v[40:43], v[80:83]
    ds_read_b128 v[32:35], v14 offset:49152
    v_mfma_f32_16x16x32_bf16 v[84:87], a[172:175], v[40:43], v[84:87]
    v_mfma_f32_16x16x32_bf16 v[88:91], a[168:171], v[44:47], v[88:91]
    ds_read_b128 v[36:39], v14 offset:49408
    v_mfma_f32_16x16x32_bf16 v[92:95], a[172:175], v[44:47], v[92:95]
    s_waitcnt lgkmcnt(4)
    v_mfma_f32_16x16x32_bf16 v[80:83], a[176:179], v[48:51], v[80:83]
    ds_read_b128 v[40:43], v14 offset:51200
    v_mfma_f32_16x16x32_bf16 v[84:87], a[180:183], v[48:51], v[84:87]
    v_mfma_f32_16x16x32_bf16 v[88:91], a[176:179], v[52:55], v[88:91]
    ds_read_b128 v[44:47], v14 offset:51456
    s_add_u32 m0, s34, 61440
    s_add_u32 s32, s35, 61440
    v_mfma_f32_16x16x32_bf16 v[92:95], a[180:183], v[52:55], v[92:95]
    buffer_load_dwordx4 v8, s[12:15], s32 offen sc1 lds
    s_add_u32 s35, s35, 65536
    s_min_u32 s35, s35, s52
    s_waitcnt lgkmcnt(4)
    v_mfma_f32_16x16x32_bf16 v[80:83], a[184:187], v[56:59], v[80:83]
    ds_read_b128 v[48:51], v14 offset:53248
    v_mfma_f32_16x16x32_bf16 v[84:87], a[188:191], v[56:59], v[84:87]
    v_mfma_f32_16x16x32_bf16 v[88:91], a[184:187], v[60:63], v[88:91]
    ds_read_b128 v[52:55], v14 offset:53504
    v_mfma_f32_16x16x32_bf16 v[92:95], a[188:191], v[60:63], v[92:95]
    s_waitcnt vmcnt(8)
    s_barrier
    s_waitcnt lgkmcnt(4)
    v_mfma_f32_16x16x32_bf16 v[80:83], a[192:195], v[32:35], v[80:83]
    ds_read_b128 v[56:59], v14 offset:55296
    v_mfma_f32_16x16x32_bf16 v[84:87], a[196:199], v[32:35], v[84:87]
    v_mfma_f32_16x16x32_bf16 v[88:91], a[192:195], v[36:39], v[88:91]
    ds_read_b128 v[60:63], v14 offset:55552
    s_add_u32 m0, s34, 65536
    s_add_u32 s32, s35, 0
    v_mfma_f32_16x16x32_bf16 v[92:95], a[196:199], v[36:39], v[92:95]
    buffer_load_dwordx4 v8, s[12:15], s32 offen sc1 lds
    s_waitcnt lgkmcnt(4)
    v_mfma_f32_16x16x32_bf16 v[80:83], a[200:203], v[40:43], v[80:83]
    ds_read_b128 v[32:35], v14 offset:57344
    v_mfma_f32_16x16x32_bf16 v[84:87], a[204:207], v[40:43], v[84:87]
    v_mfma_f32_16x16x32_bf16 v[88:91], a[200:203], v[44:47], v[88:91]
    ds_read_b128 v[36:39], v14 offset:57600
    v_mfma_f32_16x16x32_bf16 v[92:95], a[204:207], v[44:47], v[92:95]
    s_waitcnt lgkmcnt(4)
    v_mfma_f32_16x16x32_bf16 v[80:83], a[208:211], v[48:51], v[80:83]
    ds_read_b128 v[40:43], v14 offset:59392
    v_mfma_f32_16x16x32_bf16 v[84:87], a[212:215], v[48:51], v[84:87]
    v_mfma_f32_16x16x32_bf16 v[88:91], a[208:211], v[52:55], v[88:91]
    ds_read_b128 v[44:47], v14 offset:59648
    s_add_u32 m0, s34, 69632
    s_add_u32 s32, s35, 4096
    v_mfma_f32_16x16x32_bf16 v[92:95], a[212:215], v[52:55], v[92:95]
    buffer_load_dwordx4 v8, s[12:15], s32 offen sc1 lds
    s_waitcnt lgkmcnt(4)
    v_mfma_f32_16x16x32_bf16 v[80:83], a[216:219], v[56:59], v[80:83]
    ds_read_b128 v[48:51], v14 offset:61440
    v_mfma_f32_16x16x32_bf16 v[84:87], a[220:223], v[56:59], v[84:87]
    v_mfma_f32_16x16x32_bf16 v[88:91], a[216:219], v[60:63], v[88:91]
    ds_read_b128 v[52:55], v14 offset:61696
    v_mfma_f32_16x16x32_bf16 v[92:95], a[220:223], v[60:63], v[92:95]
    s_waitcnt lgkmcnt(4)
    v_mfma_f32_16x16x32_bf16 v[80:83], a[224:227], v[32:35], v[80:83]
    ds_read_b128 v[56:59], v14 offset:63488
    v_mfma_f32_16x16x32_bf16 v[84:87], a[228:231], v[32:35], v[84:87]
    v_mfma_f32_16x16x32_bf16 v[88:91], a[224:227], v[36:39], v[88:91]
    ds_read_b128 v[60:63], v14 offset:63744
    s_add_u32 m0, s34, 73728
    s_add_u32 s32, s35, 8192
    v_mfma_f32_16x16x32_bf16 v[92:95], a[228:231], v[36:39], v[92:95]
    buffer_load_dwordx4 v8, s[12:15], s32 offen sc1 lds
    s_waitcnt lgkmcnt(4)
    v_mfma_f32_16x16x32_bf16 v[80:83], a[232:235], v[40:43], v[80:83]
    ds_read_b128 v[32:35], v12 offset:0
    v_mfma_f32_16x16x32_bf16 v[84:87], a[236:239], v[40:43], v[84:87]
    v_mfma_f32_16x16x32_bf16 v[88:91], a[232:235], v[44:47], v[88:91]
    ds_read_b128 v[36:39], v12 offset:256
    v_mfma_f32_16x16x32_bf16 v[92:95], a[236:239], v[44:47], v[92:95]
    s_waitcnt lgkmcnt(4)
    v_mfma_f32_16x16x32_bf16 v[80:83], a[240:243], v[48:51], v[80:83]
    ds_read_b128 v[40:43], v12 offset:2048
    v_mfma_f32_16x16x32_bf16 v[84:87], a[244:247], v[48:51], v[84:87]
    v_mfma_f32_16x16x32_bf16 v[88:91], a[240:243], v[52:55], v[88:91]
    ds_read_b128 v[44:47], v12 offset:2304
    s_add_u32 m0, s34, 77824
    s_add_u32 s32, s35, 12288
    v_mfma_f32_16x16x32_bf16 v[92:95], a[244:247], v[52:55], v[92:95]
    buffer_load_dwordx4 v8, s[12:15], s32 offen sc1 lds
    s_waitcnt lgkmcnt(4)
    v_mfma_f32_16x16x32_bf16 v[80:83], a[248:251], v[56:59], v[80:83]
    ds_read_b128 v[48:51], v12 offset:4096
    v_mfma_f32_16x16x32_bf16 v[84:87], a[252:255], v[56:59], v[84:87]
    v_mfma_f32_16x16x32_bf16 v[88:91], a[248:251], v[60:63], v[88:91]
    ds_read_b128 v[52:55], v12 offset:4352
    v_mfma_f32_16x16x32_bf16 v[92:95], a[252:255], v[60:63], v[92:95]
    s_add_u32 s30, s30, 2
    s_cmp_lt_u32 s30, s51
    s_cbranch_scc1 sl_loop_85
    v_cvt_pk_bf16_f32 v96, v80, v81
    v_cvt_pk_bf16_f32 v97, v82, v83
    v_cvt_pk_bf16_f32 v98, v84, v85
    v_cvt_pk_bf16_f32 v99, v86, v87
    v_cvt_pk_bf16_f32 v100, v88, v89
    v_cvt_pk_bf16_f32 v101, v90, v91
    v_cvt_pk_bf16_f32 v102, v92, v93
    v_cvt_pk_bf16_f32 v103, v94, v95
    s_branch sl_e_84
sl_e_84:
    buffer_store_dwordx4 v[96:99], v9, s[20:23], s36 offen
    s_add_u32 s31, s36, 65536
    buffer_store_dwordx4 v[100:103], v9, s[20:23], s31 offen
    s_add_u32 s36, s36, s37
    s_waitcnt vmcnt(0) lgkmcnt(0)
    s_barrier
    s_branch L_dump
L_dump:
L_end:
    s_endpgm
.section .rodata,"a"
.p2align 6
.amdhsa_kernel concat_heads__memory_aug_recurrent_mem_tr__sliding_local_dilated__prompt_kernel
  .amdhsa_next_free_vgpr 512
  .amdhsa_next_free_sgpr 102
  .amdhsa_accum_offset 256
  .amdhsa_group_segment_fixed_size 0
  .amdhsa_kernarg_size 104
  .amdhsa_user_sgpr_count 2
  .amdhsa_user_sgpr_kernarg_segment_ptr 1
  .amdhsa_system_sgpr_workgroup_id_x 1
.end_amdhsa_kernel
```

```asm
; @launch grid=(256,1,1) block=(256,1,1) lds=163840
.amdgcn_target "amdgcn-amd-amdhsa--gfx950"
.text
.globl concat_heads__memory_aug_recurrent_mem_tr__sliding_local_dilated__prompt_kernel
.p2align 8
.type concat_heads__memory_aug_recurrent_mem_tr__sliding_local_dilated__prompt_kernel,@function
concat_heads__memory_aug_recurrent_mem_tr__sliding_local_dilated__prompt_kernel:
    s_cmp_ge_u32 s2, 256
    s_cbranch_scc1 L_end
    s_mov_b32 s7, s2
    s_and_b32 s3, s7, 3
    s_lshl_b32 s3, s3, 5
    s_lshr_b32 s28, s2, 3
    s_add_u32 s28, s28, s3
    s_bitcmp1_b32 s7, 2
    s_cbranch_scc1 L_gem
L_rec:
    s_mov_b32 s6, L_gem - L_rec - 16
    s_getpc_b64 s[4:5]
    v_lshlrev_b32 v1, 7, v0
    v_min_u32 v2, s6, v1
    global_load_dword v250, v2, s[4:5]
    v_add_u32 v1, 32768, v1
    s_load_dwordx2 s[72:73], s[0:1], 8
    s_load_dwordx4 s[76:79], s[0:1], 16
    s_load_dwordx4 s[80:83], s[0:1], 32
    s_load_dwordx2 s[90:91], s[0:1], 96
    s_load_dwordx2 s[92:93], s[0:1], 88
    v_and_b32 v1, 63, v0
    v_lshrrev_b32 v2, 6, v0
    s_nop 0
    v_readfirstlane_b32 s31, v2
    s_lshr_b32 s29, s28, 2
    s_and_b32 s30, s28, 3
    s_mov_b32 s41, 0
    s_waitcnt lgkmcnt(0)
    s_mov_b32 s24, s72
    s_and_b32 s25, s73, 0xffff
    s_mov_b32 s26, 16384
    s_mov_b32 s27, 0x00020000
    s_mov_b32 s8, s76
    s_and_b32 s9, s77, 0xffff
    s_mov_b32 s10, 8388608
    s_mov_b32 s11, 0x00020000
    s_mov_b32 s12, s78
    s_and_b32 s13, s79, 0xffff
    s_mov_b32 s14, 8388608
    s_mov_b32 s15, 0x00020000
    s_mov_b32 s16, s80
    s_and_b32 s17, s81, 0xffff
    s_mov_b32 s18, 8388608
    s_mov_b32 s19, 0x00020000
    s_mov_b32 s20, s82
    s_and_b32 s21, s83, 0xffff
    s_mov_b32 s22, 8388608
    s_mov_b32 s23, 0x00020000
    s_mov_b32 s4, s90
    s_and_b32 s5, s91, 0xffff
    s_mov_b32 s6, 268435456
    s_mov_b32 s7, 0x00020000
    s_sub_u32 s49, 0, s90
    s_and_b32 s49, s49, 2097151
    s_add_u32 s49, s49, 117440512
    s_mov_b32 s48, 1
    s_cmp_lg_u32 s31, 3
    s_cbranch_scc1 rec_cal_1
    s_and_b32 s38, s28, 7
    s_lshl_b32 s38, s38, 21
    s_lshr_b32 s40, s28, 3
    s_and_b32 s40, s40, 1
    s_lshl_b32 s40, s40, 13
    s_add_u32 s38, s38, s40
    s_lshr_b32 s40, s28, 4
    s_and_b32 s40, s40, 7
    s_lshl_b32 s40, s40, 8
    s_add_u32 s38, s38, s40
    s_add_u32 s38, s38, s49
    s_add_u32 s38, s38, 245760
    s_lshr_b32 s39, s28, 3
    s_and_b32 s39, s39, 1
    s_lshl_b32 s39, s39, 14
    s_sub_u32 s39, s38, s39
    s_add_u32 s39, s39, 8192
    s_load_dword s80, s[90:91], s38 glc
    s_load_dword s81, s[90:91], s39 glc
    s_waitcnt lgkmcnt(0)
    s_memtime s[76:77]
    s_waitcnt lgkmcnt(0)
    s_load_dword s80, s[90:91], s38 glc
    s_waitcnt lgkmcnt(0)
    s_memtime s[78:79]
    s_waitcnt lgkmcnt(0)
    s_sub_u32 s72, s78, s76
    s_waitcnt lgkmcnt(0)
    s_memtime s[76:77]
    s_waitcnt lgkmcnt(0)
    s_load_dword s80, s[90:91], s39 glc
    s_waitcnt lgkmcnt(0)
    s_memtime s[78:79]
    s_waitcnt lgkmcnt(0)
    s_sub_u32 s73, s78, s76
    s_cmp_lt_u32 s73, s72
    s_cselect_b32 s38, 1, 0
    s_lshr_b32 s39, s28, 3
    s_xor_b32 s38, s38, s39
    s_xor_b32 s38, s38, s28
    s_and_b32 s48, s38, 1
    s_lshl_b32 s48, s48, 16
    s_add_u32 s48, s48, 1
rec_cal_1:
    s_lshl_b32 s38, s31, 21
    s_lshl_b32 s40, s28, 6
    s_add_u32 s38, s38, s40
    v_lshrrev_b32 v184, 2, v1
    v_lshlrev_b32 v184, 13, v184
    v_and_b32 v4, 3, v1
    v_lshl_add_u32 v184, v4, 4, v184
    v_add_u32 v184, s38, v184
    s_lshl_b32 s38, s31, 21
    s_lshr_b32 s40, s28, 1
    s_lshl_b32 s40, s40, 5
    s_add_u32 s38, s38, s40
    v_lshrrev_b32 v185, 1, v1
    v_lshlrev_b32 v185, 11, v185
    v_and_b32 v4, 1, v1
    v_lshl_add_u32 v185, v4, 4, v185
    v_add_u32 v185, s38, v185
    s_lshl_b32 s33, s31, 15
    v_lshrrev_b32 v186, 4, v1
    v_lshlrev_b32 v186, 9, v186
    v_bfe_u32 v4, v1, 2, 2
    v_lshl_add_u32 v186, v4, 6, v186
    v_and_b32 v4, 3, v1
    v_lshl_add_u32 v186, v4, 3, v186
    v_add_u32 v186, s33, v186
    v_lshrrev_b32 v187, 4, v1
    v_lshlrev_b32 v187, 8, v187
    v_bfe_u32 v4, v1, 2, 2
    v_lshl_add_u32 v187, v4, 5, v187
    v_and_b32 v4, 3, v1
    v_lshl_add_u32 v187, v4, 3, v187
    v_add_u32 v187, s33, v187
    s_add_u32 m0, s33, 0
    s_mov_b32 s38, 0
    buffer_load_dwordx4 v184, s[8:11], s38 offen lds
    s_add_u32 m0, s33, 1024
    s_mov_b32 s38, 131072
    buffer_load_dwordx4 v184, s[8:11], s38 offen lds
    s_add_u32 m0, s33, 2048
    s_mov_b32 s38, 0
    buffer_load_dwordx4 v184, s[12:15], s38 offen lds
    s_add_u32 m0, s33, 3072
    s_mov_b32 s38, 131072
    buffer_load_dwordx4 v184, s[12:15], s38 offen lds
    s_add_u32 m0, s33, 4096
    s_mov_b32 s38, 0
    buffer_load_dwordx4 v184, s[16:19], s38 offen lds
    s_add_u32 m0, s33, 5120
    s_mov_b32 s38, 131072
    buffer_load_dwordx4 v184, s[16:19], s38 offen lds
    s_add_u32 m0, s33, 6144
    s_mov_b32 s38, 262144
    buffer_load_dwordx4 v184, s[8:11], s38 offen lds
    s_add_u32 m0, s33, 7168
    s_mov_b32 s38, 393216
    buffer_load_dwordx4 v184, s[8:11], s38 offen lds
    s_add_u32 m0, s33, 8192
    s_mov_b32 s38, 262144
    buffer_load_dwordx4 v184, s[12:15], s38 offen lds
    s_add_u32 m0, s33, 9216
    s_mov_b32 s38, 393216
    buffer_load_dwordx4 v184, s[12:15], s38 offen lds
    s_add_u32 m0, s33, 10240
    s_mov_b32 s38, 262144
    buffer_load_dwordx4 v184, s[16:19], s38 offen lds
    s_add_u32 m0, s33, 11264
    s_mov_b32 s38, 393216
    buffer_load_dwordx4 v184, s[16:19], s38 offen lds
    v_bfe_u32 v2, v1, 1, 1
    v_mov_b32 v3, 0xaaaa
    v_mul_u32_u24 v2, v2, v3
    v_add_u32 v5, 0x4444, v2
    v_lshlrev_b32 v16, 4, v1
    s_lshr_b32 s38, s28, 6
    s_lshl_b32 s38, s38, 14
    s_and_b32 s40, s28, 63
    s_lshl_b32 s40, s40, 7
    s_add_u32 s38, s38, s40
    s_add_u32 s38, s38, 131072
    v_lshl_add_u32 v6, v1, 2, s38
    s_lshr_b32 s38, s31, 1
    s_lshl_b32 s38, s38, 14
    s_and_b32 s40, s31, 1
    s_lshl_b32 s40, s40, 12
    s_add_u32 s38, s38, s40
    s_add_u32 s38, s38, 131072
    v_add_u32 v7, s38, v16
    s_and_b32 s38, s28, 1
    s_lshl_b32 s38, s38, 16
    s_lshl_b32 s40, s31, 14
    s_add_u32 s38, s38, s40
    v_add_u32 v12, s38, v16
    v_add_u32 v13, 4096, v12
    v_lshrrev_b32 v2, 4, v1
    v_mul_u32_u24 v2, 320, v2
    v_and_b32 v3, 15, v1
    v_lshl_add_u32 v2, v3, 2, v2
    s_mul_i32 s38, s31, 2560
    v_add_u32 v14, s38, v2
    v_add_u32 v15, 1280, v14
    s_lshl_b32 s38, s31, 10
    s_add_u32 s38, s38, 10240
    v_add_u32 v17, s38, v16
    v_and_b32 v2, 3, v1
    v_lshlrev_b32 v2, 1, v2
    v_bfe_u32 v4, v1, 2, 1
    v_lshl_add_u32 v2, v4, 0, v2
    v_add_u32 v2, 8, v2
    v_and_b32 v3, 15, v1
    v_cmp_gt_u32 vcc, 8, v3
    s_nop 1
    v_cndmask_b32 v3, v2, v3, vcc
    v_mul_u32_u24 v3, 160, v3
    v_lshrrev_b32 v2, 5, v1
    v_lshlrev_b32 v2, 6, v2
    v_bfe_u32 v4, v1, 4, 1
    v_lshl_add_u32 v2, v4, 4, v2
    v_add_u32 v18, v2, v3
    s_lshl_b32 s38, s28, 11
    v_add_u32 v19, s38, v16
    v_bfe_u32 v20, v1, 4, 1
    v_lshlrev_b32 v20, 7, v20
    v_and_b32 v4, 7, v1
    v_lshl_add_u32 v20, v4, 4, v20
    v_add_u32 v20, s38, v20
    s_add_u32 s39, s30, 1
    s_and_b32 s38, s39, 3
    s_lshl_b32 s38, s38, 11
    s_lshl_b32 s40, s29, 13
    s_add_u32 s38, s38, s40
    v_add_u32 v22, s38, v16
    s_add_u32 s39, s30, 2
    s_and_b32 s38, s39, 3
    s_lshl_b32 s38, s38, 11
    s_lshl_b32 s40, s29, 13
    s_add_u32 s38, s38, s40
    v_add_u32 v23, s38, v16
    s_add_u32 s39, s30, 3
    s_and_b32 s38, s39, 3
    s_lshl_b32 s38, s38, 11
    s_lshl_b32 s40, s29, 13
    s_add_u32 s38, s38, s40
    v_add_u32 v24, s38, v16
    s_lshl_b32 s38, s29, 13
    v_lshrrev_b32 v21, 4, v1
    v_lshlrev_b32 v21, 11, v21
    v_and_b32 v4, 15, v1
    v_lshl_add_u32 v21, v4, 4, v21
    v_add_u32 v21, s38, v21
    v_lshrrev_b32 v25, 4, v1
    v_lshlrev_b32 v25, 8, v25
    v_bfe_u32 v4, v1, 3, 1
    v_lshl_add_u32 v25, v4, 3, v25
    v_bfe_u32 v4, v1, 1, 1
    v_lshl_add_u32 v25, v4, 6, v25
    v_bfe_u32 v4, v1, 2, 1
    v_lshl_add_u32 v25, v4, 5, v25
    v_and_b32 v4, 1, v1
    v_lshl_add_u32 v25, v4, 4, v25
    v_add_u32 v25, 10240, v25
    s_lshl_b32 s38, s28, 11
    s_and_b32 s40, s31, 1
    s_lshl_b32 s40, s40, 7
    s_add_u32 s38, s38, s40
    s_add_u32 s38, s38, 16777216
    v_bfe_u32 v2, v1, 3, 1
    v_lshlrev_b32 v2, 8, v2
    v_and_b32 v4, 7, v1
    v_lshl_add_u32 v2, v4, 4, v2
    v_bfe_u32 v4, v1, 4, 1
    v_lshl_add_u32 v2, v4, 9, v2
    v_lshrrev_b32 v4, 5, v1
    v_lshl_add_u32 v2, v4, 10, v2
    v_add_u32 v2, s38, v2
    s_add_u32 s38, s38, 16777216
    v_bfe_u32 v3, v1, 3, 1
    v_lshlrev_b32 v3, 8, v3
    v_bfe_u32 v4, v1, 1, 1
    v_lshl_add_u32 v3, v4, 6, v3
    v_bfe_u32 v4, v1, 2, 1
    v_lshl_add_u32 v3, v4, 5, v3
    v_and_b32 v4, 1, v1
    v_lshl_add_u32 v3, v4, 4, v3
    v_bfe_u32 v4, v1, 4, 1
    v_lshl_add_u32 v3, v4, 9, v3
    v_lshrrev_b32 v4, 5, v1
    v_lshl_add_u32 v3, v4, 10, v3
    v_add_u32 v3, s38, v3
    s_cmp_lt_u32 s31, 2
    s_cselect_b64 vcc, -1, 0
    v_cndmask_b32 v30, v3, v2, vcc
    s_lshl_b32 s3, s31, 10
    s_lshr_b32 s38, s29, 3
    s_lshl_b32 s38, s38, 14
    s_and_b32 s40, s29, 7
    s_lshl_b32 s40, s40, 10
    s_add_u32 s38, s38, s40
    s_and_b32 s40, s30, 1
    s_lshl_b32 s40, s40, 9
    s_add_u32 s38, s38, s40
    s_lshr_b32 s40, s30, 1
    s_lshl_b32 s40, s40, 7
    s_add_u32 s38, s38, s40
    v_bfe_u32 v27, v1, 2, 1
    v_lshlrev_b32 v27, 16, v27
    v_lshrrev_b32 v4, 5, v1
    v_lshl_add_u32 v27, v4, 8, v27
    v_bfe_u32 v4, v1, 1, 1
    v_lshl_add_u32 v27, v4, 6, v27
    v_bfe_u32 v4, v1, 4, 1
    v_lshl_add_u32 v27, v4, 5, v27
    v_and_b32 v4, 1, v1
    v_lshl_add_u32 v27, v4, 4, v27
    v_add_u32 v27, s38, v27
    s_lshr_b32 s39, s31, 1
    s_lshl_b32 s39, s39, 16
    s_and_b32 s40, s31, 1
    s_lshl_b32 s40, s40, 8
    s_add_u32 s39, s39, s40
    s_add_u32 s39, s39, s38
    v_add_u32 v95, s39, v16
    v_cmp_gt_u32 vcc, 8, v1
    v_mov_b32 v4, 2130706432
    s_nop 0
    v_cndmask_b32 v95, v4, v95, vcc
    s_lshl_b32 s38, s31, 8
    s_add_u32 s38, s38, 14336
    v_lshl_add_u32 v28, v1, 2, s38
    v_bfe_u32 v29, v1, 2, 1
    v_lshlrev_b32 v29, 7, v29
    v_bfe_u32 v4, v1, 4, 1
    v_lshl_add_u32 v29, v4, 6, v29
    v_and_b32 v4, 3, v1
    v_lshl_add_u32 v29, v4, 4, v29
    v_bfe_u32 v4, v1, 3, 1
    v_lshl_add_u32 v29, v4, 3, v29
    v_add_u32 v29, 14336, v29
    s_mul_i32 s39, s31, 320
    s_lshl_b32 s38, s28, 11
    s_add_u32 s38, s38, s39
    v_add_u32 v94, s38, v16
    v_cmp_gt_u32 vcc, 20, v1
    v_mov_b32 v4, 2130706432
    s_nop 0
    v_cndmask_b32 v94, v4, v94, vcc
    s_mul_i32 s38, s31, 3
    v_min_u32 v2, 2, v1
    v_add_u32 v2, s38, v2
    v_min_u32 v2, 9, v2
    s_lshl_b32 s38, s28, 11
    s_add_u32 s38, s38, 262144
    v_lshl_add_u32 v92, v2, 7, s38
    s_lshl_b32 s38, s28, 9
    v_lshrrev_b32 v93, 4, v1
    v_lshlrev_b32 v93, 7, v93
    v_and_b32 v4, 3, v1
    v_lshl_add_u32 v93, v4, 5, v93
    v_bfe_u32 v4, v1, 2, 1
    v_lshl_add_u32 v93, v4, 4, v93
    v_add_u32 v93, s38, v93
    s_mov_b32 vcc_lo, 0xff00ff00
    s_mov_b32 vcc_hi, 0xff00ff00
    s_cmp_eq_u32 s31, 1
    s_cbranch_scc1 rec_ns_2
    s_add_u32 s38, s38, 4194304
    v_add_u32 v93, s38, v16
    s_mov_b32 vcc_lo, -1
    s_mov_b32 vcc_hi, 0
    s_cmp_eq_u32 s31, 2
    s_cbranch_scc1 rec_ns_2
    s_lshr_b32 s38, s28, 6
    s_lshl_b32 s38, s38, 14
    s_and_b32 s40, s28, 63
    s_lshl_b32 s40, s40, 7
    s_add_u32 s38, s38, s40
    s_add_u32 s38, s38, 131072
    v_add_u32 v93, s38, v16
    s_cmp_eq_u32 s31, 3
    s_cselect_b32 vcc_lo, 0xff, 0
rec_ns_2:
    s_nop 0
    v_mov_b32 v4, 2130706432
    v_cndmask_b32 v93, v4, v93, vcc
    v_mov_b32 v32, 0x3f803f80
    v_mov_b32 v33, 0x3f803f80
    v_mov_b32 v34, 0x3f803f80
    v_mov_b32 v35, 0x3f803f80
    v_mov_b32 v8, -1
    v_mov_b32 v9, -1
    v_mov_b32 v10, -1
    v_mov_b32 v11, -1
    v_mov_b32 v144, 0
    v_mov_b32 v145, 0
    v_mov_b32 v146, 0
    v_mov_b32 v147, 0
    v_mov_b32 v180, 0
    v_mov_b32 v181, 0
    v_mov_b32 v182, 0
    v_mov_b32 v183, 0
    v_mov_b32 v161, 0
    v_mov_b32 v162, 0
    v_mov_b32 v163, 0
    v_mov_b32 v138, 0
    v_mov_b32 v139, 0
    v_mov_b32 v140, 0
    v_mov_b32 v141, 0
    v_mov_b32 v142, 0
    v_mov_b32 v143, 0
    s_mov_b32 s42, 0x00ff00ff
    s_mov_b32 s43, 0x00ff00ff
    s_mov_b32 s44, 0
    s_mov_b32 s45, -1
    s_mov_b32 s46, 0
    s_mov_b32 s47, 0x00ff00ff
    s_mov_b32 s50, 0x3e0293ee
    s_mov_b32 s36, 96468992
    s_mov_b32 s37, 0
    s_mov_b32 s32, 0
    s_mov_b32 s51, 16384
    s_mov_b32 s54, 1
    s_min_u32 s38, s31, 1
    s_add_u32 s38, s38, 1
    v_mov_b32 v134, s38
    s_lshl_b32 s95, s29, 7
    s_lshr_b32 s40, s31, 1
    s_lshl_b32 s40, s40, 2
    s_add_u32 s95, s95, s40
    s_add_u32 s95, s95, 115343364
    s_lshl_b32 s97, s29, 7
    s_add_u32 s97, s97, 115351552
    s_lshl_b32 s38, s30, 4
    s_add_u32 s38, s38, s97
    v_mov_b32 v137, s38
    s_cmp_eq_u32 s31, 2
    s_cselect_b64 vcc, 1, 0
    v_mov_b32 v4, 2130706432
    v_cndmask_b32 v137, v4, v137, vcc
    s_mov_b32 s94, 0
    s_add_u32 s38, s49, 0
    buffer_store_dwordx4 v[144:147], v95, s[4:7], s38 offen sc1
    s_add_u32 s38, s49, 262144
    buffer_store_dwordx4 v[144:147], v95, s[4:7], s38 offen sc1
    s_add_u32 s38, s49, 8192
    buffer_store_dwordx4 v[144:147], v95, s[4:7], s38 offen sc1
    s_add_u32 s38, s49, 270336
    buffer_store_dwordx4 v[144:147], v95, s[4:7], s38 offen sc1
    buffer_store_dwordx4 v[8:11], v94, s[4:7], s36 offen sc1
    v_add_u32 v94, 262144, v94
    buffer_store_dwordx4 v[8:11], v94, s[4:7], s36 offen sc1
    v_add_u32 v94, 262144, v94
    buffer_store_dwordx4 v[8:11], v94, s[4:7], s36 offen sc1
    buffer_store_dword v144, v137, s[4:7], 0 offen sc1
    s_getreg_b32 s38, hwreg(HW_REG_XCC_ID)
    v_mov_b32 v2, s38
    buffer_store_dword v2, v137, s[4:7], 0 offen offset:64 sc1
    s_cmp_lg_u32 s31, 3
    s_cbranch_scc1 rec_i3_3
    s_add_u32 s38, s49, 262144
    buffer_store_dwordx4 v[144:147], v93, s[4:7], s38 offen sc1
    s_add_u32 s38, s49, 270336
    buffer_store_dwordx4 v[144:147], v93, s[4:7], s38 offen sc1
    s_lshr_b32 s39, s28, 5
    s_lshl_b32 s39, s39, 14
    s_and_b32 s40, s28, 31
    s_lshl_b32 s40, s40, 8
    s_add_u32 s39, s39, s40
    s_add_u32 s39, s39, s49
    s_add_u32 s39, s39, 163840
    s_mov_b64 exec, 0xffff
    s_add_u32 s38, s39, 0
    buffer_store_dwordx4 v[144:147], v16, s[4:7], s38 offen sc1
    s_add_u32 s38, s39, 8192
    buffer_store_dwordx4 v[144:147], v16, s[4:7], s38 offen sc1
    s_mov_b64 exec, -1
rec_i3_3:
    s_lshl_b32 s38, s31, 9
    v_bfe_u32 v2, v1, 2, 2
    v_lshlrev_b32 v2, 12, v2
    v_and_b32 v4, 1, v1
    v_lshl_add_u32 v2, v4, 11, v2
    v_lshrrev_b32 v4, 4, v1
    v_lshl_add_u32 v2, v4, 5, v2
    v_bfe_u32 v4, v1, 1, 1
    v_lshl_add_u32 v2, v4, 2, v2
    v_add_u32 v2, s38, v2
    buffer_load_dword v36, v2, s[24:27], 0 offen offset:0
    buffer_load_dword v37, v2, s[24:27], 0 offen offset:8
    buffer_load_dword v38, v2, s[24:27], 0 offen offset:16
    buffer_load_dword v39, v2, s[24:27], 0 offen offset:24
    buffer_load_dword v40, v2, s[24:27], 0 offen offset:128
    buffer_load_dword v41, v2, s[24:27], 0 offen offset:136
    buffer_load_dword v42, v2, s[24:27], 0 offen offset:144
    buffer_load_dword v43, v2, s[24:27], 0 offen offset:152
    buffer_load_dword v44, v2, s[24:27], 0 offen offset:256
    buffer_load_dword v45, v2, s[24:27], 0 offen offset:264
    buffer_load_dword v46, v2, s[24:27], 0 offen offset:272
    buffer_load_dword v47, v2, s[24:27], 0 offen offset:280
    buffer_load_dword v48, v2, s[24:27], 0 offen offset:384
    buffer_load_dword v49, v2, s[24:27], 0 offen offset:392
    buffer_load_dword v50, v2, s[24:27], 0 offen offset:400
    buffer_load_dword v51, v2, s[24:27], 0 offen offset:408
    s_add_u32 m0, s33, 12288
    s_mov_b32 s38, 524288
    buffer_load_dwordx4 v184, s[8:11], s38 offen lds
    s_add_u32 m0, s33, 13312
    s_mov_b32 s38, 655360
    buffer_load_dwordx4 v184, s[8:11], s38 offen lds
    s_add_u32 m0, s33, 14336
    s_mov_b32 s38, 524288
    buffer_load_dwordx4 v184, s[12:15], s38 offen lds
    s_add_u32 m0, s33, 15360
    s_mov_b32 s38, 655360
    buffer_load_dwordx4 v184, s[12:15], s38 offen lds
    s_add_u32 m0, s33, 16384
    s_mov_b32 s38, 524288
    buffer_load_dwordx4 v184, s[16:19], s38 offen lds
    s_add_u32 m0, s33, 17408
    s_mov_b32 s38, 655360
    buffer_load_dwordx4 v184, s[16:19], s38 offen lds
    s_add_u32 m0, s33, 18432
    s_mov_b32 s38, 786432
    buffer_load_dwordx4 v184, s[8:11], s38 offen lds
    s_add_u32 m0, s33, 19456
    s_mov_b32 s38, 917504
    buffer_load_dwordx4 v184, s[8:11], s38 offen lds
    s_add_u32 m0, s33, 20480
    s_mov_b32 s38, 786432
    buffer_load_dwordx4 v184, s[12:15], s38 offen lds
    s_add_u32 m0, s33, 21504
    s_mov_b32 s38, 917504
    buffer_load_dwordx4 v184, s[12:15], s38 offen lds
    s_add_u32 m0, s33, 22528
    s_mov_b32 s38, 786432
    buffer_load_dwordx4 v184, s[16:19], s38 offen lds
    s_add_u32 m0, s33, 23552
    s_mov_b32 s38, 917504
    buffer_load_dwordx4 v184, s[16:19], s38 offen lds
    s_add_u32 m0, s33, 24576
    s_mov_b32 s38, 1048576
    buffer_load_dwordx4 v184, s[8:11], s38 offen lds
    s_add_u32 m0, s33, 25600
    s_mov_b32 s38, 1179648
    buffer_load_dwordx4 v184, s[8:11], s38 offen lds
    s_add_u32 m0, s33, 26624
    s_mov_b32 s38, 1048576
    buffer_load_dwordx4 v184, s[12:15], s38 offen lds
    s_add_u32 m0, s33, 27648
    s_mov_b32 s38, 1179648
    buffer_load_dwordx4 v184, s[12:15], s38 offen lds
    s_add_u32 m0, s33, 28672
    s_mov_b32 s38, 1048576
    buffer_load_dwordx4 v184, s[16:19], s38 offen lds
    s_add_u32 m0, s33, 29696
    s_mov_b32 s38, 1179648
    buffer_load_dwordx4 v184, s[16:19], s38 offen lds
    s_add_u32 m0, s33, 30720
    s_mov_b32 s38, 1310720
    buffer_load_dwordx4 v184, s[8:11], s38 offen lds
    s_add_u32 m0, s33, 31744
    s_mov_b32 s38, 1441792
    buffer_load_dwordx4 v184, s[8:11], s38 offen lds
    s_waitcnt vmcnt(54)
    ds_read_b64_tr_b16 a[0:1], v186 offset:0
    ds_read_b64_tr_b16 a[2:3], v186 offset:256
    ds_read_b64_tr_b16 a[8:9], v186 offset:32
    ds_read_b64_tr_b16 a[10:11], v186 offset:288
    s_waitcnt vmcnt(52)
    ds_read_b64_tr_b16 a[16:17], v186 offset:2048
    ds_read_b64_tr_b16 a[18:19], v186 offset:2304
    ds_read_b64_tr_b16 a[24:25], v186 offset:2080
    ds_read_b64_tr_b16 a[26:27], v186 offset:2336
    s_waitcnt lgkmcnt(4)
    s_add_u32 m0, s33, 0
    s_mov_b32 s38, 1310720
    buffer_load_dwordx4 v184, s[12:15], s38 offen lds
    s_add_u32 m0, s33, 1024
    s_mov_b32 s38, 1441792
    buffer_load_dwordx4 v184, s[12:15], s38 offen lds
    s_waitcnt vmcnt(52)
    ds_read_b64_tr_b16 a[32:33], v186 offset:4096
    ds_read_b64_tr_b16 a[34:35], v186 offset:4352
    ds_read_b64_tr_b16 a[40:41], v186 offset:4128
    ds_read_b64_tr_b16 a[42:43], v186 offset:4384
    s_waitcnt lgkmcnt(4)
    s_add_u32 m0, s33, 2048
    s_mov_b32 s38, 1310720
    buffer_load_dwordx4 v184, s[16:19], s38 offen lds
    s_add_u32 m0, s33, 3072
    s_mov_b32 s38, 1441792
    buffer_load_dwordx4 v184, s[16:19], s38 offen lds
    s_waitcnt vmcnt(52)
    ds_read_b64_tr_b16 a[4:5], v186 offset:6144
    ds_read_b64_tr_b16 a[6:7], v186 offset:6400
    ds_read_b64_tr_b16 a[12:13], v186 offset:6176
    ds_read_b64_tr_b16 a[14:15], v186 offset:6432
    s_waitcnt lgkmcnt(4)
    s_add_u32 m0, s33, 4096
    s_mov_b32 s38, 1572864
    buffer_load_dwordx4 v184, s[8:11], s38 offen lds
    s_add_u32 m0, s33, 5120
    s_mov_b32 s38, 1703936
    buffer_load_dwordx4 v184, s[8:11], s38 offen lds
    s_waitcnt vmcnt(52)
    ds_read_b64_tr_b16 a[20:21], v186 offset:8192
    ds_read_b64_tr_b16 a[22:23], v186 offset:8448
    ds_read_b64_tr_b16 a[28:29], v186 offset:8224
    ds_read_b64_tr_b16 a[30:31], v186 offset:8480
    s_waitcnt lgkmcnt(4)
    s_add_u32 m0, s33, 6144
    s_mov_b32 s38, 1572864
    buffer_load_dwordx4 v184, s[12:15], s38 offen lds
    s_add_u32 m0, s33, 7168
    s_mov_b32 s38, 1703936
    buffer_load_dwordx4 v184, s[12:15], s38 offen lds
    s_waitcnt vmcnt(52)
    ds_read_b64_tr_b16 a[36:37], v186 offset:10240
    ds_read_b64_tr_b16 a[38:39], v186 offset:10496
    ds_read_b64_tr_b16 a[44:45], v186 offset:10272
    ds_read_b64_tr_b16 a[46:47], v186 offset:10528
    s_waitcnt lgkmcnt(4)
    s_add_u32 m0, s33, 8192
    s_mov_b32 s38, 1572864
    buffer_load_dwordx4 v184, s[16:19], s38 offen lds
    s_add_u32 m0, s33, 9216
    s_mov_b32 s38, 1703936
    buffer_load_dwordx4 v184, s[16:19], s38 offen lds
    s_waitcnt vmcnt(28)
    s_barrier
    s_cmp_lg_u32 s31, 3
    s_cbranch_scc1 rec_arr_4
    v_mov_b32 v2, 0
    v_mov_b32 v3, s48
    s_mov_b64 exec, 1
    global_atomic_add v2, v3, s[92:93] offset:0 sc1
    s_mov_b64 exec, -1
rec_arr_4:
    ds_read_b64_tr_b16 a[48:49], v186 offset:12288
    ds_read_b64_tr_b16 a[50:51], v186 offset:12544
    ds_read_b64_tr_b16 a[56:57], v186 offset:12320
    ds_read_b64_tr_b16 a[58:59], v186 offset:12576
    s_waitcnt lgkmcnt(4)
    s_add_u32 m0, s33, 10240
    s_mov_b32 s38, 1835008
    buffer_load_dwordx4 v184, s[8:11], s38 offen lds
    s_add_u32 m0, s33, 11264
    s_mov_b32 s38, 1966080
    buffer_load_dwordx4 v184, s[8:11], s38 offen lds
    s_waitcnt vmcnt(28)
    ds_read_b64_tr_b16 a[64:65], v186 offset:14336
    ds_read_b64_tr_b16 a[66:67], v186 offset:14592
    ds_read_b64_tr_b16 a[72:73], v186 offset:14368
    ds_read_b64_tr_b16 a[74:75], v186 offset:14624
    s_waitcnt lgkmcnt(4)
    s_add_u32 m0, s33, 12288
    s_mov_b32 s38, 1835008
    buffer_load_dwordx4 v184, s[12:15], s38 offen lds
    s_add_u32 m0, s33, 13312
    s_mov_b32 s38, 1966080
    buffer_load_dwordx4 v184, s[12:15], s38 offen lds
    s_waitcnt vmcnt(28)
    ds_read_b64_tr_b16 a[80:81], v186 offset:16384
    ds_read_b64_tr_b16 a[82:83], v186 offset:16640
    ds_read_b64_tr_b16 a[88:89], v186 offset:16416
    ds_read_b64_tr_b16 a[90:91], v186 offset:16672
    s_waitcnt lgkmcnt(4)
    s_add_u32 m0, s33, 14336
    s_mov_b32 s38, 1835008
    buffer_load_dwordx4 v184, s[16:19], s38 offen lds
    s_add_u32 m0, s33, 15360
    s_mov_b32 s38, 1966080
    buffer_load_dwordx4 v184, s[16:19], s38 offen lds
    s_waitcnt vmcnt(28)
    ds_read_b64_tr_b16 a[52:53], v186 offset:18432
    ds_read_b64_tr_b16 a[54:55], v186 offset:18688
    ds_read_b64_tr_b16 a[60:61], v186 offset:18464
    ds_read_b64_tr_b16 a[62:63], v186 offset:18720
    s_waitcnt lgkmcnt(4)
    s_add_u32 m0, s33, 16384
    s_mov_b32 s38, 0
    buffer_load_dwordx4 v185, s[20:23], s38 offen lds
    s_add_u32 m0, s33, 17408
    s_mov_b32 s38, 65536
    buffer_load_dwordx4 v185, s[20:23], s38 offen lds
    s_waitcnt vmcnt(28)
    ds_read_b64_tr_b16 a[68:69], v186 offset:20480
    ds_read_b64_tr_b16 a[70:71], v186 offset:20736
    ds_read_b64_tr_b16 a[76:77], v186 offset:20512
    ds_read_b64_tr_b16 a[78:79], v186 offset:20768
    s_waitcnt lgkmcnt(4)
    s_add_u32 m0, s33, 18432
    s_mov_b32 s38, 131072
    buffer_load_dwordx4 v185, s[20:23], s38 offen lds
    s_add_u32 m0, s33, 19456
    s_mov_b32 s38, 196608
    buffer_load_dwordx4 v185, s[20:23], s38 offen lds
    s_waitcnt vmcnt(28)
    ds_read_b64_tr_b16 a[84:85], v186 offset:22528
    ds_read_b64_tr_b16 a[86:87], v186 offset:22784
    ds_read_b64_tr_b16 a[92:93], v186 offset:22560
    ds_read_b64_tr_b16 a[94:95], v186 offset:22816
    s_waitcnt lgkmcnt(4)
    s_add_u32 m0, s33, 20480
    s_mov_b32 s38, 262144
    buffer_load_dwordx4 v185, s[20:23], s38 offen lds
    s_add_u32 m0, s33, 21504
    s_mov_b32 s38, 327680
    buffer_load_dwordx4 v185, s[20:23], s38 offen lds
    s_waitcnt vmcnt(28)
    ds_read_b64_tr_b16 a[96:97], v186 offset:24576
    ds_read_b64_tr_b16 a[98:99], v186 offset:24832
    ds_read_b64_tr_b16 a[104:105], v186 offset:24608
    ds_read_b64_tr_b16 a[106:107], v186 offset:24864
    s_waitcnt lgkmcnt(4)
    s_add_u32 m0, s33, 22528
    s_mov_b32 s38, 393216
    buffer_load_dwordx4 v185, s[20:23], s38 offen lds
    s_add_u32 m0, s33, 23552
    s_mov_b32 s38, 458752
    buffer_load_dwordx4 v185, s[20:23], s38 offen lds
    s_waitcnt vmcnt(28)
    ds_read_b64_tr_b16 a[112:113], v186 offset:26624
    ds_read_b64_tr_b16 a[114:115], v186 offset:26880
    ds_read_b64_tr_b16 a[120:121], v186 offset:26656
    ds_read_b64_tr_b16 a[122:123], v186 offset:26912
    s_waitcnt lgkmcnt(4)
    s_add_u32 m0, s33, 24576
    s_mov_b32 s38, 524288
    buffer_load_dwordx4 v185, s[20:23], s38 offen lds
    s_add_u32 m0, s33, 25600
    s_mov_b32 s38, 589824
    buffer_load_dwordx4 v185, s[20:23], s38 offen lds
    s_waitcnt vmcnt(28)
    ds_read_b64_tr_b16 a[128:129], v186 offset:28672
    ds_read_b64_tr_b16 a[130:131], v186 offset:28928
    ds_read_b64_tr_b16 a[136:137], v186 offset:28704
    ds_read_b64_tr_b16 a[138:139], v186 offset:28960
    s_waitcnt lgkmcnt(4)
    s_add_u32 m0, s33, 26624
    s_mov_b32 s38, 655360
    buffer_load_dwordx4 v185, s[20:23], s38 offen lds
    s_add_u32 m0, s33, 27648
    s_mov_b32 s38, 720896
    buffer_load_dwordx4 v185, s[20:23], s38 offen lds
    s_waitcnt vmcnt(28)
    ds_read_b64_tr_b16 a[100:101], v186 offset:30720
    ds_read_b64_tr_b16 a[102:103], v186 offset:30976
    ds_read_b64_tr_b16 a[108:109], v186 offset:30752
    ds_read_b64_tr_b16 a[110:111], v186 offset:31008
    s_waitcnt lgkmcnt(4)
    s_add_u32 m0, s33, 28672
    s_mov_b32 s38, 786432
    buffer_load_dwordx4 v185, s[20:23], s38 offen lds
    s_add_u32 m0, s33, 29696
    s_mov_b32 s38, 851968
    buffer_load_dwordx4 v185, s[20:23], s38 offen lds
    s_waitcnt vmcnt(28)
    ds_read_b64_tr_b16 a[116:117], v186 offset:0
    ds_read_b64_tr_b16 a[118:119], v186 offset:256
    ds_read_b64_tr_b16 a[124:125], v186 offset:32
    ds_read_b64_tr_b16 a[126:127], v186 offset:288
    s_waitcnt lgkmcnt(4)
    s_add_u32 m0, s33, 30720
    s_mov_b32 s38, 917504
    buffer_load_dwordx4 v185, s[20:23], s38 offen lds
    s_add_u32 m0, s33, 31744
    s_mov_b32 s38, 983040
    buffer_load_dwordx4 v185, s[20:23], s38 offen lds
    s_waitcnt vmcnt(28)
    ds_read_b64_tr_b16 a[132:133], v186 offset:2048
    ds_read_b64_tr_b16 a[134:135], v186 offset:2304
    ds_read_b64_tr_b16 a[140:141], v186 offset:2080
    ds_read_b64_tr_b16 a[142:143], v186 offset:2336
    s_waitcnt lgkmcnt(4)
    s_add_u32 m0, s33, 0
    s_mov_b32 s38, 1048576
    buffer_load_dwordx4 v185, s[20:23], s38 offen lds
    s_add_u32 m0, s33, 1024
    s_mov_b32 s38, 1114112
    buffer_load_dwordx4 v185, s[20:23], s38 offen lds
    s_waitcnt vmcnt(28)
    ds_read_b64_tr_b16 a[144:145], v186 offset:4096
    ds_read_b64_tr_b16 a[146:147], v186 offset:4352
    ds_read_b64_tr_b16 a[152:153], v186 offset:4128
    ds_read_b64_tr_b16 a[154:155], v186 offset:4384
    s_waitcnt lgkmcnt(4)
    s_add_u32 m0, s33, 2048
    s_mov_b32 s38, 1179648
    buffer_load_dwordx4 v185, s[20:23], s38 offen lds
    s_add_u32 m0, s33, 3072
    s_mov_b32 s38, 1245184
    buffer_load_dwordx4 v185, s[20:23], s38 offen lds
    s_waitcnt vmcnt(28)
    ds_read_b64_tr_b16 a[160:161], v186 offset:6144
    ds_read_b64_tr_b16 a[162:163], v186 offset:6400
    ds_read_b64_tr_b16 a[168:169], v186 offset:6176
    ds_read_b64_tr_b16 a[170:171], v186 offset:6432
    s_waitcnt lgkmcnt(4)
    s_add_u32 m0, s33, 4096
    s_mov_b32 s38, 1310720
    buffer_load_dwordx4 v185, s[20:23], s38 offen lds
    s_add_u32 m0, s33, 5120
    s_mov_b32 s38, 1376256
    buffer_load_dwordx4 v185, s[20:23], s38 offen lds
    s_waitcnt vmcnt(28)
    ds_read_b64_tr_b16 a[176:177], v186 offset:8192
    ds_read_b64_tr_b16 a[178:179], v186 offset:8448
    ds_read_b64_tr_b16 a[184:185], v186 offset:8224
    ds_read_b64_tr_b16 a[186:187], v186 offset:8480
    s_waitcnt lgkmcnt(4)
    s_add_u32 m0, s33, 6144
    s_mov_b32 s38, 1441792
    buffer_load_dwordx4 v185, s[20:23], s38 offen lds
    s_add_u32 m0, s33, 7168
    s_mov_b32 s38, 1507328
    buffer_load_dwordx4 v185, s[20:23], s38 offen lds
    s_waitcnt vmcnt(28)
    ds_read_b64_tr_b16 a[148:149], v186 offset:10240
    ds_read_b64_tr_b16 a[150:151], v186 offset:10496
    ds_read_b64_tr_b16 a[156:157], v186 offset:10272
    ds_read_b64_tr_b16 a[158:159], v186 offset:10528
    s_waitcnt lgkmcnt(4)
    s_add_u32 m0, s33, 8192
    s_mov_b32 s38, 1572864
    buffer_load_dwordx4 v185, s[20:23], s38 offen lds
    s_add_u32 m0, s33, 9216
    s_mov_b32 s38, 1638400
    buffer_load_dwordx4 v185, s[20:23], s38 offen lds
    s_waitcnt vmcnt(28)
    ds_read_b64_tr_b16 a[164:165], v186 offset:12288
    ds_read_b64_tr_b16 a[166:167], v186 offset:12544
    ds_read_b64_tr_b16 a[172:173], v186 offset:12320
    ds_read_b64_tr_b16 a[174:175], v186 offset:12576
    s_waitcnt lgkmcnt(4)
    s_add_u32 m0, s33, 10240
    s_mov_b32 s38, 1703936
    buffer_load_dwordx4 v185, s[20:23], s38 offen lds
    s_add_u32 m0, s33, 11264
    s_mov_b32 s38, 1769472
    buffer_load_dwordx4 v185, s[20:23], s38 offen lds
    s_waitcnt vmcnt(28)
    ds_read_b64_tr_b16 a[180:181], v186 offset:14336
    ds_read_b64_tr_b16 a[182:183], v186 offset:14592
    ds_read_b64_tr_b16 a[188:189], v186 offset:14368
    ds_read_b64_tr_b16 a[190:191], v186 offset:14624
    s_waitcnt lgkmcnt(4)
    s_add_u32 m0, s33, 12288
    s_mov_b32 s38, 1835008
    buffer_load_dwordx4 v185, s[20:23], s38 offen lds
    s_add_u32 m0, s33, 13312
    s_mov_b32 s38, 1900544
    buffer_load_dwordx4 v185, s[20:23], s38 offen lds
    s_waitcnt vmcnt(28)
    ds_read_b64_tr_b16 a[192:193], v187 offset:16384
    ds_read_b64_tr_b16 a[194:195], v187 offset:16512
    ds_read_b64_tr_b16 a[196:197], v187 offset:17408
    ds_read_b64_tr_b16 a[198:199], v187 offset:17536
    s_waitcnt lgkmcnt(4)
    s_add_u32 m0, s33, 14336
    s_mov_b32 s38, 1966080
    buffer_load_dwordx4 v185, s[20:23], s38 offen lds
    s_add_u32 m0, s33, 15360
    s_mov_b32 s38, 2031616
    buffer_load_dwordx4 v185, s[20:23], s38 offen lds
    s_waitcnt vmcnt(28)
    ds_read_b64_tr_b16 a[200:201], v187 offset:18432
    ds_read_b64_tr_b16 a[202:203], v187 offset:18560
    ds_read_b64_tr_b16 a[204:205], v187 offset:19456
    ds_read_b64_tr_b16 a[206:207], v187 offset:19584
    s_waitcnt vmcnt(26)
    s_cmp_lg_u32 s31, 0
    s_cbranch_scc1 rec_rdy_5
    v_mov_b32 v2, 0
    v_mov_b32 v3, 1
    s_mov_b64 exec, 1
    global_atomic_add v2, v3, s[92:93] offset:128 sc1
    s_mov_b64 exec, -1
rec_rdy_5:
    ds_read_b64_tr_b16 a[208:209], v187 offset:20480
    ds_read_b64_tr_b16 a[210:211], v187 offset:20608
    ds_read_b64_tr_b16 a[212:213], v187 offset:21504
    ds_read_b64_tr_b16 a[214:215], v187 offset:21632
    s_waitcnt vmcnt(24)
    ds_read_b64_tr_b16 a[216:217], v187 offset:22528
    ds_read_b64_tr_b16 a[218:219], v187 offset:22656
    ds_read_b64_tr_b16 a[220:221], v187 offset:23552
    ds_read_b64_tr_b16 a[222:223], v187 offset:23680
    s_waitcnt vmcnt(22)
    ds_read_b64_tr_b16 a[224:225], v187 offset:24576
    ds_read_b64_tr_b16 a[226:227], v187 offset:24704
    ds_read_b64_tr_b16 a[228:229], v187 offset:25600
    ds_read_b64_tr_b16 a[230:231], v187 offset:25728
    s_waitcnt vmcnt(20)
    ds_read_b64_tr_b16 a[232:233], v187 offset:26624
    ds_read_b64_tr_b16 a[234:235], v187 offset:26752
    ds_read_b64_tr_b16 a[236:237], v187 offset:27648
    ds_read_b64_tr_b16 a[238:239], v187 offset:27776
    s_waitcnt vmcnt(18)
    ds_read_b64_tr_b16 a[240:241], v187 offset:28672
    ds_read_b64_tr_b16 a[242:243], v187 offset:28800
    ds_read_b64_tr_b16 a[244:245], v187 offset:29696
    ds_read_b64_tr_b16 a[246:247], v187 offset:29824
    s_waitcnt vmcnt(16)
    ds_read_b64_tr_b16 a[248:249], v187 offset:30720
    ds_read_b64_tr_b16 a[250:251], v187 offset:30848
    ds_read_b64_tr_b16 a[252:253], v187 offset:31744
    ds_read_b64_tr_b16 a[254:255], v187 offset:31872
    s_waitcnt vmcnt(14)
    ds_read_b64_tr_b16 v[192:193], v187 offset:0
    ds_read_b64_tr_b16 v[194:195], v187 offset:128
    ds_read_b64_tr_b16 v[196:197], v187 offset:1024
    ds_read_b64_tr_b16 v[198:199], v187 offset:1152
    s_waitcnt vmcnt(12)
    ds_read_b64_tr_b16 v[200:201], v187 offset:2048
    ds_read_b64_tr_b16 v[202:203], v187 offset:2176
    ds_read_b64_tr_b16 v[204:205], v187 offset:3072
    ds_read_b64_tr_b16 v[206:207], v187 offset:3200
    s_waitcnt vmcnt(10)
    ds_read_b64_tr_b16 v[208:209], v187 offset:4096
    ds_read_b64_tr_b16 v[210:211], v187 offset:4224
    ds_read_b64_tr_b16 v[212:213], v187 offset:5120
    ds_read_b64_tr_b16 v[214:215], v187 offset:5248
    s_waitcnt vmcnt(8)
    ds_read_b64_tr_b16 v[216:217], v187 offset:6144
    ds_read_b64_tr_b16 v[218:219], v187 offset:6272
    ds_read_b64_tr_b16 v[220:221], v187 offset:7168
    ds_read_b64_tr_b16 v[222:223], v187 offset:7296
    s_waitcnt vmcnt(6)
    ds_read_b64_tr_b16 v[224:225], v187 offset:8192
    ds_read_b64_tr_b16 v[226:227], v187 offset:8320
    ds_read_b64_tr_b16 v[228:229], v187 offset:9216
    ds_read_b64_tr_b16 v[230:231], v187 offset:9344
    s_waitcnt vmcnt(4)
    ds_read_b64_tr_b16 v[232:233], v187 offset:10240
    ds_read_b64_tr_b16 v[234:235], v187 offset:10368
    ds_read_b64_tr_b16 v[236:237], v187 offset:11264
    ds_read_b64_tr_b16 v[238:239], v187 offset:11392
    s_waitcnt vmcnt(2)
    ds_read_b64_tr_b16 v[240:241], v187 offset:12288
    ds_read_b64_tr_b16 v[242:243], v187 offset:12416
    ds_read_b64_tr_b16 v[244:245], v187 offset:13312
    ds_read_b64_tr_b16 v[246:247], v187 offset:13440
    s_waitcnt vmcnt(0)
    ds_read_b64_tr_b16 v[248:249], v187 offset:14336
    ds_read_b64_tr_b16 v[250:251], v187 offset:14464
    ds_read_b64_tr_b16 v[252:253], v187 offset:15360
    ds_read_b64_tr_b16 v[254:255], v187 offset:15488
    s_waitcnt lgkmcnt(0)
    v_max_u32 v36, 1, v36
    v_max_u32 v37, 1, v37
    v_max_u32 v38, 1, v38
    v_max_u32 v39, 1, v39
    v_max_u32 v40, 1, v40
    v_max_u32 v41, 1, v41
    v_max_u32 v42, 1, v42
    v_max_u32 v43, 1, v43
    v_max_u32 v44, 1, v44
    v_max_u32 v45, 1, v45
    v_max_u32 v46, 1, v46
    v_max_u32 v47, 1, v47
    v_max_u32 v48, 1, v48
    v_max_u32 v49, 1, v49
    v_max_u32 v50, 1, v50
    v_max_u32 v51, 1, v51
    v_mov_b32 v68, 0
    v_mov_b32 v69, 0
    v_mov_b32 v70, 0
    v_mov_b32 v71, 0
    v_mov_b32 v72, 0
    v_mov_b32 v73, 0
    v_mov_b32 v74, 0
    v_mov_b32 v75, 0
    v_mov_b32 v76, 0
    v_mov_b32 v77, 0
    v_mov_b32 v78, 0
    v_mov_b32 v79, 0
    v_mov_b32 v80, 0
    v_mov_b32 v81, 0
    v_mov_b32 v82, 0
    v_mov_b32 v83, 0
    v_mov_b32 v84, 0
    v_mov_b32 v85, 0
    v_mov_b32 v86, 0
    v_mov_b32 v87, 0
    v_mov_b32 v88, 0
    v_mov_b32 v89, 0
    v_mov_b32 v90, 0
    v_mov_b32 v91, 0
    s_mov_b32 s72, 0
    s_mov_b32 s73, 0
    s_mov_b32 s74, 0
    s_mov_b32 s75, 0
    s_mov_b32 s76, 0
    s_mov_b32 s77, 0
    s_mov_b32 s78, 0
    s_mov_b32 s79, 0
    s_mov_b32 s80, 0
    s_mov_b32 s81, 0
    s_mov_b32 s82, 0
    s_mov_b32 s83, 0
    s_mov_b32 s84, 0
    s_mov_b32 s85, 0
    s_mov_b32 s86, 0
    s_mov_b32 s87, 0
    v_mov_b32 v2, 0
    s_branch rec_ibq_8
rec_ibp_7:
    s_sleep 16
rec_ibq_8:
    global_load_dword v3, v2, s[92:93] offset:0 sc1
    s_add_u32 s41, s41, 1
    s_cmp_ge_u32 s41, 0x80000
    s_cbranch_scc1 rec_ib_6
    s_waitcnt vmcnt(0)
    v_readfirstlane_b32 s38, v3
    s_and_b32 s39, s38, 0xffff
    s_cmp_lt_u32 s39, 256
    s_cbranch_scc1 rec_ibp_7
rec_ib_6:
    s_cmp_ge_u32 s38, 4194304
    s_cselect_b32 s48, -1, 0
    s_xor_b32 s48, s48, 0xaaa
    s_and_b32 s33, s48, 1
    s_lshl_b32 s33, s33, 13
    s_add_u32 s33, s33, s49
    s_add_u32 s34, s33, 262144
    s_add_u32 s35, s33, 524288
    s_lshr_b32 s38, s28, 5
    s_lshl_b32 s38, s38, 4
    s_lshl_b32 s40, s30, 14
    s_add_u32 s38, s38, s40
    s_add_u32 s38, s38, s33
    s_add_u32 s38, s38, 163840
    v_and_b32 v132, 31, v1
    v_lshlrev_b32 v132, 8, v132
    v_add_u32 v132, s38, v132
    s_and_b32 s39, s29, 23
    s_cmp_eq_u32 s39, 3
    s_mov_b32 vcc_hi, 0
    s_cselect_b32 vcc_lo, -1, 0
    v_mov_b32 v4, 2130706432
    v_cndmask_b32 v132, v4, v132, vcc
    v_add_u32 v133, 128, v132
    s_and_b32 s39, s29, 31
    s_cmp_eq_u32 s39, 3
    s_cselect_b32 s39, s31, 99
    s_cmp_eq_u32 s39, 1
    s_cselect_b64 vcc, -1, 0
    v_mov_b32 v4, 2130706432
    v_cndmask_b32 v133, v4, v133, vcc
    s_lshr_b32 s55, s28, 5
    s_lshl_b32 s55, s55, 14
    s_and_b32 s40, s28, 31
    s_lshl_b32 s40, s40, 8
    s_add_u32 s55, s55, s40
    s_add_u32 s55, s55, s33
    s_add_u32 s55, s55, 163840
    s_add_u32 s44, s55, 128
    v_mov_b32 v26, 2130706432
    s_mov_b32 s98, 0
    s_mov_b32 s99, 0
    s_mov_b32 s88, 88080384
    s_mov_b32 s89, 65536
    v_mov_b32 v188, 0
    v_mov_b32 v189, 0
    v_mov_b32 v190, 0
    v_mov_b32 v191, 0
    s_cmp_eq_u32 s31, 1
    s_cbranch_scc1 rec_gs1_10
    s_cmp_eq_u32 s31, 2
    s_cbranch_scc1 rec_gs2_11
    s_cmp_eq_u32 s31, 3
    s_cbranch_scc1 rec_gs3_12
    v_mov_b32 v93, v19
    v_mov_b32 v180, -1
    v_mov_b32 v181, -1
    v_mov_b32 v182, -1
    v_mov_b32 v183, -1
    s_mov_b32 s88, 97255424
    s_mov_b32 s89, 262144
    s_branch rec_gs_9
rec_gs1_10:
    v_mov_b32 v26, v19
    s_mov_b64 vcc, 0xffff
    v_mov_b32 v4, 2130706432
    v_cndmask_b32 v26, v4, v26, vcc
    v_mov_b32 v188, -1
    v_mov_b32 v189, -1
    v_mov_b32 v190, -1
    v_mov_b32 v191, -1
    s_mov_b32 s98, 97256448
    s_mov_b32 s99, 262144
    s_branch rec_gs_9
rec_gs2_11:
    v_mov_b32 v26, v137
    s_branch rec_gs_9
rec_gs3_12:
    s_lshr_b32 s38, s29, 3
    s_lshl_b32 s38, s38, 14
    s_and_b32 s40, s29, 7
    s_lshl_b32 s40, s40, 10
    s_add_u32 s38, s38, s40
    s_and_b32 s40, s30, 1
    s_lshl_b32 s40, s40, 9
    s_add_u32 s38, s38, s40
    s_lshr_b32 s40, s30, 1
    s_lshl_b32 s40, s40, 7
    s_add_u32 s38, s38, s40
    v_bfe_u32 v2, v1, 4, 1
    v_lshlrev_b32 v2, 16, v2
    v_bfe_u32 v4, v1, 3, 1
    v_lshl_add_u32 v2, v4, 8, v2
    v_and_b32 v4, 7, v1
    v_lshl_add_u32 v2, v4, 4, v2
    v_add_u32 v2, s38, v2
    s_mov_b32 vcc_lo, 0
    s_mov_b32 vcc_hi, -1
    v_cndmask_b32 v93, v93, v2, vcc
    s_mov_b32 s88, s35
rec_gs_9:
    s_cmp_eq_u32 s31, 2
    s_cselect_b32 s45, 1, 0
    s_barrier
    s_load_dwordx16 s[72:87], s[90:91], s97 offset:64 glc
    s_waitcnt lgkmcnt(0)
    s_xor_b32 s76, s76, s72
    s_xor_b32 s80, s80, s72
    s_xor_b32 s84, s84, s72
    s_or_b32 s76, s76, s80
    s_or_b32 s96, s76, s84
    s_mov_b32 s72, 0
    s_mov_b32 s73, 0
    s_mov_b32 s74, 0
    s_mov_b32 s75, 0
    s_mov_b32 s76, 0
    s_mov_b32 s77, 0
    s_mov_b32 s78, 0
    s_mov_b32 s79, 0
    s_mov_b32 s80, 0
    s_mov_b32 s81, 0
    s_mov_b32 s82, 0
    s_mov_b32 s83, 0
    s_mov_b32 s84, 0
    s_mov_b32 s85, 0
    s_mov_b32 s86, 0
    s_mov_b32 s87, 0
    s_cmp_gt_u32 s94, 0
    s_cbranch_scc0 rec_kv_13
rec_kvd_14:
    s_add_u32 m0, s51, s3
    s_nop 0
    buffer_load_dwordx4 v30, s[4:7], s37 offen sc1 lds
    s_waitcnt vmcnt(0)
    s_barrier
    s_branch rec_entry_15
rec_loop_16:
    s_barrier
    buffer_load_dwordx4 v[36:39], v7, s[4:7], s33 offen offset:0 sc1
    s_nop 3
    buffer_load_dwordx4 v[40:43], v7, s[4:7], s33 offen offset:1024 sc1
    s_nop 3
    buffer_load_dwordx4 v[44:47], v7, s[4:7], s33 offen offset:2048 sc1
    s_nop 3
    buffer_load_dwordx4 v[48:51], v7, s[4:7], s33 offen offset:3072 sc1
rec_entry_15:
    v_add_u32 v2, s51, v16
    ds_read_b128 v[60:63], v2 offset:0
    ds_read_b128 v[64:67], v2 offset:1024
    ds_read_b128 v[52:55], v2 offset:2048
    ds_read_b128 v[56:59], v2 offset:3072
    s_waitcnt vmcnt(3)
    v_smfmac_f32_16x16x64_bf16 v[68:71], v[36:39], a[0:7], v5
    v_min_u32 v31, v36, v37
    v_smfmac_f32_16x16x64_bf16 v[72:75], v[36:39], a[8:15], v5
    v_min_u32 v4, v38, v39
    v_smfmac_f32_16x16x64_bf16 v[76:79], v[36:39], a[16:23], v5
    v_smfmac_f32_16x16x64_bf16 v[80:83], v[36:39], a[24:31], v5
    s_waitcnt vmcnt(2)
    v_smfmac_f32_16x16x64_bf16 v[68:71], v[40:43], a[48:55], v5
    v_min3_u32 v31, v31, v40, v41
    v_smfmac_f32_16x16x64_bf16 v[72:75], v[40:43], a[56:63], v5
    v_min3_u32 v4, v4, v42, v43
    v_smfmac_f32_16x16x64_bf16 v[76:79], v[40:43], a[64:71], v5
    v_smfmac_f32_16x16x64_bf16 v[80:83], v[40:43], a[72:79], v5
    s_waitcnt vmcnt(1)
    v_smfmac_f32_16x16x64_bf16 v[68:71], v[44:47], a[96:103], v5
    v_min3_u32 v31, v31, v44, v45
    v_smfmac_f32_16x16x64_bf16 v[72:75], v[44:47], a[104:111], v5
    v_min3_u32 v4, v4, v46, v47
    v_smfmac_f32_16x16x64_bf16 v[76:79], v[44:47], a[112:119], v5
    v_min_u32 v31, v31, v4
    v_smfmac_f32_16x16x64_bf16 v[80:83], v[44:47], a[120:127], v5
    s_waitcnt vmcnt(0)
    v_min3_u32 v31, v31, v48, v49
    v_smfmac_f32_16x16x64_bf16 v[68:71], v[48:51], a[144:151], v5
    v_min3_u32 v31, v31, v50, v51
    v_smfmac_f32_16x16x64_bf16 v[72:75], v[48:51], a[152:159], v5
    v_cmp_eq_u32 vcc, 0, v31
    v_smfmac_f32_16x16x64_bf16 v[76:79], v[48:51], a[160:167], v5
    v_smfmac_f32_16x16x64_bf16 v[80:83], v[48:51], a[168:175], v5
    s_cbranch_vccnz rec_gafix_19
rec_gaok_18:
    s_nop 1
    v_pk_add_f32 v[68:69], v[68:69], v[70:71]
    s_nop 0
    v_pk_add_f32 v[70:71], v[72:73], v[74:75]
    ds_write2_b32 v14, v68, v69 offset0:0 offset1:40
    ds_write2_b32 v14, v70, v71 offset0:16 offset1:56
    v_pk_add_f32 v[76:77], v[76:77], v[78:79]
    v_pk_add_f32 v[78:79], v[80:81], v[82:83]
    ds_write2_b32 v15, v76, v77 offset0:0 offset1:40
    ds_write2_b32 v15, v78, v79 offset0:16 offset1:56
    s_cmp_lg_u32 s31, 0
    s_cbranch_scc1 rec_w1_21
    s_waitcnt lgkmcnt(0)
    s_barrier
    ds_read_b128 v[100:103], v18 offset:0
    v_smfmac_f32_16x16x64_bf16 v[84:87], v[36:39], a[32:39], v5
    ds_read_b128 v[104:107], v18 offset:32
    v_smfmac_f32_16x16x64_bf16 v[88:91], v[36:39], a[40:47], v5
    ds_read_b128 v[108:111], v18 offset:2560
    v_smfmac_f32_16x16x64_bf16 v[84:87], v[40:43], a[80:87], v5
    ds_read_b128 v[112:115], v18 offset:2592
    v_smfmac_f32_16x16x64_bf16 v[88:91], v[40:43], a[88:95], v5
    ds_read_b128 v[116:119], v18 offset:5120
    v_smfmac_f32_16x16x64_bf16 v[84:87], v[44:47], a[128:135], v5
    ds_read_b128 v[120:123], v18 offset:5152
    v_smfmac_f32_16x16x64_bf16 v[88:91], v[44:47], a[136:143], v5
    ds_read_b128 v[124:127], v18 offset:7680
    v_smfmac_f32_16x16x64_bf16 v[84:87], v[48:51], a[176:183], v5
    ds_read_b128 v[128:131], v18 offset:7712
    v_smfmac_f32_16x16x64_bf16 v[88:91], v[48:51], a[184:191], v5
    s_waitcnt lgkmcnt(4)
    v_pk_add_f32 v[100:101], v[100:101], v[108:109]
    v_pk_add_f32 v[102:103], v[102:103], v[110:111]
    v_pk_add_f32 v[104:105], v[104:105], v[112:113]
    v_pk_add_f32 v[106:107], v[106:107], v[114:115]
    s_waitcnt lgkmcnt(2)
    v_pk_add_f32 v[100:101], v[100:101], v[116:117]
    v_pk_add_f32 v[102:103], v[102:103], v[118:119]
    v_pk_add_f32 v[104:105], v[104:105], v[120:121]
    v_pk_add_f32 v[106:107], v[106:107], v[122:123]
    s_waitcnt lgkmcnt(0)
    v_pk_add_f32 v[100:101], v[100:101], v[124:125]
    v_pk_add_f32 v[102:103], v[102:103], v[126:127]
    v_pk_add_f32 v[104:105], v[104:105], v[128:129]
    v_pk_add_f32 v[106:107], v[106:107], v[130:131]
    v_cvt_pk_bf16_f32 v96, v100, v101
    v_cvt_pk_bf16_f32 v97, v102, v103
    v_cvt_pk_bf16_f32 v98, v104, v105
    v_cvt_pk_bf16_f32 v99, v106, v107
    s_nop 1
    v_mfma_f32_16x16x32_bf16 v[68:71], v[60:63], v[96:99], 0
    v_mfma_f32_16x16x32_bf16 v[72:75], v[64:67], v[96:99], 0
    v_mfma_f32_16x16x32_bf16 v[76:79], v[96:99], v[96:99], 0
    s_cmp_lg_u32 s96, 0
    v_pk_add_f32 v[84:85], v[84:85], v[86:87]
    v_pk_add_f32 v[86:87], v[88:89], v[90:91]
    s_cbranch_scc1 rec_slow_22
    s_mov_b64 exec, s[42:43]
    s_nop 0
    buffer_store_dwordx4 v[68:71], v19, s[4:7], s36 offen
    buffer_store_dwordx4 v[72:75], v19, s[4:7], s36 offen offset:128
    s_mov_b64 exec, s[46:47]
    buffer_store_dwordx4 v[76:79], v20, s[4:7], s36 offen offset:1024
    s_mov_b64 exec, -1
rec_slowr_23:
    ds_write_b128 v17, v[84:87]
    ds_write_b128 v16, v[96:99] offset:15360
    s_waitcnt lgkmcnt(0)
    s_barrier
    ds_read_b64 v[100:101], v25 offset:0
    ds_read_b64 v[102:103], v25 offset:128
    ds_read_b64 v[104:105], v25 offset:1024
    ds_read_b64 v[106:107], v25 offset:1152
    ds_read_b64 v[108:109], v25 offset:2048
    ds_read_b64 v[110:111], v25 offset:2176
    ds_read_b64 v[112:113], v25 offset:3072
    ds_read_b64 v[114:115], v25 offset:3200
    v_mov_b32_dpp v68, v72 row_ror:8 row_mask:0xf bank_mask:0xc
    v_mov_b32_dpp v69, v73 row_ror:8 row_mask:0xf bank_mask:0xc
    v_mov_b32_dpp v70, v74 row_ror:8 row_mask:0xf bank_mask:0xc
    v_mov_b32_dpp v71, v75 row_ror:8 row_mask:0xf bank_mask:0xc
    buffer_load_dwordx4 v[176:179], v21, s[4:7], s36 offen offset:1024 sc1
    buffer_load_dwordx4 v[164:167], v22, s[4:7], s36 offen sc1
    buffer_load_dwordx4 v[168:171], v23, s[4:7], s36 offen sc1
    buffer_load_dwordx4 v[172:175], v24, s[4:7], s36 offen sc1
    s_waitcnt lgkmcnt(0)
    v_pk_add_f32 v[100:101], v[100:101], v[104:105]
    v_pk_add_f32 v[102:103], v[102:103], v[106:107]
    v_pk_add_f32 v[108:109], v[108:109], v[112:113]
    v_pk_add_f32 v[110:111], v[110:111], v[114:115]
    v_pk_add_f32 v[100:101], v[100:101], v[108:109]
    v_pk_add_f32 v[102:103], v[102:103], v[110:111]
    v_cvt_pk_bf16_f32 v138, v100, v101
    v_cvt_pk_bf16_f32 v140, v102, v103
    s_nop 15
    buffer_load_dwordx4 v[48:51], v21, s[4:7], s36 offen offset:1024 sc1
    buffer_load_dwordx4 v[36:39], v22, s[4:7], s36 offen sc1
    buffer_load_dwordx4 v[40:43], v23, s[4:7], s36 offen sc1
    buffer_load_dwordx4 v[44:47], v24, s[4:7], s36 offen sc1
    s_cmp_eq_u32 s32, 63
    s_cbranch_scc1 rec_b2_20
    s_waitcnt vmcnt(7)
    v_permlane32_swap_b32 v176, v178
    v_permlane32_swap_b32 v177, v179
    v_pk_add_f32 v[124:125], v[176:177], v[178:179]
    s_waitcnt vmcnt(6)
    v_pk_add_f32 v[120:121], v[68:69], v[164:165]
    v_pk_add_f32 v[122:123], v[70:71], v[166:167]
    v_permlane16_swap_b32 v124, v125
    s_waitcnt vmcnt(5)
    v_pk_add_f32 v[120:121], v[120:121], v[168:169]
    v_pk_add_f32 v[122:123], v[122:123], v[170:171]
    v_add_f32 v124, v124, v125
    s_waitcnt vmcnt(4)
    v_pk_add_f32 v[120:121], v[120:121], v[172:173]
    v_pk_add_f32 v[122:123], v[122:123], v[174:175]
    v_maximum3_f32 v135, v120, v121, v124
    v_maximum3_f32 v135, v135, v122, v123
    v_cmp_u_f32 vcc, v135, v135
    s_nop 0
    v_max_f32_dpp v135, v135, v135 row_ror:8 row_mask:0xf bank_mask:0xf
    v_mov_b32 v136, v135
    s_cbranch_vccnz rec_gbr_24
rec_gbo_25:
    buffer_store_dword v134, v132, s[4:7], 0 offen sc1
    v_permlane16_swap_b32 v135, v136
    v_max_f32 v135, v135, v136
    v_mov_b32 v136, v135
    s_nop 1
    v_permlane32_swap_b32 v135, v136
    v_max_f32 v135, v135, v136
    v_mul_f32 v135, s50, v135
    v_fma_f32 v124, v124, s50, -v135
    v_fma_f32 v120, v120, s50, -v135
    v_fma_f32 v121, v121, s50, -v135
    v_fma_f32 v122, v122, s50, -v135
    v_fma_f32 v123, v123, s50, -v135
    v_exp_f32 v124, v124
    v_exp_f32 v120, v120
    v_exp_f32 v121, v121
    v_exp_f32 v122, v122
    v_exp_f32 v123, v123
    v_mov_b32_dpp v125, v124 row_ror:8 row_mask:0xf bank_mask:0xf
    v_cvt_pk_bf16_f32 v156, v120, v121
    v_cvt_pk_bf16_f32 v157, v122, v123
    v_cvt_pk_bf16_f32 v160, v124, v125
    v_mov_b32_dpp v158, v156 row_ror:8 row_mask:0xf bank_mask:0xf
    v_mov_b32_dpp v159, v157 row_ror:8 row_mask:0xf bank_mask:0xf
    v_mfma_f32_16x16x32_bf16 v[116:119], v[32:35], v[160:163], 0
    s_nop 0
    v_mfma_f32_16x16x32_bf16 v[116:119], v[32:35], v[156:159], v[116:119]
    v_mfma_f32_16x16x32_bf16 v[108:111], v[52:55], v[156:159], 0
    v_mfma_f32_16x16x32_bf16 v[108:111], v[138:141], v[160:163], v[108:111]
    v_mfma_f32_16x16x32_bf16 v[112:115], v[56:59], v[156:159], 0
    v_mfma_f32_16x16x32_bf16 v[112:115], v[140:143], v[160:163], v[112:115]
    s_nop 3
    v_rcp_f32 v100, v116
    s_nop 0
    v_mov_b32 v101, v100
    v_pk_mul_f32 v[108:109], v[108:109], v[100:101]
    v_pk_mul_f32 v[110:111], v[110:111], v[100:101]
    v_pk_mul_f32 v[112:113], v[112:113], v[100:101]
    v_pk_mul_f32 v[114:115], v[114:115], v[100:101]
    v_cvt_pk_bf16_f32 v108, v108, v109
    v_cvt_pk_bf16_f32 v109, v110, v111
    v_cvt_pk_bf16_f32 v110, v112, v113
    v_cvt_pk_bf16_f32 v111, v114, v115
    v_max_u32 v108, 1, v108
    v_max_u32 v109, 1, v109
    v_max_u32 v110, 1, v110
    v_max_u32 v111, 1, v111
    s_mov_b64 exec, s[42:43]
    buffer_store_dwordx4 v[108:111], v27, s[4:7], s33 offen sc1
    s_mov_b64 exec, -1
    v_mov_b64 v[68:69], 0
    v_mov_b64 v[70:71], 0
    v_mov_b64 v[72:73], 0
    v_mov_b64 v[74:75], 0
    v_mov_b64 v[76:77], 0
    v_mov_b64 v[78:79], 0
    v_mov_b64 v[80:81], 0
    v_mov_b64 v[82:83], 0
    v_mov_b64 v[84:85], 0
    v_mov_b64 v[86:87], 0
    v_mov_b64 v[88:89], 0
    v_mov_b64 v[90:91], 0
rec_cs_27:
    s_barrier
    buffer_load_dwordx4 v[36:39], v12, s[4:7], s33 offen offset:0 sc1
    s_nop 3
    buffer_load_dwordx4 v[40:43], v12, s[4:7], s33 offen offset:1024 sc1
    s_nop 3
    buffer_load_dwordx4 v[44:47], v12, s[4:7], s33 offen offset:2048 sc1
    s_nop 3
    buffer_load_dwordx4 v[48:51], v12, s[4:7], s33 offen offset:3072 sc1
    s_nop 3
    buffer_load_dwordx4 v[52:55], v13, s[4:7], s33 offen offset:0 sc1
    s_nop 3
    buffer_load_dwordx4 v[56:59], v13, s[4:7], s33 offen offset:1024 sc1
    s_nop 3
    buffer_load_dwordx4 v[60:63], v13, s[4:7], s33 offen offset:2048 sc1
    s_nop 3
    buffer_load_dwordx4 v[64:67], v13, s[4:7], s33 offen offset:3072 sc1
    s_waitcnt vmcnt(7)
    v_smfmac_f32_16x16x64_bf16 v[68:71], v[36:39], a[192:199], v5
    v_min_u32 v31, v36, v37
    v_smfmac_f32_16x16x64_bf16 v[72:75], v[36:39], a[200:207], v5
    v_min_u32 v4, v38, v39
    s_add_u32 s38, s32, 1
    s_cmp_gt_u32 s94, s38
    s_cbranch_scc0 rec_kv_30
rec_kvd_31:
    s_xor_b32 s51, s51, 4096
    s_add_u32 m0, s51, s3
    s_add_u32 s37, s37, 262144
    buffer_load_dwordx4 v30, s[4:7], s37 offen sc1 lds
    s_waitcnt vmcnt(7)
    v_smfmac_f32_16x16x64_bf16 v[68:71], v[40:43], a[208:215], v5
    v_min3_u32 v31, v31, v40, v41
    v_smfmac_f32_16x16x64_bf16 v[72:75], v[40:43], a[216:223], v5
    v_min3_u32 v4, v4, v42, v43
    buffer_load_dword v3, v92, s[4:7], s36 offen sc1
    s_waitcnt vmcnt(7)
    v_smfmac_f32_16x16x64_bf16 v[68:71], v[44:47], a[224:231], v5
    v_min3_u32 v31, v31, v44, v45
    v_smfmac_f32_16x16x64_bf16 v[72:75], v[44:47], a[232:239], v5
    v_min3_u32 v4, v4, v46, v47
    s_waitcnt vmcnt(6)
    v_smfmac_f32_16x16x64_bf16 v[68:71], v[48:51], a[240:247], v5
    v_min3_u32 v31, v31, v48, v49
    v_smfmac_f32_16x16x64_bf16 v[72:75], v[48:51], a[248:255], v5
    v_min3_u32 v4, v4, v50, v51
    s_waitcnt vmcnt(5)
    v_smfmac_f32_16x16x64_bf16 v[68:71], v[52:55], v[192:199], v5
    v_min3_u32 v31, v31, v52, v53
    v_smfmac_f32_16x16x64_bf16 v[72:75], v[52:55], v[200:207], v5
    v_min3_u32 v4, v4, v54, v55
    s_waitcnt vmcnt(4)
    v_smfmac_f32_16x16x64_bf16 v[68:71], v[56:59], v[208:215], v5
    v_min3_u32 v31, v31, v56, v57
    v_smfmac_f32_16x16x64_bf16 v[72:75], v[56:59], v[216:223], v5
    v_min3_u32 v4, v4, v58, v59
    s_waitcnt vmcnt(3)
    v_smfmac_f32_16x16x64_bf16 v[68:71], v[60:63], v[224:231], v5
    v_min3_u32 v31, v31, v60, v61
    v_smfmac_f32_16x16x64_bf16 v[72:75], v[60:63], v[232:239], v5
    v_min3_u32 v4, v4, v62, v63
    v_min_u32 v31, v31, v4
    s_waitcnt vmcnt(2)
    v_min3_u32 v31, v31, v64, v65
    v_smfmac_f32_16x16x64_bf16 v[68:71], v[64:67], v[240:247], v5
    v_min3_u32 v31, v31, v66, v67
    v_smfmac_f32_16x16x64_bf16 v[72:75], v[64:67], v[248:255], v5
    v_cmp_eq_u32 vcc, 0, v31
    s_add_u32 s32, s32, 1
    s_add_u32 s38, s32, 2
    s_lshr_b32 s39, s38, 3
    s_lshr_b32 s39, s48, s39
    s_cbranch_vccnz rec_gcfix_29
rec_gcok_28:
    s_mov_b32 s33, s34
    s_mov_b32 s34, s35
    s_nop 0
    v_pk_add_f32 v[68:69], v[68:69], v[70:71]
    s_nop 1
    v_add_f32_dpp v68, v72, v74 quad_perm:[0,1,2,3] row_mask:0xc bank_mask:0xf
    v_add_f32_dpp v69, v73, v75 quad_perm:[0,1,2,3] row_mask:0xc bank_mask:0xf
    s_nop 1
    v_permlane32_swap_b32 v68, v69
    v_add_f32 v68, v68, v69
    ds_write_b32 v28, v68
    s_and_b32 s35, s39, 1
    s_lshl_b32 s35, s35, 13
    s_lshl_b32 s40, s38, 18
    s_add_u32 s35, s35, s40
    s_add_u32 s35, s35, s49
    s_add_u32 s36, s36, 262144
    s_cmp_lg_u32 s31, 0
    s_cbranch_scc1 rec_b4_32
    s_waitcnt lgkmcnt(0)
    s_barrier
    ds_read_b64 v[100:101], v29 offset:0
    ds_read_b64 v[102:103], v29 offset:256
    ds_read_b64 v[104:105], v29 offset:512
    ds_read_b64 v[106:107], v29 offset:768
    v_add_u32 v134, 2, v134
    s_waitcnt lgkmcnt(0)
    v_pk_add_f32 v[100:101], v[100:101], v[102:103]
    v_pk_add_f32 v[104:105], v[104:105], v[106:107]
    v_pk_add_f32 v[100:101], v[100:101], v[104:105]
    v_cvt_pk_bf16_f32 v100, v100, v101
    v_max_u32 v100, 1, v100
    s_nop 1
    v_mov_b32_dpp v101, v100 quad_perm:[1,1,1,1] row_mask:0xf bank_mask:0xf
    v_mov_b32_dpp v102, v100 quad_perm:[2,2,2,2] row_mask:0xf bank_mask:0xf
    v_mov_b32_dpp v103, v100 quad_perm:[3,3,3,3] row_mask:0xf bank_mask:0xf
    s_mov_b64 exec, 0x11111111
    buffer_store_dwordx4 v[100:103], v6, s[4:7], s33 offen sc1
    s_mov_b64 exec, -1
    s_barrier
    buffer_store_dwordx4 v[180:183], v93, s[4:7], s88 offen sc1
    s_add_u32 s98, s98, s99
    s_add_u32 s38, s32, 3
    s_min_u32 s38, s38, 63
    s_cmp_gt_u32 s94, s38
    s_cbranch_scc1 rec_rf_33
    s_load_dword s94, s[90:91], s95 glc
rec_rf_33:
    s_add_u32 s88, s88, s89
    s_cmp_eq_u32 s31, 3
    s_cselect_b32 s88, s35, s88
    v_mov_b64 v[68:69], 0
    v_mov_b64 v[70:71], 0
    v_mov_b64 v[72:73], 0
    v_mov_b64 v[74:75], 0
    s_waitcnt vmcnt(2)
    s_branch rec_loop_16
rec_b4_32:
    s_waitcnt lgkmcnt(0)
    s_barrier
    buffer_store_dword v134, v133, s[4:7], 0 offen sc1
    s_cmp_eq_u32 s31, 3
    s_cbranch_scc1 rec_w3b_34
    v_add_u32 v134, 2, v134
    v_mov_b64 v[68:69], 0
    v_mov_b64 v[70:71], 0
    v_mov_b64 v[72:73], 0
    v_mov_b64 v[74:75], 0
    s_barrier
    buffer_store_dwordx4 v[180:183], v93, s[4:7], s88 offen sc1
    buffer_store_dwordx4 v[188:191], v26, s[4:7], s98 offen sc1
    s_add_u32 s98, s98, s99
    s_nop 0
    v_add_u32 v188, s45, v188
    s_add_u32 s38, s32, 3
    s_min_u32 s38, s38, 63
    s_cmp_gt_u32 s94, s38
    s_cbranch_scc1 rec_rf_35
    s_load_dword s94, s[90:91], s95 glc
rec_rf_35:
    s_add_u32 s88, s88, s89
    s_cmp_eq_u32 s31, 3
    s_cselect_b32 s88, s35, s88
    s_waitcnt vmcnt(2)
    s_branch rec_loop_16
rec_w3b_34:
    v_add_u32 v134, 2, v134
    v_mov_b64 v[68:69], 0
    v_mov_b64 v[70:71], 0
    v_mov_b64 v[72:73], 0
    v_mov_b64 v[74:75], 0
    s_load_dword s72, s[90:91], s44 glc
    s_barrier
    s_load_dword s72, s[90:91], s44 glc
    buffer_store_dwordx4 v[180:183], v93, s[4:7], s88 offen sc1
    s_add_u32 s98, s98, s99
    s_add_u32 s38, s32, 3
    s_min_u32 s38, s38, 63
    s_cmp_gt_u32 s94, s38
    s_cbranch_scc1 rec_rf_36
    s_load_dword s94, s[90:91], s95 glc
rec_rf_36:
    s_add_u32 s88, s88, s89
    s_cmp_eq_u32 s31, 3
    s_cselect_b32 s88, s35, s88
    s_load_dword s72, s[90:91], s44 glc
    s_waitcnt vmcnt(2)
    s_branch rec_tkc_39
rec_tk_37:
    s_load_dword s72, s[90:91], s44 glc
    s_add_u32 s41, s41, 1
    s_cmp_ge_u32 s41, 0x80000
    s_cbranch_scc1 rec_tkd_38
    s_sleep 1
rec_tkc_39:
    s_mov_b32 s38, s72
    s_cmp_lt_u32 s38, s54
    s_cbranch_scc1 rec_tk_37
rec_tkd_38:
    s_add_u32 s54, s54, 1
    s_sleep 1
    s_branch rec_loop_16
rec_kv_13:
    s_load_dword s94, s[90:91], s95 glc
    s_add_u32 s41, s41, 1
    s_cmp_ge_u32 s41, 0x80000
    s_cbranch_scc1 rec_kvd_14
    s_waitcnt lgkmcnt(0)
    s_cmp_gt_u32 s94, 0
    s_cbranch_scc1 rec_kvd_14
    s_sleep 2
    s_branch rec_kv_13
rec_gafix_19:
    s_add_u32 s41, s41, 1
    s_cmp_ge_u32 s41, 0x80000
    s_cbranch_scc1 rec_gaok_18
    buffer_load_dwordx4 v[36:39], v7, s[4:7], s33 offen offset:0 sc1
    buffer_load_dwordx4 v[40:43], v7, s[4:7], s33 offen offset:1024 sc1
    buffer_load_dwordx4 v[44:47], v7, s[4:7], s33 offen offset:2048 sc1
    buffer_load_dwordx4 v[48:51], v7, s[4:7], s33 offen offset:3072 sc1
    v_mov_b64 v[68:69], 0
    v_mov_b64 v[70:71], 0
    v_mov_b64 v[72:73], 0
    v_mov_b64 v[74:75], 0
    v_mov_b64 v[76:77], 0
    v_mov_b64 v[78:79], 0
    v_mov_b64 v[80:81], 0
    v_mov_b64 v[82:83], 0
    s_waitcnt vmcnt(3)
    v_smfmac_f32_16x16x64_bf16 v[68:71], v[36:39], a[0:7], v5
    v_min_u32 v31, v36, v37
    v_smfmac_f32_16x16x64_bf16 v[72:75], v[36:39], a[8:15], v5
    v_min_u32 v4, v38, v39
    v_smfmac_f32_16x16x64_bf16 v[76:79], v[36:39], a[16:23], v5
    v_smfmac_f32_16x16x64_bf16 v[80:83], v[36:39], a[24:31], v5
    s_waitcnt vmcnt(2)
    v_smfmac_f32_16x16x64_bf16 v[68:71], v[40:43], a[48:55], v5
    v_min3_u32 v31, v31, v40, v41
    v_smfmac_f32_16x16x64_bf16 v[72:75], v[40:43], a[56:63], v5
    v_min3_u32 v4, v4, v42, v43
    v_smfmac_f32_16x16x64_bf16 v[76:79], v[40:43], a[64:71], v5
    v_smfmac_f32_16x16x64_bf16 v[80:83], v[40:43], a[72:79], v5
    s_waitcnt vmcnt(1)
    v_smfmac_f32_16x16x64_bf16 v[68:71], v[44:47], a[96:103], v5
    v_min3_u32 v31, v31, v44, v45
    v_smfmac_f32_16x16x64_bf16 v[72:75], v[44:47], a[104:111], v5
    v_min3_u32 v4, v4, v46, v47
    v_smfmac_f32_16x16x64_bf16 v[76:79], v[44:47], a[112:119], v5
    v_min_u32 v31, v31, v4
    v_smfmac_f32_16x16x64_bf16 v[80:83], v[44:47], a[120:127], v5
    s_waitcnt vmcnt(0)
    v_min3_u32 v31, v31, v48, v49
    v_smfmac_f32_16x16x64_bf16 v[68:71], v[48:51], a[144:151], v5
    v_min3_u32 v31, v31, v50, v51
    v_smfmac_f32_16x16x64_bf16 v[72:75], v[48:51], a[152:159], v5
    v_cmp_eq_u32 vcc, 0, v31
    v_smfmac_f32_16x16x64_bf16 v[76:79], v[48:51], a[160:167], v5
    v_smfmac_f32_16x16x64_bf16 v[80:83], v[48:51], a[168:175], v5
    s_cbranch_vccnz rec_gafix_19
    s_branch rec_gaok_18
rec_slow_22:
    s_mov_b64 exec, s[42:43]
    s_nop 0
    buffer_store_dwordx4 v[68:71], v19, s[4:7], s36 offen sc1
    buffer_store_dwordx4 v[72:75], v19, s[4:7], s36 offen offset:128 sc1
    s_mov_b64 exec, s[46:47]
    buffer_store_dwordx4 v[76:79], v20, s[4:7], s36 offen offset:1024 sc1
    s_mov_b64 exec, -1
    s_branch rec_slowr_23
rec_gbr_24:
    v_max3_u32 v31, v164, v165, v166
    v_max3_u32 v31, v31, v167, v168
    v_max3_u32 v31, v31, v169, v170
    v_max3_u32 v31, v31, v171, v172
    v_max3_u32 v31, v31, v173, v174
    v_max3_u32 v31, v31, v175, v176
    v_max3_u32 v31, v31, v177, v178
    v_max_u32 v31, v31, v179
    buffer_load_dwordx4 v[176:179], v21, s[4:7], s36 offen offset:1024 sc1
    buffer_load_dwordx4 v[164:167], v22, s[4:7], s36 offen sc1
    buffer_load_dwordx4 v[168:171], v23, s[4:7], s36 offen sc1
    buffer_load_dwordx4 v[172:175], v24, s[4:7], s36 offen sc1
    v_cmp_eq_u32 vcc, -1, v31
    s_add_u32 s41, s41, 1
    s_cmp_ge_u32 s41, 0x80000
    s_cbranch_scc1 rec_gbo_25
    s_cbranch_vccz rec_gbo_25
    s_waitcnt vmcnt(7)
    v_permlane32_swap_b32 v48, v50
    v_permlane32_swap_b32 v49, v51
    v_pk_add_f32 v[124:125], v[48:49], v[50:51]
    s_waitcnt vmcnt(6)
    v_pk_add_f32 v[120:121], v[68:69], v[36:37]
    v_pk_add_f32 v[122:123], v[70:71], v[38:39]
    v_permlane16_swap_b32 v124, v125
    s_waitcnt vmcnt(5)
    v_pk_add_f32 v[120:121], v[120:121], v[40:41]
    v_pk_add_f32 v[122:123], v[122:123], v[42:43]
    v_add_f32 v124, v124, v125
    s_waitcnt vmcnt(4)
    v_pk_add_f32 v[120:121], v[120:121], v[44:45]
    v_pk_add_f32 v[122:123], v[122:123], v[46:47]
    v_maximum3_f32 v135, v120, v121, v124
    v_maximum3_f32 v135, v135, v122, v123
    v_cmp_u_f32 vcc, v135, v135
    s_nop 0
    v_max_f32_dpp v135, v135, v135 row_ror:8 row_mask:0xf bank_mask:0xf
    v_mov_b32 v136, v135
    s_cbranch_vccz rec_gbo_25
    v_max3_u32 v31, v36, v37, v38
    v_max3_u32 v31, v31, v39, v40
    v_max3_u32 v31, v31, v41, v42
    v_max3_u32 v31, v31, v43, v44
    v_max3_u32 v31, v31, v45, v46
    v_max3_u32 v31, v31, v47, v48
    v_max3_u32 v31, v31, v49, v50
    v_max_u32 v31, v31, v51
    buffer_load_dwordx4 v[48:51], v21, s[4:7], s36 offen offset:1024 sc1
    buffer_load_dwordx4 v[36:39], v22, s[4:7], s36 offen sc1
    buffer_load_dwordx4 v[40:43], v23, s[4:7], s36 offen sc1
    buffer_load_dwordx4 v[44:47], v24, s[4:7], s36 offen sc1
    v_cmp_eq_u32 vcc, -1, v31
    s_add_u32 s41, s41, 1
    s_cmp_ge_u32 s41, 0x80000
    s_cbranch_scc1 rec_gbo_25
    s_cbranch_vccz rec_gbo_25
    s_waitcnt vmcnt(7)
    v_permlane32_swap_b32 v176, v178
    v_permlane32_swap_b32 v177, v179
    v_pk_add_f32 v[124:125], v[176:177], v[178:179]
    s_waitcnt vmcnt(6)
    v_pk_add_f32 v[120:121], v[68:69], v[164:165]
    v_pk_add_f32 v[122:123], v[70:71], v[166:167]
    v_permlane16_swap_b32 v124, v125
    s_waitcnt vmcnt(5)
    v_pk_add_f32 v[120:121], v[120:121], v[168:169]
    v_pk_add_f32 v[122:123], v[122:123], v[170:171]
    v_add_f32 v124, v124, v125
    s_waitcnt vmcnt(4)
    v_pk_add_f32 v[120:121], v[120:121], v[172:173]
    v_pk_add_f32 v[122:123], v[122:123], v[174:175]
    v_maximum3_f32 v135, v120, v121, v124
    v_maximum3_f32 v135, v135, v122, v123
    v_cmp_u_f32 vcc, v135, v135
    s_nop 0
    v_max_f32_dpp v135, v135, v135 row_ror:8 row_mask:0xf bank_mask:0xf
    v_mov_b32 v136, v135
    s_cbranch_vccz rec_gbo_25
    s_branch rec_gbr_24
rec_w1_21:
    s_waitcnt lgkmcnt(0)
    s_barrier
    v_smfmac_f32_16x16x64_bf16 v[84:87], v[36:39], a[32:39], v5
    v_smfmac_f32_16x16x64_bf16 v[88:91], v[36:39], a[40:47], v5
    v_smfmac_f32_16x16x64_bf16 v[84:87], v[40:43], a[80:87], v5
    v_smfmac_f32_16x16x64_bf16 v[88:91], v[40:43], a[88:95], v5
    v_smfmac_f32_16x16x64_bf16 v[84:87], v[44:47], a[128:135], v5
    v_smfmac_f32_16x16x64_bf16 v[88:91], v[44:47], a[136:143], v5
    v_smfmac_f32_16x16x64_bf16 v[84:87], v[48:51], a[176:183], v5
    v_smfmac_f32_16x16x64_bf16 v[88:91], v[48:51], a[184:191], v5
    s_nop 6
    v_pk_add_f32 v[84:85], v[84:85], v[86:87]
    v_pk_add_f32 v[86:87], v[88:89], v[90:91]
    ds_write_b128 v17, v[84:87]
    s_waitcnt lgkmcnt(0)
    s_barrier
    v_mov_b64 v[68:69], 0
    v_mov_b64 v[70:71], 0
    v_mov_b64 v[72:73], 0
    v_mov_b64 v[74:75], 0
    v_mov_b64 v[76:77], 0
    v_mov_b64 v[78:79], 0
    v_mov_b64 v[80:81], 0
    v_mov_b64 v[82:83], 0
    v_mov_b64 v[84:85], 0
    v_mov_b64 v[86:87], 0
    v_mov_b64 v[88:89], 0
    v_mov_b64 v[90:91], 0
    s_cmp_eq_u32 s31, 3
    s_cbranch_scc1 rec_w3_41
    s_cmp_eq_u32 s31, 2
    s_cbranch_scc1 rec_w2_40
    ds_read_b128 v[180:183], v16 offset:15360
    s_branch rec_b2_20
rec_w2_40:
    ds_read_b128 v[100:103], v16 offset:10240
    ds_read_b128 v[104:107], v16 offset:11264
    ds_read_b128 v[108:111], v16 offset:12288
    ds_read_b128 v[112:115], v16 offset:13312
    s_waitcnt lgkmcnt(0)
    v_pk_add_f32 v[100:101], v[100:101], v[104:105]
    v_pk_add_f32 v[102:103], v[102:103], v[106:107]
    v_pk_add_f32 v[108:109], v[108:109], v[112:113]
    v_pk_add_f32 v[110:111], v[110:111], v[114:115]
    v_pk_add_f32 v[100:101], v[100:101], v[108:109]
    v_pk_add_f32 v[102:103], v[102:103], v[110:111]
    v_cvt_pk_bf16_f32 v180, v100, v101
    v_cvt_pk_bf16_f32 v181, v102, v103
    s_nop 0
    v_permlane32_swap_b32 v180, v182
    v_permlane32_swap_b32 v181, v183
    s_nop 1
    v_permlane16_swap_b32 v180, v181
    v_permlane16_swap_b32 v182, v183
rec_b2_20:
    s_waitcnt lgkmcnt(0)
    s_cmp_eq_u32 s32, 63
    s_cbranch_scc1 rec_done_17
    s_branch rec_cs_27
rec_w3_41:
    s_cmp_eq_u32 s32, 63
    s_cbranch_scc1 rec_done_17
    s_branch rec_tkc_44
rec_tk_42:
    s_load_dwordx8 s[72:79], s[90:91], s55 glc
    s_add_u32 s41, s41, 1
    s_cmp_ge_u32 s41, 0x80000
    s_cbranch_scc1 rec_tkd_43
    s_sleep 1
rec_tkc_44:
    s_min_u32 s38, s72, s76
    s_cmp_lt_u32 s38, s54
    s_cbranch_scc1 rec_tk_42
rec_tkd_43:
    s_add_u32 s54, s54, 1
    s_branch rec_cs_27
rec_kv_30:
    s_load_dword s94, s[90:91], s95 glc
    s_add_u32 s41, s41, 1
    s_cmp_ge_u32 s41, 0x80000
    s_cbranch_scc1 rec_kvd_31
    s_waitcnt lgkmcnt(0)
    s_cmp_gt_u32 s94, s38
    s_cbranch_scc1 rec_kvd_31
    s_sleep 2
    s_branch rec_kv_30
rec_gcfix_29:
    s_add_u32 s41, s41, 1
    s_cmp_ge_u32 s41, 0x80000
    s_cbranch_scc1 rec_gcok_28
    buffer_load_dwordx4 v[36:39], v12, s[4:7], s33 offen offset:0 sc1
    buffer_load_dwordx4 v[40:43], v12, s[4:7], s33 offen offset:1024 sc1
    buffer_load_dwordx4 v[44:47], v12, s[4:7], s33 offen offset:2048 sc1
    buffer_load_dwordx4 v[48:51], v12, s[4:7], s33 offen offset:3072 sc1
    buffer_load_dwordx4 v[52:55], v13, s[4:7], s33 offen offset:0 sc1
    buffer_load_dwordx4 v[56:59], v13, s[4:7], s33 offen offset:1024 sc1
    buffer_load_dwordx4 v[60:63], v13, s[4:7], s33 offen offset:2048 sc1
    buffer_load_dwordx4 v[64:67], v13, s[4:7], s33 offen offset:3072 sc1
    v_mov_b64 v[68:69], 0
    v_mov_b64 v[70:71], 0
    v_mov_b64 v[72:73], 0
    v_mov_b64 v[74:75], 0
    s_waitcnt vmcnt(7)
    v_smfmac_f32_16x16x64_bf16 v[68:71], v[36:39], a[192:199], v5
    v_min_u32 v31, v36, v37
    v_smfmac_f32_16x16x64_bf16 v[72:75], v[36:39], a[200:207], v5
    v_min_u32 v4, v38, v39
    s_waitcnt vmcnt(6)
    v_smfmac_f32_16x16x64_bf16 v[68:71], v[40:43], a[208:215], v5
    v_min3_u32 v31, v31, v40, v41
    v_smfmac_f32_16x16x64_bf16 v[72:75], v[40:43], a[216:223], v5
    v_min3_u32 v4, v4, v42, v43
    s_waitcnt vmcnt(5)
    v_smfmac_f32_16x16x64_bf16 v[68:71], v[44:47], a[224:231], v5
    v_min3_u32 v31, v31, v44, v45
    v_smfmac_f32_16x16x64_bf16 v[72:75], v[44:47], a[232:239], v5
    v_min3_u32 v4, v4, v46, v47
    s_waitcnt vmcnt(4)
    v_smfmac_f32_16x16x64_bf16 v[68:71], v[48:51], a[240:247], v5
    v_min3_u32 v31, v31, v48, v49
    v_smfmac_f32_16x16x64_bf16 v[72:75], v[48:51], a[248:255], v5
    v_min3_u32 v4, v4, v50, v51
    s_waitcnt vmcnt(3)
    v_smfmac_f32_16x16x64_bf16 v[68:71], v[52:55], v[192:199], v5
    v_min3_u32 v31, v31, v52, v53
    v_smfmac_f32_16x16x64_bf16 v[72:75], v[52:55], v[200:207], v5
    v_min3_u32 v4, v4, v54, v55
    s_waitcnt vmcnt(2)
    v_smfmac_f32_16x16x64_bf16 v[68:71], v[56:59], v[208:215], v5
    v_min3_u32 v31, v31, v56, v57
    v_smfmac_f32_16x16x64_bf16 v[72:75], v[56:59], v[216:223], v5
    v_min3_u32 v4, v4, v58, v59
    s_waitcnt vmcnt(1)
    v_smfmac_f32_16x16x64_bf16 v[68:71], v[60:63], v[224:231], v5
    v_min3_u32 v31, v31, v60, v61
    v_smfmac_f32_16x16x64_bf16 v[72:75], v[60:63], v[232:239], v5
    v_min3_u32 v4, v4, v62, v63
    v_min_u32 v31, v31, v4
    s_waitcnt vmcnt(0)
    v_min3_u32 v31, v31, v64, v65
    v_smfmac_f32_16x16x64_bf16 v[68:71], v[64:67], v[240:247], v5
    v_min3_u32 v31, v31, v66, v67
    v_smfmac_f32_16x16x64_bf16 v[72:75], v[64:67], v[248:255], v5
    v_cmp_eq_u32 vcc, 0, v31
    s_cbranch_vccnz rec_gcfix_29
    s_branch rec_gcok_28
rec_done_17:
    buffer_store_dwordx4 v[180:183], v93, s[4:7], s88 offen sc1
    s_waitcnt vmcnt(0)
    s_barrier
    v_add_u32 v188, 1, v188
    buffer_store_dword v188, v137, s[4:7], 0 offen sc1
    s_endpgm
L_gem:
    s_mov_b32 s6, L_end - L_gem - 16
    s_getpc_b64 s[4:5]
    v_lshlrev_b32 v1, 7, v0
    v_min_u32 v2, s6, v1
    global_load_dword v250, v2, s[4:5]
    v_add_u32 v1, 32768, v1
    v_min_u32 v2, s6, v1
    global_load_dword v251, v2, s[4:5]
    v_add_u32 v1, 32768, v1
    s_load_dwordx2 s[90:91], s[0:1], 96
    s_load_dwordx2 s[92:93], s[0:1], 88
    v_and_b32 v1, 63, v0
    v_lshrrev_b32 v2, 6, v0
    s_nop 0
    v_readfirstlane_b32 s29, v2
    v_lshlrev_b32 v5, 4, v1
    s_mov_b32 s41, 0
    s_lshl_b32 s34, s29, 10
    s_waitcnt lgkmcnt(0)
    s_mov_b32 s4, s90
    s_and_b32 s5, s91, 0xffff
    s_mov_b32 s6, 268435456
    s_mov_b32 s7, 0x00020000
    s_cmp_ge_u32 s28, 120
    s_cbranch_scc1 L_att
    s_cmp_ge_u32 s28, 96
    s_cbranch_scc1 sl_b_45
    s_lshr_b32 s31, s28, 5
    s_add_u32 s31, s31, 1
    s_cmp_eq_u32 s31, 3
    s_cselect_b32 s44, 0, s31
    s_lshl_b32 s31, s44, 3
    s_add_u32 s31, s31, 16
    s_load_dwordx2 s[72:73], s[0:1], s31
    s_load_dwordx2 s[74:75], s[0:1], 0
    s_mov_b32 s76, 8388608
    s_mov_b32 s39, 8192
    s_and_b32 s31, s28, 31
    s_lshl_b32 s31, s31, 8
    s_lshl_b32 s36, s44, 24
    s_and_b32 s33, s28, 31
    s_lshl_b32 s33, s33, 13
    s_add_u32 s36, s36, s33
    s_mov_b32 s37, 262144
    s_and_b32 s50, s28, 31
    s_lshl_b32 s50, s50, 7
    s_lshl_b32 s33, s44, 2
    s_add_u32 s50, s50, s33
    s_add_u32 s50, s50, 115343360
    s_branch sl_c_46
sl_b_45:
    s_sub_u32 s32, s28, 96
    s_lshr_b32 s44, s32, 3
    s_load_dwordx2 s[72:73], s[0:1], 64
    s_load_dwordx2 s[74:75], s[0:1], 56
    s_mov_b32 s76, 6291456
    s_mov_b32 s39, 6144
    s_lshl_b32 s31, s32, 8
    s_lshl_b32 s36, s44, 22
    s_and_b32 s33, s32, 7
    s_lshl_b32 s33, s33, 13
    s_add_u32 s36, s36, s33
    s_add_u32 s36, s36, 50331648
    s_mov_b32 s37, 65536
    s_and_b32 s50, s32, 7
    s_lshl_b32 s50, s50, 7
    s_lshl_b32 s33, s44, 2
    s_add_u32 s50, s50, s33
    s_add_u32 s50, s50, 115347456
sl_c_46:
    s_waitcnt lgkmcnt(0)
    s_cmp_lg_u32 s29, 0
    s_cbranch_scc1 sl_i_47
    v_mov_b32 v2, 0
    s_mov_b64 exec, 1
    buffer_store_dword v2, v2, s[4:7], s50 offen sc1
    s_mov_b64 exec, -1
sl_i_47:
    s_mov_b32 s8, s72
    s_and_b32 s9, s73, 0xffff
    s_mov_b32 s10, s76
    s_mov_b32 s11, 0x00020000
    s_mov_b32 s12, s74
    s_and_b32 s13, s75, 0xffff
    s_mov_b32 s14, 4194304
    s_mov_b32 s15, 0x00020000
    s_mov_b64 s[80:81], s[72:73]
    s_mov_b32 s45, s31
    s_cmp_lt_u32 s28, 96
    s_cbranch_scc1 sl_go_48
    s_cmp_lg_u32 s29, 0
    s_cbranch_scc1 sl_a2_49
    s_mov_b64 exec, 1
    v_mov_b32 v2, 0
    v_mov_b32 v3, 1
    s_waitcnt vmcnt(0)
    global_atomic_add v2, v3, s[92:93] offset:0 sc1
    s_mov_b64 exec, -1
sl_a2_49:
    s_cmp_lt_u32 s28, 96
    s_cbranch_scc1 tw_skip_50
    s_load_dwordx2 s[72:73], s[0:1], 40
    s_and_b32 s31, s28, 31
    s_lshl_b32 s31, s31, 13
    s_lshl_b32 s33, s29, 21
    s_add_u32 s31, s31, s33
    v_lshl_add_u32 v2, v1, 7, s31
    s_waitcnt lgkmcnt(0)
    s_mov_b32 s8, s72
    s_and_b32 s9, s73, 0xffff
    s_mov_b32 s10, 8388608
    s_mov_b32 s11, 0x00020000
    s_mov_b32 s31, 0
    buffer_load_dword v128, v2, s[8:11], s31 offen
    s_mov_b32 s31, 262144
    buffer_load_dword v129, v2, s[8:11], s31 offen
    s_mov_b32 s31, 524288
    buffer_load_dword v130, v2, s[8:11], s31 offen
    s_mov_b32 s31, 786432
    buffer_load_dword v131, v2, s[8:11], s31 offen
    s_mov_b32 s31, 1048576
    buffer_load_dword v132, v2, s[8:11], s31 offen
    s_mov_b32 s31, 1310720
    buffer_load_dword v133, v2, s[8:11], s31 offen
    s_mov_b32 s31, 1572864
    buffer_load_dword v134, v2, s[8:11], s31 offen
    s_mov_b32 s31, 1835008
    buffer_load_dword v135, v2, s[8:11], s31 offen
tw_skip_50:
    s_mov_b32 s8, s80
    s_and_b32 s9, s81, 0xffff
    s_mov_b32 s10, s76
    s_mov_b32 s11, 0x00020000
    s_cmp_lg_u32 s29, 0
    s_cbranch_scc1 g_wdd_52
g_wd_51:
    s_load_dword s84, s[92:93], 128 glc
    s_add_u32 s41, s41, 1
    s_cmp_ge_u32 s41, 0x200000
    s_cbranch_scc1 g_wdd_52
    s_waitcnt lgkmcnt(0)
    s_and_b32 s84, s84, 0xffff
    s_cmp_ge_u32 s84, 96
    s_cbranch_scc1 g_wdd_52
    s_sleep 32
    s_branch g_wd_51
g_wdd_52:
    s_waitcnt lgkmcnt(0)
    s_barrier
sl_go_48:
    v_lshrrev_b32 v2, 2, v1
    v_mul_lo_u32 v6, v2, s39
    s_mov_b32 s31, s45
    s_lshl_b32 s33, s29, 6
    s_add_u32 s31, s31, s33
    v_and_b32 v2, 3, v1
    v_lshlrev_b32 v2, 4, v2
    v_add_u32 v2, s31, v2
    v_add_u32 v6, v6, v2
    s_lshl_b32 s39, s39, 4
    s_mov_b32 s30, 0
    s_mov_b32 s51, 64
    s_mov_b32 s52, 4128768
    s_lshl_b32 s31, s29, 15
    v_lshrrev_b32 v7, 4, v1
    v_lshlrev_b32 v7, 9, v7
    v_bfe_u32 v4, v1, 2, 2
    v_lshl_add_u32 v7, v4, 6, v7
    v_bfe_u32 v4, v1, 1, 1
    v_lshl_add_u32 v7, v4, 5, v7
    v_and_b32 v4, 1, v1
    v_lshl_add_u32 v7, v4, 3, v7
    v_add_u32 v7, s31, v7
    s_lshl_b32 s32, s29, 15
    s_add_u32 m0, s32, 0
    s_mov_b32 s38, 0
    buffer_load_dwordx4 v6, s[8:11], s38 offen lds
    s_add_u32 m0, s32, 1024
    s_add_u32 s38, s38, s39
    buffer_load_dwordx4 v6, s[8:11], s38 offen lds
    s_add_u32 m0, s32, 2048
    s_add_u32 s38, s38, s39
    buffer_load_dwordx4 v6, s[8:11], s38 offen lds
    s_add_u32 m0, s32, 3072
    s_add_u32 s38, s38, s39
    buffer_load_dwordx4 v6, s[8:11], s38 offen lds
    s_add_u32 m0, s32, 4096
    s_add_u32 s38, s38, s39
    buffer_load_dwordx4 v6, s[8:11], s38 offen lds
    s_add_u32 m0, s32, 5120
    s_add_u32 s38, s38, s39
    buffer_load_dwordx4 v6, s[8:11], s38 offen lds
    s_add_u32 m0, s32, 6144
    s_add_u32 s38, s38, s39
    buffer_load_dwordx4 v6, s[8:11], s38 offen lds
    s_add_u32 m0, s32, 7168
    s_add_u32 s38, s38, s39
    buffer_load_dwordx4 v6, s[8:11], s38 offen lds
    s_add_u32 m0, s32, 8192
    s_add_u32 s38, s38, s39
    buffer_load_dwordx4 v6, s[8:11], s38 offen lds
    s_add_u32 m0, s32, 9216
    s_add_u32 s38, s38, s39
    buffer_load_dwordx4 v6, s[8:11], s38 offen lds
    s_add_u32 m0, s32, 10240
    s_add_u32 s38, s38, s39
    buffer_load_dwordx4 v6, s[8:11], s38 offen lds
    s_add_u32 m0, s32, 11264
    s_add_u32 s38, s38, s39
    buffer_load_dwordx4 v6, s[8:11], s38 offen lds
    s_add_u32 m0, s32, 12288
    s_add_u32 s38, s38, s39
    buffer_load_dwordx4 v6, s[8:11], s38 offen lds
    s_add_u32 m0, s32, 13312
    s_add_u32 s38, s38, s39
    buffer_load_dwordx4 v6, s[8:11], s38 offen lds
    s_add_u32 m0, s32, 14336
    s_add_u32 s38, s38, s39
    buffer_load_dwordx4 v6, s[8:11], s38 offen lds
    s_add_u32 m0, s32, 15360
    s_add_u32 s38, s38, s39
    buffer_load_dwordx4 v6, s[8:11], s38 offen lds
    s_add_u32 m0, s32, 16384
    s_add_u32 s38, s38, s39
    buffer_load_dwordx4 v6, s[8:11], s38 offen lds
    s_add_u32 m0, s32, 17408
    s_add_u32 s38, s38, s39
    buffer_load_dwordx4 v6, s[8:11], s38 offen lds
    s_add_u32 m0, s32, 18432
    s_add_u32 s38, s38, s39
    buffer_load_dwordx4 v6, s[8:11], s38 offen lds
    s_add_u32 m0, s32, 19456
    s_add_u32 s38, s38, s39
    buffer_load_dwordx4 v6, s[8:11], s38 offen lds
    s_add_u32 m0, s32, 20480
    s_add_u32 s38, s38, s39
    buffer_load_dwordx4 v6, s[8:11], s38 offen lds
    s_add_u32 m0, s32, 21504
    s_add_u32 s38, s38, s39
    buffer_load_dwordx4 v6, s[8:11], s38 offen lds
    s_add_u32 m0, s32, 22528
    s_add_u32 s38, s38, s39
    buffer_load_dwordx4 v6, s[8:11], s38 offen lds
    s_add_u32 m0, s32, 23552
    s_add_u32 s38, s38, s39
    buffer_load_dwordx4 v6, s[8:11], s38 offen lds
    s_add_u32 m0, s32, 24576
    s_add_u32 s38, s38, s39
    buffer_load_dwordx4 v6, s[8:11], s38 offen lds
    s_add_u32 m0, s32, 25600
    s_add_u32 s38, s38, s39
    buffer_load_dwordx4 v6, s[8:11], s38 offen lds
    s_add_u32 m0, s32, 26624
    s_add_u32 s38, s38, s39
    buffer_load_dwordx4 v6, s[8:11], s38 offen lds
    s_add_u32 m0, s32, 27648
    s_add_u32 s38, s38, s39
    buffer_load_dwordx4 v6, s[8:11], s38 offen lds
    s_add_u32 m0, s32, 28672
    s_add_u32 s38, s38, s39
    buffer_load_dwordx4 v6, s[8:11], s38 offen lds
    s_add_u32 m0, s32, 29696
    s_add_u32 s38, s38, s39
    buffer_load_dwordx4 v6, s[8:11], s38 offen lds
    s_add_u32 m0, s32, 30720
    s_add_u32 s38, s38, s39
    buffer_load_dwordx4 v6, s[8:11], s38 offen lds
    s_add_u32 m0, s32, 31744
    s_add_u32 s38, s38, s39
    buffer_load_dwordx4 v6, s[8:11], s38 offen lds
    s_waitcnt vmcnt(30)
    s_cmp_lg_u32 s29, 0
    s_cbranch_scc1 sl_ar_53
    s_cmp_ge_u32 s28, 96
    s_cbranch_scc1 sl_ar_53
    s_mov_b64 exec, 1
    v_mov_b32 v2, 0
    v_mov_b32 v3, 1
    global_atomic_add v2, v3, s[92:93] offset:0 sc1
    s_mov_b64 exec, -1
sl_ar_53:
    ds_read_b64_tr_b16 a[0:1], v7 offset:0
    ds_read_b64_tr_b16 a[2:3], v7 offset:256
    ds_read_b64_tr_b16 a[4:5], v7 offset:16
    ds_read_b64_tr_b16 a[6:7], v7 offset:272
    s_waitcnt vmcnt(28)
    ds_read_b64_tr_b16 a[8:9], v7 offset:2048
    ds_read_b64_tr_b16 a[10:11], v7 offset:2304
    ds_read_b64_tr_b16 a[12:13], v7 offset:2064
    ds_read_b64_tr_b16 a[14:15], v7 offset:2320
    s_waitcnt lgkmcnt(4)
    s_add_u32 m0, s32, 0
    s_add_u32 s38, s38, s39
    buffer_load_dwordx4 v6, s[8:11], s38 offen lds
    s_add_u32 m0, s32, 1024
    s_add_u32 s38, s38, s39
    buffer_load_dwordx4 v6, s[8:11], s38 offen lds
    s_waitcnt vmcnt(28)
    ds_read_b64_tr_b16 a[16:17], v7 offset:4096
    ds_read_b64_tr_b16 a[18:19], v7 offset:4352
    ds_read_b64_tr_b16 a[20:21], v7 offset:4112
    ds_read_b64_tr_b16 a[22:23], v7 offset:4368
    s_waitcnt lgkmcnt(4)
    s_add_u32 m0, s32, 2048
    s_add_u32 s38, s38, s39
    buffer_load_dwordx4 v6, s[8:11], s38 offen lds
    s_add_u32 m0, s32, 3072
    s_add_u32 s38, s38, s39
    buffer_load_dwordx4 v6, s[8:11], s38 offen lds
    s_waitcnt vmcnt(28)
    ds_read_b64_tr_b16 a[24:25], v7 offset:6144
    ds_read_b64_tr_b16 a[26:27], v7 offset:6400
    ds_read_b64_tr_b16 a[28:29], v7 offset:6160
    ds_read_b64_tr_b16 a[30:31], v7 offset:6416
    s_waitcnt lgkmcnt(4)
    s_add_u32 m0, s32, 4096
    s_add_u32 s38, s38, s39
    buffer_load_dwordx4 v6, s[8:11], s38 offen lds
    s_add_u32 m0, s32, 5120
    s_add_u32 s38, s38, s39
    buffer_load_dwordx4 v6, s[8:11], s38 offen lds
    s_waitcnt vmcnt(28)
    ds_read_b64_tr_b16 a[32:33], v7 offset:8192
    ds_read_b64_tr_b16 a[34:35], v7 offset:8448
    ds_read_b64_tr_b16 a[36:37], v7 offset:8208
    ds_read_b64_tr_b16 a[38:39], v7 offset:8464
    s_waitcnt lgkmcnt(4)
    s_add_u32 m0, s32, 6144
    s_add_u32 s38, s38, s39
    buffer_load_dwordx4 v6, s[8:11], s38 offen lds
    s_add_u32 m0, s32, 7168
    s_add_u32 s38, s38, s39
    buffer_load_dwordx4 v6, s[8:11], s38 offen lds
    s_waitcnt vmcnt(28)
    ds_read_b64_tr_b16 a[40:41], v7 offset:10240
    ds_read_b64_tr_b16 a[42:43], v7 offset:10496
    ds_read_b64_tr_b16 a[44:45], v7 offset:10256
    ds_read_b64_tr_b16 a[46:47], v7 offset:10512
    s_waitcnt lgkmcnt(4)
    s_add_u32 m0, s32, 8192
    s_add_u32 s38, s38, s39
    buffer_load_dwordx4 v6, s[8:11], s38 offen lds
    s_add_u32 m0, s32, 9216
    s_add_u32 s38, s38, s39
    buffer_load_dwordx4 v6, s[8:11], s38 offen lds
    s_waitcnt vmcnt(28)
    ds_read_b64_tr_b16 a[48:49], v7 offset:12288
    ds_read_b64_tr_b16 a[50:51], v7 offset:12544
    ds_read_b64_tr_b16 a[52:53], v7 offset:12304
    ds_read_b64_tr_b16 a[54:55], v7 offset:12560
    s_waitcnt lgkmcnt(4)
    s_add_u32 m0, s32, 10240
    s_add_u32 s38, s38, s39
    buffer_load_dwordx4 v6, s[8:11], s38 offen lds
    s_add_u32 m0, s32, 11264
    s_add_u32 s38, s38, s39
    buffer_load_dwordx4 v6, s[8:11], s38 offen lds
    s_waitcnt vmcnt(28)
    ds_read_b64_tr_b16 a[56:57], v7 offset:14336
    ds_read_b64_tr_b16 a[58:59], v7 offset:14592
    ds_read_b64_tr_b16 a[60:61], v7 offset:14352
    ds_read_b64_tr_b16 a[62:63], v7 offset:14608
    s_waitcnt lgkmcnt(4)
    s_add_u32 m0, s32, 12288
    s_add_u32 s38, s38, s39
    buffer_load_dwordx4 v6, s[8:11], s38 offen lds
    s_add_u32 m0, s32, 13312
    s_add_u32 s38, s38, s39
    buffer_load_dwordx4 v6, s[8:11], s38 offen lds
    s_waitcnt vmcnt(28)
    ds_read_b64_tr_b16 a[64:65], v7 offset:16384
    ds_read_b64_tr_b16 a[66:67], v7 offset:16640
    ds_read_b64_tr_b16 a[68:69], v7 offset:16400
    ds_read_b64_tr_b16 a[70:71], v7 offset:16656
    s_waitcnt lgkmcnt(4)
    s_add_u32 m0, s32, 14336
    s_add_u32 s38, s38, s39
    buffer_load_dwordx4 v6, s[8:11], s38 offen lds
    s_add_u32 m0, s32, 15360
    s_add_u32 s38, s38, s39
    buffer_load_dwordx4 v6, s[8:11], s38 offen lds
    s_waitcnt vmcnt(28)
    ds_read_b64_tr_b16 a[72:73], v7 offset:18432
    ds_read_b64_tr_b16 a[74:75], v7 offset:18688
    ds_read_b64_tr_b16 a[76:77], v7 offset:18448
    ds_read_b64_tr_b16 a[78:79], v7 offset:18704
    s_waitcnt lgkmcnt(4)
    s_add_u32 m0, s32, 16384
    s_add_u32 s38, s38, s39
    buffer_load_dwordx4 v6, s[8:11], s38 offen lds
    s_add_u32 m0, s32, 17408
    s_add_u32 s38, s38, s39
    buffer_load_dwordx4 v6, s[8:11], s38 offen lds
    s_waitcnt vmcnt(28)
    ds_read_b64_tr_b16 a[80:81], v7 offset:20480
    ds_read_b64_tr_b16 a[82:83], v7 offset:20736
    ds_read_b64_tr_b16 a[84:85], v7 offset:20496
    ds_read_b64_tr_b16 a[86:87], v7 offset:20752
    s_waitcnt lgkmcnt(4)
    s_add_u32 m0, s32, 18432
    s_add_u32 s38, s38, s39
    buffer_load_dwordx4 v6, s[8:11], s38 offen lds
    s_add_u32 m0, s32, 19456
    s_add_u32 s38, s38, s39
    buffer_load_dwordx4 v6, s[8:11], s38 offen lds
    s_waitcnt vmcnt(28)
    ds_read_b64_tr_b16 a[88:89], v7 offset:22528
    ds_read_b64_tr_b16 a[90:91], v7 offset:22784
    ds_read_b64_tr_b16 a[92:93], v7 offset:22544
    ds_read_b64_tr_b16 a[94:95], v7 offset:22800
    s_waitcnt lgkmcnt(4)
    s_add_u32 m0, s32, 20480
    s_add_u32 s38, s38, s39
    buffer_load_dwordx4 v6, s[8:11], s38 offen lds
    s_add_u32 m0, s32, 21504
    s_add_u32 s38, s38, s39
    buffer_load_dwordx4 v6, s[8:11], s38 offen lds
    s_waitcnt vmcnt(28)
    ds_read_b64_tr_b16 a[96:97], v7 offset:24576
    ds_read_b64_tr_b16 a[98:99], v7 offset:24832
    ds_read_b64_tr_b16 a[100:101], v7 offset:24592
    ds_read_b64_tr_b16 a[102:103], v7 offset:24848
    s_waitcnt lgkmcnt(4)
    s_add_u32 m0, s32, 22528
    s_add_u32 s38, s38, s39
    buffer_load_dwordx4 v6, s[8:11], s38 offen lds
    s_add_u32 m0, s32, 23552
    s_add_u32 s38, s38, s39
    buffer_load_dwordx4 v6, s[8:11], s38 offen lds
    s_waitcnt vmcnt(28)
    ds_read_b64_tr_b16 a[104:105], v7 offset:26624
    ds_read_b64_tr_b16 a[106:107], v7 offset:26880
    ds_read_b64_tr_b16 a[108:109], v7 offset:26640
    ds_read_b64_tr_b16 a[110:111], v7 offset:26896
    s_waitcnt lgkmcnt(4)
    s_add_u32 m0, s32, 24576
    s_add_u32 s38, s38, s39
    buffer_load_dwordx4 v6, s[8:11], s38 offen lds
    s_add_u32 m0, s32, 25600
    s_add_u32 s38, s38, s39
    buffer_load_dwordx4 v6, s[8:11], s38 offen lds
    s_waitcnt vmcnt(28)
    ds_read_b64_tr_b16 a[112:113], v7 offset:28672
    ds_read_b64_tr_b16 a[114:115], v7 offset:28928
    ds_read_b64_tr_b16 a[116:117], v7 offset:28688
    ds_read_b64_tr_b16 a[118:119], v7 offset:28944
    s_waitcnt lgkmcnt(4)
    s_add_u32 m0, s32, 26624
    s_add_u32 s38, s38, s39
    buffer_load_dwordx4 v6, s[8:11], s38 offen lds
    s_add_u32 m0, s32, 27648
    s_add_u32 s38, s38, s39
    buffer_load_dwordx4 v6, s[8:11], s38 offen lds
    s_waitcnt vmcnt(28)
    ds_read_b64_tr_b16 a[120:121], v7 offset:30720
    ds_read_b64_tr_b16 a[122:123], v7 offset:30976
    ds_read_b64_tr_b16 a[124:125], v7 offset:30736
    ds_read_b64_tr_b16 a[126:127], v7 offset:30992
    s_waitcnt lgkmcnt(4)
    s_add_u32 m0, s32, 28672
    s_add_u32 s38, s38, s39
    buffer_load_dwordx4 v6, s[8:11], s38 offen lds
    s_add_u32 m0, s32, 29696
    s_add_u32 s38, s38, s39
    buffer_load_dwordx4 v6, s[8:11], s38 offen lds
    s_waitcnt vmcnt(28)
    ds_read_b64_tr_b16 a[128:129], v7 offset:0
    ds_read_b64_tr_b16 a[130:131], v7 offset:256
    ds_read_b64_tr_b16 a[132:133], v7 offset:16
    ds_read_b64_tr_b16 a[134:135], v7 offset:272
    s_waitcnt lgkmcnt(4)
    s_add_u32 m0, s32, 30720
    s_add_u32 s38, s38, s39
    buffer_load_dwordx4 v6, s[8:11], s38 offen lds
    s_add_u32 m0, s32, 31744
    s_add_u32 s38, s38, s39
    buffer_load_dwordx4 v6, s[8:11], s38 offen lds
    s_waitcnt vmcnt(28)
    ds_read_b64_tr_b16 a[136:137], v7 offset:2048
    ds_read_b64_tr_b16 a[138:139], v7 offset:2304
    ds_read_b64_tr_b16 a[140:141], v7 offset:2064
    ds_read_b64_tr_b16 a[142:143], v7 offset:2320
    s_waitcnt vmcnt(26)
    ds_read_b64_tr_b16 a[144:145], v7 offset:4096
    ds_read_b64_tr_b16 a[146:147], v7 offset:4352
    ds_read_b64_tr_b16 a[148:149], v7 offset:4112
    ds_read_b64_tr_b16 a[150:151], v7 offset:4368
    s_waitcnt vmcnt(24)
    ds_read_b64_tr_b16 a[152:153], v7 offset:6144
    ds_read_b64_tr_b16 a[154:155], v7 offset:6400
    ds_read_b64_tr_b16 a[156:157], v7 offset:6160
    ds_read_b64_tr_b16 a[158:159], v7 offset:6416
    s_waitcnt vmcnt(22)
    ds_read_b64_tr_b16 a[160:161], v7 offset:8192
    ds_read_b64_tr_b16 a[162:163], v7 offset:8448
    ds_read_b64_tr_b16 a[164:165], v7 offset:8208
    ds_read_b64_tr_b16 a[166:167], v7 offset:8464
    s_waitcnt vmcnt(20)
    ds_read_b64_tr_b16 a[168:169], v7 offset:10240
    ds_read_b64_tr_b16 a[170:171], v7 offset:10496
    ds_read_b64_tr_b16 a[172:173], v7 offset:10256
    ds_read_b64_tr_b16 a[174:175], v7 offset:10512
    s_waitcnt vmcnt(18)
    ds_read_b64_tr_b16 a[176:177], v7 offset:12288
    ds_read_b64_tr_b16 a[178:179], v7 offset:12544
    ds_read_b64_tr_b16 a[180:181], v7 offset:12304
    ds_read_b64_tr_b16 a[182:183], v7 offset:12560
    s_waitcnt vmcnt(16)
    ds_read_b64_tr_b16 a[184:185], v7 offset:14336
    ds_read_b64_tr_b16 a[186:187], v7 offset:14592
    ds_read_b64_tr_b16 a[188:189], v7 offset:14352
    ds_read_b64_tr_b16 a[190:191], v7 offset:14608
    s_waitcnt vmcnt(14)
    ds_read_b64_tr_b16 a[192:193], v7 offset:16384
    ds_read_b64_tr_b16 a[194:195], v7 offset:16640
    ds_read_b64_tr_b16 a[196:197], v7 offset:16400
    ds_read_b64_tr_b16 a[198:199], v7 offset:16656
    s_waitcnt vmcnt(12)
    ds_read_b64_tr_b16 a[200:201], v7 offset:18432
    ds_read_b64_tr_b16 a[202:203], v7 offset:18688
    ds_read_b64_tr_b16 a[204:205], v7 offset:18448
    ds_read_b64_tr_b16 a[206:207], v7 offset:18704
    s_waitcnt vmcnt(10)
    ds_read_b64_tr_b16 a[208:209], v7 offset:20480
    ds_read_b64_tr_b16 a[210:211], v7 offset:20736
    ds_read_b64_tr_b16 a[212:213], v7 offset:20496
    ds_read_b64_tr_b16 a[214:215], v7 offset:20752
    s_waitcnt vmcnt(8)
    ds_read_b64_tr_b16 a[216:217], v7 offset:22528
    ds_read_b64_tr_b16 a[218:219], v7 offset:22784
    ds_read_b64_tr_b16 a[220:221], v7 offset:22544
    ds_read_b64_tr_b16 a[222:223], v7 offset:22800
    s_waitcnt vmcnt(6)
    ds_read_b64_tr_b16 a[224:225], v7 offset:24576
    ds_read_b64_tr_b16 a[226:227], v7 offset:24832
    ds_read_b64_tr_b16 a[228:229], v7 offset:24592
    ds_read_b64_tr_b16 a[230:231], v7 offset:24848
    s_waitcnt vmcnt(4)
    ds_read_b64_tr_b16 a[232:233], v7 offset:26624
    ds_read_b64_tr_b16 a[234:235], v7 offset:26880
    ds_read_b64_tr_b16 a[236:237], v7 offset:26640
    ds_read_b64_tr_b16 a[238:239], v7 offset:26896
    s_waitcnt vmcnt(2)
    ds_read_b64_tr_b16 a[240:241], v7 offset:28672
    ds_read_b64_tr_b16 a[242:243], v7 offset:28928
    ds_read_b64_tr_b16 a[244:245], v7 offset:28688
    ds_read_b64_tr_b16 a[246:247], v7 offset:28944
    s_waitcnt vmcnt(0)
    ds_read_b64_tr_b16 a[248:249], v7 offset:30720
    ds_read_b64_tr_b16 a[250:251], v7 offset:30976
    ds_read_b64_tr_b16 a[252:253], v7 offset:30736
    ds_read_b64_tr_b16 a[254:255], v7 offset:30992
    s_waitcnt lgkmcnt(0)
    s_lshr_b32 s31, s29, 1
    s_and_b32 s31, s31, 1
    s_lshl_b32 s31, s31, 2
    v_lshrrev_b32 v2, 4, v1
    v_add_u32 v2, s31, v2
    v_and_b32 v3, 7, v1
    v_xor_b32 v2, v2, v3
    s_lshl_b32 s31, s29, 14
    v_lshrrev_b32 v8, 3, v1
    v_lshlrev_b32 v8, 11, v8
    v_add_u32 v8, s31, v8
    v_lshl_add_u32 v8, v2, 4, v8
    v_bfe_u32 v2, v1, 1, 3
    v_lshrrev_b32 v3, 4, v1
    v_xor_b32 v2, v2, v3
    v_bfe_u32 v3, v1, 3, 1
    v_lshlrev_b32 v3, 11, v3
    v_and_b32 v4, 7, v1
    v_lshl_add_u32 v3, v4, 7, v3
    v_xor_b32 v12, 0, v2
    v_lshl_add_u32 v12, v12, 4, v3
    v_add_u32 v14, 65536, v12
    v_xor_b32 v13, 4, v2
    v_lshl_add_u32 v13, v13, 4, v3
    v_add_u32 v15, 65536, v13
    s_lshl_b32 s31, s29, 11
    v_lshrrev_b32 v9, 4, v1
    v_lshlrev_b32 v9, 9, v9
    v_bfe_u32 v4, v1, 3, 1
    v_lshl_add_u32 v9, v4, 8, v9
    v_and_b32 v4, 7, v1
    v_lshl_add_u32 v9, v4, 4, v9
    v_add_u32 v9, s31, v9
    v_mov_b32 v10, s50
    s_cmp_eq_u32 s29, 0
    s_cselect_b64 vcc, 1, 0
    v_mov_b32 v4, 2130706432
    v_cndmask_b32 v10, v4, v10, vcc
    v_mov_b32 v11, 0
    s_lshl_b32 s35, s30, 16
    s_sub_u32 s36, s36, s37
    s_barrier
    s_add_u32 m0, s34, 0
    s_nop 0
    buffer_load_dwordx4 v8, s[12:15], s35 offen offset:0 lds
    s_add_u32 m0, s34, 3968
    s_nop 0
    buffer_load_dwordx4 v8, s[12:15], s35 offen offset:128 lds
    s_add_u32 m0, s34, 7936
    s_nop 0
    buffer_load_dwordx4 v8, s[12:15], s35 offen offset:256 lds
    s_add_u32 m0, s34, 11904
    s_nop 0
    buffer_load_dwordx4 v8, s[12:15], s35 offen offset:384 lds
    s_add_u32 m0, s34, 15872
    s_nop 0
    buffer_load_dwordx4 v8, s[12:15], s35 offen offset:512 lds
    s_add_u32 m0, s34, 19840
    s_nop 0
    buffer_load_dwordx4 v8, s[12:15], s35 offen offset:640 lds
    s_add_u32 m0, s34, 23808
    s_nop 0
    buffer_load_dwordx4 v8, s[12:15], s35 offen offset:768 lds
    s_add_u32 m0, s34, 27776
    s_nop 0
    buffer_load_dwordx4 v8, s[12:15], s35 offen offset:896 lds
    s_add_u32 m0, s34, 31744
    s_nop 0
    buffer_load_dwordx4 v8, s[12:15], s35 offen offset:1024 lds
    s_add_u32 m0, s34, 35712
    s_nop 0
    buffer_load_dwordx4 v8, s[12:15], s35 offen offset:1152 lds
    s_add_u32 m0, s34, 39680
    s_nop 0
    buffer_load_dwordx4 v8, s[12:15], s35 offen offset:1280 lds
    s_add_u32 m0, s34, 43648
    s_nop 0
    buffer_load_dwordx4 v8, s[12:15], s35 offen offset:1408 lds
    s_add_u32 m0, s34, 47616
    s_nop 0
    buffer_load_dwordx4 v8, s[12:15], s35 offen offset:1536 lds
    s_add_u32 m0, s34, 51584
    s_nop 0
    buffer_load_dwordx4 v8, s[12:15], s35 offen offset:1664 lds
    s_add_u32 m0, s34, 55552
    s_nop 0
    buffer_load_dwordx4 v8, s[12:15], s35 offen offset:1792 lds
    s_add_u32 m0, s34, 59520
    s_nop 0
    buffer_load_dwordx4 v8, s[12:15], s35 offen offset:1920 lds
    s_add_u32 s35, s35, 65536
    s_add_u32 m0, s34, 65536
    s_nop 0
    buffer_load_dwordx4 v8, s[12:15], s35 offen offset:0 lds
    s_add_u32 m0, s34, 69504
    s_nop 0
    buffer_load_dwordx4 v8, s[12:15], s35 offen offset:128 lds
    s_add_u32 m0, s34, 73472
    s_nop 0
    buffer_load_dwordx4 v8, s[12:15], s35 offen offset:256 lds
    s_add_u32 m0, s34, 77440
    s_nop 0
    buffer_load_dwordx4 v8, s[12:15], s35 offen offset:384 lds
    s_waitcnt vmcnt(12)
    s_barrier
    ds_read_b128 v[32:35], v12 offset:0
    ds_read_b128 v[36:39], v12 offset:1024
    ds_read_b128 v[40:43], v13 offset:0
    ds_read_b128 v[44:47], v13 offset:1024
    ds_read_b128 v[48:51], v12 offset:4096
    ds_read_b128 v[52:55], v12 offset:5120
    v_add_u32 v9, 2130706432, v9
    s_cmp_eq_u32 s44, 2
    s_cbranch_scc1 sl_v_54
sl_loop_56:
    s_waitcnt lgkmcnt(4)
    v_mfma_f32_16x16x32_bf16 v[64:67], a[0:3], v[32:35], 0
    ds_read_b128 v[56:59], v13 offset:4096
    v_mfma_f32_16x16x32_bf16 v[68:71], a[4:7], v[32:35], 0
    v_mfma_f32_16x16x32_bf16 v[72:75], a[0:3], v[36:39], 0
    ds_read_b128 v[60:63], v13 offset:5120
    s_add_u32 m0, s34, 81408
    v_mfma_f32_16x16x32_bf16 v[76:79], a[4:7], v[36:39], 0
    buffer_load_dwordx4 v8, s[12:15], s35 offen offset:512 lds
    s_waitcnt lgkmcnt(4)
    v_mfma_f32_16x16x32_bf16 v[64:67], a[8:11], v[40:43], v[64:67]
    ds_read_b128 v[32:35], v12 offset:8192
    v_mfma_f32_16x16x32_bf16 v[68:71], a[12:15], v[40:43], v[68:71]
    v_mfma_f32_16x16x32_bf16 v[72:75], a[8:11], v[44:47], v[72:75]
    ds_read_b128 v[36:39], v12 offset:9216
    v_mfma_f32_16x16x32_bf16 v[76:79], a[12:15], v[44:47], v[76:79]
    s_waitcnt lgkmcnt(4)
    v_mfma_f32_16x16x32_bf16 v[64:67], a[16:19], v[48:51], v[64:67]
    ds_read_b128 v[40:43], v13 offset:8192
    v_mfma_f32_16x16x32_bf16 v[68:71], a[20:23], v[48:51], v[68:71]
    v_cvt_pk_bf16_f32 v96, v80, v81
    v_mfma_f32_16x16x32_bf16 v[72:75], a[16:19], v[52:55], v[72:75]
    ds_read_b128 v[44:47], v13 offset:9216
    s_add_u32 m0, s34, 85376
    v_mfma_f32_16x16x32_bf16 v[76:79], a[20:23], v[52:55], v[76:79]
    buffer_load_dwordx4 v8, s[12:15], s35 offen offset:640 lds
    v_cvt_pk_bf16_f32 v97, v82, v83
    s_waitcnt lgkmcnt(4)
    v_mfma_f32_16x16x32_bf16 v[64:67], a[24:27], v[56:59], v[64:67]
    ds_read_b128 v[48:51], v12 offset:12288
    v_mfma_f32_16x16x32_bf16 v[68:71], a[28:31], v[56:59], v[68:71]
    v_cvt_pk_bf16_f32 v98, v84, v85
    v_mfma_f32_16x16x32_bf16 v[72:75], a[24:27], v[60:63], v[72:75]
    ds_read_b128 v[52:55], v12 offset:13312
    v_mfma_f32_16x16x32_bf16 v[76:79], a[28:31], v[60:63], v[76:79]
    v_cvt_pk_bf16_f32 v99, v86, v87
    s_waitcnt lgkmcnt(4)
    v_mfma_f32_16x16x32_bf16 v[64:67], a[32:35], v[32:35], v[64:67]
    ds_read_b128 v[56:59], v13 offset:12288
    v_mfma_f32_16x16x32_bf16 v[68:71], a[36:39], v[32:35], v[68:71]
    v_cvt_pk_bf16_f32 v100, v88, v89
    v_mfma_f32_16x16x32_bf16 v[72:75], a[32:35], v[36:39], v[72:75]
    ds_read_b128 v[60:63], v13 offset:13312
    s_add_u32 m0, s34, 89344
    v_mfma_f32_16x16x32_bf16 v[76:79], a[36:39], v[36:39], v[76:79]
    buffer_load_dwordx4 v8, s[12:15], s35 offen offset:768 lds
    v_cvt_pk_bf16_f32 v101, v90, v91
    s_waitcnt lgkmcnt(4)
    v_mfma_f32_16x16x32_bf16 v[64:67], a[40:43], v[40:43], v[64:67]
    ds_read_b128 v[32:35], v12 offset:16384
    v_mfma_f32_16x16x32_bf16 v[68:71], a[44:47], v[40:43], v[68:71]
    v_cvt_pk_bf16_f32 v102, v92, v93
    v_mfma_f32_16x16x32_bf16 v[72:75], a[40:43], v[44:47], v[72:75]
    ds_read_b128 v[36:39], v12 offset:17408
    v_mfma_f32_16x16x32_bf16 v[76:79], a[44:47], v[44:47], v[76:79]
    v_cvt_pk_bf16_f32 v103, v94, v95
    buffer_store_dwordx4 v[96:99], v9, s[4:7], s36 offen sc1
    s_waitcnt lgkmcnt(4)
    v_mfma_f32_16x16x32_bf16 v[64:67], a[48:51], v[48:51], v[64:67]
    ds_read_b128 v[40:43], v13 offset:16384
    v_mfma_f32_16x16x32_bf16 v[68:71], a[52:55], v[48:51], v[68:71]
    v_mfma_f32_16x16x32_bf16 v[72:75], a[48:51], v[52:55], v[72:75]
    ds_read_b128 v[44:47], v13 offset:17408
    s_add_u32 m0, s34, 93312
    v_mfma_f32_16x16x32_bf16 v[76:79], a[52:55], v[52:55], v[76:79]
    buffer_load_dwordx4 v8, s[12:15], s35 offen offset:896 lds
    s_waitcnt lgkmcnt(4)
    v_mfma_f32_16x16x32_bf16 v[64:67], a[56:59], v[56:59], v[64:67]
    ds_read_b128 v[48:51], v12 offset:20480
    v_mfma_f32_16x16x32_bf16 v[68:71], a[60:63], v[56:59], v[68:71]
    v_mfma_f32_16x16x32_bf16 v[72:75], a[56:59], v[60:63], v[72:75]
    ds_read_b128 v[52:55], v12 offset:21504
    v_mfma_f32_16x16x32_bf16 v[76:79], a[60:63], v[60:63], v[76:79]
    buffer_store_dwordx4 v[100:103], v9, s[4:7], s36 offen offset:128 sc1
    s_add_u32 s36, s36, s37
    s_waitcnt vmcnt(8)
    s_barrier
    s_waitcnt lgkmcnt(4)
    v_mfma_f32_16x16x32_bf16 v[64:67], a[64:67], v[32:35], v[64:67]
    ds_read_b128 v[56:59], v13 offset:20480
    v_mfma_f32_16x16x32_bf16 v[68:71], a[68:71], v[32:35], v[68:71]
    v_mfma_f32_16x16x32_bf16 v[72:75], a[64:67], v[36:39], v[72:75]
    ds_read_b128 v[60:63], v13 offset:21504
    s_add_u32 m0, s34, 97280
    v_mfma_f32_16x16x32_bf16 v[76:79], a[68:71], v[36:39], v[76:79]
    buffer_load_dwordx4 v8, s[12:15], s35 offen offset:1024 lds
    s_waitcnt lgkmcnt(4)
    v_mfma_f32_16x16x32_bf16 v[64:67], a[72:75], v[40:43], v[64:67]
    ds_read_b128 v[32:35], v12 offset:24576
    v_mfma_f32_16x16x32_bf16 v[68:71], a[76:79], v[40:43], v[68:71]
    v_mfma_f32_16x16x32_bf16 v[72:75], a[72:75], v[44:47], v[72:75]
    ds_read_b128 v[36:39], v12 offset:25600
    v_mfma_f32_16x16x32_bf16 v[76:79], a[76:79], v[44:47], v[76:79]
    s_waitcnt lgkmcnt(4)
    v_mfma_f32_16x16x32_bf16 v[64:67], a[80:83], v[48:51], v[64:67]
    ds_read_b128 v[40:43], v13 offset:24576
    v_mfma_f32_16x16x32_bf16 v[68:71], a[84:87], v[48:51], v[68:71]
    v_and_b32 v9, 0xffffff, v9
    v_mfma_f32_16x16x32_bf16 v[72:75], a[80:83], v[52:55], v[72:75]
    ds_read_b128 v[44:47], v13 offset:25600
    s_add_u32 m0, s34, 101248
    v_mfma_f32_16x16x32_bf16 v[76:79], a[84:87], v[52:55], v[76:79]
    buffer_load_dwordx4 v8, s[12:15], s35 offen offset:1152 lds
    s_waitcnt lgkmcnt(4)
    v_mfma_f32_16x16x32_bf16 v[64:67], a[88:91], v[56:59], v[64:67]
    ds_read_b128 v[48:51], v12 offset:28672
    v_mfma_f32_16x16x32_bf16 v[68:71], a[92:95], v[56:59], v[68:71]
    v_mfma_f32_16x16x32_bf16 v[72:75], a[88:91], v[60:63], v[72:75]
    ds_read_b128 v[52:55], v12 offset:29696
    v_mfma_f32_16x16x32_bf16 v[76:79], a[92:95], v[60:63], v[76:79]
    s_waitcnt lgkmcnt(4)
    v_mfma_f32_16x16x32_bf16 v[64:67], a[96:99], v[32:35], v[64:67]
    ds_read_b128 v[56:59], v13 offset:28672
    v_mfma_f32_16x16x32_bf16 v[68:71], a[100:103], v[32:35], v[68:71]
    v_mfma_f32_16x16x32_bf16 v[72:75], a[96:99], v[36:39], v[72:75]
    ds_read_b128 v[60:63], v13 offset:29696
    s_add_u32 m0, s34, 105216
    v_mfma_f32_16x16x32_bf16 v[76:79], a[100:103], v[36:39], v[76:79]
    buffer_load_dwordx4 v8, s[12:15], s35 offen offset:1280 lds
    s_waitcnt lgkmcnt(4)
    v_mfma_f32_16x16x32_bf16 v[64:67], a[104:107], v[40:43], v[64:67]
    ds_read_b128 v[32:35], v12 offset:32768
    v_mfma_f32_16x16x32_bf16 v[68:71], a[108:111], v[40:43], v[68:71]
    v_mfma_f32_16x16x32_bf16 v[72:75], a[104:107], v[44:47], v[72:75]
    ds_read_b128 v[36:39], v12 offset:33792
    v_mfma_f32_16x16x32_bf16 v[76:79], a[108:111], v[44:47], v[76:79]
    s_waitcnt lgkmcnt(4)
    v_mfma_f32_16x16x32_bf16 v[64:67], a[112:115], v[48:51], v[64:67]
    ds_read_b128 v[40:43], v13 offset:32768
    v_mfma_f32_16x16x32_bf16 v[68:71], a[116:119], v[48:51], v[68:71]
    v_mfma_f32_16x16x32_bf16 v[72:75], a[112:115], v[52:55], v[72:75]
    ds_read_b128 v[44:47], v13 offset:33792
    s_add_u32 m0, s34, 109184
    v_mfma_f32_16x16x32_bf16 v[76:79], a[116:119], v[52:55], v[76:79]
    buffer_load_dwordx4 v8, s[12:15], s35 offen offset:1408 lds
    s_waitcnt lgkmcnt(4)
    v_mfma_f32_16x16x32_bf16 v[64:67], a[120:123], v[56:59], v[64:67]
    ds_read_b128 v[48:51], v12 offset:36864
    v_mfma_f32_16x16x32_bf16 v[68:71], a[124:127], v[56:59], v[68:71]
    v_mfma_f32_16x16x32_bf16 v[72:75], a[120:123], v[60:63], v[72:75]
    ds_read_b128 v[52:55], v12 offset:37888
    v_mfma_f32_16x16x32_bf16 v[76:79], a[124:127], v[60:63], v[76:79]
    s_waitcnt lgkmcnt(4)
    v_mfma_f32_16x16x32_bf16 v[64:67], a[128:131], v[32:35], v[64:67]
    ds_read_b128 v[56:59], v13 offset:36864
    v_mfma_f32_16x16x32_bf16 v[68:71], a[132:135], v[32:35], v[68:71]
    v_mfma_f32_16x16x32_bf16 v[72:75], a[128:131], v[36:39], v[72:75]
    ds_read_b128 v[60:63], v13 offset:37888
    s_add_u32 m0, s34, 113152
    v_mfma_f32_16x16x32_bf16 v[76:79], a[132:135], v[36:39], v[76:79]
    buffer_load_dwordx4 v8, s[12:15], s35 offen offset:1536 lds
    s_waitcnt lgkmcnt(4)
    v_mfma_f32_16x16x32_bf16 v[64:67], a[136:139], v[40:43], v[64:67]
    ds_read_b128 v[32:35], v12 offset:40960
    v_mfma_f32_16x16x32_bf16 v[68:71], a[140:143], v[40:43], v[68:71]
    v_mfma_f32_16x16x32_bf16 v[72:75], a[136:139], v[44:47], v[72:75]
    ds_read_b128 v[36:39], v12 offset:41984
    v_mfma_f32_16x16x32_bf16 v[76:79], a[140:143], v[44:47], v[76:79]
    s_waitcnt lgkmcnt(4)
    v_mfma_f32_16x16x32_bf16 v[64:67], a[144:147], v[48:51], v[64:67]
    ds_read_b128 v[40:43], v13 offset:40960
    v_mfma_f32_16x16x32_bf16 v[68:71], a[148:151], v[48:51], v[68:71]
    v_mfma_f32_16x16x32_bf16 v[72:75], a[144:147], v[52:55], v[72:75]
    ds_read_b128 v[44:47], v13 offset:41984
    s_add_u32 m0, s34, 117120
    v_mfma_f32_16x16x32_bf16 v[76:79], a[148:151], v[52:55], v[76:79]
    buffer_load_dwordx4 v8, s[12:15], s35 offen offset:1664 lds
    s_waitcnt lgkmcnt(4)
    v_mfma_f32_16x16x32_bf16 v[64:67], a[152:155], v[56:59], v[64:67]
    ds_read_b128 v[48:51], v12 offset:45056
    v_mfma_f32_16x16x32_bf16 v[68:71], a[156:159], v[56:59], v[68:71]
    v_mfma_f32_16x16x32_bf16 v[72:75], a[152:155], v[60:63], v[72:75]
    ds_read_b128 v[52:55], v12 offset:46080
    v_mfma_f32_16x16x32_bf16 v[76:79], a[156:159], v[60:63], v[76:79]
    s_waitcnt lgkmcnt(4)
    v_mfma_f32_16x16x32_bf16 v[64:67], a[160:163], v[32:35], v[64:67]
    ds_read_b128 v[56:59], v13 offset:45056
    v_mfma_f32_16x16x32_bf16 v[68:71], a[164:167], v[32:35], v[68:71]
    v_mfma_f32_16x16x32_bf16 v[72:75], a[160:163], v[36:39], v[72:75]
    ds_read_b128 v[60:63], v13 offset:46080
    s_add_u32 m0, s34, 121088
    v_mfma_f32_16x16x32_bf16 v[76:79], a[164:167], v[36:39], v[76:79]
    buffer_load_dwordx4 v8, s[12:15], s35 offen offset:1792 lds
    s_waitcnt lgkmcnt(4)
    v_mfma_f32_16x16x32_bf16 v[64:67], a[168:171], v[40:43], v[64:67]
    ds_read_b128 v[32:35], v12 offset:49152
    v_mfma_f32_16x16x32_bf16 v[68:71], a[172:175], v[40:43], v[68:71]
    v_mfma_f32_16x16x32_bf16 v[72:75], a[168:171], v[44:47], v[72:75]
    ds_read_b128 v[36:39], v12 offset:50176
    v_mfma_f32_16x16x32_bf16 v[76:79], a[172:175], v[44:47], v[76:79]
    s_waitcnt lgkmcnt(4)
    v_mfma_f32_16x16x32_bf16 v[64:67], a[176:179], v[48:51], v[64:67]
    ds_read_b128 v[40:43], v13 offset:49152
    v_mfma_f32_16x16x32_bf16 v[68:71], a[180:183], v[48:51], v[68:71]
    v_mfma_f32_16x16x32_bf16 v[72:75], a[176:179], v[52:55], v[72:75]
    ds_read_b128 v[44:47], v13 offset:50176
    s_add_u32 m0, s34, 125056
    v_mfma_f32_16x16x32_bf16 v[76:79], a[180:183], v[52:55], v[76:79]
    buffer_load_dwordx4 v8, s[12:15], s35 offen offset:1920 lds
    s_add_u32 s35, s35, 65536
    s_min_u32 s35, s35, s52
    s_waitcnt lgkmcnt(4)
    v_mfma_f32_16x16x32_bf16 v[64:67], a[184:187], v[56:59], v[64:67]
    ds_read_b128 v[48:51], v12 offset:53248
    v_mfma_f32_16x16x32_bf16 v[68:71], a[188:191], v[56:59], v[68:71]
    v_mfma_f32_16x16x32_bf16 v[72:75], a[184:187], v[60:63], v[72:75]
    ds_read_b128 v[52:55], v12 offset:54272
    v_mfma_f32_16x16x32_bf16 v[76:79], a[188:191], v[60:63], v[76:79]
    s_waitcnt vmcnt(8)
    s_barrier
    s_waitcnt lgkmcnt(4)
    v_mfma_f32_16x16x32_bf16 v[64:67], a[192:195], v[32:35], v[64:67]
    ds_read_b128 v[56:59], v13 offset:53248
    v_mfma_f32_16x16x32_bf16 v[68:71], a[196:199], v[32:35], v[68:71]
    v_mfma_f32_16x16x32_bf16 v[72:75], a[192:195], v[36:39], v[72:75]
    ds_read_b128 v[60:63], v13 offset:54272
    s_add_u32 m0, s34, 0
    v_mfma_f32_16x16x32_bf16 v[76:79], a[196:199], v[36:39], v[76:79]
    buffer_load_dwordx4 v8, s[12:15], s35 offen offset:0 lds
    s_waitcnt lgkmcnt(4)
    v_mfma_f32_16x16x32_bf16 v[64:67], a[200:203], v[40:43], v[64:67]
    ds_read_b128 v[32:35], v12 offset:57344
    v_mfma_f32_16x16x32_bf16 v[68:71], a[204:207], v[40:43], v[68:71]
    buffer_store_dword v11, v10, s[4:7], 0 offen sc1
    v_add_u32 v11, 1, v11
    v_mfma_f32_16x16x32_bf16 v[72:75], a[200:203], v[44:47], v[72:75]
    ds_read_b128 v[36:39], v12 offset:58368
    v_mfma_f32_16x16x32_bf16 v[76:79], a[204:207], v[44:47], v[76:79]
    s_waitcnt lgkmcnt(4)
    v_mfma_f32_16x16x32_bf16 v[64:67], a[208:211], v[48:51], v[64:67]
    ds_read_b128 v[40:43], v13 offset:57344
    v_mfma_f32_16x16x32_bf16 v[68:71], a[212:215], v[48:51], v[68:71]
    v_mfma_f32_16x16x32_bf16 v[72:75], a[208:211], v[52:55], v[72:75]
    ds_read_b128 v[44:47], v13 offset:58368
    s_add_u32 m0, s34, 3968
    v_mfma_f32_16x16x32_bf16 v[76:79], a[212:215], v[52:55], v[76:79]
    buffer_load_dwordx4 v8, s[12:15], s35 offen offset:128 lds
    s_waitcnt lgkmcnt(4)
    v_mfma_f32_16x16x32_bf16 v[64:67], a[216:219], v[56:59], v[64:67]
    ds_read_b128 v[48:51], v12 offset:61440
    v_mfma_f32_16x16x32_bf16 v[68:71], a[220:223], v[56:59], v[68:71]
    v_mfma_f32_16x16x32_bf16 v[72:75], a[216:219], v[60:63], v[72:75]
    ds_read_b128 v[52:55], v12 offset:62464
    v_mfma_f32_16x16x32_bf16 v[76:79], a[220:223], v[60:63], v[76:79]
    s_waitcnt lgkmcnt(4)
    v_mfma_f32_16x16x32_bf16 v[64:67], a[224:227], v[32:35], v[64:67]
    ds_read_b128 v[56:59], v13 offset:61440
    v_mfma_f32_16x16x32_bf16 v[68:71], a[228:231], v[32:35], v[68:71]
    v_mfma_f32_16x16x32_bf16 v[72:75], a[224:227], v[36:39], v[72:75]
    ds_read_b128 v[60:63], v13 offset:62464
    s_add_u32 m0, s34, 7936
    v_mfma_f32_16x16x32_bf16 v[76:79], a[228:231], v[36:39], v[76:79]
    buffer_load_dwordx4 v8, s[12:15], s35 offen offset:256 lds
    s_waitcnt lgkmcnt(4)
    v_mfma_f32_16x16x32_bf16 v[64:67], a[232:235], v[40:43], v[64:67]
    ds_read_b128 v[32:35], v14 offset:0
    v_mfma_f32_16x16x32_bf16 v[68:71], a[236:239], v[40:43], v[68:71]
    v_mfma_f32_16x16x32_bf16 v[72:75], a[232:235], v[44:47], v[72:75]
    ds_read_b128 v[36:39], v14 offset:1024
    v_mfma_f32_16x16x32_bf16 v[76:79], a[236:239], v[44:47], v[76:79]
    s_waitcnt lgkmcnt(4)
    v_mfma_f32_16x16x32_bf16 v[64:67], a[240:243], v[48:51], v[64:67]
    ds_read_b128 v[40:43], v15 offset:0
    v_mfma_f32_16x16x32_bf16 v[68:71], a[244:247], v[48:51], v[68:71]
    v_mfma_f32_16x16x32_bf16 v[72:75], a[240:243], v[52:55], v[72:75]
    ds_read_b128 v[44:47], v15 offset:1024
    s_add_u32 m0, s34, 11904
    v_mfma_f32_16x16x32_bf16 v[76:79], a[244:247], v[52:55], v[76:79]
    buffer_load_dwordx4 v8, s[12:15], s35 offen offset:384 lds
    s_waitcnt lgkmcnt(4)
    v_mfma_f32_16x16x32_bf16 v[64:67], a[248:251], v[56:59], v[64:67]
    ds_read_b128 v[48:51], v14 offset:4096
    v_mfma_f32_16x16x32_bf16 v[68:71], a[252:255], v[56:59], v[68:71]
    v_mfma_f32_16x16x32_bf16 v[72:75], a[248:251], v[60:63], v[72:75]
    ds_read_b128 v[52:55], v14 offset:5120
    v_mfma_f32_16x16x32_bf16 v[76:79], a[252:255], v[60:63], v[76:79]
    s_waitcnt lgkmcnt(4)
    v_mfma_f32_16x16x32_bf16 v[80:83], a[0:3], v[32:35], 0
    ds_read_b128 v[56:59], v15 offset:4096
    v_mfma_f32_16x16x32_bf16 v[84:87], a[4:7], v[32:35], 0
    v_mfma_f32_16x16x32_bf16 v[88:91], a[0:3], v[36:39], 0
    ds_read_b128 v[60:63], v15 offset:5120
    s_add_u32 m0, s34, 15872
    v_mfma_f32_16x16x32_bf16 v[92:95], a[4:7], v[36:39], 0
    buffer_load_dwordx4 v8, s[12:15], s35 offen offset:512 lds
    s_waitcnt lgkmcnt(4)
    v_mfma_f32_16x16x32_bf16 v[80:83], a[8:11], v[40:43], v[80:83]
    ds_read_b128 v[32:35], v14 offset:8192
    v_mfma_f32_16x16x32_bf16 v[84:87], a[12:15], v[40:43], v[84:87]
    v_mfma_f32_16x16x32_bf16 v[88:91], a[8:11], v[44:47], v[88:91]
    ds_read_b128 v[36:39], v14 offset:9216
    v_mfma_f32_16x16x32_bf16 v[92:95], a[12:15], v[44:47], v[92:95]
    s_waitcnt lgkmcnt(4)
    v_mfma_f32_16x16x32_bf16 v[80:83], a[16:19], v[48:51], v[80:83]
    ds_read_b128 v[40:43], v15 offset:8192
    v_mfma_f32_16x16x32_bf16 v[84:87], a[20:23], v[48:51], v[84:87]
    v_cvt_pk_bf16_f32 v96, v64, v65
    v_mfma_f32_16x16x32_bf16 v[88:91], a[16:19], v[52:55], v[88:91]
    ds_read_b128 v[44:47], v15 offset:9216
    s_add_u32 m0, s34, 19840
    v_mfma_f32_16x16x32_bf16 v[92:95], a[20:23], v[52:55], v[92:95]
    buffer_load_dwordx4 v8, s[12:15], s35 offen offset:640 lds
    v_cvt_pk_bf16_f32 v97, v66, v67
    s_waitcnt lgkmcnt(4)
    v_mfma_f32_16x16x32_bf16 v[80:83], a[24:27], v[56:59], v[80:83]
    ds_read_b128 v[48:51], v14 offset:12288
    v_mfma_f32_16x16x32_bf16 v[84:87], a[28:31], v[56:59], v[84:87]
    v_cvt_pk_bf16_f32 v98, v68, v69
    v_mfma_f32_16x16x32_bf16 v[88:91], a[24:27], v[60:63], v[88:91]
    ds_read_b128 v[52:55], v14 offset:13312
    v_mfma_f32_16x16x32_bf16 v[92:95], a[28:31], v[60:63], v[92:95]
    v_cvt_pk_bf16_f32 v99, v70, v71
    s_waitcnt lgkmcnt(4)
    v_mfma_f32_16x16x32_bf16 v[80:83], a[32:35], v[32:35], v[80:83]
    ds_read_b128 v[56:59], v15 offset:12288
    v_mfma_f32_16x16x32_bf16 v[84:87], a[36:39], v[32:35], v[84:87]
    v_cvt_pk_bf16_f32 v100, v72, v73
    v_mfma_f32_16x16x32_bf16 v[88:91], a[32:35], v[36:39], v[88:91]
    ds_read_b128 v[60:63], v15 offset:13312
    s_add_u32 m0, s34, 23808
    v_mfma_f32_16x16x32_bf16 v[92:95], a[36:39], v[36:39], v[92:95]
    buffer_load_dwordx4 v8, s[12:15], s35 offen offset:768 lds
    v_cvt_pk_bf16_f32 v101, v74, v75
    s_waitcnt lgkmcnt(4)
    v_mfma_f32_16x16x32_bf16 v[80:83], a[40:43], v[40:43], v[80:83]
    ds_read_b128 v[32:35], v14 offset:16384
    v_mfma_f32_16x16x32_bf16 v[84:87], a[44:47], v[40:43], v[84:87]
    v_cvt_pk_bf16_f32 v102, v76, v77
    v_mfma_f32_16x16x32_bf16 v[88:91], a[40:43], v[44:47], v[88:91]
    ds_read_b128 v[36:39], v14 offset:17408
    v_mfma_f32_16x16x32_bf16 v[92:95], a[44:47], v[44:47], v[92:95]
    v_cvt_pk_bf16_f32 v103, v78, v79
    buffer_store_dwordx4 v[96:99], v9, s[4:7], s36 offen sc1
    s_waitcnt lgkmcnt(4)
    v_mfma_f32_16x16x32_bf16 v[80:83], a[48:51], v[48:51], v[80:83]
    ds_read_b128 v[40:43], v15 offset:16384
    v_mfma_f32_16x16x32_bf16 v[84:87], a[52:55], v[48:51], v[84:87]
    v_mfma_f32_16x16x32_bf16 v[88:91], a[48:51], v[52:55], v[88:91]
    ds_read_b128 v[44:47], v15 offset:17408
    s_add_u32 m0, s34, 27776
    v_mfma_f32_16x16x32_bf16 v[92:95], a[52:55], v[52:55], v[92:95]
    buffer_load_dwordx4 v8, s[12:15], s35 offen offset:896 lds
    s_waitcnt lgkmcnt(4)
    v_mfma_f32_16x16x32_bf16 v[80:83], a[56:59], v[56:59], v[80:83]
    ds_read_b128 v[48:51], v14 offset:20480
    v_mfma_f32_16x16x32_bf16 v[84:87], a[60:63], v[56:59], v[84:87]
    v_mfma_f32_16x16x32_bf16 v[88:91], a[56:59], v[60:63], v[88:91]
    ds_read_b128 v[52:55], v14 offset:21504
    v_mfma_f32_16x16x32_bf16 v[92:95], a[60:63], v[60:63], v[92:95]
    buffer_store_dwordx4 v[100:103], v9, s[4:7], s36 offen offset:128 sc1
    s_add_u32 s36, s36, s37
    s_waitcnt vmcnt(8)
    s_barrier
    s_waitcnt lgkmcnt(4)
    v_mfma_f32_16x16x32_bf16 v[80:83], a[64:67], v[32:35], v[80:83]
    ds_read_b128 v[56:59], v15 offset:20480
    v_mfma_f32_16x16x32_bf16 v[84:87], a[68:71], v[32:35], v[84:87]
    v_mfma_f32_16x16x32_bf16 v[88:91], a[64:67], v[36:39], v[88:91]
    ds_read_b128 v[60:63], v15 offset:21504
    s_add_u32 m0, s34, 31744
    v_mfma_f32_16x16x32_bf16 v[92:95], a[68:71], v[36:39], v[92:95]
    buffer_load_dwordx4 v8, s[12:15], s35 offen offset:1024 lds
    s_waitcnt lgkmcnt(4)
    v_mfma_f32_16x16x32_bf16 v[80:83], a[72:75], v[40:43], v[80:83]
    ds_read_b128 v[32:35], v14 offset:24576
    v_mfma_f32_16x16x32_bf16 v[84:87], a[76:79], v[40:43], v[84:87]
    v_mfma_f32_16x16x32_bf16 v[88:91], a[72:75], v[44:47], v[88:91]
    ds_read_b128 v[36:39], v14 offset:25600
    v_mfma_f32_16x16x32_bf16 v[92:95], a[76:79], v[44:47], v[92:95]
    s_waitcnt lgkmcnt(4)
    v_mfma_f32_16x16x32_bf16 v[80:83], a[80:83], v[48:51], v[80:83]
    ds_read_b128 v[40:43], v15 offset:24576
    v_mfma_f32_16x16x32_bf16 v[84:87], a[84:87], v[48:51], v[84:87]
    v_mfma_f32_16x16x32_bf16 v[88:91], a[80:83], v[52:55], v[88:91]
    ds_read_b128 v[44:47], v15 offset:25600
    s_add_u32 m0, s34, 35712
    v_mfma_f32_16x16x32_bf16 v[92:95], a[84:87], v[52:55], v[92:95]
    buffer_load_dwordx4 v8, s[12:15], s35 offen offset:1152 lds
    s_waitcnt lgkmcnt(4)
    v_mfma_f32_16x16x32_bf16 v[80:83], a[88:91], v[56:59], v[80:83]
    ds_read_b128 v[48:51], v14 offset:28672
    v_mfma_f32_16x16x32_bf16 v[84:87], a[92:95], v[56:59], v[84:87]
    v_mfma_f32_16x16x32_bf16 v[88:91], a[88:91], v[60:63], v[88:91]
    ds_read_b128 v[52:55], v14 offset:29696
    v_mfma_f32_16x16x32_bf16 v[92:95], a[92:95], v[60:63], v[92:95]
    s_waitcnt lgkmcnt(4)
    v_mfma_f32_16x16x32_bf16 v[80:83], a[96:99], v[32:35], v[80:83]
    ds_read_b128 v[56:59], v15 offset:28672
    v_mfma_f32_16x16x32_bf16 v[84:87], a[100:103], v[32:35], v[84:87]
    v_mfma_f32_16x16x32_bf16 v[88:91], a[96:99], v[36:39], v[88:91]
    ds_read_b128 v[60:63], v15 offset:29696
    s_add_u32 m0, s34, 39680
    v_mfma_f32_16x16x32_bf16 v[92:95], a[100:103], v[36:39], v[92:95]
    buffer_load_dwordx4 v8, s[12:15], s35 offen offset:1280 lds
    s_waitcnt lgkmcnt(4)
    v_mfma_f32_16x16x32_bf16 v[80:83], a[104:107], v[40:43], v[80:83]
    ds_read_b128 v[32:35], v14 offset:32768
    v_mfma_f32_16x16x32_bf16 v[84:87], a[108:111], v[40:43], v[84:87]
    v_mfma_f32_16x16x32_bf16 v[88:91], a[104:107], v[44:47], v[88:91]
    ds_read_b128 v[36:39], v14 offset:33792
    v_mfma_f32_16x16x32_bf16 v[92:95], a[108:111], v[44:47], v[92:95]
    s_waitcnt lgkmcnt(4)
    v_mfma_f32_16x16x32_bf16 v[80:83], a[112:115], v[48:51], v[80:83]
    ds_read_b128 v[40:43], v15 offset:32768
    v_mfma_f32_16x16x32_bf16 v[84:87], a[116:119], v[48:51], v[84:87]
    v_mfma_f32_16x16x32_bf16 v[88:91], a[112:115], v[52:55], v[88:91]
    ds_read_b128 v[44:47], v15 offset:33792
    s_add_u32 m0, s34, 43648
    v_mfma_f32_16x16x32_bf16 v[92:95], a[116:119], v[52:55], v[92:95]
    buffer_load_dwordx4 v8, s[12:15], s35 offen offset:1408 lds
    s_waitcnt lgkmcnt(4)
    v_mfma_f32_16x16x32_bf16 v[80:83], a[120:123], v[56:59], v[80:83]
    ds_read_b128 v[48:51], v14 offset:36864
    v_mfma_f32_16x16x32_bf16 v[84:87], a[124:127], v[56:59], v[84:87]
    v_mfma_f32_16x16x32_bf16 v[88:91], a[120:123], v[60:63], v[88:91]
    ds_read_b128 v[52:55], v14 offset:37888
    v_mfma_f32_16x16x32_bf16 v[92:95], a[124:127], v[60:63], v[92:95]
    s_waitcnt lgkmcnt(4)
    v_mfma_f32_16x16x32_bf16 v[80:83], a[128:131], v[32:35], v[80:83]
    ds_read_b128 v[56:59], v15 offset:36864
    v_mfma_f32_16x16x32_bf16 v[84:87], a[132:135], v[32:35], v[84:87]
    v_mfma_f32_16x16x32_bf16 v[88:91], a[128:131], v[36:39], v[88:91]
    ds_read_b128 v[60:63], v15 offset:37888
    s_add_u32 m0, s34, 47616
    v_mfma_f32_16x16x32_bf16 v[92:95], a[132:135], v[36:39], v[92:95]
    buffer_load_dwordx4 v8, s[12:15], s35 offen offset:1536 lds
    s_waitcnt lgkmcnt(4)
    v_mfma_f32_16x16x32_bf16 v[80:83], a[136:139], v[40:43], v[80:83]
    ds_read_b128 v[32:35], v14 offset:40960
    v_mfma_f32_16x16x32_bf16 v[84:87], a[140:143], v[40:43], v[84:87]
    v_mfma_f32_16x16x32_bf16 v[88:91], a[136:139], v[44:47], v[88:91]
    ds_read_b128 v[36:39], v14 offset:41984
    v_mfma_f32_16x16x32_bf16 v[92:95], a[140:143], v[44:47], v[92:95]
    s_waitcnt lgkmcnt(4)
    v_mfma_f32_16x16x32_bf16 v[80:83], a[144:147], v[48:51], v[80:83]
    ds_read_b128 v[40:43], v15 offset:40960
    v_mfma_f32_16x16x32_bf16 v[84:87], a[148:151], v[48:51], v[84:87]
    v_mfma_f32_16x16x32_bf16 v[88:91], a[144:147], v[52:55], v[88:91]
    ds_read_b128 v[44:47], v15 offset:41984
    s_add_u32 m0, s34, 51584
    v_mfma_f32_16x16x32_bf16 v[92:95], a[148:151], v[52:55], v[92:95]
    buffer_load_dwordx4 v8, s[12:15], s35 offen offset:1664 lds
    s_waitcnt lgkmcnt(4)
    v_mfma_f32_16x16x32_bf16 v[80:83], a[152:155], v[56:59], v[80:83]
    ds_read_b128 v[48:51], v14 offset:45056
    v_mfma_f32_16x16x32_bf16 v[84:87], a[156:159], v[56:59], v[84:87]
    v_mfma_f32_16x16x32_bf16 v[88:91], a[152:155], v[60:63], v[88:91]
    ds_read_b128 v[52:55], v14 offset:46080
    v_mfma_f32_16x16x32_bf16 v[92:95], a[156:159], v[60:63], v[92:95]
    s_waitcnt lgkmcnt(4)
    v_mfma_f32_16x16x32_bf16 v[80:83], a[160:163], v[32:35], v[80:83]
    ds_read_b128 v[56:59], v15 offset:45056
    v_mfma_f32_16x16x32_bf16 v[84:87], a[164:167], v[32:35], v[84:87]
    v_mfma_f32_16x16x32_bf16 v[88:91], a[160:163], v[36:39], v[88:91]
    ds_read_b128 v[60:63], v15 offset:46080
    s_add_u32 m0, s34, 55552
    v_mfma_f32_16x16x32_bf16 v[92:95], a[164:167], v[36:39], v[92:95]
    buffer_load_dwordx4 v8, s[12:15], s35 offen offset:1792 lds
    s_waitcnt lgkmcnt(4)
    v_mfma_f32_16x16x32_bf16 v[80:83], a[168:171], v[40:43], v[80:83]
    ds_read_b128 v[32:35], v14 offset:49152
    v_mfma_f32_16x16x32_bf16 v[84:87], a[172:175], v[40:43], v[84:87]
    v_mfma_f32_16x16x32_bf16 v[88:91], a[168:171], v[44:47], v[88:91]
    ds_read_b128 v[36:39], v14 offset:50176
    v_mfma_f32_16x16x32_bf16 v[92:95], a[172:175], v[44:47], v[92:95]
    s_waitcnt lgkmcnt(4)
    v_mfma_f32_16x16x32_bf16 v[80:83], a[176:179], v[48:51], v[80:83]
    ds_read_b128 v[40:43], v15 offset:49152
    v_mfma_f32_16x16x32_bf16 v[84:87], a[180:183], v[48:51], v[84:87]
    v_mfma_f32_16x16x32_bf16 v[88:91], a[176:179], v[52:55], v[88:91]
    ds_read_b128 v[44:47], v15 offset:50176
    s_add_u32 m0, s34, 59520
    v_mfma_f32_16x16x32_bf16 v[92:95], a[180:183], v[52:55], v[92:95]
    buffer_load_dwordx4 v8, s[12:15], s35 offen offset:1920 lds
    s_add_u32 s35, s35, 65536
    s_min_u32 s35, s35, s52
    s_waitcnt lgkmcnt(4)
    v_mfma_f32_16x16x32_bf16 v[80:83], a[184:187], v[56:59], v[80:83]
    ds_read_b128 v[48:51], v14 offset:53248
    v_mfma_f32_16x16x32_bf16 v[84:87], a[188:191], v[56:59], v[84:87]
    v_mfma_f32_16x16x32_bf16 v[88:91], a[184:187], v[60:63], v[88:91]
    ds_read_b128 v[52:55], v14 offset:54272
    v_mfma_f32_16x16x32_bf16 v[92:95], a[188:191], v[60:63], v[92:95]
    s_waitcnt vmcnt(8)
    s_barrier
    s_waitcnt lgkmcnt(4)
    v_mfma_f32_16x16x32_bf16 v[80:83], a[192:195], v[32:35], v[80:83]
    ds_read_b128 v[56:59], v15 offset:53248
    v_mfma_f32_16x16x32_bf16 v[84:87], a[196:199], v[32:35], v[84:87]
    v_mfma_f32_16x16x32_bf16 v[88:91], a[192:195], v[36:39], v[88:91]
    ds_read_b128 v[60:63], v15 offset:54272
    s_add_u32 m0, s34, 65536
    v_mfma_f32_16x16x32_bf16 v[92:95], a[196:199], v[36:39], v[92:95]
    buffer_load_dwordx4 v8, s[12:15], s35 offen offset:0 lds
    s_waitcnt lgkmcnt(4)
    v_mfma_f32_16x16x32_bf16 v[80:83], a[200:203], v[40:43], v[80:83]
    ds_read_b128 v[32:35], v14 offset:57344
    v_mfma_f32_16x16x32_bf16 v[84:87], a[204:207], v[40:43], v[84:87]
    buffer_store_dword v11, v10, s[4:7], 0 offen sc1
    v_add_u32 v11, 1, v11
    v_mfma_f32_16x16x32_bf16 v[88:91], a[200:203], v[44:47], v[88:91]
    ds_read_b128 v[36:39], v14 offset:58368
    v_mfma_f32_16x16x32_bf16 v[92:95], a[204:207], v[44:47], v[92:95]
    s_waitcnt lgkmcnt(4)
    v_mfma_f32_16x16x32_bf16 v[80:83], a[208:211], v[48:51], v[80:83]
    ds_read_b128 v[40:43], v15 offset:57344
    v_mfma_f32_16x16x32_bf16 v[84:87], a[212:215], v[48:51], v[84:87]
    v_mfma_f32_16x16x32_bf16 v[88:91], a[208:211], v[52:55], v[88:91]
    ds_read_b128 v[44:47], v15 offset:58368
    s_add_u32 m0, s34, 69504
    v_mfma_f32_16x16x32_bf16 v[92:95], a[212:215], v[52:55], v[92:95]
    buffer_load_dwordx4 v8, s[12:15], s35 offen offset:128 lds
    s_waitcnt lgkmcnt(4)
    v_mfma_f32_16x16x32_bf16 v[80:83], a[216:219], v[56:59], v[80:83]
    ds_read_b128 v[48:51], v14 offset:61440
    v_mfma_f32_16x16x32_bf16 v[84:87], a[220:223], v[56:59], v[84:87]
    v_mfma_f32_16x16x32_bf16 v[88:91], a[216:219], v[60:63], v[88:91]
    ds_read_b128 v[52:55], v14 offset:62464
    v_mfma_f32_16x16x32_bf16 v[92:95], a[220:223], v[60:63], v[92:95]
    s_waitcnt lgkmcnt(4)
    v_mfma_f32_16x16x32_bf16 v[80:83], a[224:227], v[32:35], v[80:83]
    ds_read_b128 v[56:59], v15 offset:61440
    v_mfma_f32_16x16x32_bf16 v[84:87], a[228:231], v[32:35], v[84:87]
    v_mfma_f32_16x16x32_bf16 v[88:91], a[224:227], v[36:39], v[88:91]
    ds_read_b128 v[60:63], v15 offset:62464
    s_add_u32 m0, s34, 73472
    v_mfma_f32_16x16x32_bf16 v[92:95], a[228:231], v[36:39], v[92:95]
    buffer_load_dwordx4 v8, s[12:15], s35 offen offset:256 lds
    s_waitcnt lgkmcnt(4)
    v_mfma_f32_16x16x32_bf16 v[80:83], a[232:235], v[40:43], v[80:83]
    ds_read_b128 v[32:35], v12 offset:0
    v_mfma_f32_16x16x32_bf16 v[84:87], a[236:239], v[40:43], v[84:87]
    v_mfma_f32_16x16x32_bf16 v[88:91], a[232:235], v[44:47], v[88:91]
    ds_read_b128 v[36:39], v12 offset:1024
    v_mfma_f32_16x16x32_bf16 v[92:95], a[236:239], v[44:47], v[92:95]
    s_waitcnt lgkmcnt(4)
    v_mfma_f32_16x16x32_bf16 v[80:83], a[240:243], v[48:51], v[80:83]
    ds_read_b128 v[40:43], v13 offset:0
    v_mfma_f32_16x16x32_bf16 v[84:87], a[244:247], v[48:51], v[84:87]
    v_mfma_f32_16x16x32_bf16 v[88:91], a[240:243], v[52:55], v[88:91]
    ds_read_b128 v[44:47], v13 offset:1024
    s_add_u32 m0, s34, 77440
    v_mfma_f32_16x16x32_bf16 v[92:95], a[244:247], v[52:55], v[92:95]
    buffer_load_dwordx4 v8, s[12:15], s35 offen offset:384 lds
    s_waitcnt lgkmcnt(4)
    v_mfma_f32_16x16x32_bf16 v[80:83], a[248:251], v[56:59], v[80:83]
    ds_read_b128 v[48:51], v12 offset:4096
    v_mfma_f32_16x16x32_bf16 v[84:87], a[252:255], v[56:59], v[84:87]
    v_mfma_f32_16x16x32_bf16 v[88:91], a[248:251], v[60:63], v[88:91]
    ds_read_b128 v[52:55], v12 offset:5120
    v_mfma_f32_16x16x32_bf16 v[92:95], a[252:255], v[60:63], v[92:95]
    s_add_u32 s30, s30, 2
    s_cmp_lt_u32 s30, s51
    s_cbranch_scc1 sl_loop_56
    v_cvt_pk_bf16_f32 v96, v80, v81
    v_cvt_pk_bf16_f32 v97, v82, v83
    v_cvt_pk_bf16_f32 v98, v84, v85
    v_cvt_pk_bf16_f32 v99, v86, v87
    v_cvt_pk_bf16_f32 v100, v88, v89
    v_cvt_pk_bf16_f32 v101, v90, v91
    v_cvt_pk_bf16_f32 v102, v92, v93
    v_cvt_pk_bf16_f32 v103, v94, v95
    s_branch sl_e_55
sl_v_54:
sl_loop_57:
    s_waitcnt lgkmcnt(4)
    v_mfma_f32_16x16x32_bf16 v[64:67], v[32:35], a[0:3], 0
    ds_read_b128 v[56:59], v13 offset:4096
    v_mfma_f32_16x16x32_bf16 v[68:71], v[32:35], a[4:7], 0
    v_mfma_f32_16x16x32_bf16 v[72:75], v[36:39], a[0:3], 0
    ds_read_b128 v[60:63], v13 offset:5120
    s_add_u32 m0, s34, 81408
    v_mfma_f32_16x16x32_bf16 v[76:79], v[36:39], a[4:7], 0
    buffer_load_dwordx4 v8, s[12:15], s35 offen offset:512 lds
    s_waitcnt lgkmcnt(4)
    v_mfma_f32_16x16x32_bf16 v[64:67], v[40:43], a[8:11], v[64:67]
    ds_read_b128 v[32:35], v12 offset:8192
    v_mfma_f32_16x16x32_bf16 v[68:71], v[40:43], a[12:15], v[68:71]
    v_mfma_f32_16x16x32_bf16 v[72:75], v[44:47], a[8:11], v[72:75]
    ds_read_b128 v[36:39], v12 offset:9216
    v_mfma_f32_16x16x32_bf16 v[76:79], v[44:47], a[12:15], v[76:79]
    s_waitcnt lgkmcnt(4)
    v_mfma_f32_16x16x32_bf16 v[64:67], v[48:51], a[16:19], v[64:67]
    ds_read_b128 v[40:43], v13 offset:8192
    v_mfma_f32_16x16x32_bf16 v[68:71], v[48:51], a[20:23], v[68:71]
    v_cvt_pk_bf16_f32 v96, v80, v81
    v_mfma_f32_16x16x32_bf16 v[72:75], v[52:55], a[16:19], v[72:75]
    ds_read_b128 v[44:47], v13 offset:9216
    s_add_u32 m0, s34, 85376
    v_mfma_f32_16x16x32_bf16 v[76:79], v[52:55], a[20:23], v[76:79]
    buffer_load_dwordx4 v8, s[12:15], s35 offen offset:640 lds
    v_cvt_pk_bf16_f32 v97, v82, v83
    s_waitcnt lgkmcnt(4)
    v_mfma_f32_16x16x32_bf16 v[64:67], v[56:59], a[24:27], v[64:67]
    ds_read_b128 v[48:51], v12 offset:12288
    v_mfma_f32_16x16x32_bf16 v[68:71], v[56:59], a[28:31], v[68:71]
    v_cvt_pk_bf16_f32 v98, v88, v89
    v_mfma_f32_16x16x32_bf16 v[72:75], v[60:63], a[24:27], v[72:75]
    ds_read_b128 v[52:55], v12 offset:13312
    v_mfma_f32_16x16x32_bf16 v[76:79], v[60:63], a[28:31], v[76:79]
    v_cvt_pk_bf16_f32 v99, v90, v91
    s_waitcnt lgkmcnt(4)
    v_mfma_f32_16x16x32_bf16 v[64:67], v[32:35], a[32:35], v[64:67]
    ds_read_b128 v[56:59], v13 offset:12288
    v_mfma_f32_16x16x32_bf16 v[68:71], v[32:35], a[36:39], v[68:71]
    v_cvt_pk_bf16_f32 v100, v84, v85
    v_mfma_f32_16x16x32_bf16 v[72:75], v[36:39], a[32:35], v[72:75]
    ds_read_b128 v[60:63], v13 offset:13312
    s_add_u32 m0, s34, 89344
    v_mfma_f32_16x16x32_bf16 v[76:79], v[36:39], a[36:39], v[76:79]
    buffer_load_dwordx4 v8, s[12:15], s35 offen offset:768 lds
    v_cvt_pk_bf16_f32 v101, v86, v87
    s_waitcnt lgkmcnt(4)
    v_mfma_f32_16x16x32_bf16 v[64:67], v[40:43], a[40:43], v[64:67]
    ds_read_b128 v[32:35], v12 offset:16384
    v_mfma_f32_16x16x32_bf16 v[68:71], v[40:43], a[44:47], v[68:71]
    v_cvt_pk_bf16_f32 v102, v92, v93
    v_mfma_f32_16x16x32_bf16 v[72:75], v[44:47], a[40:43], v[72:75]
    ds_read_b128 v[36:39], v12 offset:17408
    v_mfma_f32_16x16x32_bf16 v[76:79], v[44:47], a[44:47], v[76:79]
    v_cvt_pk_bf16_f32 v103, v94, v95
    buffer_store_dwordx4 v[96:99], v9, s[4:7], s36 offen sc1
    s_waitcnt lgkmcnt(4)
    v_mfma_f32_16x16x32_bf16 v[64:67], v[48:51], a[48:51], v[64:67]
    ds_read_b128 v[40:43], v13 offset:16384
    v_mfma_f32_16x16x32_bf16 v[68:71], v[48:51], a[52:55], v[68:71]
    v_mfma_f32_16x16x32_bf16 v[72:75], v[52:55], a[48:51], v[72:75]
    ds_read_b128 v[44:47], v13 offset:17408
    s_add_u32 m0, s34, 93312
    v_mfma_f32_16x16x32_bf16 v[76:79], v[52:55], a[52:55], v[76:79]
    buffer_load_dwordx4 v8, s[12:15], s35 offen offset:896 lds
    s_waitcnt lgkmcnt(4)
    v_mfma_f32_16x16x32_bf16 v[64:67], v[56:59], a[56:59], v[64:67]
    ds_read_b128 v[48:51], v12 offset:20480
    v_mfma_f32_16x16x32_bf16 v[68:71], v[56:59], a[60:63], v[68:71]
    v_mfma_f32_16x16x32_bf16 v[72:75], v[60:63], a[56:59], v[72:75]
    ds_read_b128 v[52:55], v12 offset:21504
    v_mfma_f32_16x16x32_bf16 v[76:79], v[60:63], a[60:63], v[76:79]
    buffer_store_dwordx4 v[100:103], v9, s[4:7], s36 offen offset:128 sc1
    s_add_u32 s36, s36, s37
    s_waitcnt vmcnt(8)
    s_barrier
    s_waitcnt lgkmcnt(4)
    v_mfma_f32_16x16x32_bf16 v[64:67], v[32:35], a[64:67], v[64:67]
    ds_read_b128 v[56:59], v13 offset:20480
    v_mfma_f32_16x16x32_bf16 v[68:71], v[32:35], a[68:71], v[68:71]
    v_mfma_f32_16x16x32_bf16 v[72:75], v[36:39], a[64:67], v[72:75]
    ds_read_b128 v[60:63], v13 offset:21504
    s_add_u32 m0, s34, 97280
    v_mfma_f32_16x16x32_bf16 v[76:79], v[36:39], a[68:71], v[76:79]
    buffer_load_dwordx4 v8, s[12:15], s35 offen offset:1024 lds
    s_waitcnt lgkmcnt(4)
    v_mfma_f32_16x16x32_bf16 v[64:67], v[40:43], a[72:75], v[64:67]
    ds_read_b128 v[32:35], v12 offset:24576
    v_mfma_f32_16x16x32_bf16 v[68:71], v[40:43], a[76:79], v[68:71]
    v_mfma_f32_16x16x32_bf16 v[72:75], v[44:47], a[72:75], v[72:75]
    ds_read_b128 v[36:39], v12 offset:25600
    v_mfma_f32_16x16x32_bf16 v[76:79], v[44:47], a[76:79], v[76:79]
    s_waitcnt lgkmcnt(4)
    v_mfma_f32_16x16x32_bf16 v[64:67], v[48:51], a[80:83], v[64:67]
    ds_read_b128 v[40:43], v13 offset:24576
    v_mfma_f32_16x16x32_bf16 v[68:71], v[48:51], a[84:87], v[68:71]
    v_and_b32 v9, 0xffffff, v9
    v_mfma_f32_16x16x32_bf16 v[72:75], v[52:55], a[80:83], v[72:75]
    ds_read_b128 v[44:47], v13 offset:25600
    s_add_u32 m0, s34, 101248
    v_mfma_f32_16x16x32_bf16 v[76:79], v[52:55], a[84:87], v[76:79]
    buffer_load_dwordx4 v8, s[12:15], s35 offen offset:1152 lds
    s_waitcnt lgkmcnt(4)
    v_mfma_f32_16x16x32_bf16 v[64:67], v[56:59], a[88:91], v[64:67]
    ds_read_b128 v[48:51], v12 offset:28672
    v_mfma_f32_16x16x32_bf16 v[68:71], v[56:59], a[92:95], v[68:71]
    v_mfma_f32_16x16x32_bf16 v[72:75], v[60:63], a[88:91], v[72:75]
    ds_read_b128 v[52:55], v12 offset:29696
    v_mfma_f32_16x16x32_bf16 v[76:79], v[60:63], a[92:95], v[76:79]
    s_waitcnt lgkmcnt(4)
    v_mfma_f32_16x16x32_bf16 v[64:67], v[32:35], a[96:99], v[64:67]
    ds_read_b128 v[56:59], v13 offset:28672
    v_mfma_f32_16x16x32_bf16 v[68:71], v[32:35], a[100:103], v[68:71]
    v_mfma_f32_16x16x32_bf16 v[72:75], v[36:39], a[96:99], v[72:75]
    ds_read_b128 v[60:63], v13 offset:29696
    s_add_u32 m0, s34, 105216
    v_mfma_f32_16x16x32_bf16 v[76:79], v[36:39], a[100:103], v[76:79]
    buffer_load_dwordx4 v8, s[12:15], s35 offen offset:1280 lds
    s_waitcnt lgkmcnt(4)
    v_mfma_f32_16x16x32_bf16 v[64:67], v[40:43], a[104:107], v[64:67]
    ds_read_b128 v[32:35], v12 offset:32768
    v_mfma_f32_16x16x32_bf16 v[68:71], v[40:43], a[108:111], v[68:71]
    v_mfma_f32_16x16x32_bf16 v[72:75], v[44:47], a[104:107], v[72:75]
    ds_read_b128 v[36:39], v12 offset:33792
    v_mfma_f32_16x16x32_bf16 v[76:79], v[44:47], a[108:111], v[76:79]
    s_waitcnt lgkmcnt(4)
    v_mfma_f32_16x16x32_bf16 v[64:67], v[48:51], a[112:115], v[64:67]
    ds_read_b128 v[40:43], v13 offset:32768
    v_mfma_f32_16x16x32_bf16 v[68:71], v[48:51], a[116:119], v[68:71]
    v_mfma_f32_16x16x32_bf16 v[72:75], v[52:55], a[112:115], v[72:75]
    ds_read_b128 v[44:47], v13 offset:33792
    s_add_u32 m0, s34, 109184
    v_mfma_f32_16x16x32_bf16 v[76:79], v[52:55], a[116:119], v[76:79]
    buffer_load_dwordx4 v8, s[12:15], s35 offen offset:1408 lds
    s_waitcnt lgkmcnt(4)
    v_mfma_f32_16x16x32_bf16 v[64:67], v[56:59], a[120:123], v[64:67]
    ds_read_b128 v[48:51], v12 offset:36864
    v_mfma_f32_16x16x32_bf16 v[68:71], v[56:59], a[124:127], v[68:71]
    v_mfma_f32_16x16x32_bf16 v[72:75], v[60:63], a[120:123], v[72:75]
    ds_read_b128 v[52:55], v12 offset:37888
    v_mfma_f32_16x16x32_bf16 v[76:79], v[60:63], a[124:127], v[76:79]
    s_waitcnt lgkmcnt(4)
    v_mfma_f32_16x16x32_bf16 v[64:67], v[32:35], a[128:131], v[64:67]
    ds_read_b128 v[56:59], v13 offset:36864
    v_mfma_f32_16x16x32_bf16 v[68:71], v[32:35], a[132:135], v[68:71]
    v_mfma_f32_16x16x32_bf16 v[72:75], v[36:39], a[128:131], v[72:75]
    ds_read_b128 v[60:63], v13 offset:37888
    s_add_u32 m0, s34, 113152
    v_mfma_f32_16x16x32_bf16 v[76:79], v[36:39], a[132:135], v[76:79]
    buffer_load_dwordx4 v8, s[12:15], s35 offen offset:1536 lds
    s_waitcnt lgkmcnt(4)
    v_mfma_f32_16x16x32_bf16 v[64:67], v[40:43], a[136:139], v[64:67]
    ds_read_b128 v[32:35], v12 offset:40960
    v_mfma_f32_16x16x32_bf16 v[68:71], v[40:43], a[140:143], v[68:71]
    v_mfma_f32_16x16x32_bf16 v[72:75], v[44:47], a[136:139], v[72:75]
    ds_read_b128 v[36:39], v12 offset:41984
    v_mfma_f32_16x16x32_bf16 v[76:79], v[44:47], a[140:143], v[76:79]
    s_waitcnt lgkmcnt(4)
    v_mfma_f32_16x16x32_bf16 v[64:67], v[48:51], a[144:147], v[64:67]
    ds_read_b128 v[40:43], v13 offset:40960
    v_mfma_f32_16x16x32_bf16 v[68:71], v[48:51], a[148:151], v[68:71]
    v_mfma_f32_16x16x32_bf16 v[72:75], v[52:55], a[144:147], v[72:75]
    ds_read_b128 v[44:47], v13 offset:41984
    s_add_u32 m0, s34, 117120
    v_mfma_f32_16x16x32_bf16 v[76:79], v[52:55], a[148:151], v[76:79]
    buffer_load_dwordx4 v8, s[12:15], s35 offen offset:1664 lds
    s_waitcnt lgkmcnt(4)
    v_mfma_f32_16x16x32_bf16 v[64:67], v[56:59], a[152:155], v[64:67]
    ds_read_b128 v[48:51], v12 offset:45056
    v_mfma_f32_16x16x32_bf16 v[68:71], v[56:59], a[156:159], v[68:71]
    v_mfma_f32_16x16x32_bf16 v[72:75], v[60:63], a[152:155], v[72:75]
    ds_read_b128 v[52:55], v12 offset:46080
    v_mfma_f32_16x16x32_bf16 v[76:79], v[60:63], a[156:159], v[76:79]
    s_waitcnt lgkmcnt(4)
    v_mfma_f32_16x16x32_bf16 v[64:67], v[32:35], a[160:163], v[64:67]
    ds_read_b128 v[56:59], v13 offset:45056
    v_mfma_f32_16x16x32_bf16 v[68:71], v[32:35], a[164:167], v[68:71]
    v_mfma_f32_16x16x32_bf16 v[72:75], v[36:39], a[160:163], v[72:75]
    ds_read_b128 v[60:63], v13 offset:46080
    s_add_u32 m0, s34, 121088
    v_mfma_f32_16x16x32_bf16 v[76:79], v[36:39], a[164:167], v[76:79]
    buffer_load_dwordx4 v8, s[12:15], s35 offen offset:1792 lds
    s_waitcnt lgkmcnt(4)
    v_mfma_f32_16x16x32_bf16 v[64:67], v[40:43], a[168:171], v[64:67]
    ds_read_b128 v[32:35], v12 offset:49152
    v_mfma_f32_16x16x32_bf16 v[68:71], v[40:43], a[172:175], v[68:71]
    v_mfma_f32_16x16x32_bf16 v[72:75], v[44:47], a[168:171], v[72:75]
    ds_read_b128 v[36:39], v12 offset:50176
    v_mfma_f32_16x16x32_bf16 v[76:79], v[44:47], a[172:175], v[76:79]
    s_waitcnt lgkmcnt(4)
    v_mfma_f32_16x16x32_bf16 v[64:67], v[48:51], a[176:179], v[64:67]
    ds_read_b128 v[40:43], v13 offset:49152
    v_mfma_f32_16x16x32_bf16 v[68:71], v[48:51], a[180:183], v[68:71]
    v_mfma_f32_16x16x32_bf16 v[72:75], v[52:55], a[176:179], v[72:75]
    ds_read_b128 v[44:47], v13 offset:50176
    s_add_u32 m0, s34, 125056
    v_mfma_f32_16x16x32_bf16 v[76:79], v[52:55], a[180:183], v[76:79]
    buffer_load_dwordx4 v8, s[12:15], s35 offen offset:1920 lds
    s_add_u32 s35, s35, 65536
    s_min_u32 s35, s35, s52
    s_waitcnt lgkmcnt(4)
    v_mfma_f32_16x16x32_bf16 v[64:67], v[56:59], a[184:187], v[64:67]
    ds_read_b128 v[48:51], v12 offset:53248
    v_mfma_f32_16x16x32_bf16 v[68:71], v[56:59], a[188:191], v[68:71]
    v_mfma_f32_16x16x32_bf16 v[72:75], v[60:63], a[184:187], v[72:75]
    ds_read_b128 v[52:55], v12 offset:54272
    v_mfma_f32_16x16x32_bf16 v[76:79], v[60:63], a[188:191], v[76:79]
    s_waitcnt vmcnt(8)
    s_barrier
    s_waitcnt lgkmcnt(4)
    v_mfma_f32_16x16x32_bf16 v[64:67], v[32:35], a[192:195], v[64:67]
    ds_read_b128 v[56:59], v13 offset:53248
    v_mfma_f32_16x16x32_bf16 v[68:71], v[32:35], a[196:199], v[68:71]
    v_mfma_f32_16x16x32_bf16 v[72:75], v[36:39], a[192:195], v[72:75]
    ds_read_b128 v[60:63], v13 offset:54272
    s_add_u32 m0, s34, 0
    v_mfma_f32_16x16x32_bf16 v[76:79], v[36:39], a[196:199], v[76:79]
    buffer_load_dwordx4 v8, s[12:15], s35 offen offset:0 lds
    s_waitcnt lgkmcnt(4)
    v_mfma_f32_16x16x32_bf16 v[64:67], v[40:43], a[200:203], v[64:67]
    ds_read_b128 v[32:35], v12 offset:57344
    v_mfma_f32_16x16x32_bf16 v[68:71], v[40:43], a[204:207], v[68:71]
    buffer_store_dword v11, v10, s[4:7], 0 offen sc1
    v_add_u32 v11, 1, v11
    v_mfma_f32_16x16x32_bf16 v[72:75], v[44:47], a[200:203], v[72:75]
    ds_read_b128 v[36:39], v12 offset:58368
    v_mfma_f32_16x16x32_bf16 v[76:79], v[44:47], a[204:207], v[76:79]
    s_waitcnt lgkmcnt(4)
    v_mfma_f32_16x16x32_bf16 v[64:67], v[48:51], a[208:211], v[64:67]
    ds_read_b128 v[40:43], v13 offset:57344
    v_mfma_f32_16x16x32_bf16 v[68:71], v[48:51], a[212:215], v[68:71]
    v_mfma_f32_16x16x32_bf16 v[72:75], v[52:55], a[208:211], v[72:75]
    ds_read_b128 v[44:47], v13 offset:58368
    s_add_u32 m0, s34, 3968
    v_mfma_f32_16x16x32_bf16 v[76:79], v[52:55], a[212:215], v[76:79]
    buffer_load_dwordx4 v8, s[12:15], s35 offen offset:128 lds
    s_waitcnt lgkmcnt(4)
    v_mfma_f32_16x16x32_bf16 v[64:67], v[56:59], a[216:219], v[64:67]
    ds_read_b128 v[48:51], v12 offset:61440
    v_mfma_f32_16x16x32_bf16 v[68:71], v[56:59], a[220:223], v[68:71]
    v_mfma_f32_16x16x32_bf16 v[72:75], v[60:63], a[216:219], v[72:75]
    ds_read_b128 v[52:55], v12 offset:62464
    v_mfma_f32_16x16x32_bf16 v[76:79], v[60:63], a[220:223], v[76:79]
    s_waitcnt lgkmcnt(4)
    v_mfma_f32_16x16x32_bf16 v[64:67], v[32:35], a[224:227], v[64:67]
    ds_read_b128 v[56:59], v13 offset:61440
    v_mfma_f32_16x16x32_bf16 v[68:71], v[32:35], a[228:231], v[68:71]
    v_mfma_f32_16x16x32_bf16 v[72:75], v[36:39], a[224:227], v[72:75]
    ds_read_b128 v[60:63], v13 offset:62464
    s_add_u32 m0, s34, 7936
    v_mfma_f32_16x16x32_bf16 v[76:79], v[36:39], a[228:231], v[76:79]
    buffer_load_dwordx4 v8, s[12:15], s35 offen offset:256 lds
    s_waitcnt lgkmcnt(4)
    v_mfma_f32_16x16x32_bf16 v[64:67], v[40:43], a[232:235], v[64:67]
    ds_read_b128 v[32:35], v14 offset:0
    v_mfma_f32_16x16x32_bf16 v[68:71], v[40:43], a[236:239], v[68:71]
    v_mfma_f32_16x16x32_bf16 v[72:75], v[44:47], a[232:235], v[72:75]
    ds_read_b128 v[36:39], v14 offset:1024
    v_mfma_f32_16x16x32_bf16 v[76:79], v[44:47], a[236:239], v[76:79]
    s_waitcnt lgkmcnt(4)
    v_mfma_f32_16x16x32_bf16 v[64:67], v[48:51], a[240:243], v[64:67]
    ds_read_b128 v[40:43], v15 offset:0
    v_mfma_f32_16x16x32_bf16 v[68:71], v[48:51], a[244:247], v[68:71]
    v_mfma_f32_16x16x32_bf16 v[72:75], v[52:55], a[240:243], v[72:75]
    ds_read_b128 v[44:47], v15 offset:1024
    s_add_u32 m0, s34, 11904
    v_mfma_f32_16x16x32_bf16 v[76:79], v[52:55], a[244:247], v[76:79]
    buffer_load_dwordx4 v8, s[12:15], s35 offen offset:384 lds
    s_waitcnt lgkmcnt(4)
    v_mfma_f32_16x16x32_bf16 v[64:67], v[56:59], a[248:251], v[64:67]
    ds_read_b128 v[48:51], v14 offset:4096
    v_mfma_f32_16x16x32_bf16 v[68:71], v[56:59], a[252:255], v[68:71]
    v_mfma_f32_16x16x32_bf16 v[72:75], v[60:63], a[248:251], v[72:75]
    ds_read_b128 v[52:55], v14 offset:5120
    v_mfma_f32_16x16x32_bf16 v[76:79], v[60:63], a[252:255], v[76:79]
    s_waitcnt lgkmcnt(4)
    v_mfma_f32_16x16x32_bf16 v[80:83], v[32:35], a[0:3], 0
    ds_read_b128 v[56:59], v15 offset:4096
    v_mfma_f32_16x16x32_bf16 v[84:87], v[32:35], a[4:7], 0
    v_mfma_f32_16x16x32_bf16 v[88:91], v[36:39], a[0:3], 0
    ds_read_b128 v[60:63], v15 offset:5120
    s_add_u32 m0, s34, 15872
    v_mfma_f32_16x16x32_bf16 v[92:95], v[36:39], a[4:7], 0
    buffer_load_dwordx4 v8, s[12:15], s35 offen offset:512 lds
    s_waitcnt lgkmcnt(4)
    v_mfma_f32_16x16x32_bf16 v[80:83], v[40:43], a[8:11], v[80:83]
    ds_read_b128 v[32:35], v14 offset:8192
    v_mfma_f32_16x16x32_bf16 v[84:87], v[40:43], a[12:15], v[84:87]
    v_mfma_f32_16x16x32_bf16 v[88:91], v[44:47], a[8:11], v[88:91]
    ds_read_b128 v[36:39], v14 offset:9216
    v_mfma_f32_16x16x32_bf16 v[92:95], v[44:47], a[12:15], v[92:95]
    s_waitcnt lgkmcnt(4)
    v_mfma_f32_16x16x32_bf16 v[80:83], v[48:51], a[16:19], v[80:83]
    ds_read_b128 v[40:43], v15 offset:8192
    v_mfma_f32_16x16x32_bf16 v[84:87], v[48:51], a[20:23], v[84:87]
    v_cvt_pk_bf16_f32 v96, v64, v65
    v_mfma_f32_16x16x32_bf16 v[88:91], v[52:55], a[16:19], v[88:91]
    ds_read_b128 v[44:47], v15 offset:9216
    s_add_u32 m0, s34, 19840
    v_mfma_f32_16x16x32_bf16 v[92:95], v[52:55], a[20:23], v[92:95]
    buffer_load_dwordx4 v8, s[12:15], s35 offen offset:640 lds
    v_cvt_pk_bf16_f32 v97, v66, v67
    s_waitcnt lgkmcnt(4)
    v_mfma_f32_16x16x32_bf16 v[80:83], v[56:59], a[24:27], v[80:83]
    ds_read_b128 v[48:51], v14 offset:12288
    v_mfma_f32_16x16x32_bf16 v[84:87], v[56:59], a[28:31], v[84:87]
    v_cvt_pk_bf16_f32 v98, v72, v73
    v_mfma_f32_16x16x32_bf16 v[88:91], v[60:63], a[24:27], v[88:91]
    ds_read_b128 v[52:55], v14 offset:13312
    v_mfma_f32_16x16x32_bf16 v[92:95], v[60:63], a[28:31], v[92:95]
    v_cvt_pk_bf16_f32 v99, v74, v75
    s_waitcnt lgkmcnt(4)
    v_mfma_f32_16x16x32_bf16 v[80:83], v[32:35], a[32:35], v[80:83]
    ds_read_b128 v[56:59], v15 offset:12288
    v_mfma_f32_16x16x32_bf16 v[84:87], v[32:35], a[36:39], v[84:87]
    v_cvt_pk_bf16_f32 v100, v68, v69
    v_mfma_f32_16x16x32_bf16 v[88:91], v[36:39], a[32:35], v[88:91]
    ds_read_b128 v[60:63], v15 offset:13312
    s_add_u32 m0, s34, 23808
    v_mfma_f32_16x16x32_bf16 v[92:95], v[36:39], a[36:39], v[92:95]
    buffer_load_dwordx4 v8, s[12:15], s35 offen offset:768 lds
    v_cvt_pk_bf16_f32 v101, v70, v71
    s_waitcnt lgkmcnt(4)
    v_mfma_f32_16x16x32_bf16 v[80:83], v[40:43], a[40:43], v[80:83]
    ds_read_b128 v[32:35], v14 offset:16384
    v_mfma_f32_16x16x32_bf16 v[84:87], v[40:43], a[44:47], v[84:87]
    v_cvt_pk_bf16_f32 v102, v76, v77
    v_mfma_f32_16x16x32_bf16 v[88:91], v[44:47], a[40:43], v[88:91]
    ds_read_b128 v[36:39], v14 offset:17408
    v_mfma_f32_16x16x32_bf16 v[92:95], v[44:47], a[44:47], v[92:95]
    v_cvt_pk_bf16_f32 v103, v78, v79
    buffer_store_dwordx4 v[96:99], v9, s[4:7], s36 offen sc1
    s_waitcnt lgkmcnt(4)
    v_mfma_f32_16x16x32_bf16 v[80:83], v[48:51], a[48:51], v[80:83]
    ds_read_b128 v[40:43], v15 offset:16384
    v_mfma_f32_16x16x32_bf16 v[84:87], v[48:51], a[52:55], v[84:87]
    v_mfma_f32_16x16x32_bf16 v[88:91], v[52:55], a[48:51], v[88:91]
    ds_read_b128 v[44:47], v15 offset:17408
    s_add_u32 m0, s34, 27776
    v_mfma_f32_16x16x32_bf16 v[92:95], v[52:55], a[52:55], v[92:95]
    buffer_load_dwordx4 v8, s[12:15], s35 offen offset:896 lds
    s_waitcnt lgkmcnt(4)
    v_mfma_f32_16x16x32_bf16 v[80:83], v[56:59], a[56:59], v[80:83]
    ds_read_b128 v[48:51], v14 offset:20480
    v_mfma_f32_16x16x32_bf16 v[84:87], v[56:59], a[60:63], v[84:87]
    v_mfma_f32_16x16x32_bf16 v[88:91], v[60:63], a[56:59], v[88:91]
    ds_read_b128 v[52:55], v14 offset:21504
    v_mfma_f32_16x16x32_bf16 v[92:95], v[60:63], a[60:63], v[92:95]
    buffer_store_dwordx4 v[100:103], v9, s[4:7], s36 offen offset:128 sc1
    s_add_u32 s36, s36, s37
    s_waitcnt vmcnt(8)
    s_barrier
    s_waitcnt lgkmcnt(4)
    v_mfma_f32_16x16x32_bf16 v[80:83], v[32:35], a[64:67], v[80:83]
    ds_read_b128 v[56:59], v15 offset:20480
    v_mfma_f32_16x16x32_bf16 v[84:87], v[32:35], a[68:71], v[84:87]
    v_mfma_f32_16x16x32_bf16 v[88:91], v[36:39], a[64:67], v[88:91]
    ds_read_b128 v[60:63], v15 offset:21504
    s_add_u32 m0, s34, 31744
    v_mfma_f32_16x16x32_bf16 v[92:95], v[36:39], a[68:71], v[92:95]
    buffer_load_dwordx4 v8, s[12:15], s35 offen offset:1024 lds
    s_waitcnt lgkmcnt(4)
    v_mfma_f32_16x16x32_bf16 v[80:83], v[40:43], a[72:75], v[80:83]
    ds_read_b128 v[32:35], v14 offset:24576
    v_mfma_f32_16x16x32_bf16 v[84:87], v[40:43], a[76:79], v[84:87]
    v_mfma_f32_16x16x32_bf16 v[88:91], v[44:47], a[72:75], v[88:91]
    ds_read_b128 v[36:39], v14 offset:25600
    v_mfma_f32_16x16x32_bf16 v[92:95], v[44:47], a[76:79], v[92:95]
    s_waitcnt lgkmcnt(4)
    v_mfma_f32_16x16x32_bf16 v[80:83], v[48:51], a[80:83], v[80:83]
    ds_read_b128 v[40:43], v15 offset:24576
    v_mfma_f32_16x16x32_bf16 v[84:87], v[48:51], a[84:87], v[84:87]
    v_mfma_f32_16x16x32_bf16 v[88:91], v[52:55], a[80:83], v[88:91]
    ds_read_b128 v[44:47], v15 offset:25600
    s_add_u32 m0, s34, 35712
    v_mfma_f32_16x16x32_bf16 v[92:95], v[52:55], a[84:87], v[92:95]
    buffer_load_dwordx4 v8, s[12:15], s35 offen offset:1152 lds
    s_waitcnt lgkmcnt(4)
    v_mfma_f32_16x16x32_bf16 v[80:83], v[56:59], a[88:91], v[80:83]
    ds_read_b128 v[48:51], v14 offset:28672
    v_mfma_f32_16x16x32_bf16 v[84:87], v[56:59], a[92:95], v[84:87]
    v_mfma_f32_16x16x32_bf16 v[88:91], v[60:63], a[88:91], v[88:91]
    ds_read_b128 v[52:55], v14 offset:29696
    v_mfma_f32_16x16x32_bf16 v[92:95], v[60:63], a[92:95], v[92:95]
    s_waitcnt lgkmcnt(4)
    v_mfma_f32_16x16x32_bf16 v[80:83], v[32:35], a[96:99], v[80:83]
    ds_read_b128 v[56:59], v15 offset:28672
    v_mfma_f32_16x16x32_bf16 v[84:87], v[32:35], a[100:103], v[84:87]
    v_mfma_f32_16x16x32_bf16 v[88:91], v[36:39], a[96:99], v[88:91]
    ds_read_b128 v[60:63], v15 offset:29696
    s_add_u32 m0, s34, 39680
    v_mfma_f32_16x16x32_bf16 v[92:95], v[36:39], a[100:103], v[92:95]
    buffer_load_dwordx4 v8, s[12:15], s35 offen offset:1280 lds
    s_waitcnt lgkmcnt(4)
    v_mfma_f32_16x16x32_bf16 v[80:83], v[40:43], a[104:107], v[80:83]
    ds_read_b128 v[32:35], v14 offset:32768
    v_mfma_f32_16x16x32_bf16 v[84:87], v[40:43], a[108:111], v[84:87]
    v_mfma_f32_16x16x32_bf16 v[88:91], v[44:47], a[104:107], v[88:91]
    ds_read_b128 v[36:39], v14 offset:33792
    v_mfma_f32_16x16x32_bf16 v[92:95], v[44:47], a[108:111], v[92:95]
    s_waitcnt lgkmcnt(4)
    v_mfma_f32_16x16x32_bf16 v[80:83], v[48:51], a[112:115], v[80:83]
    ds_read_b128 v[40:43], v15 offset:32768
    v_mfma_f32_16x16x32_bf16 v[84:87], v[48:51], a[116:119], v[84:87]
    v_mfma_f32_16x16x32_bf16 v[88:91], v[52:55], a[112:115], v[88:91]
    ds_read_b128 v[44:47], v15 offset:33792
    s_add_u32 m0, s34, 43648
    v_mfma_f32_16x16x32_bf16 v[92:95], v[52:55], a[116:119], v[92:95]
    buffer_load_dwordx4 v8, s[12:15], s35 offen offset:1408 lds
    s_waitcnt lgkmcnt(4)
    v_mfma_f32_16x16x32_bf16 v[80:83], v[56:59], a[120:123], v[80:83]
    ds_read_b128 v[48:51], v14 offset:36864
    v_mfma_f32_16x16x32_bf16 v[84:87], v[56:59], a[124:127], v[84:87]
    v_mfma_f32_16x16x32_bf16 v[88:91], v[60:63], a[120:123], v[88:91]
    ds_read_b128 v[52:55], v14 offset:37888
    v_mfma_f32_16x16x32_bf16 v[92:95], v[60:63], a[124:127], v[92:95]
    s_waitcnt lgkmcnt(4)
    v_mfma_f32_16x16x32_bf16 v[80:83], v[32:35], a[128:131], v[80:83]
    ds_read_b128 v[56:59], v15 offset:36864
    v_mfma_f32_16x16x32_bf16 v[84:87], v[32:35], a[132:135], v[84:87]
    v_mfma_f32_16x16x32_bf16 v[88:91], v[36:39], a[128:131], v[88:91]
    ds_read_b128 v[60:63], v15 offset:37888
    s_add_u32 m0, s34, 47616
    v_mfma_f32_16x16x32_bf16 v[92:95], v[36:39], a[132:135], v[92:95]
    buffer_load_dwordx4 v8, s[12:15], s35 offen offset:1536 lds
    s_waitcnt lgkmcnt(4)
    v_mfma_f32_16x16x32_bf16 v[80:83], v[40:43], a[136:139], v[80:83]
    ds_read_b128 v[32:35], v14 offset:40960
    v_mfma_f32_16x16x32_bf16 v[84:87], v[40:43], a[140:143], v[84:87]
    v_mfma_f32_16x16x32_bf16 v[88:91], v[44:47], a[136:139], v[88:91]
    ds_read_b128 v[36:39], v14 offset:41984
    v_mfma_f32_16x16x32_bf16 v[92:95], v[44:47], a[140:143], v[92:95]
    s_waitcnt lgkmcnt(4)
    v_mfma_f32_16x16x32_bf16 v[80:83], v[48:51], a[144:147], v[80:83]
    ds_read_b128 v[40:43], v15 offset:40960
    v_mfma_f32_16x16x32_bf16 v[84:87], v[48:51], a[148:151], v[84:87]
    v_mfma_f32_16x16x32_bf16 v[88:91], v[52:55], a[144:147], v[88:91]
    ds_read_b128 v[44:47], v15 offset:41984
    s_add_u32 m0, s34, 51584
    v_mfma_f32_16x16x32_bf16 v[92:95], v[52:55], a[148:151], v[92:95]
    buffer_load_dwordx4 v8, s[12:15], s35 offen offset:1664 lds
    s_waitcnt lgkmcnt(4)
    v_mfma_f32_16x16x32_bf16 v[80:83], v[56:59], a[152:155], v[80:83]
    ds_read_b128 v[48:51], v14 offset:45056
    v_mfma_f32_16x16x32_bf16 v[84:87], v[56:59], a[156:159], v[84:87]
    v_mfma_f32_16x16x32_bf16 v[88:91], v[60:63], a[152:155], v[88:91]
    ds_read_b128 v[52:55], v14 offset:46080
    v_mfma_f32_16x16x32_bf16 v[92:95], v[60:63], a[156:159], v[92:95]
    s_waitcnt lgkmcnt(4)
    v_mfma_f32_16x16x32_bf16 v[80:83], v[32:35], a[160:163], v[80:83]
    ds_read_b128 v[56:59], v15 offset:45056
    v_mfma_f32_16x16x32_bf16 v[84:87], v[32:35], a[164:167], v[84:87]
    v_mfma_f32_16x16x32_bf16 v[88:91], v[36:39], a[160:163], v[88:91]
    ds_read_b128 v[60:63], v15 offset:46080
    s_add_u32 m0, s34, 55552
    v_mfma_f32_16x16x32_bf16 v[92:95], v[36:39], a[164:167], v[92:95]
    buffer_load_dwordx4 v8, s[12:15], s35 offen offset:1792 lds
    s_waitcnt lgkmcnt(4)
    v_mfma_f32_16x16x32_bf16 v[80:83], v[40:43], a[168:171], v[80:83]
    ds_read_b128 v[32:35], v14 offset:49152
    v_mfma_f32_16x16x32_bf16 v[84:87], v[40:43], a[172:175], v[84:87]
    v_mfma_f32_16x16x32_bf16 v[88:91], v[44:47], a[168:171], v[88:91]
    ds_read_b128 v[36:39], v14 offset:50176
    v_mfma_f32_16x16x32_bf16 v[92:95], v[44:47], a[172:175], v[92:95]
    s_waitcnt lgkmcnt(4)
    v_mfma_f32_16x16x32_bf16 v[80:83], v[48:51], a[176:179], v[80:83]
    ds_read_b128 v[40:43], v15 offset:49152
    v_mfma_f32_16x16x32_bf16 v[84:87], v[48:51], a[180:183], v[84:87]
    v_mfma_f32_16x16x32_bf16 v[88:91], v[52:55], a[176:179], v[88:91]
    ds_read_b128 v[44:47], v15 offset:50176
    s_add_u32 m0, s34, 59520
    v_mfma_f32_16x16x32_bf16 v[92:95], v[52:55], a[180:183], v[92:95]
    buffer_load_dwordx4 v8, s[12:15], s35 offen offset:1920 lds
    s_add_u32 s35, s35, 65536
    s_min_u32 s35, s35, s52
    s_waitcnt lgkmcnt(4)
    v_mfma_f32_16x16x32_bf16 v[80:83], v[56:59], a[184:187], v[80:83]
    ds_read_b128 v[48:51], v14 offset:53248
    v_mfma_f32_16x16x32_bf16 v[84:87], v[56:59], a[188:191], v[84:87]
    v_mfma_f32_16x16x32_bf16 v[88:91], v[60:63], a[184:187], v[88:91]
    ds_read_b128 v[52:55], v14 offset:54272
    v_mfma_f32_16x16x32_bf16 v[92:95], v[60:63], a[188:191], v[92:95]
    s_waitcnt vmcnt(8)
    s_barrier
    s_waitcnt lgkmcnt(4)
    v_mfma_f32_16x16x32_bf16 v[80:83], v[32:35], a[192:195], v[80:83]
    ds_read_b128 v[56:59], v15 offset:53248
    v_mfma_f32_16x16x32_bf16 v[84:87], v[32:35], a[196:199], v[84:87]
    v_mfma_f32_16x16x32_bf16 v[88:91], v[36:39], a[192:195], v[88:91]
    ds_read_b128 v[60:63], v15 offset:54272
    s_add_u32 m0, s34, 65536
    v_mfma_f32_16x16x32_bf16 v[92:95], v[36:39], a[196:199], v[92:95]
    buffer_load_dwordx4 v8, s[12:15], s35 offen offset:0 lds
    s_waitcnt lgkmcnt(4)
    v_mfma_f32_16x16x32_bf16 v[80:83], v[40:43], a[200:203], v[80:83]
    ds_read_b128 v[32:35], v14 offset:57344
    v_mfma_f32_16x16x32_bf16 v[84:87], v[40:43], a[204:207], v[84:87]
    buffer_store_dword v11, v10, s[4:7], 0 offen sc1
    v_add_u32 v11, 1, v11
    v_mfma_f32_16x16x32_bf16 v[88:91], v[44:47], a[200:203], v[88:91]
    ds_read_b128 v[36:39], v14 offset:58368
    v_mfma_f32_16x16x32_bf16 v[92:95], v[44:47], a[204:207], v[92:95]
    s_waitcnt lgkmcnt(4)
    v_mfma_f32_16x16x32_bf16 v[80:83], v[48:51], a[208:211], v[80:83]
    ds_read_b128 v[40:43], v15 offset:57344
    v_mfma_f32_16x16x32_bf16 v[84:87], v[48:51], a[212:215], v[84:87]
    v_mfma_f32_16x16x32_bf16 v[88:91], v[52:55], a[208:211], v[88:91]
    ds_read_b128 v[44:47], v15 offset:58368
    s_add_u32 m0, s34, 69504
    v_mfma_f32_16x16x32_bf16 v[92:95], v[52:55], a[212:215], v[92:95]
    buffer_load_dwordx4 v8, s[12:15], s35 offen offset:128 lds
    s_waitcnt lgkmcnt(4)
    v_mfma_f32_16x16x32_bf16 v[80:83], v[56:59], a[216:219], v[80:83]
    ds_read_b128 v[48:51], v14 offset:61440
    v_mfma_f32_16x16x32_bf16 v[84:87], v[56:59], a[220:223], v[84:87]
    v_mfma_f32_16x16x32_bf16 v[88:91], v[60:63], a[216:219], v[88:91]
    ds_read_b128 v[52:55], v14 offset:62464
    v_mfma_f32_16x16x32_bf16 v[92:95], v[60:63], a[220:223], v[92:95]
    s_waitcnt lgkmcnt(4)
    v_mfma_f32_16x16x32_bf16 v[80:83], v[32:35], a[224:227], v[80:83]
    ds_read_b128 v[56:59], v15 offset:61440
    v_mfma_f32_16x16x32_bf16 v[84:87], v[32:35], a[228:231], v[84:87]
    v_mfma_f32_16x16x32_bf16 v[88:91], v[36:39], a[224:227], v[88:91]
    ds_read_b128 v[60:63], v15 offset:62464
    s_add_u32 m0, s34, 73472
    v_mfma_f32_16x16x32_bf16 v[92:95], v[36:39], a[228:231], v[92:95]
    buffer_load_dwordx4 v8, s[12:15], s35 offen offset:256 lds
    s_waitcnt lgkmcnt(4)
    v_mfma_f32_16x16x32_bf16 v[80:83], v[40:43], a[232:235], v[80:83]
    ds_read_b128 v[32:35], v12 offset:0
    v_mfma_f32_16x16x32_bf16 v[84:87], v[40:43], a[236:239], v[84:87]
    v_mfma_f32_16x16x32_bf16 v[88:91], v[44:47], a[232:235], v[88:91]
    ds_read_b128 v[36:39], v12 offset:1024
    v_mfma_f32_16x16x32_bf16 v[92:95], v[44:47], a[236:239], v[92:95]
    s_waitcnt lgkmcnt(4)
    v_mfma_f32_16x16x32_bf16 v[80:83], v[48:51], a[240:243], v[80:83]
    ds_read_b128 v[40:43], v13 offset:0
    v_mfma_f32_16x16x32_bf16 v[84:87], v[48:51], a[244:247], v[84:87]
    v_mfma_f32_16x16x32_bf16 v[88:91], v[52:55], a[240:243], v[88:91]
    ds_read_b128 v[44:47], v13 offset:1024
    s_add_u32 m0, s34, 77440
    v_mfma_f32_16x16x32_bf16 v[92:95], v[52:55], a[244:247], v[92:95]
    buffer_load_dwordx4 v8, s[12:15], s35 offen offset:384 lds
    s_waitcnt lgkmcnt(4)
    v_mfma_f32_16x16x32_bf16 v[80:83], v[56:59], a[248:251], v[80:83]
    ds_read_b128 v[48:51], v12 offset:4096
    v_mfma_f32_16x16x32_bf16 v[84:87], v[56:59], a[252:255], v[84:87]
    v_mfma_f32_16x16x32_bf16 v[88:91], v[60:63], a[248:251], v[88:91]
    ds_read_b128 v[52:55], v12 offset:5120
    v_mfma_f32_16x16x32_bf16 v[92:95], v[60:63], a[252:255], v[92:95]
    s_add_u32 s30, s30, 2
    s_cmp_lt_u32 s30, s51
    s_cbranch_scc1 sl_loop_57
    v_cvt_pk_bf16_f32 v96, v80, v81
    v_cvt_pk_bf16_f32 v97, v82, v83
    s_nop 0
    v_cvt_pk_bf16_f32 v98, v88, v89
    v_cvt_pk_bf16_f32 v99, v90, v91
    v_cvt_pk_bf16_f32 v100, v84, v85
    v_cvt_pk_bf16_f32 v101, v86, v87
    v_cvt_pk_bf16_f32 v102, v92, v93
    v_cvt_pk_bf16_f32 v103, v94, v95
    s_branch sl_e_55
sl_e_55:
    buffer_store_dwordx4 v[96:99], v9, s[4:7], s36 offen sc1
    buffer_store_dwordx4 v[100:103], v9, s[4:7], s36 offen offset:128 sc1
    s_add_u32 s36, s36, s37
    s_waitcnt vmcnt(0) lgkmcnt(0)
    s_barrier
    buffer_store_dword v11, v10, s[4:7], 0 offen sc1
    s_branch L_ph2
L_ph2:
    s_cmp_ge_u32 s28, 96
    s_cbranch_scc1 L_ob
L_att:
    s_mov_b32 s42, 0x3e0293ee
    s_mov_b32 s58, 0x3e8293ee
    s_and_b32 s44, s28, 7
    s_lshl_b32 s44, s44, 2
    s_add_u32 s44, s44, s29
    s_lshl_b32 s31, s44, 11
    v_add_u32 v6, s31, v5
    v_lshrrev_b32 v9, 5, v1
    v_lshlrev_b32 v9, 7, v9
    v_and_b32 v4, 7, v1
    v_lshl_add_u32 v9, v4, 4, v9
    v_add_u32 v9, s31, v9
    s_add_u32 s31, s31, 4194304
    v_and_b32 v10, 31, v1
    v_lshlrev_b32 v10, 4, v10
    v_lshrrev_b32 v4, 5, v1
    v_lshl_add_u32 v10, v4, 3, v10
    v_add_u32 v10, s31, v10
    s_lshl_b32 s31, s44, 13
    v_add_u32 v8, s31, v5
    v_mov_b32 v7, v8
    s_lshl_b32 s55, s44, 7
    s_add_u32 s55, s55, 115343360
    s_lshr_b32 s56, s44, 2
    s_lshl_b32 s56, s56, 7
    s_add_u32 s56, s56, 115347456
    s_lshl_b32 s57, s44, 7
    s_add_u32 s57, s57, 115351552
    s_lshl_b32 s31, s44, 7
    s_add_u32 s31, s31, 115343360
    v_mov_b32 v12, s31
    v_lshl_add_u32 v13, v1, 12, s31
    s_mov_b64 vcc, 1
    v_mov_b32 v4, 2130706432
    v_cndmask_b32 v12, v4, v12, vcc
    s_cmp_lt_u32 s28, 120
    s_cbranch_scc1 at_help_58
    s_mov_b32 s53, 0
    s_mov_b32 s54, 0
    s_mov_b32 s37, 1
    s_mov_b32 s38, 6
    s_mov_b32 s39, 32
    v_mov_b32 v2, 0
    s_mov_b32 s31, 16384
    buffer_store_dword v2, v12, s[4:7], s31 offen sc1
    s_mov_b32 s31, 32768
    buffer_store_dword v2, v13, s[4:7], s31 offen sc1
    s_waitcnt vmcnt(0)
    s_barrier
    s_cmp_lg_u32 s29, 0
    s_cbranch_scc1 at_i_60
    s_mov_b64 exec, 1
    v_mov_b32 v2, 0
    v_mov_b32 v3, 1
    s_waitcnt vmcnt(0)
    global_atomic_add v2, v3, s[92:93] offset:0 sc1
    s_mov_b64 exec, -1
at_i_60:
    s_cmp_lt_u32 s28, 96
    s_cbranch_scc1 tw_skip_61
    s_load_dwordx2 s[72:73], s[0:1], 40
    s_and_b32 s31, s28, 31
    s_lshl_b32 s31, s31, 13
    s_lshl_b32 s33, s29, 21
    s_add_u32 s31, s31, s33
    v_lshl_add_u32 v2, v1, 7, s31
    s_waitcnt lgkmcnt(0)
    s_mov_b32 s8, s72
    s_and_b32 s9, s73, 0xffff
    s_mov_b32 s10, 8388608
    s_mov_b32 s11, 0x00020000
    s_mov_b32 s31, 0
    buffer_load_dword v128, v2, s[8:11], s31 offen
    s_mov_b32 s31, 262144
    buffer_load_dword v129, v2, s[8:11], s31 offen
    s_mov_b32 s31, 524288
    buffer_load_dword v130, v2, s[8:11], s31 offen
    s_mov_b32 s31, 786432
    buffer_load_dword v131, v2, s[8:11], s31 offen
    s_mov_b32 s31, 1048576
    buffer_load_dword v132, v2, s[8:11], s31 offen
    s_mov_b32 s31, 1310720
    buffer_load_dword v133, v2, s[8:11], s31 offen
    s_mov_b32 s31, 1572864
    buffer_load_dword v134, v2, s[8:11], s31 offen
    s_mov_b32 s31, 1835008
    buffer_load_dword v135, v2, s[8:11], s31 offen
tw_skip_61:
    s_load_dwordx2 s[72:73], s[0:1], 0
    s_load_dwordx2 s[74:75], s[0:1], 56
    s_load_dwordx2 s[76:77], s[0:1], 72
    s_waitcnt lgkmcnt(0)
    s_mov_b32 s8, s72
    s_and_b32 s9, s73, 0xffff
    s_mov_b32 s10, 4194304
    s_mov_b32 s11, 0x00020000
    s_mov_b32 s12, s74
    s_and_b32 s13, s75, 0xffff
    s_mov_b32 s14, 4194304
    s_mov_b32 s15, 0x00020000
    s_mov_b32 s16, s76
    s_and_b32 s17, s77, 0xffff
    s_mov_b32 s18, 2097152
    s_mov_b32 s19, 0x00020000
    s_lshl_b32 s31, s44, 13
    v_lshl_add_u32 v11, v1, 7, s31
    buffer_load_dword v144, v11, s[8:11], 0 offen
    s_cmp_lg_u32 s29, 0
    s_cbranch_scc1 g_wdd_63
g_wd_62:
    s_load_dword s84, s[92:93], 128 glc
    s_add_u32 s41, s41, 1
    s_cmp_ge_u32 s41, 0x200000
    s_cbranch_scc1 g_wdd_63
    s_waitcnt lgkmcnt(0)
    s_and_b32 s84, s84, 0xffff
    s_cmp_ge_u32 s84, 96
    s_cbranch_scc1 g_wdd_63
    s_sleep 32
    s_branch g_wd_62
g_wdd_63:
    s_waitcnt lgkmcnt(0)
    s_barrier
    s_mov_b32 s31, 0
    buffer_load_dword v144, v11, s[8:11], s31 offen
    buffer_load_dword v145, v11, s[12:15], s31 offen
    s_mov_b32 s31, 262144
    buffer_load_dword v146, v11, s[8:11], s31 offen
    buffer_load_dword v147, v11, s[12:15], s31 offen
    s_mov_b32 s31, 524288
    buffer_load_dword v148, v11, s[8:11], s31 offen
    buffer_load_dword v149, v11, s[12:15], s31 offen
    s_mov_b32 s31, 786432
    buffer_load_dword v150, v11, s[8:11], s31 offen
    buffer_load_dword v151, v11, s[12:15], s31 offen
    s_mov_b32 s31, 1048576
    buffer_load_dword v152, v11, s[8:11], s31 offen
    buffer_load_dword v153, v11, s[12:15], s31 offen
    s_mov_b32 s31, 1310720
    buffer_load_dword v154, v11, s[8:11], s31 offen
    buffer_load_dword v155, v11, s[12:15], s31 offen
    s_mov_b32 s31, 1572864
    buffer_load_dword v156, v11, s[8:11], s31 offen
    buffer_load_dword v157, v11, s[12:15], s31 offen
    s_mov_b32 s31, 1835008
    buffer_load_dword v158, v11, s[8:11], s31 offen
    buffer_load_dword v159, v11, s[12:15], s31 offen
    s_mov_b32 s31, 2097152
    buffer_load_dword v160, v11, s[8:11], s31 offen
    buffer_load_dword v161, v11, s[12:15], s31 offen
    s_mov_b32 s31, 2359296
    buffer_load_dword v162, v11, s[8:11], s31 offen
    buffer_load_dword v163, v11, s[12:15], s31 offen
    s_mov_b32 s31, 2621440
    buffer_load_dword v164, v11, s[8:11], s31 offen
    buffer_load_dword v165, v11, s[12:15], s31 offen
    s_mov_b32 s31, 2883584
    buffer_load_dword v166, v11, s[8:11], s31 offen
    buffer_load_dword v167, v11, s[12:15], s31 offen
    s_mov_b32 s31, 3145728
    buffer_load_dword v168, v11, s[8:11], s31 offen
    buffer_load_dword v169, v11, s[12:15], s31 offen
    s_mov_b32 s31, 3407872
    buffer_load_dword v170, v11, s[8:11], s31 offen
    buffer_load_dword v171, v11, s[12:15], s31 offen
    s_mov_b32 s31, 3670016
    buffer_load_dword v172, v11, s[8:11], s31 offen
    buffer_load_dword v173, v11, s[12:15], s31 offen
    s_mov_b32 s31, 3932160
    buffer_load_dword v174, v11, s[8:11], s31 offen
    buffer_load_dword v175, v11, s[12:15], s31 offen
    s_mov_b32 s31, 0
    buffer_load_dword v176, v11, s[16:19], s31 offen
    s_mov_b32 s31, 262144
    buffer_load_dword v177, v11, s[16:19], s31 offen
    s_mov_b32 s31, 524288
    buffer_load_dword v178, v11, s[16:19], s31 offen
    s_mov_b32 s31, 786432
    buffer_load_dword v179, v11, s[16:19], s31 offen
    s_mov_b32 s31, 1048576
    buffer_load_dword v180, v11, s[16:19], s31 offen
    s_mov_b32 s31, 1310720
    buffer_load_dword v181, v11, s[16:19], s31 offen
    s_mov_b32 s31, 1572864
    buffer_load_dword v182, v11, s[16:19], s31 offen
    s_mov_b32 s31, 1835008
    buffer_load_dword v183, v11, s[16:19], s31 offen
    s_branch at_com_59
at_help_58:
    s_lshr_b32 s53, s28, 3
    s_add_u32 s53, s53, 6
    s_mov_b32 s54, 64
    s_mov_b32 s37, 12
    s_mov_b32 s38, 30
    s_lshr_b32 s39, s28, 3
    s_and_b32 s39, s39, 1
    s_add_u32 s39, s39, 30
    s_cmp_lt_u32 s28, 80
    s_cselect_b32 s39, 64, s39
at_com_59:
    v_and_b32 v11, 31, v1
    v_lshrrev_b32 v3, 5, v1
    v_lshlrev_b32 v3, 2, v3
    v_sub_u32 v11, v11, v3
    v_mov_b32 v14, 0xf149f2ca
    v_add_u32 v3, 0, v11
    v_and_b32 v3, 0xfffffff1, v3
    v_cmp_ne_u32 vcc, 0, v3
    s_nop 1
    v_cndmask_b32 v64, 0, v14, vcc
    v_add_u32 v3, -1, v11
    v_and_b32 v3, 0xfffffff1, v3
    v_cmp_ne_u32 vcc, 0, v3
    s_nop 1
    v_cndmask_b32 v65, 0, v14, vcc
    v_add_u32 v3, -2, v11
    v_and_b32 v3, 0xfffffff1, v3
    v_cmp_ne_u32 vcc, 0, v3
    s_nop 1
    v_cndmask_b32 v66, 0, v14, vcc
    v_add_u32 v3, -3, v11
    v_and_b32 v3, 0xfffffff1, v3
    v_cmp_ne_u32 vcc, 0, v3
    s_nop 1
    v_cndmask_b32 v67, 0, v14, vcc
    v_add_u32 v3, -8, v11
    v_and_b32 v3, 0xfffffff1, v3
    v_cmp_ne_u32 vcc, 0, v3
    s_nop 1
    v_cndmask_b32 v68, 0, v14, vcc
    v_add_u32 v3, -9, v11
    v_and_b32 v3, 0xfffffff1, v3
    v_cmp_ne_u32 vcc, 0, v3
    s_nop 1
    v_cndmask_b32 v69, 0, v14, vcc
    v_add_u32 v3, -10, v11
    v_and_b32 v3, 0xfffffff1, v3
    v_cmp_ne_u32 vcc, 0, v3
    s_nop 1
    v_cndmask_b32 v70, 0, v14, vcc
    v_add_u32 v3, -11, v11
    v_and_b32 v3, 0xfffffff1, v3
    v_cmp_ne_u32 vcc, 0, v3
    s_nop 1
    v_cndmask_b32 v71, 0, v14, vcc
    v_add_u32 v3, -16, v11
    v_and_b32 v3, 0xfffffff1, v3
    v_cmp_ne_u32 vcc, 0, v3
    s_nop 1
    v_cndmask_b32 v72, 0, v14, vcc
    v_add_u32 v3, -17, v11
    v_and_b32 v3, 0xfffffff1, v3
    v_cmp_ne_u32 vcc, 0, v3
    s_nop 1
    v_cndmask_b32 v73, 0, v14, vcc
    v_add_u32 v3, -18, v11
    v_and_b32 v3, 0xfffffff1, v3
    v_cmp_ne_u32 vcc, 0, v3
    s_nop 1
    v_cndmask_b32 v74, 0, v14, vcc
    v_add_u32 v3, -19, v11
    v_and_b32 v3, 0xfffffff1, v3
    v_cmp_ne_u32 vcc, 0, v3
    s_nop 1
    v_cndmask_b32 v75, 0, v14, vcc
    v_add_u32 v3, -24, v11
    v_and_b32 v3, 0xfffffff1, v3
    v_cmp_ne_u32 vcc, 0, v3
    s_nop 1
    v_cndmask_b32 v76, 0, v14, vcc
    v_add_u32 v3, -25, v11
    v_and_b32 v3, 0xfffffff1, v3
    v_cmp_ne_u32 vcc, 0, v3
    s_nop 1
    v_cndmask_b32 v77, 0, v14, vcc
    v_add_u32 v3, -26, v11
    v_and_b32 v3, 0xfffffff1, v3
    v_cmp_ne_u32 vcc, 0, v3
    s_nop 1
    v_cndmask_b32 v78, 0, v14, vcc
    v_add_u32 v3, -27, v11
    v_and_b32 v3, 0xfffffff1, v3
    v_cmp_ne_u32 vcc, 0, v3
    s_nop 1
    v_cndmask_b32 v79, 0, v14, vcc
    v_cmp_gt_i32 vcc, 0, v11
    s_nop 1
    v_cndmask_b32 v96, 0, v14, vcc
    v_cmp_gt_i32 vcc, 1, v11
    s_nop 1
    v_cndmask_b32 v97, 0, v14, vcc
    v_cmp_gt_i32 vcc, 2, v11
    s_nop 1
    v_cndmask_b32 v98, 0, v14, vcc
    v_cmp_gt_i32 vcc, 3, v11
    s_nop 1
    v_cndmask_b32 v99, 0, v14, vcc
    v_cmp_gt_i32 vcc, 8, v11
    s_nop 1
    v_cndmask_b32 v100, 0, v14, vcc
    v_cmp_gt_i32 vcc, 9, v11
    s_nop 1
    v_cndmask_b32 v101, 0, v14, vcc
    v_cmp_gt_i32 vcc, 10, v11
    s_nop 1
    v_cndmask_b32 v102, 0, v14, vcc
    v_cmp_gt_i32 vcc, 11, v11
    s_nop 1
    v_cndmask_b32 v103, 0, v14, vcc
    v_cmp_gt_i32 vcc, 16, v11
    s_nop 1
    v_cndmask_b32 v104, 0, v14, vcc
    v_cmp_gt_i32 vcc, 17, v11
    s_nop 1
    v_cndmask_b32 v105, 0, v14, vcc
    v_cmp_gt_i32 vcc, 18, v11
    s_nop 1
    v_cndmask_b32 v106, 0, v14, vcc
    v_cmp_gt_i32 vcc, 19, v11
    s_nop 1
    v_cndmask_b32 v107, 0, v14, vcc
    v_cmp_gt_i32 vcc, 24, v11
    s_nop 1
    v_cndmask_b32 v108, 0, v14, vcc
    v_cmp_gt_i32 vcc, 25, v11
    s_nop 1
    v_cndmask_b32 v109, 0, v14, vcc
    v_cmp_gt_i32 vcc, 26, v11
    s_nop 1
    v_cndmask_b32 v110, 0, v14, vcc
    v_cmp_gt_i32 vcc, 27, v11
    s_nop 1
    v_cndmask_b32 v111, 0, v14, vcc
    v_mov_b32 v80, 0xf149f2ca
    v_mov_b32 v81, 0xf149f2ca
    v_mov_b32 v82, 0xf149f2ca
    v_mov_b32 v83, 0xf149f2ca
    v_mov_b32 v84, 0xf149f2ca
    v_mov_b32 v85, 0xf149f2ca
    v_mov_b32 v86, 0xf149f2ca
    v_mov_b32 v87, 0xf149f2ca
    v_mov_b32 v88, 0xf149f2ca
    v_mov_b32 v89, 0xf149f2ca
    v_mov_b32 v90, 0xf149f2ca
    v_mov_b32 v91, 0xf149f2ca
    v_mov_b32 v92, 0xf149f2ca
    v_mov_b32 v93, 0xf149f2ca
    v_mov_b32 v94, 0xf149f2ca
    v_mov_b32 v95, 0xf149f2ca
    v_accvgpr_write_b32 a184, 0
    v_accvgpr_write_b32 a185, 0
    v_accvgpr_write_b32 a186, 0
    v_accvgpr_write_b32 a187, 0
    v_accvgpr_write_b32 a188, 0
    v_accvgpr_write_b32 a189, 0
    v_accvgpr_write_b32 a190, 0
    v_accvgpr_write_b32 a191, 0
    v_accvgpr_write_b32 a192, 0
    v_accvgpr_write_b32 a193, 0
    v_accvgpr_write_b32 a194, 0
    v_accvgpr_write_b32 a195, 0
    v_accvgpr_write_b32 a128, 0
    v_accvgpr_write_b32 a129, 0
    v_accvgpr_write_b32 a130, 0
    v_accvgpr_write_b32 a131, 0
    v_accvgpr_write_b32 a132, 0
    v_accvgpr_write_b32 a133, 0
    v_accvgpr_write_b32 a134, 0
    v_accvgpr_write_b32 a135, 0
    v_accvgpr_write_b32 a136, 0
    v_accvgpr_write_b32 a137, 0
    v_accvgpr_write_b32 a138, 0
    v_accvgpr_write_b32 a139, 0
    v_accvgpr_write_b32 a140, 0
    v_accvgpr_write_b32 a141, 0
    v_accvgpr_write_b32 a142, 0
    v_accvgpr_write_b32 a143, 0
    v_mov_b32 v40, 0
    v_mov_b32 v41, 0
    v_mov_b32 v42, 0
    v_mov_b32 v43, 0
    s_cmp_lg_u32 s29, 0
    s_cbranch_scc1 g_wdd_65
g_wd_64:
    s_load_dword s72, s[92:93], 0 glc
    s_add_u32 s41, s41, 1
    s_cmp_ge_u32 s41, 0x200000
    s_cbranch_scc1 g_wdd_65
    s_waitcnt lgkmcnt(0)
    s_and_b32 s72, s72, 0xffff
    s_cmp_ge_u32 s72, 256
    s_cbranch_scc1 g_wdd_65
    s_sleep 32
    s_branch g_wd_64
g_wdd_65:
    s_waitcnt lgkmcnt(0)
    s_barrier
    s_add_u32 s49, s53, s37
    s_cmp_lt_u32 s49, s38
    s_cbranch_scc1 at_nx_73
    s_max_u32 s49, s49, s39
    s_cmp_eq_u32 s38, 255
    s_cselect_b32 s49, s49, s39
    s_mov_b32 s37, 3
    s_mov_b32 s38, 255
at_nx_73:
g_wf_74:
    s_load_dwordx4 s[72:75], s[90:91], s56 glc
    s_add_u32 s41, s41, 1
    s_cmp_ge_u32 s41, 0x200000
    s_cbranch_scc1 g_wfd_75
    s_waitcnt lgkmcnt(0)
    s_min_u32 s76, s72, s73
    s_min_u32 s76, s76, s74
    s_cmp_ge_u32 s76, 1
    s_cbranch_scc1 g_wfd_75
    s_sleep 4
    s_branch g_wf_74
g_wfd_75:
    s_waitcnt lgkmcnt(0)
    s_mov_b32 s35, 0
    s_add_u32 s31, s35, 50331648
    buffer_load_dwordx4 a[160:163], v6, s[4:7], s31 offen offset:0 sc1
    buffer_load_dwordx4 a[164:167], v6, s[4:7], s31 offen offset:1024 sc1
    s_add_u32 s31, s35, 54525952
    buffer_load_dwordx4 a[168:171], v6, s[4:7], s31 offen offset:0 sc1
    buffer_load_dwordx4 a[172:175], v6, s[4:7], s31 offen offset:1024 sc1
    s_add_u32 s31, s35, 58720256
    buffer_load_dwordx4 a[176:179], v6, s[4:7], s31 offen offset:0 sc1
    buffer_load_dwordx4 a[180:183], v6, s[4:7], s31 offen offset:1024 sc1
    s_add_u32 s32, s53, 1
g_wf_76:
    s_load_dwordx4 s[72:75], s[90:91], s55 glc
    s_add_u32 s41, s41, 1
    s_cmp_ge_u32 s41, 0x200000
    s_cbranch_scc1 g_wfd_77
    s_waitcnt lgkmcnt(0)
    s_min_u32 s76, s72, s73
    s_min_u32 s76, s76, s74
    s_cmp_ge_u32 s76, s32
    s_cbranch_scc1 g_wfd_77
    s_sleep 4
    s_branch g_wf_76
g_wfd_77:
    s_waitcnt lgkmcnt(0)
    s_lshl_b32 s36, s53, 18
    s_add_u32 s31, s36, 0
    buffer_load_dwordx4 a[0:3], v7, s[4:7], s31 offen offset:0 sc1
    buffer_load_dwordx4 a[4:7], v7, s[4:7], s31 offen offset:1024 sc1
    buffer_load_dwordx4 a[8:11], v7, s[4:7], s31 offen offset:2048 sc1
    buffer_load_dwordx4 a[12:15], v7, s[4:7], s31 offen offset:3072 sc1
    s_add_u32 s31, s36, 4096
    buffer_load_dwordx4 a[16:19], v7, s[4:7], s31 offen offset:0 sc1
    buffer_load_dwordx4 a[20:23], v7, s[4:7], s31 offen offset:1024 sc1
    buffer_load_dwordx4 a[24:27], v7, s[4:7], s31 offen offset:2048 sc1
    buffer_load_dwordx4 a[28:31], v7, s[4:7], s31 offen offset:3072 sc1
    s_add_u32 s31, s36, 16777216
    buffer_load_dwordx4 a[32:35], v7, s[4:7], s31 offen offset:0 sc1
    buffer_load_dwordx4 a[36:39], v7, s[4:7], s31 offen offset:1024 sc1
    buffer_load_dwordx4 a[40:43], v7, s[4:7], s31 offen offset:2048 sc1
    buffer_load_dwordx4 a[44:47], v7, s[4:7], s31 offen offset:3072 sc1
    s_add_u32 s31, s36, 16781312
    buffer_load_dwordx4 a[48:51], v7, s[4:7], s31 offen offset:0 sc1
    buffer_load_dwordx4 a[52:55], v7, s[4:7], s31 offen offset:1024 sc1
    buffer_load_dwordx4 a[56:59], v7, s[4:7], s31 offen offset:2048 sc1
    buffer_load_dwordx4 a[60:63], v7, s[4:7], s31 offen offset:3072 sc1
    s_add_u32 s31, s36, 33554432
    buffer_load_dwordx4 a[96:99], v7, s[4:7], s31 offen offset:0 sc1
    buffer_load_dwordx4 a[100:103], v7, s[4:7], s31 offen offset:1024 sc1
    buffer_load_dwordx4 a[104:107], v7, s[4:7], s31 offen offset:2048 sc1
    buffer_load_dwordx4 a[108:111], v7, s[4:7], s31 offen offset:3072 sc1
    s_add_u32 s31, s36, 33558528
    buffer_load_dwordx4 a[112:115], v7, s[4:7], s31 offen offset:0 sc1
    buffer_load_dwordx4 a[116:119], v7, s[4:7], s31 offen offset:1024 sc1
    buffer_load_dwordx4 a[120:123], v7, s[4:7], s31 offen offset:2048 sc1
    buffer_load_dwordx4 a[124:127], v7, s[4:7], s31 offen offset:3072 sc1
    s_mov_b32 s43, 20480
    s_mov_b32 s45, 0
    s_mov_b32 s51, 0
    s_waitcnt vmcnt(0)
at_poll_71:
    s_load_dwordx16 s[8:23], s[90:91], s57 glc
    s_load_dwordx4 s[76:79], s[90:91], s55 glc
    s_load_dwordx4 s[80:83], s[90:91], s56 glc
at_top_66:
    s_waitcnt lgkmcnt(0)
    s_min_u32 s72, s8, s12
    s_min_u32 s72, s72, s16
    s_min_u32 s72, s72, s20
    s_min_u32 s76, s76, s77
    s_min_u32 s76, s76, s78
    s_min_u32 s80, s80, s81
    s_min_u32 s80, s80, s82
    s_min_u32 s77, s49, 63
    s_cmp_gt_u32 s76, s77
    s_cselect_b32 s72, s72, 0
    s_min_u32 s72, s72, 64
    s_sub_u32 s81, s80, 1
    s_cmp_ge_u32 s80, 64
    s_cselect_b32 s80, 64, s81
    s_cmp_lt_u32 s54, s80
    s_cbranch_scc1 at_b_68
    s_cmp_lt_u32 s53, s72
    s_cbranch_scc1 at_a_67
    s_cmp_eq_u32 s43, 20480
    s_cbranch_scc1 at_nf_72
    s_waitcnt vmcnt(0)
    v_mov_b32 v2, s45
    buffer_store_dword v2, v12, s[4:7], s43 offen sc1
    s_mov_b32 s43, 20480
at_nf_72:
    s_cmp_ge_u32 s53, 64
    s_cselect_b32 s31, s54, 0
    s_cmp_ge_u32 s31, 64
    s_cbranch_scc1 at_end_69
    s_add_u32 s41, s41, 1
    s_cmp_ge_u32 s41, 0x200000
    s_cbranch_scc1 at_end_69
    s_sleep 1
    s_branch at_poll_71
at_a_67:
    s_lshl_b32 s46, s53, 16
    s_add_u32 s46, s46, 88080384
    s_cmp_lg_u32 s51, 0
    s_cbranch_scc1 at_k1_78
    s_mov_b32 exec_lo, 0xff
    s_mov_b32 exec_hi, 0xff
    buffer_load_dwordx4 a[64:67], v9, s[4:7], s46 offen offset:0 sc1
    buffer_load_dwordx4 a[68:71], v9, s[4:7], s46 offen offset:256 sc1
    buffer_load_dwordx4 a[72:75], v9, s[4:7], s46 offen offset:512 sc1
    buffer_load_dwordx4 a[76:79], v9, s[4:7], s46 offen offset:768 sc1
    buffer_load_dwordx4 a[80:83], v9, s[4:7], s46 offen offset:1024 sc1
    buffer_load_dwordx4 a[84:87], v9, s[4:7], s46 offen offset:1280 sc1
    buffer_load_dwordx4 a[88:91], v9, s[4:7], s46 offen offset:1536 sc1
    buffer_load_dwordx4 a[92:95], v9, s[4:7], s46 offen offset:1792 sc1
    s_mov_b64 exec, -1
    buffer_load_dwordx2 a[128:129], v10, s[4:7], s46 offen offset:0 sc1
    buffer_load_dwordx2 a[132:133], v10, s[4:7], s46 offen offset:512 sc1
    buffer_load_dwordx2 a[136:137], v10, s[4:7], s46 offen offset:1024 sc1
    buffer_load_dwordx2 a[140:141], v10, s[4:7], s46 offen offset:1536 sc1
at_k1_78:
    s_lshl_b32 s47, s53, 18
    s_add_u32 s47, s47, 67108864
    s_cmp_lt_u32 s49, s72
    s_cselect_b32 s52, 1, 0
    s_cmp_lt_u32 s49, 64
    s_cselect_b32 s32, s49, s53
    s_cselect_b32 s31, 0, 2130706432
    v_or_b32 v7, s31, v8
    s_lshl_b32 s36, s32, 18
    s_lshl_b32 s46, s32, 16
    s_add_u32 s46, s46, 88080384
    s_load_dwordx16 s[8:23], s[90:91], s57 glc
    s_load_dwordx4 s[76:79], s[90:91], s55 glc
    s_load_dwordx4 s[80:83], s[90:91], s56 glc
    v_mfma_f32_32x32x16_bf16 v[112:127], a[32:35], a[0:3], v[96:111]
    v_mfma_f32_32x32x16_bf16 v[112:127], a[36:39], a[4:7], v[112:127]
    v_mfma_f32_32x32x16_bf16 v[112:127], a[40:43], a[8:11], v[112:127]
    v_mfma_f32_32x32x16_bf16 v[112:127], a[44:47], a[12:15], v[112:127]
    v_mfma_f32_32x32x16_bf16 v[112:127], a[48:51], a[16:19], v[112:127]
    v_mfma_f32_32x32x16_bf16 v[112:127], a[52:55], a[20:23], v[112:127]
    v_mfma_f32_32x32x16_bf16 v[112:127], a[56:59], a[24:27], v[112:127]
    v_mfma_f32_32x32x16_bf16 v[112:127], a[60:63], a[28:31], v[112:127]
    s_cmp_lg_u32 s51, 0
    s_cbranch_scc1 at_k2_79
    s_waitcnt vmcnt(4)
at_k2_79:
    s_add_u32 s31, s36, 16777216
    buffer_load_dwordx4 a[32:35], v7, s[4:7], s31 offen offset:0 sc1
    buffer_load_dwordx4 a[36:39], v7, s[4:7], s31 offen offset:1024 sc1
    buffer_load_dwordx4 a[40:43], v7, s[4:7], s31 offen offset:2048 sc1
    buffer_load_dwordx4 a[44:47], v7, s[4:7], s31 offen offset:3072 sc1
    s_add_u32 s31, s36, 16781312
    buffer_load_dwordx4 a[48:51], v7, s[4:7], s31 offen offset:0 sc1
    buffer_load_dwordx4 a[52:55], v7, s[4:7], s31 offen offset:1024 sc1
    buffer_load_dwordx4 a[56:59], v7, s[4:7], s31 offen offset:2048 sc1
    buffer_load_dwordx4 a[60:63], v7, s[4:7], s31 offen offset:3072 sc1
    v_mfma_f32_32x32x16_bf16 v[128:143], a[64:67], a[0:3], 0
    v_mfma_f32_32x32x16_bf16 v[128:143], a[68:71], a[4:7], v[128:143]
    v_mfma_f32_32x32x16_bf16 v[128:143], a[72:75], a[8:11], v[128:143]
    v_mfma_f32_32x32x16_bf16 v[128:143], a[76:79], a[12:15], v[128:143]
    v_mfma_f32_32x32x16_bf16 v[128:143], a[80:83], a[16:19], v[128:143]
    v_mfma_f32_32x32x16_bf16 v[128:143], a[84:87], a[20:23], v[128:143]
    v_mfma_f32_32x32x16_bf16 v[128:143], a[88:91], a[24:27], v[128:143]
    v_mfma_f32_32x32x16_bf16 v[128:143], a[92:95], a[28:31], v[128:143]
    s_mov_b32 s51, s52
    s_add_u32 s31, s36, 0
    buffer_load_dwordx4 a[0:3], v7, s[4:7], s31 offen offset:0 sc1
    buffer_load_dwordx4 a[4:7], v7, s[4:7], s31 offen offset:1024 sc1
    buffer_load_dwordx4 a[8:11], v7, s[4:7], s31 offen offset:2048 sc1
    buffer_load_dwordx4 a[12:15], v7, s[4:7], s31 offen offset:3072 sc1
    s_add_u32 s31, s36, 4096
    buffer_load_dwordx4 a[16:19], v7, s[4:7], s31 offen offset:0 sc1
    buffer_load_dwordx4 a[20:23], v7, s[4:7], s31 offen offset:1024 sc1
    buffer_load_dwordx4 a[24:27], v7, s[4:7], s31 offen offset:2048 sc1
    buffer_load_dwordx4 a[28:31], v7, s[4:7], s31 offen offset:3072 sc1
    s_cmp_eq_u32 s51, 0
    s_cbranch_scc1 at_k3_80
    s_mov_b32 exec_lo, 0xff
    s_mov_b32 exec_hi, 0xff
    buffer_load_dwordx4 a[64:67], v9, s[4:7], s46 offen offset:0 sc1
    buffer_load_dwordx4 a[68:71], v9, s[4:7], s46 offen offset:256 sc1
    buffer_load_dwordx4 a[72:75], v9, s[4:7], s46 offen offset:512 sc1
    buffer_load_dwordx4 a[76:79], v9, s[4:7], s46 offen offset:768 sc1
    buffer_load_dwordx4 a[80:83], v9, s[4:7], s46 offen offset:1024 sc1
    buffer_load_dwordx4 a[84:87], v9, s[4:7], s46 offen offset:1280 sc1
    buffer_load_dwordx4 a[88:91], v9, s[4:7], s46 offen offset:1536 sc1
    buffer_load_dwordx4 a[92:95], v9, s[4:7], s46 offen offset:1792 sc1
    s_mov_b64 exec, -1
at_k3_80:
    v_max3_f32 v14, v112, v113, v114
    v_max3_f32 v14, v14, v115, v116
    v_max3_f32 v14, v14, v117, v118
    v_max3_f32 v14, v14, v119, v120
    v_max3_f32 v14, v14, v121, v122
    v_max3_f32 v14, v14, v123, v124
    v_max3_f32 v14, v14, v125, v126
    v_max3_f32 v14, v14, v127, v128
    v_max3_f32 v14, v14, v129, v130
    v_max_f32 v14, v14, v131
    v_mov_b32 v15, v14
    s_nop 1
    v_permlane32_swap_b32 v14, v15
    v_max_f32 v14, v14, v15
    v_mul_f32 v14, s42, v14
    v_fma_f32 v112, v112, s42, -v14
    v_fma_f32 v113, v113, s42, -v14
    v_fma_f32 v114, v114, s42, -v14
    v_fma_f32 v115, v115, s42, -v14
    v_fma_f32 v116, v116, s42, -v14
    v_fma_f32 v117, v117, s42, -v14
    v_fma_f32 v118, v118, s42, -v14
    v_fma_f32 v119, v119, s42, -v14
    v_fma_f32 v120, v120, s42, -v14
    v_fma_f32 v121, v121, s42, -v14
    v_fma_f32 v122, v122, s42, -v14
    v_fma_f32 v123, v123, s42, -v14
    v_fma_f32 v124, v124, s42, -v14
    v_fma_f32 v125, v125, s42, -v14
    v_fma_f32 v126, v126, s42, -v14
    v_fma_f32 v127, v127, s42, -v14
    v_fma_f32 v128, v128, s42, -v14
    v_fma_f32 v129, v129, s42, -v14
    v_fma_f32 v130, v130, s42, -v14
    v_fma_f32 v131, v131, s42, -v14
    v_exp_f32 v112, v112
    v_exp_f32 v113, v113
    v_exp_f32 v114, v114
    v_exp_f32 v115, v115
    v_exp_f32 v116, v116
    v_exp_f32 v117, v117
    v_exp_f32 v118, v118
    v_exp_f32 v119, v119
    v_exp_f32 v120, v120
    v_exp_f32 v121, v121
    v_exp_f32 v122, v122
    v_exp_f32 v123, v123
    v_exp_f32 v124, v124
    v_exp_f32 v125, v125
    v_exp_f32 v126, v126
    v_exp_f32 v127, v127
    v_exp_f32 v128, v128
    v_exp_f32 v129, v129
    v_exp_f32 v130, v130
    v_exp_f32 v131, v131
    v_add_f32 v26, v112, v113
    v_add_f32 v15, v114, v115
    v_add_f32 v26, v26, v116
    v_add_f32 v15, v15, v117
    v_add_f32 v26, v26, v118
    v_add_f32 v15, v15, v119
    v_add_f32 v26, v26, v120
    v_add_f32 v15, v15, v121
    v_add_f32 v26, v26, v122
    v_add_f32 v15, v15, v123
    v_add_f32 v26, v26, v124
    v_add_f32 v15, v15, v125
    v_add_f32 v26, v26, v126
    v_add_f32 v15, v15, v127
    v_add_f32 v26, v26, v128
    v_add_f32 v15, v15, v129
    v_add_f32 v26, v26, v130
    v_add_f32 v15, v15, v131
    v_add_f32 v26, v26, v15
    v_mov_b32 v15, v26
    s_nop 1
    v_permlane32_swap_b32 v26, v15
    v_add_f32 v26, v26, v15
    v_rcp_f32 v26, v26
    v_cvt_pk_bf16_f32 v28, v112, v113
    v_cvt_pk_bf16_f32 v29, v114, v115
    v_cvt_pk_bf16_f32 v30, v116, v117
    v_cvt_pk_bf16_f32 v31, v118, v119
    v_cvt_pk_bf16_f32 v32, v120, v121
    v_cvt_pk_bf16_f32 v33, v122, v123
    v_cvt_pk_bf16_f32 v34, v124, v125
    v_cvt_pk_bf16_f32 v35, v126, v127
    v_cvt_pk_bf16_f32 v40, v128, v129
    v_cvt_pk_bf16_f32 v41, v130, v131
    s_waitcnt vmcnt(16)
    v_mov_b32 v2, s45
    buffer_store_dword v2, v12, s[4:7], s43 offen sc1
    v_mfma_f32_32x32x16_bf16 v[144:159], a[96:99], v[28:31], 0
    v_mfma_f32_32x32x16_bf16 v[144:159], a[100:103], v[32:35], v[144:159]
    v_mfma_f32_32x32x16_bf16 v[144:159], a[128:131], v[40:43], v[144:159]
    v_mfma_f32_32x32x16_bf16 v[160:175], a[104:107], v[28:31], 0
    v_mfma_f32_32x32x16_bf16 v[160:175], a[108:111], v[32:35], v[160:175]
    v_mfma_f32_32x32x16_bf16 v[160:175], a[132:135], v[40:43], v[160:175]
    v_mfma_f32_32x32x16_bf16 v[176:191], a[112:115], v[28:31], 0
    s_nop 7
    v_mul_f32 v144, v144, v26
    v_mul_f32 v145, v145, v26
    v_mul_f32 v146, v146, v26
    v_mul_f32 v147, v147, v26
    v_mul_f32 v148, v148, v26
    v_mul_f32 v149, v149, v26
    v_mfma_f32_32x32x16_bf16 v[176:191], a[116:119], v[32:35], v[176:191]
    v_mul_f32 v150, v150, v26
    v_mul_f32 v151, v151, v26
    v_mul_f32 v152, v152, v26
    v_mul_f32 v153, v153, v26
    v_mul_f32 v154, v154, v26
    v_mul_f32 v155, v155, v26
    v_mfma_f32_32x32x16_bf16 v[176:191], a[136:139], v[40:43], v[176:191]
    v_mul_f32 v156, v156, v26
    v_mul_f32 v157, v157, v26
    v_mul_f32 v158, v158, v26
    v_mul_f32 v159, v159, v26
    v_cvt_pk_bf16_f32 v208, v144, v145
    v_cvt_pk_bf16_f32 v209, v146, v147
    v_mfma_f32_32x32x16_bf16 v[192:207], a[120:123], v[28:31], 0
    v_cvt_pk_bf16_f32 v210, v148, v149
    v_cvt_pk_bf16_f32 v211, v150, v151
    v_cvt_pk_bf16_f32 v212, v152, v153
    v_cvt_pk_bf16_f32 v213, v154, v155
    v_cvt_pk_bf16_f32 v214, v156, v157
    v_cvt_pk_bf16_f32 v215, v158, v159
    v_mfma_f32_32x32x16_bf16 v[192:207], a[124:127], v[32:35], v[192:207]
    v_mul_f32 v160, v160, v26
    v_mul_f32 v161, v161, v26
    v_mul_f32 v162, v162, v26
    v_mul_f32 v163, v163, v26
    v_mul_f32 v164, v164, v26
    v_mul_f32 v165, v165, v26
    v_mfma_f32_32x32x16_bf16 v[192:207], a[140:143], v[40:43], v[192:207]
    v_mul_f32 v166, v166, v26
    v_mul_f32 v167, v167, v26
    v_mul_f32 v168, v168, v26
    v_mul_f32 v169, v169, v26
    v_mul_f32 v170, v170, v26
    v_mul_f32 v171, v171, v26
    s_add_u32 s31, s36, 33554432
    buffer_load_dwordx4 a[96:99], v7, s[4:7], s31 offen offset:0 sc1
    buffer_load_dwordx4 a[100:103], v7, s[4:7], s31 offen offset:1024 sc1
    buffer_load_dwordx4 a[104:107], v7, s[4:7], s31 offen offset:2048 sc1
    buffer_load_dwordx4 a[108:111], v7, s[4:7], s31 offen offset:3072 sc1
    s_add_u32 s31, s36, 33558528
    buffer_load_dwordx4 a[112:115], v7, s[4:7], s31 offen offset:0 sc1
    buffer_load_dwordx4 a[116:119], v7, s[4:7], s31 offen offset:1024 sc1
    buffer_load_dwordx4 a[120:123], v7, s[4:7], s31 offen offset:2048 sc1
    buffer_load_dwordx4 a[124:127], v7, s[4:7], s31 offen offset:3072 sc1
    s_cmp_eq_u32 s51, 0
    s_cbranch_scc1 at_k4_81
    buffer_load_dwordx2 a[128:129], v10, s[4:7], s46 offen offset:0 sc1
    buffer_load_dwordx2 a[132:133], v10, s[4:7], s46 offen offset:512 sc1
    buffer_load_dwordx2 a[136:137], v10, s[4:7], s46 offen offset:1024 sc1
    buffer_load_dwordx2 a[140:141], v10, s[4:7], s46 offen offset:1536 sc1
at_k4_81:
    v_mul_f32 v172, v172, v26
    v_mul_f32 v173, v173, v26
    v_mul_f32 v174, v174, v26
    v_mul_f32 v175, v175, v26
    v_cvt_pk_bf16_f32 v216, v160, v161
    v_cvt_pk_bf16_f32 v217, v162, v163
    v_cvt_pk_bf16_f32 v218, v164, v165
    v_cvt_pk_bf16_f32 v219, v166, v167
    v_cvt_pk_bf16_f32 v220, v168, v169
    v_cvt_pk_bf16_f32 v221, v170, v171
    v_cvt_pk_bf16_f32 v222, v172, v173
    v_cvt_pk_bf16_f32 v223, v174, v175
    v_mul_f32 v176, v176, v26
    v_mul_f32 v177, v177, v26
    v_mul_f32 v178, v178, v26
    v_mul_f32 v179, v179, v26
    v_mul_f32 v180, v180, v26
    v_mul_f32 v181, v181, v26
    v_mul_f32 v182, v182, v26
    v_mul_f32 v183, v183, v26
    v_mul_f32 v184, v184, v26
    v_mul_f32 v185, v185, v26
    v_mul_f32 v186, v186, v26
    v_mul_f32 v187, v187, v26
    v_mul_f32 v188, v188, v26
    v_mul_f32 v189, v189, v26
    v_mul_f32 v190, v190, v26
    v_mul_f32 v191, v191, v26
    v_cvt_pk_bf16_f32 v224, v176, v177
    v_cvt_pk_bf16_f32 v225, v178, v179
    v_cvt_pk_bf16_f32 v226, v180, v181
    v_cvt_pk_bf16_f32 v227, v182, v183
    v_cvt_pk_bf16_f32 v228, v184, v185
    v_cvt_pk_bf16_f32 v229, v186, v187
    v_cvt_pk_bf16_f32 v230, v188, v189
    v_cvt_pk_bf16_f32 v231, v190, v191
    v_mul_f32 v192, v192, v26
    v_mul_f32 v193, v193, v26
    v_mul_f32 v194, v194, v26
    v_mul_f32 v195, v195, v26
    v_mul_f32 v196, v196, v26
    v_mul_f32 v197, v197, v26
    v_mul_f32 v198, v198, v26
    v_mul_f32 v199, v199, v26
    v_mul_f32 v200, v200, v26
    v_mul_f32 v201, v201, v26
    v_mul_f32 v202, v202, v26
    v_mul_f32 v203, v203, v26
    v_mul_f32 v204, v204, v26
    v_mul_f32 v205, v205, v26
    v_mul_f32 v206, v206, v26
    v_mul_f32 v207, v207, v26
    v_cvt_pk_bf16_f32 v232, v192, v193
    v_cvt_pk_bf16_f32 v233, v194, v195
    v_cvt_pk_bf16_f32 v234, v196, v197
    v_cvt_pk_bf16_f32 v235, v198, v199
    v_cvt_pk_bf16_f32 v236, v200, v201
    v_cvt_pk_bf16_f32 v237, v202, v203
    v_cvt_pk_bf16_f32 v238, v204, v205
    v_cvt_pk_bf16_f32 v239, v206, v207
    s_add_u32 s31, s47, 0
    buffer_store_dwordx4 v[208:211], v8, s[4:7], s31 offen offset:0 sc1
    buffer_store_dwordx4 v[212:215], v8, s[4:7], s31 offen offset:1024 sc1
    buffer_store_dwordx4 v[216:219], v8, s[4:7], s31 offen offset:2048 sc1
    buffer_store_dwordx4 v[220:223], v8, s[4:7], s31 offen offset:3072 sc1
    s_add_u32 s31, s47, 4096
    buffer_store_dwordx4 v[224:227], v8, s[4:7], s31 offen offset:0 sc1
    buffer_store_dwordx4 v[228:231], v8, s[4:7], s31 offen offset:1024 sc1
    buffer_store_dwordx4 v[232:235], v8, s[4:7], s31 offen offset:2048 sc1
    buffer_store_dwordx4 v[236:239], v8, s[4:7], s31 offen offset:3072 sc1
    s_mov_b32 s45, 1
    s_lshl_b32 s43, s53, 12
    s_add_u32 s43, s43, 32768
    s_mov_b32 s53, s49
    s_add_u32 s49, s53, s37
    s_cmp_lt_u32 s49, s38
    s_cbranch_scc1 at_nx_82
    s_max_u32 s49, s49, s39
    s_cmp_eq_u32 s38, 255
    s_cselect_b32 s49, s49, s39
    s_mov_b32 s37, 3
    s_mov_b32 s38, 255
at_nx_82:
    s_waitcnt vmcnt(17)
    s_branch at_top_66
at_b_68:
    s_load_dwordx16 s[8:23], s[90:91], s57 glc
    s_load_dwordx4 s[76:79], s[90:91], s55 glc
    s_load_dwordx4 s[80:83], s[90:91], s56 glc
    s_lshl_b32 s48, s54, 16
    s_add_u32 s48, s48, 83886080
    s_add_u32 s32, s54, 1
    s_min_u32 s32, s32, 63
    s_lshl_b32 s35, s32, 16
    v_mfma_f32_32x32x16_bf16 v[128:143], a[184:187], a[160:163], v[80:95]
    v_mfma_f32_32x32x16_bf16 v[128:143], a[188:191], a[164:167], v[128:143]
    v_mfma_f32_32x32x16_bf16 v[112:127], a[168:171], a[160:163], v[64:79]
    v_mfma_f32_32x32x16_bf16 v[112:127], a[172:175], a[164:167], v[112:127]
    v_accvgpr_mov_b32 a184, a168
    v_accvgpr_mov_b32 a185, a169
    v_accvgpr_mov_b32 a186, a170
    v_accvgpr_mov_b32 a187, a171
    v_accvgpr_mov_b32 a188, a172
    v_accvgpr_mov_b32 a189, a173
    v_accvgpr_mov_b32 a190, a174
    v_accvgpr_mov_b32 a191, a175
    v_accvgpr_mov_b32 a196, a176
    v_accvgpr_mov_b32 a197, a177
    v_accvgpr_mov_b32 a198, a178
    v_accvgpr_mov_b32 a199, a179
    v_accvgpr_mov_b32 a200, a180
    v_accvgpr_mov_b32 a201, a181
    v_accvgpr_mov_b32 a202, a182
    v_accvgpr_mov_b32 a203, a183
    s_add_u32 s31, s35, 50331648
    buffer_load_dwordx4 a[160:163], v6, s[4:7], s31 offen offset:0 sc1
    buffer_load_dwordx4 a[164:167], v6, s[4:7], s31 offen offset:1024 sc1
    s_add_u32 s31, s35, 54525952
    buffer_load_dwordx4 a[168:171], v6, s[4:7], s31 offen offset:0 sc1
    buffer_load_dwordx4 a[172:175], v6, s[4:7], s31 offen offset:1024 sc1
    s_add_u32 s31, s35, 58720256
    buffer_load_dwordx4 a[176:179], v6, s[4:7], s31 offen offset:0 sc1
    buffer_load_dwordx4 a[180:183], v6, s[4:7], s31 offen offset:1024 sc1
    v_max3_f32 v14, v136, v137, v138
    v_max3_f32 v14, v14, v139, v140
    v_max3_f32 v14, v14, v141, v142
    v_max3_f32 v14, v14, v143, v112
    v_max3_f32 v14, v14, v113, v114
    v_max3_f32 v14, v14, v115, v116
    v_max3_f32 v14, v14, v117, v118
    v_max3_f32 v14, v14, v119, v120
    v_max3_f32 v14, v14, v121, v122
    v_max3_f32 v14, v14, v123, v124
    v_max3_f32 v14, v14, v125, v126
    v_max_f32 v14, v14, v127
    v_mov_b32 v15, v14
    s_nop 1
    v_permlane32_swap_b32 v14, v15
    v_max_f32 v14, v14, v15
    v_mul_f32 v14, s58, v14
    v_fma_f32 v136, v136, s58, -v14
    v_fma_f32 v137, v137, s58, -v14
    v_fma_f32 v138, v138, s58, -v14
    v_fma_f32 v139, v139, s58, -v14
    v_fma_f32 v140, v140, s58, -v14
    v_fma_f32 v141, v141, s58, -v14
    v_fma_f32 v142, v142, s58, -v14
    v_fma_f32 v143, v143, s58, -v14
    v_fma_f32 v112, v112, s58, -v14
    v_fma_f32 v113, v113, s58, -v14
    v_fma_f32 v114, v114, s58, -v14
    v_fma_f32 v115, v115, s58, -v14
    v_fma_f32 v116, v116, s58, -v14
    v_fma_f32 v117, v117, s58, -v14
    v_fma_f32 v118, v118, s58, -v14
    v_fma_f32 v119, v119, s58, -v14
    v_fma_f32 v120, v120, s58, -v14
    v_fma_f32 v121, v121, s58, -v14
    v_fma_f32 v122, v122, s58, -v14
    v_fma_f32 v123, v123, s58, -v14
    v_fma_f32 v124, v124, s58, -v14
    v_fma_f32 v125, v125, s58, -v14
    v_fma_f32 v126, v126, s58, -v14
    v_fma_f32 v127, v127, s58, -v14
    v_exp_f32 v136, v136
    v_exp_f32 v137, v137
    v_exp_f32 v138, v138
    v_exp_f32 v139, v139
    v_exp_f32 v140, v140
    v_exp_f32 v141, v141
    v_exp_f32 v142, v142
    v_exp_f32 v143, v143
    v_exp_f32 v112, v112
    v_exp_f32 v113, v113
    v_exp_f32 v114, v114
    v_exp_f32 v115, v115
    v_exp_f32 v116, v116
    v_exp_f32 v117, v117
    v_exp_f32 v118, v118
    v_exp_f32 v119, v119
    v_exp_f32 v120, v120
    v_exp_f32 v121, v121
    v_exp_f32 v122, v122
    v_exp_f32 v123, v123
    v_exp_f32 v124, v124
    v_exp_f32 v125, v125
    v_exp_f32 v126, v126
    v_exp_f32 v127, v127
    v_add_f32 v26, v136, v137
    v_add_f32 v15, v138, v139
    v_add_f32 v26, v26, v140
    v_add_f32 v15, v15, v141
    v_add_f32 v26, v26, v142
    v_add_f32 v15, v15, v143
    v_add_f32 v26, v26, v112
    v_add_f32 v15, v15, v113
    v_add_f32 v26, v26, v114
    v_add_f32 v15, v15, v115
    v_add_f32 v26, v26, v116
    v_add_f32 v15, v15, v117
    v_add_f32 v26, v26, v118
    v_add_f32 v15, v15, v119
    v_add_f32 v26, v26, v120
    v_add_f32 v15, v15, v121
    v_add_f32 v26, v26, v122
    v_add_f32 v15, v15, v123
    v_add_f32 v26, v26, v124
    v_add_f32 v15, v15, v125
    v_add_f32 v26, v26, v126
    v_add_f32 v15, v15, v127
    v_add_f32 v26, v26, v15
    v_mov_b32 v15, v26
    s_nop 1
    v_permlane32_swap_b32 v26, v15
    v_add_f32 v26, v26, v15
    v_rcp_f32 v26, v26
    v_cvt_pk_bf16_f32 v28, v112, v113
    v_cvt_pk_bf16_f32 v29, v114, v115
    v_cvt_pk_bf16_f32 v30, v116, v117
    v_cvt_pk_bf16_f32 v31, v118, v119
    v_cvt_pk_bf16_f32 v32, v120, v121
    v_cvt_pk_bf16_f32 v33, v122, v123
    v_cvt_pk_bf16_f32 v34, v124, v125
    v_cvt_pk_bf16_f32 v35, v126, v127
    v_cvt_pk_bf16_f32 v36, v136, v137
    v_cvt_pk_bf16_f32 v37, v138, v139
    v_cvt_pk_bf16_f32 v38, v140, v141
    v_cvt_pk_bf16_f32 v39, v142, v143
    v_mfma_f32_32x32x16_bf16 v[144:159], a[196:199], v[28:31], 0
    v_mfma_f32_32x32x16_bf16 v[144:159], a[200:203], v[32:35], v[144:159]
    v_mfma_f32_32x32x16_bf16 v[144:159], a[192:195], v[36:39], v[144:159]
    v_accvgpr_mov_b32 a192, a200
    v_accvgpr_mov_b32 a193, a201
    v_accvgpr_mov_b32 a194, a202
    v_accvgpr_mov_b32 a195, a203
    s_waitcnt vmcnt(6)
    v_mov_b32 v2, s45
    buffer_store_dword v2, v12, s[4:7], s43 offen sc1
    s_cmp_lg_u32 s54, 0
    s_cbranch_scc1 at_nb_70
    v_mov_b32 v14, 0xf149f2ca
    v_add_u32 v3, 32, v11
    v_and_b32 v3, 0xfffffff1, v3
    v_cmp_ne_u32 vcc, 0, v3
    s_nop 1
    v_cndmask_b32 v80, 0, v14, vcc
    v_add_u32 v3, 31, v11
    v_and_b32 v3, 0xfffffff1, v3
    v_cmp_ne_u32 vcc, 0, v3
    s_nop 1
    v_cndmask_b32 v81, 0, v14, vcc
    v_add_u32 v3, 30, v11
    v_and_b32 v3, 0xfffffff1, v3
    v_cmp_ne_u32 vcc, 0, v3
    s_nop 1
    v_cndmask_b32 v82, 0, v14, vcc
    v_add_u32 v3, 29, v11
    v_and_b32 v3, 0xfffffff1, v3
    v_cmp_ne_u32 vcc, 0, v3
    s_nop 1
    v_cndmask_b32 v83, 0, v14, vcc
    v_add_u32 v3, 24, v11
    v_and_b32 v3, 0xfffffff1, v3
    v_cmp_ne_u32 vcc, 0, v3
    s_nop 1
    v_cndmask_b32 v84, 0, v14, vcc
    v_add_u32 v3, 23, v11
    v_and_b32 v3, 0xfffffff1, v3
    v_cmp_ne_u32 vcc, 0, v3
    s_nop 1
    v_cndmask_b32 v85, 0, v14, vcc
    v_add_u32 v3, 22, v11
    v_and_b32 v3, 0xfffffff1, v3
    v_cmp_ne_u32 vcc, 0, v3
    s_nop 1
    v_cndmask_b32 v86, 0, v14, vcc
    v_add_u32 v3, 21, v11
    v_and_b32 v3, 0xfffffff1, v3
    v_cmp_ne_u32 vcc, 0, v3
    s_nop 1
    v_cndmask_b32 v87, 0, v14, vcc
    v_add_u32 v3, 16, v11
    v_and_b32 v3, 0xfffffff1, v3
    v_cmp_ne_u32 vcc, 0, v3
    s_nop 1
    v_cndmask_b32 v88, 0, v14, vcc
    v_add_u32 v3, 15, v11
    v_and_b32 v3, 0xfffffff1, v3
    v_cmp_ne_u32 vcc, 0, v3
    s_nop 1
    v_cndmask_b32 v89, 0, v14, vcc
    v_add_u32 v3, 14, v11
    v_and_b32 v3, 0xfffffff1, v3
    v_cmp_ne_u32 vcc, 0, v3
    s_nop 1
    v_cndmask_b32 v90, 0, v14, vcc
    v_add_u32 v3, 13, v11
    v_and_b32 v3, 0xfffffff1, v3
    v_cmp_ne_u32 vcc, 0, v3
    s_nop 1
    v_cndmask_b32 v91, 0, v14, vcc
    v_add_u32 v3, 8, v11
    v_and_b32 v3, 0xfffffff1, v3
    v_cmp_ne_u32 vcc, 0, v3
    s_nop 1
    v_cndmask_b32 v92, 0, v14, vcc
    v_add_u32 v3, 7, v11
    v_and_b32 v3, 0xfffffff1, v3
    v_cmp_ne_u32 vcc, 0, v3
    s_nop 1
    v_cndmask_b32 v93, 0, v14, vcc
    v_add_u32 v3, 6, v11
    v_and_b32 v3, 0xfffffff1, v3
    v_cmp_ne_u32 vcc, 0, v3
    s_nop 1
    v_cndmask_b32 v94, 0, v14, vcc
    v_add_u32 v3, 5, v11
    v_and_b32 v3, 0xfffffff1, v3
    v_cmp_ne_u32 vcc, 0, v3
    s_nop 1
    v_cndmask_b32 v95, 0, v14, vcc
at_nb_70:
    s_nop 2
    v_mul_f32 v144, v144, v26
    v_mul_f32 v145, v145, v26
    v_mul_f32 v146, v146, v26
    v_mul_f32 v147, v147, v26
    v_mul_f32 v148, v148, v26
    v_mul_f32 v149, v149, v26
    v_mul_f32 v150, v150, v26
    v_mul_f32 v151, v151, v26
    v_mul_f32 v152, v152, v26
    v_mul_f32 v153, v153, v26
    v_mul_f32 v154, v154, v26
    v_mul_f32 v155, v155, v26
    v_mul_f32 v156, v156, v26
    v_mul_f32 v157, v157, v26
    v_mul_f32 v158, v158, v26
    v_mul_f32 v159, v159, v26
    v_cvt_pk_bf16_f32 v208, v144, v145
    v_cvt_pk_bf16_f32 v209, v146, v147
    v_cvt_pk_bf16_f32 v210, v148, v149
    v_cvt_pk_bf16_f32 v211, v150, v151
    v_cvt_pk_bf16_f32 v212, v152, v153
    v_cvt_pk_bf16_f32 v213, v154, v155
    v_cvt_pk_bf16_f32 v214, v156, v157
    v_cvt_pk_bf16_f32 v215, v158, v159
    v_permlane32_swap_b32 v208, v210
    v_permlane32_swap_b32 v209, v211
    v_permlane32_swap_b32 v212, v214
    v_permlane32_swap_b32 v213, v215
    buffer_store_dwordx4 v[208:211], v6, s[4:7], s48 offen offset:0 sc1
    buffer_store_dwordx4 v[212:215], v6, s[4:7], s48 offen offset:1024 sc1
    s_add_u32 s54, s54, 1
    s_mov_b32 s43, 16384
    s_mov_b32 s45, s54
    s_waitcnt vmcnt(3)
    s_branch at_top_66
at_end_69:
    s_waitcnt vmcnt(0) lgkmcnt(0)
    s_branch L_o64
L_o64:
    s_cmp_ge_u32 s28, 80
    s_cbranch_scc1 L_dump
    s_load_dwordx2 s[72:73], s[0:1], 40
    s_load_dwordx2 s[74:75], s[0:1], 80
    s_mul_i32 s44, s28, 205
    s_lshr_b32 s44, s44, 10
    s_mul_i32 s31, s44, 5
    s_sub_u32 s30, s28, s31
    s_waitcnt lgkmcnt(0)
    s_mov_b32 s8, s72
    s_and_b32 s9, s73, 0xffff
    s_mov_b32 s10, 8388608
    s_mov_b32 s11, 0x00020000
    s_mov_b32 s20, s74
    s_and_b32 s21, s75, 0xffff
    s_mov_b32 s22, 8388608
    s_mov_b32 s23, 0x00020000
    s_lshl_b32 s31, s29, 21
    s_lshl_b32 s33, s44, 7
    s_add_u32 s31, s31, s33
    v_lshrrev_b32 v6, 3, v1
    v_lshlrev_b32 v6, 11, v6
    v_and_b32 v4, 7, v1
    v_lshl_add_u32 v6, v4, 4, v6
    v_add_u32 v6, s31, v6
    s_lshl_b32 s31, s29, 15
    v_lshrrev_b32 v7, 5, v1
    v_lshlrev_b32 v7, 9, v7
    v_bfe_u32 v4, v1, 2, 2
    v_lshl_add_u32 v7, v4, 7, v7
    v_bfe_u32 v4, v1, 4, 1
    v_lshl_add_u32 v7, v4, 5, v7
    v_and_b32 v4, 3, v1
    v_lshl_add_u32 v7, v4, 3, v7
    v_add_u32 v7, s31, v7
    s_lshl_b32 s32, s29, 15
    s_add_u32 m0, s32, 0
    s_mov_b32 s38, 0
    buffer_load_dwordx4 v6, s[8:11], s38 offen lds
    s_add_u32 m0, s32, 1024
    s_add_u32 s38, s38, 16384
    buffer_load_dwordx4 v6, s[8:11], s38 offen lds
    s_add_u32 m0, s32, 2048
    s_add_u32 s38, s38, 16384
    buffer_load_dwordx4 v6, s[8:11], s38 offen lds
    s_add_u32 m0, s32, 3072
    s_add_u32 s38, s38, 16384
    buffer_load_dwordx4 v6, s[8:11], s38 offen lds
    s_add_u32 m0, s32, 4096
    s_add_u32 s38, s38, 16384
    buffer_load_dwordx4 v6, s[8:11], s38 offen lds
    s_add_u32 m0, s32, 5120
    s_add_u32 s38, s38, 16384
    buffer_load_dwordx4 v6, s[8:11], s38 offen lds
    s_add_u32 m0, s32, 6144
    s_add_u32 s38, s38, 16384
    buffer_load_dwordx4 v6, s[8:11], s38 offen lds
    s_add_u32 m0, s32, 7168
    s_add_u32 s38, s38, 16384
    buffer_load_dwordx4 v6, s[8:11], s38 offen lds
    s_add_u32 m0, s32, 8192
    s_add_u32 s38, s38, 16384
    buffer_load_dwordx4 v6, s[8:11], s38 offen lds
    s_add_u32 m0, s32, 9216
    s_add_u32 s38, s38, 16384
    buffer_load_dwordx4 v6, s[8:11], s38 offen lds
    s_add_u32 m0, s32, 10240
    s_add_u32 s38, s38, 16384
    buffer_load_dwordx4 v6, s[8:11], s38 offen lds
    s_add_u32 m0, s32, 11264
    s_add_u32 s38, s38, 16384
    buffer_load_dwordx4 v6, s[8:11], s38 offen lds
    s_add_u32 m0, s32, 12288
    s_add_u32 s38, s38, 16384
    buffer_load_dwordx4 v6, s[8:11], s38 offen lds
    s_add_u32 m0, s32, 13312
    s_add_u32 s38, s38, 16384
    buffer_load_dwordx4 v6, s[8:11], s38 offen lds
    s_add_u32 m0, s32, 14336
    s_add_u32 s38, s38, 16384
    buffer_load_dwordx4 v6, s[8:11], s38 offen lds
    s_add_u32 m0, s32, 15360
    s_add_u32 s38, s38, 16384
    buffer_load_dwordx4 v6, s[8:11], s38 offen lds
    s_add_u32 m0, s32, 16384
    s_add_u32 s38, s38, 16384
    buffer_load_dwordx4 v6, s[8:11], s38 offen lds
    s_add_u32 m0, s32, 17408
    s_add_u32 s38, s38, 16384
    buffer_load_dwordx4 v6, s[8:11], s38 offen lds
    s_add_u32 m0, s32, 18432
    s_add_u32 s38, s38, 16384
    buffer_load_dwordx4 v6, s[8:11], s38 offen lds
    s_add_u32 m0, s32, 19456
    s_add_u32 s38, s38, 16384
    buffer_load_dwordx4 v6, s[8:11], s38 offen lds
    s_add_u32 m0, s32, 20480
    s_add_u32 s38, s38, 16384
    buffer_load_dwordx4 v6, s[8:11], s38 offen lds
    s_add_u32 m0, s32, 21504
    s_add_u32 s38, s38, 16384
    buffer_load_dwordx4 v6, s[8:11], s38 offen lds
    s_add_u32 m0, s32, 22528
    s_add_u32 s38, s38, 16384
    buffer_load_dwordx4 v6, s[8:11], s38 offen lds
    s_add_u32 m0, s32, 23552
    s_add_u32 s38, s38, 16384
    buffer_load_dwordx4 v6, s[8:11], s38 offen lds
    s_add_u32 m0, s32, 24576
    s_add_u32 s38, s38, 16384
    buffer_load_dwordx4 v6, s[8:11], s38 offen lds
    s_add_u32 m0, s32, 25600
    s_add_u32 s38, s38, 16384
    buffer_load_dwordx4 v6, s[8:11], s38 offen lds
    s_add_u32 m0, s32, 26624
    s_add_u32 s38, s38, 16384
    buffer_load_dwordx4 v6, s[8:11], s38 offen lds
    s_add_u32 m0, s32, 27648
    s_add_u32 s38, s38, 16384
    buffer_load_dwordx4 v6, s[8:11], s38 offen lds
    s_add_u32 m0, s32, 28672
    s_add_u32 s38, s38, 16384
    buffer_load_dwordx4 v6, s[8:11], s38 offen lds
    s_add_u32 m0, s32, 29696
    s_add_u32 s38, s38, 16384
    buffer_load_dwordx4 v6, s[8:11], s38 offen lds
    s_add_u32 m0, s32, 30720
    s_add_u32 s38, s38, 16384
    buffer_load_dwordx4 v6, s[8:11], s38 offen lds
    s_add_u32 m0, s32, 31744
    s_add_u32 s38, s38, 16384
    buffer_load_dwordx4 v6, s[8:11], s38 offen lds
    s_waitcnt vmcnt(30)
    ds_read_b64_tr_b16 a[0:1], v7 offset:0
    ds_read_b64_tr_b16 a[2:3], v7 offset:1024
    ds_read_b64_tr_b16 a[4:5], v7 offset:64
    ds_read_b64_tr_b16 a[6:7], v7 offset:1088
    s_waitcnt vmcnt(28)
    ds_read_b64_tr_b16 a[8:9], v7 offset:2048
    ds_read_b64_tr_b16 a[10:11], v7 offset:3072
    ds_read_b64_tr_b16 a[12:13], v7 offset:2112
    ds_read_b64_tr_b16 a[14:15], v7 offset:3136
    s_waitcnt lgkmcnt(4)
    s_add_u32 m0, s32, 0
    s_add_u32 s38, s38, 16384
    buffer_load_dwordx4 v6, s[8:11], s38 offen lds
    s_add_u32 m0, s32, 1024
    s_add_u32 s38, s38, 16384
    buffer_load_dwordx4 v6, s[8:11], s38 offen lds
    s_waitcnt vmcnt(28)
    ds_read_b64_tr_b16 a[16:17], v7 offset:4096
    ds_read_b64_tr_b16 a[18:19], v7 offset:5120
    ds_read_b64_tr_b16 a[20:21], v7 offset:4160
    ds_read_b64_tr_b16 a[22:23], v7 offset:5184
    s_waitcnt lgkmcnt(4)
    s_add_u32 m0, s32, 2048
    s_add_u32 s38, s38, 16384
    buffer_load_dwordx4 v6, s[8:11], s38 offen lds
    s_add_u32 m0, s32, 3072
    s_add_u32 s38, s38, 16384
    buffer_load_dwordx4 v6, s[8:11], s38 offen lds
    s_waitcnt vmcnt(28)
    ds_read_b64_tr_b16 a[24:25], v7 offset:6144
    ds_read_b64_tr_b16 a[26:27], v7 offset:7168
    ds_read_b64_tr_b16 a[28:29], v7 offset:6208
    ds_read_b64_tr_b16 a[30:31], v7 offset:7232
    s_waitcnt lgkmcnt(4)
    s_add_u32 m0, s32, 4096
    s_add_u32 s38, s38, 16384
    buffer_load_dwordx4 v6, s[8:11], s38 offen lds
    s_add_u32 m0, s32, 5120
    s_add_u32 s38, s38, 16384
    buffer_load_dwordx4 v6, s[8:11], s38 offen lds
    s_waitcnt vmcnt(28)
    ds_read_b64_tr_b16 a[32:33], v7 offset:8192
    ds_read_b64_tr_b16 a[34:35], v7 offset:9216
    ds_read_b64_tr_b16 a[36:37], v7 offset:8256
    ds_read_b64_tr_b16 a[38:39], v7 offset:9280
    s_waitcnt lgkmcnt(4)
    s_add_u32 m0, s32, 6144
    s_add_u32 s38, s38, 16384
    buffer_load_dwordx4 v6, s[8:11], s38 offen lds
    s_add_u32 m0, s32, 7168
    s_add_u32 s38, s38, 16384
    buffer_load_dwordx4 v6, s[8:11], s38 offen lds
    s_waitcnt vmcnt(28)
    ds_read_b64_tr_b16 a[40:41], v7 offset:10240
    ds_read_b64_tr_b16 a[42:43], v7 offset:11264
    ds_read_b64_tr_b16 a[44:45], v7 offset:10304
    ds_read_b64_tr_b16 a[46:47], v7 offset:11328
    s_waitcnt lgkmcnt(4)
    s_add_u32 m0, s32, 8192
    s_add_u32 s38, s38, 16384
    buffer_load_dwordx4 v6, s[8:11], s38 offen lds
    s_add_u32 m0, s32, 9216
    s_add_u32 s38, s38, 16384
    buffer_load_dwordx4 v6, s[8:11], s38 offen lds
    s_waitcnt vmcnt(28)
    ds_read_b64_tr_b16 a[48:49], v7 offset:12288
    ds_read_b64_tr_b16 a[50:51], v7 offset:13312
    ds_read_b64_tr_b16 a[52:53], v7 offset:12352
    ds_read_b64_tr_b16 a[54:55], v7 offset:13376
    s_waitcnt lgkmcnt(4)
    s_add_u32 m0, s32, 10240
    s_add_u32 s38, s38, 16384
    buffer_load_dwordx4 v6, s[8:11], s38 offen lds
    s_add_u32 m0, s32, 11264
    s_add_u32 s38, s38, 16384
    buffer_load_dwordx4 v6, s[8:11], s38 offen lds
    s_waitcnt vmcnt(28)
    ds_read_b64_tr_b16 a[56:57], v7 offset:14336
    ds_read_b64_tr_b16 a[58:59], v7 offset:15360
    ds_read_b64_tr_b16 a[60:61], v7 offset:14400
    ds_read_b64_tr_b16 a[62:63], v7 offset:15424
    s_waitcnt lgkmcnt(4)
    s_add_u32 m0, s32, 12288
    s_add_u32 s38, s38, 16384
    buffer_load_dwordx4 v6, s[8:11], s38 offen lds
    s_add_u32 m0, s32, 13312
    s_add_u32 s38, s38, 16384
    buffer_load_dwordx4 v6, s[8:11], s38 offen lds
    s_waitcnt vmcnt(28)
    ds_read_b64_tr_b16 a[64:65], v7 offset:16384
    ds_read_b64_tr_b16 a[66:67], v7 offset:17408
    ds_read_b64_tr_b16 a[68:69], v7 offset:16448
    ds_read_b64_tr_b16 a[70:71], v7 offset:17472
    s_waitcnt lgkmcnt(4)
    s_add_u32 m0, s32, 14336
    s_add_u32 s38, s38, 16384
    buffer_load_dwordx4 v6, s[8:11], s38 offen lds
    s_add_u32 m0, s32, 15360
    s_add_u32 s38, s38, 16384
    buffer_load_dwordx4 v6, s[8:11], s38 offen lds
    s_waitcnt vmcnt(28)
    ds_read_b64_tr_b16 a[72:73], v7 offset:18432
    ds_read_b64_tr_b16 a[74:75], v7 offset:19456
    ds_read_b64_tr_b16 a[76:77], v7 offset:18496
    ds_read_b64_tr_b16 a[78:79], v7 offset:19520
    s_waitcnt lgkmcnt(4)
    s_add_u32 m0, s32, 16384
    s_add_u32 s38, s38, 16384
    buffer_load_dwordx4 v6, s[8:11], s38 offen lds
    s_add_u32 m0, s32, 17408
    s_add_u32 s38, s38, 16384
    buffer_load_dwordx4 v6, s[8:11], s38 offen lds
    s_waitcnt vmcnt(28)
    ds_read_b64_tr_b16 a[80:81], v7 offset:20480
    ds_read_b64_tr_b16 a[82:83], v7 offset:21504
    ds_read_b64_tr_b16 a[84:85], v7 offset:20544
    ds_read_b64_tr_b16 a[86:87], v7 offset:21568
    s_waitcnt lgkmcnt(4)
    s_add_u32 m0, s32, 18432
    s_add_u32 s38, s38, 16384
    buffer_load_dwordx4 v6, s[8:11], s38 offen lds
    s_add_u32 m0, s32, 19456
    s_add_u32 s38, s38, 16384
    buffer_load_dwordx4 v6, s[8:11], s38 offen lds
    s_waitcnt vmcnt(28)
    ds_read_b64_tr_b16 a[88:89], v7 offset:22528
    ds_read_b64_tr_b16 a[90:91], v7 offset:23552
    ds_read_b64_tr_b16 a[92:93], v7 offset:22592
    ds_read_b64_tr_b16 a[94:95], v7 offset:23616
    s_waitcnt lgkmcnt(4)
    s_add_u32 m0, s32, 20480
    s_add_u32 s38, s38, 16384
    buffer_load_dwordx4 v6, s[8:11], s38 offen lds
    s_add_u32 m0, s32, 21504
    s_add_u32 s38, s38, 16384
    buffer_load_dwordx4 v6, s[8:11], s38 offen lds
    s_waitcnt vmcnt(28)
    ds_read_b64_tr_b16 a[96:97], v7 offset:24576
    ds_read_b64_tr_b16 a[98:99], v7 offset:25600
    ds_read_b64_tr_b16 a[100:101], v7 offset:24640
    ds_read_b64_tr_b16 a[102:103], v7 offset:25664
    s_waitcnt lgkmcnt(4)
    s_add_u32 m0, s32, 22528
    s_add_u32 s38, s38, 16384
    buffer_load_dwordx4 v6, s[8:11], s38 offen lds
    s_add_u32 m0, s32, 23552
    s_add_u32 s38, s38, 16384
    buffer_load_dwordx4 v6, s[8:11], s38 offen lds
    s_waitcnt vmcnt(28)
    ds_read_b64_tr_b16 a[104:105], v7 offset:26624
    ds_read_b64_tr_b16 a[106:107], v7 offset:27648
    ds_read_b64_tr_b16 a[108:109], v7 offset:26688
    ds_read_b64_tr_b16 a[110:111], v7 offset:27712
    s_waitcnt lgkmcnt(4)
    s_add_u32 m0, s32, 24576
    s_add_u32 s38, s38, 16384
    buffer_load_dwordx4 v6, s[8:11], s38 offen lds
    s_add_u32 m0, s32, 25600
    s_add_u32 s38, s38, 16384
    buffer_load_dwordx4 v6, s[8:11], s38 offen lds
    s_waitcnt vmcnt(28)
    ds_read_b64_tr_b16 a[112:113], v7 offset:28672
    ds_read_b64_tr_b16 a[114:115], v7 offset:29696
    ds_read_b64_tr_b16 a[116:117], v7 offset:28736
    ds_read_b64_tr_b16 a[118:119], v7 offset:29760
    s_waitcnt lgkmcnt(4)
    s_add_u32 m0, s32, 26624
    s_add_u32 s38, s38, 16384
    buffer_load_dwordx4 v6, s[8:11], s38 offen lds
    s_add_u32 m0, s32, 27648
    s_add_u32 s38, s38, 16384
    buffer_load_dwordx4 v6, s[8:11], s38 offen lds
    s_waitcnt vmcnt(28)
    ds_read_b64_tr_b16 a[120:121], v7 offset:30720
    ds_read_b64_tr_b16 a[122:123], v7 offset:31744
    ds_read_b64_tr_b16 a[124:125], v7 offset:30784
    ds_read_b64_tr_b16 a[126:127], v7 offset:31808
    s_waitcnt lgkmcnt(4)
    s_add_u32 m0, s32, 28672
    s_add_u32 s38, s38, 16384
    buffer_load_dwordx4 v6, s[8:11], s38 offen lds
    s_add_u32 m0, s32, 29696
    s_add_u32 s38, s38, 16384
    buffer_load_dwordx4 v6, s[8:11], s38 offen lds
    s_waitcnt vmcnt(28)
    ds_read_b64_tr_b16 a[128:129], v7 offset:0
    ds_read_b64_tr_b16 a[130:131], v7 offset:1024
    ds_read_b64_tr_b16 a[132:133], v7 offset:64
    ds_read_b64_tr_b16 a[134:135], v7 offset:1088
    s_waitcnt lgkmcnt(4)
    s_add_u32 m0, s32, 30720
    s_add_u32 s38, s38, 16384
    buffer_load_dwordx4 v6, s[8:11], s38 offen lds
    s_add_u32 m0, s32, 31744
    s_add_u32 s38, s38, 16384
    buffer_load_dwordx4 v6, s[8:11], s38 offen lds
    s_waitcnt vmcnt(28)
    ds_read_b64_tr_b16 a[136:137], v7 offset:2048
    ds_read_b64_tr_b16 a[138:139], v7 offset:3072
    ds_read_b64_tr_b16 a[140:141], v7 offset:2112
    ds_read_b64_tr_b16 a[142:143], v7 offset:3136
    s_waitcnt lgkmcnt(4)
    s_add_u32 m0, s32, 0
    s_add_u32 s38, s38, 16384
    buffer_load_dwordx4 v6, s[8:11], s38 offen lds
    s_add_u32 m0, s32, 1024
    s_add_u32 s38, s38, 16384
    buffer_load_dwordx4 v6, s[8:11], s38 offen lds
    s_waitcnt vmcnt(28)
    ds_read_b64_tr_b16 a[144:145], v7 offset:4096
    ds_read_b64_tr_b16 a[146:147], v7 offset:5120
    ds_read_b64_tr_b16 a[148:149], v7 offset:4160
    ds_read_b64_tr_b16 a[150:151], v7 offset:5184
    s_waitcnt lgkmcnt(4)
    s_add_u32 m0, s32, 2048
    s_add_u32 s38, s38, 16384
    buffer_load_dwordx4 v6, s[8:11], s38 offen lds
    s_add_u32 m0, s32, 3072
    s_add_u32 s38, s38, 16384
    buffer_load_dwordx4 v6, s[8:11], s38 offen lds
    s_waitcnt vmcnt(28)
    ds_read_b64_tr_b16 a[152:153], v7 offset:6144
    ds_read_b64_tr_b16 a[154:155], v7 offset:7168
    ds_read_b64_tr_b16 a[156:157], v7 offset:6208
    ds_read_b64_tr_b16 a[158:159], v7 offset:7232
    s_waitcnt lgkmcnt(4)
    s_add_u32 m0, s32, 4096
    s_add_u32 s38, s38, 16384
    buffer_load_dwordx4 v6, s[8:11], s38 offen lds
    s_add_u32 m0, s32, 5120
    s_add_u32 s38, s38, 16384
    buffer_load_dwordx4 v6, s[8:11], s38 offen lds
    s_waitcnt vmcnt(28)
    ds_read_b64_tr_b16 a[160:161], v7 offset:8192
    ds_read_b64_tr_b16 a[162:163], v7 offset:9216
    ds_read_b64_tr_b16 a[164:165], v7 offset:8256
    ds_read_b64_tr_b16 a[166:167], v7 offset:9280
    s_waitcnt lgkmcnt(4)
    s_add_u32 m0, s32, 6144
    s_add_u32 s38, s38, 16384
    buffer_load_dwordx4 v6, s[8:11], s38 offen lds
    s_add_u32 m0, s32, 7168
    s_add_u32 s38, s38, 16384
    buffer_load_dwordx4 v6, s[8:11], s38 offen lds
    s_waitcnt vmcnt(28)
    ds_read_b64_tr_b16 a[168:169], v7 offset:10240
    ds_read_b64_tr_b16 a[170:171], v7 offset:11264
    ds_read_b64_tr_b16 a[172:173], v7 offset:10304
    ds_read_b64_tr_b16 a[174:175], v7 offset:11328
    s_waitcnt lgkmcnt(4)
    s_add_u32 m0, s32, 8192
    s_add_u32 s38, s38, 16384
    buffer_load_dwordx4 v6, s[8:11], s38 offen lds
    s_add_u32 m0, s32, 9216
    s_add_u32 s38, s38, 16384
    buffer_load_dwordx4 v6, s[8:11], s38 offen lds
    s_waitcnt vmcnt(28)
    ds_read_b64_tr_b16 a[176:177], v7 offset:12288
    ds_read_b64_tr_b16 a[178:179], v7 offset:13312
    ds_read_b64_tr_b16 a[180:181], v7 offset:12352
    ds_read_b64_tr_b16 a[182:183], v7 offset:13376
    s_waitcnt lgkmcnt(4)
    s_add_u32 m0, s32, 10240
    s_add_u32 s38, s38, 16384
    buffer_load_dwordx4 v6, s[8:11], s38 offen lds
    s_add_u32 m0, s32, 11264
    s_add_u32 s38, s38, 16384
    buffer_load_dwordx4 v6, s[8:11], s38 offen lds
    s_waitcnt vmcnt(28)
    ds_read_b64_tr_b16 a[184:185], v7 offset:14336
    ds_read_b64_tr_b16 a[186:187], v7 offset:15360
    ds_read_b64_tr_b16 a[188:189], v7 offset:14400
    ds_read_b64_tr_b16 a[190:191], v7 offset:15424
    s_waitcnt lgkmcnt(4)
    s_add_u32 m0, s32, 12288
    s_add_u32 s38, s38, 16384
    buffer_load_dwordx4 v6, s[8:11], s38 offen lds
    s_add_u32 m0, s32, 13312
    s_add_u32 s38, s38, 16384
    buffer_load_dwordx4 v6, s[8:11], s38 offen lds
    s_waitcnt vmcnt(28)
    ds_read_b64_tr_b16 a[192:193], v7 offset:16384
    ds_read_b64_tr_b16 a[194:195], v7 offset:17408
    ds_read_b64_tr_b16 a[196:197], v7 offset:16448
    ds_read_b64_tr_b16 a[198:199], v7 offset:17472
    s_waitcnt lgkmcnt(4)
    s_add_u32 m0, s32, 14336
    s_add_u32 s38, s38, 16384
    buffer_load_dwordx4 v6, s[8:11], s38 offen lds
    s_add_u32 m0, s32, 15360
    s_add_u32 s38, s38, 16384
    buffer_load_dwordx4 v6, s[8:11], s38 offen lds
    s_waitcnt vmcnt(28)
    ds_read_b64_tr_b16 a[200:201], v7 offset:18432
    ds_read_b64_tr_b16 a[202:203], v7 offset:19456
    ds_read_b64_tr_b16 a[204:205], v7 offset:18496
    ds_read_b64_tr_b16 a[206:207], v7 offset:19520
    s_waitcnt lgkmcnt(4)
    s_add_u32 m0, s32, 16384
    s_add_u32 s38, s38, 16384
    buffer_load_dwordx4 v6, s[8:11], s38 offen lds
    s_add_u32 m0, s32, 17408
    s_add_u32 s38, s38, 16384
    buffer_load_dwordx4 v6, s[8:11], s38 offen lds
    s_waitcnt vmcnt(28)
    ds_read_b64_tr_b16 a[208:209], v7 offset:20480
    ds_read_b64_tr_b16 a[210:211], v7 offset:21504
    ds_read_b64_tr_b16 a[212:213], v7 offset:20544
    ds_read_b64_tr_b16 a[214:215], v7 offset:21568
    s_waitcnt lgkmcnt(4)
    s_add_u32 m0, s32, 18432
    s_add_u32 s38, s38, 16384
    buffer_load_dwordx4 v6, s[8:11], s38 offen lds
    s_add_u32 m0, s32, 19456
    s_add_u32 s38, s38, 16384
    buffer_load_dwordx4 v6, s[8:11], s38 offen lds
    s_waitcnt vmcnt(28)
    ds_read_b64_tr_b16 a[216:217], v7 offset:22528
    ds_read_b64_tr_b16 a[218:219], v7 offset:23552
    ds_read_b64_tr_b16 a[220:221], v7 offset:22592
    ds_read_b64_tr_b16 a[222:223], v7 offset:23616
    s_waitcnt lgkmcnt(4)
    s_add_u32 m0, s32, 20480
    s_add_u32 s38, s38, 16384
    buffer_load_dwordx4 v6, s[8:11], s38 offen lds
    s_add_u32 m0, s32, 21504
    s_add_u32 s38, s38, 16384
    buffer_load_dwordx4 v6, s[8:11], s38 offen lds
    s_waitcnt vmcnt(28)
    ds_read_b64_tr_b16 a[224:225], v7 offset:24576
    ds_read_b64_tr_b16 a[226:227], v7 offset:25600
    ds_read_b64_tr_b16 a[228:229], v7 offset:24640
    ds_read_b64_tr_b16 a[230:231], v7 offset:25664
    s_waitcnt lgkmcnt(4)
    s_add_u32 m0, s32, 22528
    s_add_u32 s38, s38, 16384
    buffer_load_dwordx4 v6, s[8:11], s38 offen lds
    s_add_u32 m0, s32, 23552
    s_add_u32 s38, s38, 16384
    buffer_load_dwordx4 v6, s[8:11], s38 offen lds
    s_waitcnt vmcnt(28)
    ds_read_b64_tr_b16 a[232:233], v7 offset:26624
    ds_read_b64_tr_b16 a[234:235], v7 offset:27648
    ds_read_b64_tr_b16 a[236:237], v7 offset:26688
    ds_read_b64_tr_b16 a[238:239], v7 offset:27712
    s_waitcnt lgkmcnt(4)
    s_add_u32 m0, s32, 24576
    s_add_u32 s38, s38, 16384
    buffer_load_dwordx4 v6, s[8:11], s38 offen lds
    s_add_u32 m0, s32, 25600
    s_add_u32 s38, s38, 16384
    buffer_load_dwordx4 v6, s[8:11], s38 offen lds
    s_waitcnt vmcnt(28)
    ds_read_b64_tr_b16 a[240:241], v7 offset:28672
    ds_read_b64_tr_b16 a[242:243], v7 offset:29696
    ds_read_b64_tr_b16 a[244:245], v7 offset:28736
    ds_read_b64_tr_b16 a[246:247], v7 offset:29760
    s_waitcnt lgkmcnt(4)
    s_add_u32 m0, s32, 26624
    s_add_u32 s38, s38, 16384
    buffer_load_dwordx4 v6, s[8:11], s38 offen lds
    s_add_u32 m0, s32, 27648
    s_add_u32 s38, s38, 16384
    buffer_load_dwordx4 v6, s[8:11], s38 offen lds
    s_waitcnt vmcnt(28)
    ds_read_b64_tr_b16 a[248:249], v7 offset:30720
    ds_read_b64_tr_b16 a[250:251], v7 offset:31744
    ds_read_b64_tr_b16 a[252:253], v7 offset:30784
    ds_read_b64_tr_b16 a[254:255], v7 offset:31808
    s_waitcnt lgkmcnt(4)
    s_add_u32 m0, s32, 28672
    s_add_u32 s38, s38, 16384
    buffer_load_dwordx4 v6, s[8:11], s38 offen lds
    s_add_u32 m0, s32, 29696
    s_add_u32 s38, s38, 16384
    buffer_load_dwordx4 v6, s[8:11], s38 offen lds
    s_waitcnt vmcnt(28)
    ds_read_b64_tr_b16 v[128:129], v7 offset:0
    ds_read_b64_tr_b16 v[130:131], v7 offset:1024
    ds_read_b64_tr_b16 v[132:133], v7 offset:64
    ds_read_b64_tr_b16 v[134:135], v7 offset:1088
    s_waitcnt lgkmcnt(4)
    s_add_u32 m0, s32, 30720
    s_add_u32 s38, s38, 16384
    buffer_load_dwordx4 v6, s[8:11], s38 offen lds
    s_add_u32 m0, s32, 31744
    s_add_u32 s38, s38, 16384
    buffer_load_dwordx4 v6, s[8:11], s38 offen lds
    s_waitcnt vmcnt(28)
    ds_read_b64_tr_b16 v[136:137], v7 offset:2048
    ds_read_b64_tr_b16 v[138:139], v7 offset:3072
    ds_read_b64_tr_b16 v[140:141], v7 offset:2112
    ds_read_b64_tr_b16 v[142:143], v7 offset:3136
    s_waitcnt lgkmcnt(4)
    s_add_u32 m0, s32, 0
    s_add_u32 s38, s38, 16384
    buffer_load_dwordx4 v6, s[8:11], s38 offen lds
    s_add_u32 m0, s32, 1024
    s_add_u32 s38, s38, 16384
    buffer_load_dwordx4 v6, s[8:11], s38 offen lds
    s_waitcnt vmcnt(28)
    ds_read_b64_tr_b16 v[144:145], v7 offset:4096
    ds_read_b64_tr_b16 v[146:147], v7 offset:5120
    ds_read_b64_tr_b16 v[148:149], v7 offset:4160
    ds_read_b64_tr_b16 v[150:151], v7 offset:5184
    s_waitcnt lgkmcnt(4)
    s_add_u32 m0, s32, 2048
    s_add_u32 s38, s38, 16384
    buffer_load_dwordx4 v6, s[8:11], s38 offen lds
    s_add_u32 m0, s32, 3072
    s_add_u32 s38, s38, 16384
    buffer_load_dwordx4 v6, s[8:11], s38 offen lds
    s_waitcnt vmcnt(28)
    ds_read_b64_tr_b16 v[152:153], v7 offset:6144
    ds_read_b64_tr_b16 v[154:155], v7 offset:7168
    ds_read_b64_tr_b16 v[156:157], v7 offset:6208
    ds_read_b64_tr_b16 v[158:159], v7 offset:7232
    s_waitcnt lgkmcnt(4)
    s_add_u32 m0, s32, 4096
    s_add_u32 s38, s38, 16384
    buffer_load_dwordx4 v6, s[8:11], s38 offen lds
    s_add_u32 m0, s32, 5120
    s_add_u32 s38, s38, 16384
    buffer_load_dwordx4 v6, s[8:11], s38 offen lds
    s_waitcnt vmcnt(28)
    ds_read_b64_tr_b16 v[160:161], v7 offset:8192
    ds_read_b64_tr_b16 v[162:163], v7 offset:9216
    ds_read_b64_tr_b16 v[164:165], v7 offset:8256
    ds_read_b64_tr_b16 v[166:167], v7 offset:9280
    s_waitcnt lgkmcnt(4)
    s_add_u32 m0, s32, 6144
    s_add_u32 s38, s38, 16384
    buffer_load_dwordx4 v6, s[8:11], s38 offen lds
    s_add_u32 m0, s32, 7168
    s_add_u32 s38, s38, 16384
    buffer_load_dwordx4 v6, s[8:11], s38 offen lds
    s_waitcnt vmcnt(28)
    ds_read_b64_tr_b16 v[168:169], v7 offset:10240
    ds_read_b64_tr_b16 v[170:171], v7 offset:11264
    ds_read_b64_tr_b16 v[172:173], v7 offset:10304
    ds_read_b64_tr_b16 v[174:175], v7 offset:11328
    s_waitcnt lgkmcnt(4)
    s_add_u32 m0, s32, 8192
    s_add_u32 s38, s38, 16384
    buffer_load_dwordx4 v6, s[8:11], s38 offen lds
    s_add_u32 m0, s32, 9216
    s_add_u32 s38, s38, 16384
    buffer_load_dwordx4 v6, s[8:11], s38 offen lds
    s_waitcnt vmcnt(28)
    ds_read_b64_tr_b16 v[176:177], v7 offset:12288
    ds_read_b64_tr_b16 v[178:179], v7 offset:13312
    ds_read_b64_tr_b16 v[180:181], v7 offset:12352
    ds_read_b64_tr_b16 v[182:183], v7 offset:13376
    s_waitcnt lgkmcnt(4)
    s_add_u32 m0, s32, 10240
    s_add_u32 s38, s38, 16384
    buffer_load_dwordx4 v6, s[8:11], s38 offen lds
    s_add_u32 m0, s32, 11264
    s_add_u32 s38, s38, 16384
    buffer_load_dwordx4 v6, s[8:11], s38 offen lds
    s_waitcnt vmcnt(28)
    ds_read_b64_tr_b16 v[184:185], v7 offset:14336
    ds_read_b64_tr_b16 v[186:187], v7 offset:15360
    ds_read_b64_tr_b16 v[188:189], v7 offset:14400
    ds_read_b64_tr_b16 v[190:191], v7 offset:15424
    s_waitcnt lgkmcnt(4)
    s_add_u32 m0, s32, 12288
    s_add_u32 s38, s38, 16384
    buffer_load_dwordx4 v6, s[8:11], s38 offen lds
    s_add_u32 m0, s32, 13312
    s_add_u32 s38, s38, 16384
    buffer_load_dwordx4 v6, s[8:11], s38 offen lds
    s_waitcnt vmcnt(28)
    ds_read_b64_tr_b16 v[192:193], v7 offset:16384
    ds_read_b64_tr_b16 v[194:195], v7 offset:17408
    ds_read_b64_tr_b16 v[196:197], v7 offset:16448
    ds_read_b64_tr_b16 v[198:199], v7 offset:17472
    s_waitcnt lgkmcnt(4)
    s_add_u32 m0, s32, 14336
    s_add_u32 s38, s38, 16384
    buffer_load_dwordx4 v6, s[8:11], s38 offen lds
    s_add_u32 m0, s32, 15360
    s_add_u32 s38, s38, 16384
    buffer_load_dwordx4 v6, s[8:11], s38 offen lds
    s_waitcnt vmcnt(28)
    ds_read_b64_tr_b16 v[200:201], v7 offset:18432
    ds_read_b64_tr_b16 v[202:203], v7 offset:19456
    ds_read_b64_tr_b16 v[204:205], v7 offset:18496
    ds_read_b64_tr_b16 v[206:207], v7 offset:19520
    s_waitcnt lgkmcnt(4)
    s_add_u32 m0, s32, 16384
    s_add_u32 s38, s38, 16384
    buffer_load_dwordx4 v6, s[8:11], s38 offen lds
    s_add_u32 m0, s32, 17408
    s_add_u32 s38, s38, 16384
    buffer_load_dwordx4 v6, s[8:11], s38 offen lds
    s_waitcnt vmcnt(28)
    ds_read_b64_tr_b16 v[208:209], v7 offset:20480
    ds_read_b64_tr_b16 v[210:211], v7 offset:21504
    ds_read_b64_tr_b16 v[212:213], v7 offset:20544
    ds_read_b64_tr_b16 v[214:215], v7 offset:21568
    s_waitcnt lgkmcnt(4)
    s_add_u32 m0, s32, 18432
    s_add_u32 s38, s38, 16384
    buffer_load_dwordx4 v6, s[8:11], s38 offen lds
    s_add_u32 m0, s32, 19456
    s_add_u32 s38, s38, 16384
    buffer_load_dwordx4 v6, s[8:11], s38 offen lds
    s_waitcnt vmcnt(28)
    ds_read_b64_tr_b16 v[216:217], v7 offset:22528
    ds_read_b64_tr_b16 v[218:219], v7 offset:23552
    ds_read_b64_tr_b16 v[220:221], v7 offset:22592
    ds_read_b64_tr_b16 v[222:223], v7 offset:23616
    s_waitcnt lgkmcnt(4)
    s_add_u32 m0, s32, 20480
    s_add_u32 s38, s38, 16384
    buffer_load_dwordx4 v6, s[8:11], s38 offen lds
    s_add_u32 m0, s32, 21504
    s_add_u32 s38, s38, 16384
    buffer_load_dwordx4 v6, s[8:11], s38 offen lds
    s_waitcnt vmcnt(28)
    ds_read_b64_tr_b16 v[224:225], v7 offset:24576
    ds_read_b64_tr_b16 v[226:227], v7 offset:25600
    ds_read_b64_tr_b16 v[228:229], v7 offset:24640
    ds_read_b64_tr_b16 v[230:231], v7 offset:25664
    s_waitcnt lgkmcnt(4)
    s_add_u32 m0, s32, 22528
    s_add_u32 s38, s38, 16384
    buffer_load_dwordx4 v6, s[8:11], s38 offen lds
    s_add_u32 m0, s32, 23552
    s_add_u32 s38, s38, 16384
    buffer_load_dwordx4 v6, s[8:11], s38 offen lds
    s_waitcnt vmcnt(28)
    ds_read_b64_tr_b16 v[232:233], v7 offset:26624
    ds_read_b64_tr_b16 v[234:235], v7 offset:27648
    ds_read_b64_tr_b16 v[236:237], v7 offset:26688
    ds_read_b64_tr_b16 v[238:239], v7 offset:27712
    s_waitcnt lgkmcnt(4)
    s_add_u32 m0, s32, 24576
    s_add_u32 s38, s38, 16384
    buffer_load_dwordx4 v6, s[8:11], s38 offen lds
    s_add_u32 m0, s32, 25600
    s_add_u32 s38, s38, 16384
    buffer_load_dwordx4 v6, s[8:11], s38 offen lds
    s_waitcnt vmcnt(28)
    ds_read_b64_tr_b16 v[240:241], v7 offset:28672
    ds_read_b64_tr_b16 v[242:243], v7 offset:29696
    ds_read_b64_tr_b16 v[244:245], v7 offset:28736
    ds_read_b64_tr_b16 v[246:247], v7 offset:29760
    s_waitcnt lgkmcnt(4)
    s_add_u32 m0, s32, 26624
    s_add_u32 s38, s38, 16384
    buffer_load_dwordx4 v6, s[8:11], s38 offen lds
    s_add_u32 m0, s32, 27648
    s_add_u32 s38, s38, 16384
    buffer_load_dwordx4 v6, s[8:11], s38 offen lds
    s_waitcnt vmcnt(28)
    ds_read_b64_tr_b16 v[248:249], v7 offset:30720
    ds_read_b64_tr_b16 v[250:251], v7 offset:31744
    ds_read_b64_tr_b16 v[252:253], v7 offset:30784
    ds_read_b64_tr_b16 v[254:255], v7 offset:31808
    s_waitcnt lgkmcnt(4)
    s_add_u32 m0, s32, 28672
    s_add_u32 s38, s38, 16384
    buffer_load_dwordx4 v6, s[8:11], s38 offen lds
    s_add_u32 m0, s32, 29696
    s_add_u32 s38, s38, 16384
    buffer_load_dwordx4 v6, s[8:11], s38 offen lds
    s_waitcnt vmcnt(28)
    s_waitcnt lgkmcnt(0)
    s_add_u32 m0, s32, 30720
    s_add_u32 s38, s38, 16384
    buffer_load_dwordx4 v6, s[8:11], s38 offen lds
    s_add_u32 m0, s32, 31744
    s_add_u32 s38, s38, 16384
    buffer_load_dwordx4 v6, s[8:11], s38 offen lds
    s_waitcnt vmcnt(28)
    s_waitcnt vmcnt(26)
    s_waitcnt vmcnt(24)
    s_waitcnt vmcnt(22)
    s_waitcnt vmcnt(20)
    s_waitcnt vmcnt(18)
    s_waitcnt vmcnt(16)
    s_waitcnt vmcnt(14)
    s_waitcnt vmcnt(12)
    s_waitcnt vmcnt(10)
    s_waitcnt vmcnt(8)
    s_waitcnt vmcnt(6)
    s_waitcnt vmcnt(4)
    s_waitcnt vmcnt(2)
    s_waitcnt vmcnt(0)
    s_waitcnt lgkmcnt(0)
    s_lshl_b32 s31, s29, 16
    v_add_u32 v8, s31, v5
    s_lshl_b32 s31, s29, 13
    s_add_u32 s31, s31, 131072
    v_add_u32 v9, s31, v5
    s_lshl_b32 s31, s29, 7
    s_add_u32 s31, s31, 131072
    v_bfe_u32 v10, v1, 1, 2
    v_lshlrev_b32 v10, 10, v10
    v_and_b32 v4, 1, v1
    v_lshl_add_u32 v10, v4, 9, v10
    v_lshrrev_b32 v4, 3, v1
    v_lshl_add_u32 v10, v4, 4, v10
    v_add_u32 v10, s31, v10
    s_lshl_b32 s31, s29, 15
    s_lshl_b32 s33, s44, 7
    s_add_u32 s31, s31, s33
    v_lshrrev_b32 v11, 3, v1
    v_lshlrev_b32 v11, 12, v11
    v_and_b32 v4, 7, v1
    v_lshl_add_u32 v11, v4, 3, v11
    v_add_u32 v11, s31, v11
    v_and_b32 v12, 31, v1
    v_lshlrev_b32 v12, 7, v12
    v_add_u32 v12, 115343360, v12
    s_cmp_lg_u32 s29, 0
    s_cbranch_scc1 g_wdd_84
g_wd_83:
    s_load_dword s72, s[92:93], 0 glc
    s_add_u32 s41, s41, 1
    s_cmp_ge_u32 s41, 0x200000
    s_cbranch_scc1 g_wdd_84
    s_waitcnt lgkmcnt(0)
    s_and_b32 s72, s72, 0xffff
    s_cmp_ge_u32 s72, 256
    s_cbranch_scc1 g_wdd_84
    s_sleep 32
    s_branch g_wd_83
g_wdd_84:
    s_waitcnt lgkmcnt(0)
    s_barrier
o6_loop_85:
    s_lshl_b32 s47, s30, 18
    s_add_u32 s47, s47, 67108864
    s_and_b32 s52, s30, 63
    s_lshl_b32 s52, s52, 12
    s_add_u32 s52, s52, 32768
o6_w_87:
    buffer_load_dword v13, v12, s[4:7], s52 offen sc1
    s_add_u32 s41, s41, 1
    s_cmp_ge_u32 s41, 0x200000
    s_cbranch_scc1 o6_wd_88
    s_waitcnt vmcnt(0)
    v_cmp_eq_u32 vcc, 0, v13
    s_cbranch_vccz o6_wd_88
    s_sleep 10
    s_branch o6_w_87
o6_wd_88:
    s_add_u32 s31, s47, 0
    buffer_load_dwordx4 v[64:67], v8, s[4:7], s31 offen sc1
    s_add_u32 s31, s47, 1024
    buffer_load_dwordx4 v[68:71], v8, s[4:7], s31 offen sc1
    s_add_u32 s31, s47, 2048
    buffer_load_dwordx4 v[72:75], v8, s[4:7], s31 offen sc1
    s_add_u32 s31, s47, 49152
    buffer_load_dwordx4 v[76:79], v8, s[4:7], s31 offen sc1
    s_add_u32 s31, s47, 3072
    buffer_load_dwordx4 v[80:83], v8, s[4:7], s31 offen sc1
    s_add_u32 s31, s47, 4096
    buffer_load_dwordx4 v[84:87], v8, s[4:7], s31 offen sc1
    s_add_u32 s31, s47, 5120
    buffer_load_dwordx4 v[88:91], v8, s[4:7], s31 offen sc1
    s_add_u32 s31, s47, 50176
    buffer_load_dwordx4 v[92:95], v8, s[4:7], s31 offen sc1
    s_add_u32 s31, s47, 6144
    buffer_load_dwordx4 v[96:99], v8, s[4:7], s31 offen sc1
    s_add_u32 s31, s47, 7168
    buffer_load_dwordx4 v[100:103], v8, s[4:7], s31 offen sc1
    s_add_u32 s31, s47, 8192
    buffer_load_dwordx4 v[104:107], v8, s[4:7], s31 offen sc1
    s_add_u32 s31, s47, 51200
    buffer_load_dwordx4 v[108:111], v8, s[4:7], s31 offen sc1
    s_add_u32 s31, s47, 9216
    buffer_load_dwordx4 v[112:115], v8, s[4:7], s31 offen sc1
    s_add_u32 s31, s47, 10240
    buffer_load_dwordx4 v[116:119], v8, s[4:7], s31 offen sc1
    s_add_u32 s31, s47, 11264
    buffer_load_dwordx4 v[120:123], v8, s[4:7], s31 offen sc1
o6_go_86:
    s_lshl_b32 s49, s30, 17
    s_add_u32 s35, s30, 5
    s_and_b32 s52, s35, 63
    s_lshl_b32 s52, s52, 12
    s_add_u32 s52, s52, 32768
    ds_read_b64_tr_b16 v[16:17], v7 offset:0
    ds_read_b64_tr_b16 v[18:19], v7 offset:1024
    ds_read_b64_tr_b16 v[20:21], v7 offset:64
    ds_read_b64_tr_b16 v[22:23], v7 offset:1088
    s_waitcnt vmcnt(14)
    v_mfma_f32_32x32x16_bf16 v[32:47], a[0:3], v[64:67], 0
    s_add_u32 s31, s47, 52224
    buffer_load_dwordx4 v[124:127], v8, s[4:7], s31 offen sc1
    v_mfma_f32_32x32x16_bf16 v[48:63], a[4:7], v[64:67], 0
    s_waitcnt vmcnt(14)
    v_mfma_f32_32x32x16_bf16 v[32:47], a[8:11], v[68:71], v[32:47]
    s_add_u32 s31, s47, 12288
    buffer_load_dwordx4 v[64:67], v8, s[4:7], s31 offen sc1
    v_mfma_f32_32x32x16_bf16 v[48:63], a[12:15], v[68:71], v[48:63]
    s_waitcnt vmcnt(14)
    v_mfma_f32_32x32x16_bf16 v[32:47], a[16:19], v[72:75], v[32:47]
    s_add_u32 s31, s47, 13312
    buffer_load_dwordx4 v[68:71], v8, s[4:7], s31 offen sc1
    v_mfma_f32_32x32x16_bf16 v[48:63], a[20:23], v[72:75], v[48:63]
    s_waitcnt vmcnt(14)
    s_waitcnt lgkmcnt(0)
    v_mfma_f32_32x32x16_bf16 v[32:47], v[16:19], v[76:79], v[32:47]
    s_add_u32 s31, s47, 14336
    buffer_load_dwordx4 v[72:75], v8, s[4:7], s31 offen sc1
    v_mfma_f32_32x32x16_bf16 v[48:63], v[20:23], v[76:79], v[48:63]
    ds_read_b64_tr_b16 v[24:25], v7 offset:2048
    ds_read_b64_tr_b16 v[26:27], v7 offset:3072
    ds_read_b64_tr_b16 v[28:29], v7 offset:2112
    ds_read_b64_tr_b16 v[30:31], v7 offset:3136
    s_waitcnt vmcnt(14)
    v_mfma_f32_32x32x16_bf16 v[32:47], a[24:27], v[80:83], v[32:47]
    s_add_u32 s31, s47, 53248
    buffer_load_dwordx4 v[76:79], v8, s[4:7], s31 offen sc1
    v_mfma_f32_32x32x16_bf16 v[48:63], a[28:31], v[80:83], v[48:63]
    s_waitcnt vmcnt(14)
    v_mfma_f32_32x32x16_bf16 v[32:47], a[32:35], v[84:87], v[32:47]
    s_add_u32 s31, s47, 15360
    buffer_load_dwordx4 v[80:83], v8, s[4:7], s31 offen sc1
    v_mfma_f32_32x32x16_bf16 v[48:63], a[36:39], v[84:87], v[48:63]
    s_waitcnt vmcnt(14)
    v_mfma_f32_32x32x16_bf16 v[32:47], a[40:43], v[88:91], v[32:47]
    s_add_u32 s31, s47, 16384
    buffer_load_dwordx4 v[84:87], v8, s[4:7], s31 offen sc1
    v_mfma_f32_32x32x16_bf16 v[48:63], a[44:47], v[88:91], v[48:63]
    s_waitcnt vmcnt(14)
    s_waitcnt lgkmcnt(0)
    v_mfma_f32_32x32x16_bf16 v[32:47], v[24:27], v[92:95], v[32:47]
    s_add_u32 s31, s47, 17408
    buffer_load_dwordx4 v[88:91], v8, s[4:7], s31 offen sc1
    v_mfma_f32_32x32x16_bf16 v[48:63], v[28:31], v[92:95], v[48:63]
    ds_read_b64_tr_b16 v[16:17], v7 offset:4096
    ds_read_b64_tr_b16 v[18:19], v7 offset:5120
    ds_read_b64_tr_b16 v[20:21], v7 offset:4160
    ds_read_b64_tr_b16 v[22:23], v7 offset:5184
    s_waitcnt vmcnt(14)
    v_mfma_f32_32x32x16_bf16 v[32:47], a[48:51], v[96:99], v[32:47]
    s_add_u32 s31, s47, 54272
    buffer_load_dwordx4 v[92:95], v8, s[4:7], s31 offen sc1
    v_mfma_f32_32x32x16_bf16 v[48:63], a[52:55], v[96:99], v[48:63]
    s_waitcnt vmcnt(14)
    v_mfma_f32_32x32x16_bf16 v[32:47], a[56:59], v[100:103], v[32:47]
    s_add_u32 s31, s47, 18432
    buffer_load_dwordx4 v[96:99], v8, s[4:7], s31 offen sc1
    v_mfma_f32_32x32x16_bf16 v[48:63], a[60:63], v[100:103], v[48:63]
    s_waitcnt vmcnt(14)
    v_mfma_f32_32x32x16_bf16 v[32:47], a[64:67], v[104:107], v[32:47]
    s_add_u32 s31, s47, 19456
    buffer_load_dwordx4 v[100:103], v8, s[4:7], s31 offen sc1
    v_mfma_f32_32x32x16_bf16 v[48:63], a[68:71], v[104:107], v[48:63]
    s_waitcnt vmcnt(14)
    s_waitcnt lgkmcnt(0)
    v_mfma_f32_32x32x16_bf16 v[32:47], v[16:19], v[108:111], v[32:47]
    s_add_u32 s31, s47, 20480
    buffer_load_dwordx4 v[104:107], v8, s[4:7], s31 offen sc1
    v_mfma_f32_32x32x16_bf16 v[48:63], v[20:23], v[108:111], v[48:63]
    ds_read_b64_tr_b16 v[24:25], v7 offset:6144
    ds_read_b64_tr_b16 v[26:27], v7 offset:7168
    ds_read_b64_tr_b16 v[28:29], v7 offset:6208
    ds_read_b64_tr_b16 v[30:31], v7 offset:7232
    s_waitcnt vmcnt(14)
    v_mfma_f32_32x32x16_bf16 v[32:47], a[72:75], v[112:115], v[32:47]
    s_add_u32 s31, s47, 55296
    buffer_load_dwordx4 v[108:111], v8, s[4:7], s31 offen sc1
    v_mfma_f32_32x32x16_bf16 v[48:63], a[76:79], v[112:115], v[48:63]
    s_waitcnt vmcnt(14)
    v_mfma_f32_32x32x16_bf16 v[32:47], a[80:83], v[116:119], v[32:47]
    s_add_u32 s31, s47, 21504
    buffer_load_dwordx4 v[112:115], v8, s[4:7], s31 offen sc1
    v_mfma_f32_32x32x16_bf16 v[48:63], a[84:87], v[116:119], v[48:63]
    s_waitcnt vmcnt(14)
    v_mfma_f32_32x32x16_bf16 v[32:47], a[88:91], v[120:123], v[32:47]
    s_add_u32 s31, s47, 22528
    buffer_load_dwordx4 v[116:119], v8, s[4:7], s31 offen sc1
    v_mfma_f32_32x32x16_bf16 v[48:63], a[92:95], v[120:123], v[48:63]
    s_waitcnt vmcnt(14)
    s_waitcnt lgkmcnt(0)
    v_mfma_f32_32x32x16_bf16 v[32:47], v[24:27], v[124:127], v[32:47]
    s_add_u32 s31, s47, 23552
    buffer_load_dwordx4 v[120:123], v8, s[4:7], s31 offen sc1
    v_mfma_f32_32x32x16_bf16 v[48:63], v[28:31], v[124:127], v[48:63]
    ds_read_b64_tr_b16 v[16:17], v7 offset:8192
    ds_read_b64_tr_b16 v[18:19], v7 offset:9216
    ds_read_b64_tr_b16 v[20:21], v7 offset:8256
    ds_read_b64_tr_b16 v[22:23], v7 offset:9280
    s_waitcnt vmcnt(14)
    v_mfma_f32_32x32x16_bf16 v[32:47], a[96:99], v[64:67], v[32:47]
    s_add_u32 s31, s47, 56320
    buffer_load_dwordx4 v[124:127], v8, s[4:7], s31 offen sc1
    v_mfma_f32_32x32x16_bf16 v[48:63], a[100:103], v[64:67], v[48:63]
    s_waitcnt vmcnt(14)
    v_mfma_f32_32x32x16_bf16 v[32:47], a[104:107], v[68:71], v[32:47]
    s_add_u32 s31, s47, 24576
    buffer_load_dwordx4 v[64:67], v8, s[4:7], s31 offen sc1
    v_mfma_f32_32x32x16_bf16 v[48:63], a[108:111], v[68:71], v[48:63]
    s_waitcnt vmcnt(14)
    v_mfma_f32_32x32x16_bf16 v[32:47], a[112:115], v[72:75], v[32:47]
    s_add_u32 s31, s47, 25600
    buffer_load_dwordx4 v[68:71], v8, s[4:7], s31 offen sc1
    v_mfma_f32_32x32x16_bf16 v[48:63], a[116:119], v[72:75], v[48:63]
    s_waitcnt vmcnt(14)
    s_waitcnt lgkmcnt(0)
    v_mfma_f32_32x32x16_bf16 v[32:47], v[16:19], v[76:79], v[32:47]
    s_add_u32 s31, s47, 26624
    buffer_load_dwordx4 v[72:75], v8, s[4:7], s31 offen sc1
    v_mfma_f32_32x32x16_bf16 v[48:63], v[20:23], v[76:79], v[48:63]
    ds_read_b64_tr_b16 v[24:25], v7 offset:10240
    ds_read_b64_tr_b16 v[26:27], v7 offset:11264
    ds_read_b64_tr_b16 v[28:29], v7 offset:10304
    ds_read_b64_tr_b16 v[30:31], v7 offset:11328
    s_waitcnt vmcnt(14)
    v_mfma_f32_32x32x16_bf16 v[32:47], a[120:123], v[80:83], v[32:47]
    s_add_u32 s31, s47, 57344
    buffer_load_dwordx4 v[76:79], v8, s[4:7], s31 offen sc1
    v_mfma_f32_32x32x16_bf16 v[48:63], a[124:127], v[80:83], v[48:63]
    s_waitcnt vmcnt(14)
    v_mfma_f32_32x32x16_bf16 v[32:47], a[128:131], v[84:87], v[32:47]
    s_add_u32 s31, s47, 27648
    buffer_load_dwordx4 v[80:83], v8, s[4:7], s31 offen sc1
    v_mfma_f32_32x32x16_bf16 v[48:63], a[132:135], v[84:87], v[48:63]
    s_waitcnt vmcnt(14)
    v_mfma_f32_32x32x16_bf16 v[32:47], a[136:139], v[88:91], v[32:47]
    s_add_u32 s31, s47, 28672
    buffer_load_dwordx4 v[84:87], v8, s[4:7], s31 offen sc1
    v_mfma_f32_32x32x16_bf16 v[48:63], a[140:143], v[88:91], v[48:63]
    s_waitcnt vmcnt(14)
    s_waitcnt lgkmcnt(0)
    v_mfma_f32_32x32x16_bf16 v[32:47], v[24:27], v[92:95], v[32:47]
    s_add_u32 s31, s47, 29696
    buffer_load_dwordx4 v[88:91], v8, s[4:7], s31 offen sc1
    v_mfma_f32_32x32x16_bf16 v[48:63], v[28:31], v[92:95], v[48:63]
    ds_read_b64_tr_b16 v[16:17], v7 offset:12288
    ds_read_b64_tr_b16 v[18:19], v7 offset:13312
    ds_read_b64_tr_b16 v[20:21], v7 offset:12352
    ds_read_b64_tr_b16 v[22:23], v7 offset:13376
    s_waitcnt vmcnt(14)
    v_mfma_f32_32x32x16_bf16 v[32:47], a[144:147], v[96:99], v[32:47]
    s_add_u32 s31, s47, 58368
    buffer_load_dwordx4 v[92:95], v8, s[4:7], s31 offen sc1
    buffer_load_dword v13, v12, s[4:7], s52 offen sc1
    v_mfma_f32_32x32x16_bf16 v[48:63], a[148:151], v[96:99], v[48:63]
    s_waitcnt vmcnt(15)
    v_mfma_f32_32x32x16_bf16 v[32:47], a[152:155], v[100:103], v[32:47]
    s_add_u32 s31, s47, 30720
    buffer_load_dwordx4 v[96:99], v8, s[4:7], s31 offen sc1
    v_mfma_f32_32x32x16_bf16 v[48:63], a[156:159], v[100:103], v[48:63]
    s_waitcnt vmcnt(15)
    v_mfma_f32_32x32x16_bf16 v[32:47], a[160:163], v[104:107], v[32:47]
    s_add_u32 s31, s47, 31744
    buffer_load_dwordx4 v[100:103], v8, s[4:7], s31 offen sc1
    v_mfma_f32_32x32x16_bf16 v[48:63], a[164:167], v[104:107], v[48:63]
    s_waitcnt vmcnt(15)
    s_waitcnt lgkmcnt(0)
    v_mfma_f32_32x32x16_bf16 v[32:47], v[16:19], v[108:111], v[32:47]
    s_add_u32 s31, s47, 32768
    buffer_load_dwordx4 v[104:107], v8, s[4:7], s31 offen sc1
    v_mfma_f32_32x32x16_bf16 v[48:63], v[20:23], v[108:111], v[48:63]
    ds_read_b64_tr_b16 v[24:25], v7 offset:14336
    ds_read_b64_tr_b16 v[26:27], v7 offset:15360
    ds_read_b64_tr_b16 v[28:29], v7 offset:14400
    ds_read_b64_tr_b16 v[30:31], v7 offset:15424
    s_waitcnt vmcnt(15)
    v_mfma_f32_32x32x16_bf16 v[32:47], a[168:171], v[112:115], v[32:47]
    s_add_u32 s31, s47, 59392
    buffer_load_dwordx4 v[108:111], v8, s[4:7], s31 offen sc1
    v_mfma_f32_32x32x16_bf16 v[48:63], a[172:175], v[112:115], v[48:63]
    s_waitcnt vmcnt(15)
    v_mfma_f32_32x32x16_bf16 v[32:47], a[176:179], v[116:119], v[32:47]
    s_add_u32 s31, s47, 33792
    buffer_load_dwordx4 v[112:115], v8, s[4:7], s31 offen sc1
    v_mfma_f32_32x32x16_bf16 v[48:63], a[180:183], v[116:119], v[48:63]
    s_waitcnt vmcnt(15)
    v_mfma_f32_32x32x16_bf16 v[32:47], a[184:187], v[120:123], v[32:47]
    s_add_u32 s31, s47, 34816
    buffer_load_dwordx4 v[116:119], v8, s[4:7], s31 offen sc1
    v_mfma_f32_32x32x16_bf16 v[48:63], a[188:191], v[120:123], v[48:63]
    s_waitcnt vmcnt(15)
    s_waitcnt lgkmcnt(0)
    v_mfma_f32_32x32x16_bf16 v[32:47], v[24:27], v[124:127], v[32:47]
    s_add_u32 s31, s47, 35840
    buffer_load_dwordx4 v[120:123], v8, s[4:7], s31 offen sc1
    v_mfma_f32_32x32x16_bf16 v[48:63], v[28:31], v[124:127], v[48:63]
    ds_read_b64_tr_b16 v[16:17], v7 offset:16384
    ds_read_b64_tr_b16 v[18:19], v7 offset:17408
    ds_read_b64_tr_b16 v[20:21], v7 offset:16448
    ds_read_b64_tr_b16 v[22:23], v7 offset:17472
    s_waitcnt vmcnt(15)
    v_mfma_f32_32x32x16_bf16 v[32:47], a[192:195], v[64:67], v[32:47]
    s_add_u32 s31, s47, 60416
    buffer_load_dwordx4 v[124:127], v8, s[4:7], s31 offen sc1
    v_mfma_f32_32x32x16_bf16 v[48:63], a[196:199], v[64:67], v[48:63]
    s_waitcnt vmcnt(15)
    v_mfma_f32_32x32x16_bf16 v[32:47], a[200:203], v[68:71], v[32:47]
    s_add_u32 s31, s47, 36864
    buffer_load_dwordx4 v[64:67], v8, s[4:7], s31 offen sc1
    v_mfma_f32_32x32x16_bf16 v[48:63], a[204:207], v[68:71], v[48:63]
    s_waitcnt vmcnt(15)
    v_mfma_f32_32x32x16_bf16 v[32:47], a[208:211], v[72:75], v[32:47]
    s_add_u32 s31, s47, 37888
    buffer_load_dwordx4 v[68:71], v8, s[4:7], s31 offen sc1
    v_mfma_f32_32x32x16_bf16 v[48:63], a[212:215], v[72:75], v[48:63]
    s_waitcnt vmcnt(15)
    s_waitcnt lgkmcnt(0)
    v_mfma_f32_32x32x16_bf16 v[32:47], v[16:19], v[76:79], v[32:47]
    s_add_u32 s31, s47, 38912
    buffer_load_dwordx4 v[72:75], v8, s[4:7], s31 offen sc1
    v_mfma_f32_32x32x16_bf16 v[48:63], v[20:23], v[76:79], v[48:63]
    ds_read_b64_tr_b16 v[24:25], v7 offset:18432
    ds_read_b64_tr_b16 v[26:27], v7 offset:19456
    ds_read_b64_tr_b16 v[28:29], v7 offset:18496
    ds_read_b64_tr_b16 v[30:31], v7 offset:19520
    s_waitcnt vmcnt(15)
    v_mfma_f32_32x32x16_bf16 v[32:47], a[216:219], v[80:83], v[32:47]
    s_add_u32 s31, s47, 61440
    buffer_load_dwordx4 v[76:79], v8, s[4:7], s31 offen sc1
    v_mfma_f32_32x32x16_bf16 v[48:63], a[220:223], v[80:83], v[48:63]
    s_waitcnt vmcnt(15)
    v_mfma_f32_32x32x16_bf16 v[32:47], a[224:227], v[84:87], v[32:47]
    s_add_u32 s31, s47, 39936
    buffer_load_dwordx4 v[80:83], v8, s[4:7], s31 offen sc1
    v_mfma_f32_32x32x16_bf16 v[48:63], a[228:231], v[84:87], v[48:63]
    s_waitcnt vmcnt(15)
    v_mfma_f32_32x32x16_bf16 v[32:47], a[232:235], v[88:91], v[32:47]
    s_add_u32 s31, s47, 40960
    buffer_load_dwordx4 v[84:87], v8, s[4:7], s31 offen sc1
    v_mfma_f32_32x32x16_bf16 v[48:63], a[236:239], v[88:91], v[48:63]
    s_waitcnt vmcnt(15)
    s_waitcnt lgkmcnt(0)
    v_mfma_f32_32x32x16_bf16 v[32:47], v[24:27], v[92:95], v[32:47]
    s_add_u32 s31, s47, 41984
    buffer_load_dwordx4 v[88:91], v8, s[4:7], s31 offen sc1
    v_mfma_f32_32x32x16_bf16 v[48:63], v[28:31], v[92:95], v[48:63]
    ds_read_b64_tr_b16 v[16:17], v7 offset:20480
    ds_read_b64_tr_b16 v[18:19], v7 offset:21504
    ds_read_b64_tr_b16 v[20:21], v7 offset:20544
    ds_read_b64_tr_b16 v[22:23], v7 offset:21568
    s_waitcnt vmcnt(14)
    v_mfma_f32_32x32x16_bf16 v[32:47], a[240:243], v[96:99], v[32:47]
    s_add_u32 s31, s47, 62464
    buffer_load_dwordx4 v[92:95], v8, s[4:7], s31 offen sc1
    v_mfma_f32_32x32x16_bf16 v[48:63], a[244:247], v[96:99], v[48:63]
    s_waitcnt vmcnt(14)
    v_mfma_f32_32x32x16_bf16 v[32:47], a[248:251], v[100:103], v[32:47]
    s_add_u32 s31, s47, 43008
    buffer_load_dwordx4 v[96:99], v8, s[4:7], s31 offen sc1
    v_mfma_f32_32x32x16_bf16 v[48:63], a[252:255], v[100:103], v[48:63]
    s_waitcnt vmcnt(14)
    v_mfma_f32_32x32x16_bf16 v[32:47], v[128:131], v[104:107], v[32:47]
    s_add_u32 s31, s47, 44032
    buffer_load_dwordx4 v[100:103], v8, s[4:7], s31 offen sc1
    v_mfma_f32_32x32x16_bf16 v[48:63], v[132:135], v[104:107], v[48:63]
    s_waitcnt vmcnt(14)
    s_waitcnt lgkmcnt(0)
    v_mfma_f32_32x32x16_bf16 v[32:47], v[16:19], v[108:111], v[32:47]
    s_add_u32 s31, s47, 45056
    buffer_load_dwordx4 v[104:107], v8, s[4:7], s31 offen sc1
    v_mfma_f32_32x32x16_bf16 v[48:63], v[20:23], v[108:111], v[48:63]
    ds_read_b64_tr_b16 v[24:25], v7 offset:22528
    ds_read_b64_tr_b16 v[26:27], v7 offset:23552
    ds_read_b64_tr_b16 v[28:29], v7 offset:22592
    ds_read_b64_tr_b16 v[30:31], v7 offset:23616
    s_waitcnt vmcnt(14)
    v_mfma_f32_32x32x16_bf16 v[32:47], v[136:139], v[112:115], v[32:47]
    s_add_u32 s31, s47, 63488
    buffer_load_dwordx4 v[108:111], v8, s[4:7], s31 offen sc1
    v_mfma_f32_32x32x16_bf16 v[48:63], v[140:143], v[112:115], v[48:63]
    s_waitcnt vmcnt(14)
    v_mfma_f32_32x32x16_bf16 v[32:47], v[144:147], v[116:119], v[32:47]
    s_add_u32 s31, s47, 46080
    buffer_load_dwordx4 v[112:115], v8, s[4:7], s31 offen sc1
    v_mfma_f32_32x32x16_bf16 v[48:63], v[148:151], v[116:119], v[48:63]
    s_waitcnt vmcnt(14)
    v_mfma_f32_32x32x16_bf16 v[32:47], v[152:155], v[120:123], v[32:47]
    s_add_u32 s31, s47, 47104
    buffer_load_dwordx4 v[116:119], v8, s[4:7], s31 offen sc1
    v_mfma_f32_32x32x16_bf16 v[48:63], v[156:159], v[120:123], v[48:63]
    s_waitcnt vmcnt(14)
    s_waitcnt lgkmcnt(0)
    v_mfma_f32_32x32x16_bf16 v[32:47], v[24:27], v[124:127], v[32:47]
    s_add_u32 s31, s47, 48128
    buffer_load_dwordx4 v[120:123], v8, s[4:7], s31 offen sc1
    v_mfma_f32_32x32x16_bf16 v[48:63], v[28:31], v[124:127], v[48:63]
    ds_read_b64_tr_b16 v[16:17], v7 offset:24576
    ds_read_b64_tr_b16 v[18:19], v7 offset:25600
    ds_read_b64_tr_b16 v[20:21], v7 offset:24640
    ds_read_b64_tr_b16 v[22:23], v7 offset:25664
    s_waitcnt vmcnt(14)
    v_mfma_f32_32x32x16_bf16 v[32:47], v[160:163], v[64:67], v[32:47]
    s_add_u32 s31, s47, 64512
    buffer_load_dwordx4 v[124:127], v8, s[4:7], s31 offen sc1
    v_mfma_f32_32x32x16_bf16 v[48:63], v[164:167], v[64:67], v[48:63]
    s_waitcnt vmcnt(14)
    v_mfma_f32_32x32x16_bf16 v[32:47], v[168:171], v[68:71], v[32:47]
    v_cmp_eq_u32 vcc, 0, v13
    s_lshl_b32 s46, s35, 18
    s_add_u32 s46, s46, 67108864
    s_cmp_eq_u64 vcc, 0
    s_cselect_b32 s51, 1, 0
    s_cmp_ge_u32 s35, 64
    s_cselect_b32 s51, 0, s51
    s_cmp_eq_u32 s51, 0
    s_cselect_b32 s46, s47, s46
    s_add_u32 s31, s46, 0
    buffer_load_dwordx4 v[64:67], v8, s[4:7], s31 offen sc1
    v_mfma_f32_32x32x16_bf16 v[48:63], v[172:175], v[68:71], v[48:63]
    s_waitcnt vmcnt(14)
    v_mfma_f32_32x32x16_bf16 v[32:47], v[176:179], v[72:75], v[32:47]
    s_add_u32 s31, s46, 1024
    buffer_load_dwordx4 v[68:71], v8, s[4:7], s31 offen sc1
    v_mfma_f32_32x32x16_bf16 v[48:63], v[180:183], v[72:75], v[48:63]
    s_waitcnt vmcnt(14)
    s_waitcnt lgkmcnt(0)
    v_mfma_f32_32x32x16_bf16 v[32:47], v[16:19], v[76:79], v[32:47]
    s_add_u32 s31, s46, 2048
    buffer_load_dwordx4 v[72:75], v8, s[4:7], s31 offen sc1
    v_mfma_f32_32x32x16_bf16 v[48:63], v[20:23], v[76:79], v[48:63]
    ds_read_b64_tr_b16 v[24:25], v7 offset:26624
    ds_read_b64_tr_b16 v[26:27], v7 offset:27648
    ds_read_b64_tr_b16 v[28:29], v7 offset:26688
    ds_read_b64_tr_b16 v[30:31], v7 offset:27712
    s_waitcnt vmcnt(14)
    v_mfma_f32_32x32x16_bf16 v[32:47], v[184:187], v[80:83], v[32:47]
    s_add_u32 s31, s46, 49152
    buffer_load_dwordx4 v[76:79], v8, s[4:7], s31 offen sc1
    v_mfma_f32_32x32x16_bf16 v[48:63], v[188:191], v[80:83], v[48:63]
    s_waitcnt vmcnt(14)
    v_mfma_f32_32x32x16_bf16 v[32:47], v[192:195], v[84:87], v[32:47]
    s_add_u32 s31, s46, 3072
    buffer_load_dwordx4 v[80:83], v8, s[4:7], s31 offen sc1
    v_mfma_f32_32x32x16_bf16 v[48:63], v[196:199], v[84:87], v[48:63]
    s_waitcnt vmcnt(14)
    v_mfma_f32_32x32x16_bf16 v[32:47], v[200:203], v[88:91], v[32:47]
    s_add_u32 s31, s46, 4096
    buffer_load_dwordx4 v[84:87], v8, s[4:7], s31 offen sc1
    v_mfma_f32_32x32x16_bf16 v[48:63], v[204:207], v[88:91], v[48:63]
    s_waitcnt vmcnt(14)
    s_waitcnt lgkmcnt(0)
    v_mfma_f32_32x32x16_bf16 v[32:47], v[24:27], v[92:95], v[32:47]
    s_add_u32 s31, s46, 5120
    buffer_load_dwordx4 v[88:91], v8, s[4:7], s31 offen sc1
    v_mfma_f32_32x32x16_bf16 v[48:63], v[28:31], v[92:95], v[48:63]
    ds_read_b64_tr_b16 v[16:17], v7 offset:28672
    ds_read_b64_tr_b16 v[18:19], v7 offset:29696
    ds_read_b64_tr_b16 v[20:21], v7 offset:28736
    ds_read_b64_tr_b16 v[22:23], v7 offset:29760
    s_waitcnt vmcnt(14)
    v_mfma_f32_32x32x16_bf16 v[32:47], v[208:211], v[96:99], v[32:47]
    s_add_u32 s31, s46, 50176
    buffer_load_dwordx4 v[92:95], v8, s[4:7], s31 offen sc1
    v_mfma_f32_32x32x16_bf16 v[48:63], v[212:215], v[96:99], v[48:63]
    s_waitcnt vmcnt(14)
    v_mfma_f32_32x32x16_bf16 v[32:47], v[216:219], v[100:103], v[32:47]
    s_add_u32 s31, s46, 6144
    buffer_load_dwordx4 v[96:99], v8, s[4:7], s31 offen sc1
    v_mfma_f32_32x32x16_bf16 v[48:63], v[220:223], v[100:103], v[48:63]
    s_waitcnt vmcnt(14)
    v_mfma_f32_32x32x16_bf16 v[32:47], v[224:227], v[104:107], v[32:47]
    s_add_u32 s31, s46, 7168
    buffer_load_dwordx4 v[100:103], v8, s[4:7], s31 offen sc1
    v_mfma_f32_32x32x16_bf16 v[48:63], v[228:231], v[104:107], v[48:63]
    s_waitcnt vmcnt(14)
    s_waitcnt lgkmcnt(0)
    v_mfma_f32_32x32x16_bf16 v[32:47], v[16:19], v[108:111], v[32:47]
    s_add_u32 s31, s46, 8192
    buffer_load_dwordx4 v[104:107], v8, s[4:7], s31 offen sc1
    v_mfma_f32_32x32x16_bf16 v[48:63], v[20:23], v[108:111], v[48:63]
    ds_read_b64_tr_b16 v[24:25], v7 offset:30720
    ds_read_b64_tr_b16 v[26:27], v7 offset:31744
    ds_read_b64_tr_b16 v[28:29], v7 offset:30784
    ds_read_b64_tr_b16 v[30:31], v7 offset:31808
    s_waitcnt vmcnt(14)
    v_mfma_f32_32x32x16_bf16 v[32:47], v[232:235], v[112:115], v[32:47]
    s_add_u32 s31, s46, 51200
    buffer_load_dwordx4 v[108:111], v8, s[4:7], s31 offen sc1
    v_mfma_f32_32x32x16_bf16 v[48:63], v[236:239], v[112:115], v[48:63]
    s_waitcnt vmcnt(14)
    v_mfma_f32_32x32x16_bf16 v[32:47], v[240:243], v[116:119], v[32:47]
    s_add_u32 s31, s46, 9216
    buffer_load_dwordx4 v[112:115], v8, s[4:7], s31 offen sc1
    v_mfma_f32_32x32x16_bf16 v[48:63], v[244:247], v[116:119], v[48:63]
    s_waitcnt vmcnt(14)
    v_mfma_f32_32x32x16_bf16 v[32:47], v[248:251], v[120:123], v[32:47]
    s_add_u32 s31, s46, 10240
    buffer_load_dwordx4 v[116:119], v8, s[4:7], s31 offen sc1
    v_mfma_f32_32x32x16_bf16 v[48:63], v[252:255], v[120:123], v[48:63]
    s_waitcnt vmcnt(14)
    s_waitcnt lgkmcnt(0)
    v_mfma_f32_32x32x16_bf16 v[32:47], v[24:27], v[124:127], v[32:47]
    s_add_u32 s31, s46, 11264
    buffer_load_dwordx4 v[120:123], v8, s[4:7], s31 offen sc1
    v_mfma_f32_32x32x16_bf16 v[48:63], v[28:31], v[124:127], v[48:63]
    s_barrier
    s_nop 7
    ds_write_b128 v9, v[32:35] offset:0
    ds_write_b128 v9, v[36:39] offset:1024
    ds_write_b128 v9, v[40:43] offset:2048
    ds_write_b128 v9, v[44:47] offset:3072
    ds_write_b128 v9, v[48:51] offset:4096
    ds_write_b128 v9, v[52:55] offset:5120
    ds_write_b128 v9, v[56:59] offset:6144
    ds_write_b128 v9, v[60:63] offset:7168
    s_waitcnt lgkmcnt(0)
    s_barrier
    ds_read_b128 v[32:35], v10 offset:0
    ds_read_b128 v[36:39], v10 offset:8192
    ds_read_b128 v[40:43], v10 offset:16384
    ds_read_b128 v[44:47], v10 offset:24576
    ds_read_b128 v[48:51], v10 offset:4096
    ds_read_b128 v[52:55], v10 offset:12288
    ds_read_b128 v[56:59], v10 offset:20480
    ds_read_b128 v[60:63], v10 offset:28672
    s_waitcnt lgkmcnt(4)
    v_pk_add_f32 v[32:33], v[32:33], v[36:37]
    v_pk_add_f32 v[34:35], v[34:35], v[38:39]
    v_pk_add_f32 v[40:41], v[40:41], v[44:45]
    v_pk_add_f32 v[42:43], v[42:43], v[46:47]
    v_pk_add_f32 v[32:33], v[32:33], v[40:41]
    v_pk_add_f32 v[34:35], v[34:35], v[42:43]
    v_cvt_pk_bf16_f32 v24, v32, v33
    v_cvt_pk_bf16_f32 v25, v34, v35
    buffer_store_dwordx2 v[24:25], v11, s[20:23], s49 offen offset:0
    s_waitcnt lgkmcnt(0)
    v_pk_add_f32 v[48:49], v[48:49], v[52:53]
    v_pk_add_f32 v[50:51], v[50:51], v[54:55]
    v_pk_add_f32 v[56:57], v[56:57], v[60:61]
    v_pk_add_f32 v[58:59], v[58:59], v[62:63]
    v_pk_add_f32 v[48:49], v[48:49], v[56:57]
    v_pk_add_f32 v[50:51], v[50:51], v[58:59]
    v_cvt_pk_bf16_f32 v26, v48, v49
    v_cvt_pk_bf16_f32 v27, v50, v51
    buffer_store_dwordx2 v[26:27], v11, s[20:23], s49 offen offset:64
    s_mov_b32 s30, s35
    s_mov_b32 s47, s46
    s_cmp_lg_u32 s51, 0
    s_cbranch_scc1 o6_go_86
    s_cmp_lt_u32 s30, 64
    s_cbranch_scc1 o6_loop_85
    s_branch L_dump
L_ob:
    s_load_dwordx4 s[72:75], s[0:1], 72
    s_add_u32 s76, s90, 83886080
    s_addc_u32 s77, s91, 0
    s_sub_u32 s32, s28, 96
    s_lshr_b32 s32, s32, 3
    s_mul_i32 s30, s32, 22
    s_add_u32 s51, s30, 22
    s_min_u32 s51, s51, 64
    s_sub_u32 s52, s51, 1
    s_lshl_b32 s52, s52, 16
    s_waitcnt lgkmcnt(0)
    s_mov_b32 s8, s72
    s_and_b32 s9, s73, 0xffff
    s_mov_b32 s10, 2097152
    s_mov_b32 s11, 0x00020000
    s_mov_b32 s20, s74
    s_and_b32 s21, s75, 0xffff
    s_mov_b32 s22, 8388608
    s_mov_b32 s23, 0x00020000
    s_mov_b32 s12, s76
    s_and_b32 s13, s77, 0xffff
    s_mov_b32 s14, 4194304
    s_mov_b32 s15, 0x00020000
    s_and_b32 s31, s28, 7
    s_lshl_b32 s31, s31, 8
    s_lshl_b32 s33, s29, 6
    s_add_u32 s31, s31, s33
    v_lshrrev_b32 v6, 2, v1
    v_lshlrev_b32 v6, 11, v6
    v_and_b32 v4, 3, v1
    v_lshl_add_u32 v6, v4, 4, v6
    v_add_u32 v6, s31, v6
    s_mov_b32 s39, 32768
    s_lshl_b32 s36, s30, 17
    s_and_b32 s33, s28, 7
    s_lshl_b32 s33, s33, 8
    s_add_u32 s36, s36, s33
    s_add_u32 s36, s36, 2048
    s_mov_b32 s37, 131072
    s_lshl_b32 s31, s29, 15
    v_lshrrev_b32 v7, 4, v1
    v_lshlrev_b32 v7, 9, v7
    v_bfe_u32 v4, v1, 2, 2
    v_lshl_add_u32 v7, v4, 6, v7
    v_and_b32 v4, 3, v1
    v_lshl_add_u32 v7, v4, 4, v7
    v_add_u32 v7, s31, v7
    s_lshl_b32 s32, s29, 15
    s_add_u32 m0, s32, 0
    s_mov_b32 s38, 0
    buffer_load_dwordx4 v6, s[8:11], s38 offen lds
    s_add_u32 m0, s32, 1024
    s_add_u32 s38, s38, s39
    buffer_load_dwordx4 v6, s[8:11], s38 offen lds
    s_add_u32 m0, s32, 2048
    s_add_u32 s38, s38, s39
    buffer_load_dwordx4 v6, s[8:11], s38 offen lds
    s_add_u32 m0, s32, 3072
    s_add_u32 s38, s38, s39
    buffer_load_dwordx4 v6, s[8:11], s38 offen lds
    s_add_u32 m0, s32, 4096
    s_add_u32 s38, s38, s39
    buffer_load_dwordx4 v6, s[8:11], s38 offen lds
    s_add_u32 m0, s32, 5120
    s_add_u32 s38, s38, s39
    buffer_load_dwordx4 v6, s[8:11], s38 offen lds
    s_add_u32 m0, s32, 6144
    s_add_u32 s38, s38, s39
    buffer_load_dwordx4 v6, s[8:11], s38 offen lds
    s_add_u32 m0, s32, 7168
    s_add_u32 s38, s38, s39
    buffer_load_dwordx4 v6, s[8:11], s38 offen lds
    s_add_u32 m0, s32, 8192
    s_add_u32 s38, s38, s39
    buffer_load_dwordx4 v6, s[8:11], s38 offen lds
    s_add_u32 m0, s32, 9216
    s_add_u32 s38, s38, s39
    buffer_load_dwordx4 v6, s[8:11], s38 offen lds
    s_add_u32 m0, s32, 10240
    s_add_u32 s38, s38, s39
    buffer_load_dwordx4 v6, s[8:11], s38 offen lds
    s_add_u32 m0, s32, 11264
    s_add_u32 s38, s38, s39
    buffer_load_dwordx4 v6, s[8:11], s38 offen lds
    s_add_u32 m0, s32, 12288
    s_add_u32 s38, s38, s39
    buffer_load_dwordx4 v6, s[8:11], s38 offen lds
    s_add_u32 m0, s32, 13312
    s_add_u32 s38, s38, s39
    buffer_load_dwordx4 v6, s[8:11], s38 offen lds
    s_add_u32 m0, s32, 14336
    s_add_u32 s38, s38, s39
    buffer_load_dwordx4 v6, s[8:11], s38 offen lds
    s_add_u32 m0, s32, 15360
    s_add_u32 s38, s38, s39
    buffer_load_dwordx4 v6, s[8:11], s38 offen lds
    s_add_u32 m0, s32, 16384
    s_add_u32 s38, s38, s39
    buffer_load_dwordx4 v6, s[8:11], s38 offen lds
    s_add_u32 m0, s32, 17408
    s_add_u32 s38, s38, s39
    buffer_load_dwordx4 v6, s[8:11], s38 offen lds
    s_add_u32 m0, s32, 18432
    s_add_u32 s38, s38, s39
    buffer_load_dwordx4 v6, s[8:11], s38 offen lds
    s_add_u32 m0, s32, 19456
    s_add_u32 s38, s38, s39
    buffer_load_dwordx4 v6, s[8:11], s38 offen lds
    s_add_u32 m0, s32, 20480
    s_add_u32 s38, s38, s39
    buffer_load_dwordx4 v6, s[8:11], s38 offen lds
    s_add_u32 m0, s32, 21504
    s_add_u32 s38, s38, s39
    buffer_load_dwordx4 v6, s[8:11], s38 offen lds
    s_add_u32 m0, s32, 22528
    s_add_u32 s38, s38, s39
    buffer_load_dwordx4 v6, s[8:11], s38 offen lds
    s_add_u32 m0, s32, 23552
    s_add_u32 s38, s38, s39
    buffer_load_dwordx4 v6, s[8:11], s38 offen lds
    s_add_u32 m0, s32, 24576
    s_add_u32 s38, s38, s39
    buffer_load_dwordx4 v6, s[8:11], s38 offen lds
    s_add_u32 m0, s32, 25600
    s_add_u32 s38, s38, s39
    buffer_load_dwordx4 v6, s[8:11], s38 offen lds
    s_add_u32 m0, s32, 26624
    s_add_u32 s38, s38, s39
    buffer_load_dwordx4 v6, s[8:11], s38 offen lds
    s_add_u32 m0, s32, 27648
    s_add_u32 s38, s38, s39
    buffer_load_dwordx4 v6, s[8:11], s38 offen lds
    s_add_u32 m0, s32, 28672
    s_add_u32 s38, s38, s39
    buffer_load_dwordx4 v6, s[8:11], s38 offen lds
    s_add_u32 m0, s32, 29696
    s_add_u32 s38, s38, s39
    buffer_load_dwordx4 v6, s[8:11], s38 offen lds
    s_add_u32 m0, s32, 30720
    s_add_u32 s38, s38, s39
    buffer_load_dwordx4 v6, s[8:11], s38 offen lds
    s_add_u32 m0, s32, 31744
    s_add_u32 s38, s38, s39
    buffer_load_dwordx4 v6, s[8:11], s38 offen lds
    s_waitcnt vmcnt(30)
    ds_read_b64_tr_b16 a[0:1], v7 offset:0
    ds_read_b64_tr_b16 a[2:3], v7 offset:256
    ds_read_b64_tr_b16 a[4:5], v7 offset:8
    ds_read_b64_tr_b16 a[6:7], v7 offset:264
    s_waitcnt vmcnt(28)
    ds_read_b64_tr_b16 a[8:9], v7 offset:2048
    ds_read_b64_tr_b16 a[10:11], v7 offset:2304
    ds_read_b64_tr_b16 a[12:13], v7 offset:2056
    ds_read_b64_tr_b16 a[14:15], v7 offset:2312
    s_waitcnt lgkmcnt(4)
    s_add_u32 m0, s32, 0
    s_add_u32 s38, s38, s39
    buffer_load_dwordx4 v6, s[8:11], s38 offen lds
    s_add_u32 m0, s32, 1024
    s_add_u32 s38, s38, s39
    buffer_load_dwordx4 v6, s[8:11], s38 offen lds
    s_waitcnt vmcnt(28)
    ds_read_b64_tr_b16 a[16:17], v7 offset:4096
    ds_read_b64_tr_b16 a[18:19], v7 offset:4352
    ds_read_b64_tr_b16 a[20:21], v7 offset:4104
    ds_read_b64_tr_b16 a[22:23], v7 offset:4360
    s_waitcnt lgkmcnt(4)
    s_add_u32 m0, s32, 2048
    s_add_u32 s38, s38, s39
    buffer_load_dwordx4 v6, s[8:11], s38 offen lds
    s_add_u32 m0, s32, 3072
    s_add_u32 s38, s38, s39
    buffer_load_dwordx4 v6, s[8:11], s38 offen lds
    s_waitcnt vmcnt(28)
    ds_read_b64_tr_b16 a[24:25], v7 offset:6144
    ds_read_b64_tr_b16 a[26:27], v7 offset:6400
    ds_read_b64_tr_b16 a[28:29], v7 offset:6152
    ds_read_b64_tr_b16 a[30:31], v7 offset:6408
    s_waitcnt lgkmcnt(4)
    s_add_u32 m0, s32, 4096
    s_add_u32 s38, s38, s39
    buffer_load_dwordx4 v6, s[8:11], s38 offen lds
    s_add_u32 m0, s32, 5120
    s_add_u32 s38, s38, s39
    buffer_load_dwordx4 v6, s[8:11], s38 offen lds
    s_waitcnt vmcnt(28)
    ds_read_b64_tr_b16 a[32:33], v7 offset:8192
    ds_read_b64_tr_b16 a[34:35], v7 offset:8448
    ds_read_b64_tr_b16 a[36:37], v7 offset:8200
    ds_read_b64_tr_b16 a[38:39], v7 offset:8456
    s_waitcnt lgkmcnt(4)
    s_add_u32 m0, s32, 6144
    s_add_u32 s38, s38, s39
    buffer_load_dwordx4 v6, s[8:11], s38 offen lds
    s_add_u32 m0, s32, 7168
    s_add_u32 s38, s38, s39
    buffer_load_dwordx4 v6, s[8:11], s38 offen lds
    s_waitcnt vmcnt(28)
    ds_read_b64_tr_b16 a[40:41], v7 offset:10240
    ds_read_b64_tr_b16 a[42:43], v7 offset:10496
    ds_read_b64_tr_b16 a[44:45], v7 offset:10248
    ds_read_b64_tr_b16 a[46:47], v7 offset:10504
    s_waitcnt lgkmcnt(4)
    s_add_u32 m0, s32, 8192
    s_add_u32 s38, s38, s39
    buffer_load_dwordx4 v6, s[8:11], s38 offen lds
    s_add_u32 m0, s32, 9216
    s_add_u32 s38, s38, s39
    buffer_load_dwordx4 v6, s[8:11], s38 offen lds
    s_waitcnt vmcnt(28)
    ds_read_b64_tr_b16 a[48:49], v7 offset:12288
    ds_read_b64_tr_b16 a[50:51], v7 offset:12544
    ds_read_b64_tr_b16 a[52:53], v7 offset:12296
    ds_read_b64_tr_b16 a[54:55], v7 offset:12552
    s_waitcnt lgkmcnt(4)
    s_add_u32 m0, s32, 10240
    s_add_u32 s38, s38, s39
    buffer_load_dwordx4 v6, s[8:11], s38 offen lds
    s_add_u32 m0, s32, 11264
    s_add_u32 s38, s38, s39
    buffer_load_dwordx4 v6, s[8:11], s38 offen lds
    s_waitcnt vmcnt(28)
    ds_read_b64_tr_b16 a[56:57], v7 offset:14336
    ds_read_b64_tr_b16 a[58:59], v7 offset:14592
    ds_read_b64_tr_b16 a[60:61], v7 offset:14344
    ds_read_b64_tr_b16 a[62:63], v7 offset:14600
    s_waitcnt lgkmcnt(4)
    s_add_u32 m0, s32, 12288
    s_add_u32 s38, s38, s39
    buffer_load_dwordx4 v6, s[8:11], s38 offen lds
    s_add_u32 m0, s32, 13312
    s_add_u32 s38, s38, s39
    buffer_load_dwordx4 v6, s[8:11], s38 offen lds
    s_waitcnt vmcnt(28)
    ds_read_b64_tr_b16 a[64:65], v7 offset:16384
    ds_read_b64_tr_b16 a[66:67], v7 offset:16640
    ds_read_b64_tr_b16 a[68:69], v7 offset:16392
    ds_read_b64_tr_b16 a[70:71], v7 offset:16648
    s_waitcnt lgkmcnt(4)
    s_add_u32 m0, s32, 14336
    s_add_u32 s38, s38, s39
    buffer_load_dwordx4 v6, s[8:11], s38 offen lds
    s_add_u32 m0, s32, 15360
    s_add_u32 s38, s38, s39
    buffer_load_dwordx4 v6, s[8:11], s38 offen lds
    s_waitcnt vmcnt(28)
    ds_read_b64_tr_b16 a[72:73], v7 offset:18432
    ds_read_b64_tr_b16 a[74:75], v7 offset:18688
    ds_read_b64_tr_b16 a[76:77], v7 offset:18440
    ds_read_b64_tr_b16 a[78:79], v7 offset:18696
    s_waitcnt lgkmcnt(4)
    s_add_u32 m0, s32, 16384
    s_add_u32 s38, s38, s39
    buffer_load_dwordx4 v6, s[8:11], s38 offen lds
    s_add_u32 m0, s32, 17408
    s_add_u32 s38, s38, s39
    buffer_load_dwordx4 v6, s[8:11], s38 offen lds
    s_waitcnt vmcnt(28)
    ds_read_b64_tr_b16 a[80:81], v7 offset:20480
    ds_read_b64_tr_b16 a[82:83], v7 offset:20736
    ds_read_b64_tr_b16 a[84:85], v7 offset:20488
    ds_read_b64_tr_b16 a[86:87], v7 offset:20744
    s_waitcnt lgkmcnt(4)
    s_add_u32 m0, s32, 18432
    s_add_u32 s38, s38, s39
    buffer_load_dwordx4 v6, s[8:11], s38 offen lds
    s_add_u32 m0, s32, 19456
    s_add_u32 s38, s38, s39
    buffer_load_dwordx4 v6, s[8:11], s38 offen lds
    s_waitcnt vmcnt(28)
    ds_read_b64_tr_b16 a[88:89], v7 offset:22528
    ds_read_b64_tr_b16 a[90:91], v7 offset:22784
    ds_read_b64_tr_b16 a[92:93], v7 offset:22536
    ds_read_b64_tr_b16 a[94:95], v7 offset:22792
    s_waitcnt lgkmcnt(4)
    s_add_u32 m0, s32, 20480
    s_add_u32 s38, s38, s39
    buffer_load_dwordx4 v6, s[8:11], s38 offen lds
    s_add_u32 m0, s32, 21504
    s_add_u32 s38, s38, s39
    buffer_load_dwordx4 v6, s[8:11], s38 offen lds
    s_waitcnt vmcnt(28)
    ds_read_b64_tr_b16 a[96:97], v7 offset:24576
    ds_read_b64_tr_b16 a[98:99], v7 offset:24832
    ds_read_b64_tr_b16 a[100:101], v7 offset:24584
    ds_read_b64_tr_b16 a[102:103], v7 offset:24840
    s_waitcnt lgkmcnt(4)
    s_add_u32 m0, s32, 22528
    s_add_u32 s38, s38, s39
    buffer_load_dwordx4 v6, s[8:11], s38 offen lds
    s_add_u32 m0, s32, 23552
    s_add_u32 s38, s38, s39
    buffer_load_dwordx4 v6, s[8:11], s38 offen lds
    s_waitcnt vmcnt(28)
    ds_read_b64_tr_b16 a[104:105], v7 offset:26624
    ds_read_b64_tr_b16 a[106:107], v7 offset:26880
    ds_read_b64_tr_b16 a[108:109], v7 offset:26632
    ds_read_b64_tr_b16 a[110:111], v7 offset:26888
    s_waitcnt lgkmcnt(4)
    s_add_u32 m0, s32, 24576
    s_add_u32 s38, s38, s39
    buffer_load_dwordx4 v6, s[8:11], s38 offen lds
    s_add_u32 m0, s32, 25600
    s_add_u32 s38, s38, s39
    buffer_load_dwordx4 v6, s[8:11], s38 offen lds
    s_waitcnt vmcnt(28)
    ds_read_b64_tr_b16 a[112:113], v7 offset:28672
    ds_read_b64_tr_b16 a[114:115], v7 offset:28928
    ds_read_b64_tr_b16 a[116:117], v7 offset:28680
    ds_read_b64_tr_b16 a[118:119], v7 offset:28936
    s_waitcnt lgkmcnt(4)
    s_add_u32 m0, s32, 26624
    s_add_u32 s38, s38, s39
    buffer_load_dwordx4 v6, s[8:11], s38 offen lds
    s_add_u32 m0, s32, 27648
    s_add_u32 s38, s38, s39
    buffer_load_dwordx4 v6, s[8:11], s38 offen lds
    s_waitcnt vmcnt(28)
    ds_read_b64_tr_b16 a[120:121], v7 offset:30720
    ds_read_b64_tr_b16 a[122:123], v7 offset:30976
    ds_read_b64_tr_b16 a[124:125], v7 offset:30728
    ds_read_b64_tr_b16 a[126:127], v7 offset:30984
    s_waitcnt lgkmcnt(4)
    s_add_u32 m0, s32, 28672
    s_add_u32 s38, s38, s39
    buffer_load_dwordx4 v6, s[8:11], s38 offen lds
    s_add_u32 m0, s32, 29696
    s_add_u32 s38, s38, s39
    buffer_load_dwordx4 v6, s[8:11], s38 offen lds
    s_waitcnt vmcnt(28)
    ds_read_b64_tr_b16 a[128:129], v7 offset:0
    ds_read_b64_tr_b16 a[130:131], v7 offset:256
    ds_read_b64_tr_b16 a[132:133], v7 offset:8
    ds_read_b64_tr_b16 a[134:135], v7 offset:264
    s_waitcnt lgkmcnt(4)
    s_add_u32 m0, s32, 30720
    s_add_u32 s38, s38, s39
    buffer_load_dwordx4 v6, s[8:11], s38 offen lds
    s_add_u32 m0, s32, 31744
    s_add_u32 s38, s38, s39
    buffer_load_dwordx4 v6, s[8:11], s38 offen lds
    s_waitcnt vmcnt(28)
    ds_read_b64_tr_b16 a[136:137], v7 offset:2048
    ds_read_b64_tr_b16 a[138:139], v7 offset:2304
    ds_read_b64_tr_b16 a[140:141], v7 offset:2056
    ds_read_b64_tr_b16 a[142:143], v7 offset:2312
    s_waitcnt vmcnt(26)
    ds_read_b64_tr_b16 a[144:145], v7 offset:4096
    ds_read_b64_tr_b16 a[146:147], v7 offset:4352
    ds_read_b64_tr_b16 a[148:149], v7 offset:4104
    ds_read_b64_tr_b16 a[150:151], v7 offset:4360
    s_waitcnt vmcnt(24)
    ds_read_b64_tr_b16 a[152:153], v7 offset:6144
    ds_read_b64_tr_b16 a[154:155], v7 offset:6400
    ds_read_b64_tr_b16 a[156:157], v7 offset:6152
    ds_read_b64_tr_b16 a[158:159], v7 offset:6408
    s_waitcnt vmcnt(22)
    ds_read_b64_tr_b16 a[160:161], v7 offset:8192
    ds_read_b64_tr_b16 a[162:163], v7 offset:8448
    ds_read_b64_tr_b16 a[164:165], v7 offset:8200
    ds_read_b64_tr_b16 a[166:167], v7 offset:8456
    s_waitcnt vmcnt(20)
    ds_read_b64_tr_b16 a[168:169], v7 offset:10240
    ds_read_b64_tr_b16 a[170:171], v7 offset:10496
    ds_read_b64_tr_b16 a[172:173], v7 offset:10248
    ds_read_b64_tr_b16 a[174:175], v7 offset:10504
    s_waitcnt vmcnt(18)
    ds_read_b64_tr_b16 a[176:177], v7 offset:12288
    ds_read_b64_tr_b16 a[178:179], v7 offset:12544
    ds_read_b64_tr_b16 a[180:181], v7 offset:12296
    ds_read_b64_tr_b16 a[182:183], v7 offset:12552
    s_waitcnt vmcnt(16)
    ds_read_b64_tr_b16 a[184:185], v7 offset:14336
    ds_read_b64_tr_b16 a[186:187], v7 offset:14592
    ds_read_b64_tr_b16 a[188:189], v7 offset:14344
    ds_read_b64_tr_b16 a[190:191], v7 offset:14600
    s_waitcnt vmcnt(14)
    ds_read_b64_tr_b16 a[192:193], v7 offset:16384
    ds_read_b64_tr_b16 a[194:195], v7 offset:16640
    ds_read_b64_tr_b16 a[196:197], v7 offset:16392
    ds_read_b64_tr_b16 a[198:199], v7 offset:16648
    s_waitcnt vmcnt(12)
    ds_read_b64_tr_b16 a[200:201], v7 offset:18432
    ds_read_b64_tr_b16 a[202:203], v7 offset:18688
    ds_read_b64_tr_b16 a[204:205], v7 offset:18440
    ds_read_b64_tr_b16 a[206:207], v7 offset:18696
    s_waitcnt vmcnt(10)
    ds_read_b64_tr_b16 a[208:209], v7 offset:20480
    ds_read_b64_tr_b16 a[210:211], v7 offset:20736
    ds_read_b64_tr_b16 a[212:213], v7 offset:20488
    ds_read_b64_tr_b16 a[214:215], v7 offset:20744
    s_waitcnt vmcnt(8)
    ds_read_b64_tr_b16 a[216:217], v7 offset:22528
    ds_read_b64_tr_b16 a[218:219], v7 offset:22784
    ds_read_b64_tr_b16 a[220:221], v7 offset:22536
    ds_read_b64_tr_b16 a[222:223], v7 offset:22792
    s_waitcnt vmcnt(6)
    ds_read_b64_tr_b16 a[224:225], v7 offset:24576
    ds_read_b64_tr_b16 a[226:227], v7 offset:24832
    ds_read_b64_tr_b16 a[228:229], v7 offset:24584
    ds_read_b64_tr_b16 a[230:231], v7 offset:24840
    s_waitcnt vmcnt(4)
    ds_read_b64_tr_b16 a[232:233], v7 offset:26624
    ds_read_b64_tr_b16 a[234:235], v7 offset:26880
    ds_read_b64_tr_b16 a[236:237], v7 offset:26632
    ds_read_b64_tr_b16 a[238:239], v7 offset:26888
    s_waitcnt vmcnt(2)
    ds_read_b64_tr_b16 a[240:241], v7 offset:28672
    ds_read_b64_tr_b16 a[242:243], v7 offset:28928
    ds_read_b64_tr_b16 a[244:245], v7 offset:28680
    ds_read_b64_tr_b16 a[246:247], v7 offset:28936
    s_waitcnt vmcnt(0)
    ds_read_b64_tr_b16 a[248:249], v7 offset:30720
    ds_read_b64_tr_b16 a[250:251], v7 offset:30976
    ds_read_b64_tr_b16 a[252:253], v7 offset:30728
    ds_read_b64_tr_b16 a[254:255], v7 offset:30984
    s_waitcnt lgkmcnt(0)
    s_lshr_b32 s31, s29, 1
    s_and_b32 s31, s31, 1
    s_lshl_b32 s31, s31, 2
    v_lshrrev_b32 v2, 4, v1
    v_add_u32 v2, s31, v2
    v_and_b32 v3, 7, v1
    v_xor_b32 v2, v2, v3
    s_lshl_b32 s31, s29, 14
    v_lshrrev_b32 v8, 3, v1
    v_lshlrev_b32 v8, 11, v8
    v_add_u32 v8, s31, v8
    v_lshl_add_u32 v8, v2, 4, v8
    v_bfe_u32 v2, v1, 1, 3
    v_lshrrev_b32 v3, 4, v1
    v_xor_b32 v2, v2, v3
    v_bfe_u32 v3, v1, 3, 1
    v_lshlrev_b32 v3, 11, v3
    v_and_b32 v4, 7, v1
    v_lshl_add_u32 v3, v4, 7, v3
    v_xor_b32 v12, 0, v2
    v_lshl_add_u32 v12, v12, 4, v3
    v_add_u32 v14, 65536, v12
    v_xor_b32 v13, 4, v2
    v_lshl_add_u32 v13, v13, 4, v3
    v_add_u32 v15, 65536, v13
    s_lshl_b32 s31, s29, 6
    v_and_b32 v9, 15, v1
    v_lshlrev_b32 v9, 12, v9
    v_lshrrev_b32 v4, 4, v1
    v_lshl_add_u32 v9, v4, 4, v9
    v_add_u32 v9, s31, v9
    v_add_u32 v8, s34, v5
    v_lshrrev_b32 v12, 4, v1
    v_lshlrev_b32 v12, 9, v12
    v_and_b32 v4, 15, v1
    v_lshl_add_u32 v12, v4, 4, v12
    v_add_u32 v14, 65536, v12
    s_cmp_lg_u32 s29, 0
    s_cbranch_scc1 g_wdd_90
g_wd_89:
    s_load_dword s72, s[92:93], 0 glc
    s_add_u32 s41, s41, 1
    s_cmp_ge_u32 s41, 0x200000
    s_cbranch_scc1 g_wdd_90
    s_waitcnt lgkmcnt(0)
    s_and_b32 s72, s72, 0xffff
    s_cmp_ge_u32 s72, 256
    s_cbranch_scc1 g_wdd_90
    s_sleep 32
    s_branch g_wd_89
g_wdd_90:
    s_waitcnt lgkmcnt(0)
    s_barrier
    v_and_b32 v2, 31, v1
    v_lshlrev_b32 v2, 7, v2
    v_add_u32 v2, 115359744, v2
    s_cmp_lg_u32 s29, 0
    s_cbranch_scc1 g_wld_92
g_wl_91:
    buffer_load_dword v3, v2, s[4:7], 0 offen sc1
    s_add_u32 s41, s41, 1
    s_cmp_ge_u32 s41, 0x200000
    s_cbranch_scc1 g_wld_92
    s_waitcnt vmcnt(0)
    v_cmp_gt_u32 vcc, s51, v3
    s_cbranch_vccz g_wld_92
    s_sleep 8
    s_branch g_wl_91
g_wld_92:
    s_barrier
    s_lshl_b32 s35, s30, 16
    s_sub_u32 s36, s36, s37
    s_barrier
    s_add_u32 m0, s34, 0
    s_add_u32 s32, s35, 0
    buffer_load_dwordx4 v8, s[12:15], s32 offen sc1 lds
    s_add_u32 m0, s34, 4096
    s_add_u32 s32, s35, 4096
    buffer_load_dwordx4 v8, s[12:15], s32 offen sc1 lds
    s_add_u32 m0, s34, 8192
    s_add_u32 s32, s35, 8192
    buffer_load_dwordx4 v8, s[12:15], s32 offen sc1 lds
    s_add_u32 m0, s34, 12288
    s_add_u32 s32, s35, 12288
    buffer_load_dwordx4 v8, s[12:15], s32 offen sc1 lds
    s_add_u32 m0, s34, 16384
    s_add_u32 s32, s35, 16384
    buffer_load_dwordx4 v8, s[12:15], s32 offen sc1 lds
    s_add_u32 m0, s34, 20480
    s_add_u32 s32, s35, 20480
    buffer_load_dwordx4 v8, s[12:15], s32 offen sc1 lds
    s_add_u32 m0, s34, 24576
    s_add_u32 s32, s35, 24576
    buffer_load_dwordx4 v8, s[12:15], s32 offen sc1 lds
    s_add_u32 m0, s34, 28672
    s_add_u32 s32, s35, 28672
    buffer_load_dwordx4 v8, s[12:15], s32 offen sc1 lds
    s_add_u32 m0, s34, 32768
    s_add_u32 s32, s35, 32768
    buffer_load_dwordx4 v8, s[12:15], s32 offen sc1 lds
    s_add_u32 m0, s34, 36864
    s_add_u32 s32, s35, 36864
    buffer_load_dwordx4 v8, s[12:15], s32 offen sc1 lds
    s_add_u32 m0, s34, 40960
    s_add_u32 s32, s35, 40960
    buffer_load_dwordx4 v8, s[12:15], s32 offen sc1 lds
    s_add_u32 m0, s34, 45056
    s_add_u32 s32, s35, 45056
    buffer_load_dwordx4 v8, s[12:15], s32 offen sc1 lds
    s_add_u32 m0, s34, 49152
    s_add_u32 s32, s35, 49152
    buffer_load_dwordx4 v8, s[12:15], s32 offen sc1 lds
    s_add_u32 m0, s34, 53248
    s_add_u32 s32, s35, 53248
    buffer_load_dwordx4 v8, s[12:15], s32 offen sc1 lds
    s_add_u32 m0, s34, 57344
    s_add_u32 s32, s35, 57344
    buffer_load_dwordx4 v8, s[12:15], s32 offen sc1 lds
    s_add_u32 m0, s34, 61440
    s_add_u32 s32, s35, 61440
    buffer_load_dwordx4 v8, s[12:15], s32 offen sc1 lds
    s_add_u32 s35, s35, 65536
    s_add_u32 m0, s34, 65536
    s_add_u32 s32, s35, 0
    buffer_load_dwordx4 v8, s[12:15], s32 offen sc1 lds
    s_add_u32 m0, s34, 69632
    s_add_u32 s32, s35, 4096
    buffer_load_dwordx4 v8, s[12:15], s32 offen sc1 lds
    s_add_u32 m0, s34, 73728
    s_add_u32 s32, s35, 8192
    buffer_load_dwordx4 v8, s[12:15], s32 offen sc1 lds
    s_add_u32 m0, s34, 77824
    s_add_u32 s32, s35, 12288
    buffer_load_dwordx4 v8, s[12:15], s32 offen sc1 lds
    s_waitcnt vmcnt(12)
    s_barrier
    ds_read_b128 v[32:35], v12 offset:0
    ds_read_b128 v[36:39], v12 offset:256
    ds_read_b128 v[40:43], v12 offset:2048
    ds_read_b128 v[44:47], v12 offset:2304
    ds_read_b128 v[48:51], v12 offset:4096
    ds_read_b128 v[52:55], v12 offset:4352
    v_add_u32 v9, 2130706432, v9
sl_loop_95:
    s_waitcnt lgkmcnt(4)
    v_mfma_f32_16x16x32_bf16 v[64:67], a[0:3], v[32:35], 0
    ds_read_b128 v[56:59], v12 offset:6144
    v_mfma_f32_16x16x32_bf16 v[68:71], a[4:7], v[32:35], 0
    v_mfma_f32_16x16x32_bf16 v[72:75], a[0:3], v[36:39], 0
    ds_read_b128 v[60:63], v12 offset:6400
    s_add_u32 m0, s34, 81920
    s_add_u32 s32, s35, 16384
    v_mfma_f32_16x16x32_bf16 v[76:79], a[4:7], v[36:39], 0
    buffer_load_dwordx4 v8, s[12:15], s32 offen sc1 lds
    s_waitcnt lgkmcnt(4)
    v_mfma_f32_16x16x32_bf16 v[64:67], a[8:11], v[40:43], v[64:67]
    ds_read_b128 v[32:35], v12 offset:8192
    v_mfma_f32_16x16x32_bf16 v[68:71], a[12:15], v[40:43], v[68:71]
    v_mfma_f32_16x16x32_bf16 v[72:75], a[8:11], v[44:47], v[72:75]
    ds_read_b128 v[36:39], v12 offset:8448
    v_mfma_f32_16x16x32_bf16 v[76:79], a[12:15], v[44:47], v[76:79]
    s_waitcnt lgkmcnt(4)
    v_mfma_f32_16x16x32_bf16 v[64:67], a[16:19], v[48:51], v[64:67]
    ds_read_b128 v[40:43], v12 offset:10240
    v_mfma_f32_16x16x32_bf16 v[68:71], a[20:23], v[48:51], v[68:71]
    v_cvt_pk_bf16_f32 v96, v80, v81
    v_mfma_f32_16x16x32_bf16 v[72:75], a[16:19], v[52:55], v[72:75]
    ds_read_b128 v[44:47], v12 offset:10496
    s_add_u32 m0, s34, 86016
    s_add_u32 s32, s35, 20480
    v_mfma_f32_16x16x32_bf16 v[76:79], a[20:23], v[52:55], v[76:79]
    buffer_load_dwordx4 v8, s[12:15], s32 offen sc1 lds
    v_cvt_pk_bf16_f32 v97, v82, v83
    s_waitcnt lgkmcnt(4)
    v_mfma_f32_16x16x32_bf16 v[64:67], a[24:27], v[56:59], v[64:67]
    ds_read_b128 v[48:51], v12 offset:12288
    v_mfma_f32_16x16x32_bf16 v[68:71], a[28:31], v[56:59], v[68:71]
    v_cvt_pk_bf16_f32 v98, v84, v85
    v_mfma_f32_16x16x32_bf16 v[72:75], a[24:27], v[60:63], v[72:75]
    ds_read_b128 v[52:55], v12 offset:12544
    v_mfma_f32_16x16x32_bf16 v[76:79], a[28:31], v[60:63], v[76:79]
    v_cvt_pk_bf16_f32 v99, v86, v87
    s_waitcnt lgkmcnt(4)
    v_mfma_f32_16x16x32_bf16 v[64:67], a[32:35], v[32:35], v[64:67]
    ds_read_b128 v[56:59], v12 offset:14336
    v_mfma_f32_16x16x32_bf16 v[68:71], a[36:39], v[32:35], v[68:71]
    v_cvt_pk_bf16_f32 v100, v88, v89
    v_mfma_f32_16x16x32_bf16 v[72:75], a[32:35], v[36:39], v[72:75]
    ds_read_b128 v[60:63], v12 offset:14592
    s_add_u32 m0, s34, 90112
    s_add_u32 s32, s35, 24576
    v_mfma_f32_16x16x32_bf16 v[76:79], a[36:39], v[36:39], v[76:79]
    buffer_load_dwordx4 v8, s[12:15], s32 offen sc1 lds
    v_cvt_pk_bf16_f32 v101, v90, v91
    s_waitcnt lgkmcnt(4)
    v_mfma_f32_16x16x32_bf16 v[64:67], a[40:43], v[40:43], v[64:67]
    ds_read_b128 v[32:35], v12 offset:16384
    v_mfma_f32_16x16x32_bf16 v[68:71], a[44:47], v[40:43], v[68:71]
    v_cvt_pk_bf16_f32 v102, v92, v93
    v_mfma_f32_16x16x32_bf16 v[72:75], a[40:43], v[44:47], v[72:75]
    ds_read_b128 v[36:39], v12 offset:16640
    v_mfma_f32_16x16x32_bf16 v[76:79], a[44:47], v[44:47], v[76:79]
    v_cvt_pk_bf16_f32 v103, v94, v95
    buffer_store_dwordx4 v[96:99], v9, s[20:23], s36 offen
    s_add_u32 s31, s36, 65536
    s_waitcnt lgkmcnt(4)
    v_mfma_f32_16x16x32_bf16 v[64:67], a[48:51], v[48:51], v[64:67]
    ds_read_b128 v[40:43], v12 offset:18432
    v_mfma_f32_16x16x32_bf16 v[68:71], a[52:55], v[48:51], v[68:71]
    v_mfma_f32_16x16x32_bf16 v[72:75], a[48:51], v[52:55], v[72:75]
    ds_read_b128 v[44:47], v12 offset:18688
    s_add_u32 m0, s34, 94208
    s_add_u32 s32, s35, 28672
    v_mfma_f32_16x16x32_bf16 v[76:79], a[52:55], v[52:55], v[76:79]
    buffer_load_dwordx4 v8, s[12:15], s32 offen sc1 lds
    s_waitcnt lgkmcnt(4)
    v_mfma_f32_16x16x32_bf16 v[64:67], a[56:59], v[56:59], v[64:67]
    ds_read_b128 v[48:51], v12 offset:20480
    v_mfma_f32_16x16x32_bf16 v[68:71], a[60:63], v[56:59], v[68:71]
    v_mfma_f32_16x16x32_bf16 v[72:75], a[56:59], v[60:63], v[72:75]
    ds_read_b128 v[52:55], v12 offset:20736
    v_mfma_f32_16x16x32_bf16 v[76:79], a[60:63], v[60:63], v[76:79]
    buffer_store_dwordx4 v[100:103], v9, s[20:23], s31 offen
    s_add_u32 s36, s36, s37
    s_waitcnt vmcnt(8)
    s_barrier
    s_waitcnt lgkmcnt(4)
    v_mfma_f32_16x16x32_bf16 v[64:67], a[64:67], v[32:35], v[64:67]
    ds_read_b128 v[56:59], v12 offset:22528
    v_mfma_f32_16x16x32_bf16 v[68:71], a[68:71], v[32:35], v[68:71]
    v_mfma_f32_16x16x32_bf16 v[72:75], a[64:67], v[36:39], v[72:75]
    ds_read_b128 v[60:63], v12 offset:22784
    s_add_u32 m0, s34, 98304
    s_add_u32 s32, s35, 32768
    v_mfma_f32_16x16x32_bf16 v[76:79], a[68:71], v[36:39], v[76:79]
    buffer_load_dwordx4 v8, s[12:15], s32 offen sc1 lds
    s_waitcnt lgkmcnt(4)
    v_mfma_f32_16x16x32_bf16 v[64:67], a[72:75], v[40:43], v[64:67]
    ds_read_b128 v[32:35], v12 offset:24576
    v_mfma_f32_16x16x32_bf16 v[68:71], a[76:79], v[40:43], v[68:71]
    v_mfma_f32_16x16x32_bf16 v[72:75], a[72:75], v[44:47], v[72:75]
    ds_read_b128 v[36:39], v12 offset:24832
    v_mfma_f32_16x16x32_bf16 v[76:79], a[76:79], v[44:47], v[76:79]
    s_waitcnt lgkmcnt(4)
    v_mfma_f32_16x16x32_bf16 v[64:67], a[80:83], v[48:51], v[64:67]
    ds_read_b128 v[40:43], v12 offset:26624
    v_mfma_f32_16x16x32_bf16 v[68:71], a[84:87], v[48:51], v[68:71]
    v_and_b32 v9, 0xffffff, v9
    v_mfma_f32_16x16x32_bf16 v[72:75], a[80:83], v[52:55], v[72:75]
    ds_read_b128 v[44:47], v12 offset:26880
    s_add_u32 m0, s34, 102400
    s_add_u32 s32, s35, 36864
    v_mfma_f32_16x16x32_bf16 v[76:79], a[84:87], v[52:55], v[76:79]
    buffer_load_dwordx4 v8, s[12:15], s32 offen sc1 lds
    s_waitcnt lgkmcnt(4)
    v_mfma_f32_16x16x32_bf16 v[64:67], a[88:91], v[56:59], v[64:67]
    ds_read_b128 v[48:51], v12 offset:28672
    v_mfma_f32_16x16x32_bf16 v[68:71], a[92:95], v[56:59], v[68:71]
    v_mfma_f32_16x16x32_bf16 v[72:75], a[88:91], v[60:63], v[72:75]
    ds_read_b128 v[52:55], v12 offset:28928
    v_mfma_f32_16x16x32_bf16 v[76:79], a[92:95], v[60:63], v[76:79]
    s_waitcnt lgkmcnt(4)
    v_mfma_f32_16x16x32_bf16 v[64:67], a[96:99], v[32:35], v[64:67]
    ds_read_b128 v[56:59], v12 offset:30720
    v_mfma_f32_16x16x32_bf16 v[68:71], a[100:103], v[32:35], v[68:71]
    v_mfma_f32_16x16x32_bf16 v[72:75], a[96:99], v[36:39], v[72:75]
    ds_read_b128 v[60:63], v12 offset:30976
    s_add_u32 m0, s34, 106496
    s_add_u32 s32, s35, 40960
    v_mfma_f32_16x16x32_bf16 v[76:79], a[100:103], v[36:39], v[76:79]
    buffer_load_dwordx4 v8, s[12:15], s32 offen sc1 lds
    s_waitcnt lgkmcnt(4)
    v_mfma_f32_16x16x32_bf16 v[64:67], a[104:107], v[40:43], v[64:67]
    ds_read_b128 v[32:35], v12 offset:32768
    v_mfma_f32_16x16x32_bf16 v[68:71], a[108:111], v[40:43], v[68:71]
    v_mfma_f32_16x16x32_bf16 v[72:75], a[104:107], v[44:47], v[72:75]
    ds_read_b128 v[36:39], v12 offset:33024
    v_mfma_f32_16x16x32_bf16 v[76:79], a[108:111], v[44:47], v[76:79]
    s_waitcnt lgkmcnt(4)
    v_mfma_f32_16x16x32_bf16 v[64:67], a[112:115], v[48:51], v[64:67]
    ds_read_b128 v[40:43], v12 offset:34816
    v_mfma_f32_16x16x32_bf16 v[68:71], a[116:119], v[48:51], v[68:71]
    v_mfma_f32_16x16x32_bf16 v[72:75], a[112:115], v[52:55], v[72:75]
    ds_read_b128 v[44:47], v12 offset:35072
    s_add_u32 m0, s34, 110592
    s_add_u32 s32, s35, 45056
    v_mfma_f32_16x16x32_bf16 v[76:79], a[116:119], v[52:55], v[76:79]
    buffer_load_dwordx4 v8, s[12:15], s32 offen sc1 lds
    s_waitcnt lgkmcnt(4)
    v_mfma_f32_16x16x32_bf16 v[64:67], a[120:123], v[56:59], v[64:67]
    ds_read_b128 v[48:51], v12 offset:36864
    v_mfma_f32_16x16x32_bf16 v[68:71], a[124:127], v[56:59], v[68:71]
    v_mfma_f32_16x16x32_bf16 v[72:75], a[120:123], v[60:63], v[72:75]
    ds_read_b128 v[52:55], v12 offset:37120
    v_mfma_f32_16x16x32_bf16 v[76:79], a[124:127], v[60:63], v[76:79]
    s_waitcnt lgkmcnt(4)
    v_mfma_f32_16x16x32_bf16 v[64:67], a[128:131], v[32:35], v[64:67]
    ds_read_b128 v[56:59], v12 offset:38912
    v_mfma_f32_16x16x32_bf16 v[68:71], a[132:135], v[32:35], v[68:71]
    v_mfma_f32_16x16x32_bf16 v[72:75], a[128:131], v[36:39], v[72:75]
    ds_read_b128 v[60:63], v12 offset:39168
    s_add_u32 m0, s34, 114688
    s_add_u32 s32, s35, 49152
    v_mfma_f32_16x16x32_bf16 v[76:79], a[132:135], v[36:39], v[76:79]
    buffer_load_dwordx4 v8, s[12:15], s32 offen sc1 lds
    s_waitcnt lgkmcnt(4)
    v_mfma_f32_16x16x32_bf16 v[64:67], a[136:139], v[40:43], v[64:67]
    ds_read_b128 v[32:35], v12 offset:40960
    v_mfma_f32_16x16x32_bf16 v[68:71], a[140:143], v[40:43], v[68:71]
    v_mfma_f32_16x16x32_bf16 v[72:75], a[136:139], v[44:47], v[72:75]
    ds_read_b128 v[36:39], v12 offset:41216
    v_mfma_f32_16x16x32_bf16 v[76:79], a[140:143], v[44:47], v[76:79]
    s_waitcnt lgkmcnt(4)
    v_mfma_f32_16x16x32_bf16 v[64:67], a[144:147], v[48:51], v[64:67]
    ds_read_b128 v[40:43], v12 offset:43008
    v_mfma_f32_16x16x32_bf16 v[68:71], a[148:151], v[48:51], v[68:71]
    v_mfma_f32_16x16x32_bf16 v[72:75], a[144:147], v[52:55], v[72:75]
    ds_read_b128 v[44:47], v12 offset:43264
    s_add_u32 m0, s34, 118784
    s_add_u32 s32, s35, 53248
    v_mfma_f32_16x16x32_bf16 v[76:79], a[148:151], v[52:55], v[76:79]
    buffer_load_dwordx4 v8, s[12:15], s32 offen sc1 lds
    s_waitcnt lgkmcnt(4)
    v_mfma_f32_16x16x32_bf16 v[64:67], a[152:155], v[56:59], v[64:67]
    ds_read_b128 v[48:51], v12 offset:45056
    v_mfma_f32_16x16x32_bf16 v[68:71], a[156:159], v[56:59], v[68:71]
    v_mfma_f32_16x16x32_bf16 v[72:75], a[152:155], v[60:63], v[72:75]
    ds_read_b128 v[52:55], v12 offset:45312
    v_mfma_f32_16x16x32_bf16 v[76:79], a[156:159], v[60:63], v[76:79]
    s_waitcnt lgkmcnt(4)
    v_mfma_f32_16x16x32_bf16 v[64:67], a[160:163], v[32:35], v[64:67]
    ds_read_b128 v[56:59], v12 offset:47104
    v_mfma_f32_16x16x32_bf16 v[68:71], a[164:167], v[32:35], v[68:71]
    v_mfma_f32_16x16x32_bf16 v[72:75], a[160:163], v[36:39], v[72:75]
    ds_read_b128 v[60:63], v12 offset:47360
    s_add_u32 m0, s34, 122880
    s_add_u32 s32, s35, 57344
    v_mfma_f32_16x16x32_bf16 v[76:79], a[164:167], v[36:39], v[76:79]
    buffer_load_dwordx4 v8, s[12:15], s32 offen sc1 lds
    s_waitcnt lgkmcnt(4)
    v_mfma_f32_16x16x32_bf16 v[64:67], a[168:171], v[40:43], v[64:67]
    ds_read_b128 v[32:35], v12 offset:49152
    v_mfma_f32_16x16x32_bf16 v[68:71], a[172:175], v[40:43], v[68:71]
    v_mfma_f32_16x16x32_bf16 v[72:75], a[168:171], v[44:47], v[72:75]
    ds_read_b128 v[36:39], v12 offset:49408
    v_mfma_f32_16x16x32_bf16 v[76:79], a[172:175], v[44:47], v[76:79]
    s_waitcnt lgkmcnt(4)
    v_mfma_f32_16x16x32_bf16 v[64:67], a[176:179], v[48:51], v[64:67]
    ds_read_b128 v[40:43], v12 offset:51200
    v_mfma_f32_16x16x32_bf16 v[68:71], a[180:183], v[48:51], v[68:71]
    v_mfma_f32_16x16x32_bf16 v[72:75], a[176:179], v[52:55], v[72:75]
    ds_read_b128 v[44:47], v12 offset:51456
    s_add_u32 m0, s34, 126976
    s_add_u32 s32, s35, 61440
    v_mfma_f32_16x16x32_bf16 v[76:79], a[180:183], v[52:55], v[76:79]
    buffer_load_dwordx4 v8, s[12:15], s32 offen sc1 lds
    s_add_u32 s35, s35, 65536
    s_min_u32 s35, s35, s52
    s_waitcnt lgkmcnt(4)
    v_mfma_f32_16x16x32_bf16 v[64:67], a[184:187], v[56:59], v[64:67]
    ds_read_b128 v[48:51], v12 offset:53248
    v_mfma_f32_16x16x32_bf16 v[68:71], a[188:191], v[56:59], v[68:71]
    v_mfma_f32_16x16x32_bf16 v[72:75], a[184:187], v[60:63], v[72:75]
    ds_read_b128 v[52:55], v12 offset:53504
    v_mfma_f32_16x16x32_bf16 v[76:79], a[188:191], v[60:63], v[76:79]
    s_waitcnt vmcnt(8)
    s_barrier
    s_waitcnt lgkmcnt(4)
    v_mfma_f32_16x16x32_bf16 v[64:67], a[192:195], v[32:35], v[64:67]
    ds_read_b128 v[56:59], v12 offset:55296
    v_mfma_f32_16x16x32_bf16 v[68:71], a[196:199], v[32:35], v[68:71]
    v_mfma_f32_16x16x32_bf16 v[72:75], a[192:195], v[36:39], v[72:75]
    ds_read_b128 v[60:63], v12 offset:55552
    s_add_u32 m0, s34, 0
    s_add_u32 s32, s35, 0
    v_mfma_f32_16x16x32_bf16 v[76:79], a[196:199], v[36:39], v[76:79]
    buffer_load_dwordx4 v8, s[12:15], s32 offen sc1 lds
    s_waitcnt lgkmcnt(4)
    v_mfma_f32_16x16x32_bf16 v[64:67], a[200:203], v[40:43], v[64:67]
    ds_read_b128 v[32:35], v12 offset:57344
    v_mfma_f32_16x16x32_bf16 v[68:71], a[204:207], v[40:43], v[68:71]
    v_mfma_f32_16x16x32_bf16 v[72:75], a[200:203], v[44:47], v[72:75]
    ds_read_b128 v[36:39], v12 offset:57600
    v_mfma_f32_16x16x32_bf16 v[76:79], a[204:207], v[44:47], v[76:79]
    s_waitcnt lgkmcnt(4)
    v_mfma_f32_16x16x32_bf16 v[64:67], a[208:211], v[48:51], v[64:67]
    ds_read_b128 v[40:43], v12 offset:59392
    v_mfma_f32_16x16x32_bf16 v[68:71], a[212:215], v[48:51], v[68:71]
    v_mfma_f32_16x16x32_bf16 v[72:75], a[208:211], v[52:55], v[72:75]
    ds_read_b128 v[44:47], v12 offset:59648
    s_add_u32 m0, s34, 4096
    s_add_u32 s32, s35, 4096
    v_mfma_f32_16x16x32_bf16 v[76:79], a[212:215], v[52:55], v[76:79]
    buffer_load_dwordx4 v8, s[12:15], s32 offen sc1 lds
    s_waitcnt lgkmcnt(4)
    v_mfma_f32_16x16x32_bf16 v[64:67], a[216:219], v[56:59], v[64:67]
    ds_read_b128 v[48:51], v12 offset:61440
    v_mfma_f32_16x16x32_bf16 v[68:71], a[220:223], v[56:59], v[68:71]
    v_mfma_f32_16x16x32_bf16 v[72:75], a[216:219], v[60:63], v[72:75]
    ds_read_b128 v[52:55], v12 offset:61696
    v_mfma_f32_16x16x32_bf16 v[76:79], a[220:223], v[60:63], v[76:79]
    s_waitcnt lgkmcnt(4)
    v_mfma_f32_16x16x32_bf16 v[64:67], a[224:227], v[32:35], v[64:67]
    ds_read_b128 v[56:59], v12 offset:63488
    v_mfma_f32_16x16x32_bf16 v[68:71], a[228:231], v[32:35], v[68:71]
    v_mfma_f32_16x16x32_bf16 v[72:75], a[224:227], v[36:39], v[72:75]
    ds_read_b128 v[60:63], v12 offset:63744
    s_add_u32 m0, s34, 8192
    s_add_u32 s32, s35, 8192
    v_mfma_f32_16x16x32_bf16 v[76:79], a[228:231], v[36:39], v[76:79]
    buffer_load_dwordx4 v8, s[12:15], s32 offen sc1 lds
    s_waitcnt lgkmcnt(4)
    v_mfma_f32_16x16x32_bf16 v[64:67], a[232:235], v[40:43], v[64:67]
    ds_read_b128 v[32:35], v14 offset:0
    v_mfma_f32_16x16x32_bf16 v[68:71], a[236:239], v[40:43], v[68:71]
    v_mfma_f32_16x16x32_bf16 v[72:75], a[232:235], v[44:47], v[72:75]
    ds_read_b128 v[36:39], v14 offset:256
    v_mfma_f32_16x16x32_bf16 v[76:79], a[236:239], v[44:47], v[76:79]
    s_waitcnt lgkmcnt(4)
    v_mfma_f32_16x16x32_bf16 v[64:67], a[240:243], v[48:51], v[64:67]
    ds_read_b128 v[40:43], v14 offset:2048
    v_mfma_f32_16x16x32_bf16 v[68:71], a[244:247], v[48:51], v[68:71]
    v_mfma_f32_16x16x32_bf16 v[72:75], a[240:243], v[52:55], v[72:75]
    ds_read_b128 v[44:47], v14 offset:2304
    s_add_u32 m0, s34, 12288
    s_add_u32 s32, s35, 12288
    v_mfma_f32_16x16x32_bf16 v[76:79], a[244:247], v[52:55], v[76:79]
    buffer_load_dwordx4 v8, s[12:15], s32 offen sc1 lds
    s_waitcnt lgkmcnt(4)
    v_mfma_f32_16x16x32_bf16 v[64:67], a[248:251], v[56:59], v[64:67]
    ds_read_b128 v[48:51], v14 offset:4096
    v_mfma_f32_16x16x32_bf16 v[68:71], a[252:255], v[56:59], v[68:71]
    v_mfma_f32_16x16x32_bf16 v[72:75], a[248:251], v[60:63], v[72:75]
    ds_read_b128 v[52:55], v14 offset:4352
    v_mfma_f32_16x16x32_bf16 v[76:79], a[252:255], v[60:63], v[76:79]
    s_waitcnt lgkmcnt(4)
    v_mfma_f32_16x16x32_bf16 v[80:83], a[0:3], v[32:35], 0
    ds_read_b128 v[56:59], v14 offset:6144
    v_mfma_f32_16x16x32_bf16 v[84:87], a[4:7], v[32:35], 0
    v_mfma_f32_16x16x32_bf16 v[88:91], a[0:3], v[36:39], 0
    ds_read_b128 v[60:63], v14 offset:6400
    s_add_u32 m0, s34, 16384
    s_add_u32 s32, s35, 16384
    v_mfma_f32_16x16x32_bf16 v[92:95], a[4:7], v[36:39], 0
    buffer_load_dwordx4 v8, s[12:15], s32 offen sc1 lds
    s_waitcnt lgkmcnt(4)
    v_mfma_f32_16x16x32_bf16 v[80:83], a[8:11], v[40:43], v[80:83]
    ds_read_b128 v[32:35], v14 offset:8192
    v_mfma_f32_16x16x32_bf16 v[84:87], a[12:15], v[40:43], v[84:87]
    v_mfma_f32_16x16x32_bf16 v[88:91], a[8:11], v[44:47], v[88:91]
    ds_read_b128 v[36:39], v14 offset:8448
    v_mfma_f32_16x16x32_bf16 v[92:95], a[12:15], v[44:47], v[92:95]
    s_waitcnt lgkmcnt(4)
    v_mfma_f32_16x16x32_bf16 v[80:83], a[16:19], v[48:51], v[80:83]
    ds_read_b128 v[40:43], v14 offset:10240
    v_mfma_f32_16x16x32_bf16 v[84:87], a[20:23], v[48:51], v[84:87]
    v_cvt_pk_bf16_f32 v96, v64, v65
    v_mfma_f32_16x16x32_bf16 v[88:91], a[16:19], v[52:55], v[88:91]
    ds_read_b128 v[44:47], v14 offset:10496
    s_add_u32 m0, s34, 20480
    s_add_u32 s32, s35, 20480
    v_mfma_f32_16x16x32_bf16 v[92:95], a[20:23], v[52:55], v[92:95]
    buffer_load_dwordx4 v8, s[12:15], s32 offen sc1 lds
    v_cvt_pk_bf16_f32 v97, v66, v67
    s_waitcnt lgkmcnt(4)
    v_mfma_f32_16x16x32_bf16 v[80:83], a[24:27], v[56:59], v[80:83]
    ds_read_b128 v[48:51], v14 offset:12288
    v_mfma_f32_16x16x32_bf16 v[84:87], a[28:31], v[56:59], v[84:87]
    v_cvt_pk_bf16_f32 v98, v68, v69
    v_mfma_f32_16x16x32_bf16 v[88:91], a[24:27], v[60:63], v[88:91]
    ds_read_b128 v[52:55], v14 offset:12544
    v_mfma_f32_16x16x32_bf16 v[92:95], a[28:31], v[60:63], v[92:95]
    v_cvt_pk_bf16_f32 v99, v70, v71
    s_waitcnt lgkmcnt(4)
    v_mfma_f32_16x16x32_bf16 v[80:83], a[32:35], v[32:35], v[80:83]
    ds_read_b128 v[56:59], v14 offset:14336
    v_mfma_f32_16x16x32_bf16 v[84:87], a[36:39], v[32:35], v[84:87]
    v_cvt_pk_bf16_f32 v100, v72, v73
    v_mfma_f32_16x16x32_bf16 v[88:91], a[32:35], v[36:39], v[88:91]
    ds_read_b128 v[60:63], v14 offset:14592
    s_add_u32 m0, s34, 24576
    s_add_u32 s32, s35, 24576
    v_mfma_f32_16x16x32_bf16 v[92:95], a[36:39], v[36:39], v[92:95]
    buffer_load_dwordx4 v8, s[12:15], s32 offen sc1 lds
    v_cvt_pk_bf16_f32 v101, v74, v75
    s_waitcnt lgkmcnt(4)
    v_mfma_f32_16x16x32_bf16 v[80:83], a[40:43], v[40:43], v[80:83]
    ds_read_b128 v[32:35], v14 offset:16384
    v_mfma_f32_16x16x32_bf16 v[84:87], a[44:47], v[40:43], v[84:87]
    v_cvt_pk_bf16_f32 v102, v76, v77
    v_mfma_f32_16x16x32_bf16 v[88:91], a[40:43], v[44:47], v[88:91]
    ds_read_b128 v[36:39], v14 offset:16640
    v_mfma_f32_16x16x32_bf16 v[92:95], a[44:47], v[44:47], v[92:95]
    v_cvt_pk_bf16_f32 v103, v78, v79
    buffer_store_dwordx4 v[96:99], v9, s[20:23], s36 offen
    s_add_u32 s31, s36, 65536
    s_waitcnt lgkmcnt(4)
    v_mfma_f32_16x16x32_bf16 v[80:83], a[48:51], v[48:51], v[80:83]
    ds_read_b128 v[40:43], v14 offset:18432
    v_mfma_f32_16x16x32_bf16 v[84:87], a[52:55], v[48:51], v[84:87]
    v_mfma_f32_16x16x32_bf16 v[88:91], a[48:51], v[52:55], v[88:91]
    ds_read_b128 v[44:47], v14 offset:18688
    s_add_u32 m0, s34, 28672
    s_add_u32 s32, s35, 28672
    v_mfma_f32_16x16x32_bf16 v[92:95], a[52:55], v[52:55], v[92:95]
    buffer_load_dwordx4 v8, s[12:15], s32 offen sc1 lds
    s_waitcnt lgkmcnt(4)
    v_mfma_f32_16x16x32_bf16 v[80:83], a[56:59], v[56:59], v[80:83]
    ds_read_b128 v[48:51], v14 offset:20480
    v_mfma_f32_16x16x32_bf16 v[84:87], a[60:63], v[56:59], v[84:87]
    v_mfma_f32_16x16x32_bf16 v[88:91], a[56:59], v[60:63], v[88:91]
    ds_read_b128 v[52:55], v14 offset:20736
    v_mfma_f32_16x16x32_bf16 v[92:95], a[60:63], v[60:63], v[92:95]
    buffer_store_dwordx4 v[100:103], v9, s[20:23], s31 offen
    s_add_u32 s36, s36, s37
    s_waitcnt vmcnt(8)
    s_barrier
    s_waitcnt lgkmcnt(4)
    v_mfma_f32_16x16x32_bf16 v[80:83], a[64:67], v[32:35], v[80:83]
    ds_read_b128 v[56:59], v14 offset:22528
    v_mfma_f32_16x16x32_bf16 v[84:87], a[68:71], v[32:35], v[84:87]
    v_mfma_f32_16x16x32_bf16 v[88:91], a[64:67], v[36:39], v[88:91]
    ds_read_b128 v[60:63], v14 offset:22784
    s_add_u32 m0, s34, 32768
    s_add_u32 s32, s35, 32768
    v_mfma_f32_16x16x32_bf16 v[92:95], a[68:71], v[36:39], v[92:95]
    buffer_load_dwordx4 v8, s[12:15], s32 offen sc1 lds
    s_waitcnt lgkmcnt(4)
    v_mfma_f32_16x16x32_bf16 v[80:83], a[72:75], v[40:43], v[80:83]
    ds_read_b128 v[32:35], v14 offset:24576
    v_mfma_f32_16x16x32_bf16 v[84:87], a[76:79], v[40:43], v[84:87]
    v_mfma_f32_16x16x32_bf16 v[88:91], a[72:75], v[44:47], v[88:91]
    ds_read_b128 v[36:39], v14 offset:24832
    v_mfma_f32_16x16x32_bf16 v[92:95], a[76:79], v[44:47], v[92:95]
    s_waitcnt lgkmcnt(4)
    v_mfma_f32_16x16x32_bf16 v[80:83], a[80:83], v[48:51], v[80:83]
    ds_read_b128 v[40:43], v14 offset:26624
    v_mfma_f32_16x16x32_bf16 v[84:87], a[84:87], v[48:51], v[84:87]
    v_mfma_f32_16x16x32_bf16 v[88:91], a[80:83], v[52:55], v[88:91]
    ds_read_b128 v[44:47], v14 offset:26880
    s_add_u32 m0, s34, 36864
    s_add_u32 s32, s35, 36864
    v_mfma_f32_16x16x32_bf16 v[92:95], a[84:87], v[52:55], v[92:95]
    buffer_load_dwordx4 v8, s[12:15], s32 offen sc1 lds
    s_waitcnt lgkmcnt(4)
    v_mfma_f32_16x16x32_bf16 v[80:83], a[88:91], v[56:59], v[80:83]
    ds_read_b128 v[48:51], v14 offset:28672
    v_mfma_f32_16x16x32_bf16 v[84:87], a[92:95], v[56:59], v[84:87]
    v_mfma_f32_16x16x32_bf16 v[88:91], a[88:91], v[60:63], v[88:91]
    ds_read_b128 v[52:55], v14 offset:28928
    v_mfma_f32_16x16x32_bf16 v[92:95], a[92:95], v[60:63], v[92:95]
    s_waitcnt lgkmcnt(4)
    v_mfma_f32_16x16x32_bf16 v[80:83], a[96:99], v[32:35], v[80:83]
    ds_read_b128 v[56:59], v14 offset:30720
    v_mfma_f32_16x16x32_bf16 v[84:87], a[100:103], v[32:35], v[84:87]
    v_mfma_f32_16x16x32_bf16 v[88:91], a[96:99], v[36:39], v[88:91]
    ds_read_b128 v[60:63], v14 offset:30976
    s_add_u32 m0, s34, 40960
    s_add_u32 s32, s35, 40960
    v_mfma_f32_16x16x32_bf16 v[92:95], a[100:103], v[36:39], v[92:95]
    buffer_load_dwordx4 v8, s[12:15], s32 offen sc1 lds
    s_waitcnt lgkmcnt(4)
    v_mfma_f32_16x16x32_bf16 v[80:83], a[104:107], v[40:43], v[80:83]
    ds_read_b128 v[32:35], v14 offset:32768
    v_mfma_f32_16x16x32_bf16 v[84:87], a[108:111], v[40:43], v[84:87]
    v_mfma_f32_16x16x32_bf16 v[88:91], a[104:107], v[44:47], v[88:91]
    ds_read_b128 v[36:39], v14 offset:33024
    v_mfma_f32_16x16x32_bf16 v[92:95], a[108:111], v[44:47], v[92:95]
    s_waitcnt lgkmcnt(4)
    v_mfma_f32_16x16x32_bf16 v[80:83], a[112:115], v[48:51], v[80:83]
    ds_read_b128 v[40:43], v14 offset:34816
    v_mfma_f32_16x16x32_bf16 v[84:87], a[116:119], v[48:51], v[84:87]
    v_mfma_f32_16x16x32_bf16 v[88:91], a[112:115], v[52:55], v[88:91]
    ds_read_b128 v[44:47], v14 offset:35072
    s_add_u32 m0, s34, 45056
    s_add_u32 s32, s35, 45056
    v_mfma_f32_16x16x32_bf16 v[92:95], a[116:119], v[52:55], v[92:95]
    buffer_load_dwordx4 v8, s[12:15], s32 offen sc1 lds
    s_waitcnt lgkmcnt(4)
    v_mfma_f32_16x16x32_bf16 v[80:83], a[120:123], v[56:59], v[80:83]
    ds_read_b128 v[48:51], v14 offset:36864
    v_mfma_f32_16x16x32_bf16 v[84:87], a[124:127], v[56:59], v[84:87]
    v_mfma_f32_16x16x32_bf16 v[88:91], a[120:123], v[60:63], v[88:91]
    ds_read_b128 v[52:55], v14 offset:37120
    v_mfma_f32_16x16x32_bf16 v[92:95], a[124:127], v[60:63], v[92:95]
    s_waitcnt lgkmcnt(4)
    v_mfma_f32_16x16x32_bf16 v[80:83], a[128:131], v[32:35], v[80:83]
    ds_read_b128 v[56:59], v14 offset:38912
    v_mfma_f32_16x16x32_bf16 v[84:87], a[132:135], v[32:35], v[84:87]
    v_mfma_f32_16x16x32_bf16 v[88:91], a[128:131], v[36:39], v[88:91]
    ds_read_b128 v[60:63], v14 offset:39168
    s_add_u32 m0, s34, 49152
    s_add_u32 s32, s35, 49152
    v_mfma_f32_16x16x32_bf16 v[92:95], a[132:135], v[36:39], v[92:95]
    buffer_load_dwordx4 v8, s[12:15], s32 offen sc1 lds
    s_waitcnt lgkmcnt(4)
    v_mfma_f32_16x16x32_bf16 v[80:83], a[136:139], v[40:43], v[80:83]
    ds_read_b128 v[32:35], v14 offset:40960
    v_mfma_f32_16x16x32_bf16 v[84:87], a[140:143], v[40:43], v[84:87]
    v_mfma_f32_16x16x32_bf16 v[88:91], a[136:139], v[44:47], v[88:91]
    ds_read_b128 v[36:39], v14 offset:41216
    v_mfma_f32_16x16x32_bf16 v[92:95], a[140:143], v[44:47], v[92:95]
    s_waitcnt lgkmcnt(4)
    v_mfma_f32_16x16x32_bf16 v[80:83], a[144:147], v[48:51], v[80:83]
    ds_read_b128 v[40:43], v14 offset:43008
    v_mfma_f32_16x16x32_bf16 v[84:87], a[148:151], v[48:51], v[84:87]
    v_mfma_f32_16x16x32_bf16 v[88:91], a[144:147], v[52:55], v[88:91]
    ds_read_b128 v[44:47], v14 offset:43264
    s_add_u32 m0, s34, 53248
    s_add_u32 s32, s35, 53248
    v_mfma_f32_16x16x32_bf16 v[92:95], a[148:151], v[52:55], v[92:95]
    buffer_load_dwordx4 v8, s[12:15], s32 offen sc1 lds
    s_waitcnt lgkmcnt(4)
    v_mfma_f32_16x16x32_bf16 v[80:83], a[152:155], v[56:59], v[80:83]
    ds_read_b128 v[48:51], v14 offset:45056
    v_mfma_f32_16x16x32_bf16 v[84:87], a[156:159], v[56:59], v[84:87]
    v_mfma_f32_16x16x32_bf16 v[88:91], a[152:155], v[60:63], v[88:91]
    ds_read_b128 v[52:55], v14 offset:45312
    v_mfma_f32_16x16x32_bf16 v[92:95], a[156:159], v[60:63], v[92:95]
    s_waitcnt lgkmcnt(4)
    v_mfma_f32_16x16x32_bf16 v[80:83], a[160:163], v[32:35], v[80:83]
    ds_read_b128 v[56:59], v14 offset:47104
    v_mfma_f32_16x16x32_bf16 v[84:87], a[164:167], v[32:35], v[84:87]
    v_mfma_f32_16x16x32_bf16 v[88:91], a[160:163], v[36:39], v[88:91]
    ds_read_b128 v[60:63], v14 offset:47360
    s_add_u32 m0, s34, 57344
    s_add_u32 s32, s35, 57344
    v_mfma_f32_16x16x32_bf16 v[92:95], a[164:167], v[36:39], v[92:95]
    buffer_load_dwordx4 v8, s[12:15], s32 offen sc1 lds
    s_waitcnt lgkmcnt(4)
    v_mfma_f32_16x16x32_bf16 v[80:83], a[168:171], v[40:43], v[80:83]
    ds_read_b128 v[32:35], v14 offset:49152
    v_mfma_f32_16x16x32_bf16 v[84:87], a[172:175], v[40:43], v[84:87]
    v_mfma_f32_16x16x32_bf16 v[88:91], a[168:171], v[44:47], v[88:91]
    ds_read_b128 v[36:39], v14 offset:49408
    v_mfma_f32_16x16x32_bf16 v[92:95], a[172:175], v[44:47], v[92:95]
    s_waitcnt lgkmcnt(4)
    v_mfma_f32_16x16x32_bf16 v[80:83], a[176:179], v[48:51], v[80:83]
    ds_read_b128 v[40:43], v14 offset:51200
    v_mfma_f32_16x16x32_bf16 v[84:87], a[180:183], v[48:51], v[84:87]
    v_mfma_f32_16x16x32_bf16 v[88:91], a[176:179], v[52:55], v[88:91]
    ds_read_b128 v[44:47], v14 offset:51456
    s_add_u32 m0, s34, 61440
    s_add_u32 s32, s35, 61440
    v_mfma_f32_16x16x32_bf16 v[92:95], a[180:183], v[52:55], v[92:95]
    buffer_load_dwordx4 v8, s[12:15], s32 offen sc1 lds
    s_add_u32 s35, s35, 65536
    s_min_u32 s35, s35, s52
    s_waitcnt lgkmcnt(4)
    v_mfma_f32_16x16x32_bf16 v[80:83], a[184:187], v[56:59], v[80:83]
    ds_read_b128 v[48:51], v14 offset:53248
    v_mfma_f32_16x16x32_bf16 v[84:87], a[188:191], v[56:59], v[84:87]
    v_mfma_f32_16x16x32_bf16 v[88:91], a[184:187], v[60:63], v[88:91]
    ds_read_b128 v[52:55], v14 offset:53504
    v_mfma_f32_16x16x32_bf16 v[92:95], a[188:191], v[60:63], v[92:95]
    s_waitcnt vmcnt(8)
    s_barrier
    s_waitcnt lgkmcnt(4)
    v_mfma_f32_16x16x32_bf16 v[80:83], a[192:195], v[32:35], v[80:83]
    ds_read_b128 v[56:59], v14 offset:55296
    v_mfma_f32_16x16x32_bf16 v[84:87], a[196:199], v[32:35], v[84:87]
    v_mfma_f32_16x16x32_bf16 v[88:91], a[192:195], v[36:39], v[88:91]
    ds_read_b128 v[60:63], v14 offset:55552
    s_add_u32 m0, s34, 65536
    s_add_u32 s32, s35, 0
    v_mfma_f32_16x16x32_bf16 v[92:95], a[196:199], v[36:39], v[92:95]
    buffer_load_dwordx4 v8, s[12:15], s32 offen sc1 lds
    s_waitcnt lgkmcnt(4)
    v_mfma_f32_16x16x32_bf16 v[80:83], a[200:203], v[40:43], v[80:83]
    ds_read_b128 v[32:35], v14 offset:57344
    v_mfma_f32_16x16x32_bf16 v[84:87], a[204:207], v[40:43], v[84:87]
    v_mfma_f32_16x16x32_bf16 v[88:91], a[200:203], v[44:47], v[88:91]
    ds_read_b128 v[36:39], v14 offset:57600
    v_mfma_f32_16x16x32_bf16 v[92:95], a[204:207], v[44:47], v[92:95]
    s_waitcnt lgkmcnt(4)
    v_mfma_f32_16x16x32_bf16 v[80:83], a[208:211], v[48:51], v[80:83]
    ds_read_b128 v[40:43], v14 offset:59392
    v_mfma_f32_16x16x32_bf16 v[84:87], a[212:215], v[48:51], v[84:87]
    v_mfma_f32_16x16x32_bf16 v[88:91], a[208:211], v[52:55], v[88:91]
    ds_read_b128 v[44:47], v14 offset:59648
    s_add_u32 m0, s34, 69632
    s_add_u32 s32, s35, 4096
    v_mfma_f32_16x16x32_bf16 v[92:95], a[212:215], v[52:55], v[92:95]
    buffer_load_dwordx4 v8, s[12:15], s32 offen sc1 lds
    s_waitcnt lgkmcnt(4)
    v_mfma_f32_16x16x32_bf16 v[80:83], a[216:219], v[56:59], v[80:83]
    ds_read_b128 v[48:51], v14 offset:61440
    v_mfma_f32_16x16x32_bf16 v[84:87], a[220:223], v[56:59], v[84:87]
    v_mfma_f32_16x16x32_bf16 v[88:91], a[216:219], v[60:63], v[88:91]
    ds_read_b128 v[52:55], v14 offset:61696
    v_mfma_f32_16x16x32_bf16 v[92:95], a[220:223], v[60:63], v[92:95]
    s_waitcnt lgkmcnt(4)
    v_mfma_f32_16x16x32_bf16 v[80:83], a[224:227], v[32:35], v[80:83]
    ds_read_b128 v[56:59], v14 offset:63488
    v_mfma_f32_16x16x32_bf16 v[84:87], a[228:231], v[32:35], v[84:87]
    v_mfma_f32_16x16x32_bf16 v[88:91], a[224:227], v[36:39], v[88:91]
    ds_read_b128 v[60:63], v14 offset:63744
    s_add_u32 m0, s34, 73728
    s_add_u32 s32, s35, 8192
    v_mfma_f32_16x16x32_bf16 v[92:95], a[228:231], v[36:39], v[92:95]
    buffer_load_dwordx4 v8, s[12:15], s32 offen sc1 lds
    s_waitcnt lgkmcnt(4)
    v_mfma_f32_16x16x32_bf16 v[80:83], a[232:235], v[40:43], v[80:83]
    ds_read_b128 v[32:35], v12 offset:0
    v_mfma_f32_16x16x32_bf16 v[84:87], a[236:239], v[40:43], v[84:87]
    v_mfma_f32_16x16x32_bf16 v[88:91], a[232:235], v[44:47], v[88:91]
    ds_read_b128 v[36:39], v12 offset:256
    v_mfma_f32_16x16x32_bf16 v[92:95], a[236:239], v[44:47], v[92:95]
    s_waitcnt lgkmcnt(4)
    v_mfma_f32_16x16x32_bf16 v[80:83], a[240:243], v[48:51], v[80:83]
    ds_read_b128 v[40:43], v12 offset:2048
    v_mfma_f32_16x16x32_bf16 v[84:87], a[244:247], v[48:51], v[84:87]
    v_mfma_f32_16x16x32_bf16 v[88:91], a[240:243], v[52:55], v[88:91]
    ds_read_b128 v[44:47], v12 offset:2304
    s_add_u32 m0, s34, 77824
    s_add_u32 s32, s35, 12288
    v_mfma_f32_16x16x32_bf16 v[92:95], a[244:247], v[52:55], v[92:95]
    buffer_load_dwordx4 v8, s[12:15], s32 offen sc1 lds
    s_waitcnt lgkmcnt(4)
    v_mfma_f32_16x16x32_bf16 v[80:83], a[248:251], v[56:59], v[80:83]
    ds_read_b128 v[48:51], v12 offset:4096
    v_mfma_f32_16x16x32_bf16 v[84:87], a[252:255], v[56:59], v[84:87]
    v_mfma_f32_16x16x32_bf16 v[88:91], a[248:251], v[60:63], v[88:91]
    ds_read_b128 v[52:55], v12 offset:4352
    v_mfma_f32_16x16x32_bf16 v[92:95], a[252:255], v[60:63], v[92:95]
    s_add_u32 s30, s30, 2
    s_cmp_lt_u32 s30, s51
    s_cbranch_scc1 sl_loop_95
    v_cvt_pk_bf16_f32 v96, v80, v81
    v_cvt_pk_bf16_f32 v97, v82, v83
    v_cvt_pk_bf16_f32 v98, v84, v85
    v_cvt_pk_bf16_f32 v99, v86, v87
    v_cvt_pk_bf16_f32 v100, v88, v89
    v_cvt_pk_bf16_f32 v101, v90, v91
    v_cvt_pk_bf16_f32 v102, v92, v93
    v_cvt_pk_bf16_f32 v103, v94, v95
    s_branch sl_e_94
sl_e_94:
    buffer_store_dwordx4 v[96:99], v9, s[20:23], s36 offen
    s_add_u32 s31, s36, 65536
    buffer_store_dwordx4 v[100:103], v9, s[20:23], s31 offen
    s_add_u32 s36, s36, s37
    s_waitcnt vmcnt(0) lgkmcnt(0)
    s_barrier
    s_branch L_dump
L_dump:
L_end:
    s_endpgm
.section .rodata,"a"
.p2align 6
.amdhsa_kernel concat_heads__memory_aug_recurrent_mem_tr__sliding_local_dilated__prompt_kernel
  .amdhsa_next_free_vgpr 512
  .amdhsa_next_free_sgpr 102
  .amdhsa_accum_offset 256
  .amdhsa_group_segment_fixed_size 0
  .amdhsa_kernarg_size 104
  .amdhsa_user_sgpr_count 2
  .amdhsa_user_sgpr_kernarg_segment_ptr 1
  .amdhsa_system_sgpr_workgroup_id_x 1
.end_amdhsa_kernel
```

```asm
; @launch grid=(256,1,1) block=(256,1,1) lds=163840
.amdgcn_target "amdgcn-amd-amdhsa--gfx950"
.text
.globl concat_heads__memory_aug_recurrent_mem_tr__sliding_local_dilated__prompt_kernel
.p2align 8
.type concat_heads__memory_aug_recurrent_mem_tr__sliding_local_dilated__prompt_kernel,@function
concat_heads__memory_aug_recurrent_mem_tr__sliding_local_dilated__prompt_kernel:
    s_cmp_ge_u32 s2, 256
    s_cbranch_scc1 L_end
    s_getreg_b32 s6, hwreg(HW_REG_XCC_ID)
    s_sub_u32 s6, s6, s2
    s_and_b32 s6, s6, 7
    s_or_b32 s70, s6, 8
    s_mov_b32 s71, 0
    s_cmp_lg_u32 s2, 0
    s_cbranch_scc1 L_role
    s_load_dwordx2 s[4:5], s[0:1], 88
    v_mov_b32 v1, 0
    v_mov_b32 v2, s70
    s_waitcnt lgkmcnt(0)
    s_mov_b64 exec, 1
    global_store_dword v1, v2, s[4:5] offset:192 sc1
    s_mov_b64 exec, -1
L_role:
    s_add_u32 s7, s2, s70
    s_and_b32 s3, s7, 3
    s_lshl_b32 s3, s3, 5
    s_lshr_b32 s28, s2, 3
    s_add_u32 s28, s28, s3
    s_bitcmp1_b32 s7, 2
    s_cbranch_scc1 L_gem
L_rec:
    s_mov_b32 s6, L_gem - L_rec - 16
    s_load_dwordx2 s[72:73], s[0:1], 8
    s_load_dwordx4 s[76:79], s[0:1], 16
    s_load_dwordx4 s[80:83], s[0:1], 32
    s_load_dwordx2 s[90:91], s[0:1], 96
    s_load_dwordx2 s[92:93], s[0:1], 88
    v_and_b32 v1, 63, v0
    v_lshrrev_b32 v2, 6, v0
    s_nop 0
    v_readfirstlane_b32 s31, v2
    s_lshr_b32 s29, s28, 2
    s_and_b32 s30, s28, 3
    s_mov_b32 s41, 0
    s_waitcnt lgkmcnt(0)
    s_mov_b32 s24, s72
    s_and_b32 s25, s73, 0xffff
    s_mov_b32 s26, 16384
    s_mov_b32 s27, 0x00020000
    s_mov_b32 s8, s76
    s_and_b32 s9, s77, 0xffff
    s_mov_b32 s10, 8388608
    s_mov_b32 s11, 0x00020000
    s_mov_b32 s12, s78
    s_and_b32 s13, s79, 0xffff
    s_mov_b32 s14, 8388608
    s_mov_b32 s15, 0x00020000
    s_mov_b32 s16, s80
    s_and_b32 s17, s81, 0xffff
    s_mov_b32 s18, 8388608
    s_mov_b32 s19, 0x00020000
    s_mov_b32 s20, s82
    s_and_b32 s21, s83, 0xffff
    s_mov_b32 s22, 8388608
    s_mov_b32 s23, 0x00020000
    s_mov_b32 s4, s90
    s_and_b32 s5, s91, 0xffff
    s_mov_b32 s6, 268435456
    s_mov_b32 s7, 0x00020000
    s_sub_u32 s49, 0, s90
    s_and_b32 s49, s49, 2097151
    s_add_u32 s49, s49, 117440512
    s_mov_b32 s48, 1
    s_cmp_lg_u32 s31, 3
    s_cbranch_scc1 rec_cal_1
    s_and_b32 s38, s28, 7
    s_lshl_b32 s38, s38, 21
    s_lshr_b32 s40, s28, 3
    s_and_b32 s40, s40, 1
    s_lshl_b32 s40, s40, 13
    s_add_u32 s38, s38, s40
    s_lshr_b32 s40, s28, 4
    s_and_b32 s40, s40, 7
    s_lshl_b32 s40, s40, 8
    s_add_u32 s38, s38, s40
    s_add_u32 s38, s38, s49
    s_add_u32 s38, s38, 245760
    s_lshr_b32 s39, s28, 3
    s_and_b32 s39, s39, 1
    s_lshl_b32 s39, s39, 14
    s_sub_u32 s39, s38, s39
    s_add_u32 s39, s39, 8192
    s_load_dword s80, s[90:91], s38 glc
    s_load_dword s81, s[90:91], s39 glc
    s_waitcnt lgkmcnt(0)
    s_memtime s[76:77]
    s_waitcnt lgkmcnt(0)
    s_load_dword s80, s[90:91], s38 glc
    s_waitcnt lgkmcnt(0)
    s_memtime s[78:79]
    s_waitcnt lgkmcnt(0)
    s_sub_u32 s72, s78, s76
    s_waitcnt lgkmcnt(0)
    s_memtime s[76:77]
    s_waitcnt lgkmcnt(0)
    s_load_dword s80, s[90:91], s39 glc
    s_waitcnt lgkmcnt(0)
    s_memtime s[78:79]
    s_waitcnt lgkmcnt(0)
    s_sub_u32 s73, s78, s76
    s_cmp_lt_u32 s73, s72
    s_cselect_b32 s38, 1, 0
    s_lshr_b32 s39, s28, 3
    s_xor_b32 s38, s38, s39
    s_xor_b32 s38, s38, s28
    s_and_b32 s48, s38, 1
    s_lshl_b32 s48, s48, 10
    s_add_u32 s48, s48, 1
rec_cal_1:
    s_lshl_b32 s38, s31, 21
    s_lshl_b32 s40, s28, 6
    s_add_u32 s38, s38, s40
    v_lshrrev_b32 v184, 2, v1
    v_lshlrev_b32 v184, 13, v184
    v_and_b32 v4, 3, v1
    v_lshl_add_u32 v184, v4, 4, v184
    v_add_u32 v184, s38, v184
    s_lshl_b32 s38, s31, 21
    s_lshr_b32 s40, s28, 1
    s_lshl_b32 s40, s40, 5
    s_add_u32 s38, s38, s40
    v_lshrrev_b32 v185, 1, v1
    v_lshlrev_b32 v185, 11, v185
    v_and_b32 v4, 1, v1
    v_lshl_add_u32 v185, v4, 4, v185
    v_add_u32 v185, s38, v185
    s_lshl_b32 s33, s31, 15
    v_lshrrev_b32 v186, 4, v1
    v_lshlrev_b32 v186, 9, v186
    v_bfe_u32 v4, v1, 2, 2
    v_lshl_add_u32 v186, v4, 6, v186
    v_and_b32 v4, 3, v1
    v_lshl_add_u32 v186, v4, 3, v186
    v_add_u32 v186, s33, v186
    v_lshrrev_b32 v187, 4, v1
    v_lshlrev_b32 v187, 8, v187
    v_bfe_u32 v4, v1, 2, 2
    v_lshl_add_u32 v187, v4, 5, v187
    v_and_b32 v4, 3, v1
    v_lshl_add_u32 v187, v4, 3, v187
    v_add_u32 v187, s33, v187
    s_add_u32 m0, s33, 0
    s_mov_b32 s38, 0
    buffer_load_dwordx4 v184, s[8:11], s38 offen lds
    s_add_u32 m0, s33, 1024
    s_mov_b32 s38, 131072
    buffer_load_dwordx4 v184, s[8:11], s38 offen lds
    s_add_u32 m0, s33, 2048
    s_mov_b32 s38, 0
    buffer_load_dwordx4 v184, s[12:15], s38 offen lds
    s_add_u32 m0, s33, 3072
    s_mov_b32 s38, 131072
    buffer_load_dwordx4 v184, s[12:15], s38 offen lds
    s_add_u32 m0, s33, 4096
    s_mov_b32 s38, 0
    buffer_load_dwordx4 v184, s[16:19], s38 offen lds
    s_add_u32 m0, s33, 5120
    s_mov_b32 s38, 131072
    buffer_load_dwordx4 v184, s[16:19], s38 offen lds
    s_add_u32 m0, s33, 6144
    s_mov_b32 s38, 262144
    buffer_load_dwordx4 v184, s[8:11], s38 offen lds
    s_add_u32 m0, s33, 7168
    s_mov_b32 s38, 393216
    buffer_load_dwordx4 v184, s[8:11], s38 offen lds
    s_add_u32 m0, s33, 8192
    s_mov_b32 s38, 262144
    buffer_load_dwordx4 v184, s[12:15], s38 offen lds
    s_add_u32 m0, s33, 9216
    s_mov_b32 s38, 393216
    buffer_load_dwordx4 v184, s[12:15], s38 offen lds
    s_add_u32 m0, s33, 10240
    s_mov_b32 s38, 262144
    buffer_load_dwordx4 v184, s[16:19], s38 offen lds
    s_add_u32 m0, s33, 11264
    s_mov_b32 s38, 393216
    buffer_load_dwordx4 v184, s[16:19], s38 offen lds
    v_bfe_u32 v2, v1, 1, 1
    v_mov_b32 v3, 0xaaaa
    v_mul_u32_u24 v2, v2, v3
    v_add_u32 v5, 0x4444, v2
    v_lshlrev_b32 v16, 4, v1
    s_lshr_b32 s38, s28, 6
    s_lshl_b32 s38, s38, 14
    s_and_b32 s40, s28, 63
    s_lshl_b32 s40, s40, 7
    s_add_u32 s38, s38, s40
    s_add_u32 s38, s38, 131072
    v_lshl_add_u32 v6, v1, 2, s38
    s_lshr_b32 s38, s31, 1
    s_lshl_b32 s38, s38, 14
    s_and_b32 s40, s31, 1
    s_lshl_b32 s40, s40, 12
    s_add_u32 s38, s38, s40
    s_add_u32 s38, s38, 131072
    v_add_u32 v7, s38, v16
    s_and_b32 s38, s28, 1
    s_lshl_b32 s38, s38, 16
    s_lshl_b32 s40, s31, 14
    s_add_u32 s38, s38, s40
    v_add_u32 v12, s38, v16
    v_add_u32 v13, 4096, v12
    v_lshrrev_b32 v2, 4, v1
    v_mul_u32_u24 v2, 320, v2
    v_and_b32 v3, 15, v1
    v_lshl_add_u32 v2, v3, 2, v2
    s_mul_i32 s38, s31, 2560
    v_add_u32 v14, s38, v2
    v_add_u32 v15, 1280, v14
    s_lshl_b32 s38, s31, 10
    s_add_u32 s38, s38, 10240
    v_add_u32 v17, s38, v16
    v_and_b32 v2, 3, v1
    v_lshlrev_b32 v2, 1, v2
    v_bfe_u32 v4, v1, 2, 1
    v_lshl_add_u32 v2, v4, 0, v2
    v_add_u32 v2, 8, v2
    v_and_b32 v3, 15, v1
    v_cmp_gt_u32 vcc, 8, v3
    s_nop 1
    v_cndmask_b32 v3, v2, v3, vcc
    v_mul_u32_u24 v3, 160, v3
    v_lshrrev_b32 v2, 5, v1
    v_lshlrev_b32 v2, 6, v2
    v_bfe_u32 v4, v1, 4, 1
    v_lshl_add_u32 v2, v4, 4, v2
    v_add_u32 v18, v2, v3
    s_lshl_b32 s38, s28, 11
    v_add_u32 v19, s38, v16
    v_bfe_u32 v20, v1, 4, 1
    v_lshlrev_b32 v20, 7, v20
    v_and_b32 v4, 7, v1
    v_lshl_add_u32 v20, v4, 4, v20
    v_add_u32 v20, s38, v20
    s_add_u32 s39, s30, 1
    s_and_b32 s38, s39, 3
    s_lshl_b32 s38, s38, 11
    s_lshl_b32 s40, s29, 13
    s_add_u32 s38, s38, s40
    v_add_u32 v22, s38, v16
    s_add_u32 s39, s30, 2
    s_and_b32 s38, s39, 3
    s_lshl_b32 s38, s38, 11
    s_lshl_b32 s40, s29, 13
    s_add_u32 s38, s38, s40
    v_add_u32 v23, s38, v16
    s_add_u32 s39, s30, 3
    s_and_b32 s38, s39, 3
    s_lshl_b32 s38, s38, 11
    s_lshl_b32 s40, s29, 13
    s_add_u32 s38, s38, s40
    v_add_u32 v24, s38, v16
    s_lshl_b32 s38, s29, 13
    v_lshrrev_b32 v21, 4, v1
    v_lshlrev_b32 v21, 11, v21
    v_and_b32 v4, 15, v1
    v_lshl_add_u32 v21, v4, 4, v21
    v_add_u32 v21, s38, v21
    v_lshrrev_b32 v25, 4, v1
    v_lshlrev_b32 v25, 8, v25
    v_bfe_u32 v4, v1, 3, 1
    v_lshl_add_u32 v25, v4, 3, v25
    v_bfe_u32 v4, v1, 1, 1
    v_lshl_add_u32 v25, v4, 6, v25
    v_bfe_u32 v4, v1, 2, 1
    v_lshl_add_u32 v25, v4, 5, v25
    v_and_b32 v4, 1, v1
    v_lshl_add_u32 v25, v4, 4, v25
    v_add_u32 v25, 10240, v25
    s_lshl_b32 s38, s28, 11
    s_and_b32 s40, s31, 1
    s_lshl_b32 s40, s40, 7
    s_add_u32 s38, s38, s40
    s_add_u32 s38, s38, 16777216
    v_bfe_u32 v2, v1, 3, 1
    v_lshlrev_b32 v2, 8, v2
    v_and_b32 v4, 7, v1
    v_lshl_add_u32 v2, v4, 4, v2
    v_bfe_u32 v4, v1, 4, 1
    v_lshl_add_u32 v2, v4, 9, v2
    v_lshrrev_b32 v4, 5, v1
    v_lshl_add_u32 v2, v4, 10, v2
    v_add_u32 v2, s38, v2
    s_add_u32 s38, s38, 16777216
    v_bfe_u32 v3, v1, 3, 1
    v_lshlrev_b32 v3, 8, v3
    v_bfe_u32 v4, v1, 1, 1
    v_lshl_add_u32 v3, v4, 6, v3
    v_bfe_u32 v4, v1, 2, 1
    v_lshl_add_u32 v3, v4, 5, v3
    v_and_b32 v4, 1, v1
    v_lshl_add_u32 v3, v4, 4, v3
    v_bfe_u32 v4, v1, 4, 1
    v_lshl_add_u32 v3, v4, 9, v3
    v_lshrrev_b32 v4, 5, v1
    v_lshl_add_u32 v3, v4, 10, v3
    v_add_u32 v3, s38, v3
    s_cmp_lt_u32 s31, 2
    s_cselect_b64 vcc, -1, 0
    v_cndmask_b32 v30, v3, v2, vcc
    s_lshl_b32 s3, s31, 10
    s_lshr_b32 s38, s29, 3
    s_lshl_b32 s38, s38, 14
    s_and_b32 s40, s29, 7
    s_lshl_b32 s40, s40, 10
    s_add_u32 s38, s38, s40
    s_and_b32 s40, s30, 1
    s_lshl_b32 s40, s40, 9
    s_add_u32 s38, s38, s40
    s_lshr_b32 s40, s30, 1
    s_lshl_b32 s40, s40, 7
    s_add_u32 s38, s38, s40
    v_bfe_u32 v27, v1, 2, 1
    v_lshlrev_b32 v27, 16, v27
    v_lshrrev_b32 v4, 5, v1
    v_lshl_add_u32 v27, v4, 8, v27
    v_bfe_u32 v4, v1, 1, 1
    v_lshl_add_u32 v27, v4, 6, v27
    v_bfe_u32 v4, v1, 4, 1
    v_lshl_add_u32 v27, v4, 5, v27
    v_and_b32 v4, 1, v1
    v_lshl_add_u32 v27, v4, 4, v27
    v_add_u32 v27, s38, v27
    s_lshr_b32 s39, s31, 1
    s_lshl_b32 s39, s39, 16
    s_and_b32 s40, s31, 1
    s_lshl_b32 s40, s40, 8
    s_add_u32 s39, s39, s40
    s_add_u32 s39, s39, s38
    v_add_u32 v95, s39, v16
    v_cmp_gt_u32 vcc, 8, v1
    v_mov_b32 v4, 2130706432
    s_nop 0
    v_cndmask_b32 v95, v4, v95, vcc
    s_lshl_b32 s38, s31, 8
    s_add_u32 s38, s38, 14336
    v_lshl_add_u32 v28, v1, 2, s38
    v_bfe_u32 v29, v1, 2, 1
    v_lshlrev_b32 v29, 7, v29
    v_bfe_u32 v4, v1, 4, 1
    v_lshl_add_u32 v29, v4, 6, v29
    v_and_b32 v4, 3, v1
    v_lshl_add_u32 v29, v4, 4, v29
    v_bfe_u32 v4, v1, 3, 1
    v_lshl_add_u32 v29, v4, 3, v29
    v_add_u32 v29, 14336, v29
    s_mul_i32 s39, s31, 320
    s_lshl_b32 s38, s28, 11
    s_add_u32 s38, s38, s39
    v_add_u32 v94, s38, v16
    v_cmp_gt_u32 vcc, 20, v1
    v_mov_b32 v4, 2130706432
    s_nop 0
    v_cndmask_b32 v94, v4, v94, vcc
    s_mul_i32 s38, s31, 3
    v_min_u32 v2, 2, v1
    v_add_u32 v2, s38, v2
    v_min_u32 v2, 9, v2
    s_lshl_b32 s38, s28, 11
    s_add_u32 s38, s38, 262144
    v_lshl_add_u32 v92, v2, 7, s38
    s_lshl_b32 s38, s28, 9
    v_lshrrev_b32 v93, 4, v1
    v_lshlrev_b32 v93, 7, v93
    v_and_b32 v4, 3, v1
    v_lshl_add_u32 v93, v4, 5, v93
    v_bfe_u32 v4, v1, 2, 1
    v_lshl_add_u32 v93, v4, 4, v93
    v_add_u32 v93, s38, v93
    s_mov_b32 vcc_lo, 0xff00ff00
    s_mov_b32 vcc_hi, 0xff00ff00
    s_cmp_eq_u32 s31, 1
    s_cbranch_scc1 rec_ns_2
    s_add_u32 s38, s38, 4194304
    v_add_u32 v93, s38, v16
    s_mov_b32 vcc_lo, -1
    s_mov_b32 vcc_hi, 0
    s_cmp_eq_u32 s31, 2
    s_cbranch_scc1 rec_ns_2
    s_lshr_b32 s38, s28, 6
    s_lshl_b32 s38, s38, 14
    s_and_b32 s40, s28, 63
    s_lshl_b32 s40, s40, 7
    s_add_u32 s38, s38, s40
    s_add_u32 s38, s38, 131072
    v_add_u32 v93, s38, v16
    s_cmp_eq_u32 s31, 3
    s_cselect_b32 vcc_lo, 0xff, 0
rec_ns_2:
    s_nop 0
    v_mov_b32 v4, 2130706432
    v_cndmask_b32 v93, v4, v93, vcc
    v_mov_b32 v32, 0x3f803f80
    v_mov_b32 v33, 0x3f803f80
    v_mov_b32 v34, 0x3f803f80
    v_mov_b32 v35, 0x3f803f80
    v_mov_b32 v8, -1
    v_mov_b32 v9, -1
    v_mov_b32 v10, -1
    v_mov_b32 v11, -1
    v_mov_b32 v144, 0
    v_mov_b32 v145, 0
    v_mov_b32 v146, 0
    v_mov_b32 v147, 0
    v_mov_b32 v180, 0
    v_mov_b32 v181, 0
    v_mov_b32 v182, 0
    v_mov_b32 v183, 0
    v_mov_b32 v161, 0
    v_mov_b32 v162, 0
    v_mov_b32 v163, 0
    v_mov_b32 v138, 0
    v_mov_b32 v139, 0
    v_mov_b32 v140, 0
    v_mov_b32 v141, 0
    v_mov_b32 v142, 0
    v_mov_b32 v143, 0
    s_mov_b32 s42, 0x00ff00ff
    s_mov_b32 s43, 0x00ff00ff
    s_mov_b32 s44, 0
    s_mov_b32 s45, -1
    s_mov_b32 s46, 0
    s_mov_b32 s47, 0x00ff00ff
    s_mov_b32 s50, 0x3e0293ee
    s_mov_b32 s36, 96468992
    s_mov_b32 s37, 0
    s_mov_b32 s32, 0
    s_mov_b32 s51, 16384
    s_mov_b32 s54, 1
    s_min_u32 s38, s31, 1
    s_add_u32 s38, s38, 1
    v_mov_b32 v134, s38
    s_lshl_b32 s95, s29, 7
    s_lshr_b32 s40, s31, 1
    s_lshl_b32 s40, s40, 2
    s_add_u32 s95, s95, s40
    s_add_u32 s95, s95, 115343364
    s_lshl_b32 s97, s29, 7
    s_add_u32 s97, s97, 115351552
    s_lshl_b32 s38, s30, 4
    s_add_u32 s38, s38, s97
    v_mov_b32 v137, s38
    s_cmp_eq_u32 s31, 2
    s_cselect_b64 vcc, 1, 0
    v_mov_b32 v4, 2130706432
    v_cndmask_b32 v137, v4, v137, vcc
    s_mov_b32 s94, 0
    s_add_u32 s38, s49, 0
    buffer_store_dwordx4 v[144:147], v95, s[4:7], s38 offen sc1
    s_add_u32 s38, s49, 262144
    buffer_store_dwordx4 v[144:147], v95, s[4:7], s38 offen sc1
    s_add_u32 s38, s49, 8192
    buffer_store_dwordx4 v[144:147], v95, s[4:7], s38 offen sc1
    s_add_u32 s38, s49, 270336
    buffer_store_dwordx4 v[144:147], v95, s[4:7], s38 offen sc1
    buffer_store_dwordx4 v[8:11], v94, s[4:7], s36 offen sc1
    v_add_u32 v94, 262144, v94
    buffer_store_dwordx4 v[8:11], v94, s[4:7], s36 offen sc1
    v_add_u32 v94, 262144, v94
    buffer_store_dwordx4 v[8:11], v94, s[4:7], s36 offen sc1
    buffer_store_dword v144, v137, s[4:7], 0 offen sc1
    s_cmp_lg_u32 s31, 3
    s_cbranch_scc1 rec_i3_3
    s_add_u32 s38, s49, 262144
    buffer_store_dwordx4 v[144:147], v93, s[4:7], s38 offen sc1
    s_add_u32 s38, s49, 270336
    buffer_store_dwordx4 v[144:147], v93, s[4:7], s38 offen sc1
    s_lshr_b32 s39, s28, 5
    s_lshl_b32 s39, s39, 14
    s_and_b32 s40, s28, 31
    s_lshl_b32 s40, s40, 8
    s_add_u32 s39, s39, s40
    s_add_u32 s39, s39, s49
    s_add_u32 s39, s39, 163840
    s_mov_b64 exec, 0xffff
    s_add_u32 s38, s39, 0
    buffer_store_dwordx4 v[144:147], v16, s[4:7], s38 offen sc1
    s_add_u32 s38, s39, 8192
    buffer_store_dwordx4 v[144:147], v16, s[4:7], s38 offen sc1
    s_mov_b64 exec, -1
rec_i3_3:
    s_lshl_b32 s38, s31, 9
    v_bfe_u32 v2, v1, 2, 2
    v_lshlrev_b32 v2, 12, v2
    v_and_b32 v4, 1, v1
    v_lshl_add_u32 v2, v4, 11, v2
    v_lshrrev_b32 v4, 4, v1
    v_lshl_add_u32 v2, v4, 5, v2
    v_bfe_u32 v4, v1, 1, 1
    v_lshl_add_u32 v2, v4, 2, v2
    v_add_u32 v2, s38, v2
    buffer_load_dword v36, v2, s[24:27], 0 offen offset:0
    buffer_load_dword v37, v2, s[24:27], 0 offen offset:8
    buffer_load_dword v38, v2, s[24:27], 0 offen offset:16
    buffer_load_dword v39, v2, s[24:27], 0 offen offset:24
    buffer_load_dword v40, v2, s[24:27], 0 offen offset:128
    buffer_load_dword v41, v2, s[24:27], 0 offen offset:136
    buffer_load_dword v42, v2, s[24:27], 0 offen offset:144
    buffer_load_dword v43, v2, s[24:27], 0 offen offset:152
    buffer_load_dword v44, v2, s[24:27], 0 offen offset:256
    buffer_load_dword v45, v2, s[24:27], 0 offen offset:264
    buffer_load_dword v46, v2, s[24:27], 0 offen offset:272
    buffer_load_dword v47, v2, s[24:27], 0 offen offset:280
    buffer_load_dword v48, v2, s[24:27], 0 offen offset:384
    buffer_load_dword v49, v2, s[24:27], 0 offen offset:392
    buffer_load_dword v50, v2, s[24:27], 0 offen offset:400
    buffer_load_dword v51, v2, s[24:27], 0 offen offset:408
    s_add_u32 m0, s33, 12288
    s_mov_b32 s38, 524288
    buffer_load_dwordx4 v184, s[8:11], s38 offen lds
    s_add_u32 m0, s33, 13312
    s_mov_b32 s38, 655360
    buffer_load_dwordx4 v184, s[8:11], s38 offen lds
    s_add_u32 m0, s33, 14336
    s_mov_b32 s38, 524288
    buffer_load_dwordx4 v184, s[12:15], s38 offen lds
    s_add_u32 m0, s33, 15360
    s_mov_b32 s38, 655360
    buffer_load_dwordx4 v184, s[12:15], s38 offen lds
    s_add_u32 m0, s33, 16384
    s_mov_b32 s38, 524288
    buffer_load_dwordx4 v184, s[16:19], s38 offen lds
    s_add_u32 m0, s33, 17408
    s_mov_b32 s38, 655360
    buffer_load_dwordx4 v184, s[16:19], s38 offen lds
    s_add_u32 m0, s33, 18432
    s_mov_b32 s38, 786432
    buffer_load_dwordx4 v184, s[8:11], s38 offen lds
    s_add_u32 m0, s33, 19456
    s_mov_b32 s38, 917504
    buffer_load_dwordx4 v184, s[8:11], s38 offen lds
    s_add_u32 m0, s33, 20480
    s_mov_b32 s38, 786432
    buffer_load_dwordx4 v184, s[12:15], s38 offen lds
    s_add_u32 m0, s33, 21504
    s_mov_b32 s38, 917504
    buffer_load_dwordx4 v184, s[12:15], s38 offen lds
    s_add_u32 m0, s33, 22528
    s_mov_b32 s38, 786432
    buffer_load_dwordx4 v184, s[16:19], s38 offen lds
    s_add_u32 m0, s33, 23552
    s_mov_b32 s38, 917504
    buffer_load_dwordx4 v184, s[16:19], s38 offen lds
    s_add_u32 m0, s33, 24576
    s_mov_b32 s38, 1048576
    buffer_load_dwordx4 v184, s[8:11], s38 offen lds
    s_add_u32 m0, s33, 25600
    s_mov_b32 s38, 1179648
    buffer_load_dwordx4 v184, s[8:11], s38 offen lds
    s_add_u32 m0, s33, 26624
    s_mov_b32 s38, 1048576
    buffer_load_dwordx4 v184, s[12:15], s38 offen lds
    s_add_u32 m0, s33, 27648
    s_mov_b32 s38, 1179648
    buffer_load_dwordx4 v184, s[12:15], s38 offen lds
    s_add_u32 m0, s33, 28672
    s_mov_b32 s38, 1048576
    buffer_load_dwordx4 v184, s[16:19], s38 offen lds
    s_add_u32 m0, s33, 29696
    s_mov_b32 s38, 1179648
    buffer_load_dwordx4 v184, s[16:19], s38 offen lds
    s_add_u32 m0, s33, 30720
    s_mov_b32 s38, 1310720
    buffer_load_dwordx4 v184, s[8:11], s38 offen lds
    s_add_u32 m0, s33, 31744
    s_mov_b32 s38, 1441792
    buffer_load_dwordx4 v184, s[8:11], s38 offen lds
    s_waitcnt vmcnt(54)
    ds_read_b64_tr_b16 a[0:1], v186 offset:0
    ds_read_b64_tr_b16 a[2:3], v186 offset:256
    ds_read_b64_tr_b16 a[8:9], v186 offset:32
    ds_read_b64_tr_b16 a[10:11], v186 offset:288
    s_waitcnt vmcnt(52)
    ds_read_b64_tr_b16 a[16:17], v186 offset:2048
    ds_read_b64_tr_b16 a[18:19], v186 offset:2304
    ds_read_b64_tr_b16 a[24:25], v186 offset:2080
    ds_read_b64_tr_b16 a[26:27], v186 offset:2336
    s_waitcnt lgkmcnt(4)
    s_add_u32 m0, s33, 0
    s_mov_b32 s38, 1310720
    buffer_load_dwordx4 v184, s[12:15], s38 offen lds
    s_add_u32 m0, s33, 1024
    s_mov_b32 s38, 1441792
    buffer_load_dwordx4 v184, s[12:15], s38 offen lds
    s_waitcnt vmcnt(52)
    global_load_dword v31, v144, s[92:93] offset:192 sc1
    ds_read_b64_tr_b16 a[32:33], v186 offset:4096
    ds_read_b64_tr_b16 a[34:35], v186 offset:4352
    ds_read_b64_tr_b16 a[40:41], v186 offset:4128
    ds_read_b64_tr_b16 a[42:43], v186 offset:4384
    s_waitcnt lgkmcnt(4)
    s_add_u32 m0, s33, 2048
    s_mov_b32 s38, 1310720
    buffer_load_dwordx4 v184, s[16:19], s38 offen lds
    s_add_u32 m0, s33, 3072
    s_mov_b32 s38, 1441792
    buffer_load_dwordx4 v184, s[16:19], s38 offen lds
    s_waitcnt vmcnt(52)
    ds_read_b64_tr_b16 a[4:5], v186 offset:6144
    ds_read_b64_tr_b16 a[6:7], v186 offset:6400
    ds_read_b64_tr_b16 a[12:13], v186 offset:6176
    ds_read_b64_tr_b16 a[14:15], v186 offset:6432
    s_waitcnt lgkmcnt(4)
    s_add_u32 m0, s33, 4096
    s_mov_b32 s38, 1572864
    buffer_load_dwordx4 v184, s[8:11], s38 offen lds
    s_add_u32 m0, s33, 5120
    s_mov_b32 s38, 1703936
    buffer_load_dwordx4 v184, s[8:11], s38 offen lds
    s_waitcnt vmcnt(52)
    ds_read_b64_tr_b16 a[20:21], v186 offset:8192
    ds_read_b64_tr_b16 a[22:23], v186 offset:8448
    ds_read_b64_tr_b16 a[28:29], v186 offset:8224
    ds_read_b64_tr_b16 a[30:31], v186 offset:8480
    s_waitcnt lgkmcnt(4)
    s_add_u32 m0, s33, 6144
    s_mov_b32 s38, 1572864
    buffer_load_dwordx4 v184, s[12:15], s38 offen lds
    s_add_u32 m0, s33, 7168
    s_mov_b32 s38, 1703936
    buffer_load_dwordx4 v184, s[12:15], s38 offen lds
    s_waitcnt vmcnt(52)
    ds_read_b64_tr_b16 a[36:37], v186 offset:10240
    ds_read_b64_tr_b16 a[38:39], v186 offset:10496
    ds_read_b64_tr_b16 a[44:45], v186 offset:10272
    ds_read_b64_tr_b16 a[46:47], v186 offset:10528
    s_waitcnt lgkmcnt(4)
    s_add_u32 m0, s33, 8192
    s_mov_b32 s38, 1572864
    buffer_load_dwordx4 v184, s[16:19], s38 offen lds
    s_add_u32 m0, s33, 9216
    s_mov_b32 s38, 1703936
    buffer_load_dwordx4 v184, s[16:19], s38 offen lds
    s_waitcnt vmcnt(28)
    ds_read_b64_tr_b16 a[48:49], v186 offset:12288
    ds_read_b64_tr_b16 a[50:51], v186 offset:12544
    ds_read_b64_tr_b16 a[56:57], v186 offset:12320
    ds_read_b64_tr_b16 a[58:59], v186 offset:12576
    s_waitcnt lgkmcnt(4)
    s_add_u32 m0, s33, 10240
    s_mov_b32 s38, 1835008
    buffer_load_dwordx4 v184, s[8:11], s38 offen lds
    s_add_u32 m0, s33, 11264
    s_mov_b32 s38, 1966080
    buffer_load_dwordx4 v184, s[8:11], s38 offen lds
    s_waitcnt vmcnt(28)
    ds_read_b64_tr_b16 a[64:65], v186 offset:14336
    ds_read_b64_tr_b16 a[66:67], v186 offset:14592
    ds_read_b64_tr_b16 a[72:73], v186 offset:14368
    ds_read_b64_tr_b16 a[74:75], v186 offset:14624
    s_waitcnt lgkmcnt(4)
    s_add_u32 m0, s33, 12288
    s_mov_b32 s38, 1835008
    buffer_load_dwordx4 v184, s[12:15], s38 offen lds
    s_add_u32 m0, s33, 13312
    s_mov_b32 s38, 1966080
    buffer_load_dwordx4 v184, s[12:15], s38 offen lds
    s_waitcnt vmcnt(28)
    ds_read_b64_tr_b16 a[80:81], v186 offset:16384
    ds_read_b64_tr_b16 a[82:83], v186 offset:16640
    ds_read_b64_tr_b16 a[88:89], v186 offset:16416
    ds_read_b64_tr_b16 a[90:91], v186 offset:16672
    s_waitcnt lgkmcnt(4)
    s_add_u32 m0, s33, 14336
    s_mov_b32 s38, 1835008
    buffer_load_dwordx4 v184, s[16:19], s38 offen lds
    s_add_u32 m0, s33, 15360
    s_mov_b32 s38, 1966080
    buffer_load_dwordx4 v184, s[16:19], s38 offen lds
    s_waitcnt vmcnt(28)
    ds_read_b64_tr_b16 a[52:53], v186 offset:18432
    ds_read_b64_tr_b16 a[54:55], v186 offset:18688
    ds_read_b64_tr_b16 a[60:61], v186 offset:18464
    ds_read_b64_tr_b16 a[62:63], v186 offset:18720
    s_waitcnt lgkmcnt(4)
    s_add_u32 m0, s33, 16384
    s_mov_b32 s38, 0
    buffer_load_dwordx4 v185, s[20:23], s38 offen lds
    s_add_u32 m0, s33, 17408
    s_mov_b32 s38, 65536
    buffer_load_dwordx4 v185, s[20:23], s38 offen lds
    s_waitcnt vmcnt(28)
    ds_read_b64_tr_b16 a[68:69], v186 offset:20480
    ds_read_b64_tr_b16 a[70:71], v186 offset:20736
    ds_read_b64_tr_b16 a[76:77], v186 offset:20512
    ds_read_b64_tr_b16 a[78:79], v186 offset:20768
    s_waitcnt lgkmcnt(4)
    s_add_u32 m0, s33, 18432
    s_mov_b32 s38, 131072
    buffer_load_dwordx4 v185, s[20:23], s38 offen lds
    s_add_u32 m0, s33, 19456
    s_mov_b32 s38, 196608
    buffer_load_dwordx4 v185, s[20:23], s38 offen lds
    s_waitcnt vmcnt(28)
    ds_read_b64_tr_b16 a[84:85], v186 offset:22528
    ds_read_b64_tr_b16 a[86:87], v186 offset:22784
    ds_read_b64_tr_b16 a[92:93], v186 offset:22560
    ds_read_b64_tr_b16 a[94:95], v186 offset:22816
    s_waitcnt lgkmcnt(4)
    s_add_u32 m0, s33, 20480
    s_mov_b32 s38, 262144
    buffer_load_dwordx4 v185, s[20:23], s38 offen lds
    s_add_u32 m0, s33, 21504
    s_mov_b32 s38, 327680
    buffer_load_dwordx4 v185, s[20:23], s38 offen lds
    s_waitcnt vmcnt(28)
    ds_read_b64_tr_b16 a[96:97], v186 offset:24576
    ds_read_b64_tr_b16 a[98:99], v186 offset:24832
    ds_read_b64_tr_b16 a[104:105], v186 offset:24608
    ds_read_b64_tr_b16 a[106:107], v186 offset:24864
    s_waitcnt lgkmcnt(4)
    s_add_u32 m0, s33, 22528
    s_mov_b32 s38, 393216
    buffer_load_dwordx4 v185, s[20:23], s38 offen lds
    s_add_u32 m0, s33, 23552
    s_mov_b32 s38, 458752
    buffer_load_dwordx4 v185, s[20:23], s38 offen lds
    s_waitcnt vmcnt(28)
    ds_read_b64_tr_b16 a[112:113], v186 offset:26624
    ds_read_b64_tr_b16 a[114:115], v186 offset:26880
    ds_read_b64_tr_b16 a[120:121], v186 offset:26656
    ds_read_b64_tr_b16 a[122:123], v186 offset:26912
    s_waitcnt lgkmcnt(4)
    s_add_u32 m0, s33, 24576
    s_mov_b32 s38, 524288
    buffer_load_dwordx4 v185, s[20:23], s38 offen lds
    s_add_u32 m0, s33, 25600
    s_mov_b32 s38, 589824
    buffer_load_dwordx4 v185, s[20:23], s38 offen lds
    s_waitcnt vmcnt(28)
    ds_read_b64_tr_b16 a[128:129], v186 offset:28672
    ds_read_b64_tr_b16 a[130:131], v186 offset:28928
    ds_read_b64_tr_b16 a[136:137], v186 offset:28704
    ds_read_b64_tr_b16 a[138:139], v186 offset:28960
    s_waitcnt lgkmcnt(4)
    s_add_u32 m0, s33, 26624
    s_mov_b32 s38, 655360
    buffer_load_dwordx4 v185, s[20:23], s38 offen lds
    s_add_u32 m0, s33, 27648
    s_mov_b32 s38, 720896
    buffer_load_dwordx4 v185, s[20:23], s38 offen lds
    s_waitcnt vmcnt(28)
    ds_read_b64_tr_b16 a[100:101], v186 offset:30720
    ds_read_b64_tr_b16 a[102:103], v186 offset:30976
    ds_read_b64_tr_b16 a[108:109], v186 offset:30752
    ds_read_b64_tr_b16 a[110:111], v186 offset:31008
    s_waitcnt lgkmcnt(4)
    s_add_u32 m0, s33, 28672
    s_mov_b32 s38, 786432
    buffer_load_dwordx4 v185, s[20:23], s38 offen lds
    s_add_u32 m0, s33, 29696
    s_mov_b32 s38, 851968
    buffer_load_dwordx4 v185, s[20:23], s38 offen lds
    s_waitcnt vmcnt(28)
    ds_read_b64_tr_b16 a[116:117], v186 offset:0
    ds_read_b64_tr_b16 a[118:119], v186 offset:256
    ds_read_b64_tr_b16 a[124:125], v186 offset:32
    ds_read_b64_tr_b16 a[126:127], v186 offset:288
    s_waitcnt lgkmcnt(4)
    s_add_u32 m0, s33, 30720
    s_mov_b32 s38, 917504
    buffer_load_dwordx4 v185, s[20:23], s38 offen lds
    s_add_u32 m0, s33, 31744
    s_mov_b32 s38, 983040
    buffer_load_dwordx4 v185, s[20:23], s38 offen lds
    s_waitcnt vmcnt(28)
    s_branch valc_6
val_5:
    v_mov_b32 v2, 0
    global_load_dword v31, v2, s[92:93] offset:192 sc1
    s_add_u32 s41, s41, 1
    s_cmp_ge_u32 s41, 0x80000
    s_cbranch_scc1 L_end
    s_waitcnt vmcnt(0)
valc_6:
    v_readfirstlane_b32 s38, v31
    s_cmp_eq_u32 s38, s70
    s_cbranch_scc1 valok_7
    s_cmp_eq_u32 s38, 0
    s_cbranch_scc1 val_5
    s_mov_b32 s70, s38
    s_mov_b32 s71, 1048576
    s_waitcnt vmcnt(0) lgkmcnt(0)
    s_barrier
    s_branch L_role
valok_7:
    s_barrier
    s_cmp_lg_u32 s31, 3
    s_cbranch_scc1 rec_arr_4
    v_mov_b32 v2, 0
    s_add_u32 s48, s48, s71
    v_mov_b32 v3, s48
    s_mov_b64 exec, 1
    global_atomic_add v2, v3, s[92:93] offset:0 sc1
    s_mov_b64 exec, -1
rec_arr_4:
    ds_read_b64_tr_b16 a[132:133], v186 offset:2048
    ds_read_b64_tr_b16 a[134:135], v186 offset:2304
    ds_read_b64_tr_b16 a[140:141], v186 offset:2080
    ds_read_b64_tr_b16 a[142:143], v186 offset:2336
    s_waitcnt lgkmcnt(4)
    s_add_u32 m0, s33, 0
    s_mov_b32 s38, 1048576
    buffer_load_dwordx4 v185, s[20:23], s38 offen lds
    s_add_u32 m0, s33, 1024
    s_mov_b32 s38, 1114112
    buffer_load_dwordx4 v185, s[20:23], s38 offen lds
    s_waitcnt vmcnt(28)
    ds_read_b64_tr_b16 a[144:145], v186 offset:4096
    ds_read_b64_tr_b16 a[146:147], v186 offset:4352
    ds_read_b64_tr_b16 a[152:153], v186 offset:4128
    ds_read_b64_tr_b16 a[154:155], v186 offset:4384
    s_waitcnt lgkmcnt(4)
    s_add_u32 m0, s33, 2048
    s_mov_b32 s38, 1179648
    buffer_load_dwordx4 v185, s[20:23], s38 offen lds
    s_add_u32 m0, s33, 3072
    s_mov_b32 s38, 1245184
    buffer_load_dwordx4 v185, s[20:23], s38 offen lds
    s_waitcnt vmcnt(28)
    ds_read_b64_tr_b16 a[160:161], v186 offset:6144
    ds_read_b64_tr_b16 a[162:163], v186 offset:6400
    ds_read_b64_tr_b16 a[168:169], v186 offset:6176
    ds_read_b64_tr_b16 a[170:171], v186 offset:6432
    s_waitcnt lgkmcnt(4)
    s_add_u32 m0, s33, 4096
    s_mov_b32 s38, 1310720
    buffer_load_dwordx4 v185, s[20:23], s38 offen lds
    s_add_u32 m0, s33, 5120
    s_mov_b32 s38, 1376256
    buffer_load_dwordx4 v185, s[20:23], s38 offen lds
    s_waitcnt vmcnt(28)
    ds_read_b64_tr_b16 a[176:177], v186 offset:8192
    ds_read_b64_tr_b16 a[178:179], v186 offset:8448
    ds_read_b64_tr_b16 a[184:185], v186 offset:8224
    ds_read_b64_tr_b16 a[186:187], v186 offset:8480
    s_waitcnt lgkmcnt(4)
    s_add_u32 m0, s33, 6144
    s_mov_b32 s38, 1441792
    buffer_load_dwordx4 v185, s[20:23], s38 offen lds
    s_add_u32 m0, s33, 7168
    s_mov_b32 s38, 1507328
    buffer_load_dwordx4 v185, s[20:23], s38 offen lds
    s_waitcnt vmcnt(28)
    ds_read_b64_tr_b16 a[148:149], v186 offset:10240
    ds_read_b64_tr_b16 a[150:151], v186 offset:10496
    ds_read_b64_tr_b16 a[156:157], v186 offset:10272
    ds_read_b64_tr_b16 a[158:159], v186 offset:10528
    s_waitcnt lgkmcnt(4)
    s_add_u32 m0, s33, 8192
    s_mov_b32 s38, 1572864
    buffer_load_dwordx4 v185, s[20:23], s38 offen lds
    s_add_u32 m0, s33, 9216
    s_mov_b32 s38, 1638400
    buffer_load_dwordx4 v185, s[20:23], s38 offen lds
    s_waitcnt vmcnt(28)
    ds_read_b64_tr_b16 a[164:165], v186 offset:12288
    ds_read_b64_tr_b16 a[166:167], v186 offset:12544
    ds_read_b64_tr_b16 a[172:173], v186 offset:12320
    ds_read_b64_tr_b16 a[174:175], v186 offset:12576
    s_waitcnt lgkmcnt(4)
    s_add_u32 m0, s33, 10240
    s_mov_b32 s38, 1703936
    buffer_load_dwordx4 v185, s[20:23], s38 offen lds
    s_add_u32 m0, s33, 11264
    s_mov_b32 s38, 1769472
    buffer_load_dwordx4 v185, s[20:23], s38 offen lds
    s_waitcnt vmcnt(28)
    ds_read_b64_tr_b16 a[180:181], v186 offset:14336
    ds_read_b64_tr_b16 a[182:183], v186 offset:14592
    ds_read_b64_tr_b16 a[188:189], v186 offset:14368
    ds_read_b64_tr_b16 a[190:191], v186 offset:14624
    s_waitcnt lgkmcnt(4)
    s_add_u32 m0, s33, 12288
    s_mov_b32 s38, 1835008
    buffer_load_dwordx4 v185, s[20:23], s38 offen lds
    s_add_u32 m0, s33, 13312
    s_mov_b32 s38, 1900544
    buffer_load_dwordx4 v185, s[20:23], s38 offen lds
    s_waitcnt vmcnt(28)
    ds_read_b64_tr_b16 a[192:193], v187 offset:16384
    ds_read_b64_tr_b16 a[194:195], v187 offset:16512
    ds_read_b64_tr_b16 a[196:197], v187 offset:17408
    ds_read_b64_tr_b16 a[198:199], v187 offset:17536
    s_waitcnt lgkmcnt(4)
    s_add_u32 m0, s33, 14336
    s_mov_b32 s38, 1966080
    buffer_load_dwordx4 v185, s[20:23], s38 offen lds
    s_add_u32 m0, s33, 15360
    s_mov_b32 s38, 2031616
    buffer_load_dwordx4 v185, s[20:23], s38 offen lds
    s_waitcnt vmcnt(28)
    ds_read_b64_tr_b16 a[200:201], v187 offset:18432
    ds_read_b64_tr_b16 a[202:203], v187 offset:18560
    ds_read_b64_tr_b16 a[204:205], v187 offset:19456
    ds_read_b64_tr_b16 a[206:207], v187 offset:19584
    s_waitcnt vmcnt(26)
    s_cmp_lg_u32 s31, 0
    s_cbranch_scc1 rec_rdy_8
    v_mov_b32 v2, 0
    v_mov_b32 v3, 1
    s_mov_b64 exec, 1
    global_atomic_add v2, v3, s[92:93] offset:128 sc1
    s_mov_b64 exec, -1
rec_rdy_8:
    ds_read_b64_tr_b16 a[208:209], v187 offset:20480
    ds_read_b64_tr_b16 a[210:211], v187 offset:20608
    ds_read_b64_tr_b16 a[212:213], v187 offset:21504
    ds_read_b64_tr_b16 a[214:215], v187 offset:21632
    s_waitcnt vmcnt(24)
    ds_read_b64_tr_b16 a[216:217], v187 offset:22528
    ds_read_b64_tr_b16 a[218:219], v187 offset:22656
    ds_read_b64_tr_b16 a[220:221], v187 offset:23552
    ds_read_b64_tr_b16 a[222:223], v187 offset:23680
    s_waitcnt vmcnt(22)
    ds_read_b64_tr_b16 a[224:225], v187 offset:24576
    ds_read_b64_tr_b16 a[226:227], v187 offset:24704
    ds_read_b64_tr_b16 a[228:229], v187 offset:25600
    ds_read_b64_tr_b16 a[230:231], v187 offset:25728
    s_waitcnt vmcnt(20)
    ds_read_b64_tr_b16 a[232:233], v187 offset:26624
    ds_read_b64_tr_b16 a[234:235], v187 offset:26752
    ds_read_b64_tr_b16 a[236:237], v187 offset:27648
    ds_read_b64_tr_b16 a[238:239], v187 offset:27776
    s_waitcnt vmcnt(18)
    ds_read_b64_tr_b16 a[240:241], v187 offset:28672
    ds_read_b64_tr_b16 a[242:243], v187 offset:28800
    ds_read_b64_tr_b16 a[244:245], v187 offset:29696
    ds_read_b64_tr_b16 a[246:247], v187 offset:29824
    s_waitcnt vmcnt(16)
    ds_read_b64_tr_b16 a[248:249], v187 offset:30720
    ds_read_b64_tr_b16 a[250:251], v187 offset:30848
    ds_read_b64_tr_b16 a[252:253], v187 offset:31744
    ds_read_b64_tr_b16 a[254:255], v187 offset:31872
    s_waitcnt vmcnt(14)
    ds_read_b64_tr_b16 v[192:193], v187 offset:0
    ds_read_b64_tr_b16 v[194:195], v187 offset:128
    ds_read_b64_tr_b16 v[196:197], v187 offset:1024
    ds_read_b64_tr_b16 v[198:199], v187 offset:1152
    s_waitcnt vmcnt(12)
    ds_read_b64_tr_b16 v[200:201], v187 offset:2048
    ds_read_b64_tr_b16 v[202:203], v187 offset:2176
    ds_read_b64_tr_b16 v[204:205], v187 offset:3072
    ds_read_b64_tr_b16 v[206:207], v187 offset:3200
    s_waitcnt vmcnt(10)
    ds_read_b64_tr_b16 v[208:209], v187 offset:4096
    ds_read_b64_tr_b16 v[210:211], v187 offset:4224
    ds_read_b64_tr_b16 v[212:213], v187 offset:5120
    ds_read_b64_tr_b16 v[214:215], v187 offset:5248
    s_waitcnt vmcnt(8)
    ds_read_b64_tr_b16 v[216:217], v187 offset:6144
    ds_read_b64_tr_b16 v[218:219], v187 offset:6272
    ds_read_b64_tr_b16 v[220:221], v187 offset:7168
    ds_read_b64_tr_b16 v[222:223], v187 offset:7296
    s_waitcnt vmcnt(6)
    ds_read_b64_tr_b16 v[224:225], v187 offset:8192
    ds_read_b64_tr_b16 v[226:227], v187 offset:8320
    ds_read_b64_tr_b16 v[228:229], v187 offset:9216
    ds_read_b64_tr_b16 v[230:231], v187 offset:9344
    s_waitcnt vmcnt(4)
    ds_read_b64_tr_b16 v[232:233], v187 offset:10240
    ds_read_b64_tr_b16 v[234:235], v187 offset:10368
    ds_read_b64_tr_b16 v[236:237], v187 offset:11264
    ds_read_b64_tr_b16 v[238:239], v187 offset:11392
    s_waitcnt vmcnt(2)
    ds_read_b64_tr_b16 v[240:241], v187 offset:12288
    ds_read_b64_tr_b16 v[242:243], v187 offset:12416
    ds_read_b64_tr_b16 v[244:245], v187 offset:13312
    ds_read_b64_tr_b16 v[246:247], v187 offset:13440
    s_waitcnt vmcnt(0)
    ds_read_b64_tr_b16 v[248:249], v187 offset:14336
    ds_read_b64_tr_b16 v[250:251], v187 offset:14464
    ds_read_b64_tr_b16 v[252:253], v187 offset:15360
    ds_read_b64_tr_b16 v[254:255], v187 offset:15488
    s_waitcnt lgkmcnt(0)
    v_max_u32 v36, 1, v36
    v_max_u32 v37, 1, v37
    v_max_u32 v38, 1, v38
    v_max_u32 v39, 1, v39
    v_max_u32 v40, 1, v40
    v_max_u32 v41, 1, v41
    v_max_u32 v42, 1, v42
    v_max_u32 v43, 1, v43
    v_max_u32 v44, 1, v44
    v_max_u32 v45, 1, v45
    v_max_u32 v46, 1, v46
    v_max_u32 v47, 1, v47
    v_max_u32 v48, 1, v48
    v_max_u32 v49, 1, v49
    v_max_u32 v50, 1, v50
    v_max_u32 v51, 1, v51
    v_mov_b32 v68, 0
    v_mov_b32 v69, 0
    v_mov_b32 v70, 0
    v_mov_b32 v71, 0
    v_mov_b32 v72, 0
    v_mov_b32 v73, 0
    v_mov_b32 v74, 0
    v_mov_b32 v75, 0
    v_mov_b32 v76, 0
    v_mov_b32 v77, 0
    v_mov_b32 v78, 0
    v_mov_b32 v79, 0
    v_mov_b32 v80, 0
    v_mov_b32 v81, 0
    v_mov_b32 v82, 0
    v_mov_b32 v83, 0
    v_mov_b32 v84, 0
    v_mov_b32 v85, 0
    v_mov_b32 v86, 0
    v_mov_b32 v87, 0
    v_mov_b32 v88, 0
    v_mov_b32 v89, 0
    v_mov_b32 v90, 0
    v_mov_b32 v91, 0
    s_mov_b32 s72, 0
    s_mov_b32 s73, 0
    s_mov_b32 s74, 0
    s_mov_b32 s75, 0
    s_mov_b32 s76, 0
    s_mov_b32 s77, 0
    s_mov_b32 s78, 0
    s_mov_b32 s79, 0
    s_mov_b32 s80, 0
    s_mov_b32 s81, 0
    s_mov_b32 s82, 0
    s_mov_b32 s83, 0
    s_mov_b32 s84, 0
    s_mov_b32 s85, 0
    s_mov_b32 s86, 0
    s_mov_b32 s87, 0
    v_mov_b32 v2, 0
    s_branch rec_ibq_11
rec_ibp_10:
    s_sleep 16
rec_ibq_11:
    global_load_dword v3, v2, s[92:93] offset:0 sc1
    s_add_u32 s41, s41, 1
    s_cmp_ge_u32 s41, 0x80000
    s_cbranch_scc1 rec_ib_9
    s_waitcnt vmcnt(0)
    v_readfirstlane_b32 s38, v3
    s_and_b32 s39, s38, 1023
    s_cmp_lt_u32 s39, 256
    s_cbranch_scc1 rec_ibp_10
rec_ib_9:
    s_lshr_b32 s96, s38, 20
    s_bfe_u32 s38, s38, 589834
    s_cmp_ge_u32 s38, 64
    s_cselect_b32 s48, -1, 0
    s_xor_b32 s48, s48, 0xaaa
    s_and_b32 s33, s48, 1
    s_lshl_b32 s33, s33, 13
    s_add_u32 s33, s33, s49
    s_add_u32 s34, s33, 262144
    s_add_u32 s35, s33, 524288
    s_lshr_b32 s38, s28, 5
    s_lshl_b32 s38, s38, 4
    s_lshl_b32 s40, s30, 14
    s_add_u32 s38, s38, s40
    s_add_u32 s38, s38, s33
    s_add_u32 s38, s38, 163840
    v_and_b32 v132, 31, v1
    v_lshlrev_b32 v132, 8, v132
    v_add_u32 v132, s38, v132
    s_and_b32 s39, s29, 23
    s_cmp_eq_u32 s39, 3
    s_mov_b32 vcc_hi, 0
    s_cselect_b32 vcc_lo, -1, 0
    v_mov_b32 v4, 2130706432
    v_cndmask_b32 v132, v4, v132, vcc
    v_add_u32 v133, 128, v132
    s_and_b32 s39, s29, 31
    s_cmp_eq_u32 s39, 3
    s_cselect_b32 s39, s31, 99
    s_cmp_eq_u32 s39, 1
    s_cselect_b64 vcc, -1, 0
    v_mov_b32 v4, 2130706432
    v_cndmask_b32 v133, v4, v133, vcc
    s_lshr_b32 s55, s28, 5
    s_lshl_b32 s55, s55, 14
    s_and_b32 s40, s28, 31
    s_lshl_b32 s40, s40, 8
    s_add_u32 s55, s55, s40
    s_add_u32 s55, s55, s33
    s_add_u32 s55, s55, 163840
    s_add_u32 s44, s55, 128
    v_mov_b32 v26, 2130706432
    s_mov_b32 s98, 0
    s_mov_b32 s99, 0
    s_mov_b32 s88, 88080384
    s_mov_b32 s89, 65536
    v_mov_b32 v188, 0
    v_mov_b32 v189, 0
    v_mov_b32 v190, 0
    v_mov_b32 v191, 0
    s_cmp_eq_u32 s31, 1
    s_cbranch_scc1 rec_gs1_13
    s_cmp_eq_u32 s31, 2
    s_cbranch_scc1 rec_gs2_14
    s_cmp_eq_u32 s31, 3
    s_cbranch_scc1 rec_gs3_15
    v_mov_b32 v93, v19
    v_mov_b32 v180, -1
    v_mov_b32 v181, -1
    v_mov_b32 v182, -1
    v_mov_b32 v183, -1
    s_mov_b32 s88, 97255424
    s_mov_b32 s89, 262144
    s_branch rec_gs_12
rec_gs1_13:
    v_mov_b32 v26, v19
    s_mov_b64 vcc, 0xffff
    v_mov_b32 v4, 2130706432
    v_cndmask_b32 v26, v4, v26, vcc
    v_mov_b32 v188, -1
    v_mov_b32 v189, -1
    v_mov_b32 v190, -1
    v_mov_b32 v191, -1
    s_mov_b32 s98, 97256448
    s_mov_b32 s99, 262144
    s_branch rec_gs_12
rec_gs2_14:
    v_mov_b32 v26, v137
    s_branch rec_gs_12
rec_gs3_15:
    s_lshr_b32 s38, s29, 3
    s_lshl_b32 s38, s38, 14
    s_and_b32 s40, s29, 7
    s_lshl_b32 s40, s40, 10
    s_add_u32 s38, s38, s40
    s_and_b32 s40, s30, 1
    s_lshl_b32 s40, s40, 9
    s_add_u32 s38, s38, s40
    s_lshr_b32 s40, s30, 1
    s_lshl_b32 s40, s40, 7
    s_add_u32 s38, s38, s40
    v_bfe_u32 v2, v1, 4, 1
    v_lshlrev_b32 v2, 16, v2
    v_bfe_u32 v4, v1, 3, 1
    v_lshl_add_u32 v2, v4, 8, v2
    v_and_b32 v4, 7, v1
    v_lshl_add_u32 v2, v4, 4, v2
    v_add_u32 v2, s38, v2
    s_mov_b32 vcc_lo, 0
    s_mov_b32 vcc_hi, -1
    v_cndmask_b32 v93, v93, v2, vcc
    s_mov_b32 s88, s35
rec_gs_12:
    s_cmp_eq_u32 s31, 2
    s_cselect_b32 s45, 1, 0
    s_barrier
    s_mov_b32 s72, 0
    s_mov_b32 s73, 0
    s_mov_b32 s74, 0
    s_mov_b32 s75, 0
    s_mov_b32 s76, 0
    s_mov_b32 s77, 0
    s_mov_b32 s78, 0
    s_mov_b32 s79, 0
    s_mov_b32 s80, 0
    s_mov_b32 s81, 0
    s_mov_b32 s82, 0
    s_mov_b32 s83, 0
    s_mov_b32 s84, 0
    s_mov_b32 s85, 0
    s_mov_b32 s86, 0
    s_mov_b32 s87, 0
    s_cmp_gt_u32 s94, 0
    s_cbranch_scc0 rec_kv_16
rec_kvd_17:
    s_add_u32 m0, s51, s3
    s_nop 0
    buffer_load_dwordx4 v30, s[4:7], s37 offen sc1 lds
    s_waitcnt vmcnt(0)
    s_barrier
    s_branch rec_entry_18
rec_loop_19:
    s_barrier
    buffer_load_dwordx4 v[36:39], v7, s[4:7], s33 offen offset:0 sc1
    s_nop 3
    buffer_load_dwordx4 v[40:43], v7, s[4:7], s33 offen offset:1024 sc1
    s_nop 3
    buffer_load_dwordx4 v[44:47], v7, s[4:7], s33 offen offset:2048 sc1
    s_nop 3
    buffer_load_dwordx4 v[48:51], v7, s[4:7], s33 offen offset:3072 sc1
rec_entry_18:
    v_add_u32 v2, s51, v16
    ds_read_b128 v[60:63], v2 offset:0
    ds_read_b128 v[64:67], v2 offset:1024
    ds_read_b128 v[52:55], v2 offset:2048
    ds_read_b128 v[56:59], v2 offset:3072
    s_waitcnt vmcnt(3)
    v_smfmac_f32_16x16x64_bf16 v[68:71], v[36:39], a[0:7], v5
    v_min_u32 v31, v36, v37
    v_smfmac_f32_16x16x64_bf16 v[72:75], v[36:39], a[8:15], v5
    v_min_u32 v4, v38, v39
    v_smfmac_f32_16x16x64_bf16 v[76:79], v[36:39], a[16:23], v5
    v_smfmac_f32_16x16x64_bf16 v[80:83], v[36:39], a[24:31], v5
    s_waitcnt vmcnt(2)
    v_smfmac_f32_16x16x64_bf16 v[68:71], v[40:43], a[48:55], v5
    v_min3_u32 v31, v31, v40, v41
    v_smfmac_f32_16x16x64_bf16 v[72:75], v[40:43], a[56:63], v5
    v_min3_u32 v4, v4, v42, v43
    v_smfmac_f32_16x16x64_bf16 v[76:79], v[40:43], a[64:71], v5
    v_smfmac_f32_16x16x64_bf16 v[80:83], v[40:43], a[72:79], v5
    s_waitcnt vmcnt(1)
    v_smfmac_f32_16x16x64_bf16 v[68:71], v[44:47], a[96:103], v5
    v_min3_u32 v31, v31, v44, v45
    v_smfmac_f32_16x16x64_bf16 v[72:75], v[44:47], a[104:111], v5
    v_min3_u32 v4, v4, v46, v47
    v_smfmac_f32_16x16x64_bf16 v[76:79], v[44:47], a[112:119], v5
    v_min_u32 v31, v31, v4
    v_smfmac_f32_16x16x64_bf16 v[80:83], v[44:47], a[120:127], v5
    s_waitcnt vmcnt(0)
    v_min3_u32 v31, v31, v48, v49
    v_smfmac_f32_16x16x64_bf16 v[68:71], v[48:51], a[144:151], v5
    v_min3_u32 v31, v31, v50, v51
    v_smfmac_f32_16x16x64_bf16 v[72:75], v[48:51], a[152:159], v5
    v_cmp_eq_u32 vcc, 0, v31
    v_smfmac_f32_16x16x64_bf16 v[76:79], v[48:51], a[160:167], v5
    v_smfmac_f32_16x16x64_bf16 v[80:83], v[48:51], a[168:175], v5
    s_cbranch_vccnz rec_gafix_22
rec_gaok_21:
    s_nop 1
    v_pk_add_f32 v[68:69], v[68:69], v[70:71]
    s_nop 0
    v_pk_add_f32 v[70:71], v[72:73], v[74:75]
    ds_write2_b32 v14, v68, v69 offset0:0 offset1:40
    ds_write2_b32 v14, v70, v71 offset0:16 offset1:56
    v_pk_add_f32 v[76:77], v[76:77], v[78:79]
    v_pk_add_f32 v[78:79], v[80:81], v[82:83]
    ds_write2_b32 v15, v76, v77 offset0:0 offset1:40
    ds_write2_b32 v15, v78, v79 offset0:16 offset1:56
    s_cmp_lg_u32 s31, 0
    s_cbranch_scc1 rec_w1_24
    s_waitcnt lgkmcnt(0)
    s_barrier
    ds_read_b128 v[100:103], v18 offset:0
    v_smfmac_f32_16x16x64_bf16 v[84:87], v[36:39], a[32:39], v5
    ds_read_b128 v[104:107], v18 offset:32
    v_smfmac_f32_16x16x64_bf16 v[88:91], v[36:39], a[40:47], v5
    ds_read_b128 v[108:111], v18 offset:2560
    v_smfmac_f32_16x16x64_bf16 v[84:87], v[40:43], a[80:87], v5
    ds_read_b128 v[112:115], v18 offset:2592
    v_smfmac_f32_16x16x64_bf16 v[88:91], v[40:43], a[88:95], v5
    ds_read_b128 v[116:119], v18 offset:5120
    v_smfmac_f32_16x16x64_bf16 v[84:87], v[44:47], a[128:135], v5
    ds_read_b128 v[120:123], v18 offset:5152
    v_smfmac_f32_16x16x64_bf16 v[88:91], v[44:47], a[136:143], v5
    ds_read_b128 v[124:127], v18 offset:7680
    v_smfmac_f32_16x16x64_bf16 v[84:87], v[48:51], a[176:183], v5
    ds_read_b128 v[128:131], v18 offset:7712
    v_smfmac_f32_16x16x64_bf16 v[88:91], v[48:51], a[184:191], v5
    s_waitcnt lgkmcnt(4)
    v_pk_add_f32 v[100:101], v[100:101], v[108:109]
    v_pk_add_f32 v[102:103], v[102:103], v[110:111]
    v_pk_add_f32 v[104:105], v[104:105], v[112:113]
    v_pk_add_f32 v[106:107], v[106:107], v[114:115]
    s_waitcnt lgkmcnt(2)
    v_pk_add_f32 v[100:101], v[100:101], v[116:117]
    v_pk_add_f32 v[102:103], v[102:103], v[118:119]
    v_pk_add_f32 v[104:105], v[104:105], v[120:121]
    v_pk_add_f32 v[106:107], v[106:107], v[122:123]
    s_waitcnt lgkmcnt(0)
    v_pk_add_f32 v[100:101], v[100:101], v[124:125]
    v_pk_add_f32 v[102:103], v[102:103], v[126:127]
    v_pk_add_f32 v[104:105], v[104:105], v[128:129]
    v_pk_add_f32 v[106:107], v[106:107], v[130:131]
    v_cvt_pk_bf16_f32 v96, v100, v101
    v_cvt_pk_bf16_f32 v97, v102, v103
    v_cvt_pk_bf16_f32 v98, v104, v105
    v_cvt_pk_bf16_f32 v99, v106, v107
    s_nop 1
    v_mfma_f32_16x16x32_bf16 v[68:71], v[60:63], v[96:99], 0
    v_mfma_f32_16x16x32_bf16 v[72:75], v[64:67], v[96:99], 0
    v_mfma_f32_16x16x32_bf16 v[76:79], v[96:99], v[96:99], 0
    s_cmp_lg_u32 s96, 0
    v_pk_add_f32 v[84:85], v[84:85], v[86:87]
    v_pk_add_f32 v[86:87], v[88:89], v[90:91]
    s_cbranch_scc1 rec_slow_25
    s_mov_b64 exec, s[42:43]
    s_nop 0
    buffer_store_dwordx4 v[68:71], v19, s[4:7], s36 offen
    buffer_store_dwordx4 v[72:75], v19, s[4:7], s36 offen offset:128
    s_mov_b64 exec, s[46:47]
    buffer_store_dwordx4 v[76:79], v20, s[4:7], s36 offen offset:1024
    s_mov_b64 exec, -1
rec_slowr_26:
    ds_write_b128 v17, v[84:87]
    ds_write_b128 v16, v[96:99] offset:15360
    s_waitcnt lgkmcnt(0)
    s_barrier
    ds_read_b64 v[100:101], v25 offset:0
    ds_read_b64 v[102:103], v25 offset:128
    ds_read_b64 v[104:105], v25 offset:1024
    ds_read_b64 v[106:107], v25 offset:1152
    ds_read_b64 v[108:109], v25 offset:2048
    ds_read_b64 v[110:111], v25 offset:2176
    ds_read_b64 v[112:113], v25 offset:3072
    ds_read_b64 v[114:115], v25 offset:3200
    v_mov_b32_dpp v68, v72 row_ror:8 row_mask:0xf bank_mask:0xc
    v_mov_b32_dpp v69, v73 row_ror:8 row_mask:0xf bank_mask:0xc
    v_mov_b32_dpp v70, v74 row_ror:8 row_mask:0xf bank_mask:0xc
    v_mov_b32_dpp v71, v75 row_ror:8 row_mask:0xf bank_mask:0xc
    buffer_load_dwordx4 v[176:179], v21, s[4:7], s36 offen offset:1024 sc1
    buffer_load_dwordx4 v[164:167], v22, s[4:7], s36 offen sc1
    buffer_load_dwordx4 v[168:171], v23, s[4:7], s36 offen sc1
    buffer_load_dwordx4 v[172:175], v24, s[4:7], s36 offen sc1
    s_waitcnt lgkmcnt(0)
    v_pk_add_f32 v[100:101], v[100:101], v[104:105]
    v_pk_add_f32 v[102:103], v[102:103], v[106:107]
    v_pk_add_f32 v[108:109], v[108:109], v[112:113]
    v_pk_add_f32 v[110:111], v[110:111], v[114:115]
    v_pk_add_f32 v[100:101], v[100:101], v[108:109]
    v_pk_add_f32 v[102:103], v[102:103], v[110:111]
    v_cvt_pk_bf16_f32 v138, v100, v101
    v_cvt_pk_bf16_f32 v140, v102, v103
    s_nop 15
    buffer_load_dwordx4 v[48:51], v21, s[4:7], s36 offen offset:1024 sc1
    buffer_load_dwordx4 v[36:39], v22, s[4:7], s36 offen sc1
    buffer_load_dwordx4 v[40:43], v23, s[4:7], s36 offen sc1
    buffer_load_dwordx4 v[44:47], v24, s[4:7], s36 offen sc1
    s_cmp_eq_u32 s32, 63
    s_cbranch_scc1 rec_b2_23
    s_waitcnt vmcnt(7)
    v_permlane32_swap_b32 v176, v178
    v_permlane32_swap_b32 v177, v179
    v_pk_add_f32 v[124:125], v[176:177], v[178:179]
    s_waitcnt vmcnt(6)
    v_pk_add_f32 v[120:121], v[68:69], v[164:165]
    v_pk_add_f32 v[122:123], v[70:71], v[166:167]
    v_permlane16_swap_b32 v124, v125
    s_waitcnt vmcnt(5)
    v_pk_add_f32 v[120:121], v[120:121], v[168:169]
    v_pk_add_f32 v[122:123], v[122:123], v[170:171]
    v_add_f32 v124, v124, v125
    s_waitcnt vmcnt(4)
    v_pk_add_f32 v[120:121], v[120:121], v[172:173]
    v_pk_add_f32 v[122:123], v[122:123], v[174:175]
    v_maximum3_f32 v135, v120, v121, v124
    v_maximum3_f32 v135, v135, v122, v123
    v_cmp_u_f32 vcc, v135, v135
    s_nop 0
    v_max_f32_dpp v135, v135, v135 row_ror:8 row_mask:0xf bank_mask:0xf
    v_mov_b32 v136, v135
    s_cbranch_vccnz rec_gbr_27
rec_gbo_28:
    buffer_store_dword v134, v132, s[4:7], 0 offen sc1
    v_permlane16_swap_b32 v135, v136
    v_max_f32 v135, v135, v136
    v_mov_b32 v136, v135
    s_nop 1
    v_permlane32_swap_b32 v135, v136
    v_max_f32 v135, v135, v136
    v_mul_f32 v135, s50, v135
    v_fma_f32 v124, v124, s50, -v135
    v_fma_f32 v120, v120, s50, -v135
    v_fma_f32 v121, v121, s50, -v135
    v_fma_f32 v122, v122, s50, -v135
    v_fma_f32 v123, v123, s50, -v135
    v_exp_f32 v124, v124
    v_exp_f32 v120, v120
    v_exp_f32 v121, v121
    v_exp_f32 v122, v122
    v_exp_f32 v123, v123
    v_mov_b32_dpp v125, v124 row_ror:8 row_mask:0xf bank_mask:0xf
    v_cvt_pk_bf16_f32 v156, v120, v121
    v_cvt_pk_bf16_f32 v157, v122, v123
    v_cvt_pk_bf16_f32 v160, v124, v125
    v_mov_b32_dpp v158, v156 row_ror:8 row_mask:0xf bank_mask:0xf
    v_mov_b32_dpp v159, v157 row_ror:8 row_mask:0xf bank_mask:0xf
    v_mfma_f32_16x16x32_bf16 v[116:119], v[32:35], v[160:163], 0
    s_nop 0
    v_mfma_f32_16x16x32_bf16 v[116:119], v[32:35], v[156:159], v[116:119]
    v_mfma_f32_16x16x32_bf16 v[108:111], v[52:55], v[156:159], 0
    v_mfma_f32_16x16x32_bf16 v[108:111], v[138:141], v[160:163], v[108:111]
    v_mfma_f32_16x16x32_bf16 v[112:115], v[56:59], v[156:159], 0
    v_mfma_f32_16x16x32_bf16 v[112:115], v[140:143], v[160:163], v[112:115]
    s_nop 3
    v_rcp_f32 v100, v116
    s_nop 0
    v_mov_b32 v101, v100
    v_pk_mul_f32 v[108:109], v[108:109], v[100:101]
    v_pk_mul_f32 v[110:111], v[110:111], v[100:101]
    v_pk_mul_f32 v[112:113], v[112:113], v[100:101]
    v_pk_mul_f32 v[114:115], v[114:115], v[100:101]
    v_cvt_pk_bf16_f32 v108, v108, v109
    v_cvt_pk_bf16_f32 v109, v110, v111
    v_cvt_pk_bf16_f32 v110, v112, v113
    v_cvt_pk_bf16_f32 v111, v114, v115
    v_max_u32 v108, 1, v108
    v_max_u32 v109, 1, v109
    v_max_u32 v110, 1, v110
    v_max_u32 v111, 1, v111
    s_mov_b64 exec, s[42:43]
    buffer_store_dwordx4 v[108:111], v27, s[4:7], s33 offen sc1
    s_mov_b64 exec, -1
    v_mov_b64 v[68:69], 0
    v_mov_b64 v[70:71], 0
    v_mov_b64 v[72:73], 0
    v_mov_b64 v[74:75], 0
    v_mov_b64 v[76:77], 0
    v_mov_b64 v[78:79], 0
    v_mov_b64 v[80:81], 0
    v_mov_b64 v[82:83], 0
    v_mov_b64 v[84:85], 0
    v_mov_b64 v[86:87], 0
    v_mov_b64 v[88:89], 0
    v_mov_b64 v[90:91], 0
rec_cs_30:
    s_barrier
    buffer_load_dwordx4 v[36:39], v12, s[4:7], s33 offen offset:0 sc1
    s_nop 3
    buffer_load_dwordx4 v[40:43], v12, s[4:7], s33 offen offset:1024 sc1
    s_nop 3
    buffer_load_dwordx4 v[44:47], v12, s[4:7], s33 offen offset:2048 sc1
    s_nop 3
    buffer_load_dwordx4 v[48:51], v12, s[4:7], s33 offen offset:3072 sc1
    s_nop 3
    buffer_load_dwordx4 v[52:55], v13, s[4:7], s33 offen offset:0 sc1
    s_nop 3
    buffer_load_dwordx4 v[56:59], v13, s[4:7], s33 offen offset:1024 sc1
    s_nop 3
    buffer_load_dwordx4 v[60:63], v13, s[4:7], s33 offen offset:2048 sc1
    s_nop 3
    buffer_load_dwordx4 v[64:67], v13, s[4:7], s33 offen offset:3072 sc1
    s_waitcnt vmcnt(7)
    v_smfmac_f32_16x16x64_bf16 v[68:71], v[36:39], a[192:199], v5
    v_min_u32 v31, v36, v37
    v_smfmac_f32_16x16x64_bf16 v[72:75], v[36:39], a[200:207], v5
    v_min_u32 v4, v38, v39
    s_add_u32 s38, s32, 1
    s_cmp_gt_u32 s94, s38
    s_cbranch_scc0 rec_kv_33
rec_kvd_34:
    s_xor_b32 s51, s51, 4096
    s_add_u32 m0, s51, s3
    s_add_u32 s37, s37, 262144
    buffer_load_dwordx4 v30, s[4:7], s37 offen sc1 lds
    s_waitcnt vmcnt(7)
    v_smfmac_f32_16x16x64_bf16 v[68:71], v[40:43], a[208:215], v5
    v_min3_u32 v31, v31, v40, v41
    v_smfmac_f32_16x16x64_bf16 v[72:75], v[40:43], a[216:223], v5
    v_min3_u32 v4, v4, v42, v43
    buffer_load_dword v3, v92, s[4:7], s36 offen sc1
    s_waitcnt vmcnt(7)
    v_smfmac_f32_16x16x64_bf16 v[68:71], v[44:47], a[224:231], v5
    v_min3_u32 v31, v31, v44, v45
    v_smfmac_f32_16x16x64_bf16 v[72:75], v[44:47], a[232:239], v5
    v_min3_u32 v4, v4, v46, v47
    s_waitcnt vmcnt(6)
    v_smfmac_f32_16x16x64_bf16 v[68:71], v[48:51], a[240:247], v5
    v_min3_u32 v31, v31, v48, v49
    v_smfmac_f32_16x16x64_bf16 v[72:75], v[48:51], a[248:255], v5
    v_min3_u32 v4, v4, v50, v51
    s_waitcnt vmcnt(5)
    v_smfmac_f32_16x16x64_bf16 v[68:71], v[52:55], v[192:199], v5
    v_min3_u32 v31, v31, v52, v53
    v_smfmac_f32_16x16x64_bf16 v[72:75], v[52:55], v[200:207], v5
    v_min3_u32 v4, v4, v54, v55
    s_waitcnt vmcnt(4)
    v_smfmac_f32_16x16x64_bf16 v[68:71], v[56:59], v[208:215], v5
    v_min3_u32 v31, v31, v56, v57
    v_smfmac_f32_16x16x64_bf16 v[72:75], v[56:59], v[216:223], v5
    v_min3_u32 v4, v4, v58, v59
    s_waitcnt vmcnt(3)
    v_smfmac_f32_16x16x64_bf16 v[68:71], v[60:63], v[224:231], v5
    v_min3_u32 v31, v31, v60, v61
    v_smfmac_f32_16x16x64_bf16 v[72:75], v[60:63], v[232:239], v5
    v_min3_u32 v4, v4, v62, v63
    v_min_u32 v31, v31, v4
    s_waitcnt vmcnt(2)
    v_min3_u32 v31, v31, v64, v65
    v_smfmac_f32_16x16x64_bf16 v[68:71], v[64:67], v[240:247], v5
    v_min3_u32 v31, v31, v66, v67
    v_smfmac_f32_16x16x64_bf16 v[72:75], v[64:67], v[248:255], v5
    v_cmp_eq_u32 vcc, 0, v31
    s_add_u32 s32, s32, 1
    s_add_u32 s38, s32, 2
    s_lshr_b32 s39, s38, 3
    s_lshr_b32 s39, s48, s39
    s_cbranch_vccnz rec_gcfix_32
rec_gcok_31:
    s_mov_b32 s33, s34
    s_mov_b32 s34, s35
    s_nop 0
    v_pk_add_f32 v[68:69], v[68:69], v[70:71]
    s_nop 1
    v_add_f32_dpp v68, v72, v74 quad_perm:[0,1,2,3] row_mask:0xc bank_mask:0xf
    v_add_f32_dpp v69, v73, v75 quad_perm:[0,1,2,3] row_mask:0xc bank_mask:0xf
    s_nop 1
    v_permlane32_swap_b32 v68, v69
    v_add_f32 v68, v68, v69
    ds_write_b32 v28, v68
    s_and_b32 s35, s39, 1
    s_lshl_b32 s35, s35, 13
    s_lshl_b32 s40, s38, 18
    s_add_u32 s35, s35, s40
    s_add_u32 s35, s35, s49
    s_add_u32 s36, s36, 262144
    s_cmp_lg_u32 s31, 0
    s_cbranch_scc1 rec_b4_35
    s_waitcnt lgkmcnt(0)
    s_barrier
    ds_read_b64 v[100:101], v29 offset:0
    ds_read_b64 v[102:103], v29 offset:256
    ds_read_b64 v[104:105], v29 offset:512
    ds_read_b64 v[106:107], v29 offset:768
    v_add_u32 v134, 2, v134
    s_waitcnt lgkmcnt(0)
    v_pk_add_f32 v[100:101], v[100:101], v[102:103]
    v_pk_add_f32 v[104:105], v[104:105], v[106:107]
    v_pk_add_f32 v[100:101], v[100:101], v[104:105]
    v_cvt_pk_bf16_f32 v100, v100, v101
    v_max_u32 v100, 1, v100
    s_nop 1
    v_mov_b32_dpp v101, v100 quad_perm:[1,1,1,1] row_mask:0xf bank_mask:0xf
    v_mov_b32_dpp v102, v100 quad_perm:[2,2,2,2] row_mask:0xf bank_mask:0xf
    v_mov_b32_dpp v103, v100 quad_perm:[3,3,3,3] row_mask:0xf bank_mask:0xf
    s_mov_b64 exec, 0x11111111
    buffer_store_dwordx4 v[100:103], v6, s[4:7], s33 offen sc1
    s_mov_b64 exec, -1
    s_barrier
    buffer_store_dwordx4 v[180:183], v93, s[4:7], s88 offen sc1
    s_add_u32 s98, s98, s99
    s_add_u32 s38, s32, 3
    s_min_u32 s38, s38, 63
    s_cmp_gt_u32 s94, s38
    s_cbranch_scc1 rec_rf_36
    s_load_dword s94, s[90:91], s95 glc
rec_rf_36:
    s_add_u32 s88, s88, s89
    s_cmp_eq_u32 s31, 3
    s_cselect_b32 s88, s35, s88
    v_mov_b64 v[68:69], 0
    v_mov_b64 v[70:71], 0
    v_mov_b64 v[72:73], 0
    v_mov_b64 v[74:75], 0
    s_waitcnt vmcnt(2)
    s_branch rec_loop_19
rec_b4_35:
    s_waitcnt lgkmcnt(0)
    s_barrier
    buffer_store_dword v134, v133, s[4:7], 0 offen sc1
    s_cmp_eq_u32 s31, 3
    s_cbranch_scc1 rec_w3b_37
    v_add_u32 v134, 2, v134
    v_mov_b64 v[68:69], 0
    v_mov_b64 v[70:71], 0
    v_mov_b64 v[72:73], 0
    v_mov_b64 v[74:75], 0
    s_barrier
    buffer_store_dwordx4 v[180:183], v93, s[4:7], s88 offen sc1
    buffer_store_dwordx4 v[188:191], v26, s[4:7], s98 offen sc1
    s_add_u32 s98, s98, s99
    s_nop 0
    v_add_u32 v188, s45, v188
    s_add_u32 s38, s32, 3
    s_min_u32 s38, s38, 63
    s_cmp_gt_u32 s94, s38
    s_cbranch_scc1 rec_rf_38
    s_load_dword s94, s[90:91], s95 glc
rec_rf_38:
    s_add_u32 s88, s88, s89
    s_cmp_eq_u32 s31, 3
    s_cselect_b32 s88, s35, s88
    s_waitcnt vmcnt(2)
    s_branch rec_loop_19
rec_w3b_37:
    v_add_u32 v134, 2, v134
    v_mov_b64 v[68:69], 0
    v_mov_b64 v[70:71], 0
    v_mov_b64 v[72:73], 0
    v_mov_b64 v[74:75], 0
    s_load_dword s72, s[90:91], s44 glc
    s_barrier
    s_load_dword s72, s[90:91], s44 glc
    buffer_store_dwordx4 v[180:183], v93, s[4:7], s88 offen sc1
    s_add_u32 s98, s98, s99
    s_add_u32 s38, s32, 3
    s_min_u32 s38, s38, 63
    s_cmp_gt_u32 s94, s38
    s_cbranch_scc1 rec_rf_39
    s_load_dword s94, s[90:91], s95 glc
rec_rf_39:
    s_add_u32 s88, s88, s89
    s_cmp_eq_u32 s31, 3
    s_cselect_b32 s88, s35, s88
    s_load_dword s72, s[90:91], s44 glc
    s_waitcnt vmcnt(2)
    s_branch rec_tkc_42
rec_tk_40:
    s_load_dword s72, s[90:91], s44 glc
    s_add_u32 s41, s41, 1
    s_cmp_ge_u32 s41, 0x80000
    s_cbranch_scc1 rec_tkd_41
    s_sleep 1
rec_tkc_42:
    s_mov_b32 s38, s72
    s_cmp_lt_u32 s38, s54
    s_cbranch_scc1 rec_tk_40
rec_tkd_41:
    s_add_u32 s54, s54, 1
    s_sleep 1
    s_branch rec_loop_19
rec_kv_16:
    s_load_dword s94, s[90:91], s95 glc
    s_add_u32 s41, s41, 1
    s_cmp_ge_u32 s41, 0x80000
    s_cbranch_scc1 rec_kvd_17
    s_waitcnt lgkmcnt(0)
    s_cmp_gt_u32 s94, 0
    s_cbranch_scc1 rec_kvd_17
    s_sleep 2
    s_branch rec_kv_16
rec_gafix_22:
    s_add_u32 s41, s41, 1
    s_cmp_ge_u32 s41, 0x80000
    s_cbranch_scc1 rec_gaok_21
    buffer_load_dwordx4 v[36:39], v7, s[4:7], s33 offen offset:0 sc1
    buffer_load_dwordx4 v[40:43], v7, s[4:7], s33 offen offset:1024 sc1
    buffer_load_dwordx4 v[44:47], v7, s[4:7], s33 offen offset:2048 sc1
    buffer_load_dwordx4 v[48:51], v7, s[4:7], s33 offen offset:3072 sc1
    v_mov_b64 v[68:69], 0
    v_mov_b64 v[70:71], 0
    v_mov_b64 v[72:73], 0
    v_mov_b64 v[74:75], 0
    v_mov_b64 v[76:77], 0
    v_mov_b64 v[78:79], 0
    v_mov_b64 v[80:81], 0
    v_mov_b64 v[82:83], 0
    s_waitcnt vmcnt(3)
    v_smfmac_f32_16x16x64_bf16 v[68:71], v[36:39], a[0:7], v5
    v_min_u32 v31, v36, v37
    v_smfmac_f32_16x16x64_bf16 v[72:75], v[36:39], a[8:15], v5
    v_min_u32 v4, v38, v39
    v_smfmac_f32_16x16x64_bf16 v[76:79], v[36:39], a[16:23], v5
    v_smfmac_f32_16x16x64_bf16 v[80:83], v[36:39], a[24:31], v5
    s_waitcnt vmcnt(2)
    v_smfmac_f32_16x16x64_bf16 v[68:71], v[40:43], a[48:55], v5
    v_min3_u32 v31, v31, v40, v41
    v_smfmac_f32_16x16x64_bf16 v[72:75], v[40:43], a[56:63], v5
    v_min3_u32 v4, v4, v42, v43
    v_smfmac_f32_16x16x64_bf16 v[76:79], v[40:43], a[64:71], v5
    v_smfmac_f32_16x16x64_bf16 v[80:83], v[40:43], a[72:79], v5
    s_waitcnt vmcnt(1)
    v_smfmac_f32_16x16x64_bf16 v[68:71], v[44:47], a[96:103], v5
    v_min3_u32 v31, v31, v44, v45
    v_smfmac_f32_16x16x64_bf16 v[72:75], v[44:47], a[104:111], v5
    v_min3_u32 v4, v4, v46, v47
    v_smfmac_f32_16x16x64_bf16 v[76:79], v[44:47], a[112:119], v5
    v_min_u32 v31, v31, v4
    v_smfmac_f32_16x16x64_bf16 v[80:83], v[44:47], a[120:127], v5
    s_waitcnt vmcnt(0)
    v_min3_u32 v31, v31, v48, v49
    v_smfmac_f32_16x16x64_bf16 v[68:71], v[48:51], a[144:151], v5
    v_min3_u32 v31, v31, v50, v51
    v_smfmac_f32_16x16x64_bf16 v[72:75], v[48:51], a[152:159], v5
    v_cmp_eq_u32 vcc, 0, v31
    v_smfmac_f32_16x16x64_bf16 v[76:79], v[48:51], a[160:167], v5
    v_smfmac_f32_16x16x64_bf16 v[80:83], v[48:51], a[168:175], v5
    s_cbranch_vccnz rec_gafix_22
    s_branch rec_gaok_21
rec_slow_25:
    s_mov_b64 exec, s[42:43]
    s_nop 0
    buffer_store_dwordx4 v[68:71], v19, s[4:7], s36 offen sc1
    buffer_store_dwordx4 v[72:75], v19, s[4:7], s36 offen offset:128 sc1
    s_mov_b64 exec, s[46:47]
    buffer_store_dwordx4 v[76:79], v20, s[4:7], s36 offen offset:1024 sc1
    s_mov_b64 exec, -1
    s_branch rec_slowr_26
rec_gbr_27:
    v_max3_u32 v31, v164, v165, v166
    v_max3_u32 v31, v31, v167, v168
    v_max3_u32 v31, v31, v169, v170
    v_max3_u32 v31, v31, v171, v172
    v_max3_u32 v31, v31, v173, v174
    v_max3_u32 v31, v31, v175, v176
    v_max3_u32 v31, v31, v177, v178
    v_max_u32 v31, v31, v179
    buffer_load_dwordx4 v[176:179], v21, s[4:7], s36 offen offset:1024 sc1
    buffer_load_dwordx4 v[164:167], v22, s[4:7], s36 offen sc1
    buffer_load_dwordx4 v[168:171], v23, s[4:7], s36 offen sc1
    buffer_load_dwordx4 v[172:175], v24, s[4:7], s36 offen sc1
    v_cmp_eq_u32 vcc, -1, v31
    s_add_u32 s41, s41, 1
    s_cmp_ge_u32 s41, 0x80000
    s_cbranch_scc1 rec_gbo_28
    s_cbranch_vccz rec_gbo_28
    s_waitcnt vmcnt(7)
    v_permlane32_swap_b32 v48, v50
    v_permlane32_swap_b32 v49, v51
    v_pk_add_f32 v[124:125], v[48:49], v[50:51]
    s_waitcnt vmcnt(6)
    v_pk_add_f32 v[120:121], v[68:69], v[36:37]
    v_pk_add_f32 v[122:123], v[70:71], v[38:39]
    v_permlane16_swap_b32 v124, v125
    s_waitcnt vmcnt(5)
    v_pk_add_f32 v[120:121], v[120:121], v[40:41]
    v_pk_add_f32 v[122:123], v[122:123], v[42:43]
    v_add_f32 v124, v124, v125
    s_waitcnt vmcnt(4)
    v_pk_add_f32 v[120:121], v[120:121], v[44:45]
    v_pk_add_f32 v[122:123], v[122:123], v[46:47]
    v_maximum3_f32 v135, v120, v121, v124
    v_maximum3_f32 v135, v135, v122, v123
    v_cmp_u_f32 vcc, v135, v135
    s_nop 0
    v_max_f32_dpp v135, v135, v135 row_ror:8 row_mask:0xf bank_mask:0xf
    v_mov_b32 v136, v135
    s_cbranch_vccz rec_gbo_28
    v_max3_u32 v31, v36, v37, v38
    v_max3_u32 v31, v31, v39, v40
    v_max3_u32 v31, v31, v41, v42
    v_max3_u32 v31, v31, v43, v44
    v_max3_u32 v31, v31, v45, v46
    v_max3_u32 v31, v31, v47, v48
    v_max3_u32 v31, v31, v49, v50
    v_max_u32 v31, v31, v51
    buffer_load_dwordx4 v[48:51], v21, s[4:7], s36 offen offset:1024 sc1
    buffer_load_dwordx4 v[36:39], v22, s[4:7], s36 offen sc1
    buffer_load_dwordx4 v[40:43], v23, s[4:7], s36 offen sc1
    buffer_load_dwordx4 v[44:47], v24, s[4:7], s36 offen sc1
    v_cmp_eq_u32 vcc, -1, v31
    s_add_u32 s41, s41, 1
    s_cmp_ge_u32 s41, 0x80000
    s_cbranch_scc1 rec_gbo_28
    s_cbranch_vccz rec_gbo_28
    s_waitcnt vmcnt(7)
    v_permlane32_swap_b32 v176, v178
    v_permlane32_swap_b32 v177, v179
    v_pk_add_f32 v[124:125], v[176:177], v[178:179]
    s_waitcnt vmcnt(6)
    v_pk_add_f32 v[120:121], v[68:69], v[164:165]
    v_pk_add_f32 v[122:123], v[70:71], v[166:167]
    v_permlane16_swap_b32 v124, v125
    s_waitcnt vmcnt(5)
    v_pk_add_f32 v[120:121], v[120:121], v[168:169]
    v_pk_add_f32 v[122:123], v[122:123], v[170:171]
    v_add_f32 v124, v124, v125
    s_waitcnt vmcnt(4)
    v_pk_add_f32 v[120:121], v[120:121], v[172:173]
    v_pk_add_f32 v[122:123], v[122:123], v[174:175]
    v_maximum3_f32 v135, v120, v121, v124
    v_maximum3_f32 v135, v135, v122, v123
    v_cmp_u_f32 vcc, v135, v135
    s_nop 0
    v_max_f32_dpp v135, v135, v135 row_ror:8 row_mask:0xf bank_mask:0xf
    v_mov_b32 v136, v135
    s_cbranch_vccz rec_gbo_28
    s_branch rec_gbr_27
rec_w1_24:
    s_waitcnt lgkmcnt(0)
    s_barrier
    v_smfmac_f32_16x16x64_bf16 v[84:87], v[36:39], a[32:39], v5
    v_smfmac_f32_16x16x64_bf16 v[88:91], v[36:39], a[40:47], v5
    v_smfmac_f32_16x16x64_bf16 v[84:87], v[40:43], a[80:87], v5
    v_smfmac_f32_16x16x64_bf16 v[88:91], v[40:43], a[88:95], v5
    v_smfmac_f32_16x16x64_bf16 v[84:87], v[44:47], a[128:135], v5
    v_smfmac_f32_16x16x64_bf16 v[88:91], v[44:47], a[136:143], v5
    v_smfmac_f32_16x16x64_bf16 v[84:87], v[48:51], a[176:183], v5
    v_smfmac_f32_16x16x64_bf16 v[88:91], v[48:51], a[184:191], v5
    s_nop 6
    v_pk_add_f32 v[84:85], v[84:85], v[86:87]
    v_pk_add_f32 v[86:87], v[88:89], v[90:91]
    ds_write_b128 v17, v[84:87]
    s_waitcnt lgkmcnt(0)
    s_barrier
    v_mov_b64 v[68:69], 0
    v_mov_b64 v[70:71], 0
    v_mov_b64 v[72:73], 0
    v_mov_b64 v[74:75], 0
    v_mov_b64 v[76:77], 0
    v_mov_b64 v[78:79], 0
    v_mov_b64 v[80:81], 0
    v_mov_b64 v[82:83], 0
    v_mov_b64 v[84:85], 0
    v_mov_b64 v[86:87], 0
    v_mov_b64 v[88:89], 0
    v_mov_b64 v[90:91], 0
    s_cmp_eq_u32 s31, 3
    s_cbranch_scc1 rec_w3_44
    s_cmp_eq_u32 s31, 2
    s_cbranch_scc1 rec_w2_43
    ds_read_b128 v[180:183], v16 offset:15360
    s_branch rec_b2_23
rec_w2_43:
    ds_read_b128 v[100:103], v16 offset:10240
    ds_read_b128 v[104:107], v16 offset:11264
    ds_read_b128 v[108:111], v16 offset:12288
    ds_read_b128 v[112:115], v16 offset:13312
    s_waitcnt lgkmcnt(0)
    v_pk_add_f32 v[100:101], v[100:101], v[104:105]
    v_pk_add_f32 v[102:103], v[102:103], v[106:107]
    v_pk_add_f32 v[108:109], v[108:109], v[112:113]
    v_pk_add_f32 v[110:111], v[110:111], v[114:115]
    v_pk_add_f32 v[100:101], v[100:101], v[108:109]
    v_pk_add_f32 v[102:103], v[102:103], v[110:111]
    v_cvt_pk_bf16_f32 v180, v100, v101
    v_cvt_pk_bf16_f32 v181, v102, v103
    s_nop 0
    v_permlane32_swap_b32 v180, v182
    v_permlane32_swap_b32 v181, v183
    s_nop 1
    v_permlane16_swap_b32 v180, v181
    v_permlane16_swap_b32 v182, v183
rec_b2_23:
    s_waitcnt lgkmcnt(0)
    s_cmp_eq_u32 s32, 63
    s_cbranch_scc1 rec_done_20
    s_branch rec_cs_30
rec_w3_44:
    s_cmp_eq_u32 s32, 63
    s_cbranch_scc1 rec_done_20
    s_branch rec_tkc_47
rec_tk_45:
    s_load_dwordx8 s[72:79], s[90:91], s55 glc
    s_add_u32 s41, s41, 1
    s_cmp_ge_u32 s41, 0x80000
    s_cbranch_scc1 rec_tkd_46
    s_sleep 1
rec_tkc_47:
    s_min_u32 s38, s72, s76
    s_cmp_lt_u32 s38, s54
    s_cbranch_scc1 rec_tk_45
rec_tkd_46:
    s_add_u32 s54, s54, 1
    s_branch rec_cs_30
rec_kv_33:
    s_load_dword s94, s[90:91], s95 glc
    s_add_u32 s41, s41, 1
    s_cmp_ge_u32 s41, 0x80000
    s_cbranch_scc1 rec_kvd_34
    s_waitcnt lgkmcnt(0)
    s_cmp_gt_u32 s94, s38
    s_cbranch_scc1 rec_kvd_34
    s_sleep 2
    s_branch rec_kv_33
rec_gcfix_32:
    s_add_u32 s41, s41, 1
    s_cmp_ge_u32 s41, 0x80000
    s_cbranch_scc1 rec_gcok_31
    buffer_load_dwordx4 v[36:39], v12, s[4:7], s33 offen offset:0 sc1
    buffer_load_dwordx4 v[40:43], v12, s[4:7], s33 offen offset:1024 sc1
    buffer_load_dwordx4 v[44:47], v12, s[4:7], s33 offen offset:2048 sc1
    buffer_load_dwordx4 v[48:51], v12, s[4:7], s33 offen offset:3072 sc1
    buffer_load_dwordx4 v[52:55], v13, s[4:7], s33 offen offset:0 sc1
    buffer_load_dwordx4 v[56:59], v13, s[4:7], s33 offen offset:1024 sc1
    buffer_load_dwordx4 v[60:63], v13, s[4:7], s33 offen offset:2048 sc1
    buffer_load_dwordx4 v[64:67], v13, s[4:7], s33 offen offset:3072 sc1
    v_mov_b64 v[68:69], 0
    v_mov_b64 v[70:71], 0
    v_mov_b64 v[72:73], 0
    v_mov_b64 v[74:75], 0
    s_waitcnt vmcnt(7)
    v_smfmac_f32_16x16x64_bf16 v[68:71], v[36:39], a[192:199], v5
    v_min_u32 v31, v36, v37
    v_smfmac_f32_16x16x64_bf16 v[72:75], v[36:39], a[200:207], v5
    v_min_u32 v4, v38, v39
    s_waitcnt vmcnt(6)
    v_smfmac_f32_16x16x64_bf16 v[68:71], v[40:43], a[208:215], v5
    v_min3_u32 v31, v31, v40, v41
    v_smfmac_f32_16x16x64_bf16 v[72:75], v[40:43], a[216:223], v5
    v_min3_u32 v4, v4, v42, v43
    s_waitcnt vmcnt(5)
    v_smfmac_f32_16x16x64_bf16 v[68:71], v[44:47], a[224:231], v5
    v_min3_u32 v31, v31, v44, v45
    v_smfmac_f32_16x16x64_bf16 v[72:75], v[44:47], a[232:239], v5
    v_min3_u32 v4, v4, v46, v47
    s_waitcnt vmcnt(4)
    v_smfmac_f32_16x16x64_bf16 v[68:71], v[48:51], a[240:247], v5
    v_min3_u32 v31, v31, v48, v49
    v_smfmac_f32_16x16x64_bf16 v[72:75], v[48:51], a[248:255], v5
    v_min3_u32 v4, v4, v50, v51
    s_waitcnt vmcnt(3)
    v_smfmac_f32_16x16x64_bf16 v[68:71], v[52:55], v[192:199], v5
    v_min3_u32 v31, v31, v52, v53
    v_smfmac_f32_16x16x64_bf16 v[72:75], v[52:55], v[200:207], v5
    v_min3_u32 v4, v4, v54, v55
    s_waitcnt vmcnt(2)
    v_smfmac_f32_16x16x64_bf16 v[68:71], v[56:59], v[208:215], v5
    v_min3_u32 v31, v31, v56, v57
    v_smfmac_f32_16x16x64_bf16 v[72:75], v[56:59], v[216:223], v5
    v_min3_u32 v4, v4, v58, v59
    s_waitcnt vmcnt(1)
    v_smfmac_f32_16x16x64_bf16 v[68:71], v[60:63], v[224:231], v5
    v_min3_u32 v31, v31, v60, v61
    v_smfmac_f32_16x16x64_bf16 v[72:75], v[60:63], v[232:239], v5
    v_min3_u32 v4, v4, v62, v63
    v_min_u32 v31, v31, v4
    s_waitcnt vmcnt(0)
    v_min3_u32 v31, v31, v64, v65
    v_smfmac_f32_16x16x64_bf16 v[68:71], v[64:67], v[240:247], v5
    v_min3_u32 v31, v31, v66, v67
    v_smfmac_f32_16x16x64_bf16 v[72:75], v[64:67], v[248:255], v5
    v_cmp_eq_u32 vcc, 0, v31
    s_cbranch_vccnz rec_gcfix_32
    s_branch rec_gcok_31
rec_done_20:
    buffer_store_dwordx4 v[180:183], v93, s[4:7], s88 offen sc1
    s_waitcnt vmcnt(0)
    s_barrier
    v_add_u32 v188, 1, v188
    buffer_store_dword v188, v137, s[4:7], 0 offen sc1
    s_endpgm
L_gem:
    s_mov_b32 s6, L_end - L_gem - 16
    s_load_dwordx2 s[90:91], s[0:1], 96
    s_load_dwordx2 s[92:93], s[0:1], 88
    v_and_b32 v1, 63, v0
    v_lshrrev_b32 v2, 6, v0
    s_nop 0
    v_readfirstlane_b32 s29, v2
    v_lshlrev_b32 v5, 4, v1
    s_mov_b32 s41, 0
    s_lshl_b32 s34, s29, 10
    s_waitcnt lgkmcnt(0)
    s_mov_b32 s4, s90
    s_and_b32 s5, s91, 0xffff
    s_mov_b32 s6, 268435456
    s_mov_b32 s7, 0x00020000
    v_mov_b32 v31, 0
    s_cmp_lt_u32 s28, 96
    s_cbranch_scc1 g_nv_48
    s_branch valc_50
val_49:
    v_mov_b32 v2, 0
    global_load_dword v31, v2, s[92:93] offset:192 sc1
    s_add_u32 s41, s41, 1
    s_cmp_ge_u32 s41, 0x80000
    s_cbranch_scc1 L_end
    s_waitcnt vmcnt(0)
valc_50:
    v_readfirstlane_b32 s31, v31
    s_cmp_eq_u32 s31, s70
    s_cbranch_scc1 valok_51
    s_cmp_eq_u32 s31, 0
    s_cbranch_scc1 val_49
    s_mov_b32 s70, s31
    s_mov_b32 s71, 1048576
    s_waitcnt vmcnt(0) lgkmcnt(0)
    s_barrier
    s_branch L_role
valok_51:
g_nv_48:
    s_cmp_ge_u32 s28, 120
    s_cbranch_scc1 L_att
    s_cmp_ge_u32 s28, 96
    s_cbranch_scc1 sl_b_52
    s_lshr_b32 s31, s28, 5
    s_add_u32 s31, s31, 1
    s_cmp_eq_u32 s31, 3
    s_cselect_b32 s44, 0, s31
    s_lshl_b32 s31, s44, 3
    s_add_u32 s31, s31, 16
    s_load_dwordx2 s[72:73], s[0:1], s31
    s_load_dwordx2 s[74:75], s[0:1], 0
    s_mov_b32 s76, 8388608
    s_mov_b32 s39, 8192
    s_and_b32 s31, s28, 31
    s_lshl_b32 s31, s31, 8
    s_lshl_b32 s36, s44, 24
    s_and_b32 s33, s28, 31
    s_lshl_b32 s33, s33, 13
    s_add_u32 s36, s36, s33
    s_mov_b32 s37, 262144
    s_and_b32 s50, s28, 31
    s_lshl_b32 s50, s50, 7
    s_lshl_b32 s33, s44, 2
    s_add_u32 s50, s50, s33
    s_add_u32 s50, s50, 115343360
    s_branch sl_c_53
sl_b_52:
    s_sub_u32 s32, s28, 96
    s_lshr_b32 s44, s32, 3
    s_load_dwordx2 s[72:73], s[0:1], 64
    s_load_dwordx2 s[74:75], s[0:1], 56
    s_mov_b32 s76, 6291456
    s_mov_b32 s39, 6144
    s_lshl_b32 s31, s32, 8
    s_lshl_b32 s36, s44, 22
    s_and_b32 s33, s32, 7
    s_lshl_b32 s33, s33, 13
    s_add_u32 s36, s36, s33
    s_add_u32 s36, s36, 50331648
    s_mov_b32 s37, 65536
    s_and_b32 s50, s32, 7
    s_lshl_b32 s50, s50, 7
    s_lshl_b32 s33, s44, 2
    s_add_u32 s50, s50, s33
    s_add_u32 s50, s50, 115347456
sl_c_53:
    s_waitcnt lgkmcnt(0)
    s_mov_b32 s8, s72
    s_and_b32 s9, s73, 0xffff
    s_mov_b32 s10, s76
    s_mov_b32 s11, 0x00020000
    s_mov_b32 s12, s74
    s_and_b32 s13, s75, 0xffff
    s_mov_b32 s14, 4194304
    s_mov_b32 s15, 0x00020000
    s_mov_b64 s[80:81], s[72:73]
    s_mov_b32 s45, s31
    s_cmp_lt_u32 s28, 96
    s_cbranch_scc1 sl_go_54
    s_cmp_lg_u32 s29, 0
    s_cbranch_scc1 sl_a2_55
    s_mov_b64 exec, 1
    v_mov_b32 v2, 0
    buffer_store_dword v2, v2, s[4:7], s50 offen sc1
    v_mov_b32 v2, 0
    s_add_u32 s71, s71, 1
    v_mov_b32 v3, s71
    s_waitcnt vmcnt(0)
    global_atomic_add v2, v3, s[92:93] offset:0 sc1
    s_mov_b64 exec, -1
sl_a2_55:
    s_cmp_lt_u32 s28, 96
    s_cbranch_scc1 tw_skip_56
    s_load_dwordx2 s[72:73], s[0:1], 40
    s_and_b32 s31, s28, 31
    s_lshl_b32 s31, s31, 13
    s_lshl_b32 s33, s29, 21
    s_add_u32 s31, s31, s33
    v_lshl_add_u32 v2, v1, 7, s31
    s_waitcnt lgkmcnt(0)
    s_mov_b32 s8, s72
    s_and_b32 s9, s73, 0xffff
    s_mov_b32 s10, 8388608
    s_mov_b32 s11, 0x00020000
    s_mov_b32 s31, 0
    buffer_load_dword v128, v2, s[8:11], s31 offen
    s_mov_b32 s31, 262144
    buffer_load_dword v129, v2, s[8:11], s31 offen
    s_mov_b32 s31, 524288
    buffer_load_dword v130, v2, s[8:11], s31 offen
    s_mov_b32 s31, 786432
    buffer_load_dword v131, v2, s[8:11], s31 offen
    s_mov_b32 s31, 1048576
    buffer_load_dword v132, v2, s[8:11], s31 offen
    s_mov_b32 s31, 1310720
    buffer_load_dword v133, v2, s[8:11], s31 offen
    s_mov_b32 s31, 1572864
    buffer_load_dword v134, v2, s[8:11], s31 offen
    s_mov_b32 s31, 1835008
    buffer_load_dword v135, v2, s[8:11], s31 offen
tw_skip_56:
    s_mov_b32 s8, s80
    s_and_b32 s9, s81, 0xffff
    s_mov_b32 s10, s76
    s_mov_b32 s11, 0x00020000
    s_cmp_lg_u32 s29, 0
    s_cbranch_scc1 g_wdd_58
g_wd_57:
    s_load_dword s84, s[92:93], 128 glc
    s_add_u32 s41, s41, 1
    s_cmp_ge_u32 s41, 0x200000
    s_cbranch_scc1 g_wdd_58
    s_waitcnt lgkmcnt(0)
    s_and_b32 s84, s84, 1023
    s_cmp_ge_u32 s84, 96
    s_cbranch_scc1 g_wdd_58
    s_sleep 32
    s_branch g_wd_57
g_wdd_58:
    s_waitcnt lgkmcnt(0)
    s_barrier
sl_go_54:
    v_lshrrev_b32 v2, 2, v1
    v_mul_lo_u32 v6, v2, s39
    s_mov_b32 s31, s45
    s_lshl_b32 s33, s29, 6
    s_add_u32 s31, s31, s33
    v_and_b32 v2, 3, v1
    v_lshlrev_b32 v2, 4, v2
    v_add_u32 v2, s31, v2
    v_add_u32 v6, v6, v2
    s_lshl_b32 s39, s39, 4
    s_mov_b32 s30, 0
    s_mov_b32 s51, 64
    s_mov_b32 s52, 4128768
    s_lshl_b32 s31, s29, 15
    v_lshrrev_b32 v7, 4, v1
    v_lshlrev_b32 v7, 9, v7
    v_bfe_u32 v4, v1, 2, 2
    v_lshl_add_u32 v7, v4, 6, v7
    v_bfe_u32 v4, v1, 1, 1
    v_lshl_add_u32 v7, v4, 5, v7
    v_and_b32 v4, 1, v1
    v_lshl_add_u32 v7, v4, 3, v7
    v_add_u32 v7, s31, v7
    s_lshl_b32 s32, s29, 15
    s_add_u32 m0, s32, 0
    s_mov_b32 s38, 0
    buffer_load_dwordx4 v6, s[8:11], s38 offen lds
    s_add_u32 m0, s32, 1024
    s_add_u32 s38, s38, s39
    buffer_load_dwordx4 v6, s[8:11], s38 offen lds
    s_add_u32 m0, s32, 2048
    s_add_u32 s38, s38, s39
    buffer_load_dwordx4 v6, s[8:11], s38 offen lds
    s_add_u32 m0, s32, 3072
    s_add_u32 s38, s38, s39
    buffer_load_dwordx4 v6, s[8:11], s38 offen lds
    s_add_u32 m0, s32, 4096
    s_add_u32 s38, s38, s39
    buffer_load_dwordx4 v6, s[8:11], s38 offen lds
    s_add_u32 m0, s32, 5120
    s_add_u32 s38, s38, s39
    buffer_load_dwordx4 v6, s[8:11], s38 offen lds
    s_add_u32 m0, s32, 6144
    s_add_u32 s38, s38, s39
    buffer_load_dwordx4 v6, s[8:11], s38 offen lds
    s_add_u32 m0, s32, 7168
    s_add_u32 s38, s38, s39
    buffer_load_dwordx4 v6, s[8:11], s38 offen lds
    s_add_u32 m0, s32, 8192
    s_add_u32 s38, s38, s39
    buffer_load_dwordx4 v6, s[8:11], s38 offen lds
    s_add_u32 m0, s32, 9216
    s_add_u32 s38, s38, s39
    buffer_load_dwordx4 v6, s[8:11], s38 offen lds
    s_add_u32 m0, s32, 10240
    s_add_u32 s38, s38, s39
    buffer_load_dwordx4 v6, s[8:11], s38 offen lds
    s_add_u32 m0, s32, 11264
    s_add_u32 s38, s38, s39
    buffer_load_dwordx4 v6, s[8:11], s38 offen lds
    s_add_u32 m0, s32, 12288
    s_add_u32 s38, s38, s39
    buffer_load_dwordx4 v6, s[8:11], s38 offen lds
    s_add_u32 m0, s32, 13312
    s_add_u32 s38, s38, s39
    buffer_load_dwordx4 v6, s[8:11], s38 offen lds
    s_add_u32 m0, s32, 14336
    s_add_u32 s38, s38, s39
    buffer_load_dwordx4 v6, s[8:11], s38 offen lds
    s_add_u32 m0, s32, 15360
    s_add_u32 s38, s38, s39
    buffer_load_dwordx4 v6, s[8:11], s38 offen lds
    s_add_u32 m0, s32, 16384
    s_add_u32 s38, s38, s39
    buffer_load_dwordx4 v6, s[8:11], s38 offen lds
    s_add_u32 m0, s32, 17408
    s_add_u32 s38, s38, s39
    buffer_load_dwordx4 v6, s[8:11], s38 offen lds
    s_add_u32 m0, s32, 18432
    s_add_u32 s38, s38, s39
    buffer_load_dwordx4 v6, s[8:11], s38 offen lds
    s_add_u32 m0, s32, 19456
    s_add_u32 s38, s38, s39
    buffer_load_dwordx4 v6, s[8:11], s38 offen lds
    s_add_u32 m0, s32, 20480
    s_add_u32 s38, s38, s39
    buffer_load_dwordx4 v6, s[8:11], s38 offen lds
    s_add_u32 m0, s32, 21504
    s_add_u32 s38, s38, s39
    buffer_load_dwordx4 v6, s[8:11], s38 offen lds
    s_add_u32 m0, s32, 22528
    s_add_u32 s38, s38, s39
    buffer_load_dwordx4 v6, s[8:11], s38 offen lds
    s_add_u32 m0, s32, 23552
    s_add_u32 s38, s38, s39
    buffer_load_dwordx4 v6, s[8:11], s38 offen lds
    s_add_u32 m0, s32, 24576
    s_add_u32 s38, s38, s39
    buffer_load_dwordx4 v6, s[8:11], s38 offen lds
    s_add_u32 m0, s32, 25600
    s_add_u32 s38, s38, s39
    buffer_load_dwordx4 v6, s[8:11], s38 offen lds
    s_add_u32 m0, s32, 26624
    s_add_u32 s38, s38, s39
    buffer_load_dwordx4 v6, s[8:11], s38 offen lds
    s_add_u32 m0, s32, 27648
    s_add_u32 s38, s38, s39
    buffer_load_dwordx4 v6, s[8:11], s38 offen lds
    s_add_u32 m0, s32, 28672
    s_add_u32 s38, s38, s39
    buffer_load_dwordx4 v6, s[8:11], s38 offen lds
    s_add_u32 m0, s32, 29696
    s_add_u32 s38, s38, s39
    buffer_load_dwordx4 v6, s[8:11], s38 offen lds
    s_add_u32 m0, s32, 30720
    s_add_u32 s38, s38, s39
    buffer_load_dwordx4 v6, s[8:11], s38 offen lds
    s_add_u32 m0, s32, 31744
    s_add_u32 s38, s38, s39
    buffer_load_dwordx4 v6, s[8:11], s38 offen lds
    s_waitcnt vmcnt(30)
    ds_read_b64_tr_b16 a[0:1], v7 offset:0
    ds_read_b64_tr_b16 a[2:3], v7 offset:256
    ds_read_b64_tr_b16 a[4:5], v7 offset:16
    ds_read_b64_tr_b16 a[6:7], v7 offset:272
    s_waitcnt vmcnt(28)
    ds_read_b64_tr_b16 a[8:9], v7 offset:2048
    ds_read_b64_tr_b16 a[10:11], v7 offset:2304
    ds_read_b64_tr_b16 a[12:13], v7 offset:2064
    ds_read_b64_tr_b16 a[14:15], v7 offset:2320
    s_waitcnt lgkmcnt(4)
    s_add_u32 m0, s32, 0
    s_add_u32 s38, s38, s39
    buffer_load_dwordx4 v6, s[8:11], s38 offen lds
    s_add_u32 m0, s32, 1024
    s_add_u32 s38, s38, s39
    buffer_load_dwordx4 v6, s[8:11], s38 offen lds
    s_waitcnt vmcnt(28)
    v_mov_b32 v2, 0
    global_load_dword v31, v2, s[92:93] offset:192 sc1
    ds_read_b64_tr_b16 a[16:17], v7 offset:4096
    ds_read_b64_tr_b16 a[18:19], v7 offset:4352
    ds_read_b64_tr_b16 a[20:21], v7 offset:4112
    ds_read_b64_tr_b16 a[22:23], v7 offset:4368
    s_waitcnt lgkmcnt(4)
    s_add_u32 m0, s32, 2048
    s_add_u32 s38, s38, s39
    buffer_load_dwordx4 v6, s[8:11], s38 offen lds
    s_add_u32 m0, s32, 3072
    s_add_u32 s38, s38, s39
    buffer_load_dwordx4 v6, s[8:11], s38 offen lds
    s_waitcnt vmcnt(28)
    ds_read_b64_tr_b16 a[24:25], v7 offset:6144
    ds_read_b64_tr_b16 a[26:27], v7 offset:6400
    ds_read_b64_tr_b16 a[28:29], v7 offset:6160
    ds_read_b64_tr_b16 a[30:31], v7 offset:6416
    s_waitcnt lgkmcnt(4)
    s_add_u32 m0, s32, 4096
    s_add_u32 s38, s38, s39
    buffer_load_dwordx4 v6, s[8:11], s38 offen lds
    s_add_u32 m0, s32, 5120
    s_add_u32 s38, s38, s39
    buffer_load_dwordx4 v6, s[8:11], s38 offen lds
    s_waitcnt vmcnt(28)
    ds_read_b64_tr_b16 a[32:33], v7 offset:8192
    ds_read_b64_tr_b16 a[34:35], v7 offset:8448
    ds_read_b64_tr_b16 a[36:37], v7 offset:8208
    ds_read_b64_tr_b16 a[38:39], v7 offset:8464
    s_waitcnt lgkmcnt(4)
    s_add_u32 m0, s32, 6144
    s_add_u32 s38, s38, s39
    buffer_load_dwordx4 v6, s[8:11], s38 offen lds
    s_add_u32 m0, s32, 7168
    s_add_u32 s38, s38, s39
    buffer_load_dwordx4 v6, s[8:11], s38 offen lds
    s_waitcnt vmcnt(28)
    ds_read_b64_tr_b16 a[40:41], v7 offset:10240
    ds_read_b64_tr_b16 a[42:43], v7 offset:10496
    ds_read_b64_tr_b16 a[44:45], v7 offset:10256
    ds_read_b64_tr_b16 a[46:47], v7 offset:10512
    s_waitcnt lgkmcnt(4)
    s_add_u32 m0, s32, 8192
    s_add_u32 s38, s38, s39
    buffer_load_dwordx4 v6, s[8:11], s38 offen lds
    s_add_u32 m0, s32, 9216
    s_add_u32 s38, s38, s39
    buffer_load_dwordx4 v6, s[8:11], s38 offen lds
    s_waitcnt vmcnt(28)
    ds_read_b64_tr_b16 a[48:49], v7 offset:12288
    ds_read_b64_tr_b16 a[50:51], v7 offset:12544
    ds_read_b64_tr_b16 a[52:53], v7 offset:12304
    ds_read_b64_tr_b16 a[54:55], v7 offset:12560
    s_waitcnt lgkmcnt(4)
    s_add_u32 m0, s32, 10240
    s_add_u32 s38, s38, s39
    buffer_load_dwordx4 v6, s[8:11], s38 offen lds
    s_add_u32 m0, s32, 11264
    s_add_u32 s38, s38, s39
    buffer_load_dwordx4 v6, s[8:11], s38 offen lds
    s_waitcnt vmcnt(28)
    ds_read_b64_tr_b16 a[56:57], v7 offset:14336
    ds_read_b64_tr_b16 a[58:59], v7 offset:14592
    ds_read_b64_tr_b16 a[60:61], v7 offset:14352
    ds_read_b64_tr_b16 a[62:63], v7 offset:14608
    s_waitcnt lgkmcnt(4)
    s_add_u32 m0, s32, 12288
    s_add_u32 s38, s38, s39
    buffer_load_dwordx4 v6, s[8:11], s38 offen lds
    s_add_u32 m0, s32, 13312
    s_add_u32 s38, s38, s39
    buffer_load_dwordx4 v6, s[8:11], s38 offen lds
    s_waitcnt vmcnt(28)
    ds_read_b64_tr_b16 a[64:65], v7 offset:16384
    ds_read_b64_tr_b16 a[66:67], v7 offset:16640
    ds_read_b64_tr_b16 a[68:69], v7 offset:16400
    ds_read_b64_tr_b16 a[70:71], v7 offset:16656
    s_waitcnt lgkmcnt(4)
    s_add_u32 m0, s32, 14336
    s_add_u32 s38, s38, s39
    buffer_load_dwordx4 v6, s[8:11], s38 offen lds
    s_add_u32 m0, s32, 15360
    s_add_u32 s38, s38, s39
    buffer_load_dwordx4 v6, s[8:11], s38 offen lds
    s_waitcnt vmcnt(28)
    ds_read_b64_tr_b16 a[72:73], v7 offset:18432
    ds_read_b64_tr_b16 a[74:75], v7 offset:18688
    ds_read_b64_tr_b16 a[76:77], v7 offset:18448
    ds_read_b64_tr_b16 a[78:79], v7 offset:18704
    s_waitcnt lgkmcnt(4)
    s_add_u32 m0, s32, 16384
    s_add_u32 s38, s38, s39
    buffer_load_dwordx4 v6, s[8:11], s38 offen lds
    s_add_u32 m0, s32, 17408
    s_add_u32 s38, s38, s39
    buffer_load_dwordx4 v6, s[8:11], s38 offen lds
    s_waitcnt vmcnt(28)
    ds_read_b64_tr_b16 a[80:81], v7 offset:20480
    ds_read_b64_tr_b16 a[82:83], v7 offset:20736
    ds_read_b64_tr_b16 a[84:85], v7 offset:20496
    ds_read_b64_tr_b16 a[86:87], v7 offset:20752
    s_waitcnt lgkmcnt(4)
    s_add_u32 m0, s32, 18432
    s_add_u32 s38, s38, s39
    buffer_load_dwordx4 v6, s[8:11], s38 offen lds
    s_add_u32 m0, s32, 19456
    s_add_u32 s38, s38, s39
    buffer_load_dwordx4 v6, s[8:11], s38 offen lds
    s_waitcnt vmcnt(28)
    ds_read_b64_tr_b16 a[88:89], v7 offset:22528
    ds_read_b64_tr_b16 a[90:91], v7 offset:22784
    ds_read_b64_tr_b16 a[92:93], v7 offset:22544
    ds_read_b64_tr_b16 a[94:95], v7 offset:22800
    s_waitcnt lgkmcnt(4)
    s_add_u32 m0, s32, 20480
    s_add_u32 s38, s38, s39
    buffer_load_dwordx4 v6, s[8:11], s38 offen lds
    s_add_u32 m0, s32, 21504
    s_add_u32 s38, s38, s39
    buffer_load_dwordx4 v6, s[8:11], s38 offen lds
    s_waitcnt vmcnt(28)
    ds_read_b64_tr_b16 a[96:97], v7 offset:24576
    ds_read_b64_tr_b16 a[98:99], v7 offset:24832
    ds_read_b64_tr_b16 a[100:101], v7 offset:24592
    ds_read_b64_tr_b16 a[102:103], v7 offset:24848
    s_waitcnt lgkmcnt(4)
    s_add_u32 m0, s32, 22528
    s_add_u32 s38, s38, s39
    buffer_load_dwordx4 v6, s[8:11], s38 offen lds
    s_add_u32 m0, s32, 23552
    s_add_u32 s38, s38, s39
    buffer_load_dwordx4 v6, s[8:11], s38 offen lds
    s_waitcnt vmcnt(28)
    ds_read_b64_tr_b16 a[104:105], v7 offset:26624
    ds_read_b64_tr_b16 a[106:107], v7 offset:26880
    ds_read_b64_tr_b16 a[108:109], v7 offset:26640
    ds_read_b64_tr_b16 a[110:111], v7 offset:26896
    s_waitcnt lgkmcnt(4)
    s_add_u32 m0, s32, 24576
    s_add_u32 s38, s38, s39
    buffer_load_dwordx4 v6, s[8:11], s38 offen lds
    s_add_u32 m0, s32, 25600
    s_add_u32 s38, s38, s39
    buffer_load_dwordx4 v6, s[8:11], s38 offen lds
    s_waitcnt vmcnt(28)
    ds_read_b64_tr_b16 a[112:113], v7 offset:28672
    ds_read_b64_tr_b16 a[114:115], v7 offset:28928
    ds_read_b64_tr_b16 a[116:117], v7 offset:28688
    ds_read_b64_tr_b16 a[118:119], v7 offset:28944
    s_waitcnt lgkmcnt(4)
    s_add_u32 m0, s32, 26624
    s_add_u32 s38, s38, s39
    buffer_load_dwordx4 v6, s[8:11], s38 offen lds
    s_add_u32 m0, s32, 27648
    s_add_u32 s38, s38, s39
    buffer_load_dwordx4 v6, s[8:11], s38 offen lds
    s_waitcnt vmcnt(28)
    ds_read_b64_tr_b16 a[120:121], v7 offset:30720
    ds_read_b64_tr_b16 a[122:123], v7 offset:30976
    ds_read_b64_tr_b16 a[124:125], v7 offset:30736
    ds_read_b64_tr_b16 a[126:127], v7 offset:30992
    s_waitcnt lgkmcnt(4)
    s_add_u32 m0, s32, 28672
    s_add_u32 s38, s38, s39
    buffer_load_dwordx4 v6, s[8:11], s38 offen lds
    s_add_u32 m0, s32, 29696
    s_add_u32 s38, s38, s39
    buffer_load_dwordx4 v6, s[8:11], s38 offen lds
    s_waitcnt vmcnt(28)
    ds_read_b64_tr_b16 a[128:129], v7 offset:0
    ds_read_b64_tr_b16 a[130:131], v7 offset:256
    ds_read_b64_tr_b16 a[132:133], v7 offset:16
    ds_read_b64_tr_b16 a[134:135], v7 offset:272
    s_waitcnt lgkmcnt(4)
    s_add_u32 m0, s32, 30720
    s_add_u32 s38, s38, s39
    buffer_load_dwordx4 v6, s[8:11], s38 offen lds
    s_add_u32 m0, s32, 31744
    s_add_u32 s38, s38, s39
    buffer_load_dwordx4 v6, s[8:11], s38 offen lds
    s_waitcnt vmcnt(28)
    s_branch valc_61
val_60:
    v_mov_b32 v2, 0
    global_load_dword v31, v2, s[92:93] offset:192 sc1
    s_add_u32 s41, s41, 1
    s_cmp_ge_u32 s41, 0x80000
    s_cbranch_scc1 L_end
    s_waitcnt vmcnt(0)
valc_61:
    v_readfirstlane_b32 s31, v31
    s_cmp_eq_u32 s31, s70
    s_cbranch_scc1 valok_62
    s_cmp_eq_u32 s31, 0
    s_cbranch_scc1 val_60
    s_mov_b32 s70, s31
    s_mov_b32 s71, 1048576
    s_waitcnt vmcnt(0) lgkmcnt(0)
    s_barrier
    s_branch L_role
valok_62:
    s_cmp_lg_u32 s29, 0
    s_cbranch_scc1 sl_ar_59
    s_cmp_ge_u32 s28, 96
    s_cbranch_scc1 sl_ar_59
    s_mov_b64 exec, 1
    v_mov_b32 v2, 0
    buffer_store_dword v2, v2, s[4:7], s50 offen sc1
    s_mov_b64 exec, -1
sl_ar_59:
    ds_read_b64_tr_b16 a[136:137], v7 offset:2048
    ds_read_b64_tr_b16 a[138:139], v7 offset:2304
    ds_read_b64_tr_b16 a[140:141], v7 offset:2064
    ds_read_b64_tr_b16 a[142:143], v7 offset:2320
    s_waitcnt vmcnt(26)
    ds_read_b64_tr_b16 a[144:145], v7 offset:4096
    ds_read_b64_tr_b16 a[146:147], v7 offset:4352
    ds_read_b64_tr_b16 a[148:149], v7 offset:4112
    ds_read_b64_tr_b16 a[150:151], v7 offset:4368
    s_waitcnt vmcnt(24)
    ds_read_b64_tr_b16 a[152:153], v7 offset:6144
    ds_read_b64_tr_b16 a[154:155], v7 offset:6400
    ds_read_b64_tr_b16 a[156:157], v7 offset:6160
    ds_read_b64_tr_b16 a[158:159], v7 offset:6416
    s_waitcnt vmcnt(22)
    ds_read_b64_tr_b16 a[160:161], v7 offset:8192
    ds_read_b64_tr_b16 a[162:163], v7 offset:8448
    ds_read_b64_tr_b16 a[164:165], v7 offset:8208
    ds_read_b64_tr_b16 a[166:167], v7 offset:8464
    s_waitcnt vmcnt(20)
    ds_read_b64_tr_b16 a[168:169], v7 offset:10240
    ds_read_b64_tr_b16 a[170:171], v7 offset:10496
    ds_read_b64_tr_b16 a[172:173], v7 offset:10256
    ds_read_b64_tr_b16 a[174:175], v7 offset:10512
    s_waitcnt vmcnt(18)
    ds_read_b64_tr_b16 a[176:177], v7 offset:12288
    ds_read_b64_tr_b16 a[178:179], v7 offset:12544
    ds_read_b64_tr_b16 a[180:181], v7 offset:12304
    ds_read_b64_tr_b16 a[182:183], v7 offset:12560
    s_waitcnt vmcnt(16)
    ds_read_b64_tr_b16 a[184:185], v7 offset:14336
    ds_read_b64_tr_b16 a[186:187], v7 offset:14592
    ds_read_b64_tr_b16 a[188:189], v7 offset:14352
    ds_read_b64_tr_b16 a[190:191], v7 offset:14608
    s_waitcnt vmcnt(14)
    ds_read_b64_tr_b16 a[192:193], v7 offset:16384
    ds_read_b64_tr_b16 a[194:195], v7 offset:16640
    ds_read_b64_tr_b16 a[196:197], v7 offset:16400
    ds_read_b64_tr_b16 a[198:199], v7 offset:16656
    s_waitcnt vmcnt(12)
    ds_read_b64_tr_b16 a[200:201], v7 offset:18432
    ds_read_b64_tr_b16 a[202:203], v7 offset:18688
    ds_read_b64_tr_b16 a[204:205], v7 offset:18448
    ds_read_b64_tr_b16 a[206:207], v7 offset:18704
    s_waitcnt vmcnt(10)
    ds_read_b64_tr_b16 a[208:209], v7 offset:20480
    ds_read_b64_tr_b16 a[210:211], v7 offset:20736
    ds_read_b64_tr_b16 a[212:213], v7 offset:20496
    ds_read_b64_tr_b16 a[214:215], v7 offset:20752
    s_waitcnt vmcnt(8)
    ds_read_b64_tr_b16 a[216:217], v7 offset:22528
    ds_read_b64_tr_b16 a[218:219], v7 offset:22784
    ds_read_b64_tr_b16 a[220:221], v7 offset:22544
    ds_read_b64_tr_b16 a[222:223], v7 offset:22800
    s_waitcnt vmcnt(6)
    ds_read_b64_tr_b16 a[224:225], v7 offset:24576
    ds_read_b64_tr_b16 a[226:227], v7 offset:24832
    ds_read_b64_tr_b16 a[228:229], v7 offset:24592
    ds_read_b64_tr_b16 a[230:231], v7 offset:24848
    s_waitcnt vmcnt(4)
    ds_read_b64_tr_b16 a[232:233], v7 offset:26624
    ds_read_b64_tr_b16 a[234:235], v7 offset:26880
    ds_read_b64_tr_b16 a[236:237], v7 offset:26640
    ds_read_b64_tr_b16 a[238:239], v7 offset:26896
    s_waitcnt vmcnt(2)
    ds_read_b64_tr_b16 a[240:241], v7 offset:28672
    ds_read_b64_tr_b16 a[242:243], v7 offset:28928
    ds_read_b64_tr_b16 a[244:245], v7 offset:28688
    ds_read_b64_tr_b16 a[246:247], v7 offset:28944
    s_waitcnt vmcnt(0)
    s_cmp_lg_u32 s29, 0
    s_cbranch_scc1 sl_ar_63
    s_cmp_ge_u32 s28, 96
    s_cbranch_scc1 sl_ar_63
    s_mov_b64 exec, 1
    v_mov_b32 v2, 0
    s_add_u32 s71, s71, 1
    v_mov_b32 v3, s71
    global_atomic_add v2, v3, s[92:93] offset:0 sc1
    s_mov_b64 exec, -1
sl_ar_63:
    ds_read_b64_tr_b16 a[248:249], v7 offset:30720
    ds_read_b64_tr_b16 a[250:251], v7 offset:30976
    ds_read_b64_tr_b16 a[252:253], v7 offset:30736
    ds_read_b64_tr_b16 a[254:255], v7 offset:30992
    s_waitcnt lgkmcnt(0)
    s_lshr_b32 s31, s29, 1
    s_and_b32 s31, s31, 1
    s_lshl_b32 s31, s31, 2
    v_lshrrev_b32 v2, 4, v1
    v_add_u32 v2, s31, v2
    v_and_b32 v3, 7, v1
    v_xor_b32 v2, v2, v3
    s_lshl_b32 s31, s29, 14
    v_lshrrev_b32 v8, 3, v1
    v_lshlrev_b32 v8, 11, v8
    v_add_u32 v8, s31, v8
    v_lshl_add_u32 v8, v2, 4, v8
    v_bfe_u32 v2, v1, 1, 3
    v_lshrrev_b32 v3, 4, v1
    v_xor_b32 v2, v2, v3
    v_bfe_u32 v3, v1, 3, 1
    v_lshlrev_b32 v3, 11, v3
    v_and_b32 v4, 7, v1
    v_lshl_add_u32 v3, v4, 7, v3
    v_xor_b32 v12, 0, v2
    v_lshl_add_u32 v12, v12, 4, v3
    v_add_u32 v14, 65536, v12
    v_xor_b32 v13, 4, v2
    v_lshl_add_u32 v13, v13, 4, v3
    v_add_u32 v15, 65536, v13
    s_lshl_b32 s31, s29, 11
    v_lshrrev_b32 v9, 4, v1
    v_lshlrev_b32 v9, 9, v9
    v_bfe_u32 v4, v1, 3, 1
    v_lshl_add_u32 v9, v4, 8, v9
    v_and_b32 v4, 7, v1
    v_lshl_add_u32 v9, v4, 4, v9
    v_add_u32 v9, s31, v9
    v_mov_b32 v10, s50
    s_cmp_eq_u32 s29, 0
    s_cselect_b64 vcc, 1, 0
    v_mov_b32 v4, 2130706432
    v_cndmask_b32 v10, v4, v10, vcc
    v_mov_b32 v11, 0
    s_lshl_b32 s35, s30, 16
    s_sub_u32 s36, s36, s37
    s_barrier
    s_add_u32 m0, s34, 0
    s_nop 0
    buffer_load_dwordx4 v8, s[12:15], s35 offen offset:0 lds
    s_add_u32 m0, s34, 3968
    s_nop 0
    buffer_load_dwordx4 v8, s[12:15], s35 offen offset:128 lds
    s_add_u32 m0, s34, 7936
    s_nop 0
    buffer_load_dwordx4 v8, s[12:15], s35 offen offset:256 lds
    s_add_u32 m0, s34, 11904
    s_nop 0
    buffer_load_dwordx4 v8, s[12:15], s35 offen offset:384 lds
    s_add_u32 m0, s34, 15872
    s_nop 0
    buffer_load_dwordx4 v8, s[12:15], s35 offen offset:512 lds
    s_add_u32 m0, s34, 19840
    s_nop 0
    buffer_load_dwordx4 v8, s[12:15], s35 offen offset:640 lds
    s_add_u32 m0, s34, 23808
    s_nop 0
    buffer_load_dwordx4 v8, s[12:15], s35 offen offset:768 lds
    s_add_u32 m0, s34, 27776
    s_nop 0
    buffer_load_dwordx4 v8, s[12:15], s35 offen offset:896 lds
    s_add_u32 m0, s34, 31744
    s_nop 0
    buffer_load_dwordx4 v8, s[12:15], s35 offen offset:1024 lds
    s_add_u32 m0, s34, 35712
    s_nop 0
    buffer_load_dwordx4 v8, s[12:15], s35 offen offset:1152 lds
    s_add_u32 m0, s34, 39680
    s_nop 0
    buffer_load_dwordx4 v8, s[12:15], s35 offen offset:1280 lds
    s_add_u32 m0, s34, 43648
    s_nop 0
    buffer_load_dwordx4 v8, s[12:15], s35 offen offset:1408 lds
    s_add_u32 m0, s34, 47616
    s_nop 0
    buffer_load_dwordx4 v8, s[12:15], s35 offen offset:1536 lds
    s_add_u32 m0, s34, 51584
    s_nop 0
    buffer_load_dwordx4 v8, s[12:15], s35 offen offset:1664 lds
    s_add_u32 m0, s34, 55552
    s_nop 0
    buffer_load_dwordx4 v8, s[12:15], s35 offen offset:1792 lds
    s_add_u32 m0, s34, 59520
    s_nop 0
    buffer_load_dwordx4 v8, s[12:15], s35 offen offset:1920 lds
    s_add_u32 s35, s35, 65536
    s_add_u32 m0, s34, 65536
    s_nop 0
    buffer_load_dwordx4 v8, s[12:15], s35 offen offset:0 lds
    s_add_u32 m0, s34, 69504
    s_nop 0
    buffer_load_dwordx4 v8, s[12:15], s35 offen offset:128 lds
    s_add_u32 m0, s34, 73472
    s_nop 0
    buffer_load_dwordx4 v8, s[12:15], s35 offen offset:256 lds
    s_add_u32 m0, s34, 77440
    s_nop 0
    buffer_load_dwordx4 v8, s[12:15], s35 offen offset:384 lds
    s_waitcnt vmcnt(12)
    s_barrier
    ds_read_b128 v[32:35], v12 offset:0
    ds_read_b128 v[36:39], v12 offset:1024
    ds_read_b128 v[40:43], v13 offset:0
    ds_read_b128 v[44:47], v13 offset:1024
    ds_read_b128 v[48:51], v12 offset:4096
    ds_read_b128 v[52:55], v12 offset:5120
    v_add_u32 v9, 2130706432, v9
    s_cmp_eq_u32 s44, 2
    s_cbranch_scc1 sl_v_64
sl_loop_66:
    s_waitcnt lgkmcnt(4)
    v_mfma_f32_16x16x32_bf16 v[64:67], a[0:3], v[32:35], 0
    ds_read_b128 v[56:59], v13 offset:4096
    v_mfma_f32_16x16x32_bf16 v[68:71], a[4:7], v[32:35], 0
    v_mfma_f32_16x16x32_bf16 v[72:75], a[0:3], v[36:39], 0
    ds_read_b128 v[60:63], v13 offset:5120
    s_add_u32 m0, s34, 81408
    v_mfma_f32_16x16x32_bf16 v[76:79], a[4:7], v[36:39], 0
    buffer_load_dwordx4 v8, s[12:15], s35 offen offset:512 lds
    s_waitcnt lgkmcnt(4)
    v_mfma_f32_16x16x32_bf16 v[64:67], a[8:11], v[40:43], v[64:67]
    ds_read_b128 v[32:35], v12 offset:8192
    v_mfma_f32_16x16x32_bf16 v[68:71], a[12:15], v[40:43], v[68:71]
    v_mfma_f32_16x16x32_bf16 v[72:75], a[8:11], v[44:47], v[72:75]
    ds_read_b128 v[36:39], v12 offset:9216
    v_mfma_f32_16x16x32_bf16 v[76:79], a[12:15], v[44:47], v[76:79]
    s_waitcnt lgkmcnt(4)
    v_mfma_f32_16x16x32_bf16 v[64:67], a[16:19], v[48:51], v[64:67]
    ds_read_b128 v[40:43], v13 offset:8192
    v_mfma_f32_16x16x32_bf16 v[68:71], a[20:23], v[48:51], v[68:71]
    v_cvt_pk_bf16_f32 v96, v80, v81
    v_mfma_f32_16x16x32_bf16 v[72:75], a[16:19], v[52:55], v[72:75]
    ds_read_b128 v[44:47], v13 offset:9216
    s_add_u32 m0, s34, 85376
    v_mfma_f32_16x16x32_bf16 v[76:79], a[20:23], v[52:55], v[76:79]
    buffer_load_dwordx4 v8, s[12:15], s35 offen offset:640 lds
    v_cvt_pk_bf16_f32 v97, v82, v83
    s_waitcnt lgkmcnt(4)
    v_mfma_f32_16x16x32_bf16 v[64:67], a[24:27], v[56:59], v[64:67]
    ds_read_b128 v[48:51], v12 offset:12288
    v_mfma_f32_16x16x32_bf16 v[68:71], a[28:31], v[56:59], v[68:71]
    v_cvt_pk_bf16_f32 v98, v84, v85
    v_mfma_f32_16x16x32_bf16 v[72:75], a[24:27], v[60:63], v[72:75]
    ds_read_b128 v[52:55], v12 offset:13312
    v_mfma_f32_16x16x32_bf16 v[76:79], a[28:31], v[60:63], v[76:79]
    v_cvt_pk_bf16_f32 v99, v86, v87
    s_waitcnt lgkmcnt(4)
    v_mfma_f32_16x16x32_bf16 v[64:67], a[32:35], v[32:35], v[64:67]
    ds_read_b128 v[56:59], v13 offset:12288
    v_mfma_f32_16x16x32_bf16 v[68:71], a[36:39], v[32:35], v[68:71]
    v_cvt_pk_bf16_f32 v100, v88, v89
    v_mfma_f32_16x16x32_bf16 v[72:75], a[32:35], v[36:39], v[72:75]
    ds_read_b128 v[60:63], v13 offset:13312
    s_add_u32 m0, s34, 89344
    v_mfma_f32_16x16x32_bf16 v[76:79], a[36:39], v[36:39], v[76:79]
    buffer_load_dwordx4 v8, s[12:15], s35 offen offset:768 lds
    v_cvt_pk_bf16_f32 v101, v90, v91
    s_waitcnt lgkmcnt(4)
    v_mfma_f32_16x16x32_bf16 v[64:67], a[40:43], v[40:43], v[64:67]
    ds_read_b128 v[32:35], v12 offset:16384
    v_mfma_f32_16x16x32_bf16 v[68:71], a[44:47], v[40:43], v[68:71]
    v_cvt_pk_bf16_f32 v102, v92, v93
    v_mfma_f32_16x16x32_bf16 v[72:75], a[40:43], v[44:47], v[72:75]
    ds_read_b128 v[36:39], v12 offset:17408
    v_mfma_f32_16x16x32_bf16 v[76:79], a[44:47], v[44:47], v[76:79]
    v_cvt_pk_bf16_f32 v103, v94, v95
    buffer_store_dwordx4 v[96:99], v9, s[4:7], s36 offen sc1
    s_waitcnt lgkmcnt(4)
    v_mfma_f32_16x16x32_bf16 v[64:67], a[48:51], v[48:51], v[64:67]
    ds_read_b128 v[40:43], v13 offset:16384
    v_mfma_f32_16x16x32_bf16 v[68:71], a[52:55], v[48:51], v[68:71]
    v_mfma_f32_16x16x32_bf16 v[72:75], a[48:51], v[52:55], v[72:75]
    ds_read_b128 v[44:47], v13 offset:17408
    s_add_u32 m0, s34, 93312
    v_mfma_f32_16x16x32_bf16 v[76:79], a[52:55], v[52:55], v[76:79]
    buffer_load_dwordx4 v8, s[12:15], s35 offen offset:896 lds
    s_waitcnt lgkmcnt(4)
    v_mfma_f32_16x16x32_bf16 v[64:67], a[56:59], v[56:59], v[64:67]
    ds_read_b128 v[48:51], v12 offset:20480
    v_mfma_f32_16x16x32_bf16 v[68:71], a[60:63], v[56:59], v[68:71]
    v_mfma_f32_16x16x32_bf16 v[72:75], a[56:59], v[60:63], v[72:75]
    ds_read_b128 v[52:55], v12 offset:21504
    v_mfma_f32_16x16x32_bf16 v[76:79], a[60:63], v[60:63], v[76:79]
    buffer_store_dwordx4 v[100:103], v9, s[4:7], s36 offen offset:128 sc1
    s_add_u32 s36, s36, s37
    s_waitcnt vmcnt(8)
    s_barrier
    s_waitcnt lgkmcnt(4)
    v_mfma_f32_16x16x32_bf16 v[64:67], a[64:67], v[32:35], v[64:67]
    ds_read_b128 v[56:59], v13 offset:20480
    v_mfma_f32_16x16x32_bf16 v[68:71], a[68:71], v[32:35], v[68:71]
    v_mfma_f32_16x16x32_bf16 v[72:75], a[64:67], v[36:39], v[72:75]
    ds_read_b128 v[60:63], v13 offset:21504
    s_add_u32 m0, s34, 97280
    v_mfma_f32_16x16x32_bf16 v[76:79], a[68:71], v[36:39], v[76:79]
    buffer_load_dwordx4 v8, s[12:15], s35 offen offset:1024 lds
    s_waitcnt lgkmcnt(4)
    v_mfma_f32_16x16x32_bf16 v[64:67], a[72:75], v[40:43], v[64:67]
    ds_read_b128 v[32:35], v12 offset:24576
    v_mfma_f32_16x16x32_bf16 v[68:71], a[76:79], v[40:43], v[68:71]
    v_mfma_f32_16x16x32_bf16 v[72:75], a[72:75], v[44:47], v[72:75]
    ds_read_b128 v[36:39], v12 offset:25600
    v_mfma_f32_16x16x32_bf16 v[76:79], a[76:79], v[44:47], v[76:79]
    s_waitcnt lgkmcnt(4)
    v_mfma_f32_16x16x32_bf16 v[64:67], a[80:83], v[48:51], v[64:67]
    ds_read_b128 v[40:43], v13 offset:24576
    v_mfma_f32_16x16x32_bf16 v[68:71], a[84:87], v[48:51], v[68:71]
    v_and_b32 v9, 0xffffff, v9
    v_mfma_f32_16x16x32_bf16 v[72:75], a[80:83], v[52:55], v[72:75]
    ds_read_b128 v[44:47], v13 offset:25600
    s_add_u32 m0, s34, 101248
    v_mfma_f32_16x16x32_bf16 v[76:79], a[84:87], v[52:55], v[76:79]
    buffer_load_dwordx4 v8, s[12:15], s35 offen offset:1152 lds
    s_waitcnt lgkmcnt(4)
    v_mfma_f32_16x16x32_bf16 v[64:67], a[88:91], v[56:59], v[64:67]
    ds_read_b128 v[48:51], v12 offset:28672
    v_mfma_f32_16x16x32_bf16 v[68:71], a[92:95], v[56:59], v[68:71]
    v_mfma_f32_16x16x32_bf16 v[72:75], a[88:91], v[60:63], v[72:75]
    ds_read_b128 v[52:55], v12 offset:29696
    v_mfma_f32_16x16x32_bf16 v[76:79], a[92:95], v[60:63], v[76:79]
    s_waitcnt lgkmcnt(4)
    v_mfma_f32_16x16x32_bf16 v[64:67], a[96:99], v[32:35], v[64:67]
    ds_read_b128 v[56:59], v13 offset:28672
    v_mfma_f32_16x16x32_bf16 v[68:71], a[100:103], v[32:35], v[68:71]
    v_mfma_f32_16x16x32_bf16 v[72:75], a[96:99], v[36:39], v[72:75]
    ds_read_b128 v[60:63], v13 offset:29696
    s_add_u32 m0, s34, 105216
    v_mfma_f32_16x16x32_bf16 v[76:79], a[100:103], v[36:39], v[76:79]
    buffer_load_dwordx4 v8, s[12:15], s35 offen offset:1280 lds
    s_waitcnt lgkmcnt(4)
    v_mfma_f32_16x16x32_bf16 v[64:67], a[104:107], v[40:43], v[64:67]
    ds_read_b128 v[32:35], v12 offset:32768
    v_mfma_f32_16x16x32_bf16 v[68:71], a[108:111], v[40:43], v[68:71]
    v_mfma_f32_16x16x32_bf16 v[72:75], a[104:107], v[44:47], v[72:75]
    ds_read_b128 v[36:39], v12 offset:33792
    v_mfma_f32_16x16x32_bf16 v[76:79], a[108:111], v[44:47], v[76:79]
    s_waitcnt lgkmcnt(4)
    v_mfma_f32_16x16x32_bf16 v[64:67], a[112:115], v[48:51], v[64:67]
    ds_read_b128 v[40:43], v13 offset:32768
    v_mfma_f32_16x16x32_bf16 v[68:71], a[116:119], v[48:51], v[68:71]
    v_mfma_f32_16x16x32_bf16 v[72:75], a[112:115], v[52:55], v[72:75]
    ds_read_b128 v[44:47], v13 offset:33792
    s_add_u32 m0, s34, 109184
    v_mfma_f32_16x16x32_bf16 v[76:79], a[116:119], v[52:55], v[76:79]
    buffer_load_dwordx4 v8, s[12:15], s35 offen offset:1408 lds
    s_waitcnt lgkmcnt(4)
    v_mfma_f32_16x16x32_bf16 v[64:67], a[120:123], v[56:59], v[64:67]
    ds_read_b128 v[48:51], v12 offset:36864
    v_mfma_f32_16x16x32_bf16 v[68:71], a[124:127], v[56:59], v[68:71]
    v_mfma_f32_16x16x32_bf16 v[72:75], a[120:123], v[60:63], v[72:75]
    ds_read_b128 v[52:55], v12 offset:37888
    v_mfma_f32_16x16x32_bf16 v[76:79], a[124:127], v[60:63], v[76:79]
    s_waitcnt lgkmcnt(4)
    v_mfma_f32_16x16x32_bf16 v[64:67], a[128:131], v[32:35], v[64:67]
    ds_read_b128 v[56:59], v13 offset:36864
    v_mfma_f32_16x16x32_bf16 v[68:71], a[132:135], v[32:35], v[68:71]
    v_mfma_f32_16x16x32_bf16 v[72:75], a[128:131], v[36:39], v[72:75]
    ds_read_b128 v[60:63], v13 offset:37888
    s_add_u32 m0, s34, 113152
    v_mfma_f32_16x16x32_bf16 v[76:79], a[132:135], v[36:39], v[76:79]
    buffer_load_dwordx4 v8, s[12:15], s35 offen offset:1536 lds
    s_waitcnt lgkmcnt(4)
    v_mfma_f32_16x16x32_bf16 v[64:67], a[136:139], v[40:43], v[64:67]
    ds_read_b128 v[32:35], v12 offset:40960
    v_mfma_f32_16x16x32_bf16 v[68:71], a[140:143], v[40:43], v[68:71]
    v_mfma_f32_16x16x32_bf16 v[72:75], a[136:139], v[44:47], v[72:75]
    ds_read_b128 v[36:39], v12 offset:41984
    v_mfma_f32_16x16x32_bf16 v[76:79], a[140:143], v[44:47], v[76:79]
    s_waitcnt lgkmcnt(4)
    v_mfma_f32_16x16x32_bf16 v[64:67], a[144:147], v[48:51], v[64:67]
    ds_read_b128 v[40:43], v13 offset:40960
    v_mfma_f32_16x16x32_bf16 v[68:71], a[148:151], v[48:51], v[68:71]
    v_mfma_f32_16x16x32_bf16 v[72:75], a[144:147], v[52:55], v[72:75]
    ds_read_b128 v[44:47], v13 offset:41984
    s_add_u32 m0, s34, 117120
    v_mfma_f32_16x16x32_bf16 v[76:79], a[148:151], v[52:55], v[76:79]
    buffer_load_dwordx4 v8, s[12:15], s35 offen offset:1664 lds
    s_waitcnt lgkmcnt(4)
    v_mfma_f32_16x16x32_bf16 v[64:67], a[152:155], v[56:59], v[64:67]
    ds_read_b128 v[48:51], v12 offset:45056
    v_mfma_f32_16x16x32_bf16 v[68:71], a[156:159], v[56:59], v[68:71]
    v_mfma_f32_16x16x32_bf16 v[72:75], a[152:155], v[60:63], v[72:75]
    ds_read_b128 v[52:55], v12 offset:46080
    v_mfma_f32_16x16x32_bf16 v[76:79], a[156:159], v[60:63], v[76:79]
    s_waitcnt lgkmcnt(4)
    v_mfma_f32_16x16x32_bf16 v[64:67], a[160:163], v[32:35], v[64:67]
    ds_read_b128 v[56:59], v13 offset:45056
    v_mfma_f32_16x16x32_bf16 v[68:71], a[164:167], v[32:35], v[68:71]
    v_mfma_f32_16x16x32_bf16 v[72:75], a[160:163], v[36:39], v[72:75]
    ds_read_b128 v[60:63], v13 offset:46080
    s_add_u32 m0, s34, 121088
    v_mfma_f32_16x16x32_bf16 v[76:79], a[164:167], v[36:39], v[76:79]
    buffer_load_dwordx4 v8, s[12:15], s35 offen offset:1792 lds
    s_waitcnt lgkmcnt(4)
    v_mfma_f32_16x16x32_bf16 v[64:67], a[168:171], v[40:43], v[64:67]
    ds_read_b128 v[32:35], v12 offset:49152
    v_mfma_f32_16x16x32_bf16 v[68:71], a[172:175], v[40:43], v[68:71]
    v_mfma_f32_16x16x32_bf16 v[72:75], a[168:171], v[44:47], v[72:75]
    ds_read_b128 v[36:39], v12 offset:50176
    v_mfma_f32_16x16x32_bf16 v[76:79], a[172:175], v[44:47], v[76:79]
    s_waitcnt lgkmcnt(4)
    v_mfma_f32_16x16x32_bf16 v[64:67], a[176:179], v[48:51], v[64:67]
    ds_read_b128 v[40:43], v13 offset:49152
    v_mfma_f32_16x16x32_bf16 v[68:71], a[180:183], v[48:51], v[68:71]
    v_mfma_f32_16x16x32_bf16 v[72:75], a[176:179], v[52:55], v[72:75]
    ds_read_b128 v[44:47], v13 offset:50176
    s_add_u32 m0, s34, 125056
    v_mfma_f32_16x16x32_bf16 v[76:79], a[180:183], v[52:55], v[76:79]
    buffer_load_dwordx4 v8, s[12:15], s35 offen offset:1920 lds
    s_add_u32 s35, s35, 65536
    s_min_u32 s35, s35, s52
    s_waitcnt lgkmcnt(4)
    v_mfma_f32_16x16x32_bf16 v[64:67], a[184:187], v[56:59], v[64:67]
    ds_read_b128 v[48:51], v12 offset:53248
    v_mfma_f32_16x16x32_bf16 v[68:71], a[188:191], v[56:59], v[68:71]
    v_mfma_f32_16x16x32_bf16 v[72:75], a[184:187], v[60:63], v[72:75]
    ds_read_b128 v[52:55], v12 offset:54272
    v_mfma_f32_16x16x32_bf16 v[76:79], a[188:191], v[60:63], v[76:79]
    s_waitcnt vmcnt(8)
    s_barrier
    s_waitcnt lgkmcnt(4)
    v_mfma_f32_16x16x32_bf16 v[64:67], a[192:195], v[32:35], v[64:67]
    ds_read_b128 v[56:59], v13 offset:53248
    v_mfma_f32_16x16x32_bf16 v[68:71], a[196:199], v[32:35], v[68:71]
    v_mfma_f32_16x16x32_bf16 v[72:75], a[192:195], v[36:39], v[72:75]
    ds_read_b128 v[60:63], v13 offset:54272
    s_add_u32 m0, s34, 0
    v_mfma_f32_16x16x32_bf16 v[76:79], a[196:199], v[36:39], v[76:79]
    buffer_load_dwordx4 v8, s[12:15], s35 offen offset:0 lds
    s_waitcnt lgkmcnt(4)
    v_mfma_f32_16x16x32_bf16 v[64:67], a[200:203], v[40:43], v[64:67]
    ds_read_b128 v[32:35], v12 offset:57344
    v_mfma_f32_16x16x32_bf16 v[68:71], a[204:207], v[40:43], v[68:71]
    buffer_store_dword v11, v10, s[4:7], 0 offen sc1
    v_add_u32 v11, 1, v11
    v_mfma_f32_16x16x32_bf16 v[72:75], a[200:203], v[44:47], v[72:75]
    ds_read_b128 v[36:39], v12 offset:58368
    v_mfma_f32_16x16x32_bf16 v[76:79], a[204:207], v[44:47], v[76:79]
    s_waitcnt lgkmcnt(4)
    v_mfma_f32_16x16x32_bf16 v[64:67], a[208:211], v[48:51], v[64:67]
    ds_read_b128 v[40:43], v13 offset:57344
    v_mfma_f32_16x16x32_bf16 v[68:71], a[212:215], v[48:51], v[68:71]
    v_mfma_f32_16x16x32_bf16 v[72:75], a[208:211], v[52:55], v[72:75]
    ds_read_b128 v[44:47], v13 offset:58368
    s_add_u32 m0, s34, 3968
    v_mfma_f32_16x16x32_bf16 v[76:79], a[212:215], v[52:55], v[76:79]
    buffer_load_dwordx4 v8, s[12:15], s35 offen offset:128 lds
    s_waitcnt lgkmcnt(4)
    v_mfma_f32_16x16x32_bf16 v[64:67], a[216:219], v[56:59], v[64:67]
    ds_read_b128 v[48:51], v12 offset:61440
    v_mfma_f32_16x16x32_bf16 v[68:71], a[220:223], v[56:59], v[68:71]
    v_mfma_f32_16x16x32_bf16 v[72:75], a[216:219], v[60:63], v[72:75]
    ds_read_b128 v[52:55], v12 offset:62464
    v_mfma_f32_16x16x32_bf16 v[76:79], a[220:223], v[60:63], v[76:79]
    s_waitcnt lgkmcnt(4)
    v_mfma_f32_16x16x32_bf16 v[64:67], a[224:227], v[32:35], v[64:67]
    ds_read_b128 v[56:59], v13 offset:61440
    v_mfma_f32_16x16x32_bf16 v[68:71], a[228:231], v[32:35], v[68:71]
    v_mfma_f32_16x16x32_bf16 v[72:75], a[224:227], v[36:39], v[72:75]
    ds_read_b128 v[60:63], v13 offset:62464
    s_add_u32 m0, s34, 7936
    v_mfma_f32_16x16x32_bf16 v[76:79], a[228:231], v[36:39], v[76:79]
    buffer_load_dwordx4 v8, s[12:15], s35 offen offset:256 lds
    s_waitcnt lgkmcnt(4)
    v_mfma_f32_16x16x32_bf16 v[64:67], a[232:235], v[40:43], v[64:67]
    ds_read_b128 v[32:35], v14 offset:0
    v_mfma_f32_16x16x32_bf16 v[68:71], a[236:239], v[40:43], v[68:71]
    v_mfma_f32_16x16x32_bf16 v[72:75], a[232:235], v[44:47], v[72:75]
    ds_read_b128 v[36:39], v14 offset:1024
    v_mfma_f32_16x16x32_bf16 v[76:79], a[236:239], v[44:47], v[76:79]
    s_waitcnt lgkmcnt(4)
    v_mfma_f32_16x16x32_bf16 v[64:67], a[240:243], v[48:51], v[64:67]
    ds_read_b128 v[40:43], v15 offset:0
    v_mfma_f32_16x16x32_bf16 v[68:71], a[244:247], v[48:51], v[68:71]
    v_mfma_f32_16x16x32_bf16 v[72:75], a[240:243], v[52:55], v[72:75]
    ds_read_b128 v[44:47], v15 offset:1024
    s_add_u32 m0, s34, 11904
    v_mfma_f32_16x16x32_bf16 v[76:79], a[244:247], v[52:55], v[76:79]
    buffer_load_dwordx4 v8, s[12:15], s35 offen offset:384 lds
    s_waitcnt lgkmcnt(4)
    v_mfma_f32_16x16x32_bf16 v[64:67], a[248:251], v[56:59], v[64:67]
    ds_read_b128 v[48:51], v14 offset:4096
    v_mfma_f32_16x16x32_bf16 v[68:71], a[252:255], v[56:59], v[68:71]
    v_mfma_f32_16x16x32_bf16 v[72:75], a[248:251], v[60:63], v[72:75]
    ds_read_b128 v[52:55], v14 offset:5120
    v_mfma_f32_16x16x32_bf16 v[76:79], a[252:255], v[60:63], v[76:79]
    s_waitcnt lgkmcnt(4)
    v_mfma_f32_16x16x32_bf16 v[80:83], a[0:3], v[32:35], 0
    ds_read_b128 v[56:59], v15 offset:4096
    v_mfma_f32_16x16x32_bf16 v[84:87], a[4:7], v[32:35], 0
    v_mfma_f32_16x16x32_bf16 v[88:91], a[0:3], v[36:39], 0
    ds_read_b128 v[60:63], v15 offset:5120
    s_add_u32 m0, s34, 15872
    v_mfma_f32_16x16x32_bf16 v[92:95], a[4:7], v[36:39], 0
    buffer_load_dwordx4 v8, s[12:15], s35 offen offset:512 lds
    s_waitcnt lgkmcnt(4)
    v_mfma_f32_16x16x32_bf16 v[80:83], a[8:11], v[40:43], v[80:83]
    ds_read_b128 v[32:35], v14 offset:8192
    v_mfma_f32_16x16x32_bf16 v[84:87], a[12:15], v[40:43], v[84:87]
    v_mfma_f32_16x16x32_bf16 v[88:91], a[8:11], v[44:47], v[88:91]
    ds_read_b128 v[36:39], v14 offset:9216
    v_mfma_f32_16x16x32_bf16 v[92:95], a[12:15], v[44:47], v[92:95]
    s_waitcnt lgkmcnt(4)
    v_mfma_f32_16x16x32_bf16 v[80:83], a[16:19], v[48:51], v[80:83]
    ds_read_b128 v[40:43], v15 offset:8192
    v_mfma_f32_16x16x32_bf16 v[84:87], a[20:23], v[48:51], v[84:87]
    v_cvt_pk_bf16_f32 v96, v64, v65
    v_mfma_f32_16x16x32_bf16 v[88:91], a[16:19], v[52:55], v[88:91]
    ds_read_b128 v[44:47], v15 offset:9216
    s_add_u32 m0, s34, 19840
    v_mfma_f32_16x16x32_bf16 v[92:95], a[20:23], v[52:55], v[92:95]
    buffer_load_dwordx4 v8, s[12:15], s35 offen offset:640 lds
    v_cvt_pk_bf16_f32 v97, v66, v67
    s_waitcnt lgkmcnt(4)
    v_mfma_f32_16x16x32_bf16 v[80:83], a[24:27], v[56:59], v[80:83]
    ds_read_b128 v[48:51], v14 offset:12288
    v_mfma_f32_16x16x32_bf16 v[84:87], a[28:31], v[56:59], v[84:87]
    v_cvt_pk_bf16_f32 v98, v68, v69
    v_mfma_f32_16x16x32_bf16 v[88:91], a[24:27], v[60:63], v[88:91]
    ds_read_b128 v[52:55], v14 offset:13312
    v_mfma_f32_16x16x32_bf16 v[92:95], a[28:31], v[60:63], v[92:95]
    v_cvt_pk_bf16_f32 v99, v70, v71
    s_waitcnt lgkmcnt(4)
    v_mfma_f32_16x16x32_bf16 v[80:83], a[32:35], v[32:35], v[80:83]
    ds_read_b128 v[56:59], v15 offset:12288
    v_mfma_f32_16x16x32_bf16 v[84:87], a[36:39], v[32:35], v[84:87]
    v_cvt_pk_bf16_f32 v100, v72, v73
    v_mfma_f32_16x16x32_bf16 v[88:91], a[32:35], v[36:39], v[88:91]
    ds_read_b128 v[60:63], v15 offset:13312
    s_add_u32 m0, s34, 23808
    v_mfma_f32_16x16x32_bf16 v[92:95], a[36:39], v[36:39], v[92:95]
    buffer_load_dwordx4 v8, s[12:15], s35 offen offset:768 lds
    v_cvt_pk_bf16_f32 v101, v74, v75
    s_waitcnt lgkmcnt(4)
    v_mfma_f32_16x16x32_bf16 v[80:83], a[40:43], v[40:43], v[80:83]
    ds_read_b128 v[32:35], v14 offset:16384
    v_mfma_f32_16x16x32_bf16 v[84:87], a[44:47], v[40:43], v[84:87]
    v_cvt_pk_bf16_f32 v102, v76, v77
    v_mfma_f32_16x16x32_bf16 v[88:91], a[40:43], v[44:47], v[88:91]
    ds_read_b128 v[36:39], v14 offset:17408
    v_mfma_f32_16x16x32_bf16 v[92:95], a[44:47], v[44:47], v[92:95]
    v_cvt_pk_bf16_f32 v103, v78, v79
    buffer_store_dwordx4 v[96:99], v9, s[4:7], s36 offen sc1
    s_waitcnt lgkmcnt(4)
    v_mfma_f32_16x16x32_bf16 v[80:83], a[48:51], v[48:51], v[80:83]
    ds_read_b128 v[40:43], v15 offset:16384
    v_mfma_f32_16x16x32_bf16 v[84:87], a[52:55], v[48:51], v[84:87]
    v_mfma_f32_16x16x32_bf16 v[88:91], a[48:51], v[52:55], v[88:91]
    ds_read_b128 v[44:47], v15 offset:17408
    s_add_u32 m0, s34, 27776
    v_mfma_f32_16x16x32_bf16 v[92:95], a[52:55], v[52:55], v[92:95]
    buffer_load_dwordx4 v8, s[12:15], s35 offen offset:896 lds
    s_waitcnt lgkmcnt(4)
    v_mfma_f32_16x16x32_bf16 v[80:83], a[56:59], v[56:59], v[80:83]
    ds_read_b128 v[48:51], v14 offset:20480
    v_mfma_f32_16x16x32_bf16 v[84:87], a[60:63], v[56:59], v[84:87]
    v_mfma_f32_16x16x32_bf16 v[88:91], a[56:59], v[60:63], v[88:91]
    ds_read_b128 v[52:55], v14 offset:21504
    v_mfma_f32_16x16x32_bf16 v[92:95], a[60:63], v[60:63], v[92:95]
    buffer_store_dwordx4 v[100:103], v9, s[4:7], s36 offen offset:128 sc1
    s_add_u32 s36, s36, s37
    s_waitcnt vmcnt(8)
    s_barrier
    s_waitcnt lgkmcnt(4)
    v_mfma_f32_16x16x32_bf16 v[80:83], a[64:67], v[32:35], v[80:83]
    ds_read_b128 v[56:59], v15 offset:20480
    v_mfma_f32_16x16x32_bf16 v[84:87], a[68:71], v[32:35], v[84:87]
    v_mfma_f32_16x16x32_bf16 v[88:91], a[64:67], v[36:39], v[88:91]
    ds_read_b128 v[60:63], v15 offset:21504
    s_add_u32 m0, s34, 31744
    v_mfma_f32_16x16x32_bf16 v[92:95], a[68:71], v[36:39], v[92:95]
    buffer_load_dwordx4 v8, s[12:15], s35 offen offset:1024 lds
    s_waitcnt lgkmcnt(4)
    v_mfma_f32_16x16x32_bf16 v[80:83], a[72:75], v[40:43], v[80:83]
    ds_read_b128 v[32:35], v14 offset:24576
    v_mfma_f32_16x16x32_bf16 v[84:87], a[76:79], v[40:43], v[84:87]
    v_mfma_f32_16x16x32_bf16 v[88:91], a[72:75], v[44:47], v[88:91]
    ds_read_b128 v[36:39], v14 offset:25600
    v_mfma_f32_16x16x32_bf16 v[92:95], a[76:79], v[44:47], v[92:95]
    s_waitcnt lgkmcnt(4)
    v_mfma_f32_16x16x32_bf16 v[80:83], a[80:83], v[48:51], v[80:83]
    ds_read_b128 v[40:43], v15 offset:24576
    v_mfma_f32_16x16x32_bf16 v[84:87], a[84:87], v[48:51], v[84:87]
    v_mfma_f32_16x16x32_bf16 v[88:91], a[80:83], v[52:55], v[88:91]
    ds_read_b128 v[44:47], v15 offset:25600
    s_add_u32 m0, s34, 35712
    v_mfma_f32_16x16x32_bf16 v[92:95], a[84:87], v[52:55], v[92:95]
    buffer_load_dwordx4 v8, s[12:15], s35 offen offset:1152 lds
    s_waitcnt lgkmcnt(4)
    v_mfma_f32_16x16x32_bf16 v[80:83], a[88:91], v[56:59], v[80:83]
    ds_read_b128 v[48:51], v14 offset:28672
    v_mfma_f32_16x16x32_bf16 v[84:87], a[92:95], v[56:59], v[84:87]
    v_mfma_f32_16x16x32_bf16 v[88:91], a[88:91], v[60:63], v[88:91]
    ds_read_b128 v[52:55], v14 offset:29696
    v_mfma_f32_16x16x32_bf16 v[92:95], a[92:95], v[60:63], v[92:95]
    s_waitcnt lgkmcnt(4)
    v_mfma_f32_16x16x32_bf16 v[80:83], a[96:99], v[32:35], v[80:83]
    ds_read_b128 v[56:59], v15 offset:28672
    v_mfma_f32_16x16x32_bf16 v[84:87], a[100:103], v[32:35], v[84:87]
    v_mfma_f32_16x16x32_bf16 v[88:91], a[96:99], v[36:39], v[88:91]
    ds_read_b128 v[60:63], v15 offset:29696
    s_add_u32 m0, s34, 39680
    v_mfma_f32_16x16x32_bf16 v[92:95], a[100:103], v[36:39], v[92:95]
    buffer_load_dwordx4 v8, s[12:15], s35 offen offset:1280 lds
    s_waitcnt lgkmcnt(4)
    v_mfma_f32_16x16x32_bf16 v[80:83], a[104:107], v[40:43], v[80:83]
    ds_read_b128 v[32:35], v14 offset:32768
    v_mfma_f32_16x16x32_bf16 v[84:87], a[108:111], v[40:43], v[84:87]
    v_mfma_f32_16x16x32_bf16 v[88:91], a[104:107], v[44:47], v[88:91]
    ds_read_b128 v[36:39], v14 offset:33792
    v_mfma_f32_16x16x32_bf16 v[92:95], a[108:111], v[44:47], v[92:95]
    s_waitcnt lgkmcnt(4)
    v_mfma_f32_16x16x32_bf16 v[80:83], a[112:115], v[48:51], v[80:83]
    ds_read_b128 v[40:43], v15 offset:32768
    v_mfma_f32_16x16x32_bf16 v[84:87], a[116:119], v[48:51], v[84:87]
    v_mfma_f32_16x16x32_bf16 v[88:91], a[112:115], v[52:55], v[88:91]
    ds_read_b128 v[44:47], v15 offset:33792
    s_add_u32 m0, s34, 43648
    v_mfma_f32_16x16x32_bf16 v[92:95], a[116:119], v[52:55], v[92:95]
    buffer_load_dwordx4 v8, s[12:15], s35 offen offset:1408 lds
    s_waitcnt lgkmcnt(4)
    v_mfma_f32_16x16x32_bf16 v[80:83], a[120:123], v[56:59], v[80:83]
    ds_read_b128 v[48:51], v14 offset:36864
    v_mfma_f32_16x16x32_bf16 v[84:87], a[124:127], v[56:59], v[84:87]
    v_mfma_f32_16x16x32_bf16 v[88:91], a[120:123], v[60:63], v[88:91]
    ds_read_b128 v[52:55], v14 offset:37888
    v_mfma_f32_16x16x32_bf16 v[92:95], a[124:127], v[60:63], v[92:95]
    s_waitcnt lgkmcnt(4)
    v_mfma_f32_16x16x32_bf16 v[80:83], a[128:131], v[32:35], v[80:83]
    ds_read_b128 v[56:59], v15 offset:36864
    v_mfma_f32_16x16x32_bf16 v[84:87], a[132:135], v[32:35], v[84:87]
    v_mfma_f32_16x16x32_bf16 v[88:91], a[128:131], v[36:39], v[88:91]
    ds_read_b128 v[60:63], v15 offset:37888
    s_add_u32 m0, s34, 47616
    v_mfma_f32_16x16x32_bf16 v[92:95], a[132:135], v[36:39], v[92:95]
    buffer_load_dwordx4 v8, s[12:15], s35 offen offset:1536 lds
    s_waitcnt lgkmcnt(4)
    v_mfma_f32_16x16x32_bf16 v[80:83], a[136:139], v[40:43], v[80:83]
    ds_read_b128 v[32:35], v14 offset:40960
    v_mfma_f32_16x16x32_bf16 v[84:87], a[140:143], v[40:43], v[84:87]
    v_mfma_f32_16x16x32_bf16 v[88:91], a[136:139], v[44:47], v[88:91]
    ds_read_b128 v[36:39], v14 offset:41984
    v_mfma_f32_16x16x32_bf16 v[92:95], a[140:143], v[44:47], v[92:95]
    s_waitcnt lgkmcnt(4)
    v_mfma_f32_16x16x32_bf16 v[80:83], a[144:147], v[48:51], v[80:83]
    ds_read_b128 v[40:43], v15 offset:40960
    v_mfma_f32_16x16x32_bf16 v[84:87], a[148:151], v[48:51], v[84:87]
    v_mfma_f32_16x16x32_bf16 v[88:91], a[144:147], v[52:55], v[88:91]
    ds_read_b128 v[44:47], v15 offset:41984
    s_add_u32 m0, s34, 51584
    v_mfma_f32_16x16x32_bf16 v[92:95], a[148:151], v[52:55], v[92:95]
    buffer_load_dwordx4 v8, s[12:15], s35 offen offset:1664 lds
    s_waitcnt lgkmcnt(4)
    v_mfma_f32_16x16x32_bf16 v[80:83], a[152:155], v[56:59], v[80:83]
    ds_read_b128 v[48:51], v14 offset:45056
    v_mfma_f32_16x16x32_bf16 v[84:87], a[156:159], v[56:59], v[84:87]
    v_mfma_f32_16x16x32_bf16 v[88:91], a[152:155], v[60:63], v[88:91]
    ds_read_b128 v[52:55], v14 offset:46080
    v_mfma_f32_16x16x32_bf16 v[92:95], a[156:159], v[60:63], v[92:95]
    s_waitcnt lgkmcnt(4)
    v_mfma_f32_16x16x32_bf16 v[80:83], a[160:163], v[32:35], v[80:83]
    ds_read_b128 v[56:59], v15 offset:45056
    v_mfma_f32_16x16x32_bf16 v[84:87], a[164:167], v[32:35], v[84:87]
    v_mfma_f32_16x16x32_bf16 v[88:91], a[160:163], v[36:39], v[88:91]
    ds_read_b128 v[60:63], v15 offset:46080
    s_add_u32 m0, s34, 55552
    v_mfma_f32_16x16x32_bf16 v[92:95], a[164:167], v[36:39], v[92:95]
    buffer_load_dwordx4 v8, s[12:15], s35 offen offset:1792 lds
    s_waitcnt lgkmcnt(4)
    v_mfma_f32_16x16x32_bf16 v[80:83], a[168:171], v[40:43], v[80:83]
    ds_read_b128 v[32:35], v14 offset:49152
    v_mfma_f32_16x16x32_bf16 v[84:87], a[172:175], v[40:43], v[84:87]
    v_mfma_f32_16x16x32_bf16 v[88:91], a[168:171], v[44:47], v[88:91]
    ds_read_b128 v[36:39], v14 offset:50176
    v_mfma_f32_16x16x32_bf16 v[92:95], a[172:175], v[44:47], v[92:95]
    s_waitcnt lgkmcnt(4)
    v_mfma_f32_16x16x32_bf16 v[80:83], a[176:179], v[48:51], v[80:83]
    ds_read_b128 v[40:43], v15 offset:49152
    v_mfma_f32_16x16x32_bf16 v[84:87], a[180:183], v[48:51], v[84:87]
    v_mfma_f32_16x16x32_bf16 v[88:91], a[176:179], v[52:55], v[88:91]
    ds_read_b128 v[44:47], v15 offset:50176
    s_add_u32 m0, s34, 59520
    v_mfma_f32_16x16x32_bf16 v[92:95], a[180:183], v[52:55], v[92:95]
    buffer_load_dwordx4 v8, s[12:15], s35 offen offset:1920 lds
    s_add_u32 s35, s35, 65536
    s_min_u32 s35, s35, s52
    s_waitcnt lgkmcnt(4)
    v_mfma_f32_16x16x32_bf16 v[80:83], a[184:187], v[56:59], v[80:83]
    ds_read_b128 v[48:51], v14 offset:53248
    v_mfma_f32_16x16x32_bf16 v[84:87], a[188:191], v[56:59], v[84:87]
    v_mfma_f32_16x16x32_bf16 v[88:91], a[184:187], v[60:63], v[88:91]
    ds_read_b128 v[52:55], v14 offset:54272
    v_mfma_f32_16x16x32_bf16 v[92:95], a[188:191], v[60:63], v[92:95]
    s_waitcnt vmcnt(8)
    s_barrier
    s_waitcnt lgkmcnt(4)
    v_mfma_f32_16x16x32_bf16 v[80:83], a[192:195], v[32:35], v[80:83]
    ds_read_b128 v[56:59], v15 offset:53248
    v_mfma_f32_16x16x32_bf16 v[84:87], a[196:199], v[32:35], v[84:87]
    v_mfma_f32_16x16x32_bf16 v[88:91], a[192:195], v[36:39], v[88:91]
    ds_read_b128 v[60:63], v15 offset:54272
    s_add_u32 m0, s34, 65536
    v_mfma_f32_16x16x32_bf16 v[92:95], a[196:199], v[36:39], v[92:95]
    buffer_load_dwordx4 v8, s[12:15], s35 offen offset:0 lds
    s_waitcnt lgkmcnt(4)
    v_mfma_f32_16x16x32_bf16 v[80:83], a[200:203], v[40:43], v[80:83]
    ds_read_b128 v[32:35], v14 offset:57344
    v_mfma_f32_16x16x32_bf16 v[84:87], a[204:207], v[40:43], v[84:87]
    buffer_store_dword v11, v10, s[4:7], 0 offen sc1
    v_add_u32 v11, 1, v11
    v_mfma_f32_16x16x32_bf16 v[88:91], a[200:203], v[44:47], v[88:91]
    ds_read_b128 v[36:39], v14 offset:58368
    v_mfma_f32_16x16x32_bf16 v[92:95], a[204:207], v[44:47], v[92:95]
    s_waitcnt lgkmcnt(4)
    v_mfma_f32_16x16x32_bf16 v[80:83], a[208:211], v[48:51], v[80:83]
    ds_read_b128 v[40:43], v15 offset:57344
    v_mfma_f32_16x16x32_bf16 v[84:87], a[212:215], v[48:51], v[84:87]
    v_mfma_f32_16x16x32_bf16 v[88:91], a[208:211], v[52:55], v[88:91]
    ds_read_b128 v[44:47], v15 offset:58368
    s_add_u32 m0, s34, 69504
    v_mfma_f32_16x16x32_bf16 v[92:95], a[212:215], v[52:55], v[92:95]
    buffer_load_dwordx4 v8, s[12:15], s35 offen offset:128 lds
    s_waitcnt lgkmcnt(4)
    v_mfma_f32_16x16x32_bf16 v[80:83], a[216:219], v[56:59], v[80:83]
    ds_read_b128 v[48:51], v14 offset:61440
    v_mfma_f32_16x16x32_bf16 v[84:87], a[220:223], v[56:59], v[84:87]
    v_mfma_f32_16x16x32_bf16 v[88:91], a[216:219], v[60:63], v[88:91]
    ds_read_b128 v[52:55], v14 offset:62464
    v_mfma_f32_16x16x32_bf16 v[92:95], a[220:223], v[60:63], v[92:95]
    s_waitcnt lgkmcnt(4)
    v_mfma_f32_16x16x32_bf16 v[80:83], a[224:227], v[32:35], v[80:83]
    ds_read_b128 v[56:59], v15 offset:61440
    v_mfma_f32_16x16x32_bf16 v[84:87], a[228:231], v[32:35], v[84:87]
    v_mfma_f32_16x16x32_bf16 v[88:91], a[224:227], v[36:39], v[88:91]
    ds_read_b128 v[60:63], v15 offset:62464
    s_add_u32 m0, s34, 73472
    v_mfma_f32_16x16x32_bf16 v[92:95], a[228:231], v[36:39], v[92:95]
    buffer_load_dwordx4 v8, s[12:15], s35 offen offset:256 lds
    s_waitcnt lgkmcnt(4)
    v_mfma_f32_16x16x32_bf16 v[80:83], a[232:235], v[40:43], v[80:83]
    ds_read_b128 v[32:35], v12 offset:0
    v_mfma_f32_16x16x32_bf16 v[84:87], a[236:239], v[40:43], v[84:87]
    v_mfma_f32_16x16x32_bf16 v[88:91], a[232:235], v[44:47], v[88:91]
    ds_read_b128 v[36:39], v12 offset:1024
    v_mfma_f32_16x16x32_bf16 v[92:95], a[236:239], v[44:47], v[92:95]
    s_waitcnt lgkmcnt(4)
    v_mfma_f32_16x16x32_bf16 v[80:83], a[240:243], v[48:51], v[80:83]
    ds_read_b128 v[40:43], v13 offset:0
    v_mfma_f32_16x16x32_bf16 v[84:87], a[244:247], v[48:51], v[84:87]
    v_mfma_f32_16x16x32_bf16 v[88:91], a[240:243], v[52:55], v[88:91]
    ds_read_b128 v[44:47], v13 offset:1024
    s_add_u32 m0, s34, 77440
    v_mfma_f32_16x16x32_bf16 v[92:95], a[244:247], v[52:55], v[92:95]
    buffer_load_dwordx4 v8, s[12:15], s35 offen offset:384 lds
    s_waitcnt lgkmcnt(4)
    v_mfma_f32_16x16x32_bf16 v[80:83], a[248:251], v[56:59], v[80:83]
    ds_read_b128 v[48:51], v12 offset:4096
    v_mfma_f32_16x16x32_bf16 v[84:87], a[252:255], v[56:59], v[84:87]
    v_mfma_f32_16x16x32_bf16 v[88:91], a[248:251], v[60:63], v[88:91]
    ds_read_b128 v[52:55], v12 offset:5120
    v_mfma_f32_16x16x32_bf16 v[92:95], a[252:255], v[60:63], v[92:95]
    s_add_u32 s30, s30, 2
    s_cmp_lt_u32 s30, s51
    s_cbranch_scc1 sl_loop_66
    v_cvt_pk_bf16_f32 v96, v80, v81
    v_cvt_pk_bf16_f32 v97, v82, v83
    v_cvt_pk_bf16_f32 v98, v84, v85
    v_cvt_pk_bf16_f32 v99, v86, v87
    v_cvt_pk_bf16_f32 v100, v88, v89
    v_cvt_pk_bf16_f32 v101, v90, v91
    v_cvt_pk_bf16_f32 v102, v92, v93
    v_cvt_pk_bf16_f32 v103, v94, v95
    s_branch sl_e_65
sl_v_64:
sl_loop_67:
    s_waitcnt lgkmcnt(4)
    v_mfma_f32_16x16x32_bf16 v[64:67], v[32:35], a[0:3], 0
    ds_read_b128 v[56:59], v13 offset:4096
    v_mfma_f32_16x16x32_bf16 v[68:71], v[32:35], a[4:7], 0
    v_mfma_f32_16x16x32_bf16 v[72:75], v[36:39], a[0:3], 0
    ds_read_b128 v[60:63], v13 offset:5120
    s_add_u32 m0, s34, 81408
    v_mfma_f32_16x16x32_bf16 v[76:79], v[36:39], a[4:7], 0
    buffer_load_dwordx4 v8, s[12:15], s35 offen offset:512 lds
    s_waitcnt lgkmcnt(4)
    v_mfma_f32_16x16x32_bf16 v[64:67], v[40:43], a[8:11], v[64:67]
    ds_read_b128 v[32:35], v12 offset:8192
    v_mfma_f32_16x16x32_bf16 v[68:71], v[40:43], a[12:15], v[68:71]
    v_mfma_f32_16x16x32_bf16 v[72:75], v[44:47], a[8:11], v[72:75]
    ds_read_b128 v[36:39], v12 offset:9216
    v_mfma_f32_16x16x32_bf16 v[76:79], v[44:47], a[12:15], v[76:79]
    s_waitcnt lgkmcnt(4)
    v_mfma_f32_16x16x32_bf16 v[64:67], v[48:51], a[16:19], v[64:67]
    ds_read_b128 v[40:43], v13 offset:8192
    v_mfma_f32_16x16x32_bf16 v[68:71], v[48:51], a[20:23], v[68:71]
    v_cvt_pk_bf16_f32 v96, v80, v81
    v_mfma_f32_16x16x32_bf16 v[72:75], v[52:55], a[16:19], v[72:75]
    ds_read_b128 v[44:47], v13 offset:9216
    s_add_u32 m0, s34, 85376
    v_mfma_f32_16x16x32_bf16 v[76:79], v[52:55], a[20:23], v[76:79]
    buffer_load_dwordx4 v8, s[12:15], s35 offen offset:640 lds
    v_cvt_pk_bf16_f32 v97, v82, v83
    s_waitcnt lgkmcnt(4)
    v_mfma_f32_16x16x32_bf16 v[64:67], v[56:59], a[24:27], v[64:67]
    ds_read_b128 v[48:51], v12 offset:12288
    v_mfma_f32_16x16x32_bf16 v[68:71], v[56:59], a[28:31], v[68:71]
    v_cvt_pk_bf16_f32 v98, v88, v89
    v_mfma_f32_16x16x32_bf16 v[72:75], v[60:63], a[24:27], v[72:75]
    ds_read_b128 v[52:55], v12 offset:13312
    v_mfma_f32_16x16x32_bf16 v[76:79], v[60:63], a[28:31], v[76:79]
    v_cvt_pk_bf16_f32 v99, v90, v91
    s_waitcnt lgkmcnt(4)
    v_mfma_f32_16x16x32_bf16 v[64:67], v[32:35], a[32:35], v[64:67]
    ds_read_b128 v[56:59], v13 offset:12288
    v_mfma_f32_16x16x32_bf16 v[68:71], v[32:35], a[36:39], v[68:71]
    v_cvt_pk_bf16_f32 v100, v84, v85
    v_mfma_f32_16x16x32_bf16 v[72:75], v[36:39], a[32:35], v[72:75]
    ds_read_b128 v[60:63], v13 offset:13312
    s_add_u32 m0, s34, 89344
    v_mfma_f32_16x16x32_bf16 v[76:79], v[36:39], a[36:39], v[76:79]
    buffer_load_dwordx4 v8, s[12:15], s35 offen offset:768 lds
    v_cvt_pk_bf16_f32 v101, v86, v87
    s_waitcnt lgkmcnt(4)
    v_mfma_f32_16x16x32_bf16 v[64:67], v[40:43], a[40:43], v[64:67]
    ds_read_b128 v[32:35], v12 offset:16384
    v_mfma_f32_16x16x32_bf16 v[68:71], v[40:43], a[44:47], v[68:71]
    v_cvt_pk_bf16_f32 v102, v92, v93
    v_mfma_f32_16x16x32_bf16 v[72:75], v[44:47], a[40:43], v[72:75]
    ds_read_b128 v[36:39], v12 offset:17408
    v_mfma_f32_16x16x32_bf16 v[76:79], v[44:47], a[44:47], v[76:79]
    v_cvt_pk_bf16_f32 v103, v94, v95
    buffer_store_dwordx4 v[96:99], v9, s[4:7], s36 offen sc1
    s_waitcnt lgkmcnt(4)
    v_mfma_f32_16x16x32_bf16 v[64:67], v[48:51], a[48:51], v[64:67]
    ds_read_b128 v[40:43], v13 offset:16384
    v_mfma_f32_16x16x32_bf16 v[68:71], v[48:51], a[52:55], v[68:71]
    v_mfma_f32_16x16x32_bf16 v[72:75], v[52:55], a[48:51], v[72:75]
    ds_read_b128 v[44:47], v13 offset:17408
    s_add_u32 m0, s34, 93312
    v_mfma_f32_16x16x32_bf16 v[76:79], v[52:55], a[52:55], v[76:79]
    buffer_load_dwordx4 v8, s[12:15], s35 offen offset:896 lds
    s_waitcnt lgkmcnt(4)
    v_mfma_f32_16x16x32_bf16 v[64:67], v[56:59], a[56:59], v[64:67]
    ds_read_b128 v[48:51], v12 offset:20480
    v_mfma_f32_16x16x32_bf16 v[68:71], v[56:59], a[60:63], v[68:71]
    v_mfma_f32_16x16x32_bf16 v[72:75], v[60:63], a[56:59], v[72:75]
    ds_read_b128 v[52:55], v12 offset:21504
    v_mfma_f32_16x16x32_bf16 v[76:79], v[60:63], a[60:63], v[76:79]
    buffer_store_dwordx4 v[100:103], v9, s[4:7], s36 offen offset:128 sc1
    s_add_u32 s36, s36, s37
    s_waitcnt vmcnt(8)
    s_barrier
    s_waitcnt lgkmcnt(4)
    v_mfma_f32_16x16x32_bf16 v[64:67], v[32:35], a[64:67], v[64:67]
    ds_read_b128 v[56:59], v13 offset:20480
    v_mfma_f32_16x16x32_bf16 v[68:71], v[32:35], a[68:71], v[68:71]
    v_mfma_f32_16x16x32_bf16 v[72:75], v[36:39], a[64:67], v[72:75]
    ds_read_b128 v[60:63], v13 offset:21504
    s_add_u32 m0, s34, 97280
    v_mfma_f32_16x16x32_bf16 v[76:79], v[36:39], a[68:71], v[76:79]
    buffer_load_dwordx4 v8, s[12:15], s35 offen offset:1024 lds
    s_waitcnt lgkmcnt(4)
    v_mfma_f32_16x16x32_bf16 v[64:67], v[40:43], a[72:75], v[64:67]
    ds_read_b128 v[32:35], v12 offset:24576
    v_mfma_f32_16x16x32_bf16 v[68:71], v[40:43], a[76:79], v[68:71]
    v_mfma_f32_16x16x32_bf16 v[72:75], v[44:47], a[72:75], v[72:75]
    ds_read_b128 v[36:39], v12 offset:25600
    v_mfma_f32_16x16x32_bf16 v[76:79], v[44:47], a[76:79], v[76:79]
    s_waitcnt lgkmcnt(4)
    v_mfma_f32_16x16x32_bf16 v[64:67], v[48:51], a[80:83], v[64:67]
    ds_read_b128 v[40:43], v13 offset:24576
    v_mfma_f32_16x16x32_bf16 v[68:71], v[48:51], a[84:87], v[68:71]
    v_and_b32 v9, 0xffffff, v9
    v_mfma_f32_16x16x32_bf16 v[72:75], v[52:55], a[80:83], v[72:75]
    ds_read_b128 v[44:47], v13 offset:25600
    s_add_u32 m0, s34, 101248
    v_mfma_f32_16x16x32_bf16 v[76:79], v[52:55], a[84:87], v[76:79]
    buffer_load_dwordx4 v8, s[12:15], s35 offen offset:1152 lds
    s_waitcnt lgkmcnt(4)
    v_mfma_f32_16x16x32_bf16 v[64:67], v[56:59], a[88:91], v[64:67]
    ds_read_b128 v[48:51], v12 offset:28672
    v_mfma_f32_16x16x32_bf16 v[68:71], v[56:59], a[92:95], v[68:71]
    v_mfma_f32_16x16x32_bf16 v[72:75], v[60:63], a[88:91], v[72:75]
    ds_read_b128 v[52:55], v12 offset:29696
    v_mfma_f32_16x16x32_bf16 v[76:79], v[60:63], a[92:95], v[76:79]
    s_waitcnt lgkmcnt(4)
    v_mfma_f32_16x16x32_bf16 v[64:67], v[32:35], a[96:99], v[64:67]
    ds_read_b128 v[56:59], v13 offset:28672
    v_mfma_f32_16x16x32_bf16 v[68:71], v[32:35], a[100:103], v[68:71]
    v_mfma_f32_16x16x32_bf16 v[72:75], v[36:39], a[96:99], v[72:75]
    ds_read_b128 v[60:63], v13 offset:29696
    s_add_u32 m0, s34, 105216
    v_mfma_f32_16x16x32_bf16 v[76:79], v[36:39], a[100:103], v[76:79]
    buffer_load_dwordx4 v8, s[12:15], s35 offen offset:1280 lds
    s_waitcnt lgkmcnt(4)
    v_mfma_f32_16x16x32_bf16 v[64:67], v[40:43], a[104:107], v[64:67]
    ds_read_b128 v[32:35], v12 offset:32768
    v_mfma_f32_16x16x32_bf16 v[68:71], v[40:43], a[108:111], v[68:71]
    v_mfma_f32_16x16x32_bf16 v[72:75], v[44:47], a[104:107], v[72:75]
    ds_read_b128 v[36:39], v12 offset:33792
    v_mfma_f32_16x16x32_bf16 v[76:79], v[44:47], a[108:111], v[76:79]
    s_waitcnt lgkmcnt(4)
    v_mfma_f32_16x16x32_bf16 v[64:67], v[48:51], a[112:115], v[64:67]
    ds_read_b128 v[40:43], v13 offset:32768
    v_mfma_f32_16x16x32_bf16 v[68:71], v[48:51], a[116:119], v[68:71]
    v_mfma_f32_16x16x32_bf16 v[72:75], v[52:55], a[112:115], v[72:75]
    ds_read_b128 v[44:47], v13 offset:33792
    s_add_u32 m0, s34, 109184
    v_mfma_f32_16x16x32_bf16 v[76:79], v[52:55], a[116:119], v[76:79]
    buffer_load_dwordx4 v8, s[12:15], s35 offen offset:1408 lds
    s_waitcnt lgkmcnt(4)
    v_mfma_f32_16x16x32_bf16 v[64:67], v[56:59], a[120:123], v[64:67]
    ds_read_b128 v[48:51], v12 offset:36864
    v_mfma_f32_16x16x32_bf16 v[68:71], v[56:59], a[124:127], v[68:71]
    v_mfma_f32_16x16x32_bf16 v[72:75], v[60:63], a[120:123], v[72:75]
    ds_read_b128 v[52:55], v12 offset:37888
    v_mfma_f32_16x16x32_bf16 v[76:79], v[60:63], a[124:127], v[76:79]
    s_waitcnt lgkmcnt(4)
    v_mfma_f32_16x16x32_bf16 v[64:67], v[32:35], a[128:131], v[64:67]
    ds_read_b128 v[56:59], v13 offset:36864
    v_mfma_f32_16x16x32_bf16 v[68:71], v[32:35], a[132:135], v[68:71]
    v_mfma_f32_16x16x32_bf16 v[72:75], v[36:39], a[128:131], v[72:75]
    ds_read_b128 v[60:63], v13 offset:37888
    s_add_u32 m0, s34, 113152
    v_mfma_f32_16x16x32_bf16 v[76:79], v[36:39], a[132:135], v[76:79]
    buffer_load_dwordx4 v8, s[12:15], s35 offen offset:1536 lds
    s_waitcnt lgkmcnt(4)
    v_mfma_f32_16x16x32_bf16 v[64:67], v[40:43], a[136:139], v[64:67]
    ds_read_b128 v[32:35], v12 offset:40960
    v_mfma_f32_16x16x32_bf16 v[68:71], v[40:43], a[140:143], v[68:71]
    v_mfma_f32_16x16x32_bf16 v[72:75], v[44:47], a[136:139], v[72:75]
    ds_read_b128 v[36:39], v12 offset:41984
    v_mfma_f32_16x16x32_bf16 v[76:79], v[44:47], a[140:143], v[76:79]
    s_waitcnt lgkmcnt(4)
    v_mfma_f32_16x16x32_bf16 v[64:67], v[48:51], a[144:147], v[64:67]
    ds_read_b128 v[40:43], v13 offset:40960
    v_mfma_f32_16x16x32_bf16 v[68:71], v[48:51], a[148:151], v[68:71]
    v_mfma_f32_16x16x32_bf16 v[72:75], v[52:55], a[144:147], v[72:75]
    ds_read_b128 v[44:47], v13 offset:41984
    s_add_u32 m0, s34, 117120
    v_mfma_f32_16x16x32_bf16 v[76:79], v[52:55], a[148:151], v[76:79]
    buffer_load_dwordx4 v8, s[12:15], s35 offen offset:1664 lds
    s_waitcnt lgkmcnt(4)
    v_mfma_f32_16x16x32_bf16 v[64:67], v[56:59], a[152:155], v[64:67]
    ds_read_b128 v[48:51], v12 offset:45056
    v_mfma_f32_16x16x32_bf16 v[68:71], v[56:59], a[156:159], v[68:71]
    v_mfma_f32_16x16x32_bf16 v[72:75], v[60:63], a[152:155], v[72:75]
    ds_read_b128 v[52:55], v12 offset:46080
    v_mfma_f32_16x16x32_bf16 v[76:79], v[60:63], a[156:159], v[76:79]
    s_waitcnt lgkmcnt(4)
    v_mfma_f32_16x16x32_bf16 v[64:67], v[32:35], a[160:163], v[64:67]
    ds_read_b128 v[56:59], v13 offset:45056
    v_mfma_f32_16x16x32_bf16 v[68:71], v[32:35], a[164:167], v[68:71]
    v_mfma_f32_16x16x32_bf16 v[72:75], v[36:39], a[160:163], v[72:75]
    ds_read_b128 v[60:63], v13 offset:46080
    s_add_u32 m0, s34, 121088
    v_mfma_f32_16x16x32_bf16 v[76:79], v[36:39], a[164:167], v[76:79]
    buffer_load_dwordx4 v8, s[12:15], s35 offen offset:1792 lds
    s_waitcnt lgkmcnt(4)
    v_mfma_f32_16x16x32_bf16 v[64:67], v[40:43], a[168:171], v[64:67]
    ds_read_b128 v[32:35], v12 offset:49152
    v_mfma_f32_16x16x32_bf16 v[68:71], v[40:43], a[172:175], v[68:71]
    v_mfma_f32_16x16x32_bf16 v[72:75], v[44:47], a[168:171], v[72:75]
    ds_read_b128 v[36:39], v12 offset:50176
    v_mfma_f32_16x16x32_bf16 v[76:79], v[44:47], a[172:175], v[76:79]
    s_waitcnt lgkmcnt(4)
    v_mfma_f32_16x16x32_bf16 v[64:67], v[48:51], a[176:179], v[64:67]
    ds_read_b128 v[40:43], v13 offset:49152
    v_mfma_f32_16x16x32_bf16 v[68:71], v[48:51], a[180:183], v[68:71]
    v_mfma_f32_16x16x32_bf16 v[72:75], v[52:55], a[176:179], v[72:75]
    ds_read_b128 v[44:47], v13 offset:50176
    s_add_u32 m0, s34, 125056
    v_mfma_f32_16x16x32_bf16 v[76:79], v[52:55], a[180:183], v[76:79]
    buffer_load_dwordx4 v8, s[12:15], s35 offen offset:1920 lds
    s_add_u32 s35, s35, 65536
    s_min_u32 s35, s35, s52
    s_waitcnt lgkmcnt(4)
    v_mfma_f32_16x16x32_bf16 v[64:67], v[56:59], a[184:187], v[64:67]
    ds_read_b128 v[48:51], v12 offset:53248
    v_mfma_f32_16x16x32_bf16 v[68:71], v[56:59], a[188:191], v[68:71]
    v_mfma_f32_16x16x32_bf16 v[72:75], v[60:63], a[184:187], v[72:75]
    ds_read_b128 v[52:55], v12 offset:54272
    v_mfma_f32_16x16x32_bf16 v[76:79], v[60:63], a[188:191], v[76:79]
    s_waitcnt vmcnt(8)
    s_barrier
    s_waitcnt lgkmcnt(4)
    v_mfma_f32_16x16x32_bf16 v[64:67], v[32:35], a[192:195], v[64:67]
    ds_read_b128 v[56:59], v13 offset:53248
    v_mfma_f32_16x16x32_bf16 v[68:71], v[32:35], a[196:199], v[68:71]
    v_mfma_f32_16x16x32_bf16 v[72:75], v[36:39], a[192:195], v[72:75]
    ds_read_b128 v[60:63], v13 offset:54272
    s_add_u32 m0, s34, 0
    v_mfma_f32_16x16x32_bf16 v[76:79], v[36:39], a[196:199], v[76:79]
    buffer_load_dwordx4 v8, s[12:15], s35 offen offset:0 lds
    s_waitcnt lgkmcnt(4)
    v_mfma_f32_16x16x32_bf16 v[64:67], v[40:43], a[200:203], v[64:67]
    ds_read_b128 v[32:35], v12 offset:57344
    v_mfma_f32_16x16x32_bf16 v[68:71], v[40:43], a[204:207], v[68:71]
    buffer_store_dword v11, v10, s[4:7], 0 offen sc1
    v_add_u32 v11, 1, v11
    v_mfma_f32_16x16x32_bf16 v[72:75], v[44:47], a[200:203], v[72:75]
    ds_read_b128 v[36:39], v12 offset:58368
    v_mfma_f32_16x16x32_bf16 v[76:79], v[44:47], a[204:207], v[76:79]
    s_waitcnt lgkmcnt(4)
    v_mfma_f32_16x16x32_bf16 v[64:67], v[48:51], a[208:211], v[64:67]
    ds_read_b128 v[40:43], v13 offset:57344
    v_mfma_f32_16x16x32_bf16 v[68:71], v[48:51], a[212:215], v[68:71]
    v_mfma_f32_16x16x32_bf16 v[72:75], v[52:55], a[208:211], v[72:75]
    ds_read_b128 v[44:47], v13 offset:58368
    s_add_u32 m0, s34, 3968
    v_mfma_f32_16x16x32_bf16 v[76:79], v[52:55], a[212:215], v[76:79]
    buffer_load_dwordx4 v8, s[12:15], s35 offen offset:128 lds
    s_waitcnt lgkmcnt(4)
    v_mfma_f32_16x16x32_bf16 v[64:67], v[56:59], a[216:219], v[64:67]
    ds_read_b128 v[48:51], v12 offset:61440
    v_mfma_f32_16x16x32_bf16 v[68:71], v[56:59], a[220:223], v[68:71]
    v_mfma_f32_16x16x32_bf16 v[72:75], v[60:63], a[216:219], v[72:75]
    ds_read_b128 v[52:55], v12 offset:62464
    v_mfma_f32_16x16x32_bf16 v[76:79], v[60:63], a[220:223], v[76:79]
    s_waitcnt lgkmcnt(4)
    v_mfma_f32_16x16x32_bf16 v[64:67], v[32:35], a[224:227], v[64:67]
    ds_read_b128 v[56:59], v13 offset:61440
    v_mfma_f32_16x16x32_bf16 v[68:71], v[32:35], a[228:231], v[68:71]
    v_mfma_f32_16x16x32_bf16 v[72:75], v[36:39], a[224:227], v[72:75]
    ds_read_b128 v[60:63], v13 offset:62464
    s_add_u32 m0, s34, 7936
    v_mfma_f32_16x16x32_bf16 v[76:79], v[36:39], a[228:231], v[76:79]
    buffer_load_dwordx4 v8, s[12:15], s35 offen offset:256 lds
    s_waitcnt lgkmcnt(4)
    v_mfma_f32_16x16x32_bf16 v[64:67], v[40:43], a[232:235], v[64:67]
    ds_read_b128 v[32:35], v14 offset:0
    v_mfma_f32_16x16x32_bf16 v[68:71], v[40:43], a[236:239], v[68:71]
    v_mfma_f32_16x16x32_bf16 v[72:75], v[44:47], a[232:235], v[72:75]
    ds_read_b128 v[36:39], v14 offset:1024
    v_mfma_f32_16x16x32_bf16 v[76:79], v[44:47], a[236:239], v[76:79]
    s_waitcnt lgkmcnt(4)
    v_mfma_f32_16x16x32_bf16 v[64:67], v[48:51], a[240:243], v[64:67]
    ds_read_b128 v[40:43], v15 offset:0
    v_mfma_f32_16x16x32_bf16 v[68:71], v[48:51], a[244:247], v[68:71]
    v_mfma_f32_16x16x32_bf16 v[72:75], v[52:55], a[240:243], v[72:75]
    ds_read_b128 v[44:47], v15 offset:1024
    s_add_u32 m0, s34, 11904
    v_mfma_f32_16x16x32_bf16 v[76:79], v[52:55], a[244:247], v[76:79]
    buffer_load_dwordx4 v8, s[12:15], s35 offen offset:384 lds
    s_waitcnt lgkmcnt(4)
    v_mfma_f32_16x16x32_bf16 v[64:67], v[56:59], a[248:251], v[64:67]
    ds_read_b128 v[48:51], v14 offset:4096
    v_mfma_f32_16x16x32_bf16 v[68:71], v[56:59], a[252:255], v[68:71]
    v_mfma_f32_16x16x32_bf16 v[72:75], v[60:63], a[248:251], v[72:75]
    ds_read_b128 v[52:55], v14 offset:5120
    v_mfma_f32_16x16x32_bf16 v[76:79], v[60:63], a[252:255], v[76:79]
    s_waitcnt lgkmcnt(4)
    v_mfma_f32_16x16x32_bf16 v[80:83], v[32:35], a[0:3], 0
    ds_read_b128 v[56:59], v15 offset:4096
    v_mfma_f32_16x16x32_bf16 v[84:87], v[32:35], a[4:7], 0
    v_mfma_f32_16x16x32_bf16 v[88:91], v[36:39], a[0:3], 0
    ds_read_b128 v[60:63], v15 offset:5120
    s_add_u32 m0, s34, 15872
    v_mfma_f32_16x16x32_bf16 v[92:95], v[36:39], a[4:7], 0
    buffer_load_dwordx4 v8, s[12:15], s35 offen offset:512 lds
    s_waitcnt lgkmcnt(4)
    v_mfma_f32_16x16x32_bf16 v[80:83], v[40:43], a[8:11], v[80:83]
    ds_read_b128 v[32:35], v14 offset:8192
    v_mfma_f32_16x16x32_bf16 v[84:87], v[40:43], a[12:15], v[84:87]
    v_mfma_f32_16x16x32_bf16 v[88:91], v[44:47], a[8:11], v[88:91]
    ds_read_b128 v[36:39], v14 offset:9216
    v_mfma_f32_16x16x32_bf16 v[92:95], v[44:47], a[12:15], v[92:95]
    s_waitcnt lgkmcnt(4)
    v_mfma_f32_16x16x32_bf16 v[80:83], v[48:51], a[16:19], v[80:83]
    ds_read_b128 v[40:43], v15 offset:8192
    v_mfma_f32_16x16x32_bf16 v[84:87], v[48:51], a[20:23], v[84:87]
    v_cvt_pk_bf16_f32 v96, v64, v65
    v_mfma_f32_16x16x32_bf16 v[88:91], v[52:55], a[16:19], v[88:91]
    ds_read_b128 v[44:47], v15 offset:9216
    s_add_u32 m0, s34, 19840
    v_mfma_f32_16x16x32_bf16 v[92:95], v[52:55], a[20:23], v[92:95]
    buffer_load_dwordx4 v8, s[12:15], s35 offen offset:640 lds
    v_cvt_pk_bf16_f32 v97, v66, v67
    s_waitcnt lgkmcnt(4)
    v_mfma_f32_16x16x32_bf16 v[80:83], v[56:59], a[24:27], v[80:83]
    ds_read_b128 v[48:51], v14 offset:12288
    v_mfma_f32_16x16x32_bf16 v[84:87], v[56:59], a[28:31], v[84:87]
    v_cvt_pk_bf16_f32 v98, v72, v73
    v_mfma_f32_16x16x32_bf16 v[88:91], v[60:63], a[24:27], v[88:91]
    ds_read_b128 v[52:55], v14 offset:13312
    v_mfma_f32_16x16x32_bf16 v[92:95], v[60:63], a[28:31], v[92:95]
    v_cvt_pk_bf16_f32 v99, v74, v75
    s_waitcnt lgkmcnt(4)
    v_mfma_f32_16x16x32_bf16 v[80:83], v[32:35], a[32:35], v[80:83]
    ds_read_b128 v[56:59], v15 offset:12288
    v_mfma_f32_16x16x32_bf16 v[84:87], v[32:35], a[36:39], v[84:87]
    v_cvt_pk_bf16_f32 v100, v68, v69
    v_mfma_f32_16x16x32_bf16 v[88:91], v[36:39], a[32:35], v[88:91]
    ds_read_b128 v[60:63], v15 offset:13312
    s_add_u32 m0, s34, 23808
    v_mfma_f32_16x16x32_bf16 v[92:95], v[36:39], a[36:39], v[92:95]
    buffer_load_dwordx4 v8, s[12:15], s35 offen offset:768 lds
    v_cvt_pk_bf16_f32 v101, v70, v71
    s_waitcnt lgkmcnt(4)
    v_mfma_f32_16x16x32_bf16 v[80:83], v[40:43], a[40:43], v[80:83]
    ds_read_b128 v[32:35], v14 offset:16384
    v_mfma_f32_16x16x32_bf16 v[84:87], v[40:43], a[44:47], v[84:87]
    v_cvt_pk_bf16_f32 v102, v76, v77
    v_mfma_f32_16x16x32_bf16 v[88:91], v[44:47], a[40:43], v[88:91]
    ds_read_b128 v[36:39], v14 offset:17408
    v_mfma_f32_16x16x32_bf16 v[92:95], v[44:47], a[44:47], v[92:95]
    v_cvt_pk_bf16_f32 v103, v78, v79
    buffer_store_dwordx4 v[96:99], v9, s[4:7], s36 offen sc1
    s_waitcnt lgkmcnt(4)
    v_mfma_f32_16x16x32_bf16 v[80:83], v[48:51], a[48:51], v[80:83]
    ds_read_b128 v[40:43], v15 offset:16384
    v_mfma_f32_16x16x32_bf16 v[84:87], v[48:51], a[52:55], v[84:87]
    v_mfma_f32_16x16x32_bf16 v[88:91], v[52:55], a[48:51], v[88:91]
    ds_read_b128 v[44:47], v15 offset:17408
    s_add_u32 m0, s34, 27776
    v_mfma_f32_16x16x32_bf16 v[92:95], v[52:55], a[52:55], v[92:95]
    buffer_load_dwordx4 v8, s[12:15], s35 offen offset:896 lds
    s_waitcnt lgkmcnt(4)
    v_mfma_f32_16x16x32_bf16 v[80:83], v[56:59], a[56:59], v[80:83]
    ds_read_b128 v[48:51], v14 offset:20480
    v_mfma_f32_16x16x32_bf16 v[84:87], v[56:59], a[60:63], v[84:87]
    v_mfma_f32_16x16x32_bf16 v[88:91], v[60:63], a[56:59], v[88:91]
    ds_read_b128 v[52:55], v14 offset:21504
    v_mfma_f32_16x16x32_bf16 v[92:95], v[60:63], a[60:63], v[92:95]
    buffer_store_dwordx4 v[100:103], v9, s[4:7], s36 offen offset:128 sc1
    s_add_u32 s36, s36, s37
    s_waitcnt vmcnt(8)
    s_barrier
    s_waitcnt lgkmcnt(4)
    v_mfma_f32_16x16x32_bf16 v[80:83], v[32:35], a[64:67], v[80:83]
    ds_read_b128 v[56:59], v15 offset:20480
    v_mfma_f32_16x16x32_bf16 v[84:87], v[32:35], a[68:71], v[84:87]
    v_mfma_f32_16x16x32_bf16 v[88:91], v[36:39], a[64:67], v[88:91]
    ds_read_b128 v[60:63], v15 offset:21504
    s_add_u32 m0, s34, 31744
    v_mfma_f32_16x16x32_bf16 v[92:95], v[36:39], a[68:71], v[92:95]
    buffer_load_dwordx4 v8, s[12:15], s35 offen offset:1024 lds
    s_waitcnt lgkmcnt(4)
    v_mfma_f32_16x16x32_bf16 v[80:83], v[40:43], a[72:75], v[80:83]
    ds_read_b128 v[32:35], v14 offset:24576
    v_mfma_f32_16x16x32_bf16 v[84:87], v[40:43], a[76:79], v[84:87]
    v_mfma_f32_16x16x32_bf16 v[88:91], v[44:47], a[72:75], v[88:91]
    ds_read_b128 v[36:39], v14 offset:25600
    v_mfma_f32_16x16x32_bf16 v[92:95], v[44:47], a[76:79], v[92:95]
    s_waitcnt lgkmcnt(4)
    v_mfma_f32_16x16x32_bf16 v[80:83], v[48:51], a[80:83], v[80:83]
    ds_read_b128 v[40:43], v15 offset:24576
    v_mfma_f32_16x16x32_bf16 v[84:87], v[48:51], a[84:87], v[84:87]
    v_mfma_f32_16x16x32_bf16 v[88:91], v[52:55], a[80:83], v[88:91]
    ds_read_b128 v[44:47], v15 offset:25600
    s_add_u32 m0, s34, 35712
    v_mfma_f32_16x16x32_bf16 v[92:95], v[52:55], a[84:87], v[92:95]
    buffer_load_dwordx4 v8, s[12:15], s35 offen offset:1152 lds
    s_waitcnt lgkmcnt(4)
    v_mfma_f32_16x16x32_bf16 v[80:83], v[56:59], a[88:91], v[80:83]
    ds_read_b128 v[48:51], v14 offset:28672
    v_mfma_f32_16x16x32_bf16 v[84:87], v[56:59], a[92:95], v[84:87]
    v_mfma_f32_16x16x32_bf16 v[88:91], v[60:63], a[88:91], v[88:91]
    ds_read_b128 v[52:55], v14 offset:29696
    v_mfma_f32_16x16x32_bf16 v[92:95], v[60:63], a[92:95], v[92:95]
    s_waitcnt lgkmcnt(4)
    v_mfma_f32_16x16x32_bf16 v[80:83], v[32:35], a[96:99], v[80:83]
    ds_read_b128 v[56:59], v15 offset:28672
    v_mfma_f32_16x16x32_bf16 v[84:87], v[32:35], a[100:103], v[84:87]
    v_mfma_f32_16x16x32_bf16 v[88:91], v[36:39], a[96:99], v[88:91]
    ds_read_b128 v[60:63], v15 offset:29696
    s_add_u32 m0, s34, 39680
    v_mfma_f32_16x16x32_bf16 v[92:95], v[36:39], a[100:103], v[92:95]
    buffer_load_dwordx4 v8, s[12:15], s35 offen offset:1280 lds
    s_waitcnt lgkmcnt(4)
    v_mfma_f32_16x16x32_bf16 v[80:83], v[40:43], a[104:107], v[80:83]
    ds_read_b128 v[32:35], v14 offset:32768
    v_mfma_f32_16x16x32_bf16 v[84:87], v[40:43], a[108:111], v[84:87]
    v_mfma_f32_16x16x32_bf16 v[88:91], v[44:47], a[104:107], v[88:91]
    ds_read_b128 v[36:39], v14 offset:33792
    v_mfma_f32_16x16x32_bf16 v[92:95], v[44:47], a[108:111], v[92:95]
    s_waitcnt lgkmcnt(4)
    v_mfma_f32_16x16x32_bf16 v[80:83], v[48:51], a[112:115], v[80:83]
    ds_read_b128 v[40:43], v15 offset:32768
    v_mfma_f32_16x16x32_bf16 v[84:87], v[48:51], a[116:119], v[84:87]
    v_mfma_f32_16x16x32_bf16 v[88:91], v[52:55], a[112:115], v[88:91]
    ds_read_b128 v[44:47], v15 offset:33792
    s_add_u32 m0, s34, 43648
    v_mfma_f32_16x16x32_bf16 v[92:95], v[52:55], a[116:119], v[92:95]
    buffer_load_dwordx4 v8, s[12:15], s35 offen offset:1408 lds
    s_waitcnt lgkmcnt(4)
    v_mfma_f32_16x16x32_bf16 v[80:83], v[56:59], a[120:123], v[80:83]
    ds_read_b128 v[48:51], v14 offset:36864
    v_mfma_f32_16x16x32_bf16 v[84:87], v[56:59], a[124:127], v[84:87]
    v_mfma_f32_16x16x32_bf16 v[88:91], v[60:63], a[120:123], v[88:91]
    ds_read_b128 v[52:55], v14 offset:37888
    v_mfma_f32_16x16x32_bf16 v[92:95], v[60:63], a[124:127], v[92:95]
    s_waitcnt lgkmcnt(4)
    v_mfma_f32_16x16x32_bf16 v[80:83], v[32:35], a[128:131], v[80:83]
    ds_read_b128 v[56:59], v15 offset:36864
    v_mfma_f32_16x16x32_bf16 v[84:87], v[32:35], a[132:135], v[84:87]
    v_mfma_f32_16x16x32_bf16 v[88:91], v[36:39], a[128:131], v[88:91]
    ds_read_b128 v[60:63], v15 offset:37888
    s_add_u32 m0, s34, 47616
    v_mfma_f32_16x16x32_bf16 v[92:95], v[36:39], a[132:135], v[92:95]
    buffer_load_dwordx4 v8, s[12:15], s35 offen offset:1536 lds
    s_waitcnt lgkmcnt(4)
    v_mfma_f32_16x16x32_bf16 v[80:83], v[40:43], a[136:139], v[80:83]
    ds_read_b128 v[32:35], v14 offset:40960
    v_mfma_f32_16x16x32_bf16 v[84:87], v[40:43], a[140:143], v[84:87]
    v_mfma_f32_16x16x32_bf16 v[88:91], v[44:47], a[136:139], v[88:91]
    ds_read_b128 v[36:39], v14 offset:41984
    v_mfma_f32_16x16x32_bf16 v[92:95], v[44:47], a[140:143], v[92:95]
    s_waitcnt lgkmcnt(4)
    v_mfma_f32_16x16x32_bf16 v[80:83], v[48:51], a[144:147], v[80:83]
    ds_read_b128 v[40:43], v15 offset:40960
    v_mfma_f32_16x16x32_bf16 v[84:87], v[48:51], a[148:151], v[84:87]
    v_mfma_f32_16x16x32_bf16 v[88:91], v[52:55], a[144:147], v[88:91]
    ds_read_b128 v[44:47], v15 offset:41984
    s_add_u32 m0, s34, 51584
    v_mfma_f32_16x16x32_bf16 v[92:95], v[52:55], a[148:151], v[92:95]
    buffer_load_dwordx4 v8, s[12:15], s35 offen offset:1664 lds
    s_waitcnt lgkmcnt(4)
    v_mfma_f32_16x16x32_bf16 v[80:83], v[56:59], a[152:155], v[80:83]
    ds_read_b128 v[48:51], v14 offset:45056
    v_mfma_f32_16x16x32_bf16 v[84:87], v[56:59], a[156:159], v[84:87]
    v_mfma_f32_16x16x32_bf16 v[88:91], v[60:63], a[152:155], v[88:91]
    ds_read_b128 v[52:55], v14 offset:46080
    v_mfma_f32_16x16x32_bf16 v[92:95], v[60:63], a[156:159], v[92:95]
    s_waitcnt lgkmcnt(4)
    v_mfma_f32_16x16x32_bf16 v[80:83], v[32:35], a[160:163], v[80:83]
    ds_read_b128 v[56:59], v15 offset:45056
    v_mfma_f32_16x16x32_bf16 v[84:87], v[32:35], a[164:167], v[84:87]
    v_mfma_f32_16x16x32_bf16 v[88:91], v[36:39], a[160:163], v[88:91]
    ds_read_b128 v[60:63], v15 offset:46080
    s_add_u32 m0, s34, 55552
    v_mfma_f32_16x16x32_bf16 v[92:95], v[36:39], a[164:167], v[92:95]
    buffer_load_dwordx4 v8, s[12:15], s35 offen offset:1792 lds
    s_waitcnt lgkmcnt(4)
    v_mfma_f32_16x16x32_bf16 v[80:83], v[40:43], a[168:171], v[80:83]
    ds_read_b128 v[32:35], v14 offset:49152
    v_mfma_f32_16x16x32_bf16 v[84:87], v[40:43], a[172:175], v[84:87]
    v_mfma_f32_16x16x32_bf16 v[88:91], v[44:47], a[168:171], v[88:91]
    ds_read_b128 v[36:39], v14 offset:50176
    v_mfma_f32_16x16x32_bf16 v[92:95], v[44:47], a[172:175], v[92:95]
    s_waitcnt lgkmcnt(4)
    v_mfma_f32_16x16x32_bf16 v[80:83], v[48:51], a[176:179], v[80:83]
    ds_read_b128 v[40:43], v15 offset:49152
    v_mfma_f32_16x16x32_bf16 v[84:87], v[48:51], a[180:183], v[84:87]
    v_mfma_f32_16x16x32_bf16 v[88:91], v[52:55], a[176:179], v[88:91]
    ds_read_b128 v[44:47], v15 offset:50176
    s_add_u32 m0, s34, 59520
    v_mfma_f32_16x16x32_bf16 v[92:95], v[52:55], a[180:183], v[92:95]
    buffer_load_dwordx4 v8, s[12:15], s35 offen offset:1920 lds
    s_add_u32 s35, s35, 65536
    s_min_u32 s35, s35, s52
    s_waitcnt lgkmcnt(4)
    v_mfma_f32_16x16x32_bf16 v[80:83], v[56:59], a[184:187], v[80:83]
    ds_read_b128 v[48:51], v14 offset:53248
    v_mfma_f32_16x16x32_bf16 v[84:87], v[56:59], a[188:191], v[84:87]
    v_mfma_f32_16x16x32_bf16 v[88:91], v[60:63], a[184:187], v[88:91]
    ds_read_b128 v[52:55], v14 offset:54272
    v_mfma_f32_16x16x32_bf16 v[92:95], v[60:63], a[188:191], v[92:95]
    s_waitcnt vmcnt(8)
    s_barrier
    s_waitcnt lgkmcnt(4)
    v_mfma_f32_16x16x32_bf16 v[80:83], v[32:35], a[192:195], v[80:83]
    ds_read_b128 v[56:59], v15 offset:53248
    v_mfma_f32_16x16x32_bf16 v[84:87], v[32:35], a[196:199], v[84:87]
    v_mfma_f32_16x16x32_bf16 v[88:91], v[36:39], a[192:195], v[88:91]
    ds_read_b128 v[60:63], v15 offset:54272
    s_add_u32 m0, s34, 65536
    v_mfma_f32_16x16x32_bf16 v[92:95], v[36:39], a[196:199], v[92:95]
    buffer_load_dwordx4 v8, s[12:15], s35 offen offset:0 lds
    s_waitcnt lgkmcnt(4)
    v_mfma_f32_16x16x32_bf16 v[80:83], v[40:43], a[200:203], v[80:83]
    ds_read_b128 v[32:35], v14 offset:57344
    v_mfma_f32_16x16x32_bf16 v[84:87], v[40:43], a[204:207], v[84:87]
    buffer_store_dword v11, v10, s[4:7], 0 offen sc1
    v_add_u32 v11, 1, v11
    v_mfma_f32_16x16x32_bf16 v[88:91], v[44:47], a[200:203], v[88:91]
    ds_read_b128 v[36:39], v14 offset:58368
    v_mfma_f32_16x16x32_bf16 v[92:95], v[44:47], a[204:207], v[92:95]
    s_waitcnt lgkmcnt(4)
    v_mfma_f32_16x16x32_bf16 v[80:83], v[48:51], a[208:211], v[80:83]
    ds_read_b128 v[40:43], v15 offset:57344
    v_mfma_f32_16x16x32_bf16 v[84:87], v[48:51], a[212:215], v[84:87]
    v_mfma_f32_16x16x32_bf16 v[88:91], v[52:55], a[208:211], v[88:91]
    ds_read_b128 v[44:47], v15 offset:58368
    s_add_u32 m0, s34, 69504
    v_mfma_f32_16x16x32_bf16 v[92:95], v[52:55], a[212:215], v[92:95]
    buffer_load_dwordx4 v8, s[12:15], s35 offen offset:128 lds
    s_waitcnt lgkmcnt(4)
    v_mfma_f32_16x16x32_bf16 v[80:83], v[56:59], a[216:219], v[80:83]
    ds_read_b128 v[48:51], v14 offset:61440
    v_mfma_f32_16x16x32_bf16 v[84:87], v[56:59], a[220:223], v[84:87]
    v_mfma_f32_16x16x32_bf16 v[88:91], v[60:63], a[216:219], v[88:91]
    ds_read_b128 v[52:55], v14 offset:62464
    v_mfma_f32_16x16x32_bf16 v[92:95], v[60:63], a[220:223], v[92:95]
    s_waitcnt lgkmcnt(4)
    v_mfma_f32_16x16x32_bf16 v[80:83], v[32:35], a[224:227], v[80:83]
    ds_read_b128 v[56:59], v15 offset:61440
    v_mfma_f32_16x16x32_bf16 v[84:87], v[32:35], a[228:231], v[84:87]
    v_mfma_f32_16x16x32_bf16 v[88:91], v[36:39], a[224:227], v[88:91]
    ds_read_b128 v[60:63], v15 offset:62464
    s_add_u32 m0, s34, 73472
    v_mfma_f32_16x16x32_bf16 v[92:95], v[36:39], a[228:231], v[92:95]
    buffer_load_dwordx4 v8, s[12:15], s35 offen offset:256 lds
    s_waitcnt lgkmcnt(4)
    v_mfma_f32_16x16x32_bf16 v[80:83], v[40:43], a[232:235], v[80:83]
    ds_read_b128 v[32:35], v12 offset:0
    v_mfma_f32_16x16x32_bf16 v[84:87], v[40:43], a[236:239], v[84:87]
    v_mfma_f32_16x16x32_bf16 v[88:91], v[44:47], a[232:235], v[88:91]
    ds_read_b128 v[36:39], v12 offset:1024
    v_mfma_f32_16x16x32_bf16 v[92:95], v[44:47], a[236:239], v[92:95]
    s_waitcnt lgkmcnt(4)
    v_mfma_f32_16x16x32_bf16 v[80:83], v[48:51], a[240:243], v[80:83]
    ds_read_b128 v[40:43], v13 offset:0
    v_mfma_f32_16x16x32_bf16 v[84:87], v[48:51], a[244:247], v[84:87]
    v_mfma_f32_16x16x32_bf16 v[88:91], v[52:55], a[240:243], v[88:91]
    ds_read_b128 v[44:47], v13 offset:1024
    s_add_u32 m0, s34, 77440
    v_mfma_f32_16x16x32_bf16 v[92:95], v[52:55], a[244:247], v[92:95]
    buffer_load_dwordx4 v8, s[12:15], s35 offen offset:384 lds
    s_waitcnt lgkmcnt(4)
    v_mfma_f32_16x16x32_bf16 v[80:83], v[56:59], a[248:251], v[80:83]
    ds_read_b128 v[48:51], v12 offset:4096
    v_mfma_f32_16x16x32_bf16 v[84:87], v[56:59], a[252:255], v[84:87]
    v_mfma_f32_16x16x32_bf16 v[88:91], v[60:63], a[248:251], v[88:91]
    ds_read_b128 v[52:55], v12 offset:5120
    v_mfma_f32_16x16x32_bf16 v[92:95], v[60:63], a[252:255], v[92:95]
    s_add_u32 s30, s30, 2
    s_cmp_lt_u32 s30, s51
    s_cbranch_scc1 sl_loop_67
    v_cvt_pk_bf16_f32 v96, v80, v81
    v_cvt_pk_bf16_f32 v97, v82, v83
    s_nop 0
    v_cvt_pk_bf16_f32 v98, v88, v89
    v_cvt_pk_bf16_f32 v99, v90, v91
    v_cvt_pk_bf16_f32 v100, v84, v85
    v_cvt_pk_bf16_f32 v101, v86, v87
    v_cvt_pk_bf16_f32 v102, v92, v93
    v_cvt_pk_bf16_f32 v103, v94, v95
    s_branch sl_e_65
sl_e_65:
    buffer_store_dwordx4 v[96:99], v9, s[4:7], s36 offen sc1
    buffer_store_dwordx4 v[100:103], v9, s[4:7], s36 offen offset:128 sc1
    s_add_u32 s36, s36, s37
    s_waitcnt vmcnt(0) lgkmcnt(0)
    s_barrier
    buffer_store_dword v11, v10, s[4:7], 0 offen sc1
    s_branch L_ph2
L_ph2:
    s_cmp_ge_u32 s28, 96
    s_cbranch_scc1 L_ob
L_att:
    s_mov_b32 s42, 0x3e0293ee
    s_mov_b32 s58, 0x3e8293ee
    s_and_b32 s44, s28, 7
    s_lshl_b32 s44, s44, 2
    s_add_u32 s44, s44, s29
    s_lshl_b32 s31, s44, 11
    v_add_u32 v6, s31, v5
    v_lshrrev_b32 v9, 5, v1
    v_lshlrev_b32 v9, 7, v9
    v_and_b32 v4, 7, v1
    v_lshl_add_u32 v9, v4, 4, v9
    v_add_u32 v9, s31, v9
    s_add_u32 s31, s31, 4194304
    v_and_b32 v10, 31, v1
    v_lshlrev_b32 v10, 4, v10
    v_lshrrev_b32 v4, 5, v1
    v_lshl_add_u32 v10, v4, 3, v10
    v_add_u32 v10, s31, v10
    s_lshl_b32 s31, s44, 13
    v_add_u32 v8, s31, v5
    v_mov_b32 v7, v8
    s_lshl_b32 s55, s44, 7
    s_add_u32 s55, s55, 115343360
    s_lshr_b32 s56, s44, 2
    s_lshl_b32 s56, s56, 7
    s_add_u32 s56, s56, 115347456
    s_lshl_b32 s57, s44, 7
    s_add_u32 s57, s57, 115351552
    s_lshl_b32 s31, s44, 7
    s_add_u32 s31, s31, 115343360
    v_mov_b32 v12, s31
    v_lshl_add_u32 v13, v1, 12, s31
    s_mov_b64 vcc, 1
    v_mov_b32 v4, 2130706432
    v_cndmask_b32 v12, v4, v12, vcc
    s_cmp_lt_u32 s28, 120
    s_cbranch_scc1 at_help_68
    s_mov_b32 s53, 0
    s_mov_b32 s54, 0
    s_mov_b32 s37, 1
    s_mov_b32 s38, 6
    s_mov_b32 s39, 32
    v_mov_b32 v2, 0
    s_mov_b32 s31, 16384
    buffer_store_dword v2, v12, s[4:7], s31 offen sc1
    s_mov_b32 s31, 32768
    buffer_store_dword v2, v13, s[4:7], s31 offen sc1
    s_waitcnt vmcnt(0)
    s_barrier
    s_cmp_lg_u32 s29, 0
    s_cbranch_scc1 at_i_70
    s_mov_b64 exec, 1
    v_mov_b32 v2, 0
    s_add_u32 s71, s71, 1
    v_mov_b32 v3, s71
    s_waitcnt vmcnt(0)
    global_atomic_add v2, v3, s[92:93] offset:0 sc1
    s_mov_b64 exec, -1
at_i_70:
    s_cmp_lt_u32 s28, 96
    s_cbranch_scc1 tw_skip_71
    s_load_dwordx2 s[72:73], s[0:1], 40
    s_and_b32 s31, s28, 31
    s_lshl_b32 s31, s31, 13
    s_lshl_b32 s33, s29, 21
    s_add_u32 s31, s31, s33
    v_lshl_add_u32 v2, v1, 7, s31
    s_waitcnt lgkmcnt(0)
    s_mov_b32 s8, s72
    s_and_b32 s9, s73, 0xffff
    s_mov_b32 s10, 8388608
    s_mov_b32 s11, 0x00020000
    s_mov_b32 s31, 0
    buffer_load_dword v128, v2, s[8:11], s31 offen
    s_mov_b32 s31, 262144
    buffer_load_dword v129, v2, s[8:11], s31 offen
    s_mov_b32 s31, 524288
    buffer_load_dword v130, v2, s[8:11], s31 offen
    s_mov_b32 s31, 786432
    buffer_load_dword v131, v2, s[8:11], s31 offen
    s_mov_b32 s31, 1048576
    buffer_load_dword v132, v2, s[8:11], s31 offen
    s_mov_b32 s31, 1310720
    buffer_load_dword v133, v2, s[8:11], s31 offen
    s_mov_b32 s31, 1572864
    buffer_load_dword v134, v2, s[8:11], s31 offen
    s_mov_b32 s31, 1835008
    buffer_load_dword v135, v2, s[8:11], s31 offen
tw_skip_71:
    s_load_dwordx2 s[72:73], s[0:1], 0
    s_load_dwordx2 s[74:75], s[0:1], 56
    s_load_dwordx2 s[76:77], s[0:1], 72
    s_waitcnt lgkmcnt(0)
    s_mov_b32 s8, s72
    s_and_b32 s9, s73, 0xffff
    s_mov_b32 s10, 4194304
    s_mov_b32 s11, 0x00020000
    s_mov_b32 s12, s74
    s_and_b32 s13, s75, 0xffff
    s_mov_b32 s14, 4194304
    s_mov_b32 s15, 0x00020000
    s_mov_b32 s16, s76
    s_and_b32 s17, s77, 0xffff
    s_mov_b32 s18, 2097152
    s_mov_b32 s19, 0x00020000
    s_lshl_b32 s31, s44, 13
    v_lshl_add_u32 v11, v1, 7, s31
    buffer_load_dword v144, v11, s[8:11], 0 offen
    s_cmp_lg_u32 s29, 0
    s_cbranch_scc1 g_wdd_73
g_wd_72:
    s_load_dword s84, s[92:93], 128 glc
    s_add_u32 s41, s41, 1
    s_cmp_ge_u32 s41, 0x200000
    s_cbranch_scc1 g_wdd_73
    s_waitcnt lgkmcnt(0)
    s_and_b32 s84, s84, 1023
    s_cmp_ge_u32 s84, 96
    s_cbranch_scc1 g_wdd_73
    s_sleep 32
    s_branch g_wd_72
g_wdd_73:
    s_waitcnt lgkmcnt(0)
    s_barrier
    s_mov_b32 s31, 0
    buffer_load_dword v144, v11, s[8:11], s31 offen
    buffer_load_dword v145, v11, s[12:15], s31 offen
    s_mov_b32 s31, 262144
    buffer_load_dword v146, v11, s[8:11], s31 offen
    buffer_load_dword v147, v11, s[12:15], s31 offen
    s_mov_b32 s31, 524288
    buffer_load_dword v148, v11, s[8:11], s31 offen
    buffer_load_dword v149, v11, s[12:15], s31 offen
    s_mov_b32 s31, 786432
    buffer_load_dword v150, v11, s[8:11], s31 offen
    buffer_load_dword v151, v11, s[12:15], s31 offen
    s_mov_b32 s31, 1048576
    buffer_load_dword v152, v11, s[8:11], s31 offen
    buffer_load_dword v153, v11, s[12:15], s31 offen
    s_mov_b32 s31, 1310720
    buffer_load_dword v154, v11, s[8:11], s31 offen
    buffer_load_dword v155, v11, s[12:15], s31 offen
    s_mov_b32 s31, 1572864
    buffer_load_dword v156, v11, s[8:11], s31 offen
    buffer_load_dword v157, v11, s[12:15], s31 offen
    s_mov_b32 s31, 1835008
    buffer_load_dword v158, v11, s[8:11], s31 offen
    buffer_load_dword v159, v11, s[12:15], s31 offen
    s_mov_b32 s31, 2097152
    buffer_load_dword v160, v11, s[8:11], s31 offen
    buffer_load_dword v161, v11, s[12:15], s31 offen
    s_mov_b32 s31, 2359296
    buffer_load_dword v162, v11, s[8:11], s31 offen
    buffer_load_dword v163, v11, s[12:15], s31 offen
    s_mov_b32 s31, 2621440
    buffer_load_dword v164, v11, s[8:11], s31 offen
    buffer_load_dword v165, v11, s[12:15], s31 offen
    s_mov_b32 s31, 2883584
    buffer_load_dword v166, v11, s[8:11], s31 offen
    buffer_load_dword v167, v11, s[12:15], s31 offen
    s_mov_b32 s31, 3145728
    buffer_load_dword v168, v11, s[8:11], s31 offen
    buffer_load_dword v169, v11, s[12:15], s31 offen
    s_mov_b32 s31, 3407872
    buffer_load_dword v170, v11, s[8:11], s31 offen
    buffer_load_dword v171, v11, s[12:15], s31 offen
    s_mov_b32 s31, 3670016
    buffer_load_dword v172, v11, s[8:11], s31 offen
    buffer_load_dword v173, v11, s[12:15], s31 offen
    s_mov_b32 s31, 3932160
    buffer_load_dword v174, v11, s[8:11], s31 offen
    buffer_load_dword v175, v11, s[12:15], s31 offen
    s_mov_b32 s31, 0
    buffer_load_dword v176, v11, s[16:19], s31 offen
    s_mov_b32 s31, 262144
    buffer_load_dword v177, v11, s[16:19], s31 offen
    s_mov_b32 s31, 524288
    buffer_load_dword v178, v11, s[16:19], s31 offen
    s_mov_b32 s31, 786432
    buffer_load_dword v179, v11, s[16:19], s31 offen
    s_mov_b32 s31, 1048576
    buffer_load_dword v180, v11, s[16:19], s31 offen
    s_mov_b32 s31, 1310720
    buffer_load_dword v181, v11, s[16:19], s31 offen
    s_mov_b32 s31, 1572864
    buffer_load_dword v182, v11, s[16:19], s31 offen
    s_mov_b32 s31, 1835008
    buffer_load_dword v183, v11, s[16:19], s31 offen
    s_branch at_com_69
at_help_68:
    s_lshr_b32 s53, s28, 3
    s_add_u32 s53, s53, 6
    s_mov_b32 s54, 64
    s_mov_b32 s37, 12
    s_mov_b32 s38, 30
    s_lshr_b32 s39, s28, 3
    s_and_b32 s39, s39, 1
    s_add_u32 s39, s39, 30
    s_cmp_lt_u32 s28, 80
    s_cselect_b32 s39, 64, s39
at_com_69:
    v_and_b32 v11, 31, v1
    v_lshrrev_b32 v3, 5, v1
    v_lshlrev_b32 v3, 2, v3
    v_sub_u32 v11, v11, v3
    v_mov_b32 v14, 0xf149f2ca
    v_add_u32 v3, 0, v11
    v_and_b32 v3, 0xfffffff1, v3
    v_cmp_ne_u32 vcc, 0, v3
    s_nop 1
    v_cndmask_b32 v64, 0, v14, vcc
    v_add_u32 v3, -1, v11
    v_and_b32 v3, 0xfffffff1, v3
    v_cmp_ne_u32 vcc, 0, v3
    s_nop 1
    v_cndmask_b32 v65, 0, v14, vcc
    v_add_u32 v3, -2, v11
    v_and_b32 v3, 0xfffffff1, v3
    v_cmp_ne_u32 vcc, 0, v3
    s_nop 1
    v_cndmask_b32 v66, 0, v14, vcc
    v_add_u32 v3, -3, v11
    v_and_b32 v3, 0xfffffff1, v3
    v_cmp_ne_u32 vcc, 0, v3
    s_nop 1
    v_cndmask_b32 v67, 0, v14, vcc
    v_add_u32 v3, -8, v11
    v_and_b32 v3, 0xfffffff1, v3
    v_cmp_ne_u32 vcc, 0, v3
    s_nop 1
    v_cndmask_b32 v68, 0, v14, vcc
    v_add_u32 v3, -9, v11
    v_and_b32 v3, 0xfffffff1, v3
    v_cmp_ne_u32 vcc, 0, v3
    s_nop 1
    v_cndmask_b32 v69, 0, v14, vcc
    v_add_u32 v3, -10, v11
    v_and_b32 v3, 0xfffffff1, v3
    v_cmp_ne_u32 vcc, 0, v3
    s_nop 1
    v_cndmask_b32 v70, 0, v14, vcc
    v_add_u32 v3, -11, v11
    v_and_b32 v3, 0xfffffff1, v3
    v_cmp_ne_u32 vcc, 0, v3
    s_nop 1
    v_cndmask_b32 v71, 0, v14, vcc
    v_add_u32 v3, -16, v11
    v_and_b32 v3, 0xfffffff1, v3
    v_cmp_ne_u32 vcc, 0, v3
    s_nop 1
    v_cndmask_b32 v72, 0, v14, vcc
    v_add_u32 v3, -17, v11
    v_and_b32 v3, 0xfffffff1, v3
    v_cmp_ne_u32 vcc, 0, v3
    s_nop 1
    v_cndmask_b32 v73, 0, v14, vcc
    v_add_u32 v3, -18, v11
    v_and_b32 v3, 0xfffffff1, v3
    v_cmp_ne_u32 vcc, 0, v3
    s_nop 1
    v_cndmask_b32 v74, 0, v14, vcc
    v_add_u32 v3, -19, v11
    v_and_b32 v3, 0xfffffff1, v3
    v_cmp_ne_u32 vcc, 0, v3
    s_nop 1
    v_cndmask_b32 v75, 0, v14, vcc
    v_add_u32 v3, -24, v11
    v_and_b32 v3, 0xfffffff1, v3
    v_cmp_ne_u32 vcc, 0, v3
    s_nop 1
    v_cndmask_b32 v76, 0, v14, vcc
    v_add_u32 v3, -25, v11
    v_and_b32 v3, 0xfffffff1, v3
    v_cmp_ne_u32 vcc, 0, v3
    s_nop 1
    v_cndmask_b32 v77, 0, v14, vcc
    v_add_u32 v3, -26, v11
    v_and_b32 v3, 0xfffffff1, v3
    v_cmp_ne_u32 vcc, 0, v3
    s_nop 1
    v_cndmask_b32 v78, 0, v14, vcc
    v_add_u32 v3, -27, v11
    v_and_b32 v3, 0xfffffff1, v3
    v_cmp_ne_u32 vcc, 0, v3
    s_nop 1
    v_cndmask_b32 v79, 0, v14, vcc
    v_cmp_gt_i32 vcc, 0, v11
    s_nop 1
    v_cndmask_b32 v96, 0, v14, vcc
    v_cmp_gt_i32 vcc, 1, v11
    s_nop 1
    v_cndmask_b32 v97, 0, v14, vcc
    v_cmp_gt_i32 vcc, 2, v11
    s_nop 1
    v_cndmask_b32 v98, 0, v14, vcc
    v_cmp_gt_i32 vcc, 3, v11
    s_nop 1
    v_cndmask_b32 v99, 0, v14, vcc
    v_cmp_gt_i32 vcc, 8, v11
    s_nop 1
    v_cndmask_b32 v100, 0, v14, vcc
    v_cmp_gt_i32 vcc, 9, v11
    s_nop 1
    v_cndmask_b32 v101, 0, v14, vcc
    v_cmp_gt_i32 vcc, 10, v11
    s_nop 1
    v_cndmask_b32 v102, 0, v14, vcc
    v_cmp_gt_i32 vcc, 11, v11
    s_nop 1
    v_cndmask_b32 v103, 0, v14, vcc
    v_cmp_gt_i32 vcc, 16, v11
    s_nop 1
    v_cndmask_b32 v104, 0, v14, vcc
    v_cmp_gt_i32 vcc, 17, v11
    s_nop 1
    v_cndmask_b32 v105, 0, v14, vcc
    v_cmp_gt_i32 vcc, 18, v11
    s_nop 1
    v_cndmask_b32 v106, 0, v14, vcc
    v_cmp_gt_i32 vcc, 19, v11
    s_nop 1
    v_cndmask_b32 v107, 0, v14, vcc
    v_cmp_gt_i32 vcc, 24, v11
    s_nop 1
    v_cndmask_b32 v108, 0, v14, vcc
    v_cmp_gt_i32 vcc, 25, v11
    s_nop 1
    v_cndmask_b32 v109, 0, v14, vcc
    v_cmp_gt_i32 vcc, 26, v11
    s_nop 1
    v_cndmask_b32 v110, 0, v14, vcc
    v_cmp_gt_i32 vcc, 27, v11
    s_nop 1
    v_cndmask_b32 v111, 0, v14, vcc
    v_mov_b32 v80, 0xf149f2ca
    v_mov_b32 v81, 0xf149f2ca
    v_mov_b32 v82, 0xf149f2ca
    v_mov_b32 v83, 0xf149f2ca
    v_mov_b32 v84, 0xf149f2ca
    v_mov_b32 v85, 0xf149f2ca
    v_mov_b32 v86, 0xf149f2ca
    v_mov_b32 v87, 0xf149f2ca
    v_mov_b32 v88, 0xf149f2ca
    v_mov_b32 v89, 0xf149f2ca
    v_mov_b32 v90, 0xf149f2ca
    v_mov_b32 v91, 0xf149f2ca
    v_mov_b32 v92, 0xf149f2ca
    v_mov_b32 v93, 0xf149f2ca
    v_mov_b32 v94, 0xf149f2ca
    v_mov_b32 v95, 0xf149f2ca
    v_accvgpr_write_b32 a184, 0
    v_accvgpr_write_b32 a185, 0
    v_accvgpr_write_b32 a186, 0
    v_accvgpr_write_b32 a187, 0
    v_accvgpr_write_b32 a188, 0
    v_accvgpr_write_b32 a189, 0
    v_accvgpr_write_b32 a190, 0
    v_accvgpr_write_b32 a191, 0
    v_accvgpr_write_b32 a192, 0
    v_accvgpr_write_b32 a193, 0
    v_accvgpr_write_b32 a194, 0
    v_accvgpr_write_b32 a195, 0
    v_accvgpr_write_b32 a128, 0
    v_accvgpr_write_b32 a129, 0
    v_accvgpr_write_b32 a130, 0
    v_accvgpr_write_b32 a131, 0
    v_accvgpr_write_b32 a132, 0
    v_accvgpr_write_b32 a133, 0
    v_accvgpr_write_b32 a134, 0
    v_accvgpr_write_b32 a135, 0
    v_accvgpr_write_b32 a136, 0
    v_accvgpr_write_b32 a137, 0
    v_accvgpr_write_b32 a138, 0
    v_accvgpr_write_b32 a139, 0
    v_accvgpr_write_b32 a140, 0
    v_accvgpr_write_b32 a141, 0
    v_accvgpr_write_b32 a142, 0
    v_accvgpr_write_b32 a143, 0
    v_mov_b32 v40, 0
    v_mov_b32 v41, 0
    v_mov_b32 v42, 0
    v_mov_b32 v43, 0
    s_cmp_lg_u32 s29, 0
    s_cbranch_scc1 g_wdd_75
g_wd_74:
    s_load_dword s72, s[92:93], 0 glc
    s_add_u32 s41, s41, 1
    s_cmp_ge_u32 s41, 0x200000
    s_cbranch_scc1 g_wdd_75
    s_waitcnt lgkmcnt(0)
    s_and_b32 s72, s72, 1023
    s_cmp_ge_u32 s72, 256
    s_cbranch_scc1 g_wdd_75
    s_sleep 32
    s_branch g_wd_74
g_wdd_75:
    s_waitcnt lgkmcnt(0)
    s_barrier
    s_add_u32 s49, s53, s37
    s_cmp_lt_u32 s49, s38
    s_cbranch_scc1 at_nx_83
    s_max_u32 s49, s49, s39
    s_cmp_eq_u32 s38, 255
    s_cselect_b32 s49, s49, s39
    s_mov_b32 s37, 3
    s_mov_b32 s38, 255
at_nx_83:
g_wf_84:
    s_load_dwordx4 s[72:75], s[90:91], s56 glc
    s_add_u32 s41, s41, 1
    s_cmp_ge_u32 s41, 0x200000
    s_cbranch_scc1 g_wfd_85
    s_waitcnt lgkmcnt(0)
    s_min_u32 s76, s72, s73
    s_min_u32 s76, s76, s74
    s_cmp_ge_u32 s76, 1
    s_cbranch_scc1 g_wfd_85
    s_sleep 4
    s_branch g_wf_84
g_wfd_85:
    s_waitcnt lgkmcnt(0)
    s_mov_b32 s35, 0
    s_add_u32 s31, s35, 50331648
    buffer_load_dwordx4 a[160:163], v6, s[4:7], s31 offen offset:0 sc1
    buffer_load_dwordx4 a[164:167], v6, s[4:7], s31 offen offset:1024 sc1
    s_add_u32 s31, s35, 54525952
    buffer_load_dwordx4 a[168:171], v6, s[4:7], s31 offen offset:0 sc1
    buffer_load_dwordx4 a[172:175], v6, s[4:7], s31 offen offset:1024 sc1
    s_add_u32 s31, s35, 58720256
    buffer_load_dwordx4 a[176:179], v6, s[4:7], s31 offen offset:0 sc1
    buffer_load_dwordx4 a[180:183], v6, s[4:7], s31 offen offset:1024 sc1
    s_add_u32 s32, s53, 1
g_wf_86:
    s_load_dwordx4 s[72:75], s[90:91], s55 glc
    s_add_u32 s41, s41, 1
    s_cmp_ge_u32 s41, 0x200000
    s_cbranch_scc1 g_wfd_87
    s_waitcnt lgkmcnt(0)
    s_min_u32 s76, s72, s73
    s_min_u32 s76, s76, s74
    s_cmp_ge_u32 s76, s32
    s_cbranch_scc1 g_wfd_87
    s_sleep 4
    s_branch g_wf_86
g_wfd_87:
    s_waitcnt lgkmcnt(0)
    s_lshl_b32 s36, s53, 18
    s_add_u32 s31, s36, 0
    buffer_load_dwordx4 a[0:3], v7, s[4:7], s31 offen offset:0 sc1
    buffer_load_dwordx4 a[4:7], v7, s[4:7], s31 offen offset:1024 sc1
    buffer_load_dwordx4 a[8:11], v7, s[4:7], s31 offen offset:2048 sc1
    buffer_load_dwordx4 a[12:15], v7, s[4:7], s31 offen offset:3072 sc1
    s_add_u32 s31, s36, 4096
    buffer_load_dwordx4 a[16:19], v7, s[4:7], s31 offen offset:0 sc1
    buffer_load_dwordx4 a[20:23], v7, s[4:7], s31 offen offset:1024 sc1
    buffer_load_dwordx4 a[24:27], v7, s[4:7], s31 offen offset:2048 sc1
    buffer_load_dwordx4 a[28:31], v7, s[4:7], s31 offen offset:3072 sc1
    s_add_u32 s31, s36, 16777216
    buffer_load_dwordx4 a[32:35], v7, s[4:7], s31 offen offset:0 sc1
    buffer_load_dwordx4 a[36:39], v7, s[4:7], s31 offen offset:1024 sc1
    buffer_load_dwordx4 a[40:43], v7, s[4:7], s31 offen offset:2048 sc1
    buffer_load_dwordx4 a[44:47], v7, s[4:7], s31 offen offset:3072 sc1
    s_add_u32 s31, s36, 16781312
    buffer_load_dwordx4 a[48:51], v7, s[4:7], s31 offen offset:0 sc1
    buffer_load_dwordx4 a[52:55], v7, s[4:7], s31 offen offset:1024 sc1
    buffer_load_dwordx4 a[56:59], v7, s[4:7], s31 offen offset:2048 sc1
    buffer_load_dwordx4 a[60:63], v7, s[4:7], s31 offen offset:3072 sc1
    s_add_u32 s31, s36, 33554432
    buffer_load_dwordx4 a[96:99], v7, s[4:7], s31 offen offset:0 sc1
    buffer_load_dwordx4 a[100:103], v7, s[4:7], s31 offen offset:1024 sc1
    buffer_load_dwordx4 a[104:107], v7, s[4:7], s31 offen offset:2048 sc1
    buffer_load_dwordx4 a[108:111], v7, s[4:7], s31 offen offset:3072 sc1
    s_add_u32 s31, s36, 33558528
    buffer_load_dwordx4 a[112:115], v7, s[4:7], s31 offen offset:0 sc1
    buffer_load_dwordx4 a[116:119], v7, s[4:7], s31 offen offset:1024 sc1
    buffer_load_dwordx4 a[120:123], v7, s[4:7], s31 offen offset:2048 sc1
    buffer_load_dwordx4 a[124:127], v7, s[4:7], s31 offen offset:3072 sc1
    s_mov_b32 s43, 20480
    s_mov_b32 s45, 0
    s_mov_b32 s51, 0
    s_waitcnt vmcnt(0)
at_poll_81:
    s_load_dwordx16 s[8:23], s[90:91], s57 glc
    s_load_dwordx4 s[76:79], s[90:91], s55 glc
    s_load_dwordx4 s[80:83], s[90:91], s56 glc
at_top_76:
    s_waitcnt lgkmcnt(0)
    s_min_u32 s72, s8, s12
    s_min_u32 s72, s72, s16
    s_min_u32 s72, s72, s20
    s_min_u32 s76, s76, s77
    s_min_u32 s76, s76, s78
    s_min_u32 s80, s80, s81
    s_min_u32 s80, s80, s82
    s_min_u32 s77, s49, 63
    s_cmp_gt_u32 s76, s77
    s_cselect_b32 s72, s72, 0
    s_min_u32 s72, s72, 64
    s_sub_u32 s81, s80, 1
    s_cmp_ge_u32 s80, 64
    s_cselect_b32 s80, 64, s81
    s_cmp_lt_u32 s54, s80
    s_cbranch_scc1 at_b_78
    s_cmp_lt_u32 s53, s72
    s_cbranch_scc1 at_a_77
    s_cmp_eq_u32 s43, 20480
    s_cbranch_scc1 at_nf_82
    s_waitcnt vmcnt(0)
    v_mov_b32 v2, s45
    buffer_store_dword v2, v12, s[4:7], s43 offen sc1
    s_mov_b32 s43, 20480
at_nf_82:
    s_cmp_ge_u32 s53, 64
    s_cselect_b32 s31, s54, 0
    s_cmp_ge_u32 s31, 64
    s_cbranch_scc1 at_end_79
    s_add_u32 s41, s41, 1
    s_cmp_ge_u32 s41, 0x200000
    s_cbranch_scc1 at_end_79
    s_sleep 1
    s_branch at_poll_81
at_a_77:
    s_lshl_b32 s46, s53, 16
    s_add_u32 s46, s46, 88080384
    s_cmp_lg_u32 s51, 0
    s_cbranch_scc1 at_k1_88
    s_mov_b32 exec_lo, 0xff
    s_mov_b32 exec_hi, 0xff
    buffer_load_dwordx4 a[64:67], v9, s[4:7], s46 offen offset:0 sc1
    buffer_load_dwordx4 a[68:71], v9, s[4:7], s46 offen offset:256 sc1
    buffer_load_dwordx4 a[72:75], v9, s[4:7], s46 offen offset:512 sc1
    buffer_load_dwordx4 a[76:79], v9, s[4:7], s46 offen offset:768 sc1
    buffer_load_dwordx4 a[80:83], v9, s[4:7], s46 offen offset:1024 sc1
    buffer_load_dwordx4 a[84:87], v9, s[4:7], s46 offen offset:1280 sc1
    buffer_load_dwordx4 a[88:91], v9, s[4:7], s46 offen offset:1536 sc1
    buffer_load_dwordx4 a[92:95], v9, s[4:7], s46 offen offset:1792 sc1
    s_mov_b64 exec, -1
    buffer_load_dwordx2 a[128:129], v10, s[4:7], s46 offen offset:0 sc1
    buffer_load_dwordx2 a[132:133], v10, s[4:7], s46 offen offset:512 sc1
    buffer_load_dwordx2 a[136:137], v10, s[4:7], s46 offen offset:1024 sc1
    buffer_load_dwordx2 a[140:141], v10, s[4:7], s46 offen offset:1536 sc1
at_k1_88:
    s_lshl_b32 s47, s53, 18
    s_add_u32 s47, s47, 67108864
    s_cmp_lt_u32 s49, s72
    s_cselect_b32 s52, 1, 0
    s_cmp_lt_u32 s49, 64
    s_cselect_b32 s32, s49, s53
    s_cselect_b32 s31, 0, 2130706432
    v_or_b32 v7, s31, v8
    s_lshl_b32 s36, s32, 18
    s_lshl_b32 s46, s32, 16
    s_add_u32 s46, s46, 88080384
    s_load_dwordx16 s[8:23], s[90:91], s57 glc
    s_load_dwordx4 s[76:79], s[90:91], s55 glc
    s_load_dwordx4 s[80:83], s[90:91], s56 glc
    v_mfma_f32_32x32x16_bf16 v[112:127], a[32:35], a[0:3], v[96:111]
    v_mfma_f32_32x32x16_bf16 v[112:127], a[36:39], a[4:7], v[112:127]
    v_mfma_f32_32x32x16_bf16 v[112:127], a[40:43], a[8:11], v[112:127]
    v_mfma_f32_32x32x16_bf16 v[112:127], a[44:47], a[12:15], v[112:127]
    v_mfma_f32_32x32x16_bf16 v[112:127], a[48:51], a[16:19], v[112:127]
    v_mfma_f32_32x32x16_bf16 v[112:127], a[52:55], a[20:23], v[112:127]
    v_mfma_f32_32x32x16_bf16 v[112:127], a[56:59], a[24:27], v[112:127]
    v_mfma_f32_32x32x16_bf16 v[112:127], a[60:63], a[28:31], v[112:127]
    s_cmp_lg_u32 s51, 0
    s_cbranch_scc1 at_k2_89
    s_waitcnt vmcnt(4)
at_k2_89:
    s_add_u32 s31, s36, 16777216
    buffer_load_dwordx4 a[32:35], v7, s[4:7], s31 offen offset:0 sc1
    buffer_load_dwordx4 a[36:39], v7, s[4:7], s31 offen offset:1024 sc1
    buffer_load_dwordx4 a[40:43], v7, s[4:7], s31 offen offset:2048 sc1
    buffer_load_dwordx4 a[44:47], v7, s[4:7], s31 offen offset:3072 sc1
    s_add_u32 s31, s36, 16781312
    buffer_load_dwordx4 a[48:51], v7, s[4:7], s31 offen offset:0 sc1
    buffer_load_dwordx4 a[52:55], v7, s[4:7], s31 offen offset:1024 sc1
    buffer_load_dwordx4 a[56:59], v7, s[4:7], s31 offen offset:2048 sc1
    buffer_load_dwordx4 a[60:63], v7, s[4:7], s31 offen offset:3072 sc1
    v_mfma_f32_32x32x16_bf16 v[128:143], a[64:67], a[0:3], 0
    v_mfma_f32_32x32x16_bf16 v[128:143], a[68:71], a[4:7], v[128:143]
    v_mfma_f32_32x32x16_bf16 v[128:143], a[72:75], a[8:11], v[128:143]
    v_mfma_f32_32x32x16_bf16 v[128:143], a[76:79], a[12:15], v[128:143]
    v_mfma_f32_32x32x16_bf16 v[128:143], a[80:83], a[16:19], v[128:143]
    v_mfma_f32_32x32x16_bf16 v[128:143], a[84:87], a[20:23], v[128:143]
    v_mfma_f32_32x32x16_bf16 v[128:143], a[88:91], a[24:27], v[128:143]
    v_mfma_f32_32x32x16_bf16 v[128:143], a[92:95], a[28:31], v[128:143]
    s_mov_b32 s51, s52
    s_add_u32 s31, s36, 0
    buffer_load_dwordx4 a[0:3], v7, s[4:7], s31 offen offset:0 sc1
    buffer_load_dwordx4 a[4:7], v7, s[4:7], s31 offen offset:1024 sc1
    buffer_load_dwordx4 a[8:11], v7, s[4:7], s31 offen offset:2048 sc1
    buffer_load_dwordx4 a[12:15], v7, s[4:7], s31 offen offset:3072 sc1
    s_add_u32 s31, s36, 4096
    buffer_load_dwordx4 a[16:19], v7, s[4:7], s31 offen offset:0 sc1
    buffer_load_dwordx4 a[20:23], v7, s[4:7], s31 offen offset:1024 sc1
    buffer_load_dwordx4 a[24:27], v7, s[4:7], s31 offen offset:2048 sc1
    buffer_load_dwordx4 a[28:31], v7, s[4:7], s31 offen offset:3072 sc1
    s_cmp_eq_u32 s51, 0
    s_cbranch_scc1 at_k3_90
    s_mov_b32 exec_lo, 0xff
    s_mov_b32 exec_hi, 0xff
    buffer_load_dwordx4 a[64:67], v9, s[4:7], s46 offen offset:0 sc1
    buffer_load_dwordx4 a[68:71], v9, s[4:7], s46 offen offset:256 sc1
    buffer_load_dwordx4 a[72:75], v9, s[4:7], s46 offen offset:512 sc1
    buffer_load_dwordx4 a[76:79], v9, s[4:7], s46 offen offset:768 sc1
    buffer_load_dwordx4 a[80:83], v9, s[4:7], s46 offen offset:1024 sc1
    buffer_load_dwordx4 a[84:87], v9, s[4:7], s46 offen offset:1280 sc1
    buffer_load_dwordx4 a[88:91], v9, s[4:7], s46 offen offset:1536 sc1
    buffer_load_dwordx4 a[92:95], v9, s[4:7], s46 offen offset:1792 sc1
    s_mov_b64 exec, -1
at_k3_90:
    v_max3_f32 v14, v112, v113, v114
    v_max3_f32 v14, v14, v115, v116
    v_max3_f32 v14, v14, v117, v118
    v_max3_f32 v14, v14, v119, v120
    v_max3_f32 v14, v14, v121, v122
    v_max3_f32 v14, v14, v123, v124
    v_max3_f32 v14, v14, v125, v126
    v_max3_f32 v14, v14, v127, v128
    v_max3_f32 v14, v14, v129, v130
    v_max_f32 v14, v14, v131
    v_mov_b32 v15, v14
    s_nop 1
    v_permlane32_swap_b32 v14, v15
    v_max_f32 v14, v14, v15
    v_mul_f32 v14, s42, v14
    v_fma_f32 v112, v112, s42, -v14
    v_fma_f32 v113, v113, s42, -v14
    v_fma_f32 v114, v114, s42, -v14
    v_fma_f32 v115, v115, s42, -v14
    v_fma_f32 v116, v116, s42, -v14
    v_fma_f32 v117, v117, s42, -v14
    v_fma_f32 v118, v118, s42, -v14
    v_fma_f32 v119, v119, s42, -v14
    v_fma_f32 v120, v120, s42, -v14
    v_fma_f32 v121, v121, s42, -v14
    v_fma_f32 v122, v122, s42, -v14
    v_fma_f32 v123, v123, s42, -v14
    v_fma_f32 v124, v124, s42, -v14
    v_fma_f32 v125, v125, s42, -v14
    v_fma_f32 v126, v126, s42, -v14
    v_fma_f32 v127, v127, s42, -v14
    v_fma_f32 v128, v128, s42, -v14
    v_fma_f32 v129, v129, s42, -v14
    v_fma_f32 v130, v130, s42, -v14
    v_fma_f32 v131, v131, s42, -v14
    v_exp_f32 v112, v112
    v_exp_f32 v113, v113
    v_exp_f32 v114, v114
    v_exp_f32 v115, v115
    v_exp_f32 v116, v116
    v_exp_f32 v117, v117
    v_exp_f32 v118, v118
    v_exp_f32 v119, v119
    v_exp_f32 v120, v120
    v_exp_f32 v121, v121
    v_exp_f32 v122, v122
    v_exp_f32 v123, v123
    v_exp_f32 v124, v124
    v_exp_f32 v125, v125
    v_exp_f32 v126, v126
    v_exp_f32 v127, v127
    v_exp_f32 v128, v128
    v_exp_f32 v129, v129
    v_exp_f32 v130, v130
    v_exp_f32 v131, v131
    v_add_f32 v26, v112, v113
    v_add_f32 v15, v114, v115
    v_add_f32 v26, v26, v116
    v_add_f32 v15, v15, v117
    v_add_f32 v26, v26, v118
    v_add_f32 v15, v15, v119
    v_add_f32 v26, v26, v120
    v_add_f32 v15, v15, v121
    v_add_f32 v26, v26, v122
    v_add_f32 v15, v15, v123
    v_add_f32 v26, v26, v124
    v_add_f32 v15, v15, v125
    v_add_f32 v26, v26, v126
    v_add_f32 v15, v15, v127
    v_add_f32 v26, v26, v128
    v_add_f32 v15, v15, v129
    v_add_f32 v26, v26, v130
    v_add_f32 v15, v15, v131
    v_add_f32 v26, v26, v15
    v_mov_b32 v15, v26
    s_nop 1
    v_permlane32_swap_b32 v26, v15
    v_add_f32 v26, v26, v15
    v_rcp_f32 v26, v26
    v_cvt_pk_bf16_f32 v28, v112, v113
    v_cvt_pk_bf16_f32 v29, v114, v115
    v_cvt_pk_bf16_f32 v30, v116, v117
    v_cvt_pk_bf16_f32 v31, v118, v119
    v_cvt_pk_bf16_f32 v32, v120, v121
    v_cvt_pk_bf16_f32 v33, v122, v123
    v_cvt_pk_bf16_f32 v34, v124, v125
    v_cvt_pk_bf16_f32 v35, v126, v127
    v_cvt_pk_bf16_f32 v40, v128, v129
    v_cvt_pk_bf16_f32 v41, v130, v131
    s_waitcnt vmcnt(16)
    v_mov_b32 v2, s45
    buffer_store_dword v2, v12, s[4:7], s43 offen sc1
    v_mfma_f32_32x32x16_bf16 v[144:159], a[96:99], v[28:31], 0
    v_mfma_f32_32x32x16_bf16 v[144:159], a[100:103], v[32:35], v[144:159]
    v_mfma_f32_32x32x16_bf16 v[144:159], a[128:131], v[40:43], v[144:159]
    v_mfma_f32_32x32x16_bf16 v[160:175], a[104:107], v[28:31], 0
    v_mfma_f32_32x32x16_bf16 v[160:175], a[108:111], v[32:35], v[160:175]
    v_mfma_f32_32x32x16_bf16 v[160:175], a[132:135], v[40:43], v[160:175]
    v_mfma_f32_32x32x16_bf16 v[176:191], a[112:115], v[28:31], 0
    s_nop 7
    v_mul_f32 v144, v144, v26
    v_mul_f32 v145, v145, v26
    v_mul_f32 v146, v146, v26
    v_mul_f32 v147, v147, v26
    v_mul_f32 v148, v148, v26
    v_mul_f32 v149, v149, v26
    v_mfma_f32_32x32x16_bf16 v[176:191], a[116:119], v[32:35], v[176:191]
    v_mul_f32 v150, v150, v26
    v_mul_f32 v151, v151, v26
    v_mul_f32 v152, v152, v26
    v_mul_f32 v153, v153, v26
    v_mul_f32 v154, v154, v26
    v_mul_f32 v155, v155, v26
    v_mfma_f32_32x32x16_bf16 v[176:191], a[136:139], v[40:43], v[176:191]
    v_mul_f32 v156, v156, v26
    v_mul_f32 v157, v157, v26
    v_mul_f32 v158, v158, v26
    v_mul_f32 v159, v159, v26
    v_cvt_pk_bf16_f32 v208, v144, v145
    v_cvt_pk_bf16_f32 v209, v146, v147
    v_mfma_f32_32x32x16_bf16 v[192:207], a[120:123], v[28:31], 0
    v_cvt_pk_bf16_f32 v210, v148, v149
    v_cvt_pk_bf16_f32 v211, v150, v151
    v_cvt_pk_bf16_f32 v212, v152, v153
    v_cvt_pk_bf16_f32 v213, v154, v155
    v_cvt_pk_bf16_f32 v214, v156, v157
    v_cvt_pk_bf16_f32 v215, v158, v159
    v_mfma_f32_32x32x16_bf16 v[192:207], a[124:127], v[32:35], v[192:207]
    v_mul_f32 v160, v160, v26
    v_mul_f32 v161, v161, v26
    v_mul_f32 v162, v162, v26
    v_mul_f32 v163, v163, v26
    v_mul_f32 v164, v164, v26
    v_mul_f32 v165, v165, v26
    v_mfma_f32_32x32x16_bf16 v[192:207], a[140:143], v[40:43], v[192:207]
    v_mul_f32 v166, v166, v26
    v_mul_f32 v167, v167, v26
    v_mul_f32 v168, v168, v26
    v_mul_f32 v169, v169, v26
    v_mul_f32 v170, v170, v26
    v_mul_f32 v171, v171, v26
    s_add_u32 s31, s36, 33554432
    buffer_load_dwordx4 a[96:99], v7, s[4:7], s31 offen offset:0 sc1
    buffer_load_dwordx4 a[100:103], v7, s[4:7], s31 offen offset:1024 sc1
    buffer_load_dwordx4 a[104:107], v7, s[4:7], s31 offen offset:2048 sc1
    buffer_load_dwordx4 a[108:111], v7, s[4:7], s31 offen offset:3072 sc1
    s_add_u32 s31, s36, 33558528
    buffer_load_dwordx4 a[112:115], v7, s[4:7], s31 offen offset:0 sc1
    buffer_load_dwordx4 a[116:119], v7, s[4:7], s31 offen offset:1024 sc1
    buffer_load_dwordx4 a[120:123], v7, s[4:7], s31 offen offset:2048 sc1
    buffer_load_dwordx4 a[124:127], v7, s[4:7], s31 offen offset:3072 sc1
    s_cmp_eq_u32 s51, 0
    s_cbranch_scc1 at_k4_91
    buffer_load_dwordx2 a[128:129], v10, s[4:7], s46 offen offset:0 sc1
    buffer_load_dwordx2 a[132:133], v10, s[4:7], s46 offen offset:512 sc1
    buffer_load_dwordx2 a[136:137], v10, s[4:7], s46 offen offset:1024 sc1
    buffer_load_dwordx2 a[140:141], v10, s[4:7], s46 offen offset:1536 sc1
at_k4_91:
    v_mul_f32 v172, v172, v26
    v_mul_f32 v173, v173, v26
    v_mul_f32 v174, v174, v26
    v_mul_f32 v175, v175, v26
    v_cvt_pk_bf16_f32 v216, v160, v161
    v_cvt_pk_bf16_f32 v217, v162, v163
    v_cvt_pk_bf16_f32 v218, v164, v165
    v_cvt_pk_bf16_f32 v219, v166, v167
    v_cvt_pk_bf16_f32 v220, v168, v169
    v_cvt_pk_bf16_f32 v221, v170, v171
    v_cvt_pk_bf16_f32 v222, v172, v173
    v_cvt_pk_bf16_f32 v223, v174, v175
    v_mul_f32 v176, v176, v26
    v_mul_f32 v177, v177, v26
    v_mul_f32 v178, v178, v26
    v_mul_f32 v179, v179, v26
    v_mul_f32 v180, v180, v26
    v_mul_f32 v181, v181, v26
    v_mul_f32 v182, v182, v26
    v_mul_f32 v183, v183, v26
    v_mul_f32 v184, v184, v26
    v_mul_f32 v185, v185, v26
    v_mul_f32 v186, v186, v26
    v_mul_f32 v187, v187, v26
    v_mul_f32 v188, v188, v26
    v_mul_f32 v189, v189, v26
    v_mul_f32 v190, v190, v26
    v_mul_f32 v191, v191, v26
    v_cvt_pk_bf16_f32 v224, v176, v177
    v_cvt_pk_bf16_f32 v225, v178, v179
    v_cvt_pk_bf16_f32 v226, v180, v181
    v_cvt_pk_bf16_f32 v227, v182, v183
    v_cvt_pk_bf16_f32 v228, v184, v185
    v_cvt_pk_bf16_f32 v229, v186, v187
    v_cvt_pk_bf16_f32 v230, v188, v189
    v_cvt_pk_bf16_f32 v231, v190, v191
    v_mul_f32 v192, v192, v26
    v_mul_f32 v193, v193, v26
    v_mul_f32 v194, v194, v26
    v_mul_f32 v195, v195, v26
    v_mul_f32 v196, v196, v26
    v_mul_f32 v197, v197, v26
    v_mul_f32 v198, v198, v26
    v_mul_f32 v199, v199, v26
    v_mul_f32 v200, v200, v26
    v_mul_f32 v201, v201, v26
    v_mul_f32 v202, v202, v26
    v_mul_f32 v203, v203, v26
    v_mul_f32 v204, v204, v26
    v_mul_f32 v205, v205, v26
    v_mul_f32 v206, v206, v26
    v_mul_f32 v207, v207, v26
    v_cvt_pk_bf16_f32 v232, v192, v193
    v_cvt_pk_bf16_f32 v233, v194, v195
    v_cvt_pk_bf16_f32 v234, v196, v197
    v_cvt_pk_bf16_f32 v235, v198, v199
    v_cvt_pk_bf16_f32 v236, v200, v201
    v_cvt_pk_bf16_f32 v237, v202, v203
    v_cvt_pk_bf16_f32 v238, v204, v205
    v_cvt_pk_bf16_f32 v239, v206, v207
    s_add_u32 s31, s47, 0
    buffer_store_dwordx4 v[208:211], v8, s[4:7], s31 offen offset:0 sc1
    buffer_store_dwordx4 v[212:215], v8, s[4:7], s31 offen offset:1024 sc1
    buffer_store_dwordx4 v[216:219], v8, s[4:7], s31 offen offset:2048 sc1
    buffer_store_dwordx4 v[220:223], v8, s[4:7], s31 offen offset:3072 sc1
    s_add_u32 s31, s47, 4096
    buffer_store_dwordx4 v[224:227], v8, s[4:7], s31 offen offset:0 sc1
    buffer_store_dwordx4 v[228:231], v8, s[4:7], s31 offen offset:1024 sc1
    buffer_store_dwordx4 v[232:235], v8, s[4:7], s31 offen offset:2048 sc1
    buffer_store_dwordx4 v[236:239], v8, s[4:7], s31 offen offset:3072 sc1
    s_mov_b32 s45, 1
    s_lshl_b32 s43, s53, 12
    s_add_u32 s43, s43, 32768
    s_mov_b32 s53, s49
    s_add_u32 s49, s53, s37
    s_cmp_lt_u32 s49, s38
    s_cbranch_scc1 at_nx_92
    s_max_u32 s49, s49, s39
    s_cmp_eq_u32 s38, 255
    s_cselect_b32 s49, s49, s39
    s_mov_b32 s37, 3
    s_mov_b32 s38, 255
at_nx_92:
    s_waitcnt vmcnt(17)
    s_branch at_top_76
at_b_78:
    s_load_dwordx16 s[8:23], s[90:91], s57 glc
    s_load_dwordx4 s[76:79], s[90:91], s55 glc
    s_load_dwordx4 s[80:83], s[90:91], s56 glc
    s_lshl_b32 s48, s54, 16
    s_add_u32 s48, s48, 83886080
    s_add_u32 s32, s54, 1
    s_min_u32 s32, s32, 63
    s_lshl_b32 s35, s32, 16
    v_mfma_f32_32x32x16_bf16 v[128:143], a[184:187], a[160:163], v[80:95]
    v_mfma_f32_32x32x16_bf16 v[128:143], a[188:191], a[164:167], v[128:143]
    v_mfma_f32_32x32x16_bf16 v[112:127], a[168:171], a[160:163], v[64:79]
    v_mfma_f32_32x32x16_bf16 v[112:127], a[172:175], a[164:167], v[112:127]
    v_accvgpr_mov_b32 a184, a168
    v_accvgpr_mov_b32 a185, a169
    v_accvgpr_mov_b32 a186, a170
    v_accvgpr_mov_b32 a187, a171
    v_accvgpr_mov_b32 a188, a172
    v_accvgpr_mov_b32 a189, a173
    v_accvgpr_mov_b32 a190, a174
    v_accvgpr_mov_b32 a191, a175
    v_accvgpr_mov_b32 a196, a176
    v_accvgpr_mov_b32 a197, a177
    v_accvgpr_mov_b32 a198, a178
    v_accvgpr_mov_b32 a199, a179
    v_accvgpr_mov_b32 a200, a180
    v_accvgpr_mov_b32 a201, a181
    v_accvgpr_mov_b32 a202, a182
    v_accvgpr_mov_b32 a203, a183
    s_add_u32 s31, s35, 50331648
    buffer_load_dwordx4 a[160:163], v6, s[4:7], s31 offen offset:0 sc1
    buffer_load_dwordx4 a[164:167], v6, s[4:7], s31 offen offset:1024 sc1
    s_add_u32 s31, s35, 54525952
    buffer_load_dwordx4 a[168:171], v6, s[4:7], s31 offen offset:0 sc1
    buffer_load_dwordx4 a[172:175], v6, s[4:7], s31 offen offset:1024 sc1
    s_add_u32 s31, s35, 58720256
    buffer_load_dwordx4 a[176:179], v6, s[4:7], s31 offen offset:0 sc1
    buffer_load_dwordx4 a[180:183], v6, s[4:7], s31 offen offset:1024 sc1
    v_max3_f32 v14, v136, v137, v138
    v_max3_f32 v14, v14, v139, v140
    v_max3_f32 v14, v14, v141, v142
    v_max3_f32 v14, v14, v143, v112
    v_max3_f32 v14, v14, v113, v114
    v_max3_f32 v14, v14, v115, v116
    v_max3_f32 v14, v14, v117, v118
    v_max3_f32 v14, v14, v119, v120
    v_max3_f32 v14, v14, v121, v122
    v_max3_f32 v14, v14, v123, v124
    v_max3_f32 v14, v14, v125, v126
    v_max_f32 v14, v14, v127
    v_mov_b32 v15, v14
    s_nop 1
    v_permlane32_swap_b32 v14, v15
    v_max_f32 v14, v14, v15
    v_mul_f32 v14, s58, v14
    v_fma_f32 v136, v136, s58, -v14
    v_fma_f32 v137, v137, s58, -v14
    v_fma_f32 v138, v138, s58, -v14
    v_fma_f32 v139, v139, s58, -v14
    v_fma_f32 v140, v140, s58, -v14
    v_fma_f32 v141, v141, s58, -v14
    v_fma_f32 v142, v142, s58, -v14
    v_fma_f32 v143, v143, s58, -v14
    v_fma_f32 v112, v112, s58, -v14
    v_fma_f32 v113, v113, s58, -v14
    v_fma_f32 v114, v114, s58, -v14
    v_fma_f32 v115, v115, s58, -v14
    v_fma_f32 v116, v116, s58, -v14
    v_fma_f32 v117, v117, s58, -v14
    v_fma_f32 v118, v118, s58, -v14
    v_fma_f32 v119, v119, s58, -v14
    v_fma_f32 v120, v120, s58, -v14
    v_fma_f32 v121, v121, s58, -v14
    v_fma_f32 v122, v122, s58, -v14
    v_fma_f32 v123, v123, s58, -v14
    v_fma_f32 v124, v124, s58, -v14
    v_fma_f32 v125, v125, s58, -v14
    v_fma_f32 v126, v126, s58, -v14
    v_fma_f32 v127, v127, s58, -v14
    v_exp_f32 v136, v136
    v_exp_f32 v137, v137
    v_exp_f32 v138, v138
    v_exp_f32 v139, v139
    v_exp_f32 v140, v140
    v_exp_f32 v141, v141
    v_exp_f32 v142, v142
    v_exp_f32 v143, v143
    v_exp_f32 v112, v112
    v_exp_f32 v113, v113
    v_exp_f32 v114, v114
    v_exp_f32 v115, v115
    v_exp_f32 v116, v116
    v_exp_f32 v117, v117
    v_exp_f32 v118, v118
    v_exp_f32 v119, v119
    v_exp_f32 v120, v120
    v_exp_f32 v121, v121
    v_exp_f32 v122, v122
    v_exp_f32 v123, v123
    v_exp_f32 v124, v124
    v_exp_f32 v125, v125
    v_exp_f32 v126, v126
    v_exp_f32 v127, v127
    v_add_f32 v26, v136, v137
    v_add_f32 v15, v138, v139
    v_add_f32 v26, v26, v140
    v_add_f32 v15, v15, v141
    v_add_f32 v26, v26, v142
    v_add_f32 v15, v15, v143
    v_add_f32 v26, v26, v112
    v_add_f32 v15, v15, v113
    v_add_f32 v26, v26, v114
    v_add_f32 v15, v15, v115
    v_add_f32 v26, v26, v116
    v_add_f32 v15, v15, v117
    v_add_f32 v26, v26, v118
    v_add_f32 v15, v15, v119
    v_add_f32 v26, v26, v120
    v_add_f32 v15, v15, v121
    v_add_f32 v26, v26, v122
    v_add_f32 v15, v15, v123
    v_add_f32 v26, v26, v124
    v_add_f32 v15, v15, v125
    v_add_f32 v26, v26, v126
    v_add_f32 v15, v15, v127
    v_add_f32 v26, v26, v15
    v_mov_b32 v15, v26
    s_nop 1
    v_permlane32_swap_b32 v26, v15
    v_add_f32 v26, v26, v15
    v_rcp_f32 v26, v26
    v_cvt_pk_bf16_f32 v28, v112, v113
    v_cvt_pk_bf16_f32 v29, v114, v115
    v_cvt_pk_bf16_f32 v30, v116, v117
    v_cvt_pk_bf16_f32 v31, v118, v119
    v_cvt_pk_bf16_f32 v32, v120, v121
    v_cvt_pk_bf16_f32 v33, v122, v123
    v_cvt_pk_bf16_f32 v34, v124, v125
    v_cvt_pk_bf16_f32 v35, v126, v127
    v_cvt_pk_bf16_f32 v36, v136, v137
    v_cvt_pk_bf16_f32 v37, v138, v139
    v_cvt_pk_bf16_f32 v38, v140, v141
    v_cvt_pk_bf16_f32 v39, v142, v143
    v_mfma_f32_32x32x16_bf16 v[144:159], a[196:199], v[28:31], 0
    v_mfma_f32_32x32x16_bf16 v[144:159], a[200:203], v[32:35], v[144:159]
    v_mfma_f32_32x32x16_bf16 v[144:159], a[192:195], v[36:39], v[144:159]
    v_accvgpr_mov_b32 a192, a200
    v_accvgpr_mov_b32 a193, a201
    v_accvgpr_mov_b32 a194, a202
    v_accvgpr_mov_b32 a195, a203
    s_waitcnt vmcnt(6)
    v_mov_b32 v2, s45
    buffer_store_dword v2, v12, s[4:7], s43 offen sc1
    s_cmp_lg_u32 s54, 0
    s_cbranch_scc1 at_nb_80
    v_mov_b32 v14, 0xf149f2ca
    v_add_u32 v3, 32, v11
    v_and_b32 v3, 0xfffffff1, v3
    v_cmp_ne_u32 vcc, 0, v3
    s_nop 1
    v_cndmask_b32 v80, 0, v14, vcc
    v_add_u32 v3, 31, v11
    v_and_b32 v3, 0xfffffff1, v3
    v_cmp_ne_u32 vcc, 0, v3
    s_nop 1
    v_cndmask_b32 v81, 0, v14, vcc
    v_add_u32 v3, 30, v11
    v_and_b32 v3, 0xfffffff1, v3
    v_cmp_ne_u32 vcc, 0, v3
    s_nop 1
    v_cndmask_b32 v82, 0, v14, vcc
    v_add_u32 v3, 29, v11
    v_and_b32 v3, 0xfffffff1, v3
    v_cmp_ne_u32 vcc, 0, v3
    s_nop 1
    v_cndmask_b32 v83, 0, v14, vcc
    v_add_u32 v3, 24, v11
    v_and_b32 v3, 0xfffffff1, v3
    v_cmp_ne_u32 vcc, 0, v3
    s_nop 1
    v_cndmask_b32 v84, 0, v14, vcc
    v_add_u32 v3, 23, v11
    v_and_b32 v3, 0xfffffff1, v3
    v_cmp_ne_u32 vcc, 0, v3
    s_nop 1
    v_cndmask_b32 v85, 0, v14, vcc
    v_add_u32 v3, 22, v11
    v_and_b32 v3, 0xfffffff1, v3
    v_cmp_ne_u32 vcc, 0, v3
    s_nop 1
    v_cndmask_b32 v86, 0, v14, vcc
    v_add_u32 v3, 21, v11
    v_and_b32 v3, 0xfffffff1, v3
    v_cmp_ne_u32 vcc, 0, v3
    s_nop 1
    v_cndmask_b32 v87, 0, v14, vcc
    v_add_u32 v3, 16, v11
    v_and_b32 v3, 0xfffffff1, v3
    v_cmp_ne_u32 vcc, 0, v3
    s_nop 1
    v_cndmask_b32 v88, 0, v14, vcc
    v_add_u32 v3, 15, v11
    v_and_b32 v3, 0xfffffff1, v3
    v_cmp_ne_u32 vcc, 0, v3
    s_nop 1
    v_cndmask_b32 v89, 0, v14, vcc
    v_add_u32 v3, 14, v11
    v_and_b32 v3, 0xfffffff1, v3
    v_cmp_ne_u32 vcc, 0, v3
    s_nop 1
    v_cndmask_b32 v90, 0, v14, vcc
    v_add_u32 v3, 13, v11
    v_and_b32 v3, 0xfffffff1, v3
    v_cmp_ne_u32 vcc, 0, v3
    s_nop 1
    v_cndmask_b32 v91, 0, v14, vcc
    v_add_u32 v3, 8, v11
    v_and_b32 v3, 0xfffffff1, v3
    v_cmp_ne_u32 vcc, 0, v3
    s_nop 1
    v_cndmask_b32 v92, 0, v14, vcc
    v_add_u32 v3, 7, v11
    v_and_b32 v3, 0xfffffff1, v3
    v_cmp_ne_u32 vcc, 0, v3
    s_nop 1
    v_cndmask_b32 v93, 0, v14, vcc
    v_add_u32 v3, 6, v11
    v_and_b32 v3, 0xfffffff1, v3
    v_cmp_ne_u32 vcc, 0, v3
    s_nop 1
    v_cndmask_b32 v94, 0, v14, vcc
    v_add_u32 v3, 5, v11
    v_and_b32 v3, 0xfffffff1, v3
    v_cmp_ne_u32 vcc, 0, v3
    s_nop 1
    v_cndmask_b32 v95, 0, v14, vcc
at_nb_80:
    s_nop 2
    v_mul_f32 v144, v144, v26
    v_mul_f32 v145, v145, v26
    v_mul_f32 v146, v146, v26
    v_mul_f32 v147, v147, v26
    v_mul_f32 v148, v148, v26
    v_mul_f32 v149, v149, v26
    v_mul_f32 v150, v150, v26
    v_mul_f32 v151, v151, v26
    v_mul_f32 v152, v152, v26
    v_mul_f32 v153, v153, v26
    v_mul_f32 v154, v154, v26
    v_mul_f32 v155, v155, v26
    v_mul_f32 v156, v156, v26
    v_mul_f32 v157, v157, v26
    v_mul_f32 v158, v158, v26
    v_mul_f32 v159, v159, v26
    v_cvt_pk_bf16_f32 v208, v144, v145
    v_cvt_pk_bf16_f32 v209, v146, v147
    v_cvt_pk_bf16_f32 v210, v148, v149
    v_cvt_pk_bf16_f32 v211, v150, v151
    v_cvt_pk_bf16_f32 v212, v152, v153
    v_cvt_pk_bf16_f32 v213, v154, v155
    v_cvt_pk_bf16_f32 v214, v156, v157
    v_cvt_pk_bf16_f32 v215, v158, v159
    v_permlane32_swap_b32 v208, v210
    v_permlane32_swap_b32 v209, v211
    v_permlane32_swap_b32 v212, v214
    v_permlane32_swap_b32 v213, v215
    buffer_store_dwordx4 v[208:211], v6, s[4:7], s48 offen offset:0 sc1
    buffer_store_dwordx4 v[212:215], v6, s[4:7], s48 offen offset:1024 sc1
    s_add_u32 s54, s54, 1
    s_mov_b32 s43, 16384
    s_mov_b32 s45, s54
    s_waitcnt vmcnt(3)
    s_branch at_top_76
at_end_79:
    s_waitcnt vmcnt(0) lgkmcnt(0)
    s_branch L_o64
L_o64:
    s_cmp_ge_u32 s28, 80
    s_cbranch_scc1 L_dump
    s_load_dwordx2 s[72:73], s[0:1], 40
    s_load_dwordx2 s[74:75], s[0:1], 80
    s_mul_i32 s44, s28, 205
    s_lshr_b32 s44, s44, 10
    s_mul_i32 s31, s44, 5
    s_sub_u32 s30, s28, s31
    s_waitcnt lgkmcnt(0)
    s_mov_b32 s8, s72
    s_and_b32 s9, s73, 0xffff
    s_mov_b32 s10, 8388608
    s_mov_b32 s11, 0x00020000
    s_mov_b32 s20, s74
    s_and_b32 s21, s75, 0xffff
    s_mov_b32 s22, 8388608
    s_mov_b32 s23, 0x00020000
    s_lshl_b32 s31, s29, 21
    s_lshl_b32 s33, s44, 7
    s_add_u32 s31, s31, s33
    v_lshrrev_b32 v6, 3, v1
    v_lshlrev_b32 v6, 11, v6
    v_and_b32 v4, 7, v1
    v_lshl_add_u32 v6, v4, 4, v6
    v_add_u32 v6, s31, v6
    s_lshl_b32 s31, s29, 15
    v_lshrrev_b32 v7, 5, v1
    v_lshlrev_b32 v7, 9, v7
    v_bfe_u32 v4, v1, 2, 2
    v_lshl_add_u32 v7, v4, 7, v7
    v_bfe_u32 v4, v1, 4, 1
    v_lshl_add_u32 v7, v4, 5, v7
    v_and_b32 v4, 3, v1
    v_lshl_add_u32 v7, v4, 3, v7
    v_add_u32 v7, s31, v7
    s_lshl_b32 s32, s29, 15
    s_add_u32 m0, s32, 0
    s_mov_b32 s38, 0
    buffer_load_dwordx4 v6, s[8:11], s38 offen lds
    s_add_u32 m0, s32, 1024
    s_add_u32 s38, s38, 16384
    buffer_load_dwordx4 v6, s[8:11], s38 offen lds
    s_add_u32 m0, s32, 2048
    s_add_u32 s38, s38, 16384
    buffer_load_dwordx4 v6, s[8:11], s38 offen lds
    s_add_u32 m0, s32, 3072
    s_add_u32 s38, s38, 16384
    buffer_load_dwordx4 v6, s[8:11], s38 offen lds
    s_add_u32 m0, s32, 4096
    s_add_u32 s38, s38, 16384
    buffer_load_dwordx4 v6, s[8:11], s38 offen lds
    s_add_u32 m0, s32, 5120
    s_add_u32 s38, s38, 16384
    buffer_load_dwordx4 v6, s[8:11], s38 offen lds
    s_add_u32 m0, s32, 6144
    s_add_u32 s38, s38, 16384
    buffer_load_dwordx4 v6, s[8:11], s38 offen lds
    s_add_u32 m0, s32, 7168
    s_add_u32 s38, s38, 16384
    buffer_load_dwordx4 v6, s[8:11], s38 offen lds
    s_add_u32 m0, s32, 8192
    s_add_u32 s38, s38, 16384
    buffer_load_dwordx4 v6, s[8:11], s38 offen lds
    s_add_u32 m0, s32, 9216
    s_add_u32 s38, s38, 16384
    buffer_load_dwordx4 v6, s[8:11], s38 offen lds
    s_add_u32 m0, s32, 10240
    s_add_u32 s38, s38, 16384
    buffer_load_dwordx4 v6, s[8:11], s38 offen lds
    s_add_u32 m0, s32, 11264
    s_add_u32 s38, s38, 16384
    buffer_load_dwordx4 v6, s[8:11], s38 offen lds
    s_add_u32 m0, s32, 12288
    s_add_u32 s38, s38, 16384
    buffer_load_dwordx4 v6, s[8:11], s38 offen lds
    s_add_u32 m0, s32, 13312
    s_add_u32 s38, s38, 16384
    buffer_load_dwordx4 v6, s[8:11], s38 offen lds
    s_add_u32 m0, s32, 14336
    s_add_u32 s38, s38, 16384
    buffer_load_dwordx4 v6, s[8:11], s38 offen lds
    s_add_u32 m0, s32, 15360
    s_add_u32 s38, s38, 16384
    buffer_load_dwordx4 v6, s[8:11], s38 offen lds
    s_add_u32 m0, s32, 16384
    s_add_u32 s38, s38, 16384
    buffer_load_dwordx4 v6, s[8:11], s38 offen lds
    s_add_u32 m0, s32, 17408
    s_add_u32 s38, s38, 16384
    buffer_load_dwordx4 v6, s[8:11], s38 offen lds
    s_add_u32 m0, s32, 18432
    s_add_u32 s38, s38, 16384
    buffer_load_dwordx4 v6, s[8:11], s38 offen lds
    s_add_u32 m0, s32, 19456
    s_add_u32 s38, s38, 16384
    buffer_load_dwordx4 v6, s[8:11], s38 offen lds
    s_add_u32 m0, s32, 20480
    s_add_u32 s38, s38, 16384
    buffer_load_dwordx4 v6, s[8:11], s38 offen lds
    s_add_u32 m0, s32, 21504
    s_add_u32 s38, s38, 16384
    buffer_load_dwordx4 v6, s[8:11], s38 offen lds
    s_add_u32 m0, s32, 22528
    s_add_u32 s38, s38, 16384
    buffer_load_dwordx4 v6, s[8:11], s38 offen lds
    s_add_u32 m0, s32, 23552
    s_add_u32 s38, s38, 16384
    buffer_load_dwordx4 v6, s[8:11], s38 offen lds
    s_add_u32 m0, s32, 24576
    s_add_u32 s38, s38, 16384
    buffer_load_dwordx4 v6, s[8:11], s38 offen lds
    s_add_u32 m0, s32, 25600
    s_add_u32 s38, s38, 16384
    buffer_load_dwordx4 v6, s[8:11], s38 offen lds
    s_add_u32 m0, s32, 26624
    s_add_u32 s38, s38, 16384
    buffer_load_dwordx4 v6, s[8:11], s38 offen lds
    s_add_u32 m0, s32, 27648
    s_add_u32 s38, s38, 16384
    buffer_load_dwordx4 v6, s[8:11], s38 offen lds
    s_add_u32 m0, s32, 28672
    s_add_u32 s38, s38, 16384
    buffer_load_dwordx4 v6, s[8:11], s38 offen lds
    s_add_u32 m0, s32, 29696
    s_add_u32 s38, s38, 16384
    buffer_load_dwordx4 v6, s[8:11], s38 offen lds
    s_add_u32 m0, s32, 30720
    s_add_u32 s38, s38, 16384
    buffer_load_dwordx4 v6, s[8:11], s38 offen lds
    s_add_u32 m0, s32, 31744
    s_add_u32 s38, s38, 16384
    buffer_load_dwordx4 v6, s[8:11], s38 offen lds
    s_waitcnt vmcnt(30)
    ds_read_b64_tr_b16 a[0:1], v7 offset:0
    ds_read_b64_tr_b16 a[2:3], v7 offset:1024
    ds_read_b64_tr_b16 a[4:5], v7 offset:64
    ds_read_b64_tr_b16 a[6:7], v7 offset:1088
    s_waitcnt vmcnt(28)
    ds_read_b64_tr_b16 a[8:9], v7 offset:2048
    ds_read_b64_tr_b16 a[10:11], v7 offset:3072
    ds_read_b64_tr_b16 a[12:13], v7 offset:2112
    ds_read_b64_tr_b16 a[14:15], v7 offset:3136
    s_waitcnt lgkmcnt(4)
    s_add_u32 m0, s32, 0
    s_add_u32 s38, s38, 16384
    buffer_load_dwordx4 v6, s[8:11], s38 offen lds
    s_add_u32 m0, s32, 1024
    s_add_u32 s38, s38, 16384
    buffer_load_dwordx4 v6, s[8:11], s38 offen lds
    s_waitcnt vmcnt(28)
    ds_read_b64_tr_b16 a[16:17], v7 offset:4096
    ds_read_b64_tr_b16 a[18:19], v7 offset:5120
    ds_read_b64_tr_b16 a[20:21], v7 offset:4160
    ds_read_b64_tr_b16 a[22:23], v7 offset:5184
    s_waitcnt lgkmcnt(4)
    s_add_u32 m0, s32, 2048
    s_add_u32 s38, s38, 16384
    buffer_load_dwordx4 v6, s[8:11], s38 offen lds
    s_add_u32 m0, s32, 3072
    s_add_u32 s38, s38, 16384
    buffer_load_dwordx4 v6, s[8:11], s38 offen lds
    s_waitcnt vmcnt(28)
    ds_read_b64_tr_b16 a[24:25], v7 offset:6144
    ds_read_b64_tr_b16 a[26:27], v7 offset:7168
    ds_read_b64_tr_b16 a[28:29], v7 offset:6208
    ds_read_b64_tr_b16 a[30:31], v7 offset:7232
    s_waitcnt lgkmcnt(4)
    s_add_u32 m0, s32, 4096
    s_add_u32 s38, s38, 16384
    buffer_load_dwordx4 v6, s[8:11], s38 offen lds
    s_add_u32 m0, s32, 5120
    s_add_u32 s38, s38, 16384
    buffer_load_dwordx4 v6, s[8:11], s38 offen lds
    s_waitcnt vmcnt(28)
    ds_read_b64_tr_b16 a[32:33], v7 offset:8192
    ds_read_b64_tr_b16 a[34:35], v7 offset:9216
    ds_read_b64_tr_b16 a[36:37], v7 offset:8256
    ds_read_b64_tr_b16 a[38:39], v7 offset:9280
    s_waitcnt lgkmcnt(4)
    s_add_u32 m0, s32, 6144
    s_add_u32 s38, s38, 16384
    buffer_load_dwordx4 v6, s[8:11], s38 offen lds
    s_add_u32 m0, s32, 7168
    s_add_u32 s38, s38, 16384
    buffer_load_dwordx4 v6, s[8:11], s38 offen lds
    s_waitcnt vmcnt(28)
    ds_read_b64_tr_b16 a[40:41], v7 offset:10240
    ds_read_b64_tr_b16 a[42:43], v7 offset:11264
    ds_read_b64_tr_b16 a[44:45], v7 offset:10304
    ds_read_b64_tr_b16 a[46:47], v7 offset:11328
    s_waitcnt lgkmcnt(4)
    s_add_u32 m0, s32, 8192
    s_add_u32 s38, s38, 16384
    buffer_load_dwordx4 v6, s[8:11], s38 offen lds
    s_add_u32 m0, s32, 9216
    s_add_u32 s38, s38, 16384
    buffer_load_dwordx4 v6, s[8:11], s38 offen lds
    s_waitcnt vmcnt(28)
    ds_read_b64_tr_b16 a[48:49], v7 offset:12288
    ds_read_b64_tr_b16 a[50:51], v7 offset:13312
    ds_read_b64_tr_b16 a[52:53], v7 offset:12352
    ds_read_b64_tr_b16 a[54:55], v7 offset:13376
    s_waitcnt lgkmcnt(4)
    s_add_u32 m0, s32, 10240
    s_add_u32 s38, s38, 16384
    buffer_load_dwordx4 v6, s[8:11], s38 offen lds
    s_add_u32 m0, s32, 11264
    s_add_u32 s38, s38, 16384
    buffer_load_dwordx4 v6, s[8:11], s38 offen lds
    s_waitcnt vmcnt(28)
    ds_read_b64_tr_b16 a[56:57], v7 offset:14336
    ds_read_b64_tr_b16 a[58:59], v7 offset:15360
    ds_read_b64_tr_b16 a[60:61], v7 offset:14400
    ds_read_b64_tr_b16 a[62:63], v7 offset:15424
    s_waitcnt lgkmcnt(4)
    s_add_u32 m0, s32, 12288
    s_add_u32 s38, s38, 16384
    buffer_load_dwordx4 v6, s[8:11], s38 offen lds
    s_add_u32 m0, s32, 13312
    s_add_u32 s38, s38, 16384
    buffer_load_dwordx4 v6, s[8:11], s38 offen lds
    s_waitcnt vmcnt(28)
    ds_read_b64_tr_b16 a[64:65], v7 offset:16384
    ds_read_b64_tr_b16 a[66:67], v7 offset:17408
    ds_read_b64_tr_b16 a[68:69], v7 offset:16448
    ds_read_b64_tr_b16 a[70:71], v7 offset:17472
    s_waitcnt lgkmcnt(4)
    s_add_u32 m0, s32, 14336
    s_add_u32 s38, s38, 16384
    buffer_load_dwordx4 v6, s[8:11], s38 offen lds
    s_add_u32 m0, s32, 15360
    s_add_u32 s38, s38, 16384
    buffer_load_dwordx4 v6, s[8:11], s38 offen lds
    s_waitcnt vmcnt(28)
    ds_read_b64_tr_b16 a[72:73], v7 offset:18432
    ds_read_b64_tr_b16 a[74:75], v7 offset:19456
    ds_read_b64_tr_b16 a[76:77], v7 offset:18496
    ds_read_b64_tr_b16 a[78:79], v7 offset:19520
    s_waitcnt lgkmcnt(4)
    s_add_u32 m0, s32, 16384
    s_add_u32 s38, s38, 16384
    buffer_load_dwordx4 v6, s[8:11], s38 offen lds
    s_add_u32 m0, s32, 17408
    s_add_u32 s38, s38, 16384
    buffer_load_dwordx4 v6, s[8:11], s38 offen lds
    s_waitcnt vmcnt(28)
    ds_read_b64_tr_b16 a[80:81], v7 offset:20480
    ds_read_b64_tr_b16 a[82:83], v7 offset:21504
    ds_read_b64_tr_b16 a[84:85], v7 offset:20544
    ds_read_b64_tr_b16 a[86:87], v7 offset:21568
    s_waitcnt lgkmcnt(4)
    s_add_u32 m0, s32, 18432
    s_add_u32 s38, s38, 16384
    buffer_load_dwordx4 v6, s[8:11], s38 offen lds
    s_add_u32 m0, s32, 19456
    s_add_u32 s38, s38, 16384
    buffer_load_dwordx4 v6, s[8:11], s38 offen lds
    s_waitcnt vmcnt(28)
    ds_read_b64_tr_b16 a[88:89], v7 offset:22528
    ds_read_b64_tr_b16 a[90:91], v7 offset:23552
    ds_read_b64_tr_b16 a[92:93], v7 offset:22592
    ds_read_b64_tr_b16 a[94:95], v7 offset:23616
    s_waitcnt lgkmcnt(4)
    s_add_u32 m0, s32, 20480
    s_add_u32 s38, s38, 16384
    buffer_load_dwordx4 v6, s[8:11], s38 offen lds
    s_add_u32 m0, s32, 21504
    s_add_u32 s38, s38, 16384
    buffer_load_dwordx4 v6, s[8:11], s38 offen lds
    s_waitcnt vmcnt(28)
    ds_read_b64_tr_b16 a[96:97], v7 offset:24576
    ds_read_b64_tr_b16 a[98:99], v7 offset:25600
    ds_read_b64_tr_b16 a[100:101], v7 offset:24640
    ds_read_b64_tr_b16 a[102:103], v7 offset:25664
    s_waitcnt lgkmcnt(4)
    s_add_u32 m0, s32, 22528
    s_add_u32 s38, s38, 16384
    buffer_load_dwordx4 v6, s[8:11], s38 offen lds
    s_add_u32 m0, s32, 23552
    s_add_u32 s38, s38, 16384
    buffer_load_dwordx4 v6, s[8:11], s38 offen lds
    s_waitcnt vmcnt(28)
    ds_read_b64_tr_b16 a[104:105], v7 offset:26624
    ds_read_b64_tr_b16 a[106:107], v7 offset:27648
    ds_read_b64_tr_b16 a[108:109], v7 offset:26688
    ds_read_b64_tr_b16 a[110:111], v7 offset:27712
    s_waitcnt lgkmcnt(4)
    s_add_u32 m0, s32, 24576
    s_add_u32 s38, s38, 16384
    buffer_load_dwordx4 v6, s[8:11], s38 offen lds
    s_add_u32 m0, s32, 25600
    s_add_u32 s38, s38, 16384
    buffer_load_dwordx4 v6, s[8:11], s38 offen lds
    s_waitcnt vmcnt(28)
    ds_read_b64_tr_b16 a[112:113], v7 offset:28672
    ds_read_b64_tr_b16 a[114:115], v7 offset:29696
    ds_read_b64_tr_b16 a[116:117], v7 offset:28736
    ds_read_b64_tr_b16 a[118:119], v7 offset:29760
    s_waitcnt lgkmcnt(4)
    s_add_u32 m0, s32, 26624
    s_add_u32 s38, s38, 16384
    buffer_load_dwordx4 v6, s[8:11], s38 offen lds
    s_add_u32 m0, s32, 27648
    s_add_u32 s38, s38, 16384
    buffer_load_dwordx4 v6, s[8:11], s38 offen lds
    s_waitcnt vmcnt(28)
    ds_read_b64_tr_b16 a[120:121], v7 offset:30720
    ds_read_b64_tr_b16 a[122:123], v7 offset:31744
    ds_read_b64_tr_b16 a[124:125], v7 offset:30784
    ds_read_b64_tr_b16 a[126:127], v7 offset:31808
    s_waitcnt lgkmcnt(4)
    s_add_u32 m0, s32, 28672
    s_add_u32 s38, s38, 16384
    buffer_load_dwordx4 v6, s[8:11], s38 offen lds
    s_add_u32 m0, s32, 29696
    s_add_u32 s38, s38, 16384
    buffer_load_dwordx4 v6, s[8:11], s38 offen lds
    s_waitcnt vmcnt(28)
    ds_read_b64_tr_b16 a[128:129], v7 offset:0
    ds_read_b64_tr_b16 a[130:131], v7 offset:1024
    ds_read_b64_tr_b16 a[132:133], v7 offset:64
    ds_read_b64_tr_b16 a[134:135], v7 offset:1088
    s_waitcnt lgkmcnt(4)
    s_add_u32 m0, s32, 30720
    s_add_u32 s38, s38, 16384
    buffer_load_dwordx4 v6, s[8:11], s38 offen lds
    s_add_u32 m0, s32, 31744
    s_add_u32 s38, s38, 16384
    buffer_load_dwordx4 v6, s[8:11], s38 offen lds
    s_waitcnt vmcnt(28)
    ds_read_b64_tr_b16 a[136:137], v7 offset:2048
    ds_read_b64_tr_b16 a[138:139], v7 offset:3072
    ds_read_b64_tr_b16 a[140:141], v7 offset:2112
    ds_read_b64_tr_b16 a[142:143], v7 offset:3136
    s_waitcnt lgkmcnt(4)
    s_add_u32 m0, s32, 0
    s_add_u32 s38, s38, 16384
    buffer_load_dwordx4 v6, s[8:11], s38 offen lds
    s_add_u32 m0, s32, 1024
    s_add_u32 s38, s38, 16384
    buffer_load_dwordx4 v6, s[8:11], s38 offen lds
    s_waitcnt vmcnt(28)
    ds_read_b64_tr_b16 a[144:145], v7 offset:4096
    ds_read_b64_tr_b16 a[146:147], v7 offset:5120
    ds_read_b64_tr_b16 a[148:149], v7 offset:4160
    ds_read_b64_tr_b16 a[150:151], v7 offset:5184
    s_waitcnt lgkmcnt(4)
    s_add_u32 m0, s32, 2048
    s_add_u32 s38, s38, 16384
    buffer_load_dwordx4 v6, s[8:11], s38 offen lds
    s_add_u32 m0, s32, 3072
    s_add_u32 s38, s38, 16384
    buffer_load_dwordx4 v6, s[8:11], s38 offen lds
    s_waitcnt vmcnt(28)
    ds_read_b64_tr_b16 a[152:153], v7 offset:6144
    ds_read_b64_tr_b16 a[154:155], v7 offset:7168
    ds_read_b64_tr_b16 a[156:157], v7 offset:6208
    ds_read_b64_tr_b16 a[158:159], v7 offset:7232
    s_waitcnt lgkmcnt(4)
    s_add_u32 m0, s32, 4096
    s_add_u32 s38, s38, 16384
    buffer_load_dwordx4 v6, s[8:11], s38 offen lds
    s_add_u32 m0, s32, 5120
    s_add_u32 s38, s38, 16384
    buffer_load_dwordx4 v6, s[8:11], s38 offen lds
    s_waitcnt vmcnt(28)
    ds_read_b64_tr_b16 a[160:161], v7 offset:8192
    ds_read_b64_tr_b16 a[162:163], v7 offset:9216
    ds_read_b64_tr_b16 a[164:165], v7 offset:8256
    ds_read_b64_tr_b16 a[166:167], v7 offset:9280
    s_waitcnt lgkmcnt(4)
    s_add_u32 m0, s32, 6144
    s_add_u32 s38, s38, 16384
    buffer_load_dwordx4 v6, s[8:11], s38 offen lds
    s_add_u32 m0, s32, 7168
    s_add_u32 s38, s38, 16384
    buffer_load_dwordx4 v6, s[8:11], s38 offen lds
    s_waitcnt vmcnt(28)
    ds_read_b64_tr_b16 a[168:169], v7 offset:10240
    ds_read_b64_tr_b16 a[170:171], v7 offset:11264
    ds_read_b64_tr_b16 a[172:173], v7 offset:10304
    ds_read_b64_tr_b16 a[174:175], v7 offset:11328
    s_waitcnt lgkmcnt(4)
    s_add_u32 m0, s32, 8192
    s_add_u32 s38, s38, 16384
    buffer_load_dwordx4 v6, s[8:11], s38 offen lds
    s_add_u32 m0, s32, 9216
    s_add_u32 s38, s38, 16384
    buffer_load_dwordx4 v6, s[8:11], s38 offen lds
    s_waitcnt vmcnt(28)
    ds_read_b64_tr_b16 a[176:177], v7 offset:12288
    ds_read_b64_tr_b16 a[178:179], v7 offset:13312
    ds_read_b64_tr_b16 a[180:181], v7 offset:12352
    ds_read_b64_tr_b16 a[182:183], v7 offset:13376
    s_waitcnt lgkmcnt(4)
    s_add_u32 m0, s32, 10240
    s_add_u32 s38, s38, 16384
    buffer_load_dwordx4 v6, s[8:11], s38 offen lds
    s_add_u32 m0, s32, 11264
    s_add_u32 s38, s38, 16384
    buffer_load_dwordx4 v6, s[8:11], s38 offen lds
    s_waitcnt vmcnt(28)
    ds_read_b64_tr_b16 a[184:185], v7 offset:14336
    ds_read_b64_tr_b16 a[186:187], v7 offset:15360
    ds_read_b64_tr_b16 a[188:189], v7 offset:14400
    ds_read_b64_tr_b16 a[190:191], v7 offset:15424
    s_waitcnt lgkmcnt(4)
    s_add_u32 m0, s32, 12288
    s_add_u32 s38, s38, 16384
    buffer_load_dwordx4 v6, s[8:11], s38 offen lds
    s_add_u32 m0, s32, 13312
    s_add_u32 s38, s38, 16384
    buffer_load_dwordx4 v6, s[8:11], s38 offen lds
    s_waitcnt vmcnt(28)
    ds_read_b64_tr_b16 a[192:193], v7 offset:16384
    ds_read_b64_tr_b16 a[194:195], v7 offset:17408
    ds_read_b64_tr_b16 a[196:197], v7 offset:16448
    ds_read_b64_tr_b16 a[198:199], v7 offset:17472
    s_waitcnt lgkmcnt(4)
    s_add_u32 m0, s32, 14336
    s_add_u32 s38, s38, 16384
    buffer_load_dwordx4 v6, s[8:11], s38 offen lds
    s_add_u32 m0, s32, 15360
    s_add_u32 s38, s38, 16384
    buffer_load_dwordx4 v6, s[8:11], s38 offen lds
    s_waitcnt vmcnt(28)
    ds_read_b64_tr_b16 a[200:201], v7 offset:18432
    ds_read_b64_tr_b16 a[202:203], v7 offset:19456
    ds_read_b64_tr_b16 a[204:205], v7 offset:18496
    ds_read_b64_tr_b16 a[206:207], v7 offset:19520
    s_waitcnt lgkmcnt(4)
    s_add_u32 m0, s32, 16384
    s_add_u32 s38, s38, 16384
    buffer_load_dwordx4 v6, s[8:11], s38 offen lds
    s_add_u32 m0, s32, 17408
    s_add_u32 s38, s38, 16384
    buffer_load_dwordx4 v6, s[8:11], s38 offen lds
    s_waitcnt vmcnt(28)
    ds_read_b64_tr_b16 a[208:209], v7 offset:20480
    ds_read_b64_tr_b16 a[210:211], v7 offset:21504
    ds_read_b64_tr_b16 a[212:213], v7 offset:20544
    ds_read_b64_tr_b16 a[214:215], v7 offset:21568
    s_waitcnt lgkmcnt(4)
    s_add_u32 m0, s32, 18432
    s_add_u32 s38, s38, 16384
    buffer_load_dwordx4 v6, s[8:11], s38 offen lds
    s_add_u32 m0, s32, 19456
    s_add_u32 s38, s38, 16384
    buffer_load_dwordx4 v6, s[8:11], s38 offen lds
    s_waitcnt vmcnt(28)
    ds_read_b64_tr_b16 a[216:217], v7 offset:22528
    ds_read_b64_tr_b16 a[218:219], v7 offset:23552
    ds_read_b64_tr_b16 a[220:221], v7 offset:22592
    ds_read_b64_tr_b16 a[222:223], v7 offset:23616
    s_waitcnt lgkmcnt(4)
    s_add_u32 m0, s32, 20480
    s_add_u32 s38, s38, 16384
    buffer_load_dwordx4 v6, s[8:11], s38 offen lds
    s_add_u32 m0, s32, 21504
    s_add_u32 s38, s38, 16384
    buffer_load_dwordx4 v6, s[8:11], s38 offen lds
    s_waitcnt vmcnt(28)
    ds_read_b64_tr_b16 a[224:225], v7 offset:24576
    ds_read_b64_tr_b16 a[226:227], v7 offset:25600
    ds_read_b64_tr_b16 a[228:229], v7 offset:24640
    ds_read_b64_tr_b16 a[230:231], v7 offset:25664
    s_waitcnt lgkmcnt(4)
    s_add_u32 m0, s32, 22528
    s_add_u32 s38, s38, 16384
    buffer_load_dwordx4 v6, s[8:11], s38 offen lds
    s_add_u32 m0, s32, 23552
    s_add_u32 s38, s38, 16384
    buffer_load_dwordx4 v6, s[8:11], s38 offen lds
    s_waitcnt vmcnt(28)
    ds_read_b64_tr_b16 a[232:233], v7 offset:26624
    ds_read_b64_tr_b16 a[234:235], v7 offset:27648
    ds_read_b64_tr_b16 a[236:237], v7 offset:26688
    ds_read_b64_tr_b16 a[238:239], v7 offset:27712
    s_waitcnt lgkmcnt(4)
    s_add_u32 m0, s32, 24576
    s_add_u32 s38, s38, 16384
    buffer_load_dwordx4 v6, s[8:11], s38 offen lds
    s_add_u32 m0, s32, 25600
    s_add_u32 s38, s38, 16384
    buffer_load_dwordx4 v6, s[8:11], s38 offen lds
    s_waitcnt vmcnt(28)
    ds_read_b64_tr_b16 a[240:241], v7 offset:28672
    ds_read_b64_tr_b16 a[242:243], v7 offset:29696
    ds_read_b64_tr_b16 a[244:245], v7 offset:28736
    ds_read_b64_tr_b16 a[246:247], v7 offset:29760
    s_waitcnt lgkmcnt(4)
    s_add_u32 m0, s32, 26624
    s_add_u32 s38, s38, 16384
    buffer_load_dwordx4 v6, s[8:11], s38 offen lds
    s_add_u32 m0, s32, 27648
    s_add_u32 s38, s38, 16384
    buffer_load_dwordx4 v6, s[8:11], s38 offen lds
    s_waitcnt vmcnt(28)
    ds_read_b64_tr_b16 a[248:249], v7 offset:30720
    ds_read_b64_tr_b16 a[250:251], v7 offset:31744
    ds_read_b64_tr_b16 a[252:253], v7 offset:30784
    ds_read_b64_tr_b16 a[254:255], v7 offset:31808
    s_waitcnt lgkmcnt(4)
    s_add_u32 m0, s32, 28672
    s_add_u32 s38, s38, 16384
    buffer_load_dwordx4 v6, s[8:11], s38 offen lds
    s_add_u32 m0, s32, 29696
    s_add_u32 s38, s38, 16384
    buffer_load_dwordx4 v6, s[8:11], s38 offen lds
    s_waitcnt vmcnt(28)
    ds_read_b64_tr_b16 v[128:129], v7 offset:0
    ds_read_b64_tr_b16 v[130:131], v7 offset:1024
    ds_read_b64_tr_b16 v[132:133], v7 offset:64
    ds_read_b64_tr_b16 v[134:135], v7 offset:1088
    s_waitcnt lgkmcnt(4)
    s_add_u32 m0, s32, 30720
    s_add_u32 s38, s38, 16384
    buffer_load_dwordx4 v6, s[8:11], s38 offen lds
    s_add_u32 m0, s32, 31744
    s_add_u32 s38, s38, 16384
    buffer_load_dwordx4 v6, s[8:11], s38 offen lds
    s_waitcnt vmcnt(28)
    ds_read_b64_tr_b16 v[136:137], v7 offset:2048
    ds_read_b64_tr_b16 v[138:139], v7 offset:3072
    ds_read_b64_tr_b16 v[140:141], v7 offset:2112
    ds_read_b64_tr_b16 v[142:143], v7 offset:3136
    s_waitcnt lgkmcnt(4)
    s_add_u32 m0, s32, 0
    s_add_u32 s38, s38, 16384
    buffer_load_dwordx4 v6, s[8:11], s38 offen lds
    s_add_u32 m0, s32, 1024
    s_add_u32 s38, s38, 16384
    buffer_load_dwordx4 v6, s[8:11], s38 offen lds
    s_waitcnt vmcnt(28)
    ds_read_b64_tr_b16 v[144:145], v7 offset:4096
    ds_read_b64_tr_b16 v[146:147], v7 offset:5120
    ds_read_b64_tr_b16 v[148:149], v7 offset:4160
    ds_read_b64_tr_b16 v[150:151], v7 offset:5184
    s_waitcnt lgkmcnt(4)
    s_add_u32 m0, s32, 2048
    s_add_u32 s38, s38, 16384
    buffer_load_dwordx4 v6, s[8:11], s38 offen lds
    s_add_u32 m0, s32, 3072
    s_add_u32 s38, s38, 16384
    buffer_load_dwordx4 v6, s[8:11], s38 offen lds
    s_waitcnt vmcnt(28)
    ds_read_b64_tr_b16 v[152:153], v7 offset:6144
    ds_read_b64_tr_b16 v[154:155], v7 offset:7168
    ds_read_b64_tr_b16 v[156:157], v7 offset:6208
    ds_read_b64_tr_b16 v[158:159], v7 offset:7232
    s_waitcnt lgkmcnt(4)
    s_add_u32 m0, s32, 4096
    s_add_u32 s38, s38, 16384
    buffer_load_dwordx4 v6, s[8:11], s38 offen lds
    s_add_u32 m0, s32, 5120
    s_add_u32 s38, s38, 16384
    buffer_load_dwordx4 v6, s[8:11], s38 offen lds
    s_waitcnt vmcnt(28)
    ds_read_b64_tr_b16 v[160:161], v7 offset:8192
    ds_read_b64_tr_b16 v[162:163], v7 offset:9216
    ds_read_b64_tr_b16 v[164:165], v7 offset:8256
    ds_read_b64_tr_b16 v[166:167], v7 offset:9280
    s_waitcnt lgkmcnt(4)
    s_add_u32 m0, s32, 6144
    s_add_u32 s38, s38, 16384
    buffer_load_dwordx4 v6, s[8:11], s38 offen lds
    s_add_u32 m0, s32, 7168
    s_add_u32 s38, s38, 16384
    buffer_load_dwordx4 v6, s[8:11], s38 offen lds
    s_waitcnt vmcnt(28)
    ds_read_b64_tr_b16 v[168:169], v7 offset:10240
    ds_read_b64_tr_b16 v[170:171], v7 offset:11264
    ds_read_b64_tr_b16 v[172:173], v7 offset:10304
    ds_read_b64_tr_b16 v[174:175], v7 offset:11328
    s_waitcnt lgkmcnt(4)
    s_add_u32 m0, s32, 8192
    s_add_u32 s38, s38, 16384
    buffer_load_dwordx4 v6, s[8:11], s38 offen lds
    s_add_u32 m0, s32, 9216
    s_add_u32 s38, s38, 16384
    buffer_load_dwordx4 v6, s[8:11], s38 offen lds
    s_waitcnt vmcnt(28)
    ds_read_b64_tr_b16 v[176:177], v7 offset:12288
    ds_read_b64_tr_b16 v[178:179], v7 offset:13312
    ds_read_b64_tr_b16 v[180:181], v7 offset:12352
    ds_read_b64_tr_b16 v[182:183], v7 offset:13376
    s_waitcnt lgkmcnt(4)
    s_add_u32 m0, s32, 10240
    s_add_u32 s38, s38, 16384
    buffer_load_dwordx4 v6, s[8:11], s38 offen lds
    s_add_u32 m0, s32, 11264
    s_add_u32 s38, s38, 16384
    buffer_load_dwordx4 v6, s[8:11], s38 offen lds
    s_waitcnt vmcnt(28)
    ds_read_b64_tr_b16 v[184:185], v7 offset:14336
    ds_read_b64_tr_b16 v[186:187], v7 offset:15360
    ds_read_b64_tr_b16 v[188:189], v7 offset:14400
    ds_read_b64_tr_b16 v[190:191], v7 offset:15424
    s_waitcnt lgkmcnt(4)
    s_add_u32 m0, s32, 12288
    s_add_u32 s38, s38, 16384
    buffer_load_dwordx4 v6, s[8:11], s38 offen lds
    s_add_u32 m0, s32, 13312
    s_add_u32 s38, s38, 16384
    buffer_load_dwordx4 v6, s[8:11], s38 offen lds
    s_waitcnt vmcnt(28)
    ds_read_b64_tr_b16 v[192:193], v7 offset:16384
    ds_read_b64_tr_b16 v[194:195], v7 offset:17408
    ds_read_b64_tr_b16 v[196:197], v7 offset:16448
    ds_read_b64_tr_b16 v[198:199], v7 offset:17472
    s_waitcnt lgkmcnt(4)
    s_add_u32 m0, s32, 14336
    s_add_u32 s38, s38, 16384
    buffer_load_dwordx4 v6, s[8:11], s38 offen lds
    s_add_u32 m0, s32, 15360
    s_add_u32 s38, s38, 16384
    buffer_load_dwordx4 v6, s[8:11], s38 offen lds
    s_waitcnt vmcnt(28)
    ds_read_b64_tr_b16 v[200:201], v7 offset:18432
    ds_read_b64_tr_b16 v[202:203], v7 offset:19456
    ds_read_b64_tr_b16 v[204:205], v7 offset:18496
    ds_read_b64_tr_b16 v[206:207], v7 offset:19520
    s_waitcnt lgkmcnt(4)
    s_add_u32 m0, s32, 16384
    s_add_u32 s38, s38, 16384
    buffer_load_dwordx4 v6, s[8:11], s38 offen lds
    s_add_u32 m0, s32, 17408
    s_add_u32 s38, s38, 16384
    buffer_load_dwordx4 v6, s[8:11], s38 offen lds
    s_waitcnt vmcnt(28)
    ds_read_b64_tr_b16 v[208:209], v7 offset:20480
    ds_read_b64_tr_b16 v[210:211], v7 offset:21504
    ds_read_b64_tr_b16 v[212:213], v7 offset:20544
    ds_read_b64_tr_b16 v[214:215], v7 offset:21568
    s_waitcnt lgkmcnt(4)
    s_add_u32 m0, s32, 18432
    s_add_u32 s38, s38, 16384
    buffer_load_dwordx4 v6, s[8:11], s38 offen lds
    s_add_u32 m0, s32, 19456
    s_add_u32 s38, s38, 16384
    buffer_load_dwordx4 v6, s[8:11], s38 offen lds
    s_waitcnt vmcnt(28)
    ds_read_b64_tr_b16 v[216:217], v7 offset:22528
    ds_read_b64_tr_b16 v[218:219], v7 offset:23552
    ds_read_b64_tr_b16 v[220:221], v7 offset:22592
    ds_read_b64_tr_b16 v[222:223], v7 offset:23616
    s_waitcnt lgkmcnt(4)
    s_add_u32 m0, s32, 20480
    s_add_u32 s38, s38, 16384
    buffer_load_dwordx4 v6, s[8:11], s38 offen lds
    s_add_u32 m0, s32, 21504
    s_add_u32 s38, s38, 16384
    buffer_load_dwordx4 v6, s[8:11], s38 offen lds
    s_waitcnt vmcnt(28)
    ds_read_b64_tr_b16 v[224:225], v7 offset:24576
    ds_read_b64_tr_b16 v[226:227], v7 offset:25600
    ds_read_b64_tr_b16 v[228:229], v7 offset:24640
    ds_read_b64_tr_b16 v[230:231], v7 offset:25664
    s_waitcnt lgkmcnt(4)
    s_add_u32 m0, s32, 22528
    s_add_u32 s38, s38, 16384
    buffer_load_dwordx4 v6, s[8:11], s38 offen lds
    s_add_u32 m0, s32, 23552
    s_add_u32 s38, s38, 16384
    buffer_load_dwordx4 v6, s[8:11], s38 offen lds
    s_waitcnt vmcnt(28)
    ds_read_b64_tr_b16 v[232:233], v7 offset:26624
    ds_read_b64_tr_b16 v[234:235], v7 offset:27648
    ds_read_b64_tr_b16 v[236:237], v7 offset:26688
    ds_read_b64_tr_b16 v[238:239], v7 offset:27712
    s_waitcnt lgkmcnt(4)
    s_add_u32 m0, s32, 24576
    s_add_u32 s38, s38, 16384
    buffer_load_dwordx4 v6, s[8:11], s38 offen lds
    s_add_u32 m0, s32, 25600
    s_add_u32 s38, s38, 16384
    buffer_load_dwordx4 v6, s[8:11], s38 offen lds
    s_waitcnt vmcnt(28)
    ds_read_b64_tr_b16 v[240:241], v7 offset:28672
    ds_read_b64_tr_b16 v[242:243], v7 offset:29696
    ds_read_b64_tr_b16 v[244:245], v7 offset:28736
    ds_read_b64_tr_b16 v[246:247], v7 offset:29760
    s_waitcnt lgkmcnt(4)
    s_add_u32 m0, s32, 26624
    s_add_u32 s38, s38, 16384
    buffer_load_dwordx4 v6, s[8:11], s38 offen lds
    s_add_u32 m0, s32, 27648
    s_add_u32 s38, s38, 16384
    buffer_load_dwordx4 v6, s[8:11], s38 offen lds
    s_waitcnt vmcnt(28)
    ds_read_b64_tr_b16 v[248:249], v7 offset:30720
    ds_read_b64_tr_b16 v[250:251], v7 offset:31744
    ds_read_b64_tr_b16 v[252:253], v7 offset:30784
    ds_read_b64_tr_b16 v[254:255], v7 offset:31808
    s_waitcnt lgkmcnt(4)
    s_add_u32 m0, s32, 28672
    s_add_u32 s38, s38, 16384
    buffer_load_dwordx4 v6, s[8:11], s38 offen lds
    s_add_u32 m0, s32, 29696
    s_add_u32 s38, s38, 16384
    buffer_load_dwordx4 v6, s[8:11], s38 offen lds
    s_waitcnt vmcnt(28)
    s_waitcnt lgkmcnt(0)
    s_add_u32 m0, s32, 30720
    s_add_u32 s38, s38, 16384
    buffer_load_dwordx4 v6, s[8:11], s38 offen lds
    s_add_u32 m0, s32, 31744
    s_add_u32 s38, s38, 16384
    buffer_load_dwordx4 v6, s[8:11], s38 offen lds
    s_waitcnt vmcnt(28)
    s_waitcnt vmcnt(26)
    s_waitcnt vmcnt(24)
    s_waitcnt vmcnt(22)
    s_waitcnt vmcnt(20)
    s_waitcnt vmcnt(18)
    s_waitcnt vmcnt(16)
    s_waitcnt vmcnt(14)
    s_waitcnt vmcnt(12)
    s_waitcnt vmcnt(10)
    s_waitcnt vmcnt(8)
    s_waitcnt vmcnt(6)
    s_waitcnt vmcnt(4)
    s_waitcnt vmcnt(2)
    s_waitcnt vmcnt(0)
    s_waitcnt lgkmcnt(0)
    s_lshl_b32 s31, s29, 16
    v_add_u32 v8, s31, v5
    s_lshl_b32 s31, s29, 13
    s_add_u32 s31, s31, 131072
    v_add_u32 v9, s31, v5
    s_lshl_b32 s31, s29, 7
    s_add_u32 s31, s31, 131072
    v_bfe_u32 v10, v1, 1, 2
    v_lshlrev_b32 v10, 10, v10
    v_and_b32 v4, 1, v1
    v_lshl_add_u32 v10, v4, 9, v10
    v_lshrrev_b32 v4, 3, v1
    v_lshl_add_u32 v10, v4, 4, v10
    v_add_u32 v10, s31, v10
    s_lshl_b32 s31, s29, 15
    s_lshl_b32 s33, s44, 7
    s_add_u32 s31, s31, s33
    v_lshrrev_b32 v11, 3, v1
    v_lshlrev_b32 v11, 12, v11
    v_and_b32 v4, 7, v1
    v_lshl_add_u32 v11, v4, 3, v11
    v_add_u32 v11, s31, v11
    v_and_b32 v12, 31, v1
    v_lshlrev_b32 v12, 7, v12
    v_add_u32 v12, 115343360, v12
    s_cmp_lg_u32 s29, 0
    s_cbranch_scc1 g_wdd_94
g_wd_93:
    s_load_dword s72, s[92:93], 0 glc
    s_add_u32 s41, s41, 1
    s_cmp_ge_u32 s41, 0x200000
    s_cbranch_scc1 g_wdd_94
    s_waitcnt lgkmcnt(0)
    s_and_b32 s72, s72, 1023
    s_cmp_ge_u32 s72, 256
    s_cbranch_scc1 g_wdd_94
    s_sleep 32
    s_branch g_wd_93
g_wdd_94:
    s_waitcnt lgkmcnt(0)
    s_barrier
o6_loop_95:
    s_lshl_b32 s47, s30, 18
    s_add_u32 s47, s47, 67108864
    s_and_b32 s52, s30, 63
    s_lshl_b32 s52, s52, 12
    s_add_u32 s52, s52, 32768
o6_w_97:
    buffer_load_dword v13, v12, s[4:7], s52 offen sc1
    s_add_u32 s41, s41, 1
    s_cmp_ge_u32 s41, 0x200000
    s_cbranch_scc1 o6_wd_98
    s_waitcnt vmcnt(0)
    v_cmp_eq_u32 vcc, 0, v13
    s_cbranch_vccz o6_wd_98
    s_sleep 10
    s_branch o6_w_97
o6_wd_98:
    s_add_u32 s31, s47, 0
    buffer_load_dwordx4 v[64:67], v8, s[4:7], s31 offen sc1
    s_add_u32 s31, s47, 1024
    buffer_load_dwordx4 v[68:71], v8, s[4:7], s31 offen sc1
    s_add_u32 s31, s47, 2048
    buffer_load_dwordx4 v[72:75], v8, s[4:7], s31 offen sc1
    s_add_u32 s31, s47, 49152
    buffer_load_dwordx4 v[76:79], v8, s[4:7], s31 offen sc1
    s_add_u32 s31, s47, 3072
    buffer_load_dwordx4 v[80:83], v8, s[4:7], s31 offen sc1
    s_add_u32 s31, s47, 4096
    buffer_load_dwordx4 v[84:87], v8, s[4:7], s31 offen sc1
    s_add_u32 s31, s47, 5120
    buffer_load_dwordx4 v[88:91], v8, s[4:7], s31 offen sc1
    s_add_u32 s31, s47, 50176
    buffer_load_dwordx4 v[92:95], v8, s[4:7], s31 offen sc1
    s_add_u32 s31, s47, 6144
    buffer_load_dwordx4 v[96:99], v8, s[4:7], s31 offen sc1
    s_add_u32 s31, s47, 7168
    buffer_load_dwordx4 v[100:103], v8, s[4:7], s31 offen sc1
    s_add_u32 s31, s47, 8192
    buffer_load_dwordx4 v[104:107], v8, s[4:7], s31 offen sc1
    s_add_u32 s31, s47, 51200
    buffer_load_dwordx4 v[108:111], v8, s[4:7], s31 offen sc1
    s_add_u32 s31, s47, 9216
    buffer_load_dwordx4 v[112:115], v8, s[4:7], s31 offen sc1
    s_add_u32 s31, s47, 10240
    buffer_load_dwordx4 v[116:119], v8, s[4:7], s31 offen sc1
    s_add_u32 s31, s47, 11264
    buffer_load_dwordx4 v[120:123], v8, s[4:7], s31 offen sc1
o6_go_96:
    s_lshl_b32 s49, s30, 17
    s_add_u32 s35, s30, 5
    s_and_b32 s52, s35, 63
    s_lshl_b32 s52, s52, 12
    s_add_u32 s52, s52, 32768
    ds_read_b64_tr_b16 v[16:17], v7 offset:0
    ds_read_b64_tr_b16 v[18:19], v7 offset:1024
    ds_read_b64_tr_b16 v[20:21], v7 offset:64
    ds_read_b64_tr_b16 v[22:23], v7 offset:1088
    s_waitcnt vmcnt(14)
    v_mfma_f32_32x32x16_bf16 v[32:47], a[0:3], v[64:67], 0
    s_add_u32 s31, s47, 52224
    buffer_load_dwordx4 v[124:127], v8, s[4:7], s31 offen sc1
    v_mfma_f32_32x32x16_bf16 v[48:63], a[4:7], v[64:67], 0
    s_waitcnt vmcnt(14)
    v_mfma_f32_32x32x16_bf16 v[32:47], a[8:11], v[68:71], v[32:47]
    s_add_u32 s31, s47, 12288
    buffer_load_dwordx4 v[64:67], v8, s[4:7], s31 offen sc1
    v_mfma_f32_32x32x16_bf16 v[48:63], a[12:15], v[68:71], v[48:63]
    s_waitcnt vmcnt(14)
    v_mfma_f32_32x32x16_bf16 v[32:47], a[16:19], v[72:75], v[32:47]
    s_add_u32 s31, s47, 13312
    buffer_load_dwordx4 v[68:71], v8, s[4:7], s31 offen sc1
    v_mfma_f32_32x32x16_bf16 v[48:63], a[20:23], v[72:75], v[48:63]
    s_waitcnt vmcnt(14)
    s_waitcnt lgkmcnt(0)
    v_mfma_f32_32x32x16_bf16 v[32:47], v[16:19], v[76:79], v[32:47]
    s_add_u32 s31, s47, 14336
    buffer_load_dwordx4 v[72:75], v8, s[4:7], s31 offen sc1
    v_mfma_f32_32x32x16_bf16 v[48:63], v[20:23], v[76:79], v[48:63]
    ds_read_b64_tr_b16 v[24:25], v7 offset:2048
    ds_read_b64_tr_b16 v[26:27], v7 offset:3072
    ds_read_b64_tr_b16 v[28:29], v7 offset:2112
    ds_read_b64_tr_b16 v[30:31], v7 offset:3136
    s_waitcnt vmcnt(14)
    v_mfma_f32_32x32x16_bf16 v[32:47], a[24:27], v[80:83], v[32:47]
    s_add_u32 s31, s47, 53248
    buffer_load_dwordx4 v[76:79], v8, s[4:7], s31 offen sc1
    v_mfma_f32_32x32x16_bf16 v[48:63], a[28:31], v[80:83], v[48:63]
    s_waitcnt vmcnt(14)
    v_mfma_f32_32x32x16_bf16 v[32:47], a[32:35], v[84:87], v[32:47]
    s_add_u32 s31, s47, 15360
    buffer_load_dwordx4 v[80:83], v8, s[4:7], s31 offen sc1
    v_mfma_f32_32x32x16_bf16 v[48:63], a[36:39], v[84:87], v[48:63]
    s_waitcnt vmcnt(14)
    v_mfma_f32_32x32x16_bf16 v[32:47], a[40:43], v[88:91], v[32:47]
    s_add_u32 s31, s47, 16384
    buffer_load_dwordx4 v[84:87], v8, s[4:7], s31 offen sc1
    v_mfma_f32_32x32x16_bf16 v[48:63], a[44:47], v[88:91], v[48:63]
    s_waitcnt vmcnt(14)
    s_waitcnt lgkmcnt(0)
    v_mfma_f32_32x32x16_bf16 v[32:47], v[24:27], v[92:95], v[32:47]
    s_add_u32 s31, s47, 17408
    buffer_load_dwordx4 v[88:91], v8, s[4:7], s31 offen sc1
    v_mfma_f32_32x32x16_bf16 v[48:63], v[28:31], v[92:95], v[48:63]
    ds_read_b64_tr_b16 v[16:17], v7 offset:4096
    ds_read_b64_tr_b16 v[18:19], v7 offset:5120
    ds_read_b64_tr_b16 v[20:21], v7 offset:4160
    ds_read_b64_tr_b16 v[22:23], v7 offset:5184
    s_waitcnt vmcnt(14)
    v_mfma_f32_32x32x16_bf16 v[32:47], a[48:51], v[96:99], v[32:47]
    s_add_u32 s31, s47, 54272
    buffer_load_dwordx4 v[92:95], v8, s[4:7], s31 offen sc1
    v_mfma_f32_32x32x16_bf16 v[48:63], a[52:55], v[96:99], v[48:63]
    s_waitcnt vmcnt(14)
    v_mfma_f32_32x32x16_bf16 v[32:47], a[56:59], v[100:103], v[32:47]
    s_add_u32 s31, s47, 18432
    buffer_load_dwordx4 v[96:99], v8, s[4:7], s31 offen sc1
    v_mfma_f32_32x32x16_bf16 v[48:63], a[60:63], v[100:103], v[48:63]
    s_waitcnt vmcnt(14)
    v_mfma_f32_32x32x16_bf16 v[32:47], a[64:67], v[104:107], v[32:47]
    s_add_u32 s31, s47, 19456
    buffer_load_dwordx4 v[100:103], v8, s[4:7], s31 offen sc1
    v_mfma_f32_32x32x16_bf16 v[48:63], a[68:71], v[104:107], v[48:63]
    s_waitcnt vmcnt(14)
    s_waitcnt lgkmcnt(0)
    v_mfma_f32_32x32x16_bf16 v[32:47], v[16:19], v[108:111], v[32:47]
    s_add_u32 s31, s47, 20480
    buffer_load_dwordx4 v[104:107], v8, s[4:7], s31 offen sc1
    v_mfma_f32_32x32x16_bf16 v[48:63], v[20:23], v[108:111], v[48:63]
    ds_read_b64_tr_b16 v[24:25], v7 offset:6144
    ds_read_b64_tr_b16 v[26:27], v7 offset:7168
    ds_read_b64_tr_b16 v[28:29], v7 offset:6208
    ds_read_b64_tr_b16 v[30:31], v7 offset:7232
    s_waitcnt vmcnt(14)
    v_mfma_f32_32x32x16_bf16 v[32:47], a[72:75], v[112:115], v[32:47]
    s_add_u32 s31, s47, 55296
    buffer_load_dwordx4 v[108:111], v8, s[4:7], s31 offen sc1
    v_mfma_f32_32x32x16_bf16 v[48:63], a[76:79], v[112:115], v[48:63]
    s_waitcnt vmcnt(14)
    v_mfma_f32_32x32x16_bf16 v[32:47], a[80:83], v[116:119], v[32:47]
    s_add_u32 s31, s47, 21504
    buffer_load_dwordx4 v[112:115], v8, s[4:7], s31 offen sc1
    v_mfma_f32_32x32x16_bf16 v[48:63], a[84:87], v[116:119], v[48:63]
    s_waitcnt vmcnt(14)
    v_mfma_f32_32x32x16_bf16 v[32:47], a[88:91], v[120:123], v[32:47]
    s_add_u32 s31, s47, 22528
    buffer_load_dwordx4 v[116:119], v8, s[4:7], s31 offen sc1
    v_mfma_f32_32x32x16_bf16 v[48:63], a[92:95], v[120:123], v[48:63]
    s_waitcnt vmcnt(14)
    s_waitcnt lgkmcnt(0)
    v_mfma_f32_32x32x16_bf16 v[32:47], v[24:27], v[124:127], v[32:47]
    s_add_u32 s31, s47, 23552
    buffer_load_dwordx4 v[120:123], v8, s[4:7], s31 offen sc1
    v_mfma_f32_32x32x16_bf16 v[48:63], v[28:31], v[124:127], v[48:63]
    ds_read_b64_tr_b16 v[16:17], v7 offset:8192
    ds_read_b64_tr_b16 v[18:19], v7 offset:9216
    ds_read_b64_tr_b16 v[20:21], v7 offset:8256
    ds_read_b64_tr_b16 v[22:23], v7 offset:9280
    s_waitcnt vmcnt(14)
    v_mfma_f32_32x32x16_bf16 v[32:47], a[96:99], v[64:67], v[32:47]
    s_add_u32 s31, s47, 56320
    buffer_load_dwordx4 v[124:127], v8, s[4:7], s31 offen sc1
    v_mfma_f32_32x32x16_bf16 v[48:63], a[100:103], v[64:67], v[48:63]
    s_waitcnt vmcnt(14)
    v_mfma_f32_32x32x16_bf16 v[32:47], a[104:107], v[68:71], v[32:47]
    s_add_u32 s31, s47, 24576
    buffer_load_dwordx4 v[64:67], v8, s[4:7], s31 offen sc1
    v_mfma_f32_32x32x16_bf16 v[48:63], a[108:111], v[68:71], v[48:63]
    s_waitcnt vmcnt(14)
    v_mfma_f32_32x32x16_bf16 v[32:47], a[112:115], v[72:75], v[32:47]
    s_add_u32 s31, s47, 25600
    buffer_load_dwordx4 v[68:71], v8, s[4:7], s31 offen sc1
    v_mfma_f32_32x32x16_bf16 v[48:63], a[116:119], v[72:75], v[48:63]
    s_waitcnt vmcnt(14)
    s_waitcnt lgkmcnt(0)
    v_mfma_f32_32x32x16_bf16 v[32:47], v[16:19], v[76:79], v[32:47]
    s_add_u32 s31, s47, 26624
    buffer_load_dwordx4 v[72:75], v8, s[4:7], s31 offen sc1
    v_mfma_f32_32x32x16_bf16 v[48:63], v[20:23], v[76:79], v[48:63]
    ds_read_b64_tr_b16 v[24:25], v7 offset:10240
    ds_read_b64_tr_b16 v[26:27], v7 offset:11264
    ds_read_b64_tr_b16 v[28:29], v7 offset:10304
    ds_read_b64_tr_b16 v[30:31], v7 offset:11328
    s_waitcnt vmcnt(14)
    v_mfma_f32_32x32x16_bf16 v[32:47], a[120:123], v[80:83], v[32:47]
    s_add_u32 s31, s47, 57344
    buffer_load_dwordx4 v[76:79], v8, s[4:7], s31 offen sc1
    v_mfma_f32_32x32x16_bf16 v[48:63], a[124:127], v[80:83], v[48:63]
    s_waitcnt vmcnt(14)
    v_mfma_f32_32x32x16_bf16 v[32:47], a[128:131], v[84:87], v[32:47]
    s_add_u32 s31, s47, 27648
    buffer_load_dwordx4 v[80:83], v8, s[4:7], s31 offen sc1
    v_mfma_f32_32x32x16_bf16 v[48:63], a[132:135], v[84:87], v[48:63]
    s_waitcnt vmcnt(14)
    v_mfma_f32_32x32x16_bf16 v[32:47], a[136:139], v[88:91], v[32:47]
    s_add_u32 s31, s47, 28672
    buffer_load_dwordx4 v[84:87], v8, s[4:7], s31 offen sc1
    v_mfma_f32_32x32x16_bf16 v[48:63], a[140:143], v[88:91], v[48:63]
    s_waitcnt vmcnt(14)
    s_waitcnt lgkmcnt(0)
    v_mfma_f32_32x32x16_bf16 v[32:47], v[24:27], v[92:95], v[32:47]
    s_add_u32 s31, s47, 29696
    buffer_load_dwordx4 v[88:91], v8, s[4:7], s31 offen sc1
    v_mfma_f32_32x32x16_bf16 v[48:63], v[28:31], v[92:95], v[48:63]
    ds_read_b64_tr_b16 v[16:17], v7 offset:12288
    ds_read_b64_tr_b16 v[18:19], v7 offset:13312
    ds_read_b64_tr_b16 v[20:21], v7 offset:12352
    ds_read_b64_tr_b16 v[22:23], v7 offset:13376
    s_waitcnt vmcnt(14)
    v_mfma_f32_32x32x16_bf16 v[32:47], a[144:147], v[96:99], v[32:47]
    s_add_u32 s31, s47, 58368
    buffer_load_dwordx4 v[92:95], v8, s[4:7], s31 offen sc1
    buffer_load_dword v13, v12, s[4:7], s52 offen sc1
    v_mfma_f32_32x32x16_bf16 v[48:63], a[148:151], v[96:99], v[48:63]
    s_waitcnt vmcnt(15)
    v_mfma_f32_32x32x16_bf16 v[32:47], a[152:155], v[100:103], v[32:47]
    s_add_u32 s31, s47, 30720
    buffer_load_dwordx4 v[96:99], v8, s[4:7], s31 offen sc1
    v_mfma_f32_32x32x16_bf16 v[48:63], a[156:159], v[100:103], v[48:63]
    s_waitcnt vmcnt(15)
    v_mfma_f32_32x32x16_bf16 v[32:47], a[160:163], v[104:107], v[32:47]
    s_add_u32 s31, s47, 31744
    buffer_load_dwordx4 v[100:103], v8, s[4:7], s31 offen sc1
    v_mfma_f32_32x32x16_bf16 v[48:63], a[164:167], v[104:107], v[48:63]
    s_waitcnt vmcnt(15)
    s_waitcnt lgkmcnt(0)
    v_mfma_f32_32x32x16_bf16 v[32:47], v[16:19], v[108:111], v[32:47]
    s_add_u32 s31, s47, 32768
    buffer_load_dwordx4 v[104:107], v8, s[4:7], s31 offen sc1
    v_mfma_f32_32x32x16_bf16 v[48:63], v[20:23], v[108:111], v[48:63]
    ds_read_b64_tr_b16 v[24:25], v7 offset:14336
    ds_read_b64_tr_b16 v[26:27], v7 offset:15360
    ds_read_b64_tr_b16 v[28:29], v7 offset:14400
    ds_read_b64_tr_b16 v[30:31], v7 offset:15424
    s_waitcnt vmcnt(15)
    v_mfma_f32_32x32x16_bf16 v[32:47], a[168:171], v[112:115], v[32:47]
    s_add_u32 s31, s47, 59392
    buffer_load_dwordx4 v[108:111], v8, s[4:7], s31 offen sc1
    v_mfma_f32_32x32x16_bf16 v[48:63], a[172:175], v[112:115], v[48:63]
    s_waitcnt vmcnt(15)
    v_mfma_f32_32x32x16_bf16 v[32:47], a[176:179], v[116:119], v[32:47]
    s_add_u32 s31, s47, 33792
    buffer_load_dwordx4 v[112:115], v8, s[4:7], s31 offen sc1
    v_mfma_f32_32x32x16_bf16 v[48:63], a[180:183], v[116:119], v[48:63]
    s_waitcnt vmcnt(15)
    v_mfma_f32_32x32x16_bf16 v[32:47], a[184:187], v[120:123], v[32:47]
    s_add_u32 s31, s47, 34816
    buffer_load_dwordx4 v[116:119], v8, s[4:7], s31 offen sc1
    v_mfma_f32_32x32x16_bf16 v[48:63], a[188:191], v[120:123], v[48:63]
    s_waitcnt vmcnt(15)
    s_waitcnt lgkmcnt(0)
    v_mfma_f32_32x32x16_bf16 v[32:47], v[24:27], v[124:127], v[32:47]
    s_add_u32 s31, s47, 35840
    buffer_load_dwordx4 v[120:123], v8, s[4:7], s31 offen sc1
    v_mfma_f32_32x32x16_bf16 v[48:63], v[28:31], v[124:127], v[48:63]
    ds_read_b64_tr_b16 v[16:17], v7 offset:16384
    ds_read_b64_tr_b16 v[18:19], v7 offset:17408
    ds_read_b64_tr_b16 v[20:21], v7 offset:16448
    ds_read_b64_tr_b16 v[22:23], v7 offset:17472
    s_waitcnt vmcnt(15)
    v_mfma_f32_32x32x16_bf16 v[32:47], a[192:195], v[64:67], v[32:47]
    s_add_u32 s31, s47, 60416
    buffer_load_dwordx4 v[124:127], v8, s[4:7], s31 offen sc1
    v_mfma_f32_32x32x16_bf16 v[48:63], a[196:199], v[64:67], v[48:63]
    s_waitcnt vmcnt(15)
    v_mfma_f32_32x32x16_bf16 v[32:47], a[200:203], v[68:71], v[32:47]
    s_add_u32 s31, s47, 36864
    buffer_load_dwordx4 v[64:67], v8, s[4:7], s31 offen sc1
    v_mfma_f32_32x32x16_bf16 v[48:63], a[204:207], v[68:71], v[48:63]
    s_waitcnt vmcnt(15)
    v_mfma_f32_32x32x16_bf16 v[32:47], a[208:211], v[72:75], v[32:47]
    s_add_u32 s31, s47, 37888
    buffer_load_dwordx4 v[68:71], v8, s[4:7], s31 offen sc1
    v_mfma_f32_32x32x16_bf16 v[48:63], a[212:215], v[72:75], v[48:63]
    s_waitcnt vmcnt(15)
    s_waitcnt lgkmcnt(0)
    v_mfma_f32_32x32x16_bf16 v[32:47], v[16:19], v[76:79], v[32:47]
    s_add_u32 s31, s47, 38912
    buffer_load_dwordx4 v[72:75], v8, s[4:7], s31 offen sc1
    v_mfma_f32_32x32x16_bf16 v[48:63], v[20:23], v[76:79], v[48:63]
    ds_read_b64_tr_b16 v[24:25], v7 offset:18432
    ds_read_b64_tr_b16 v[26:27], v7 offset:19456
    ds_read_b64_tr_b16 v[28:29], v7 offset:18496
    ds_read_b64_tr_b16 v[30:31], v7 offset:19520
    s_waitcnt vmcnt(15)
    v_mfma_f32_32x32x16_bf16 v[32:47], a[216:219], v[80:83], v[32:47]
    s_add_u32 s31, s47, 61440
    buffer_load_dwordx4 v[76:79], v8, s[4:7], s31 offen sc1
    v_mfma_f32_32x32x16_bf16 v[48:63], a[220:223], v[80:83], v[48:63]
    s_waitcnt vmcnt(15)
    v_mfma_f32_32x32x16_bf16 v[32:47], a[224:227], v[84:87], v[32:47]
    s_add_u32 s31, s47, 39936
    buffer_load_dwordx4 v[80:83], v8, s[4:7], s31 offen sc1
    v_mfma_f32_32x32x16_bf16 v[48:63], a[228:231], v[84:87], v[48:63]
    s_waitcnt vmcnt(15)
    v_mfma_f32_32x32x16_bf16 v[32:47], a[232:235], v[88:91], v[32:47]
    s_add_u32 s31, s47, 40960
    buffer_load_dwordx4 v[84:87], v8, s[4:7], s31 offen sc1
    v_mfma_f32_32x32x16_bf16 v[48:63], a[236:239], v[88:91], v[48:63]
    s_waitcnt vmcnt(15)
    s_waitcnt lgkmcnt(0)
    v_mfma_f32_32x32x16_bf16 v[32:47], v[24:27], v[92:95], v[32:47]
    s_add_u32 s31, s47, 41984
    buffer_load_dwordx4 v[88:91], v8, s[4:7], s31 offen sc1
    v_mfma_f32_32x32x16_bf16 v[48:63], v[28:31], v[92:95], v[48:63]
    ds_read_b64_tr_b16 v[16:17], v7 offset:20480
    ds_read_b64_tr_b16 v[18:19], v7 offset:21504
    ds_read_b64_tr_b16 v[20:21], v7 offset:20544
    ds_read_b64_tr_b16 v[22:23], v7 offset:21568
    s_waitcnt vmcnt(14)
    v_mfma_f32_32x32x16_bf16 v[32:47], a[240:243], v[96:99], v[32:47]
    s_add_u32 s31, s47, 62464
    buffer_load_dwordx4 v[92:95], v8, s[4:7], s31 offen sc1
    v_mfma_f32_32x32x16_bf16 v[48:63], a[244:247], v[96:99], v[48:63]
    s_waitcnt vmcnt(14)
    v_mfma_f32_32x32x16_bf16 v[32:47], a[248:251], v[100:103], v[32:47]
    s_add_u32 s31, s47, 43008
    buffer_load_dwordx4 v[96:99], v8, s[4:7], s31 offen sc1
    v_mfma_f32_32x32x16_bf16 v[48:63], a[252:255], v[100:103], v[48:63]
    s_waitcnt vmcnt(14)
    v_mfma_f32_32x32x16_bf16 v[32:47], v[128:131], v[104:107], v[32:47]
    s_add_u32 s31, s47, 44032
    buffer_load_dwordx4 v[100:103], v8, s[4:7], s31 offen sc1
    v_mfma_f32_32x32x16_bf16 v[48:63], v[132:135], v[104:107], v[48:63]
    s_waitcnt vmcnt(14)
    s_waitcnt lgkmcnt(0)
    v_mfma_f32_32x32x16_bf16 v[32:47], v[16:19], v[108:111], v[32:47]
    s_add_u32 s31, s47, 45056
    buffer_load_dwordx4 v[104:107], v8, s[4:7], s31 offen sc1
    v_mfma_f32_32x32x16_bf16 v[48:63], v[20:23], v[108:111], v[48:63]
    ds_read_b64_tr_b16 v[24:25], v7 offset:22528
    ds_read_b64_tr_b16 v[26:27], v7 offset:23552
    ds_read_b64_tr_b16 v[28:29], v7 offset:22592
    ds_read_b64_tr_b16 v[30:31], v7 offset:23616
    s_waitcnt vmcnt(14)
    v_mfma_f32_32x32x16_bf16 v[32:47], v[136:139], v[112:115], v[32:47]
    s_add_u32 s31, s47, 63488
    buffer_load_dwordx4 v[108:111], v8, s[4:7], s31 offen sc1
    v_mfma_f32_32x32x16_bf16 v[48:63], v[140:143], v[112:115], v[48:63]
    s_waitcnt vmcnt(14)
    v_mfma_f32_32x32x16_bf16 v[32:47], v[144:147], v[116:119], v[32:47]
    s_add_u32 s31, s47, 46080
    buffer_load_dwordx4 v[112:115], v8, s[4:7], s31 offen sc1
    v_mfma_f32_32x32x16_bf16 v[48:63], v[148:151], v[116:119], v[48:63]
    s_waitcnt vmcnt(14)
    v_mfma_f32_32x32x16_bf16 v[32:47], v[152:155], v[120:123], v[32:47]
    s_add_u32 s31, s47, 47104
    buffer_load_dwordx4 v[116:119], v8, s[4:7], s31 offen sc1
    v_mfma_f32_32x32x16_bf16 v[48:63], v[156:159], v[120:123], v[48:63]
    s_waitcnt vmcnt(14)
    s_waitcnt lgkmcnt(0)
    v_mfma_f32_32x32x16_bf16 v[32:47], v[24:27], v[124:127], v[32:47]
    s_add_u32 s31, s47, 48128
    buffer_load_dwordx4 v[120:123], v8, s[4:7], s31 offen sc1
    v_mfma_f32_32x32x16_bf16 v[48:63], v[28:31], v[124:127], v[48:63]
    ds_read_b64_tr_b16 v[16:17], v7 offset:24576
    ds_read_b64_tr_b16 v[18:19], v7 offset:25600
    ds_read_b64_tr_b16 v[20:21], v7 offset:24640
    ds_read_b64_tr_b16 v[22:23], v7 offset:25664
    s_waitcnt vmcnt(14)
    v_mfma_f32_32x32x16_bf16 v[32:47], v[160:163], v[64:67], v[32:47]
    s_add_u32 s31, s47, 64512
    buffer_load_dwordx4 v[124:127], v8, s[4:7], s31 offen sc1
    v_mfma_f32_32x32x16_bf16 v[48:63], v[164:167], v[64:67], v[48:63]
    s_waitcnt vmcnt(14)
    v_mfma_f32_32x32x16_bf16 v[32:47], v[168:171], v[68:71], v[32:47]
    v_cmp_eq_u32 vcc, 0, v13
    s_lshl_b32 s46, s35, 18
    s_add_u32 s46, s46, 67108864
    s_cmp_eq_u64 vcc, 0
    s_cselect_b32 s51, 1, 0
    s_cmp_ge_u32 s35, 64
    s_cselect_b32 s51, 0, s51
    s_cmp_eq_u32 s51, 0
    s_cselect_b32 s46, s47, s46
    s_add_u32 s31, s46, 0
    buffer_load_dwordx4 v[64:67], v8, s[4:7], s31 offen sc1
    v_mfma_f32_32x32x16_bf16 v[48:63], v[172:175], v[68:71], v[48:63]
    s_waitcnt vmcnt(14)
    v_mfma_f32_32x32x16_bf16 v[32:47], v[176:179], v[72:75], v[32:47]
    s_add_u32 s31, s46, 1024
    buffer_load_dwordx4 v[68:71], v8, s[4:7], s31 offen sc1
    v_mfma_f32_32x32x16_bf16 v[48:63], v[180:183], v[72:75], v[48:63]
    s_waitcnt vmcnt(14)
    s_waitcnt lgkmcnt(0)
    v_mfma_f32_32x32x16_bf16 v[32:47], v[16:19], v[76:79], v[32:47]
    s_add_u32 s31, s46, 2048
    buffer_load_dwordx4 v[72:75], v8, s[4:7], s31 offen sc1
    v_mfma_f32_32x32x16_bf16 v[48:63], v[20:23], v[76:79], v[48:63]
    ds_read_b64_tr_b16 v[24:25], v7 offset:26624
    ds_read_b64_tr_b16 v[26:27], v7 offset:27648
    ds_read_b64_tr_b16 v[28:29], v7 offset:26688
    ds_read_b64_tr_b16 v[30:31], v7 offset:27712
    s_waitcnt vmcnt(14)
    v_mfma_f32_32x32x16_bf16 v[32:47], v[184:187], v[80:83], v[32:47]
    s_add_u32 s31, s46, 49152
    buffer_load_dwordx4 v[76:79], v8, s[4:7], s31 offen sc1
    v_mfma_f32_32x32x16_bf16 v[48:63], v[188:191], v[80:83], v[48:63]
    s_waitcnt vmcnt(14)
    v_mfma_f32_32x32x16_bf16 v[32:47], v[192:195], v[84:87], v[32:47]
    s_add_u32 s31, s46, 3072
    buffer_load_dwordx4 v[80:83], v8, s[4:7], s31 offen sc1
    v_mfma_f32_32x32x16_bf16 v[48:63], v[196:199], v[84:87], v[48:63]
    s_waitcnt vmcnt(14)
    v_mfma_f32_32x32x16_bf16 v[32:47], v[200:203], v[88:91], v[32:47]
    s_add_u32 s31, s46, 4096
    buffer_load_dwordx4 v[84:87], v8, s[4:7], s31 offen sc1
    v_mfma_f32_32x32x16_bf16 v[48:63], v[204:207], v[88:91], v[48:63]
    s_waitcnt vmcnt(14)
    s_waitcnt lgkmcnt(0)
    v_mfma_f32_32x32x16_bf16 v[32:47], v[24:27], v[92:95], v[32:47]
    s_add_u32 s31, s46, 5120
    buffer_load_dwordx4 v[88:91], v8, s[4:7], s31 offen sc1
    v_mfma_f32_32x32x16_bf16 v[48:63], v[28:31], v[92:95], v[48:63]
    ds_read_b64_tr_b16 v[16:17], v7 offset:28672
    ds_read_b64_tr_b16 v[18:19], v7 offset:29696
    ds_read_b64_tr_b16 v[20:21], v7 offset:28736
    ds_read_b64_tr_b16 v[22:23], v7 offset:29760
    s_waitcnt vmcnt(14)
    v_mfma_f32_32x32x16_bf16 v[32:47], v[208:211], v[96:99], v[32:47]
    s_add_u32 s31, s46, 50176
    buffer_load_dwordx4 v[92:95], v8, s[4:7], s31 offen sc1
    v_mfma_f32_32x32x16_bf16 v[48:63], v[212:215], v[96:99], v[48:63]
    s_waitcnt vmcnt(14)
    v_mfma_f32_32x32x16_bf16 v[32:47], v[216:219], v[100:103], v[32:47]
    s_add_u32 s31, s46, 6144
    buffer_load_dwordx4 v[96:99], v8, s[4:7], s31 offen sc1
    v_mfma_f32_32x32x16_bf16 v[48:63], v[220:223], v[100:103], v[48:63]
    s_waitcnt vmcnt(14)
    v_mfma_f32_32x32x16_bf16 v[32:47], v[224:227], v[104:107], v[32:47]
    s_add_u32 s31, s46, 7168
    buffer_load_dwordx4 v[100:103], v8, s[4:7], s31 offen sc1
    v_mfma_f32_32x32x16_bf16 v[48:63], v[228:231], v[104:107], v[48:63]
    s_waitcnt vmcnt(14)
    s_waitcnt lgkmcnt(0)
    v_mfma_f32_32x32x16_bf16 v[32:47], v[16:19], v[108:111], v[32:47]
    s_add_u32 s31, s46, 8192
    buffer_load_dwordx4 v[104:107], v8, s[4:7], s31 offen sc1
    v_mfma_f32_32x32x16_bf16 v[48:63], v[20:23], v[108:111], v[48:63]
    ds_read_b64_tr_b16 v[24:25], v7 offset:30720
    ds_read_b64_tr_b16 v[26:27], v7 offset:31744
    ds_read_b64_tr_b16 v[28:29], v7 offset:30784
    ds_read_b64_tr_b16 v[30:31], v7 offset:31808
    s_waitcnt vmcnt(14)
    v_mfma_f32_32x32x16_bf16 v[32:47], v[232:235], v[112:115], v[32:47]
    s_add_u32 s31, s46, 51200
    buffer_load_dwordx4 v[108:111], v8, s[4:7], s31 offen sc1
    v_mfma_f32_32x32x16_bf16 v[48:63], v[236:239], v[112:115], v[48:63]
    s_waitcnt vmcnt(14)
    v_mfma_f32_32x32x16_bf16 v[32:47], v[240:243], v[116:119], v[32:47]
    s_add_u32 s31, s46, 9216
    buffer_load_dwordx4 v[112:115], v8, s[4:7], s31 offen sc1
    v_mfma_f32_32x32x16_bf16 v[48:63], v[244:247], v[116:119], v[48:63]
    s_waitcnt vmcnt(14)
    v_mfma_f32_32x32x16_bf16 v[32:47], v[248:251], v[120:123], v[32:47]
    s_add_u32 s31, s46, 10240
    buffer_load_dwordx4 v[116:119], v8, s[4:7], s31 offen sc1
    v_mfma_f32_32x32x16_bf16 v[48:63], v[252:255], v[120:123], v[48:63]
    s_waitcnt vmcnt(14)
    s_waitcnt lgkmcnt(0)
    v_mfma_f32_32x32x16_bf16 v[32:47], v[24:27], v[124:127], v[32:47]
    s_add_u32 s31, s46, 11264
    buffer_load_dwordx4 v[120:123], v8, s[4:7], s31 offen sc1
    v_mfma_f32_32x32x16_bf16 v[48:63], v[28:31], v[124:127], v[48:63]
    s_barrier
    s_nop 7
    ds_write_b128 v9, v[32:35] offset:0
    ds_write_b128 v9, v[36:39] offset:1024
    ds_write_b128 v9, v[40:43] offset:2048
    ds_write_b128 v9, v[44:47] offset:3072
    ds_write_b128 v9, v[48:51] offset:4096
    ds_write_b128 v9, v[52:55] offset:5120
    ds_write_b128 v9, v[56:59] offset:6144
    ds_write_b128 v9, v[60:63] offset:7168
    s_waitcnt lgkmcnt(0)
    s_barrier
    ds_read_b128 v[32:35], v10 offset:0
    ds_read_b128 v[36:39], v10 offset:8192
    ds_read_b128 v[40:43], v10 offset:16384
    ds_read_b128 v[44:47], v10 offset:24576
    ds_read_b128 v[48:51], v10 offset:4096
    ds_read_b128 v[52:55], v10 offset:12288
    ds_read_b128 v[56:59], v10 offset:20480
    ds_read_b128 v[60:63], v10 offset:28672
    s_waitcnt lgkmcnt(4)
    v_pk_add_f32 v[32:33], v[32:33], v[36:37]
    v_pk_add_f32 v[34:35], v[34:35], v[38:39]
    v_pk_add_f32 v[40:41], v[40:41], v[44:45]
    v_pk_add_f32 v[42:43], v[42:43], v[46:47]
    v_pk_add_f32 v[32:33], v[32:33], v[40:41]
    v_pk_add_f32 v[34:35], v[34:35], v[42:43]
    v_cvt_pk_bf16_f32 v24, v32, v33
    v_cvt_pk_bf16_f32 v25, v34, v35
    buffer_store_dwordx2 v[24:25], v11, s[20:23], s49 offen offset:0
    s_waitcnt lgkmcnt(0)
    v_pk_add_f32 v[48:49], v[48:49], v[52:53]
    v_pk_add_f32 v[50:51], v[50:51], v[54:55]
    v_pk_add_f32 v[56:57], v[56:57], v[60:61]
    v_pk_add_f32 v[58:59], v[58:59], v[62:63]
    v_pk_add_f32 v[48:49], v[48:49], v[56:57]
    v_pk_add_f32 v[50:51], v[50:51], v[58:59]
    v_cvt_pk_bf16_f32 v26, v48, v49
    v_cvt_pk_bf16_f32 v27, v50, v51
    buffer_store_dwordx2 v[26:27], v11, s[20:23], s49 offen offset:64
    s_mov_b32 s30, s35
    s_mov_b32 s47, s46
    s_cmp_lg_u32 s51, 0
    s_cbranch_scc1 o6_go_96
    s_cmp_lt_u32 s30, 64
    s_cbranch_scc1 o6_loop_95
    s_branch L_dump
L_ob:
    s_load_dwordx4 s[72:75], s[0:1], 72
    s_add_u32 s76, s90, 83886080
    s_addc_u32 s77, s91, 0
    s_sub_u32 s32, s28, 96
    s_lshr_b32 s32, s32, 3
    s_mul_i32 s30, s32, 22
    s_add_u32 s51, s30, 22
    s_min_u32 s51, s51, 64
    s_sub_u32 s52, s51, 1
    s_lshl_b32 s52, s52, 16
    s_waitcnt lgkmcnt(0)
    s_mov_b32 s8, s72
    s_and_b32 s9, s73, 0xffff
    s_mov_b32 s10, 2097152
    s_mov_b32 s11, 0x00020000
    s_mov_b32 s20, s74
    s_and_b32 s21, s75, 0xffff
    s_mov_b32 s22, 8388608
    s_mov_b32 s23, 0x00020000
    s_mov_b32 s12, s76
    s_and_b32 s13, s77, 0xffff
    s_mov_b32 s14, 4194304
    s_mov_b32 s15, 0x00020000
    s_and_b32 s31, s28, 7
    s_lshl_b32 s31, s31, 8
    s_lshl_b32 s33, s29, 6
    s_add_u32 s31, s31, s33
    v_lshrrev_b32 v6, 2, v1
    v_lshlrev_b32 v6, 11, v6
    v_and_b32 v4, 3, v1
    v_lshl_add_u32 v6, v4, 4, v6
    v_add_u32 v6, s31, v6
    s_mov_b32 s39, 32768
    s_lshl_b32 s36, s30, 17
    s_and_b32 s33, s28, 7
    s_lshl_b32 s33, s33, 8
    s_add_u32 s36, s36, s33
    s_add_u32 s36, s36, 2048
    s_mov_b32 s37, 131072
    s_lshl_b32 s31, s29, 15
    v_lshrrev_b32 v7, 4, v1
    v_lshlrev_b32 v7, 9, v7
    v_bfe_u32 v4, v1, 2, 2
    v_lshl_add_u32 v7, v4, 6, v7
    v_and_b32 v4, 3, v1
    v_lshl_add_u32 v7, v4, 4, v7
    v_add_u32 v7, s31, v7
    s_lshl_b32 s32, s29, 15
    s_add_u32 m0, s32, 0
    s_mov_b32 s38, 0
    buffer_load_dwordx4 v6, s[8:11], s38 offen lds
    s_add_u32 m0, s32, 1024
    s_add_u32 s38, s38, s39
    buffer_load_dwordx4 v6, s[8:11], s38 offen lds
    s_add_u32 m0, s32, 2048
    s_add_u32 s38, s38, s39
    buffer_load_dwordx4 v6, s[8:11], s38 offen lds
    s_add_u32 m0, s32, 3072
    s_add_u32 s38, s38, s39
    buffer_load_dwordx4 v6, s[8:11], s38 offen lds
    s_add_u32 m0, s32, 4096
    s_add_u32 s38, s38, s39
    buffer_load_dwordx4 v6, s[8:11], s38 offen lds
    s_add_u32 m0, s32, 5120
    s_add_u32 s38, s38, s39
    buffer_load_dwordx4 v6, s[8:11], s38 offen lds
    s_add_u32 m0, s32, 6144
    s_add_u32 s38, s38, s39
    buffer_load_dwordx4 v6, s[8:11], s38 offen lds
    s_add_u32 m0, s32, 7168
    s_add_u32 s38, s38, s39
    buffer_load_dwordx4 v6, s[8:11], s38 offen lds
    s_add_u32 m0, s32, 8192
    s_add_u32 s38, s38, s39
    buffer_load_dwordx4 v6, s[8:11], s38 offen lds
    s_add_u32 m0, s32, 9216
    s_add_u32 s38, s38, s39
    buffer_load_dwordx4 v6, s[8:11], s38 offen lds
    s_add_u32 m0, s32, 10240
    s_add_u32 s38, s38, s39
    buffer_load_dwordx4 v6, s[8:11], s38 offen lds
    s_add_u32 m0, s32, 11264
    s_add_u32 s38, s38, s39
    buffer_load_dwordx4 v6, s[8:11], s38 offen lds
    s_add_u32 m0, s32, 12288
    s_add_u32 s38, s38, s39
    buffer_load_dwordx4 v6, s[8:11], s38 offen lds
    s_add_u32 m0, s32, 13312
    s_add_u32 s38, s38, s39
    buffer_load_dwordx4 v6, s[8:11], s38 offen lds
    s_add_u32 m0, s32, 14336
    s_add_u32 s38, s38, s39
    buffer_load_dwordx4 v6, s[8:11], s38 offen lds
    s_add_u32 m0, s32, 15360
    s_add_u32 s38, s38, s39
    buffer_load_dwordx4 v6, s[8:11], s38 offen lds
    s_add_u32 m0, s32, 16384
    s_add_u32 s38, s38, s39
    buffer_load_dwordx4 v6, s[8:11], s38 offen lds
    s_add_u32 m0, s32, 17408
    s_add_u32 s38, s38, s39
    buffer_load_dwordx4 v6, s[8:11], s38 offen lds
    s_add_u32 m0, s32, 18432
    s_add_u32 s38, s38, s39
    buffer_load_dwordx4 v6, s[8:11], s38 offen lds
    s_add_u32 m0, s32, 19456
    s_add_u32 s38, s38, s39
    buffer_load_dwordx4 v6, s[8:11], s38 offen lds
    s_add_u32 m0, s32, 20480
    s_add_u32 s38, s38, s39
    buffer_load_dwordx4 v6, s[8:11], s38 offen lds
    s_add_u32 m0, s32, 21504
    s_add_u32 s38, s38, s39
    buffer_load_dwordx4 v6, s[8:11], s38 offen lds
    s_add_u32 m0, s32, 22528
    s_add_u32 s38, s38, s39
    buffer_load_dwordx4 v6, s[8:11], s38 offen lds
    s_add_u32 m0, s32, 23552
    s_add_u32 s38, s38, s39
    buffer_load_dwordx4 v6, s[8:11], s38 offen lds
    s_add_u32 m0, s32, 24576
    s_add_u32 s38, s38, s39
    buffer_load_dwordx4 v6, s[8:11], s38 offen lds
    s_add_u32 m0, s32, 25600
    s_add_u32 s38, s38, s39
    buffer_load_dwordx4 v6, s[8:11], s38 offen lds
    s_add_u32 m0, s32, 26624
    s_add_u32 s38, s38, s39
    buffer_load_dwordx4 v6, s[8:11], s38 offen lds
    s_add_u32 m0, s32, 27648
    s_add_u32 s38, s38, s39
    buffer_load_dwordx4 v6, s[8:11], s38 offen lds
    s_add_u32 m0, s32, 28672
    s_add_u32 s38, s38, s39
    buffer_load_dwordx4 v6, s[8:11], s38 offen lds
    s_add_u32 m0, s32, 29696
    s_add_u32 s38, s38, s39
    buffer_load_dwordx4 v6, s[8:11], s38 offen lds
    s_add_u32 m0, s32, 30720
    s_add_u32 s38, s38, s39
    buffer_load_dwordx4 v6, s[8:11], s38 offen lds
    s_add_u32 m0, s32, 31744
    s_add_u32 s38, s38, s39
    buffer_load_dwordx4 v6, s[8:11], s38 offen lds
    s_waitcnt vmcnt(30)
    ds_read_b64_tr_b16 a[0:1], v7 offset:0
    ds_read_b64_tr_b16 a[2:3], v7 offset:256
    ds_read_b64_tr_b16 a[4:5], v7 offset:8
    ds_read_b64_tr_b16 a[6:7], v7 offset:264
    s_waitcnt vmcnt(28)
    ds_read_b64_tr_b16 a[8:9], v7 offset:2048
    ds_read_b64_tr_b16 a[10:11], v7 offset:2304
    ds_read_b64_tr_b16 a[12:13], v7 offset:2056
    ds_read_b64_tr_b16 a[14:15], v7 offset:2312
    s_waitcnt lgkmcnt(4)
    s_add_u32 m0, s32, 0
    s_add_u32 s38, s38, s39
    buffer_load_dwordx4 v6, s[8:11], s38 offen lds
    s_add_u32 m0, s32, 1024
    s_add_u32 s38, s38, s39
    buffer_load_dwordx4 v6, s[8:11], s38 offen lds
    s_waitcnt vmcnt(28)
    ds_read_b64_tr_b16 a[16:17], v7 offset:4096
    ds_read_b64_tr_b16 a[18:19], v7 offset:4352
    ds_read_b64_tr_b16 a[20:21], v7 offset:4104
    ds_read_b64_tr_b16 a[22:23], v7 offset:4360
    s_waitcnt lgkmcnt(4)
    s_add_u32 m0, s32, 2048
    s_add_u32 s38, s38, s39
    buffer_load_dwordx4 v6, s[8:11], s38 offen lds
    s_add_u32 m0, s32, 3072
    s_add_u32 s38, s38, s39
    buffer_load_dwordx4 v6, s[8:11], s38 offen lds
    s_waitcnt vmcnt(28)
    ds_read_b64_tr_b16 a[24:25], v7 offset:6144
    ds_read_b64_tr_b16 a[26:27], v7 offset:6400
    ds_read_b64_tr_b16 a[28:29], v7 offset:6152
    ds_read_b64_tr_b16 a[30:31], v7 offset:6408
    s_waitcnt lgkmcnt(4)
    s_add_u32 m0, s32, 4096
    s_add_u32 s38, s38, s39
    buffer_load_dwordx4 v6, s[8:11], s38 offen lds
    s_add_u32 m0, s32, 5120
    s_add_u32 s38, s38, s39
    buffer_load_dwordx4 v6, s[8:11], s38 offen lds
    s_waitcnt vmcnt(28)
    ds_read_b64_tr_b16 a[32:33], v7 offset:8192
    ds_read_b64_tr_b16 a[34:35], v7 offset:8448
    ds_read_b64_tr_b16 a[36:37], v7 offset:8200
    ds_read_b64_tr_b16 a[38:39], v7 offset:8456
    s_waitcnt lgkmcnt(4)
    s_add_u32 m0, s32, 6144
    s_add_u32 s38, s38, s39
    buffer_load_dwordx4 v6, s[8:11], s38 offen lds
    s_add_u32 m0, s32, 7168
    s_add_u32 s38, s38, s39
    buffer_load_dwordx4 v6, s[8:11], s38 offen lds
    s_waitcnt vmcnt(28)
    ds_read_b64_tr_b16 a[40:41], v7 offset:10240
    ds_read_b64_tr_b16 a[42:43], v7 offset:10496
    ds_read_b64_tr_b16 a[44:45], v7 offset:10248
    ds_read_b64_tr_b16 a[46:47], v7 offset:10504
    s_waitcnt lgkmcnt(4)
    s_add_u32 m0, s32, 8192
    s_add_u32 s38, s38, s39
    buffer_load_dwordx4 v6, s[8:11], s38 offen lds
    s_add_u32 m0, s32, 9216
    s_add_u32 s38, s38, s39
    buffer_load_dwordx4 v6, s[8:11], s38 offen lds
    s_waitcnt vmcnt(28)
    ds_read_b64_tr_b16 a[48:49], v7 offset:12288
    ds_read_b64_tr_b16 a[50:51], v7 offset:12544
    ds_read_b64_tr_b16 a[52:53], v7 offset:12296
    ds_read_b64_tr_b16 a[54:55], v7 offset:12552
    s_waitcnt lgkmcnt(4)
    s_add_u32 m0, s32, 10240
    s_add_u32 s38, s38, s39
    buffer_load_dwordx4 v6, s[8:11], s38 offen lds
    s_add_u32 m0, s32, 11264
    s_add_u32 s38, s38, s39
    buffer_load_dwordx4 v6, s[8:11], s38 offen lds
    s_waitcnt vmcnt(28)
    ds_read_b64_tr_b16 a[56:57], v7 offset:14336
    ds_read_b64_tr_b16 a[58:59], v7 offset:14592
    ds_read_b64_tr_b16 a[60:61], v7 offset:14344
    ds_read_b64_tr_b16 a[62:63], v7 offset:14600
    s_waitcnt lgkmcnt(4)
    s_add_u32 m0, s32, 12288
    s_add_u32 s38, s38, s39
    buffer_load_dwordx4 v6, s[8:11], s38 offen lds
    s_add_u32 m0, s32, 13312
    s_add_u32 s38, s38, s39
    buffer_load_dwordx4 v6, s[8:11], s38 offen lds
    s_waitcnt vmcnt(28)
    ds_read_b64_tr_b16 a[64:65], v7 offset:16384
    ds_read_b64_tr_b16 a[66:67], v7 offset:16640
    ds_read_b64_tr_b16 a[68:69], v7 offset:16392
    ds_read_b64_tr_b16 a[70:71], v7 offset:16648
    s_waitcnt lgkmcnt(4)
    s_add_u32 m0, s32, 14336
    s_add_u32 s38, s38, s39
    buffer_load_dwordx4 v6, s[8:11], s38 offen lds
    s_add_u32 m0, s32, 15360
    s_add_u32 s38, s38, s39
    buffer_load_dwordx4 v6, s[8:11], s38 offen lds
    s_waitcnt vmcnt(28)
    ds_read_b64_tr_b16 a[72:73], v7 offset:18432
    ds_read_b64_tr_b16 a[74:75], v7 offset:18688
    ds_read_b64_tr_b16 a[76:77], v7 offset:18440
    ds_read_b64_tr_b16 a[78:79], v7 offset:18696
    s_waitcnt lgkmcnt(4)
    s_add_u32 m0, s32, 16384
    s_add_u32 s38, s38, s39
    buffer_load_dwordx4 v6, s[8:11], s38 offen lds
    s_add_u32 m0, s32, 17408
    s_add_u32 s38, s38, s39
    buffer_load_dwordx4 v6, s[8:11], s38 offen lds
    s_waitcnt vmcnt(28)
    ds_read_b64_tr_b16 a[80:81], v7 offset:20480
    ds_read_b64_tr_b16 a[82:83], v7 offset:20736
    ds_read_b64_tr_b16 a[84:85], v7 offset:20488
    ds_read_b64_tr_b16 a[86:87], v7 offset:20744
    s_waitcnt lgkmcnt(4)
    s_add_u32 m0, s32, 18432
    s_add_u32 s38, s38, s39
    buffer_load_dwordx4 v6, s[8:11], s38 offen lds
    s_add_u32 m0, s32, 19456
    s_add_u32 s38, s38, s39
    buffer_load_dwordx4 v6, s[8:11], s38 offen lds
    s_waitcnt vmcnt(28)
    ds_read_b64_tr_b16 a[88:89], v7 offset:22528
    ds_read_b64_tr_b16 a[90:91], v7 offset:22784
    ds_read_b64_tr_b16 a[92:93], v7 offset:22536
    ds_read_b64_tr_b16 a[94:95], v7 offset:22792
    s_waitcnt lgkmcnt(4)
    s_add_u32 m0, s32, 20480
    s_add_u32 s38, s38, s39
    buffer_load_dwordx4 v6, s[8:11], s38 offen lds
    s_add_u32 m0, s32, 21504
    s_add_u32 s38, s38, s39
    buffer_load_dwordx4 v6, s[8:11], s38 offen lds
    s_waitcnt vmcnt(28)
    ds_read_b64_tr_b16 a[96:97], v7 offset:24576
    ds_read_b64_tr_b16 a[98:99], v7 offset:24832
    ds_read_b64_tr_b16 a[100:101], v7 offset:24584
    ds_read_b64_tr_b16 a[102:103], v7 offset:24840
    s_waitcnt lgkmcnt(4)
    s_add_u32 m0, s32, 22528
    s_add_u32 s38, s38, s39
    buffer_load_dwordx4 v6, s[8:11], s38 offen lds
    s_add_u32 m0, s32, 23552
    s_add_u32 s38, s38, s39
    buffer_load_dwordx4 v6, s[8:11], s38 offen lds
    s_waitcnt vmcnt(28)
    ds_read_b64_tr_b16 a[104:105], v7 offset:26624
    ds_read_b64_tr_b16 a[106:107], v7 offset:26880
    ds_read_b64_tr_b16 a[108:109], v7 offset:26632
    ds_read_b64_tr_b16 a[110:111], v7 offset:26888
    s_waitcnt lgkmcnt(4)
    s_add_u32 m0, s32, 24576
    s_add_u32 s38, s38, s39
    buffer_load_dwordx4 v6, s[8:11], s38 offen lds
    s_add_u32 m0, s32, 25600
    s_add_u32 s38, s38, s39
    buffer_load_dwordx4 v6, s[8:11], s38 offen lds
    s_waitcnt vmcnt(28)
    ds_read_b64_tr_b16 a[112:113], v7 offset:28672
    ds_read_b64_tr_b16 a[114:115], v7 offset:28928
    ds_read_b64_tr_b16 a[116:117], v7 offset:28680
    ds_read_b64_tr_b16 a[118:119], v7 offset:28936
    s_waitcnt lgkmcnt(4)
    s_add_u32 m0, s32, 26624
    s_add_u32 s38, s38, s39
    buffer_load_dwordx4 v6, s[8:11], s38 offen lds
    s_add_u32 m0, s32, 27648
    s_add_u32 s38, s38, s39
    buffer_load_dwordx4 v6, s[8:11], s38 offen lds
    s_waitcnt vmcnt(28)
    ds_read_b64_tr_b16 a[120:121], v7 offset:30720
    ds_read_b64_tr_b16 a[122:123], v7 offset:30976
    ds_read_b64_tr_b16 a[124:125], v7 offset:30728
    ds_read_b64_tr_b16 a[126:127], v7 offset:30984
    s_waitcnt lgkmcnt(4)
    s_add_u32 m0, s32, 28672
    s_add_u32 s38, s38, s39
    buffer_load_dwordx4 v6, s[8:11], s38 offen lds
    s_add_u32 m0, s32, 29696
    s_add_u32 s38, s38, s39
    buffer_load_dwordx4 v6, s[8:11], s38 offen lds
    s_waitcnt vmcnt(28)
    ds_read_b64_tr_b16 a[128:129], v7 offset:0
    ds_read_b64_tr_b16 a[130:131], v7 offset:256
    ds_read_b64_tr_b16 a[132:133], v7 offset:8
    ds_read_b64_tr_b16 a[134:135], v7 offset:264
    s_waitcnt lgkmcnt(4)
    s_add_u32 m0, s32, 30720
    s_add_u32 s38, s38, s39
    buffer_load_dwordx4 v6, s[8:11], s38 offen lds
    s_add_u32 m0, s32, 31744
    s_add_u32 s38, s38, s39
    buffer_load_dwordx4 v6, s[8:11], s38 offen lds
    s_waitcnt vmcnt(28)
    ds_read_b64_tr_b16 a[136:137], v7 offset:2048
    ds_read_b64_tr_b16 a[138:139], v7 offset:2304
    ds_read_b64_tr_b16 a[140:141], v7 offset:2056
    ds_read_b64_tr_b16 a[142:143], v7 offset:2312
    s_waitcnt vmcnt(26)
    ds_read_b64_tr_b16 a[144:145], v7 offset:4096
    ds_read_b64_tr_b16 a[146:147], v7 offset:4352
    ds_read_b64_tr_b16 a[148:149], v7 offset:4104
    ds_read_b64_tr_b16 a[150:151], v7 offset:4360
    s_waitcnt vmcnt(24)
    ds_read_b64_tr_b16 a[152:153], v7 offset:6144
    ds_read_b64_tr_b16 a[154:155], v7 offset:6400
    ds_read_b64_tr_b16 a[156:157], v7 offset:6152
    ds_read_b64_tr_b16 a[158:159], v7 offset:6408
    s_waitcnt vmcnt(22)
    ds_read_b64_tr_b16 a[160:161], v7 offset:8192
    ds_read_b64_tr_b16 a[162:163], v7 offset:8448
    ds_read_b64_tr_b16 a[164:165], v7 offset:8200
    ds_read_b64_tr_b16 a[166:167], v7 offset:8456
    s_waitcnt vmcnt(20)
    ds_read_b64_tr_b16 a[168:169], v7 offset:10240
    ds_read_b64_tr_b16 a[170:171], v7 offset:10496
    ds_read_b64_tr_b16 a[172:173], v7 offset:10248
    ds_read_b64_tr_b16 a[174:175], v7 offset:10504
    s_waitcnt vmcnt(18)
    ds_read_b64_tr_b16 a[176:177], v7 offset:12288
    ds_read_b64_tr_b16 a[178:179], v7 offset:12544
    ds_read_b64_tr_b16 a[180:181], v7 offset:12296
    ds_read_b64_tr_b16 a[182:183], v7 offset:12552
    s_waitcnt vmcnt(16)
    ds_read_b64_tr_b16 a[184:185], v7 offset:14336
    ds_read_b64_tr_b16 a[186:187], v7 offset:14592
    ds_read_b64_tr_b16 a[188:189], v7 offset:14344
    ds_read_b64_tr_b16 a[190:191], v7 offset:14600
    s_waitcnt vmcnt(14)
    ds_read_b64_tr_b16 a[192:193], v7 offset:16384
    ds_read_b64_tr_b16 a[194:195], v7 offset:16640
    ds_read_b64_tr_b16 a[196:197], v7 offset:16392
    ds_read_b64_tr_b16 a[198:199], v7 offset:16648
    s_waitcnt vmcnt(12)
    ds_read_b64_tr_b16 a[200:201], v7 offset:18432
    ds_read_b64_tr_b16 a[202:203], v7 offset:18688
    ds_read_b64_tr_b16 a[204:205], v7 offset:18440
    ds_read_b64_tr_b16 a[206:207], v7 offset:18696
    s_waitcnt vmcnt(10)
    ds_read_b64_tr_b16 a[208:209], v7 offset:20480
    ds_read_b64_tr_b16 a[210:211], v7 offset:20736
    ds_read_b64_tr_b16 a[212:213], v7 offset:20488
    ds_read_b64_tr_b16 a[214:215], v7 offset:20744
    s_waitcnt vmcnt(8)
    ds_read_b64_tr_b16 a[216:217], v7 offset:22528
    ds_read_b64_tr_b16 a[218:219], v7 offset:22784
    ds_read_b64_tr_b16 a[220:221], v7 offset:22536
    ds_read_b64_tr_b16 a[222:223], v7 offset:22792
    s_waitcnt vmcnt(6)
    ds_read_b64_tr_b16 a[224:225], v7 offset:24576
    ds_read_b64_tr_b16 a[226:227], v7 offset:24832
    ds_read_b64_tr_b16 a[228:229], v7 offset:24584
    ds_read_b64_tr_b16 a[230:231], v7 offset:24840
    s_waitcnt vmcnt(4)
    ds_read_b64_tr_b16 a[232:233], v7 offset:26624
    ds_read_b64_tr_b16 a[234:235], v7 offset:26880
    ds_read_b64_tr_b16 a[236:237], v7 offset:26632
    ds_read_b64_tr_b16 a[238:239], v7 offset:26888
    s_waitcnt vmcnt(2)
    ds_read_b64_tr_b16 a[240:241], v7 offset:28672
    ds_read_b64_tr_b16 a[242:243], v7 offset:28928
    ds_read_b64_tr_b16 a[244:245], v7 offset:28680
    ds_read_b64_tr_b16 a[246:247], v7 offset:28936
    s_waitcnt vmcnt(0)
    ds_read_b64_tr_b16 a[248:249], v7 offset:30720
    ds_read_b64_tr_b16 a[250:251], v7 offset:30976
    ds_read_b64_tr_b16 a[252:253], v7 offset:30728
    ds_read_b64_tr_b16 a[254:255], v7 offset:30984
    s_waitcnt lgkmcnt(0)
    s_lshr_b32 s31, s29, 1
    s_and_b32 s31, s31, 1
    s_lshl_b32 s31, s31, 2
    v_lshrrev_b32 v2, 4, v1
    v_add_u32 v2, s31, v2
    v_and_b32 v3, 7, v1
    v_xor_b32 v2, v2, v3
    s_lshl_b32 s31, s29, 14
    v_lshrrev_b32 v8, 3, v1
    v_lshlrev_b32 v8, 11, v8
    v_add_u32 v8, s31, v8
    v_lshl_add_u32 v8, v2, 4, v8
    v_bfe_u32 v2, v1, 1, 3
    v_lshrrev_b32 v3, 4, v1
    v_xor_b32 v2, v2, v3
    v_bfe_u32 v3, v1, 3, 1
    v_lshlrev_b32 v3, 11, v3
    v_and_b32 v4, 7, v1
    v_lshl_add_u32 v3, v4, 7, v3
    v_xor_b32 v12, 0, v2
    v_lshl_add_u32 v12, v12, 4, v3
    v_add_u32 v14, 65536, v12
    v_xor_b32 v13, 4, v2
    v_lshl_add_u32 v13, v13, 4, v3
    v_add_u32 v15, 65536, v13
    s_lshl_b32 s31, s29, 6
    v_and_b32 v9, 15, v1
    v_lshlrev_b32 v9, 12, v9
    v_lshrrev_b32 v4, 4, v1
    v_lshl_add_u32 v9, v4, 4, v9
    v_add_u32 v9, s31, v9
    v_add_u32 v8, s34, v5
    v_lshrrev_b32 v12, 4, v1
    v_lshlrev_b32 v12, 9, v12
    v_and_b32 v4, 15, v1
    v_lshl_add_u32 v12, v4, 4, v12
    v_add_u32 v14, 65536, v12
    s_cmp_lg_u32 s29, 0
    s_cbranch_scc1 g_wdd_100
g_wd_99:
    s_load_dword s72, s[92:93], 0 glc
    s_add_u32 s41, s41, 1
    s_cmp_ge_u32 s41, 0x200000
    s_cbranch_scc1 g_wdd_100
    s_waitcnt lgkmcnt(0)
    s_and_b32 s72, s72, 1023
    s_cmp_ge_u32 s72, 256
    s_cbranch_scc1 g_wdd_100
    s_sleep 32
    s_branch g_wd_99
g_wdd_100:
    s_waitcnt lgkmcnt(0)
    s_barrier
    v_and_b32 v2, 31, v1
    v_lshlrev_b32 v2, 7, v2
    v_add_u32 v2, 115359744, v2
    s_cmp_lg_u32 s29, 0
    s_cbranch_scc1 g_wld_102
g_wl_101:
    buffer_load_dword v3, v2, s[4:7], 0 offen sc1
    s_add_u32 s41, s41, 1
    s_cmp_ge_u32 s41, 0x200000
    s_cbranch_scc1 g_wld_102
    s_waitcnt vmcnt(0)
    v_cmp_gt_u32 vcc, s51, v3
    s_cbranch_vccz g_wld_102
    s_sleep 8
    s_branch g_wl_101
g_wld_102:
    s_barrier
    s_lshl_b32 s35, s30, 16
    s_sub_u32 s36, s36, s37
    s_barrier
    s_add_u32 m0, s34, 0
    s_add_u32 s32, s35, 0
    buffer_load_dwordx4 v8, s[12:15], s32 offen sc1 lds
    s_add_u32 m0, s34, 4096
    s_add_u32 s32, s35, 4096
    buffer_load_dwordx4 v8, s[12:15], s32 offen sc1 lds
    s_add_u32 m0, s34, 8192
    s_add_u32 s32, s35, 8192
    buffer_load_dwordx4 v8, s[12:15], s32 offen sc1 lds
    s_add_u32 m0, s34, 12288
    s_add_u32 s32, s35, 12288
    buffer_load_dwordx4 v8, s[12:15], s32 offen sc1 lds
    s_add_u32 m0, s34, 16384
    s_add_u32 s32, s35, 16384
    buffer_load_dwordx4 v8, s[12:15], s32 offen sc1 lds
    s_add_u32 m0, s34, 20480
    s_add_u32 s32, s35, 20480
    buffer_load_dwordx4 v8, s[12:15], s32 offen sc1 lds
    s_add_u32 m0, s34, 24576
    s_add_u32 s32, s35, 24576
    buffer_load_dwordx4 v8, s[12:15], s32 offen sc1 lds
    s_add_u32 m0, s34, 28672
    s_add_u32 s32, s35, 28672
    buffer_load_dwordx4 v8, s[12:15], s32 offen sc1 lds
    s_add_u32 m0, s34, 32768
    s_add_u32 s32, s35, 32768
    buffer_load_dwordx4 v8, s[12:15], s32 offen sc1 lds
    s_add_u32 m0, s34, 36864
    s_add_u32 s32, s35, 36864
    buffer_load_dwordx4 v8, s[12:15], s32 offen sc1 lds
    s_add_u32 m0, s34, 40960
    s_add_u32 s32, s35, 40960
    buffer_load_dwordx4 v8, s[12:15], s32 offen sc1 lds
    s_add_u32 m0, s34, 45056
    s_add_u32 s32, s35, 45056
    buffer_load_dwordx4 v8, s[12:15], s32 offen sc1 lds
    s_add_u32 m0, s34, 49152
    s_add_u32 s32, s35, 49152
    buffer_load_dwordx4 v8, s[12:15], s32 offen sc1 lds
    s_add_u32 m0, s34, 53248
    s_add_u32 s32, s35, 53248
    buffer_load_dwordx4 v8, s[12:15], s32 offen sc1 lds
    s_add_u32 m0, s34, 57344
    s_add_u32 s32, s35, 57344
    buffer_load_dwordx4 v8, s[12:15], s32 offen sc1 lds
    s_add_u32 m0, s34, 61440
    s_add_u32 s32, s35, 61440
    buffer_load_dwordx4 v8, s[12:15], s32 offen sc1 lds
    s_add_u32 s35, s35, 65536
    s_add_u32 m0, s34, 65536
    s_add_u32 s32, s35, 0
    buffer_load_dwordx4 v8, s[12:15], s32 offen sc1 lds
    s_add_u32 m0, s34, 69632
    s_add_u32 s32, s35, 4096
    buffer_load_dwordx4 v8, s[12:15], s32 offen sc1 lds
    s_add_u32 m0, s34, 73728
    s_add_u32 s32, s35, 8192
    buffer_load_dwordx4 v8, s[12:15], s32 offen sc1 lds
    s_add_u32 m0, s34, 77824
    s_add_u32 s32, s35, 12288
    buffer_load_dwordx4 v8, s[12:15], s32 offen sc1 lds
    s_waitcnt vmcnt(12)
    s_barrier
    ds_read_b128 v[32:35], v12 offset:0
    ds_read_b128 v[36:39], v12 offset:256
    ds_read_b128 v[40:43], v12 offset:2048
    ds_read_b128 v[44:47], v12 offset:2304
    ds_read_b128 v[48:51], v12 offset:4096
    ds_read_b128 v[52:55], v12 offset:4352
    v_add_u32 v9, 2130706432, v9
sl_loop_105:
    s_waitcnt lgkmcnt(4)
    v_mfma_f32_16x16x32_bf16 v[64:67], a[0:3], v[32:35], 0
    ds_read_b128 v[56:59], v12 offset:6144
    v_mfma_f32_16x16x32_bf16 v[68:71], a[4:7], v[32:35], 0
    v_mfma_f32_16x16x32_bf16 v[72:75], a[0:3], v[36:39], 0
    ds_read_b128 v[60:63], v12 offset:6400
    s_add_u32 m0, s34, 81920
    s_add_u32 s32, s35, 16384
    v_mfma_f32_16x16x32_bf16 v[76:79], a[4:7], v[36:39], 0
    buffer_load_dwordx4 v8, s[12:15], s32 offen sc1 lds
    s_waitcnt lgkmcnt(4)
    v_mfma_f32_16x16x32_bf16 v[64:67], a[8:11], v[40:43], v[64:67]
    ds_read_b128 v[32:35], v12 offset:8192
    v_mfma_f32_16x16x32_bf16 v[68:71], a[12:15], v[40:43], v[68:71]
    v_mfma_f32_16x16x32_bf16 v[72:75], a[8:11], v[44:47], v[72:75]
    ds_read_b128 v[36:39], v12 offset:8448
    v_mfma_f32_16x16x32_bf16 v[76:79], a[12:15], v[44:47], v[76:79]
    s_waitcnt lgkmcnt(4)
    v_mfma_f32_16x16x32_bf16 v[64:67], a[16:19], v[48:51], v[64:67]
    ds_read_b128 v[40:43], v12 offset:10240
    v_mfma_f32_16x16x32_bf16 v[68:71], a[20:23], v[48:51], v[68:71]
    v_cvt_pk_bf16_f32 v96, v80, v81
    v_mfma_f32_16x16x32_bf16 v[72:75], a[16:19], v[52:55], v[72:75]
    ds_read_b128 v[44:47], v12 offset:10496
    s_add_u32 m0, s34, 86016
    s_add_u32 s32, s35, 20480
    v_mfma_f32_16x16x32_bf16 v[76:79], a[20:23], v[52:55], v[76:79]
    buffer_load_dwordx4 v8, s[12:15], s32 offen sc1 lds
    v_cvt_pk_bf16_f32 v97, v82, v83
    s_waitcnt lgkmcnt(4)
    v_mfma_f32_16x16x32_bf16 v[64:67], a[24:27], v[56:59], v[64:67]
    ds_read_b128 v[48:51], v12 offset:12288
    v_mfma_f32_16x16x32_bf16 v[68:71], a[28:31], v[56:59], v[68:71]
    v_cvt_pk_bf16_f32 v98, v84, v85
    v_mfma_f32_16x16x32_bf16 v[72:75], a[24:27], v[60:63], v[72:75]
    ds_read_b128 v[52:55], v12 offset:12544
    v_mfma_f32_16x16x32_bf16 v[76:79], a[28:31], v[60:63], v[76:79]
    v_cvt_pk_bf16_f32 v99, v86, v87
    s_waitcnt lgkmcnt(4)
    v_mfma_f32_16x16x32_bf16 v[64:67], a[32:35], v[32:35], v[64:67]
    ds_read_b128 v[56:59], v12 offset:14336
    v_mfma_f32_16x16x32_bf16 v[68:71], a[36:39], v[32:35], v[68:71]
    v_cvt_pk_bf16_f32 v100, v88, v89
    v_mfma_f32_16x16x32_bf16 v[72:75], a[32:35], v[36:39], v[72:75]
    ds_read_b128 v[60:63], v12 offset:14592
    s_add_u32 m0, s34, 90112
    s_add_u32 s32, s35, 24576
    v_mfma_f32_16x16x32_bf16 v[76:79], a[36:39], v[36:39], v[76:79]
    buffer_load_dwordx4 v8, s[12:15], s32 offen sc1 lds
    v_cvt_pk_bf16_f32 v101, v90, v91
    s_waitcnt lgkmcnt(4)
    v_mfma_f32_16x16x32_bf16 v[64:67], a[40:43], v[40:43], v[64:67]
    ds_read_b128 v[32:35], v12 offset:16384
    v_mfma_f32_16x16x32_bf16 v[68:71], a[44:47], v[40:43], v[68:71]
    v_cvt_pk_bf16_f32 v102, v92, v93
    v_mfma_f32_16x16x32_bf16 v[72:75], a[40:43], v[44:47], v[72:75]
    ds_read_b128 v[36:39], v12 offset:16640
    v_mfma_f32_16x16x32_bf16 v[76:79], a[44:47], v[44:47], v[76:79]
    v_cvt_pk_bf16_f32 v103, v94, v95
    buffer_store_dwordx4 v[96:99], v9, s[20:23], s36 offen
    s_add_u32 s31, s36, 65536
    s_waitcnt lgkmcnt(4)
    v_mfma_f32_16x16x32_bf16 v[64:67], a[48:51], v[48:51], v[64:67]
    ds_read_b128 v[40:43], v12 offset:18432
    v_mfma_f32_16x16x32_bf16 v[68:71], a[52:55], v[48:51], v[68:71]
    v_mfma_f32_16x16x32_bf16 v[72:75], a[48:51], v[52:55], v[72:75]
    ds_read_b128 v[44:47], v12 offset:18688
    s_add_u32 m0, s34, 94208
    s_add_u32 s32, s35, 28672
    v_mfma_f32_16x16x32_bf16 v[76:79], a[52:55], v[52:55], v[76:79]
    buffer_load_dwordx4 v8, s[12:15], s32 offen sc1 lds
    s_waitcnt lgkmcnt(4)
    v_mfma_f32_16x16x32_bf16 v[64:67], a[56:59], v[56:59], v[64:67]
    ds_read_b128 v[48:51], v12 offset:20480
    v_mfma_f32_16x16x32_bf16 v[68:71], a[60:63], v[56:59], v[68:71]
    v_mfma_f32_16x16x32_bf16 v[72:75], a[56:59], v[60:63], v[72:75]
    ds_read_b128 v[52:55], v12 offset:20736
    v_mfma_f32_16x16x32_bf16 v[76:79], a[60:63], v[60:63], v[76:79]
    buffer_store_dwordx4 v[100:103], v9, s[20:23], s31 offen
    s_add_u32 s36, s36, s37
    s_waitcnt vmcnt(8)
    s_barrier
    s_waitcnt lgkmcnt(4)
    v_mfma_f32_16x16x32_bf16 v[64:67], a[64:67], v[32:35], v[64:67]
    ds_read_b128 v[56:59], v12 offset:22528
    v_mfma_f32_16x16x32_bf16 v[68:71], a[68:71], v[32:35], v[68:71]
    v_mfma_f32_16x16x32_bf16 v[72:75], a[64:67], v[36:39], v[72:75]
    ds_read_b128 v[60:63], v12 offset:22784
    s_add_u32 m0, s34, 98304
    s_add_u32 s32, s35, 32768
    v_mfma_f32_16x16x32_bf16 v[76:79], a[68:71], v[36:39], v[76:79]
    buffer_load_dwordx4 v8, s[12:15], s32 offen sc1 lds
    s_waitcnt lgkmcnt(4)
    v_mfma_f32_16x16x32_bf16 v[64:67], a[72:75], v[40:43], v[64:67]
    ds_read_b128 v[32:35], v12 offset:24576
    v_mfma_f32_16x16x32_bf16 v[68:71], a[76:79], v[40:43], v[68:71]
    v_mfma_f32_16x16x32_bf16 v[72:75], a[72:75], v[44:47], v[72:75]
    ds_read_b128 v[36:39], v12 offset:24832
    v_mfma_f32_16x16x32_bf16 v[76:79], a[76:79], v[44:47], v[76:79]
    s_waitcnt lgkmcnt(4)
    v_mfma_f32_16x16x32_bf16 v[64:67], a[80:83], v[48:51], v[64:67]
    ds_read_b128 v[40:43], v12 offset:26624
    v_mfma_f32_16x16x32_bf16 v[68:71], a[84:87], v[48:51], v[68:71]
    v_and_b32 v9, 0xffffff, v9
    v_mfma_f32_16x16x32_bf16 v[72:75], a[80:83], v[52:55], v[72:75]
    ds_read_b128 v[44:47], v12 offset:26880
    s_add_u32 m0, s34, 102400
    s_add_u32 s32, s35, 36864
    v_mfma_f32_16x16x32_bf16 v[76:79], a[84:87], v[52:55], v[76:79]
    buffer_load_dwordx4 v8, s[12:15], s32 offen sc1 lds
    s_waitcnt lgkmcnt(4)
    v_mfma_f32_16x16x32_bf16 v[64:67], a[88:91], v[56:59], v[64:67]
    ds_read_b128 v[48:51], v12 offset:28672
    v_mfma_f32_16x16x32_bf16 v[68:71], a[92:95], v[56:59], v[68:71]
    v_mfma_f32_16x16x32_bf16 v[72:75], a[88:91], v[60:63], v[72:75]
    ds_read_b128 v[52:55], v12 offset:28928
    v_mfma_f32_16x16x32_bf16 v[76:79], a[92:95], v[60:63], v[76:79]
    s_waitcnt lgkmcnt(4)
    v_mfma_f32_16x16x32_bf16 v[64:67], a[96:99], v[32:35], v[64:67]
    ds_read_b128 v[56:59], v12 offset:30720
    v_mfma_f32_16x16x32_bf16 v[68:71], a[100:103], v[32:35], v[68:71]
    v_mfma_f32_16x16x32_bf16 v[72:75], a[96:99], v[36:39], v[72:75]
    ds_read_b128 v[60:63], v12 offset:30976
    s_add_u32 m0, s34, 106496
    s_add_u32 s32, s35, 40960
    v_mfma_f32_16x16x32_bf16 v[76:79], a[100:103], v[36:39], v[76:79]
    buffer_load_dwordx4 v8, s[12:15], s32 offen sc1 lds
    s_waitcnt lgkmcnt(4)
    v_mfma_f32_16x16x32_bf16 v[64:67], a[104:107], v[40:43], v[64:67]
    ds_read_b128 v[32:35], v12 offset:32768
    v_mfma_f32_16x16x32_bf16 v[68:71], a[108:111], v[40:43], v[68:71]
    v_mfma_f32_16x16x32_bf16 v[72:75], a[104:107], v[44:47], v[72:75]
    ds_read_b128 v[36:39], v12 offset:33024
    v_mfma_f32_16x16x32_bf16 v[76:79], a[108:111], v[44:47], v[76:79]
    s_waitcnt lgkmcnt(4)
    v_mfma_f32_16x16x32_bf16 v[64:67], a[112:115], v[48:51], v[64:67]
    ds_read_b128 v[40:43], v12 offset:34816
    v_mfma_f32_16x16x32_bf16 v[68:71], a[116:119], v[48:51], v[68:71]
    v_mfma_f32_16x16x32_bf16 v[72:75], a[112:115], v[52:55], v[72:75]
    ds_read_b128 v[44:47], v12 offset:35072
    s_add_u32 m0, s34, 110592
    s_add_u32 s32, s35, 45056
    v_mfma_f32_16x16x32_bf16 v[76:79], a[116:119], v[52:55], v[76:79]
    buffer_load_dwordx4 v8, s[12:15], s32 offen sc1 lds
    s_waitcnt lgkmcnt(4)
    v_mfma_f32_16x16x32_bf16 v[64:67], a[120:123], v[56:59], v[64:67]
    ds_read_b128 v[48:51], v12 offset:36864
    v_mfma_f32_16x16x32_bf16 v[68:71], a[124:127], v[56:59], v[68:71]
    v_mfma_f32_16x16x32_bf16 v[72:75], a[120:123], v[60:63], v[72:75]
    ds_read_b128 v[52:55], v12 offset:37120
    v_mfma_f32_16x16x32_bf16 v[76:79], a[124:127], v[60:63], v[76:79]
    s_waitcnt lgkmcnt(4)
    v_mfma_f32_16x16x32_bf16 v[64:67], a[128:131], v[32:35], v[64:67]
    ds_read_b128 v[56:59], v12 offset:38912
    v_mfma_f32_16x16x32_bf16 v[68:71], a[132:135], v[32:35], v[68:71]
    v_mfma_f32_16x16x32_bf16 v[72:75], a[128:131], v[36:39], v[72:75]
    ds_read_b128 v[60:63], v12 offset:39168
    s_add_u32 m0, s34, 114688
    s_add_u32 s32, s35, 49152
    v_mfma_f32_16x16x32_bf16 v[76:79], a[132:135], v[36:39], v[76:79]
    buffer_load_dwordx4 v8, s[12:15], s32 offen sc1 lds
    s_waitcnt lgkmcnt(4)
    v_mfma_f32_16x16x32_bf16 v[64:67], a[136:139], v[40:43], v[64:67]
    ds_read_b128 v[32:35], v12 offset:40960
    v_mfma_f32_16x16x32_bf16 v[68:71], a[140:143], v[40:43], v[68:71]
    v_mfma_f32_16x16x32_bf16 v[72:75], a[136:139], v[44:47], v[72:75]
    ds_read_b128 v[36:39], v12 offset:41216
    v_mfma_f32_16x16x32_bf16 v[76:79], a[140:143], v[44:47], v[76:79]
    s_waitcnt lgkmcnt(4)
    v_mfma_f32_16x16x32_bf16 v[64:67], a[144:147], v[48:51], v[64:67]
    ds_read_b128 v[40:43], v12 offset:43008
    v_mfma_f32_16x16x32_bf16 v[68:71], a[148:151], v[48:51], v[68:71]
    v_mfma_f32_16x16x32_bf16 v[72:75], a[144:147], v[52:55], v[72:75]
    ds_read_b128 v[44:47], v12 offset:43264
    s_add_u32 m0, s34, 118784
    s_add_u32 s32, s35, 53248
    v_mfma_f32_16x16x32_bf16 v[76:79], a[148:151], v[52:55], v[76:79]
    buffer_load_dwordx4 v8, s[12:15], s32 offen sc1 lds
    s_waitcnt lgkmcnt(4)
    v_mfma_f32_16x16x32_bf16 v[64:67], a[152:155], v[56:59], v[64:67]
    ds_read_b128 v[48:51], v12 offset:45056
    v_mfma_f32_16x16x32_bf16 v[68:71], a[156:159], v[56:59], v[68:71]
    v_mfma_f32_16x16x32_bf16 v[72:75], a[152:155], v[60:63], v[72:75]
    ds_read_b128 v[52:55], v12 offset:45312
    v_mfma_f32_16x16x32_bf16 v[76:79], a[156:159], v[60:63], v[76:79]
    s_waitcnt lgkmcnt(4)
    v_mfma_f32_16x16x32_bf16 v[64:67], a[160:163], v[32:35], v[64:67]
    ds_read_b128 v[56:59], v12 offset:47104
    v_mfma_f32_16x16x32_bf16 v[68:71], a[164:167], v[32:35], v[68:71]
    v_mfma_f32_16x16x32_bf16 v[72:75], a[160:163], v[36:39], v[72:75]
    ds_read_b128 v[60:63], v12 offset:47360
    s_add_u32 m0, s34, 122880
    s_add_u32 s32, s35, 57344
    v_mfma_f32_16x16x32_bf16 v[76:79], a[164:167], v[36:39], v[76:79]
    buffer_load_dwordx4 v8, s[12:15], s32 offen sc1 lds
    s_waitcnt lgkmcnt(4)
    v_mfma_f32_16x16x32_bf16 v[64:67], a[168:171], v[40:43], v[64:67]
    ds_read_b128 v[32:35], v12 offset:49152
    v_mfma_f32_16x16x32_bf16 v[68:71], a[172:175], v[40:43], v[68:71]
    v_mfma_f32_16x16x32_bf16 v[72:75], a[168:171], v[44:47], v[72:75]
    ds_read_b128 v[36:39], v12 offset:49408
    v_mfma_f32_16x16x32_bf16 v[76:79], a[172:175], v[44:47], v[76:79]
    s_waitcnt lgkmcnt(4)
    v_mfma_f32_16x16x32_bf16 v[64:67], a[176:179], v[48:51], v[64:67]
    ds_read_b128 v[40:43], v12 offset:51200
    v_mfma_f32_16x16x32_bf16 v[68:71], a[180:183], v[48:51], v[68:71]
    v_mfma_f32_16x16x32_bf16 v[72:75], a[176:179], v[52:55], v[72:75]
    ds_read_b128 v[44:47], v12 offset:51456
    s_add_u32 m0, s34, 126976
    s_add_u32 s32, s35, 61440
    v_mfma_f32_16x16x32_bf16 v[76:79], a[180:183], v[52:55], v[76:79]
    buffer_load_dwordx4 v8, s[12:15], s32 offen sc1 lds
    s_add_u32 s35, s35, 65536
    s_min_u32 s35, s35, s52
    s_waitcnt lgkmcnt(4)
    v_mfma_f32_16x16x32_bf16 v[64:67], a[184:187], v[56:59], v[64:67]
    ds_read_b128 v[48:51], v12 offset:53248
    v_mfma_f32_16x16x32_bf16 v[68:71], a[188:191], v[56:59], v[68:71]
    v_mfma_f32_16x16x32_bf16 v[72:75], a[184:187], v[60:63], v[72:75]
    ds_read_b128 v[52:55], v12 offset:53504
    v_mfma_f32_16x16x32_bf16 v[76:79], a[188:191], v[60:63], v[76:79]
    s_waitcnt vmcnt(8)
    s_barrier
    s_waitcnt lgkmcnt(4)
    v_mfma_f32_16x16x32_bf16 v[64:67], a[192:195], v[32:35], v[64:67]
    ds_read_b128 v[56:59], v12 offset:55296
    v_mfma_f32_16x16x32_bf16 v[68:71], a[196:199], v[32:35], v[68:71]
    v_mfma_f32_16x16x32_bf16 v[72:75], a[192:195], v[36:39], v[72:75]
    ds_read_b128 v[60:63], v12 offset:55552
    s_add_u32 m0, s34, 0
    s_add_u32 s32, s35, 0
    v_mfma_f32_16x16x32_bf16 v[76:79], a[196:199], v[36:39], v[76:79]
    buffer_load_dwordx4 v8, s[12:15], s32 offen sc1 lds
    s_waitcnt lgkmcnt(4)
    v_mfma_f32_16x16x32_bf16 v[64:67], a[200:203], v[40:43], v[64:67]
    ds_read_b128 v[32:35], v12 offset:57344
    v_mfma_f32_16x16x32_bf16 v[68:71], a[204:207], v[40:43], v[68:71]
    v_mfma_f32_16x16x32_bf16 v[72:75], a[200:203], v[44:47], v[72:75]
    ds_read_b128 v[36:39], v12 offset:57600
    v_mfma_f32_16x16x32_bf16 v[76:79], a[204:207], v[44:47], v[76:79]
    s_waitcnt lgkmcnt(4)
    v_mfma_f32_16x16x32_bf16 v[64:67], a[208:211], v[48:51], v[64:67]
    ds_read_b128 v[40:43], v12 offset:59392
    v_mfma_f32_16x16x32_bf16 v[68:71], a[212:215], v[48:51], v[68:71]
    v_mfma_f32_16x16x32_bf16 v[72:75], a[208:211], v[52:55], v[72:75]
    ds_read_b128 v[44:47], v12 offset:59648
    s_add_u32 m0, s34, 4096
    s_add_u32 s32, s35, 4096
    v_mfma_f32_16x16x32_bf16 v[76:79], a[212:215], v[52:55], v[76:79]
    buffer_load_dwordx4 v8, s[12:15], s32 offen sc1 lds
    s_waitcnt lgkmcnt(4)
    v_mfma_f32_16x16x32_bf16 v[64:67], a[216:219], v[56:59], v[64:67]
    ds_read_b128 v[48:51], v12 offset:61440
    v_mfma_f32_16x16x32_bf16 v[68:71], a[220:223], v[56:59], v[68:71]
    v_mfma_f32_16x16x32_bf16 v[72:75], a[216:219], v[60:63], v[72:75]
    ds_read_b128 v[52:55], v12 offset:61696
    v_mfma_f32_16x16x32_bf16 v[76:79], a[220:223], v[60:63], v[76:79]
    s_waitcnt lgkmcnt(4)
    v_mfma_f32_16x16x32_bf16 v[64:67], a[224:227], v[32:35], v[64:67]
    ds_read_b128 v[56:59], v12 offset:63488
    v_mfma_f32_16x16x32_bf16 v[68:71], a[228:231], v[32:35], v[68:71]
    v_mfma_f32_16x16x32_bf16 v[72:75], a[224:227], v[36:39], v[72:75]
    ds_read_b128 v[60:63], v12 offset:63744
    s_add_u32 m0, s34, 8192
    s_add_u32 s32, s35, 8192
    v_mfma_f32_16x16x32_bf16 v[76:79], a[228:231], v[36:39], v[76:79]
    buffer_load_dwordx4 v8, s[12:15], s32 offen sc1 lds
    s_waitcnt lgkmcnt(4)
    v_mfma_f32_16x16x32_bf16 v[64:67], a[232:235], v[40:43], v[64:67]
    ds_read_b128 v[32:35], v14 offset:0
    v_mfma_f32_16x16x32_bf16 v[68:71], a[236:239], v[40:43], v[68:71]
    v_mfma_f32_16x16x32_bf16 v[72:75], a[232:235], v[44:47], v[72:75]
    ds_read_b128 v[36:39], v14 offset:256
    v_mfma_f32_16x16x32_bf16 v[76:79], a[236:239], v[44:47], v[76:79]
    s_waitcnt lgkmcnt(4)
    v_mfma_f32_16x16x32_bf16 v[64:67], a[240:243], v[48:51], v[64:67]
    ds_read_b128 v[40:43], v14 offset:2048
    v_mfma_f32_16x16x32_bf16 v[68:71], a[244:247], v[48:51], v[68:71]
    v_mfma_f32_16x16x32_bf16 v[72:75], a[240:243], v[52:55], v[72:75]
    ds_read_b128 v[44:47], v14 offset:2304
    s_add_u32 m0, s34, 12288
    s_add_u32 s32, s35, 12288
    v_mfma_f32_16x16x32_bf16 v[76:79], a[244:247], v[52:55], v[76:79]
    buffer_load_dwordx4 v8, s[12:15], s32 offen sc1 lds
    s_waitcnt lgkmcnt(4)
    v_mfma_f32_16x16x32_bf16 v[64:67], a[248:251], v[56:59], v[64:67]
    ds_read_b128 v[48:51], v14 offset:4096
    v_mfma_f32_16x16x32_bf16 v[68:71], a[252:255], v[56:59], v[68:71]
    v_mfma_f32_16x16x32_bf16 v[72:75], a[248:251], v[60:63], v[72:75]
    ds_read_b128 v[52:55], v14 offset:4352
    v_mfma_f32_16x16x32_bf16 v[76:79], a[252:255], v[60:63], v[76:79]
    s_waitcnt lgkmcnt(4)
    v_mfma_f32_16x16x32_bf16 v[80:83], a[0:3], v[32:35], 0
    ds_read_b128 v[56:59], v14 offset:6144
    v_mfma_f32_16x16x32_bf16 v[84:87], a[4:7], v[32:35], 0
    v_mfma_f32_16x16x32_bf16 v[88:91], a[0:3], v[36:39], 0
    ds_read_b128 v[60:63], v14 offset:6400
    s_add_u32 m0, s34, 16384
    s_add_u32 s32, s35, 16384
    v_mfma_f32_16x16x32_bf16 v[92:95], a[4:7], v[36:39], 0
    buffer_load_dwordx4 v8, s[12:15], s32 offen sc1 lds
    s_waitcnt lgkmcnt(4)
    v_mfma_f32_16x16x32_bf16 v[80:83], a[8:11], v[40:43], v[80:83]
    ds_read_b128 v[32:35], v14 offset:8192
    v_mfma_f32_16x16x32_bf16 v[84:87], a[12:15], v[40:43], v[84:87]
    v_mfma_f32_16x16x32_bf16 v[88:91], a[8:11], v[44:47], v[88:91]
    ds_read_b128 v[36:39], v14 offset:8448
    v_mfma_f32_16x16x32_bf16 v[92:95], a[12:15], v[44:47], v[92:95]
    s_waitcnt lgkmcnt(4)
    v_mfma_f32_16x16x32_bf16 v[80:83], a[16:19], v[48:51], v[80:83]
    ds_read_b128 v[40:43], v14 offset:10240
    v_mfma_f32_16x16x32_bf16 v[84:87], a[20:23], v[48:51], v[84:87]
    v_cvt_pk_bf16_f32 v96, v64, v65
    v_mfma_f32_16x16x32_bf16 v[88:91], a[16:19], v[52:55], v[88:91]
    ds_read_b128 v[44:47], v14 offset:10496
    s_add_u32 m0, s34, 20480
    s_add_u32 s32, s35, 20480
    v_mfma_f32_16x16x32_bf16 v[92:95], a[20:23], v[52:55], v[92:95]
    buffer_load_dwordx4 v8, s[12:15], s32 offen sc1 lds
    v_cvt_pk_bf16_f32 v97, v66, v67
    s_waitcnt lgkmcnt(4)
    v_mfma_f32_16x16x32_bf16 v[80:83], a[24:27], v[56:59], v[80:83]
    ds_read_b128 v[48:51], v14 offset:12288
    v_mfma_f32_16x16x32_bf16 v[84:87], a[28:31], v[56:59], v[84:87]
    v_cvt_pk_bf16_f32 v98, v68, v69
    v_mfma_f32_16x16x32_bf16 v[88:91], a[24:27], v[60:63], v[88:91]
    ds_read_b128 v[52:55], v14 offset:12544
    v_mfma_f32_16x16x32_bf16 v[92:95], a[28:31], v[60:63], v[92:95]
    v_cvt_pk_bf16_f32 v99, v70, v71
    s_waitcnt lgkmcnt(4)
    v_mfma_f32_16x16x32_bf16 v[80:83], a[32:35], v[32:35], v[80:83]
    ds_read_b128 v[56:59], v14 offset:14336
    v_mfma_f32_16x16x32_bf16 v[84:87], a[36:39], v[32:35], v[84:87]
    v_cvt_pk_bf16_f32 v100, v72, v73
    v_mfma_f32_16x16x32_bf16 v[88:91], a[32:35], v[36:39], v[88:91]
    ds_read_b128 v[60:63], v14 offset:14592
    s_add_u32 m0, s34, 24576
    s_add_u32 s32, s35, 24576
    v_mfma_f32_16x16x32_bf16 v[92:95], a[36:39], v[36:39], v[92:95]
    buffer_load_dwordx4 v8, s[12:15], s32 offen sc1 lds
    v_cvt_pk_bf16_f32 v101, v74, v75
    s_waitcnt lgkmcnt(4)
    v_mfma_f32_16x16x32_bf16 v[80:83], a[40:43], v[40:43], v[80:83]
    ds_read_b128 v[32:35], v14 offset:16384
    v_mfma_f32_16x16x32_bf16 v[84:87], a[44:47], v[40:43], v[84:87]
    v_cvt_pk_bf16_f32 v102, v76, v77
    v_mfma_f32_16x16x32_bf16 v[88:91], a[40:43], v[44:47], v[88:91]
    ds_read_b128 v[36:39], v14 offset:16640
    v_mfma_f32_16x16x32_bf16 v[92:95], a[44:47], v[44:47], v[92:95]
    v_cvt_pk_bf16_f32 v103, v78, v79
    buffer_store_dwordx4 v[96:99], v9, s[20:23], s36 offen
    s_add_u32 s31, s36, 65536
    s_waitcnt lgkmcnt(4)
    v_mfma_f32_16x16x32_bf16 v[80:83], a[48:51], v[48:51], v[80:83]
    ds_read_b128 v[40:43], v14 offset:18432
    v_mfma_f32_16x16x32_bf16 v[84:87], a[52:55], v[48:51], v[84:87]
    v_mfma_f32_16x16x32_bf16 v[88:91], a[48:51], v[52:55], v[88:91]
    ds_read_b128 v[44:47], v14 offset:18688
    s_add_u32 m0, s34, 28672
    s_add_u32 s32, s35, 28672
    v_mfma_f32_16x16x32_bf16 v[92:95], a[52:55], v[52:55], v[92:95]
    buffer_load_dwordx4 v8, s[12:15], s32 offen sc1 lds
    s_waitcnt lgkmcnt(4)
    v_mfma_f32_16x16x32_bf16 v[80:83], a[56:59], v[56:59], v[80:83]
    ds_read_b128 v[48:51], v14 offset:20480
    v_mfma_f32_16x16x32_bf16 v[84:87], a[60:63], v[56:59], v[84:87]
    v_mfma_f32_16x16x32_bf16 v[88:91], a[56:59], v[60:63], v[88:91]
    ds_read_b128 v[52:55], v14 offset:20736
    v_mfma_f32_16x16x32_bf16 v[92:95], a[60:63], v[60:63], v[92:95]
    buffer_store_dwordx4 v[100:103], v9, s[20:23], s31 offen
    s_add_u32 s36, s36, s37
    s_waitcnt vmcnt(8)
    s_barrier
    s_waitcnt lgkmcnt(4)
    v_mfma_f32_16x16x32_bf16 v[80:83], a[64:67], v[32:35], v[80:83]
    ds_read_b128 v[56:59], v14 offset:22528
    v_mfma_f32_16x16x32_bf16 v[84:87], a[68:71], v[32:35], v[84:87]
    v_mfma_f32_16x16x32_bf16 v[88:91], a[64:67], v[36:39], v[88:91]
    ds_read_b128 v[60:63], v14 offset:22784
    s_add_u32 m0, s34, 32768
    s_add_u32 s32, s35, 32768
    v_mfma_f32_16x16x32_bf16 v[92:95], a[68:71], v[36:39], v[92:95]
    buffer_load_dwordx4 v8, s[12:15], s32 offen sc1 lds
    s_waitcnt lgkmcnt(4)
    v_mfma_f32_16x16x32_bf16 v[80:83], a[72:75], v[40:43], v[80:83]
    ds_read_b128 v[32:35], v14 offset:24576
    v_mfma_f32_16x16x32_bf16 v[84:87], a[76:79], v[40:43], v[84:87]
    v_mfma_f32_16x16x32_bf16 v[88:91], a[72:75], v[44:47], v[88:91]
    ds_read_b128 v[36:39], v14 offset:24832
    v_mfma_f32_16x16x32_bf16 v[92:95], a[76:79], v[44:47], v[92:95]
    s_waitcnt lgkmcnt(4)
    v_mfma_f32_16x16x32_bf16 v[80:83], a[80:83], v[48:51], v[80:83]
    ds_read_b128 v[40:43], v14 offset:26624
    v_mfma_f32_16x16x32_bf16 v[84:87], a[84:87], v[48:51], v[84:87]
    v_mfma_f32_16x16x32_bf16 v[88:91], a[80:83], v[52:55], v[88:91]
    ds_read_b128 v[44:47], v14 offset:26880
    s_add_u32 m0, s34, 36864
    s_add_u32 s32, s35, 36864
    v_mfma_f32_16x16x32_bf16 v[92:95], a[84:87], v[52:55], v[92:95]
    buffer_load_dwordx4 v8, s[12:15], s32 offen sc1 lds
    s_waitcnt lgkmcnt(4)
    v_mfma_f32_16x16x32_bf16 v[80:83], a[88:91], v[56:59], v[80:83]
    ds_read_b128 v[48:51], v14 offset:28672
    v_mfma_f32_16x16x32_bf16 v[84:87], a[92:95], v[56:59], v[84:87]
    v_mfma_f32_16x16x32_bf16 v[88:91], a[88:91], v[60:63], v[88:91]
    ds_read_b128 v[52:55], v14 offset:28928
    v_mfma_f32_16x16x32_bf16 v[92:95], a[92:95], v[60:63], v[92:95]
    s_waitcnt lgkmcnt(4)
    v_mfma_f32_16x16x32_bf16 v[80:83], a[96:99], v[32:35], v[80:83]
    ds_read_b128 v[56:59], v14 offset:30720
    v_mfma_f32_16x16x32_bf16 v[84:87], a[100:103], v[32:35], v[84:87]
    v_mfma_f32_16x16x32_bf16 v[88:91], a[96:99], v[36:39], v[88:91]
    ds_read_b128 v[60:63], v14 offset:30976
    s_add_u32 m0, s34, 40960
    s_add_u32 s32, s35, 40960
    v_mfma_f32_16x16x32_bf16 v[92:95], a[100:103], v[36:39], v[92:95]
    buffer_load_dwordx4 v8, s[12:15], s32 offen sc1 lds
    s_waitcnt lgkmcnt(4)
    v_mfma_f32_16x16x32_bf16 v[80:83], a[104:107], v[40:43], v[80:83]
    ds_read_b128 v[32:35], v14 offset:32768
    v_mfma_f32_16x16x32_bf16 v[84:87], a[108:111], v[40:43], v[84:87]
    v_mfma_f32_16x16x32_bf16 v[88:91], a[104:107], v[44:47], v[88:91]
    ds_read_b128 v[36:39], v14 offset:33024
    v_mfma_f32_16x16x32_bf16 v[92:95], a[108:111], v[44:47], v[92:95]
    s_waitcnt lgkmcnt(4)
    v_mfma_f32_16x16x32_bf16 v[80:83], a[112:115], v[48:51], v[80:83]
    ds_read_b128 v[40:43], v14 offset:34816
    v_mfma_f32_16x16x32_bf16 v[84:87], a[116:119], v[48:51], v[84:87]
    v_mfma_f32_16x16x32_bf16 v[88:91], a[112:115], v[52:55], v[88:91]
    ds_read_b128 v[44:47], v14 offset:35072
    s_add_u32 m0, s34, 45056
    s_add_u32 s32, s35, 45056
    v_mfma_f32_16x16x32_bf16 v[92:95], a[116:119], v[52:55], v[92:95]
    buffer_load_dwordx4 v8, s[12:15], s32 offen sc1 lds
    s_waitcnt lgkmcnt(4)
    v_mfma_f32_16x16x32_bf16 v[80:83], a[120:123], v[56:59], v[80:83]
    ds_read_b128 v[48:51], v14 offset:36864
    v_mfma_f32_16x16x32_bf16 v[84:87], a[124:127], v[56:59], v[84:87]
    v_mfma_f32_16x16x32_bf16 v[88:91], a[120:123], v[60:63], v[88:91]
    ds_read_b128 v[52:55], v14 offset:37120
    v_mfma_f32_16x16x32_bf16 v[92:95], a[124:127], v[60:63], v[92:95]
    s_waitcnt lgkmcnt(4)
    v_mfma_f32_16x16x32_bf16 v[80:83], a[128:131], v[32:35], v[80:83]
    ds_read_b128 v[56:59], v14 offset:38912
    v_mfma_f32_16x16x32_bf16 v[84:87], a[132:135], v[32:35], v[84:87]
    v_mfma_f32_16x16x32_bf16 v[88:91], a[128:131], v[36:39], v[88:91]
    ds_read_b128 v[60:63], v14 offset:39168
    s_add_u32 m0, s34, 49152
    s_add_u32 s32, s35, 49152
    v_mfma_f32_16x16x32_bf16 v[92:95], a[132:135], v[36:39], v[92:95]
    buffer_load_dwordx4 v8, s[12:15], s32 offen sc1 lds
    s_waitcnt lgkmcnt(4)
    v_mfma_f32_16x16x32_bf16 v[80:83], a[136:139], v[40:43], v[80:83]
    ds_read_b128 v[32:35], v14 offset:40960
    v_mfma_f32_16x16x32_bf16 v[84:87], a[140:143], v[40:43], v[84:87]
    v_mfma_f32_16x16x32_bf16 v[88:91], a[136:139], v[44:47], v[88:91]
    ds_read_b128 v[36:39], v14 offset:41216
    v_mfma_f32_16x16x32_bf16 v[92:95], a[140:143], v[44:47], v[92:95]
    s_waitcnt lgkmcnt(4)
    v_mfma_f32_16x16x32_bf16 v[80:83], a[144:147], v[48:51], v[80:83]
    ds_read_b128 v[40:43], v14 offset:43008
    v_mfma_f32_16x16x32_bf16 v[84:87], a[148:151], v[48:51], v[84:87]
    v_mfma_f32_16x16x32_bf16 v[88:91], a[144:147], v[52:55], v[88:91]
    ds_read_b128 v[44:47], v14 offset:43264
    s_add_u32 m0, s34, 53248
    s_add_u32 s32, s35, 53248
    v_mfma_f32_16x16x32_bf16 v[92:95], a[148:151], v[52:55], v[92:95]
    buffer_load_dwordx4 v8, s[12:15], s32 offen sc1 lds
    s_waitcnt lgkmcnt(4)
    v_mfma_f32_16x16x32_bf16 v[80:83], a[152:155], v[56:59], v[80:83]
    ds_read_b128 v[48:51], v14 offset:45056
    v_mfma_f32_16x16x32_bf16 v[84:87], a[156:159], v[56:59], v[84:87]
    v_mfma_f32_16x16x32_bf16 v[88:91], a[152:155], v[60:63], v[88:91]
    ds_read_b128 v[52:55], v14 offset:45312
    v_mfma_f32_16x16x32_bf16 v[92:95], a[156:159], v[60:63], v[92:95]
    s_waitcnt lgkmcnt(4)
    v_mfma_f32_16x16x32_bf16 v[80:83], a[160:163], v[32:35], v[80:83]
    ds_read_b128 v[56:59], v14 offset:47104
    v_mfma_f32_16x16x32_bf16 v[84:87], a[164:167], v[32:35], v[84:87]
    v_mfma_f32_16x16x32_bf16 v[88:91], a[160:163], v[36:39], v[88:91]
    ds_read_b128 v[60:63], v14 offset:47360
    s_add_u32 m0, s34, 57344
    s_add_u32 s32, s35, 57344
    v_mfma_f32_16x16x32_bf16 v[92:95], a[164:167], v[36:39], v[92:95]
    buffer_load_dwordx4 v8, s[12:15], s32 offen sc1 lds
    s_waitcnt lgkmcnt(4)
    v_mfma_f32_16x16x32_bf16 v[80:83], a[168:171], v[40:43], v[80:83]
    ds_read_b128 v[32:35], v14 offset:49152
    v_mfma_f32_16x16x32_bf16 v[84:87], a[172:175], v[40:43], v[84:87]
    v_mfma_f32_16x16x32_bf16 v[88:91], a[168:171], v[44:47], v[88:91]
    ds_read_b128 v[36:39], v14 offset:49408
    v_mfma_f32_16x16x32_bf16 v[92:95], a[172:175], v[44:47], v[92:95]
    s_waitcnt lgkmcnt(4)
    v_mfma_f32_16x16x32_bf16 v[80:83], a[176:179], v[48:51], v[80:83]
    ds_read_b128 v[40:43], v14 offset:51200
    v_mfma_f32_16x16x32_bf16 v[84:87], a[180:183], v[48:51], v[84:87]
    v_mfma_f32_16x16x32_bf16 v[88:91], a[176:179], v[52:55], v[88:91]
    ds_read_b128 v[44:47], v14 offset:51456
    s_add_u32 m0, s34, 61440
    s_add_u32 s32, s35, 61440
    v_mfma_f32_16x16x32_bf16 v[92:95], a[180:183], v[52:55], v[92:95]
    buffer_load_dwordx4 v8, s[12:15], s32 offen sc1 lds
    s_add_u32 s35, s35, 65536
    s_min_u32 s35, s35, s52
    s_waitcnt lgkmcnt(4)
    v_mfma_f32_16x16x32_bf16 v[80:83], a[184:187], v[56:59], v[80:83]
    ds_read_b128 v[48:51], v14 offset:53248
    v_mfma_f32_16x16x32_bf16 v[84:87], a[188:191], v[56:59], v[84:87]
    v_mfma_f32_16x16x32_bf16 v[88:91], a[184:187], v[60:63], v[88:91]
    ds_read_b128 v[52:55], v14 offset:53504
    v_mfma_f32_16x16x32_bf16 v[92:95], a[188:191], v[60:63], v[92:95]
    s_waitcnt vmcnt(8)
    s_barrier
    s_waitcnt lgkmcnt(4)
    v_mfma_f32_16x16x32_bf16 v[80:83], a[192:195], v[32:35], v[80:83]
    ds_read_b128 v[56:59], v14 offset:55296
    v_mfma_f32_16x16x32_bf16 v[84:87], a[196:199], v[32:35], v[84:87]
    v_mfma_f32_16x16x32_bf16 v[88:91], a[192:195], v[36:39], v[88:91]
    ds_read_b128 v[60:63], v14 offset:55552
    s_add_u32 m0, s34, 65536
    s_add_u32 s32, s35, 0
    v_mfma_f32_16x16x32_bf16 v[92:95], a[196:199], v[36:39], v[92:95]
    buffer_load_dwordx4 v8, s[12:15], s32 offen sc1 lds
    s_waitcnt lgkmcnt(4)
    v_mfma_f32_16x16x32_bf16 v[80:83], a[200:203], v[40:43], v[80:83]
    ds_read_b128 v[32:35], v14 offset:57344
    v_mfma_f32_16x16x32_bf16 v[84:87], a[204:207], v[40:43], v[84:87]
    v_mfma_f32_16x16x32_bf16 v[88:91], a[200:203], v[44:47], v[88:91]
    ds_read_b128 v[36:39], v14 offset:57600
    v_mfma_f32_16x16x32_bf16 v[92:95], a[204:207], v[44:47], v[92:95]
    s_waitcnt lgkmcnt(4)
    v_mfma_f32_16x16x32_bf16 v[80:83], a[208:211], v[48:51], v[80:83]
    ds_read_b128 v[40:43], v14 offset:59392
    v_mfma_f32_16x16x32_bf16 v[84:87], a[212:215], v[48:51], v[84:87]
    v_mfma_f32_16x16x32_bf16 v[88:91], a[208:211], v[52:55], v[88:91]
    ds_read_b128 v[44:47], v14 offset:59648
    s_add_u32 m0, s34, 69632
    s_add_u32 s32, s35, 4096
    v_mfma_f32_16x16x32_bf16 v[92:95], a[212:215], v[52:55], v[92:95]
    buffer_load_dwordx4 v8, s[12:15], s32 offen sc1 lds
    s_waitcnt lgkmcnt(4)
    v_mfma_f32_16x16x32_bf16 v[80:83], a[216:219], v[56:59], v[80:83]
    ds_read_b128 v[48:51], v14 offset:61440
    v_mfma_f32_16x16x32_bf16 v[84:87], a[220:223], v[56:59], v[84:87]
    v_mfma_f32_16x16x32_bf16 v[88:91], a[216:219], v[60:63], v[88:91]
    ds_read_b128 v[52:55], v14 offset:61696
    v_mfma_f32_16x16x32_bf16 v[92:95], a[220:223], v[60:63], v[92:95]
    s_waitcnt lgkmcnt(4)
    v_mfma_f32_16x16x32_bf16 v[80:83], a[224:227], v[32:35], v[80:83]
    ds_read_b128 v[56:59], v14 offset:63488
    v_mfma_f32_16x16x32_bf16 v[84:87], a[228:231], v[32:35], v[84:87]
    v_mfma_f32_16x16x32_bf16 v[88:91], a[224:227], v[36:39], v[88:91]
    ds_read_b128 v[60:63], v14 offset:63744
    s_add_u32 m0, s34, 73728
    s_add_u32 s32, s35, 8192
    v_mfma_f32_16x16x32_bf16 v[92:95], a[228:231], v[36:39], v[92:95]
    buffer_load_dwordx4 v8, s[12:15], s32 offen sc1 lds
    s_waitcnt lgkmcnt(4)
    v_mfma_f32_16x16x32_bf16 v[80:83], a[232:235], v[40:43], v[80:83]
    ds_read_b128 v[32:35], v12 offset:0
    v_mfma_f32_16x16x32_bf16 v[84:87], a[236:239], v[40:43], v[84:87]
    v_mfma_f32_16x16x32_bf16 v[88:91], a[232:235], v[44:47], v[88:91]
    ds_read_b128 v[36:39], v12 offset:256
    v_mfma_f32_16x16x32_bf16 v[92:95], a[236:239], v[44:47], v[92:95]
    s_waitcnt lgkmcnt(4)
    v_mfma_f32_16x16x32_bf16 v[80:83], a[240:243], v[48:51], v[80:83]
    ds_read_b128 v[40:43], v12 offset:2048
    v_mfma_f32_16x16x32_bf16 v[84:87], a[244:247], v[48:51], v[84:87]
    v_mfma_f32_16x16x32_bf16 v[88:91], a[240:243], v[52:55], v[88:91]
    ds_read_b128 v[44:47], v12 offset:2304
    s_add_u32 m0, s34, 77824
    s_add_u32 s32, s35, 12288
    v_mfma_f32_16x16x32_bf16 v[92:95], a[244:247], v[52:55], v[92:95]
    buffer_load_dwordx4 v8, s[12:15], s32 offen sc1 lds
    s_waitcnt lgkmcnt(4)
    v_mfma_f32_16x16x32_bf16 v[80:83], a[248:251], v[56:59], v[80:83]
    ds_read_b128 v[48:51], v12 offset:4096
    v_mfma_f32_16x16x32_bf16 v[84:87], a[252:255], v[56:59], v[84:87]
    v_mfma_f32_16x16x32_bf16 v[88:91], a[248:251], v[60:63], v[88:91]
    ds_read_b128 v[52:55], v12 offset:4352
    v_mfma_f32_16x16x32_bf16 v[92:95], a[252:255], v[60:63], v[92:95]
    s_add_u32 s30, s30, 2
    s_cmp_lt_u32 s30, s51
    s_cbranch_scc1 sl_loop_105
    v_cvt_pk_bf16_f32 v96, v80, v81
    v_cvt_pk_bf16_f32 v97, v82, v83
    v_cvt_pk_bf16_f32 v98, v84, v85
    v_cvt_pk_bf16_f32 v99, v86, v87
    v_cvt_pk_bf16_f32 v100, v88, v89
    v_cvt_pk_bf16_f32 v101, v90, v91
    v_cvt_pk_bf16_f32 v102, v92, v93
    v_cvt_pk_bf16_f32 v103, v94, v95
    s_branch sl_e_104
sl_e_104:
    buffer_store_dwordx4 v[96:99], v9, s[20:23], s36 offen
    s_add_u32 s31, s36, 65536
    buffer_store_dwordx4 v[100:103], v9, s[20:23], s31 offen
    s_add_u32 s36, s36, s37
    s_waitcnt vmcnt(0) lgkmcnt(0)
    s_barrier
    s_branch L_dump
L_dump:
L_end:
    s_endpgm
.section .rodata,"a"
.p2align 6
.amdhsa_kernel concat_heads__memory_aug_recurrent_mem_tr__sliding_local_dilated__prompt_kernel
  .amdhsa_next_free_vgpr 512
  .amdhsa_next_free_sgpr 102
  .amdhsa_accum_offset 256
  .amdhsa_group_segment_fixed_size 0
  .amdhsa_kernarg_size 104
  .amdhsa_user_sgpr_count 2
  .amdhsa_user_sgpr_kernarg_segment_ptr 1
  .amdhsa_system_sgpr_workgroup_id_x 1
.end_amdhsa_kernel
```

```asm
; @launch grid=(256,1,1) block=(256,1,1) lds=163840
.amdgcn_target "amdgcn-amd-amdhsa--gfx950"
.text
.globl concat_heads__memory_aug_recurrent_mem_tr__sliding_local_dilated__prompt_kernel
.p2align 8
.type concat_heads__memory_aug_recurrent_mem_tr__sliding_local_dilated__prompt_kernel,@function
concat_heads__memory_aug_recurrent_mem_tr__sliding_local_dilated__prompt_kernel:
    s_cmp_ge_u32 s2, 256
    s_cbranch_scc1 L_end
    s_getreg_b32 s6, hwreg(HW_REG_XCC_ID)
    s_sub_u32 s6, s6, s2
    s_and_b32 s6, s6, 7
    s_or_b32 s70, s6, 8
    s_mov_b32 s71, 0
    s_cmp_lg_u32 s2, 0
    s_cbranch_scc1 L_role
    s_load_dwordx2 s[4:5], s[0:1], 88
    v_mov_b32 v1, 0
    v_mov_b32 v2, s70
    s_waitcnt lgkmcnt(0)
    s_mov_b64 exec, 1
    global_store_dword v1, v2, s[4:5] offset:192 sc1
    s_mov_b64 exec, -1
L_role:
    s_add_u32 s7, s2, s70
    s_and_b32 s3, s7, 3
    s_lshl_b32 s3, s3, 5
    s_lshr_b32 s28, s2, 3
    s_add_u32 s28, s28, s3
    s_bitcmp1_b32 s7, 2
    s_cbranch_scc1 L_gem
L_rec:
    s_mov_b32 s6, L_gem - L_rec - 16
    s_load_dwordx2 s[72:73], s[0:1], 8
    s_load_dwordx4 s[76:79], s[0:1], 16
    s_load_dwordx4 s[80:83], s[0:1], 32
    s_load_dwordx2 s[90:91], s[0:1], 96
    s_load_dwordx2 s[92:93], s[0:1], 88
    v_and_b32 v1, 63, v0
    v_lshrrev_b32 v2, 6, v0
    s_nop 0
    v_readfirstlane_b32 s31, v2
    s_lshr_b32 s29, s28, 2
    s_and_b32 s30, s28, 3
    s_mov_b32 s41, 0
    s_waitcnt lgkmcnt(0)
    s_mov_b32 s24, s72
    s_and_b32 s25, s73, 0xffff
    s_mov_b32 s26, 16384
    s_mov_b32 s27, 0x00020000
    s_mov_b32 s8, s76
    s_and_b32 s9, s77, 0xffff
    s_mov_b32 s10, 8388608
    s_mov_b32 s11, 0x00020000
    s_mov_b32 s12, s78
    s_and_b32 s13, s79, 0xffff
    s_mov_b32 s14, 8388608
    s_mov_b32 s15, 0x00020000
    s_mov_b32 s16, s80
    s_and_b32 s17, s81, 0xffff
    s_mov_b32 s18, 8388608
    s_mov_b32 s19, 0x00020000
    s_mov_b32 s20, s82
    s_and_b32 s21, s83, 0xffff
    s_mov_b32 s22, 8388608
    s_mov_b32 s23, 0x00020000
    s_mov_b32 s4, s90
    s_and_b32 s5, s91, 0xffff
    s_mov_b32 s6, 268435456
    s_mov_b32 s7, 0x00020000
    s_sub_u32 s49, 0, s90
    s_and_b32 s49, s49, 2097151
    s_add_u32 s49, s49, 117440512
    s_mov_b32 s48, 0
rec_cal_1:
    s_lshl_b32 s38, s31, 21
    s_lshl_b32 s40, s28, 6
    s_add_u32 s38, s38, s40
    v_lshrrev_b32 v184, 2, v1
    v_lshlrev_b32 v184, 13, v184
    v_and_b32 v4, 3, v1
    v_lshl_add_u32 v184, v4, 4, v184
    v_add_u32 v184, s38, v184
    s_lshl_b32 s38, s31, 21
    s_lshr_b32 s40, s28, 1
    s_lshl_b32 s40, s40, 5
    s_add_u32 s38, s38, s40
    v_lshrrev_b32 v185, 1, v1
    v_lshlrev_b32 v185, 11, v185
    v_and_b32 v4, 1, v1
    v_lshl_add_u32 v185, v4, 4, v185
    v_add_u32 v185, s38, v185
    s_lshl_b32 s33, s31, 15
    v_lshrrev_b32 v186, 4, v1
    v_lshlrev_b32 v186, 9, v186
    v_bfe_u32 v4, v1, 2, 2
    v_lshl_add_u32 v186, v4, 6, v186
    v_and_b32 v4, 3, v1
    v_lshl_add_u32 v186, v4, 3, v186
    v_add_u32 v186, s33, v186
    v_lshrrev_b32 v187, 4, v1
    v_lshlrev_b32 v187, 8, v187
    v_bfe_u32 v4, v1, 2, 2
    v_lshl_add_u32 v187, v4, 5, v187
    v_and_b32 v4, 3, v1
    v_lshl_add_u32 v187, v4, 3, v187
    v_add_u32 v187, s33, v187
    s_lshl_b32 s38, s31, 21
    s_and_b32 s40, s28, 7
    s_lshl_b32 s40, s40, 14
    s_add_u32 s38, s38, s40
    s_lshr_b32 s40, s28, 3
    s_lshl_b32 s40, s40, 7
    s_add_u32 s38, s38, s40
    v_lshrrev_b32 v96, 3, v1
    v_lshlrev_b32 v96, 11, v96
    v_and_b32 v4, 7, v1
    v_lshl_add_u32 v96, v4, 4, v96
    v_add_u32 v96, s38, v96
    s_and_b32 s60, s28, 7
    s_lshl_b32 s60, s60, 18
    s_and_b32 s61, s28, 1
    s_lshl_b32 s61, s61, 20
    s_add_u32 m0, s33, 0
    s_mov_b32 s38, 0
    buffer_load_dwordx4 v184, s[8:11], s38 offen lds
    s_add_u32 m0, s33, 1024
    s_mov_b32 s38, 131072
    buffer_load_dwordx4 v184, s[8:11], s38 offen lds
    s_add_u32 m0, s33, 2048
    s_mov_b32 s38, 0
    buffer_load_dwordx4 v184, s[12:15], s38 offen lds
    s_add_u32 m0, s33, 3072
    s_mov_b32 s38, 131072
    buffer_load_dwordx4 v184, s[12:15], s38 offen lds
    s_add_u32 m0, s33, 4096
    s_mov_b32 s38, 0
    buffer_load_dwordx4 v184, s[16:19], s38 offen lds
    s_add_u32 m0, s33, 5120
    s_mov_b32 s38, 131072
    buffer_load_dwordx4 v184, s[16:19], s38 offen lds
    s_add_u32 m0, s33, 6144
    s_mov_b32 s38, 262144
    buffer_load_dwordx4 v184, s[8:11], s38 offen lds
    s_add_u32 m0, s33, 7168
    s_mov_b32 s38, 393216
    buffer_load_dwordx4 v184, s[8:11], s38 offen lds
    s_add_u32 m0, s33, 8192
    s_mov_b32 s38, 262144
    buffer_load_dwordx4 v184, s[12:15], s38 offen lds
    s_add_u32 m0, s33, 9216
    s_mov_b32 s38, 393216
    buffer_load_dwordx4 v184, s[12:15], s38 offen lds
    s_add_u32 m0, s33, 10240
    s_mov_b32 s38, 262144
    buffer_load_dwordx4 v184, s[16:19], s38 offen lds
    s_add_u32 m0, s33, 11264
    s_mov_b32 s38, 393216
    buffer_load_dwordx4 v184, s[16:19], s38 offen lds
    v_bfe_u32 v2, v1, 1, 1
    v_mov_b32 v3, 0xaaaa
    v_mul_u32_u24 v2, v2, v3
    v_add_u32 v5, 0x4444, v2
    v_lshlrev_b32 v16, 4, v1
    s_lshr_b32 s38, s28, 6
    s_lshl_b32 s38, s38, 14
    s_and_b32 s40, s28, 63
    s_lshl_b32 s40, s40, 7
    s_add_u32 s38, s38, s40
    s_add_u32 s38, s38, 131072
    v_lshl_add_u32 v6, v1, 2, s38
    s_lshr_b32 s38, s31, 1
    s_lshl_b32 s38, s38, 14
    s_and_b32 s40, s31, 1
    s_lshl_b32 s40, s40, 12
    s_add_u32 s38, s38, s40
    s_add_u32 s38, s38, 131072
    v_add_u32 v7, s38, v16
    s_and_b32 s38, s28, 1
    s_lshl_b32 s38, s38, 16
    s_lshl_b32 s40, s31, 14
    s_add_u32 s38, s38, s40
    v_add_u32 v12, s38, v16
    v_add_u32 v13, 4096, v12
    v_lshrrev_b32 v2, 4, v1
    v_mul_u32_u24 v2, 320, v2
    v_and_b32 v3, 15, v1
    v_lshl_add_u32 v2, v3, 2, v2
    s_mul_i32 s38, s31, 2560
    v_add_u32 v14, s38, v2
    v_add_u32 v15, 1280, v14
    s_lshl_b32 s38, s31, 10
    s_add_u32 s38, s38, 10240
    v_add_u32 v17, s38, v16
    v_and_b32 v2, 3, v1
    v_lshlrev_b32 v2, 1, v2
    v_bfe_u32 v4, v1, 2, 1
    v_lshl_add_u32 v2, v4, 0, v2
    v_add_u32 v2, 8, v2
    v_and_b32 v3, 15, v1
    v_cmp_gt_u32 vcc, 8, v3
    s_nop 1
    v_cndmask_b32 v3, v2, v3, vcc
    v_mul_u32_u24 v3, 160, v3
    v_lshrrev_b32 v2, 5, v1
    v_lshlrev_b32 v2, 6, v2
    v_bfe_u32 v4, v1, 4, 1
    v_lshl_add_u32 v2, v4, 4, v2
    v_add_u32 v18, v2, v3
    s_lshl_b32 s38, s28, 11
    v_add_u32 v19, s38, v16
    v_bfe_u32 v20, v1, 4, 1
    v_lshlrev_b32 v20, 7, v20
    v_and_b32 v4, 7, v1
    v_lshl_add_u32 v20, v4, 4, v20
    v_add_u32 v20, s38, v20
    s_add_u32 s39, s30, 1
    s_and_b32 s38, s39, 3
    s_lshl_b32 s38, s38, 11
    s_lshl_b32 s40, s29, 13
    s_add_u32 s38, s38, s40
    v_add_u32 v22, s38, v16
    s_add_u32 s39, s30, 2
    s_and_b32 s38, s39, 3
    s_lshl_b32 s38, s38, 11
    s_lshl_b32 s40, s29, 13
    s_add_u32 s38, s38, s40
    v_add_u32 v23, s38, v16
    s_add_u32 s39, s30, 3
    s_and_b32 s38, s39, 3
    s_lshl_b32 s38, s38, 11
    s_lshl_b32 s40, s29, 13
    s_add_u32 s38, s38, s40
    v_add_u32 v24, s38, v16
    s_lshl_b32 s38, s29, 13
    v_lshrrev_b32 v21, 4, v1
    v_lshlrev_b32 v21, 11, v21
    v_and_b32 v4, 15, v1
    v_lshl_add_u32 v21, v4, 4, v21
    v_add_u32 v21, s38, v21
    v_lshrrev_b32 v25, 4, v1
    v_lshlrev_b32 v25, 8, v25
    v_bfe_u32 v4, v1, 3, 1
    v_lshl_add_u32 v25, v4, 3, v25
    v_bfe_u32 v4, v1, 1, 1
    v_lshl_add_u32 v25, v4, 6, v25
    v_bfe_u32 v4, v1, 2, 1
    v_lshl_add_u32 v25, v4, 5, v25
    v_and_b32 v4, 1, v1
    v_lshl_add_u32 v25, v4, 4, v25
    v_add_u32 v25, 10240, v25
    s_lshl_b32 s38, s28, 11
    s_and_b32 s40, s31, 1
    s_lshl_b32 s40, s40, 7
    s_add_u32 s38, s38, s40
    s_add_u32 s38, s38, 16777216
    v_bfe_u32 v2, v1, 3, 1
    v_lshlrev_b32 v2, 8, v2
    v_and_b32 v4, 7, v1
    v_lshl_add_u32 v2, v4, 4, v2
    v_bfe_u32 v4, v1, 4, 1
    v_lshl_add_u32 v2, v4, 9, v2
    v_lshrrev_b32 v4, 5, v1
    v_lshl_add_u32 v2, v4, 10, v2
    v_add_u32 v2, s38, v2
    s_add_u32 s38, s38, 16777216
    v_bfe_u32 v3, v1, 3, 1
    v_lshlrev_b32 v3, 8, v3
    v_bfe_u32 v4, v1, 1, 1
    v_lshl_add_u32 v3, v4, 6, v3
    v_bfe_u32 v4, v1, 2, 1
    v_lshl_add_u32 v3, v4, 5, v3
    v_and_b32 v4, 1, v1
    v_lshl_add_u32 v3, v4, 4, v3
    v_bfe_u32 v4, v1, 4, 1
    v_lshl_add_u32 v3, v4, 9, v3
    v_lshrrev_b32 v4, 5, v1
    v_lshl_add_u32 v3, v4, 10, v3
    v_add_u32 v3, s38, v3
    s_cmp_lt_u32 s31, 2
    s_cselect_b64 vcc, -1, 0
    v_cndmask_b32 v30, v3, v2, vcc
    s_lshl_b32 s3, s31, 10
    s_lshr_b32 s38, s29, 3
    s_lshl_b32 s38, s38, 14
    s_and_b32 s40, s29, 7
    s_lshl_b32 s40, s40, 10
    s_add_u32 s38, s38, s40
    s_and_b32 s40, s30, 1
    s_lshl_b32 s40, s40, 9
    s_add_u32 s38, s38, s40
    s_lshr_b32 s40, s30, 1
    s_lshl_b32 s40, s40, 7
    s_add_u32 s38, s38, s40
    v_bfe_u32 v27, v1, 2, 1
    v_lshlrev_b32 v27, 16, v27
    v_lshrrev_b32 v4, 5, v1
    v_lshl_add_u32 v27, v4, 8, v27
    v_bfe_u32 v4, v1, 1, 1
    v_lshl_add_u32 v27, v4, 6, v27
    v_bfe_u32 v4, v1, 4, 1
    v_lshl_add_u32 v27, v4, 5, v27
    v_and_b32 v4, 1, v1
    v_lshl_add_u32 v27, v4, 4, v27
    v_add_u32 v27, s38, v27
    s_lshr_b32 s39, s31, 1
    s_lshl_b32 s39, s39, 16
    s_and_b32 s40, s31, 1
    s_lshl_b32 s40, s40, 8
    s_add_u32 s39, s39, s40
    s_add_u32 s39, s39, s38
    v_add_u32 v95, s39, v16
    v_cmp_gt_u32 vcc, 8, v1
    v_mov_b32 v4, 2130706432
    s_nop 0
    v_cndmask_b32 v95, v4, v95, vcc
    s_lshl_b32 s38, s31, 8
    s_add_u32 s38, s38, 14336
    v_lshl_add_u32 v28, v1, 2, s38
    v_bfe_u32 v29, v1, 2, 1
    v_lshlrev_b32 v29, 7, v29
    v_bfe_u32 v4, v1, 4, 1
    v_lshl_add_u32 v29, v4, 6, v29
    v_and_b32 v4, 3, v1
    v_lshl_add_u32 v29, v4, 4, v29
    v_bfe_u32 v4, v1, 3, 1
    v_lshl_add_u32 v29, v4, 3, v29
    v_add_u32 v29, 14336, v29
    s_mul_i32 s39, s31, 320
    s_lshl_b32 s38, s28, 11
    s_add_u32 s38, s38, s39
    v_add_u32 v94, s38, v16
    v_cmp_gt_u32 vcc, 20, v1
    v_mov_b32 v4, 2130706432
    s_nop 0
    v_cndmask_b32 v94, v4, v94, vcc
    s_mul_i32 s38, s31, 3
    v_min_u32 v2, 2, v1
    v_add_u32 v2, s38, v2
    v_min_u32 v2, 9, v2
    s_lshl_b32 s38, s28, 11
    s_add_u32 s38, s38, 262144
    v_lshl_add_u32 v92, v2, 7, s38
    s_lshl_b32 s38, s28, 9
    v_lshrrev_b32 v93, 4, v1
    v_lshlrev_b32 v93, 7, v93
    v_and_b32 v4, 3, v1
    v_lshl_add_u32 v93, v4, 5, v93
    v_bfe_u32 v4, v1, 2, 1
    v_lshl_add_u32 v93, v4, 4, v93
    v_add_u32 v93, s38, v93
    s_mov_b32 vcc_lo, 0xff00ff00
    s_mov_b32 vcc_hi, 0xff00ff00
    s_cmp_eq_u32 s31, 1
    s_cbranch_scc1 rec_ns_2
    s_add_u32 s38, s38, 4194304
    v_add_u32 v93, s38, v16
    s_mov_b32 vcc_lo, -1
    s_mov_b32 vcc_hi, 0
    s_cmp_eq_u32 s31, 2
    s_cbranch_scc1 rec_ns_2
    s_lshr_b32 s38, s28, 6
    s_lshl_b32 s38, s38, 14
    s_and_b32 s40, s28, 63
    s_lshl_b32 s40, s40, 7
    s_add_u32 s38, s38, s40
    s_add_u32 s38, s38, 131072
    v_add_u32 v93, s38, v16
    s_cmp_eq_u32 s31, 3
    s_cselect_b32 vcc_lo, 0xff, 0
rec_ns_2:
    s_nop 0
    v_mov_b32 v4, 2130706432
    v_cndmask_b32 v93, v4, v93, vcc
    v_mov_b32 v32, 0x3f803f80
    v_mov_b32 v33, 0x3f803f80
    v_mov_b32 v34, 0x3f803f80
    v_mov_b32 v35, 0x3f803f80
    v_mov_b32 v8, -1
    v_mov_b32 v9, -1
    v_mov_b32 v10, -1
    v_mov_b32 v11, -1
    v_mov_b32 v144, 0
    v_mov_b32 v145, 0
    v_mov_b32 v146, 0
    v_mov_b32 v147, 0
    v_mov_b32 v180, 0
    v_mov_b32 v181, 0
    v_mov_b32 v182, 0
    v_mov_b32 v183, 0
    v_mov_b32 v161, 0
    v_mov_b32 v162, 0
    v_mov_b32 v163, 0
    v_mov_b32 v138, 0
    v_mov_b32 v139, 0
    v_mov_b32 v140, 0
    v_mov_b32 v141, 0
    v_mov_b32 v142, 0
    v_mov_b32 v143, 0
    s_mov_b32 s42, 0x00ff00ff
    s_mov_b32 s43, 0x00ff00ff
    s_mov_b32 s44, 0
    s_mov_b32 s45, -1
    s_mov_b32 s46, 0
    s_mov_b32 s47, 0x00ff00ff
    s_mov_b32 s50, 0x3e0293ee
    s_mov_b32 s36, 96468992
    s_mov_b32 s37, 0
    s_mov_b32 s32, 0
    s_mov_b32 s51, 131072
    s_mov_b32 s54, 1
    s_min_u32 s38, s31, 1
    s_add_u32 s38, s38, 1
    v_mov_b32 v134, s38
    s_lshl_b32 s95, s29, 7
    s_lshr_b32 s40, s31, 1
    s_lshl_b32 s40, s40, 2
    s_add_u32 s95, s95, s40
    s_add_u32 s95, s95, 115343364
    s_lshl_b32 s97, s29, 7
    s_add_u32 s97, s97, 115351552
    s_lshl_b32 s38, s30, 4
    s_add_u32 s38, s38, s97
    v_mov_b32 v137, s38
    s_cmp_eq_u32 s31, 2
    s_cselect_b64 vcc, 1, 0
    v_mov_b32 v4, 2130706432
    v_cndmask_b32 v137, v4, v137, vcc
    s_mov_b32 s94, 0
    s_add_u32 s38, s49, 0
    buffer_store_dwordx4 v[144:147], v95, s[4:7], s38 offen sc1
    s_add_u32 s38, s49, 262144
    buffer_store_dwordx4 v[144:147], v95, s[4:7], s38 offen sc1
    s_add_u32 s38, s49, 8192
    buffer_store_dwordx4 v[144:147], v95, s[4:7], s38 offen sc1
    s_add_u32 s38, s49, 270336
    buffer_store_dwordx4 v[144:147], v95, s[4:7], s38 offen sc1
    buffer_store_dwordx4 v[8:11], v94, s[4:7], s36 offen sc1
    v_add_u32 v94, 262144, v94
    buffer_store_dwordx4 v[8:11], v94, s[4:7], s36 offen sc1
    v_add_u32 v94, 262144, v94
    buffer_store_dwordx4 v[8:11], v94, s[4:7], s36 offen sc1
    buffer_store_dword v144, v137, s[4:7], 0 offen sc1
    s_cmp_lg_u32 s31, 3
    s_cbranch_scc1 rec_i3_3
    s_add_u32 s38, s49, 262144
    buffer_store_dwordx4 v[144:147], v93, s[4:7], s38 offen sc1
    s_add_u32 s38, s49, 270336
    buffer_store_dwordx4 v[144:147], v93, s[4:7], s38 offen sc1
    s_lshr_b32 s39, s28, 5
    s_lshl_b32 s39, s39, 14
    s_and_b32 s40, s28, 31
    s_lshl_b32 s40, s40, 8
    s_add_u32 s39, s39, s40
    s_add_u32 s39, s39, s49
    s_add_u32 s39, s39, 163840
    s_mov_b64 exec, 0xffff
    s_add_u32 s38, s39, 0
    buffer_store_dwordx4 v[144:147], v16, s[4:7], s38 offen sc1
    s_add_u32 s38, s39, 8192
    buffer_store_dwordx4 v[144:147], v16, s[4:7], s38 offen sc1
    s_mov_b64 exec, -1
rec_i3_3:
    s_lshl_b32 s38, s31, 9
    v_bfe_u32 v2, v1, 2, 2
    v_lshlrev_b32 v2, 12, v2
    v_and_b32 v4, 1, v1
    v_lshl_add_u32 v2, v4, 11, v2
    v_lshrrev_b32 v4, 4, v1
    v_lshl_add_u32 v2, v4, 5, v2
    v_bfe_u32 v4, v1, 1, 1
    v_lshl_add_u32 v2, v4, 2, v2
    v_add_u32 v2, s38, v2
    s_mov_b32 s38, 0
    s_xor_b32 s38, s38, 0
    buffer_load_dword v36, v2, s[24:27], s38 offen offset:0
    buffer_load_dword v37, v2, s[24:27], s38 offen offset:8
    buffer_load_dword v38, v2, s[24:27], s38 offen offset:16
    buffer_load_dword v39, v2, s[24:27], s38 offen offset:24
    buffer_load_dword v40, v2, s[24:27], s38 offen offset:128
    buffer_load_dword v41, v2, s[24:27], s38 offen offset:136
    buffer_load_dword v42, v2, s[24:27], s38 offen offset:144
    buffer_load_dword v43, v2, s[24:27], s38 offen offset:152
    s_mov_b32 s38, 0
    s_xor_b32 s38, s38, 256
    buffer_load_dword v44, v2, s[24:27], s38 offen offset:0
    buffer_load_dword v45, v2, s[24:27], s38 offen offset:8
    buffer_load_dword v46, v2, s[24:27], s38 offen offset:16
    buffer_load_dword v47, v2, s[24:27], s38 offen offset:24
    buffer_load_dword v48, v2, s[24:27], s38 offen offset:128
    buffer_load_dword v49, v2, s[24:27], s38 offen offset:136
    buffer_load_dword v50, v2, s[24:27], s38 offen offset:144
    buffer_load_dword v51, v2, s[24:27], s38 offen offset:152
    s_add_u32 m0, s33, 12288
    s_mov_b32 s38, 524288
    buffer_load_dwordx4 v184, s[8:11], s38 offen lds
    s_add_u32 m0, s33, 13312
    s_mov_b32 s38, 655360
    buffer_load_dwordx4 v184, s[8:11], s38 offen lds
    s_add_u32 m0, s33, 14336
    s_mov_b32 s38, 524288
    buffer_load_dwordx4 v184, s[12:15], s38 offen lds
    s_add_u32 m0, s33, 15360
    s_mov_b32 s38, 655360
    buffer_load_dwordx4 v184, s[12:15], s38 offen lds
    s_add_u32 m0, s33, 16384
    s_mov_b32 s38, 524288
    buffer_load_dwordx4 v184, s[16:19], s38 offen lds
    s_add_u32 m0, s33, 17408
    s_mov_b32 s38, 655360
    buffer_load_dwordx4 v184, s[16:19], s38 offen lds
    s_add_u32 m0, s33, 18432
    s_mov_b32 s38, 786432
    buffer_load_dwordx4 v184, s[8:11], s38 offen lds
    s_add_u32 m0, s33, 19456
    s_mov_b32 s38, 917504
    buffer_load_dwordx4 v184, s[8:11], s38 offen lds
    s_add_u32 m0, s33, 20480
    s_mov_b32 s38, 786432
    buffer_load_dwordx4 v184, s[12:15], s38 offen lds
    s_add_u32 m0, s33, 21504
    s_mov_b32 s38, 917504
    buffer_load_dwordx4 v184, s[12:15], s38 offen lds
    s_add_u32 m0, s33, 22528
    s_mov_b32 s38, 786432
    buffer_load_dwordx4 v184, s[16:19], s38 offen lds
    s_add_u32 m0, s33, 23552
    s_mov_b32 s38, 917504
    buffer_load_dwordx4 v184, s[16:19], s38 offen lds
    s_add_u32 m0, s33, 24576
    s_mov_b32 s38, 1048576
    buffer_load_dwordx4 v184, s[8:11], s38 offen lds
    s_add_u32 m0, s33, 25600
    s_mov_b32 s38, 1179648
    buffer_load_dwordx4 v184, s[8:11], s38 offen lds
    s_add_u32 m0, s33, 26624
    s_mov_b32 s38, 1048576
    buffer_load_dwordx4 v184, s[12:15], s38 offen lds
    s_add_u32 m0, s33, 27648
    s_mov_b32 s38, 1179648
    buffer_load_dwordx4 v184, s[12:15], s38 offen lds
    s_add_u32 m0, s33, 28672
    s_mov_b32 s38, 1048576
    buffer_load_dwordx4 v184, s[16:19], s38 offen lds
    s_add_u32 m0, s33, 29696
    s_mov_b32 s38, 1179648
    buffer_load_dwordx4 v184, s[16:19], s38 offen lds
    s_add_u32 m0, s33, 30720
    s_mov_b32 s38, 1310720
    buffer_load_dwordx4 v184, s[8:11], s38 offen lds
    s_add_u32 m0, s33, 31744
    s_mov_b32 s38, 1441792
    buffer_load_dwordx4 v184, s[8:11], s38 offen lds
    s_waitcnt vmcnt(54)
    ds_read_b64_tr_b16 a[0:1], v186 offset:0
    ds_read_b64_tr_b16 a[2:3], v186 offset:256
    ds_read_b64_tr_b16 a[8:9], v186 offset:32
    ds_read_b64_tr_b16 a[10:11], v186 offset:288
    s_waitcnt vmcnt(52)
    ds_read_b64_tr_b16 a[16:17], v186 offset:2048
    ds_read_b64_tr_b16 a[18:19], v186 offset:2304
    ds_read_b64_tr_b16 a[24:25], v186 offset:2080
    ds_read_b64_tr_b16 a[26:27], v186 offset:2336
    s_waitcnt lgkmcnt(4)
    s_add_u32 m0, s33, 0
    s_mov_b32 s38, 1310720
    buffer_load_dwordx4 v184, s[12:15], s38 offen lds
    s_add_u32 m0, s33, 1024
    s_mov_b32 s38, 1441792
    buffer_load_dwordx4 v184, s[12:15], s38 offen lds
    s_waitcnt vmcnt(52)
    global_load_dword v31, v144, s[92:93] offset:192 sc1
    ds_read_b64_tr_b16 a[32:33], v186 offset:4096
    ds_read_b64_tr_b16 a[34:35], v186 offset:4352
    ds_read_b64_tr_b16 a[40:41], v186 offset:4128
    ds_read_b64_tr_b16 a[42:43], v186 offset:4384
    s_waitcnt lgkmcnt(4)
    s_add_u32 m0, s33, 2048
    s_mov_b32 s38, 1310720
    buffer_load_dwordx4 v184, s[16:19], s38 offen lds
    s_add_u32 m0, s33, 3072
    s_mov_b32 s38, 1441792
    buffer_load_dwordx4 v184, s[16:19], s38 offen lds
    s_waitcnt vmcnt(53)
    ds_read_b64_tr_b16 a[4:5], v186 offset:6144
    ds_read_b64_tr_b16 a[6:7], v186 offset:6400
    ds_read_b64_tr_b16 a[12:13], v186 offset:6176
    ds_read_b64_tr_b16 a[14:15], v186 offset:6432
    s_waitcnt lgkmcnt(4)
    s_add_u32 m0, s33, 4096
    s_mov_b32 s38, 1572864
    buffer_load_dwordx4 v184, s[8:11], s38 offen lds
    s_add_u32 m0, s33, 5120
    s_mov_b32 s38, 1703936
    buffer_load_dwordx4 v184, s[8:11], s38 offen lds
    s_waitcnt vmcnt(53)
    ds_read_b64_tr_b16 a[20:21], v186 offset:8192
    ds_read_b64_tr_b16 a[22:23], v186 offset:8448
    ds_read_b64_tr_b16 a[28:29], v186 offset:8224
    ds_read_b64_tr_b16 a[30:31], v186 offset:8480
    s_waitcnt lgkmcnt(4)
    s_add_u32 m0, s33, 6144
    s_mov_b32 s38, 1572864
    buffer_load_dwordx4 v184, s[12:15], s38 offen lds
    s_add_u32 m0, s33, 7168
    s_mov_b32 s38, 1703936
    buffer_load_dwordx4 v184, s[12:15], s38 offen lds
    s_waitcnt vmcnt(53)
    ds_read_b64_tr_b16 a[36:37], v186 offset:10240
    ds_read_b64_tr_b16 a[38:39], v186 offset:10496
    ds_read_b64_tr_b16 a[44:45], v186 offset:10272
    ds_read_b64_tr_b16 a[46:47], v186 offset:10528
    s_waitcnt lgkmcnt(4)
    s_add_u32 m0, s33, 8192
    s_mov_b32 s38, 1572864
    buffer_load_dwordx4 v184, s[16:19], s38 offen lds
    s_add_u32 m0, s33, 9216
    s_mov_b32 s38, 1703936
    buffer_load_dwordx4 v184, s[16:19], s38 offen lds
    s_waitcnt vmcnt(29)
    ds_read_b64_tr_b16 a[48:49], v186 offset:12288
    ds_read_b64_tr_b16 a[50:51], v186 offset:12544
    ds_read_b64_tr_b16 a[56:57], v186 offset:12320
    ds_read_b64_tr_b16 a[58:59], v186 offset:12576
    s_waitcnt lgkmcnt(4)
    s_add_u32 m0, s33, 10240
    s_mov_b32 s38, 1835008
    buffer_load_dwordx4 v184, s[8:11], s38 offen lds
    s_add_u32 m0, s33, 11264
    s_mov_b32 s38, 1966080
    buffer_load_dwordx4 v184, s[8:11], s38 offen lds
    s_waitcnt vmcnt(29)
    ds_read_b64_tr_b16 a[64:65], v186 offset:14336
    ds_read_b64_tr_b16 a[66:67], v186 offset:14592
    ds_read_b64_tr_b16 a[72:73], v186 offset:14368
    ds_read_b64_tr_b16 a[74:75], v186 offset:14624
    s_waitcnt lgkmcnt(4)
    s_add_u32 m0, s33, 12288
    s_mov_b32 s38, 1835008
    buffer_load_dwordx4 v184, s[12:15], s38 offen lds
    s_add_u32 m0, s33, 13312
    s_mov_b32 s38, 1966080
    buffer_load_dwordx4 v184, s[12:15], s38 offen lds
    s_waitcnt vmcnt(29)
    ds_read_b64_tr_b16 a[80:81], v186 offset:16384
    ds_read_b64_tr_b16 a[82:83], v186 offset:16640
    ds_read_b64_tr_b16 a[88:89], v186 offset:16416
    ds_read_b64_tr_b16 a[90:91], v186 offset:16672
    s_waitcnt lgkmcnt(4)
    s_add_u32 m0, s33, 14336
    s_mov_b32 s38, 1835008
    buffer_load_dwordx4 v184, s[16:19], s38 offen lds
    s_add_u32 m0, s33, 15360
    s_mov_b32 s38, 1966080
    buffer_load_dwordx4 v184, s[16:19], s38 offen lds
    s_waitcnt vmcnt(29)
    ds_read_b64_tr_b16 a[52:53], v186 offset:18432
    ds_read_b64_tr_b16 a[54:55], v186 offset:18688
    ds_read_b64_tr_b16 a[60:61], v186 offset:18464
    ds_read_b64_tr_b16 a[62:63], v186 offset:18720
    s_waitcnt lgkmcnt(4)
    s_add_u32 m0, s33, 16384
    s_mov_b32 s38, 0
    buffer_load_dwordx4 v185, s[20:23], s38 offen lds
    s_add_u32 m0, s33, 17408
    s_mov_b32 s38, 65536
    buffer_load_dwordx4 v185, s[20:23], s38 offen lds
    s_waitcnt vmcnt(29)
    ds_read_b64_tr_b16 a[68:69], v186 offset:20480
    ds_read_b64_tr_b16 a[70:71], v186 offset:20736
    ds_read_b64_tr_b16 a[76:77], v186 offset:20512
    ds_read_b64_tr_b16 a[78:79], v186 offset:20768
    s_waitcnt lgkmcnt(4)
    s_add_u32 m0, s33, 18432
    s_mov_b32 s38, 131072
    buffer_load_dwordx4 v185, s[20:23], s38 offen lds
    s_add_u32 m0, s33, 19456
    s_mov_b32 s38, 196608
    buffer_load_dwordx4 v185, s[20:23], s38 offen lds
    s_waitcnt vmcnt(29)
    ds_read_b64_tr_b16 a[84:85], v186 offset:22528
    ds_read_b64_tr_b16 a[86:87], v186 offset:22784
    ds_read_b64_tr_b16 a[92:93], v186 offset:22560
    ds_read_b64_tr_b16 a[94:95], v186 offset:22816
    s_waitcnt lgkmcnt(4)
    s_add_u32 m0, s33, 20480
    s_mov_b32 s38, 262144
    buffer_load_dwordx4 v185, s[20:23], s38 offen lds
    s_add_u32 m0, s33, 21504
    s_mov_b32 s38, 327680
    buffer_load_dwordx4 v185, s[20:23], s38 offen lds
    s_waitcnt vmcnt(29)
    ds_read_b64_tr_b16 a[96:97], v186 offset:24576
    ds_read_b64_tr_b16 a[98:99], v186 offset:24832
    ds_read_b64_tr_b16 a[104:105], v186 offset:24608
    ds_read_b64_tr_b16 a[106:107], v186 offset:24864
    s_waitcnt lgkmcnt(4)
    s_add_u32 m0, s33, 22528
    s_mov_b32 s38, 393216
    buffer_load_dwordx4 v185, s[20:23], s38 offen lds
    s_add_u32 m0, s33, 23552
    s_mov_b32 s38, 458752
    buffer_load_dwordx4 v185, s[20:23], s38 offen lds
    s_waitcnt vmcnt(29)
    ds_read_b64_tr_b16 a[112:113], v186 offset:26624
    ds_read_b64_tr_b16 a[114:115], v186 offset:26880
    ds_read_b64_tr_b16 a[120:121], v186 offset:26656
    ds_read_b64_tr_b16 a[122:123], v186 offset:26912
    s_waitcnt lgkmcnt(4)
    s_add_u32 m0, s33, 24576
    s_mov_b32 s38, 524288
    buffer_load_dwordx4 v185, s[20:23], s38 offen lds
    s_add_u32 m0, s33, 25600
    s_mov_b32 s38, 589824
    buffer_load_dwordx4 v185, s[20:23], s38 offen lds
    s_waitcnt vmcnt(29)
    ds_read_b64_tr_b16 a[128:129], v186 offset:28672
    ds_read_b64_tr_b16 a[130:131], v186 offset:28928
    ds_read_b64_tr_b16 a[136:137], v186 offset:28704
    ds_read_b64_tr_b16 a[138:139], v186 offset:28960
    s_waitcnt lgkmcnt(4)
    s_add_u32 m0, s33, 26624
    s_mov_b32 s38, 655360
    buffer_load_dwordx4 v185, s[20:23], s38 offen lds
    s_add_u32 m0, s33, 27648
    s_mov_b32 s38, 720896
    buffer_load_dwordx4 v185, s[20:23], s38 offen lds
    s_waitcnt vmcnt(29)
    ds_read_b64_tr_b16 a[100:101], v186 offset:30720
    ds_read_b64_tr_b16 a[102:103], v186 offset:30976
    ds_read_b64_tr_b16 a[108:109], v186 offset:30752
    ds_read_b64_tr_b16 a[110:111], v186 offset:31008
    s_waitcnt lgkmcnt(4)
    s_add_u32 m0, s33, 28672
    s_mov_b32 s38, 786432
    buffer_load_dwordx4 v185, s[20:23], s38 offen lds
    s_add_u32 m0, s33, 29696
    s_mov_b32 s38, 851968
    buffer_load_dwordx4 v185, s[20:23], s38 offen lds
    s_waitcnt vmcnt(29)
    ds_read_b64_tr_b16 a[116:117], v186 offset:0
    ds_read_b64_tr_b16 a[118:119], v186 offset:256
    ds_read_b64_tr_b16 a[124:125], v186 offset:32
    ds_read_b64_tr_b16 a[126:127], v186 offset:288
    s_waitcnt lgkmcnt(4)
    s_add_u32 m0, s33, 30720
    s_mov_b32 s38, 917504
    buffer_load_dwordx4 v185, s[20:23], s38 offen lds
    s_add_u32 m0, s33, 31744
    s_mov_b32 s38, 983040
    buffer_load_dwordx4 v185, s[20:23], s38 offen lds
    s_waitcnt vmcnt(28)
    s_branch valc_6
val_5:
    v_mov_b32 v2, 0
    global_load_dword v31, v2, s[92:93] offset:192 sc1
    s_add_u32 s41, s41, 1
    s_cmp_ge_u32 s41, 0x80000
    s_cbranch_scc1 L_end
    s_waitcnt vmcnt(0)
valc_6:
    v_readfirstlane_b32 s38, v31
    s_cmp_eq_u32 s38, s70
    s_cbranch_scc1 valok_7
    s_cmp_eq_u32 s38, 0
    s_cbranch_scc1 val_5
    s_mov_b32 s70, s38
    s_mov_b32 s71, 65536
    s_waitcnt vmcnt(0) lgkmcnt(0)
    s_barrier
    s_branch L_role
valok_7:
    s_barrier
rec_arr_4:
    ds_read_b64_tr_b16 a[132:133], v186 offset:2048
    ds_read_b64_tr_b16 a[134:135], v186 offset:2304
    ds_read_b64_tr_b16 a[140:141], v186 offset:2080
    ds_read_b64_tr_b16 a[142:143], v186 offset:2336
    s_waitcnt lgkmcnt(4)
    s_add_u32 m0, s33, 0
    s_mov_b32 s38, 1048576
    buffer_load_dwordx4 v185, s[20:23], s38 offen lds
    s_add_u32 m0, s33, 1024
    s_mov_b32 s38, 1114112
    buffer_load_dwordx4 v185, s[20:23], s38 offen lds
    s_waitcnt vmcnt(28)
    s_mov_b32 s24, s92
    s_and_b32 s25, s93, 0xffff
    s_mov_b32 s26, 256
    s_mov_b32 s27, 0x00020000
    s_add_u32 s48, s48, s71
    s_mov_b32 s38, 2130706432
    s_cmp_eq_u32 s31, 0
    s_cselect_b32 s38, 128, s38
    s_cselect_b32 s39, 0, s48
    s_cmp_eq_u32 s31, 3
    s_cselect_b32 s38, 0, s38
    v_mov_b32 v4, s38
    v_mov_b32 v2, 1
    v_mov_b32 v3, s39
    s_mov_b64 exec, 1
    buffer_atomic_add_x2 v[2:3], v4, s[24:27], 0 offen sc1
    s_mov_b64 exec, -1
    ds_read_b64_tr_b16 a[144:145], v186 offset:4096
    ds_read_b64_tr_b16 a[146:147], v186 offset:4352
    ds_read_b64_tr_b16 a[152:153], v186 offset:4128
    ds_read_b64_tr_b16 a[154:155], v186 offset:4384
    s_waitcnt lgkmcnt(4)
    s_add_u32 m0, s33, 2048
    s_mov_b32 s38, 1179648
    buffer_load_dwordx4 v185, s[20:23], s38 offen lds
    s_add_u32 m0, s33, 3072
    s_mov_b32 s38, 1245184
    buffer_load_dwordx4 v185, s[20:23], s38 offen lds
    s_waitcnt vmcnt(29)
    ds_read_b64_tr_b16 a[160:161], v186 offset:6144
    ds_read_b64_tr_b16 a[162:163], v186 offset:6400
    ds_read_b64_tr_b16 a[168:169], v186 offset:6176
    ds_read_b64_tr_b16 a[170:171], v186 offset:6432
    s_waitcnt lgkmcnt(4)
    s_add_u32 m0, s33, 4096
    s_mov_b32 s38, 1310720
    buffer_load_dwordx4 v185, s[20:23], s38 offen lds
    s_add_u32 m0, s33, 5120
    s_mov_b32 s38, 1376256
    buffer_load_dwordx4 v185, s[20:23], s38 offen lds
    s_waitcnt vmcnt(29)
    ds_read_b64_tr_b16 a[176:177], v186 offset:8192
    ds_read_b64_tr_b16 a[178:179], v186 offset:8448
    ds_read_b64_tr_b16 a[184:185], v186 offset:8224
    ds_read_b64_tr_b16 a[186:187], v186 offset:8480
    s_waitcnt lgkmcnt(4)
    s_add_u32 m0, s33, 6144
    s_mov_b32 s38, 1441792
    buffer_load_dwordx4 v185, s[20:23], s38 offen lds
    s_add_u32 m0, s33, 7168
    s_mov_b32 s38, 1507328
    buffer_load_dwordx4 v185, s[20:23], s38 offen lds
    s_waitcnt vmcnt(29)
    ds_read_b64_tr_b16 a[148:149], v186 offset:10240
    ds_read_b64_tr_b16 a[150:151], v186 offset:10496
    ds_read_b64_tr_b16 a[156:157], v186 offset:10272
    ds_read_b64_tr_b16 a[158:159], v186 offset:10528
    s_waitcnt lgkmcnt(4)
    s_add_u32 m0, s33, 8192
    s_mov_b32 s38, 1572864
    buffer_load_dwordx4 v185, s[20:23], s38 offen lds
    s_add_u32 m0, s33, 9216
    s_mov_b32 s38, 1638400
    buffer_load_dwordx4 v185, s[20:23], s38 offen lds
    s_waitcnt vmcnt(29)
    ds_read_b64_tr_b16 a[164:165], v186 offset:12288
    ds_read_b64_tr_b16 a[166:167], v186 offset:12544
    ds_read_b64_tr_b16 a[172:173], v186 offset:12320
    ds_read_b64_tr_b16 a[174:175], v186 offset:12576
    s_waitcnt lgkmcnt(4)
    s_add_u32 m0, s33, 10240
    s_mov_b32 s38, 1703936
    buffer_load_dwordx4 v185, s[20:23], s38 offen lds
    s_add_u32 m0, s33, 11264
    s_mov_b32 s38, 1769472
    buffer_load_dwordx4 v185, s[20:23], s38 offen lds
    s_waitcnt vmcnt(29)
    ds_read_b64_tr_b16 a[180:181], v186 offset:14336
    ds_read_b64_tr_b16 a[182:183], v186 offset:14592
    ds_read_b64_tr_b16 a[188:189], v186 offset:14368
    ds_read_b64_tr_b16 a[190:191], v186 offset:14624
    s_waitcnt lgkmcnt(4)
    s_add_u32 m0, s33, 12288
    s_mov_b32 s38, 1835008
    buffer_load_dwordx4 v185, s[20:23], s38 offen lds
    s_add_u32 m0, s33, 13312
    s_mov_b32 s38, 1900544
    buffer_load_dwordx4 v185, s[20:23], s38 offen lds
    s_waitcnt vmcnt(29)
    ds_read_b64_tr_b16 a[192:193], v187 offset:16384
    ds_read_b64_tr_b16 a[194:195], v187 offset:16512
    ds_read_b64_tr_b16 a[196:197], v187 offset:17408
    ds_read_b64_tr_b16 a[198:199], v187 offset:17536
    s_waitcnt lgkmcnt(4)
    s_add_u32 m0, s33, 14336
    s_mov_b32 s38, 1966080
    buffer_load_dwordx4 v185, s[20:23], s38 offen lds
    s_add_u32 m0, s33, 15360
    s_mov_b32 s38, 2031616
    buffer_load_dwordx4 v185, s[20:23], s38 offen lds
    s_waitcnt vmcnt(29)
    ds_read_b64_tr_b16 a[200:201], v187 offset:18432
    ds_read_b64_tr_b16 a[202:203], v187 offset:18560
    ds_read_b64_tr_b16 a[204:205], v187 offset:19456
    ds_read_b64_tr_b16 a[206:207], v187 offset:19584
    s_waitcnt vmcnt(27)
    ds_read_b64_tr_b16 a[208:209], v187 offset:20480
    ds_read_b64_tr_b16 a[210:211], v187 offset:20608
    ds_read_b64_tr_b16 a[212:213], v187 offset:21504
    ds_read_b64_tr_b16 a[214:215], v187 offset:21632
    s_waitcnt vmcnt(25)
    ds_read_b64_tr_b16 a[216:217], v187 offset:22528
    ds_read_b64_tr_b16 a[218:219], v187 offset:22656
    ds_read_b64_tr_b16 a[220:221], v187 offset:23552
    ds_read_b64_tr_b16 a[222:223], v187 offset:23680
    s_waitcnt vmcnt(23)
    ds_read_b64_tr_b16 a[224:225], v187 offset:24576
    ds_read_b64_tr_b16 a[226:227], v187 offset:24704
    ds_read_b64_tr_b16 a[228:229], v187 offset:25600
    ds_read_b64_tr_b16 a[230:231], v187 offset:25728
    s_waitcnt vmcnt(21)
    ds_read_b64_tr_b16 a[232:233], v187 offset:26624
    ds_read_b64_tr_b16 a[234:235], v187 offset:26752
    ds_read_b64_tr_b16 a[236:237], v187 offset:27648
    ds_read_b64_tr_b16 a[238:239], v187 offset:27776
    s_waitcnt vmcnt(19)
    ds_read_b64_tr_b16 a[240:241], v187 offset:28672
    ds_read_b64_tr_b16 a[242:243], v187 offset:28800
    ds_read_b64_tr_b16 a[244:245], v187 offset:29696
    ds_read_b64_tr_b16 a[246:247], v187 offset:29824
    s_waitcnt vmcnt(17)
    ds_read_b64_tr_b16 a[248:249], v187 offset:30720
    ds_read_b64_tr_b16 a[250:251], v187 offset:30848
    ds_read_b64_tr_b16 a[252:253], v187 offset:31744
    ds_read_b64_tr_b16 a[254:255], v187 offset:31872
    s_waitcnt vmcnt(15)
    ds_read_b64_tr_b16 v[192:193], v187 offset:0
    ds_read_b64_tr_b16 v[194:195], v187 offset:128
    ds_read_b64_tr_b16 v[196:197], v187 offset:1024
    ds_read_b64_tr_b16 v[198:199], v187 offset:1152
    s_waitcnt vmcnt(12)
    ds_read_b64_tr_b16 v[200:201], v187 offset:2048
    ds_read_b64_tr_b16 v[202:203], v187 offset:2176
    ds_read_b64_tr_b16 v[204:205], v187 offset:3072
    ds_read_b64_tr_b16 v[206:207], v187 offset:3200
    s_waitcnt vmcnt(10)
    ds_read_b64_tr_b16 v[208:209], v187 offset:4096
    ds_read_b64_tr_b16 v[210:211], v187 offset:4224
    ds_read_b64_tr_b16 v[212:213], v187 offset:5120
    ds_read_b64_tr_b16 v[214:215], v187 offset:5248
    s_waitcnt vmcnt(8)
    ds_read_b64_tr_b16 v[216:217], v187 offset:6144
    ds_read_b64_tr_b16 v[218:219], v187 offset:6272
    ds_read_b64_tr_b16 v[220:221], v187 offset:7168
    ds_read_b64_tr_b16 v[222:223], v187 offset:7296
    s_waitcnt vmcnt(6)
    ds_read_b64_tr_b16 v[224:225], v187 offset:8192
    ds_read_b64_tr_b16 v[226:227], v187 offset:8320
    ds_read_b64_tr_b16 v[228:229], v187 offset:9216
    ds_read_b64_tr_b16 v[230:231], v187 offset:9344
    s_waitcnt vmcnt(4)
    ds_read_b64_tr_b16 v[232:233], v187 offset:10240
    ds_read_b64_tr_b16 v[234:235], v187 offset:10368
    ds_read_b64_tr_b16 v[236:237], v187 offset:11264
    ds_read_b64_tr_b16 v[238:239], v187 offset:11392
    s_waitcnt vmcnt(2)
    global_load_dwordx2 v[98:99], v144, s[92:93] offset:0 sc1
    ds_read_b64_tr_b16 v[240:241], v187 offset:12288
    ds_read_b64_tr_b16 v[242:243], v187 offset:12416
    ds_read_b64_tr_b16 v[244:245], v187 offset:13312
    ds_read_b64_tr_b16 v[246:247], v187 offset:13440
    s_waitcnt vmcnt(1)
    ds_read_b64_tr_b16 v[248:249], v187 offset:14336
    ds_read_b64_tr_b16 v[250:251], v187 offset:14464
    ds_read_b64_tr_b16 v[252:253], v187 offset:15360
    ds_read_b64_tr_b16 v[254:255], v187 offset:15488
    s_waitcnt lgkmcnt(0)
    v_max_u32 v36, 1, v36
    v_max_u32 v37, 1, v37
    v_max_u32 v38, 1, v38
    v_max_u32 v39, 1, v39
    v_max_u32 v40, 1, v40
    v_max_u32 v41, 1, v41
    v_max_u32 v42, 1, v42
    v_max_u32 v43, 1, v43
    v_max_u32 v44, 1, v44
    v_max_u32 v45, 1, v45
    v_max_u32 v46, 1, v46
    v_max_u32 v47, 1, v47
    v_max_u32 v48, 1, v48
    v_max_u32 v49, 1, v49
    v_max_u32 v50, 1, v50
    v_max_u32 v51, 1, v51
    v_mov_b32 v68, 0
    v_mov_b32 v69, 0
    v_mov_b32 v70, 0
    v_mov_b32 v71, 0
    v_mov_b32 v72, 0
    v_mov_b32 v73, 0
    v_mov_b32 v74, 0
    v_mov_b32 v75, 0
    v_mov_b32 v76, 0
    v_mov_b32 v77, 0
    v_mov_b32 v78, 0
    v_mov_b32 v79, 0
    v_mov_b32 v80, 0
    v_mov_b32 v81, 0
    v_mov_b32 v82, 0
    v_mov_b32 v83, 0
    v_mov_b32 v84, 0
    v_mov_b32 v85, 0
    v_mov_b32 v86, 0
    v_mov_b32 v87, 0
    v_mov_b32 v88, 0
    v_mov_b32 v89, 0
    v_mov_b32 v90, 0
    v_mov_b32 v91, 0
    s_mov_b32 s72, 0
    s_mov_b32 s73, 0
    s_mov_b32 s74, 0
    s_mov_b32 s75, 0
    s_mov_b32 s76, 0
    s_mov_b32 s77, 0
    s_mov_b32 s78, 0
    s_mov_b32 s79, 0
    s_mov_b32 s80, 0
    s_mov_b32 s81, 0
    s_mov_b32 s82, 0
    s_mov_b32 s83, 0
    s_mov_b32 s84, 0
    s_mov_b32 s85, 0
    s_mov_b32 s86, 0
    s_mov_b32 s87, 0
    v_mov_b32 v2, 0
    s_branch rec_ibq_10
rec_ibp_9:
    s_sleep 16
    global_load_dwordx2 v[98:99], v144, s[92:93] offset:0 sc1
    s_add_u32 s41, s41, 1
    s_cmp_ge_u32 s41, 0x80000
    s_cbranch_scc1 rec_ib_8
rec_ibq_10:
    s_waitcnt vmcnt(0)
    v_readfirstlane_b32 s39, v98
    v_readfirstlane_b32 s38, v99
    s_cmp_lt_u32 s39, 352
    s_cbranch_scc1 rec_ibp_9
rec_ib_8:
    s_mov_b32 s94, 1
    s_add_u32 m0, s51, s3
    s_nop 0
    buffer_load_dwordx4 v30, s[4:7], s37 offen sc1 lds
    s_lshr_b32 s96, s38, 16
    s_and_b32 s38, s38, 0xffff
    s_cmp_ge_u32 s38, 64
    s_cselect_b32 s48, -1, 0
    s_xor_b32 s48, s48, 0xaaa
    s_and_b32 s33, s48, 1
    s_lshl_b32 s33, s33, 13
    s_add_u32 s33, s33, s49
    s_add_u32 s34, s33, 262144
    s_add_u32 s35, s33, 524288
    s_lshr_b32 s38, s28, 5
    s_lshl_b32 s38, s38, 4
    s_lshl_b32 s40, s30, 14
    s_add_u32 s38, s38, s40
    s_add_u32 s38, s38, s33
    s_add_u32 s38, s38, 163840
    v_and_b32 v132, 31, v1
    v_lshlrev_b32 v132, 8, v132
    v_add_u32 v132, s38, v132
    s_and_b32 s39, s29, 23
    s_cmp_eq_u32 s39, 3
    s_mov_b32 vcc_hi, 0
    s_cselect_b32 vcc_lo, -1, 0
    v_mov_b32 v4, 2130706432
    v_cndmask_b32 v132, v4, v132, vcc
    v_add_u32 v133, 128, v132
    s_and_b32 s39, s29, 31
    s_cmp_eq_u32 s39, 3
    s_cselect_b32 s39, s31, 99
    s_cmp_eq_u32 s39, 1
    s_cselect_b64 vcc, -1, 0
    v_mov_b32 v4, 2130706432
    v_cndmask_b32 v133, v4, v133, vcc
    s_lshr_b32 s55, s28, 5
    s_lshl_b32 s55, s55, 14
    s_and_b32 s40, s28, 31
    s_lshl_b32 s40, s40, 8
    s_add_u32 s55, s55, s40
    s_add_u32 s55, s55, s33
    s_add_u32 s55, s55, 163840
    s_add_u32 s44, s55, 128
    v_mov_b32 v26, 2130706432
    s_mov_b32 s98, 0
    s_mov_b32 s99, 0
    s_mov_b32 s88, 88080384
    s_mov_b32 s89, 65536
    v_mov_b32 v188, 0
    v_mov_b32 v189, 0
    v_mov_b32 v190, 0
    v_mov_b32 v191, 0
    s_cmp_eq_u32 s31, 1
    s_cbranch_scc1 rec_gs1_12
    s_cmp_eq_u32 s31, 2
    s_cbranch_scc1 rec_gs2_13
    s_cmp_eq_u32 s31, 3
    s_cbranch_scc1 rec_gs3_14
    v_mov_b32 v93, v19
    v_mov_b32 v180, -1
    v_mov_b32 v181, -1
    v_mov_b32 v182, -1
    v_mov_b32 v183, -1
    s_mov_b32 s88, 97255424
    s_mov_b32 s89, 262144
    s_branch rec_gs_11
rec_gs1_12:
    v_mov_b32 v26, v19
    s_mov_b64 vcc, 0xffff
    v_mov_b32 v4, 2130706432
    v_cndmask_b32 v26, v4, v26, vcc
    v_mov_b32 v188, -1
    v_mov_b32 v189, -1
    v_mov_b32 v190, -1
    v_mov_b32 v191, -1
    s_mov_b32 s98, 97256448
    s_mov_b32 s99, 262144
    s_branch rec_gs_11
rec_gs2_13:
    v_mov_b32 v26, v137
    s_branch rec_gs_11
rec_gs3_14:
    s_lshr_b32 s38, s29, 3
    s_lshl_b32 s38, s38, 14
    s_and_b32 s40, s29, 7
    s_lshl_b32 s40, s40, 10
    s_add_u32 s38, s38, s40
    s_and_b32 s40, s30, 1
    s_lshl_b32 s40, s40, 9
    s_add_u32 s38, s38, s40
    s_lshr_b32 s40, s30, 1
    s_lshl_b32 s40, s40, 7
    s_add_u32 s38, s38, s40
    v_bfe_u32 v2, v1, 4, 1
    v_lshlrev_b32 v2, 16, v2
    v_bfe_u32 v4, v1, 3, 1
    v_lshl_add_u32 v2, v4, 8, v2
    v_and_b32 v4, 7, v1
    v_lshl_add_u32 v2, v4, 4, v2
    v_add_u32 v2, s38, v2
    s_mov_b32 vcc_lo, 0
    s_mov_b32 vcc_hi, -1
    v_cndmask_b32 v93, v93, v2, vcc
    s_mov_b32 s88, s35
rec_gs_11:
    s_cmp_eq_u32 s31, 2
    s_cselect_b32 s45, 1, 0
    s_mov_b32 s72, 0
    s_mov_b32 s73, 0
    s_mov_b32 s74, 0
    s_mov_b32 s75, 0
    s_mov_b32 s76, 0
    s_mov_b32 s77, 0
    s_mov_b32 s78, 0
    s_mov_b32 s79, 0
    s_mov_b32 s80, 0
    s_mov_b32 s81, 0
    s_mov_b32 s82, 0
    s_mov_b32 s83, 0
    s_mov_b32 s84, 0
    s_mov_b32 s85, 0
    s_mov_b32 s86, 0
    s_mov_b32 s87, 0
    s_waitcnt vmcnt(0)
    s_barrier
    s_branch rec_entry_15
rec_loop_16:
    s_barrier
    buffer_load_dwordx4 v[36:39], v7, s[4:7], s33 offen offset:0 sc1
    s_nop 3
    buffer_load_dwordx4 v[40:43], v7, s[4:7], s33 offen offset:1024 sc1
    s_nop 3
    buffer_load_dwordx4 v[44:47], v7, s[4:7], s33 offen offset:2048 sc1
    s_nop 3
    buffer_load_dwordx4 v[48:51], v7, s[4:7], s33 offen offset:3072 sc1
rec_entry_15:
    v_add_u32 v2, s51, v16
    ds_read_b128 v[60:63], v2 offset:0
    ds_read_b128 v[64:67], v2 offset:1024
    ds_read_b128 v[52:55], v2 offset:2048
    ds_read_b128 v[56:59], v2 offset:3072
    s_waitcnt vmcnt(3)
    v_smfmac_f32_16x16x64_bf16 v[68:71], v[36:39], a[0:7], v5
    v_min_u32 v31, v36, v37
    v_smfmac_f32_16x16x64_bf16 v[72:75], v[36:39], a[8:15], v5
    v_min_u32 v4, v38, v39
    v_smfmac_f32_16x16x64_bf16 v[76:79], v[36:39], a[16:23], v5
    v_smfmac_f32_16x16x64_bf16 v[80:83], v[36:39], a[24:31], v5
    s_waitcnt vmcnt(2)
    v_smfmac_f32_16x16x64_bf16 v[68:71], v[40:43], a[48:55], v5
    v_min3_u32 v31, v31, v40, v41
    v_smfmac_f32_16x16x64_bf16 v[72:75], v[40:43], a[56:63], v5
    v_min3_u32 v4, v4, v42, v43
    v_smfmac_f32_16x16x64_bf16 v[76:79], v[40:43], a[64:71], v5
    v_smfmac_f32_16x16x64_bf16 v[80:83], v[40:43], a[72:79], v5
    s_waitcnt vmcnt(1)
    v_smfmac_f32_16x16x64_bf16 v[68:71], v[44:47], a[96:103], v5
    v_min3_u32 v31, v31, v44, v45
    v_smfmac_f32_16x16x64_bf16 v[72:75], v[44:47], a[104:111], v5
    v_min3_u32 v4, v4, v46, v47
    v_smfmac_f32_16x16x64_bf16 v[76:79], v[44:47], a[112:119], v5
    v_min_u32 v31, v31, v4
    v_smfmac_f32_16x16x64_bf16 v[80:83], v[44:47], a[120:127], v5
    s_waitcnt vmcnt(0)
    v_min3_u32 v31, v31, v48, v49
    v_smfmac_f32_16x16x64_bf16 v[68:71], v[48:51], a[144:151], v5
    v_min3_u32 v31, v31, v50, v51
    v_smfmac_f32_16x16x64_bf16 v[72:75], v[48:51], a[152:159], v5
    v_cmp_eq_u32 vcc, 0, v31
    v_smfmac_f32_16x16x64_bf16 v[76:79], v[48:51], a[160:167], v5
    v_smfmac_f32_16x16x64_bf16 v[80:83], v[48:51], a[168:175], v5
    s_cbranch_vccnz rec_gafix_19
rec_gaok_18:
    s_nop 1
    v_pk_add_f32 v[68:69], v[68:69], v[70:71]
    s_nop 0
    v_pk_add_f32 v[70:71], v[72:73], v[74:75]
    ds_write2_b32 v14, v68, v69 offset0:0 offset1:40
    ds_write2_b32 v14, v70, v71 offset0:16 offset1:56
    v_pk_add_f32 v[76:77], v[76:77], v[78:79]
    v_pk_add_f32 v[78:79], v[80:81], v[82:83]
    ds_write2_b32 v15, v76, v77 offset0:0 offset1:40
    ds_write2_b32 v15, v78, v79 offset0:16 offset1:56
    s_cmp_lg_u32 s31, 0
    s_cbranch_scc1 rec_w1_21
    s_waitcnt lgkmcnt(0)
    s_barrier
    ds_read_b128 v[100:103], v18 offset:0
    v_smfmac_f32_16x16x64_bf16 v[84:87], v[36:39], a[32:39], v5
    ds_read_b128 v[104:107], v18 offset:32
    v_smfmac_f32_16x16x64_bf16 v[88:91], v[36:39], a[40:47], v5
    ds_read_b128 v[108:111], v18 offset:2560
    v_smfmac_f32_16x16x64_bf16 v[84:87], v[40:43], a[80:87], v5
    ds_read_b128 v[112:115], v18 offset:2592
    v_smfmac_f32_16x16x64_bf16 v[88:91], v[40:43], a[88:95], v5
    ds_read_b128 v[116:119], v18 offset:5120
    v_smfmac_f32_16x16x64_bf16 v[84:87], v[44:47], a[128:135], v5
    ds_read_b128 v[120:123], v18 offset:5152
    v_smfmac_f32_16x16x64_bf16 v[88:91], v[44:47], a[136:143], v5
    ds_read_b128 v[124:127], v18 offset:7680
    v_smfmac_f32_16x16x64_bf16 v[84:87], v[48:51], a[176:183], v5
    ds_read_b128 v[128:131], v18 offset:7712
    v_smfmac_f32_16x16x64_bf16 v[88:91], v[48:51], a[184:191], v5
    s_waitcnt lgkmcnt(4)
    v_pk_add_f32 v[100:101], v[100:101], v[108:109]
    v_pk_add_f32 v[102:103], v[102:103], v[110:111]
    v_pk_add_f32 v[104:105], v[104:105], v[112:113]
    v_pk_add_f32 v[106:107], v[106:107], v[114:115]
    s_waitcnt lgkmcnt(2)
    v_pk_add_f32 v[100:101], v[100:101], v[116:117]
    v_pk_add_f32 v[102:103], v[102:103], v[118:119]
    v_pk_add_f32 v[104:105], v[104:105], v[120:121]
    v_pk_add_f32 v[106:107], v[106:107], v[122:123]
    s_waitcnt lgkmcnt(0)
    v_pk_add_f32 v[100:101], v[100:101], v[124:125]
    v_pk_add_f32 v[102:103], v[102:103], v[126:127]
    v_pk_add_f32 v[104:105], v[104:105], v[128:129]
    v_pk_add_f32 v[106:107], v[106:107], v[130:131]
    v_cvt_pk_bf16_f32 v96, v100, v101
    v_cvt_pk_bf16_f32 v97, v102, v103
    v_cvt_pk_bf16_f32 v98, v104, v105
    v_cvt_pk_bf16_f32 v99, v106, v107
    s_nop 1
    v_mfma_f32_16x16x32_bf16 v[68:71], v[60:63], v[96:99], 0
    v_mfma_f32_16x16x32_bf16 v[72:75], v[64:67], v[96:99], 0
    v_mfma_f32_16x16x32_bf16 v[76:79], v[96:99], v[96:99], 0
    s_cmp_lg_u32 s96, 0
    v_pk_add_f32 v[84:85], v[84:85], v[86:87]
    v_pk_add_f32 v[86:87], v[88:89], v[90:91]
    s_cbranch_scc1 rec_slow_22
    s_mov_b64 exec, s[42:43]
    s_nop 0
    buffer_store_dwordx4 v[68:71], v19, s[4:7], s36 offen
    buffer_store_dwordx4 v[72:75], v19, s[4:7], s36 offen offset:128
    s_mov_b64 exec, s[46:47]
    buffer_store_dwordx4 v[76:79], v20, s[4:7], s36 offen offset:1024
    s_mov_b64 exec, -1
rec_slowr_23:
    ds_write_b128 v17, v[84:87]
    ds_write_b128 v16, v[96:99] offset:15360
    s_waitcnt lgkmcnt(0)
    s_barrier
    ds_read_b64 v[100:101], v25 offset:0
    ds_read_b64 v[102:103], v25 offset:128
    ds_read_b64 v[104:105], v25 offset:1024
    ds_read_b64 v[106:107], v25 offset:1152
    ds_read_b64 v[108:109], v25 offset:2048
    ds_read_b64 v[110:111], v25 offset:2176
    ds_read_b64 v[112:113], v25 offset:3072
    ds_read_b64 v[114:115], v25 offset:3200
    v_mov_b32_dpp v68, v72 row_ror:8 row_mask:0xf bank_mask:0xc
    v_mov_b32_dpp v69, v73 row_ror:8 row_mask:0xf bank_mask:0xc
    v_mov_b32_dpp v70, v74 row_ror:8 row_mask:0xf bank_mask:0xc
    v_mov_b32_dpp v71, v75 row_ror:8 row_mask:0xf bank_mask:0xc
    buffer_load_dwordx4 v[176:179], v21, s[4:7], s36 offen offset:1024 sc1
    buffer_load_dwordx4 v[164:167], v22, s[4:7], s36 offen sc1
    buffer_load_dwordx4 v[168:171], v23, s[4:7], s36 offen sc1
    buffer_load_dwordx4 v[172:175], v24, s[4:7], s36 offen sc1
    s_waitcnt lgkmcnt(0)
    v_pk_add_f32 v[100:101], v[100:101], v[104:105]
    v_pk_add_f32 v[102:103], v[102:103], v[106:107]
    v_pk_add_f32 v[108:109], v[108:109], v[112:113]
    v_pk_add_f32 v[110:111], v[110:111], v[114:115]
    v_pk_add_f32 v[100:101], v[100:101], v[108:109]
    v_pk_add_f32 v[102:103], v[102:103], v[110:111]
    v_cvt_pk_bf16_f32 v138, v100, v101
    v_cvt_pk_bf16_f32 v140, v102, v103
    s_nop 15
    buffer_load_dwordx4 v[48:51], v21, s[4:7], s36 offen offset:1024 sc1
    buffer_load_dwordx4 v[36:39], v22, s[4:7], s36 offen sc1
    buffer_load_dwordx4 v[40:43], v23, s[4:7], s36 offen sc1
    buffer_load_dwordx4 v[44:47], v24, s[4:7], s36 offen sc1
    s_cmp_eq_u32 s32, 63
    s_cbranch_scc1 rec_b2_20
    s_waitcnt vmcnt(7)
    v_permlane32_swap_b32 v176, v178
    v_permlane32_swap_b32 v177, v179
    v_pk_add_f32 v[124:125], v[176:177], v[178:179]
    s_waitcnt vmcnt(6)
    v_pk_add_f32 v[120:121], v[68:69], v[164:165]
    v_pk_add_f32 v[122:123], v[70:71], v[166:167]
    v_permlane16_swap_b32 v124, v125
    s_waitcnt vmcnt(5)
    v_pk_add_f32 v[120:121], v[120:121], v[168:169]
    v_pk_add_f32 v[122:123], v[122:123], v[170:171]
    v_add_f32 v124, v124, v125
    s_waitcnt vmcnt(4)
    v_pk_add_f32 v[120:121], v[120:121], v[172:173]
    v_pk_add_f32 v[122:123], v[122:123], v[174:175]
    v_maximum3_f32 v135, v120, v121, v124
    v_maximum3_f32 v135, v135, v122, v123
    v_cmp_u_f32 vcc, v135, v135
    s_nop 0
    v_max_f32_dpp v135, v135, v135 row_ror:8 row_mask:0xf bank_mask:0xf
    v_mov_b32 v136, v135
    s_cbranch_vccnz rec_gbr_24
rec_gbo_25:
    buffer_store_dword v134, v132, s[4:7], 0 offen sc1
    v_permlane16_swap_b32 v135, v136
    v_max_f32 v135, v135, v136
    v_mov_b32 v136, v135
    s_nop 1
    v_permlane32_swap_b32 v135, v136
    v_max_f32 v135, v135, v136
    v_mul_f32 v135, s50, v135
    v_fma_f32 v124, v124, s50, -v135
    v_fma_f32 v120, v120, s50, -v135
    v_fma_f32 v121, v121, s50, -v135
    v_fma_f32 v122, v122, s50, -v135
    v_fma_f32 v123, v123, s50, -v135
    v_exp_f32 v124, v124
    v_exp_f32 v120, v120
    v_exp_f32 v121, v121
    v_exp_f32 v122, v122
    v_exp_f32 v123, v123
    v_mov_b32_dpp v125, v124 row_ror:8 row_mask:0xf bank_mask:0xf
    v_cvt_pk_bf16_f32 v156, v120, v121
    v_cvt_pk_bf16_f32 v157, v122, v123
    v_cvt_pk_bf16_f32 v160, v124, v125
    v_mov_b32_dpp v158, v156 row_ror:8 row_mask:0xf bank_mask:0xf
    v_mov_b32_dpp v159, v157 row_ror:8 row_mask:0xf bank_mask:0xf
    v_mfma_f32_16x16x32_bf16 v[116:119], v[32:35], v[160:163], 0
    s_nop 0
    v_mfma_f32_16x16x32_bf16 v[116:119], v[32:35], v[156:159], v[116:119]
    v_mfma_f32_16x16x32_bf16 v[108:111], v[52:55], v[156:159], 0
    v_mfma_f32_16x16x32_bf16 v[108:111], v[138:141], v[160:163], v[108:111]
    v_mfma_f32_16x16x32_bf16 v[112:115], v[56:59], v[156:159], 0
    v_mfma_f32_16x16x32_bf16 v[112:115], v[140:143], v[160:163], v[112:115]
    s_nop 3
    v_rcp_f32 v100, v116
    s_nop 0
    v_mov_b32 v101, v100
    v_pk_mul_f32 v[108:109], v[108:109], v[100:101]
    v_pk_mul_f32 v[110:111], v[110:111], v[100:101]
    v_pk_mul_f32 v[112:113], v[112:113], v[100:101]
    v_pk_mul_f32 v[114:115], v[114:115], v[100:101]
    v_cvt_pk_bf16_f32 v108, v108, v109
    v_cvt_pk_bf16_f32 v109, v110, v111
    v_cvt_pk_bf16_f32 v110, v112, v113
    v_cvt_pk_bf16_f32 v111, v114, v115
    v_max_u32 v108, 1, v108
    v_max_u32 v109, 1, v109
    v_max_u32 v110, 1, v110
    v_max_u32 v111, 1, v111
    s_mov_b64 exec, s[42:43]
    buffer_store_dwordx4 v[108:111], v27, s[4:7], s33 offen sc1
    s_mov_b64 exec, -1
    v_mov_b64 v[68:69], 0
    v_mov_b64 v[70:71], 0
    v_mov_b64 v[72:73], 0
    v_mov_b64 v[74:75], 0
    v_mov_b64 v[76:77], 0
    v_mov_b64 v[78:79], 0
    v_mov_b64 v[80:81], 0
    v_mov_b64 v[82:83], 0
    v_mov_b64 v[84:85], 0
    v_mov_b64 v[86:87], 0
    v_mov_b64 v[88:89], 0
    v_mov_b64 v[90:91], 0
rec_cs_27:
    s_barrier
    buffer_load_dwordx4 v[36:39], v12, s[4:7], s33 offen offset:0 sc1
    s_nop 3
    buffer_load_dwordx4 v[40:43], v12, s[4:7], s33 offen offset:1024 sc1
    s_nop 3
    buffer_load_dwordx4 v[44:47], v12, s[4:7], s33 offen offset:2048 sc1
    s_nop 3
    buffer_load_dwordx4 v[48:51], v12, s[4:7], s33 offen offset:3072 sc1
    s_nop 3
    buffer_load_dwordx4 v[52:55], v13, s[4:7], s33 offen offset:0 sc1
    s_nop 3
    buffer_load_dwordx4 v[56:59], v13, s[4:7], s33 offen offset:1024 sc1
    s_nop 3
    buffer_load_dwordx4 v[60:63], v13, s[4:7], s33 offen offset:2048 sc1
    s_nop 3
    buffer_load_dwordx4 v[64:67], v13, s[4:7], s33 offen offset:3072 sc1
    s_waitcnt vmcnt(7)
    v_smfmac_f32_16x16x64_bf16 v[68:71], v[36:39], a[192:199], v5
    v_min_u32 v31, v36, v37
    v_smfmac_f32_16x16x64_bf16 v[72:75], v[36:39], a[200:207], v5
    v_min_u32 v4, v38, v39
    s_add_u32 s38, s32, 1
    s_cmp_gt_u32 s94, s38
    s_cbranch_scc0 rec_kv_30
rec_kvd_31:
    s_xor_b32 s51, s51, 4096
    s_add_u32 m0, s51, s3
    s_add_u32 s37, s37, 262144
    buffer_load_dwordx4 v30, s[4:7], s37 offen sc1 lds
    s_waitcnt vmcnt(7)
    v_smfmac_f32_16x16x64_bf16 v[68:71], v[40:43], a[208:215], v5
    v_min3_u32 v31, v31, v40, v41
    v_smfmac_f32_16x16x64_bf16 v[72:75], v[40:43], a[216:223], v5
    v_min3_u32 v4, v4, v42, v43
    buffer_load_dword v3, v92, s[4:7], s36 offen sc1
    s_waitcnt vmcnt(7)
    v_smfmac_f32_16x16x64_bf16 v[68:71], v[44:47], a[224:231], v5
    v_min3_u32 v31, v31, v44, v45
    v_smfmac_f32_16x16x64_bf16 v[72:75], v[44:47], a[232:239], v5
    v_min3_u32 v4, v4, v46, v47
    s_waitcnt vmcnt(6)
    v_smfmac_f32_16x16x64_bf16 v[68:71], v[48:51], a[240:247], v5
    v_min3_u32 v31, v31, v48, v49
    v_smfmac_f32_16x16x64_bf16 v[72:75], v[48:51], a[248:255], v5
    v_min3_u32 v4, v4, v50, v51
    s_waitcnt vmcnt(5)
    v_smfmac_f32_16x16x64_bf16 v[68:71], v[52:55], v[192:199], v5
    v_min3_u32 v31, v31, v52, v53
    v_smfmac_f32_16x16x64_bf16 v[72:75], v[52:55], v[200:207], v5
    v_min3_u32 v4, v4, v54, v55
    s_waitcnt vmcnt(4)
    v_smfmac_f32_16x16x64_bf16 v[68:71], v[56:59], v[208:215], v5
    v_min3_u32 v31, v31, v56, v57
    v_smfmac_f32_16x16x64_bf16 v[72:75], v[56:59], v[216:223], v5
    v_min3_u32 v4, v4, v58, v59
    s_waitcnt vmcnt(3)
    v_smfmac_f32_16x16x64_bf16 v[68:71], v[60:63], v[224:231], v5
    v_min3_u32 v31, v31, v60, v61
    v_smfmac_f32_16x16x64_bf16 v[72:75], v[60:63], v[232:239], v5
    v_min3_u32 v4, v4, v62, v63
    v_min_u32 v31, v31, v4
    s_waitcnt vmcnt(2)
    v_min3_u32 v31, v31, v64, v65
    v_smfmac_f32_16x16x64_bf16 v[68:71], v[64:67], v[240:247], v5
    v_min3_u32 v31, v31, v66, v67
    v_smfmac_f32_16x16x64_bf16 v[72:75], v[64:67], v[248:255], v5
    v_cmp_eq_u32 vcc, 0, v31
    s_add_u32 s32, s32, 1
    s_add_u32 s38, s32, 2
    s_lshr_b32 s39, s38, 3
    s_lshr_b32 s39, s48, s39
    s_cbranch_vccnz rec_gcfix_29
rec_gcok_28:
    s_mov_b32 s33, s34
    s_mov_b32 s34, s35
    s_nop 0
    v_pk_add_f32 v[68:69], v[68:69], v[70:71]
    s_nop 1
    v_add_f32_dpp v68, v72, v74 quad_perm:[0,1,2,3] row_mask:0xc bank_mask:0xf
    v_add_f32_dpp v69, v73, v75 quad_perm:[0,1,2,3] row_mask:0xc bank_mask:0xf
    s_nop 1
    v_permlane32_swap_b32 v68, v69
    v_add_f32 v68, v68, v69
    ds_write_b32 v28, v68
    s_and_b32 s35, s39, 1
    s_lshl_b32 s35, s35, 13
    s_lshl_b32 s40, s38, 18
    s_add_u32 s35, s35, s40
    s_add_u32 s35, s35, s49
    s_add_u32 s36, s36, 262144
    s_cmp_lg_u32 s31, 0
    s_cbranch_scc1 rec_b4_32
    s_waitcnt lgkmcnt(0)
    s_barrier
    ds_read_b64 v[100:101], v29 offset:0
    ds_read_b64 v[102:103], v29 offset:256
    ds_read_b64 v[104:105], v29 offset:512
    ds_read_b64 v[106:107], v29 offset:768
    v_add_u32 v134, 2, v134
    s_waitcnt lgkmcnt(0)
    v_pk_add_f32 v[100:101], v[100:101], v[102:103]
    v_pk_add_f32 v[104:105], v[104:105], v[106:107]
    v_pk_add_f32 v[100:101], v[100:101], v[104:105]
    v_cvt_pk_bf16_f32 v100, v100, v101
    v_max_u32 v100, 1, v100
    s_nop 1
    v_mov_b32_dpp v101, v100 quad_perm:[1,1,1,1] row_mask:0xf bank_mask:0xf
    v_mov_b32_dpp v102, v100 quad_perm:[2,2,2,2] row_mask:0xf bank_mask:0xf
    v_mov_b32_dpp v103, v100 quad_perm:[3,3,3,3] row_mask:0xf bank_mask:0xf
    s_mov_b64 exec, 0x11111111
    buffer_store_dwordx4 v[100:103], v6, s[4:7], s33 offen sc1
    s_mov_b64 exec, -1
    s_barrier
    buffer_store_dwordx4 v[180:183], v93, s[4:7], s88 offen sc1
    s_add_u32 s98, s98, s99
    s_add_u32 s38, s32, 3
    s_min_u32 s38, s38, 63
    s_cmp_gt_u32 s94, s38
    s_cbranch_scc1 rec_rf_33
    s_load_dword s94, s[90:91], s95 glc
rec_rf_33:
    s_add_u32 s88, s88, s89
    s_cmp_eq_u32 s31, 3
    s_cselect_b32 s88, s35, s88
    v_mov_b64 v[68:69], 0
    v_mov_b64 v[70:71], 0
    v_mov_b64 v[72:73], 0
    v_mov_b64 v[74:75], 0
    s_waitcnt vmcnt(2)
    s_branch rec_loop_16
rec_b4_32:
    s_waitcnt lgkmcnt(0)
    s_barrier
    buffer_store_dword v134, v133, s[4:7], 0 offen sc1
    s_cmp_eq_u32 s31, 3
    s_cbranch_scc1 rec_w3b_34
    v_add_u32 v134, 2, v134
    v_mov_b64 v[68:69], 0
    v_mov_b64 v[70:71], 0
    v_mov_b64 v[72:73], 0
    v_mov_b64 v[74:75], 0
    s_barrier
    buffer_store_dwordx4 v[180:183], v93, s[4:7], s88 offen sc1
    buffer_store_dwordx4 v[188:191], v26, s[4:7], s98 offen sc1
    s_add_u32 s98, s98, s99
    s_nop 0
    v_add_u32 v188, s45, v188
    s_add_u32 s38, s32, 3
    s_min_u32 s38, s38, 63
    s_cmp_gt_u32 s94, s38
    s_cbranch_scc1 rec_rf_35
    s_load_dword s94, s[90:91], s95 glc
rec_rf_35:
    s_add_u32 s88, s88, s89
    s_cmp_eq_u32 s31, 3
    s_cselect_b32 s88, s35, s88
    s_waitcnt vmcnt(2)
    s_branch rec_loop_16
rec_w3b_34:
    v_add_u32 v134, 2, v134
    v_mov_b64 v[68:69], 0
    v_mov_b64 v[70:71], 0
    v_mov_b64 v[72:73], 0
    v_mov_b64 v[74:75], 0
    s_load_dword s72, s[90:91], s44 glc
    s_barrier
    s_load_dword s72, s[90:91], s44 glc
    buffer_store_dwordx4 v[180:183], v93, s[4:7], s88 offen sc1
    s_add_u32 s98, s98, s99
    s_add_u32 s38, s32, 3
    s_min_u32 s38, s38, 63
    s_cmp_gt_u32 s94, s38
    s_cbranch_scc1 rec_rf_36
    s_load_dword s94, s[90:91], s95 glc
rec_rf_36:
    s_add_u32 s88, s88, s89
    s_cmp_eq_u32 s31, 3
    s_cselect_b32 s88, s35, s88
    s_load_dword s72, s[90:91], s44 glc
    s_waitcnt vmcnt(2)
    s_branch rec_tkc_39
rec_tk_37:
    s_load_dword s72, s[90:91], s44 glc
    s_add_u32 s41, s41, 1
    s_cmp_ge_u32 s41, 0x80000
    s_cbranch_scc1 rec_tkd_38
    s_sleep 1
rec_tkc_39:
    s_mov_b32 s38, s72
    s_cmp_lt_u32 s38, s54
    s_cbranch_scc1 rec_tk_37
rec_tkd_38:
    s_add_u32 s54, s54, 1
    s_sleep 1
    s_branch rec_loop_16
rec_gafix_19:
    s_add_u32 s41, s41, 1
    s_cmp_ge_u32 s41, 0x80000
    s_cbranch_scc1 rec_gaok_18
    buffer_load_dwordx4 v[36:39], v7, s[4:7], s33 offen offset:0 sc1
    buffer_load_dwordx4 v[40:43], v7, s[4:7], s33 offen offset:1024 sc1
    buffer_load_dwordx4 v[44:47], v7, s[4:7], s33 offen offset:2048 sc1
    buffer_load_dwordx4 v[48:51], v7, s[4:7], s33 offen offset:3072 sc1
    v_mov_b64 v[68:69], 0
    v_mov_b64 v[70:71], 0
    v_mov_b64 v[72:73], 0
    v_mov_b64 v[74:75], 0
    v_mov_b64 v[76:77], 0
    v_mov_b64 v[78:79], 0
    v_mov_b64 v[80:81], 0
    v_mov_b64 v[82:83], 0
    s_waitcnt vmcnt(3)
    v_smfmac_f32_16x16x64_bf16 v[68:71], v[36:39], a[0:7], v5
    v_min_u32 v31, v36, v37
    v_smfmac_f32_16x16x64_bf16 v[72:75], v[36:39], a[8:15], v5
    v_min_u32 v4, v38, v39
    v_smfmac_f32_16x16x64_bf16 v[76:79], v[36:39], a[16:23], v5
    v_smfmac_f32_16x16x64_bf16 v[80:83], v[36:39], a[24:31], v5
    s_waitcnt vmcnt(2)
    v_smfmac_f32_16x16x64_bf16 v[68:71], v[40:43], a[48:55], v5
    v_min3_u32 v31, v31, v40, v41
    v_smfmac_f32_16x16x64_bf16 v[72:75], v[40:43], a[56:63], v5
    v_min3_u32 v4, v4, v42, v43
    v_smfmac_f32_16x16x64_bf16 v[76:79], v[40:43], a[64:71], v5
    v_smfmac_f32_16x16x64_bf16 v[80:83], v[40:43], a[72:79], v5
    s_waitcnt vmcnt(1)
    v_smfmac_f32_16x16x64_bf16 v[68:71], v[44:47], a[96:103], v5
    v_min3_u32 v31, v31, v44, v45
    v_smfmac_f32_16x16x64_bf16 v[72:75], v[44:47], a[104:111], v5
    v_min3_u32 v4, v4, v46, v47
    v_smfmac_f32_16x16x64_bf16 v[76:79], v[44:47], a[112:119], v5
    v_min_u32 v31, v31, v4
    v_smfmac_f32_16x16x64_bf16 v[80:83], v[44:47], a[120:127], v5
    s_waitcnt vmcnt(0)
    v_min3_u32 v31, v31, v48, v49
    v_smfmac_f32_16x16x64_bf16 v[68:71], v[48:51], a[144:151], v5
    v_min3_u32 v31, v31, v50, v51
    v_smfmac_f32_16x16x64_bf16 v[72:75], v[48:51], a[152:159], v5
    v_cmp_eq_u32 vcc, 0, v31
    v_smfmac_f32_16x16x64_bf16 v[76:79], v[48:51], a[160:167], v5
    v_smfmac_f32_16x16x64_bf16 v[80:83], v[48:51], a[168:175], v5
    s_cbranch_vccnz rec_gafix_19
    s_branch rec_gaok_18
rec_slow_22:
    s_mov_b64 exec, s[42:43]
    s_nop 0
    buffer_store_dwordx4 v[68:71], v19, s[4:7], s36 offen sc1
    buffer_store_dwordx4 v[72:75], v19, s[4:7], s36 offen offset:128 sc1
    s_mov_b64 exec, s[46:47]
    buffer_store_dwordx4 v[76:79], v20, s[4:7], s36 offen offset:1024 sc1
    s_mov_b64 exec, -1
    s_branch rec_slowr_23
rec_gbr_24:
    v_max3_u32 v31, v164, v165, v166
    v_max3_u32 v31, v31, v167, v168
    v_max3_u32 v31, v31, v169, v170
    v_max3_u32 v31, v31, v171, v172
    v_max3_u32 v31, v31, v173, v174
    v_max3_u32 v31, v31, v175, v176
    v_max3_u32 v31, v31, v177, v178
    v_max_u32 v31, v31, v179
    buffer_load_dwordx4 v[176:179], v21, s[4:7], s36 offen offset:1024 sc1
    buffer_load_dwordx4 v[164:167], v22, s[4:7], s36 offen sc1
    buffer_load_dwordx4 v[168:171], v23, s[4:7], s36 offen sc1
    buffer_load_dwordx4 v[172:175], v24, s[4:7], s36 offen sc1
    v_cmp_eq_u32 vcc, -1, v31
    s_add_u32 s41, s41, 1
    s_cmp_ge_u32 s41, 0x80000
    s_cbranch_scc1 rec_gbo_25
    s_cbranch_vccz rec_gbo_25
    s_waitcnt vmcnt(7)
    v_permlane32_swap_b32 v48, v50
    v_permlane32_swap_b32 v49, v51
    v_pk_add_f32 v[124:125], v[48:49], v[50:51]
    s_waitcnt vmcnt(6)
    v_pk_add_f32 v[120:121], v[68:69], v[36:37]
    v_pk_add_f32 v[122:123], v[70:71], v[38:39]
    v_permlane16_swap_b32 v124, v125
    s_waitcnt vmcnt(5)
    v_pk_add_f32 v[120:121], v[120:121], v[40:41]
    v_pk_add_f32 v[122:123], v[122:123], v[42:43]
    v_add_f32 v124, v124, v125
    s_waitcnt vmcnt(4)
    v_pk_add_f32 v[120:121], v[120:121], v[44:45]
    v_pk_add_f32 v[122:123], v[122:123], v[46:47]
    v_maximum3_f32 v135, v120, v121, v124
    v_maximum3_f32 v135, v135, v122, v123
    v_cmp_u_f32 vcc, v135, v135
    s_nop 0
    v_max_f32_dpp v135, v135, v135 row_ror:8 row_mask:0xf bank_mask:0xf
    v_mov_b32 v136, v135
    s_cbranch_vccz rec_gbo_25
    v_max3_u32 v31, v36, v37, v38
    v_max3_u32 v31, v31, v39, v40
    v_max3_u32 v31, v31, v41, v42
    v_max3_u32 v31, v31, v43, v44
    v_max3_u32 v31, v31, v45, v46
    v_max3_u32 v31, v31, v47, v48
    v_max3_u32 v31, v31, v49, v50
    v_max_u32 v31, v31, v51
    buffer_load_dwordx4 v[48:51], v21, s[4:7], s36 offen offset:1024 sc1
    buffer_load_dwordx4 v[36:39], v22, s[4:7], s36 offen sc1
    buffer_load_dwordx4 v[40:43], v23, s[4:7], s36 offen sc1
    buffer_load_dwordx4 v[44:47], v24, s[4:7], s36 offen sc1
    v_cmp_eq_u32 vcc, -1, v31
    s_add_u32 s41, s41, 1
    s_cmp_ge_u32 s41, 0x80000
    s_cbranch_scc1 rec_gbo_25
    s_cbranch_vccz rec_gbo_25
    s_waitcnt vmcnt(7)
    v_permlane32_swap_b32 v176, v178
    v_permlane32_swap_b32 v177, v179
    v_pk_add_f32 v[124:125], v[176:177], v[178:179]
    s_waitcnt vmcnt(6)
    v_pk_add_f32 v[120:121], v[68:69], v[164:165]
    v_pk_add_f32 v[122:123], v[70:71], v[166:167]
    v_permlane16_swap_b32 v124, v125
    s_waitcnt vmcnt(5)
    v_pk_add_f32 v[120:121], v[120:121], v[168:169]
    v_pk_add_f32 v[122:123], v[122:123], v[170:171]
    v_add_f32 v124, v124, v125
    s_waitcnt vmcnt(4)
    v_pk_add_f32 v[120:121], v[120:121], v[172:173]
    v_pk_add_f32 v[122:123], v[122:123], v[174:175]
    v_maximum3_f32 v135, v120, v121, v124
    v_maximum3_f32 v135, v135, v122, v123
    v_cmp_u_f32 vcc, v135, v135
    s_nop 0
    v_max_f32_dpp v135, v135, v135 row_ror:8 row_mask:0xf bank_mask:0xf
    v_mov_b32 v136, v135
    s_cbranch_vccz rec_gbo_25
    s_branch rec_gbr_24
rec_w1_21:
    s_waitcnt lgkmcnt(0)
    s_barrier
    v_smfmac_f32_16x16x64_bf16 v[84:87], v[36:39], a[32:39], v5
    v_smfmac_f32_16x16x64_bf16 v[88:91], v[36:39], a[40:47], v5
    v_smfmac_f32_16x16x64_bf16 v[84:87], v[40:43], a[80:87], v5
    v_smfmac_f32_16x16x64_bf16 v[88:91], v[40:43], a[88:95], v5
    v_smfmac_f32_16x16x64_bf16 v[84:87], v[44:47], a[128:135], v5
    v_smfmac_f32_16x16x64_bf16 v[88:91], v[44:47], a[136:143], v5
    v_smfmac_f32_16x16x64_bf16 v[84:87], v[48:51], a[176:183], v5
    v_smfmac_f32_16x16x64_bf16 v[88:91], v[48:51], a[184:191], v5
    s_nop 6
    v_pk_add_f32 v[84:85], v[84:85], v[86:87]
    v_pk_add_f32 v[86:87], v[88:89], v[90:91]
    ds_write_b128 v17, v[84:87]
    s_waitcnt lgkmcnt(0)
    s_barrier
    v_mov_b64 v[68:69], 0
    v_mov_b64 v[70:71], 0
    v_mov_b64 v[72:73], 0
    v_mov_b64 v[74:75], 0
    v_mov_b64 v[76:77], 0
    v_mov_b64 v[78:79], 0
    v_mov_b64 v[80:81], 0
    v_mov_b64 v[82:83], 0
    v_mov_b64 v[84:85], 0
    v_mov_b64 v[86:87], 0
    v_mov_b64 v[88:89], 0
    v_mov_b64 v[90:91], 0
    s_cmp_eq_u32 s31, 3
    s_cbranch_scc1 rec_w3_41
    s_cmp_eq_u32 s31, 2
    s_cbranch_scc1 rec_w2_40
    ds_read_b128 v[180:183], v16 offset:15360
    s_branch rec_b2_20
rec_w2_40:
    ds_read_b128 v[100:103], v16 offset:10240
    ds_read_b128 v[104:107], v16 offset:11264
    ds_read_b128 v[108:111], v16 offset:12288
    ds_read_b128 v[112:115], v16 offset:13312
    s_waitcnt lgkmcnt(0)
    v_pk_add_f32 v[100:101], v[100:101], v[104:105]
    v_pk_add_f32 v[102:103], v[102:103], v[106:107]
    v_pk_add_f32 v[108:109], v[108:109], v[112:113]
    v_pk_add_f32 v[110:111], v[110:111], v[114:115]
    v_pk_add_f32 v[100:101], v[100:101], v[108:109]
    v_pk_add_f32 v[102:103], v[102:103], v[110:111]
    v_cvt_pk_bf16_f32 v180, v100, v101
    v_cvt_pk_bf16_f32 v181, v102, v103
    s_nop 0
    v_permlane32_swap_b32 v180, v182
    v_permlane32_swap_b32 v181, v183
    s_nop 1
    v_permlane16_swap_b32 v180, v181
    v_permlane16_swap_b32 v182, v183
rec_b2_20:
    s_waitcnt lgkmcnt(0)
    s_cmp_eq_u32 s32, 63
    s_cbranch_scc1 rec_done_17
    s_branch rec_cs_27
rec_w3_41:
    s_cmp_eq_u32 s32, 63
    s_cbranch_scc1 rec_done_17
    s_branch rec_tkc_44
rec_tk_42:
    s_load_dwordx8 s[72:79], s[90:91], s55 glc
    s_add_u32 s41, s41, 1
    s_cmp_ge_u32 s41, 0x80000
    s_cbranch_scc1 rec_tkd_43
    s_sleep 1
rec_tkc_44:
    s_min_u32 s38, s72, s76
    s_cmp_lt_u32 s38, s54
    s_cbranch_scc1 rec_tk_42
rec_tkd_43:
    s_add_u32 s54, s54, 1
    s_branch rec_cs_27
rec_kv_30:
    s_load_dword s94, s[90:91], s95 glc
    s_add_u32 s41, s41, 1
    s_cmp_ge_u32 s41, 0x80000
    s_cbranch_scc1 rec_kvd_31
    s_waitcnt lgkmcnt(0)
    s_cmp_gt_u32 s94, s38
    s_cbranch_scc1 rec_kvd_31
    s_sleep 2
    s_branch rec_kv_30
rec_gcfix_29:
    s_add_u32 s41, s41, 1
    s_cmp_ge_u32 s41, 0x80000
    s_cbranch_scc1 rec_gcok_28
    buffer_load_dwordx4 v[36:39], v12, s[4:7], s33 offen offset:0 sc1
    buffer_load_dwordx4 v[40:43], v12, s[4:7], s33 offen offset:1024 sc1
    buffer_load_dwordx4 v[44:47], v12, s[4:7], s33 offen offset:2048 sc1
    buffer_load_dwordx4 v[48:51], v12, s[4:7], s33 offen offset:3072 sc1
    buffer_load_dwordx4 v[52:55], v13, s[4:7], s33 offen offset:0 sc1
    buffer_load_dwordx4 v[56:59], v13, s[4:7], s33 offen offset:1024 sc1
    buffer_load_dwordx4 v[60:63], v13, s[4:7], s33 offen offset:2048 sc1
    buffer_load_dwordx4 v[64:67], v13, s[4:7], s33 offen offset:3072 sc1
    v_mov_b64 v[68:69], 0
    v_mov_b64 v[70:71], 0
    v_mov_b64 v[72:73], 0
    v_mov_b64 v[74:75], 0
    s_waitcnt vmcnt(7)
    v_smfmac_f32_16x16x64_bf16 v[68:71], v[36:39], a[192:199], v5
    v_min_u32 v31, v36, v37
    v_smfmac_f32_16x16x64_bf16 v[72:75], v[36:39], a[200:207], v5
    v_min_u32 v4, v38, v39
    s_waitcnt vmcnt(6)
    v_smfmac_f32_16x16x64_bf16 v[68:71], v[40:43], a[208:215], v5
    v_min3_u32 v31, v31, v40, v41
    v_smfmac_f32_16x16x64_bf16 v[72:75], v[40:43], a[216:223], v5
    v_min3_u32 v4, v4, v42, v43
    s_waitcnt vmcnt(5)
    v_smfmac_f32_16x16x64_bf16 v[68:71], v[44:47], a[224:231], v5
    v_min3_u32 v31, v31, v44, v45
    v_smfmac_f32_16x16x64_bf16 v[72:75], v[44:47], a[232:239], v5
    v_min3_u32 v4, v4, v46, v47
    s_waitcnt vmcnt(4)
    v_smfmac_f32_16x16x64_bf16 v[68:71], v[48:51], a[240:247], v5
    v_min3_u32 v31, v31, v48, v49
    v_smfmac_f32_16x16x64_bf16 v[72:75], v[48:51], a[248:255], v5
    v_min3_u32 v4, v4, v50, v51
    s_waitcnt vmcnt(3)
    v_smfmac_f32_16x16x64_bf16 v[68:71], v[52:55], v[192:199], v5
    v_min3_u32 v31, v31, v52, v53
    v_smfmac_f32_16x16x64_bf16 v[72:75], v[52:55], v[200:207], v5
    v_min3_u32 v4, v4, v54, v55
    s_waitcnt vmcnt(2)
    v_smfmac_f32_16x16x64_bf16 v[68:71], v[56:59], v[208:215], v5
    v_min3_u32 v31, v31, v56, v57
    v_smfmac_f32_16x16x64_bf16 v[72:75], v[56:59], v[216:223], v5
    v_min3_u32 v4, v4, v58, v59
    s_waitcnt vmcnt(1)
    v_smfmac_f32_16x16x64_bf16 v[68:71], v[60:63], v[224:231], v5
    v_min3_u32 v31, v31, v60, v61
    v_smfmac_f32_16x16x64_bf16 v[72:75], v[60:63], v[232:239], v5
    v_min3_u32 v4, v4, v62, v63
    v_min_u32 v31, v31, v4
    s_waitcnt vmcnt(0)
    v_min3_u32 v31, v31, v64, v65
    v_smfmac_f32_16x16x64_bf16 v[68:71], v[64:67], v[240:247], v5
    v_min3_u32 v31, v31, v66, v67
    v_smfmac_f32_16x16x64_bf16 v[72:75], v[64:67], v[248:255], v5
    v_cmp_eq_u32 vcc, 0, v31
    s_cbranch_vccnz rec_gcfix_29
    s_branch rec_gcok_28
rec_done_17:
    buffer_store_dwordx4 v[180:183], v93, s[4:7], s88 offen sc1
    s_waitcnt vmcnt(0)
    s_barrier
    v_add_u32 v188, 1, v188
    buffer_store_dword v188, v137, s[4:7], 0 offen sc1
    s_endpgm
L_gem:
    s_mov_b32 s6, L_end - L_gem - 16
    s_load_dwordx2 s[90:91], s[0:1], 96
    s_load_dwordx2 s[92:93], s[0:1], 88
    v_and_b32 v1, 63, v0
    v_lshrrev_b32 v2, 6, v0
    s_nop 0
    v_readfirstlane_b32 s29, v2
    v_lshlrev_b32 v5, 4, v1
    s_mov_b32 s41, 0
    s_lshl_b32 s34, s29, 10
    s_waitcnt lgkmcnt(0)
    s_mov_b32 s4, s90
    s_and_b32 s5, s91, 0xffff
    s_mov_b32 s6, 268435456
    s_mov_b32 s7, 0x00020000
    v_mov_b32 v31, 0
    s_cmp_lt_u32 s28, 96
    s_cbranch_scc1 g_nv_45
    s_load_dwordx8 s[72:79], s[0:1], 16
    s_and_b32 s31, s28, 31
    s_lshl_b32 s31, s31, 18
    s_lshl_b32 s33, s29, 16
    s_add_u32 s31, s31, s33
    v_lshrrev_b32 v2, 3, v1
    v_lshlrev_b32 v2, 13, v2
    v_and_b32 v4, 7, v1
    v_lshl_add_u32 v2, v4, 10, v2
    v_add_u32 v2, s31, v2
    v_and_b32 v3, 7, v1
    v_lshlrev_b32 v3, 13, v3
    v_add_u32 v3, s31, v3
    s_waitcnt lgkmcnt(0)
    s_mov_b32 s8, s72
    s_and_b32 s9, s73, 0xffff
    s_mov_b32 s10, 8388608
    s_mov_b32 s11, 0x00020000
    s_sub_u32 s31, 384, s72
    s_and_b32 s31, s31, 0x380
    buffer_load_dword v120, v2, s[8:11], s31 offen
    s_mov_b32 s12, s74
    s_and_b32 s13, s75, 0xffff
    s_mov_b32 s14, 8388608
    s_mov_b32 s15, 0x00020000
    s_sub_u32 s31, 384, s74
    s_and_b32 s31, s31, 0x380
    buffer_load_dword v121, v2, s[12:15], s31 offen
    s_mov_b32 s16, s76
    s_and_b32 s17, s77, 0xffff
    s_mov_b32 s18, 8388608
    s_mov_b32 s19, 0x00020000
    s_sub_u32 s31, 384, s76
    s_and_b32 s31, s31, 0x380
    buffer_load_dword v122, v2, s[16:19], s31 offen
    s_mov_b64 exec, 0xff
    s_sub_u32 s31, 8064, s72
    s_and_b32 s31, s31, 0x1f80
    buffer_load_dword v124, v3, s[8:11], s31 offen
    s_sub_u32 s31, 8064, s74
    s_and_b32 s31, s31, 0x1f80
    buffer_load_dword v125, v3, s[12:15], s31 offen
    s_sub_u32 s31, 8064, s76
    s_and_b32 s31, s31, 0x1f80
    buffer_load_dword v126, v3, s[16:19], s31 offen
    s_mov_b64 exec, -1
    s_branch valc_47
val_46:
    v_mov_b32 v2, 0
    global_load_dword v31, v2, s[92:93] offset:192 sc1
    s_add_u32 s41, s41, 1
    s_cmp_ge_u32 s41, 0x80000
    s_cbranch_scc1 L_end
    s_waitcnt vmcnt(0)
valc_47:
    v_readfirstlane_b32 s31, v31
    s_cmp_eq_u32 s31, s70
    s_cbranch_scc1 valok_48
    s_cmp_eq_u32 s31, 0
    s_cbranch_scc1 val_46
    s_mov_b32 s70, s31
    s_mov_b32 s71, 65536
    s_waitcnt vmcnt(0) lgkmcnt(0)
    s_barrier
    s_branch L_role
valok_48:
g_nv_45:
    s_cmp_ge_u32 s28, 120
    s_cbranch_scc1 L_att
    s_cmp_ge_u32 s28, 96
    s_cbranch_scc1 sl_b_49
    s_lshr_b32 s31, s28, 5
    s_add_u32 s31, s31, 1
    s_cmp_eq_u32 s31, 3
    s_cselect_b32 s44, 0, s31
    s_lshl_b32 s31, s44, 3
    s_add_u32 s31, s31, 16
    s_load_dwordx2 s[72:73], s[0:1], s31
    s_load_dwordx2 s[74:75], s[0:1], 0
    s_mov_b32 s76, 8388608
    s_mov_b32 s39, 8192
    s_and_b32 s31, s28, 31
    s_lshl_b32 s31, s31, 8
    s_lshl_b32 s36, s44, 24
    s_and_b32 s33, s28, 31
    s_lshl_b32 s33, s33, 13
    s_add_u32 s36, s36, s33
    s_mov_b32 s37, 262144
    s_and_b32 s50, s28, 31
    s_lshl_b32 s50, s50, 7
    s_lshl_b32 s33, s44, 2
    s_add_u32 s50, s50, s33
    s_add_u32 s50, s50, 115343360
    s_branch sl_c_50
sl_b_49:
    s_sub_u32 s32, s28, 96
    s_lshr_b32 s44, s32, 3
    s_load_dwordx2 s[72:73], s[0:1], 64
    s_load_dwordx2 s[74:75], s[0:1], 56
    s_mov_b32 s76, 6291456
    s_mov_b32 s39, 6144
    s_lshl_b32 s31, s32, 8
    s_lshl_b32 s36, s44, 22
    s_and_b32 s33, s32, 7
    s_lshl_b32 s33, s33, 13
    s_add_u32 s36, s36, s33
    s_add_u32 s36, s36, 50331648
    s_mov_b32 s37, 65536
    s_and_b32 s50, s32, 7
    s_lshl_b32 s50, s50, 7
    s_lshl_b32 s33, s44, 2
    s_add_u32 s50, s50, s33
    s_add_u32 s50, s50, 115347456
sl_c_50:
    s_waitcnt lgkmcnt(0)
    s_mov_b32 s8, s72
    s_and_b32 s9, s73, 0xffff
    s_mov_b32 s10, s76
    s_mov_b32 s11, 0x00020000
    s_mov_b32 s12, s74
    s_and_b32 s13, s75, 0xffff
    s_mov_b32 s14, 4194304
    s_mov_b32 s15, 0x00020000
    s_mov_b64 s[80:81], s[72:73]
    s_mov_b32 s45, s31
    s_cmp_lt_u32 s28, 96
    s_cbranch_scc1 sl_go_51
    s_mov_b64 exec, 1
    v_mov_b32 v2, 0
    buffer_store_dword v2, v2, s[4:7], s50 offen sc1
    s_mov_b64 exec, -1
    s_cmp_lt_u32 s28, 96
    s_cbranch_scc1 tw_skip_53
    s_load_dwordx2 s[72:73], s[0:1], 40
    s_and_b32 s31, s28, 31
    s_lshl_b32 s31, s31, 13
    s_lshl_b32 s33, s29, 21
    s_add_u32 s31, s31, s33
    v_lshl_add_u32 v2, v1, 7, s31
    s_waitcnt lgkmcnt(0)
    s_mov_b32 s8, s72
    s_and_b32 s9, s73, 0xffff
    s_mov_b32 s10, 8388608
    s_mov_b32 s11, 0x00020000
    s_mov_b32 s31, 0
    buffer_load_dword v128, v2, s[8:11], s31 offen
    s_mov_b32 s31, 262144
    buffer_load_dword v129, v2, s[8:11], s31 offen
    s_mov_b32 s31, 524288
    buffer_load_dword v130, v2, s[8:11], s31 offen
    s_mov_b32 s31, 786432
    buffer_load_dword v131, v2, s[8:11], s31 offen
    s_mov_b32 s31, 1048576
    buffer_load_dword v132, v2, s[8:11], s31 offen
    s_mov_b32 s31, 1310720
    buffer_load_dword v133, v2, s[8:11], s31 offen
    s_mov_b32 s31, 1572864
    buffer_load_dword v134, v2, s[8:11], s31 offen
    s_mov_b32 s31, 1835008
    buffer_load_dword v135, v2, s[8:11], s31 offen
tw_skip_53:
    s_and_b32 s59, s28, 31
    s_lshl_b32 s59, s59, 2
    s_add_u32 s59, s59, s29
    s_sub_u32 s31, 0, s90
    s_and_b32 s31, s31, 2097151
    s_and_b32 s60, s59, 7
    s_lshl_b32 s60, s60, 21
    s_lshr_b32 s33, s59, 3
    s_and_b32 s33, s33, 1
    s_lshl_b32 s33, s33, 13
    s_add_u32 s60, s60, s33
    s_lshr_b32 s33, s59, 4
    s_and_b32 s33, s33, 7
    s_lshl_b32 s33, s33, 8
    s_add_u32 s60, s60, s33
    s_add_u32 s60, s60, s31
    s_add_u32 s60, s60, 117686272
    s_lshr_b32 s32, s59, 3
    s_and_b32 s32, s32, 1
    s_lshl_b32 s32, s32, 14
    s_sub_u32 s61, s60, s32
    s_add_u32 s61, s61, 8192
    s_load_dword s68, s[90:91], s60 glc
    s_mov_b32 s62, -1
    s_load_dword s69, s[90:91], s61 glc
    s_mov_b32 s63, -1
    s_waitcnt lgkmcnt(0)
    s_memtime s[64:65]
    s_waitcnt lgkmcnt(0)
    s_load_dword s68, s[90:91], s60 glc
    s_waitcnt lgkmcnt(0)
    s_memtime s[66:67]
    s_waitcnt lgkmcnt(0)
    s_sub_u32 s31, s66, s64
    s_min_u32 s62, s62, s31
    s_waitcnt lgkmcnt(0)
    s_memtime s[64:65]
    s_waitcnt lgkmcnt(0)
    s_load_dword s68, s[90:91], s61 glc
    s_waitcnt lgkmcnt(0)
    s_memtime s[66:67]
    s_waitcnt lgkmcnt(0)
    s_sub_u32 s31, s66, s64
    s_min_u32 s63, s63, s31
    s_waitcnt lgkmcnt(0)
    s_memtime s[64:65]
    s_waitcnt lgkmcnt(0)
    s_load_dword s68, s[90:91], s60 glc
    s_waitcnt lgkmcnt(0)
    s_memtime s[66:67]
    s_waitcnt lgkmcnt(0)
    s_sub_u32 s31, s66, s64
    s_min_u32 s62, s62, s31
    s_waitcnt lgkmcnt(0)
    s_memtime s[64:65]
    s_waitcnt lgkmcnt(0)
    s_load_dword s68, s[90:91], s61 glc
    s_waitcnt lgkmcnt(0)
    s_memtime s[66:67]
    s_waitcnt lgkmcnt(0)
    s_sub_u32 s31, s66, s64
    s_min_u32 s63, s63, s31
    s_cmp_gt_u32 s63, s62
    s_cselect_b32 s31, 1, 0
    s_lshr_b32 s32, s59, 3
    s_xor_b32 s31, s31, s32
    s_xor_b32 s31, s31, s59
    s_and_b32 s31, s31, 1
    s_add_u32 s71, s71, s31
    s_waitcnt vmcnt(8)
    s_mov_b64 exec, 1
    v_mov_b32 v4, 0
    v_mov_b32 v2, 1
    v_mov_b32 v3, s71
    global_atomic_add_x2 v4, v[2:3], s[92:93] offset:0 sc1
    s_mov_b64 exec, -1
sl_a2_52:
    s_mov_b32 s8, s80
    s_and_b32 s9, s81, 0xffff
    s_mov_b32 s10, s76
    s_mov_b32 s11, 0x00020000
    s_cmp_lt_u32 s28, 96
    s_cselect_b32 s33, 96, 96
    s_cmp_lg_u32 s29, 0
    s_cbranch_scc1 g_wdd_55
g_wd_54:
    s_load_dword s84, s[92:93], 128 glc
    s_add_u32 s41, s41, 1
    s_cmp_ge_u32 s41, 0x200000
    s_cbranch_scc1 g_wdd_55
    s_waitcnt lgkmcnt(0)
    s_cmp_ge_u32 s84, s33
    s_cbranch_scc1 g_wdd_55
    s_sleep 32
    s_branch g_wd_54
g_wdd_55:
    s_waitcnt lgkmcnt(0)
    s_barrier
sl_go_51:
    v_lshrrev_b32 v2, 2, v1
    v_mul_lo_u32 v6, v2, s39
    s_mov_b32 s31, s45
    s_lshl_b32 s33, s29, 6
    s_add_u32 s31, s31, s33
    v_and_b32 v2, 3, v1
    v_lshlrev_b32 v2, 4, v2
    v_add_u32 v2, s31, v2
    v_add_u32 v6, v6, v2
    s_lshl_b32 s39, s39, 4
    s_mov_b32 s30, 0
    s_mov_b32 s51, 64
    s_mov_b32 s52, 4128768
    s_lshl_b32 s31, s29, 15
    v_lshrrev_b32 v7, 4, v1
    v_lshlrev_b32 v7, 9, v7
    v_bfe_u32 v4, v1, 2, 2
    v_lshl_add_u32 v7, v4, 6, v7
    v_bfe_u32 v4, v1, 1, 1
    v_lshl_add_u32 v7, v4, 5, v7
    v_and_b32 v4, 1, v1
    v_lshl_add_u32 v7, v4, 3, v7
    v_add_u32 v7, s31, v7
    s_lshl_b32 s32, s29, 15
    s_add_u32 m0, s32, 0
    s_mov_b32 s38, 0
    buffer_load_dwordx4 v6, s[8:11], s38 offen lds
    s_add_u32 m0, s32, 1024
    s_add_u32 s38, s38, s39
    buffer_load_dwordx4 v6, s[8:11], s38 offen lds
    s_add_u32 m0, s32, 2048
    s_add_u32 s38, s38, s39
    buffer_load_dwordx4 v6, s[8:11], s38 offen lds
    s_add_u32 m0, s32, 3072
    s_add_u32 s38, s38, s39
    buffer_load_dwordx4 v6, s[8:11], s38 offen lds
    s_add_u32 m0, s32, 4096
    s_add_u32 s38, s38, s39
    buffer_load_dwordx4 v6, s[8:11], s38 offen lds
    s_add_u32 m0, s32, 5120
    s_add_u32 s38, s38, s39
    buffer_load_dwordx4 v6, s[8:11], s38 offen lds
    s_add_u32 m0, s32, 6144
    s_add_u32 s38, s38, s39
    buffer_load_dwordx4 v6, s[8:11], s38 offen lds
    s_add_u32 m0, s32, 7168
    s_add_u32 s38, s38, s39
    buffer_load_dwordx4 v6, s[8:11], s38 offen lds
    s_add_u32 m0, s32, 8192
    s_add_u32 s38, s38, s39
    buffer_load_dwordx4 v6, s[8:11], s38 offen lds
    s_add_u32 m0, s32, 9216
    s_add_u32 s38, s38, s39
    buffer_load_dwordx4 v6, s[8:11], s38 offen lds
    s_add_u32 m0, s32, 10240
    s_add_u32 s38, s38, s39
    buffer_load_dwordx4 v6, s[8:11], s38 offen lds
    s_add_u32 m0, s32, 11264
    s_add_u32 s38, s38, s39
    buffer_load_dwordx4 v6, s[8:11], s38 offen lds
    s_add_u32 m0, s32, 12288
    s_add_u32 s38, s38, s39
    buffer_load_dwordx4 v6, s[8:11], s38 offen lds
    s_add_u32 m0, s32, 13312
    s_add_u32 s38, s38, s39
    buffer_load_dwordx4 v6, s[8:11], s38 offen lds
    s_add_u32 m0, s32, 14336
    s_add_u32 s38, s38, s39
    buffer_load_dwordx4 v6, s[8:11], s38 offen lds
    s_add_u32 m0, s32, 15360
    s_add_u32 s38, s38, s39
    buffer_load_dwordx4 v6, s[8:11], s38 offen lds
    s_add_u32 m0, s32, 16384
    s_add_u32 s38, s38, s39
    buffer_load_dwordx4 v6, s[8:11], s38 offen lds
    s_add_u32 m0, s32, 17408
    s_add_u32 s38, s38, s39
    buffer_load_dwordx4 v6, s[8:11], s38 offen lds
    s_add_u32 m0, s32, 18432
    s_add_u32 s38, s38, s39
    buffer_load_dwordx4 v6, s[8:11], s38 offen lds
    s_add_u32 m0, s32, 19456
    s_add_u32 s38, s38, s39
    buffer_load_dwordx4 v6, s[8:11], s38 offen lds
    s_add_u32 m0, s32, 20480
    s_add_u32 s38, s38, s39
    buffer_load_dwordx4 v6, s[8:11], s38 offen lds
    s_add_u32 m0, s32, 21504
    s_add_u32 s38, s38, s39
    buffer_load_dwordx4 v6, s[8:11], s38 offen lds
    s_add_u32 m0, s32, 22528
    s_add_u32 s38, s38, s39
    buffer_load_dwordx4 v6, s[8:11], s38 offen lds
    s_add_u32 m0, s32, 23552
    s_add_u32 s38, s38, s39
    buffer_load_dwordx4 v6, s[8:11], s38 offen lds
    s_add_u32 m0, s32, 24576
    s_add_u32 s38, s38, s39
    buffer_load_dwordx4 v6, s[8:11], s38 offen lds
    s_add_u32 m0, s32, 25600
    s_add_u32 s38, s38, s39
    buffer_load_dwordx4 v6, s[8:11], s38 offen lds
    s_add_u32 m0, s32, 26624
    s_add_u32 s38, s38, s39
    buffer_load_dwordx4 v6, s[8:11], s38 offen lds
    s_add_u32 m0, s32, 27648
    s_add_u32 s38, s38, s39
    buffer_load_dwordx4 v6, s[8:11], s38 offen lds
    s_add_u32 m0, s32, 28672
    s_add_u32 s38, s38, s39
    buffer_load_dwordx4 v6, s[8:11], s38 offen lds
    s_add_u32 m0, s32, 29696
    s_add_u32 s38, s38, s39
    buffer_load_dwordx4 v6, s[8:11], s38 offen lds
    s_add_u32 m0, s32, 30720
    s_add_u32 s38, s38, s39
    buffer_load_dwordx4 v6, s[8:11], s38 offen lds
    s_add_u32 m0, s32, 31744
    s_add_u32 s38, s38, s39
    buffer_load_dwordx4 v6, s[8:11], s38 offen lds
    s_waitcnt vmcnt(30)
    ds_read_b64_tr_b16 a[0:1], v7 offset:0
    ds_read_b64_tr_b16 a[2:3], v7 offset:256
    ds_read_b64_tr_b16 a[4:5], v7 offset:16
    ds_read_b64_tr_b16 a[6:7], v7 offset:272
    s_waitcnt vmcnt(28)
    ds_read_b64_tr_b16 a[8:9], v7 offset:2048
    ds_read_b64_tr_b16 a[10:11], v7 offset:2304
    ds_read_b64_tr_b16 a[12:13], v7 offset:2064
    ds_read_b64_tr_b16 a[14:15], v7 offset:2320
    s_waitcnt lgkmcnt(4)
    s_add_u32 m0, s32, 0
    s_add_u32 s38, s38, s39
    buffer_load_dwordx4 v6, s[8:11], s38 offen lds
    s_add_u32 m0, s32, 1024
    s_add_u32 s38, s38, s39
    buffer_load_dwordx4 v6, s[8:11], s38 offen lds
    s_waitcnt vmcnt(28)
    v_mov_b32 v2, 0
    global_load_dword v31, v2, s[92:93] offset:192 sc1
    ds_read_b64_tr_b16 a[16:17], v7 offset:4096
    ds_read_b64_tr_b16 a[18:19], v7 offset:4352
    ds_read_b64_tr_b16 a[20:21], v7 offset:4112
    ds_read_b64_tr_b16 a[22:23], v7 offset:4368
    s_waitcnt lgkmcnt(4)
    s_add_u32 m0, s32, 2048
    s_add_u32 s38, s38, s39
    buffer_load_dwordx4 v6, s[8:11], s38 offen lds
    s_add_u32 m0, s32, 3072
    s_add_u32 s38, s38, s39
    buffer_load_dwordx4 v6, s[8:11], s38 offen lds
    s_waitcnt vmcnt(28)
    ds_read_b64_tr_b16 a[24:25], v7 offset:6144
    ds_read_b64_tr_b16 a[26:27], v7 offset:6400
    ds_read_b64_tr_b16 a[28:29], v7 offset:6160
    ds_read_b64_tr_b16 a[30:31], v7 offset:6416
    s_waitcnt lgkmcnt(4)
    s_add_u32 m0, s32, 4096
    s_add_u32 s38, s38, s39
    buffer_load_dwordx4 v6, s[8:11], s38 offen lds
    s_add_u32 m0, s32, 5120
    s_add_u32 s38, s38, s39
    buffer_load_dwordx4 v6, s[8:11], s38 offen lds
    s_waitcnt vmcnt(28)
    ds_read_b64_tr_b16 a[32:33], v7 offset:8192
    ds_read_b64_tr_b16 a[34:35], v7 offset:8448
    ds_read_b64_tr_b16 a[36:37], v7 offset:8208
    ds_read_b64_tr_b16 a[38:39], v7 offset:8464
    s_waitcnt lgkmcnt(4)
    s_add_u32 m0, s32, 6144
    s_add_u32 s38, s38, s39
    buffer_load_dwordx4 v6, s[8:11], s38 offen lds
    s_add_u32 m0, s32, 7168
    s_add_u32 s38, s38, s39
    buffer_load_dwordx4 v6, s[8:11], s38 offen lds
    s_waitcnt vmcnt(28)
    ds_read_b64_tr_b16 a[40:41], v7 offset:10240
    ds_read_b64_tr_b16 a[42:43], v7 offset:10496
    ds_read_b64_tr_b16 a[44:45], v7 offset:10256
    ds_read_b64_tr_b16 a[46:47], v7 offset:10512
    s_waitcnt lgkmcnt(4)
    s_add_u32 m0, s32, 8192
    s_add_u32 s38, s38, s39
    buffer_load_dwordx4 v6, s[8:11], s38 offen lds
    s_add_u32 m0, s32, 9216
    s_add_u32 s38, s38, s39
    buffer_load_dwordx4 v6, s[8:11], s38 offen lds
    s_waitcnt vmcnt(28)
    ds_read_b64_tr_b16 a[48:49], v7 offset:12288
    ds_read_b64_tr_b16 a[50:51], v7 offset:12544
    ds_read_b64_tr_b16 a[52:53], v7 offset:12304
    ds_read_b64_tr_b16 a[54:55], v7 offset:12560
    s_waitcnt lgkmcnt(4)
    s_add_u32 m0, s32, 10240
    s_add_u32 s38, s38, s39
    buffer_load_dwordx4 v6, s[8:11], s38 offen lds
    s_add_u32 m0, s32, 11264
    s_add_u32 s38, s38, s39
    buffer_load_dwordx4 v6, s[8:11], s38 offen lds
    s_waitcnt vmcnt(28)
    ds_read_b64_tr_b16 a[56:57], v7 offset:14336
    ds_read_b64_tr_b16 a[58:59], v7 offset:14592
    ds_read_b64_tr_b16 a[60:61], v7 offset:14352
    ds_read_b64_tr_b16 a[62:63], v7 offset:14608
    s_waitcnt lgkmcnt(4)
    s_add_u32 m0, s32, 12288
    s_add_u32 s38, s38, s39
    buffer_load_dwordx4 v6, s[8:11], s38 offen lds
    s_add_u32 m0, s32, 13312
    s_add_u32 s38, s38, s39
    buffer_load_dwordx4 v6, s[8:11], s38 offen lds
    s_waitcnt vmcnt(28)
    ds_read_b64_tr_b16 a[64:65], v7 offset:16384
    ds_read_b64_tr_b16 a[66:67], v7 offset:16640
    ds_read_b64_tr_b16 a[68:69], v7 offset:16400
    ds_read_b64_tr_b16 a[70:71], v7 offset:16656
    s_waitcnt lgkmcnt(4)
    s_add_u32 m0, s32, 14336
    s_add_u32 s38, s38, s39
    buffer_load_dwordx4 v6, s[8:11], s38 offen lds
    s_add_u32 m0, s32, 15360
    s_add_u32 s38, s38, s39
    buffer_load_dwordx4 v6, s[8:11], s38 offen lds
    s_waitcnt vmcnt(28)
    ds_read_b64_tr_b16 a[72:73], v7 offset:18432
    ds_read_b64_tr_b16 a[74:75], v7 offset:18688
    ds_read_b64_tr_b16 a[76:77], v7 offset:18448
    ds_read_b64_tr_b16 a[78:79], v7 offset:18704
    s_waitcnt lgkmcnt(4)
    s_add_u32 m0, s32, 16384
    s_add_u32 s38, s38, s39
    buffer_load_dwordx4 v6, s[8:11], s38 offen lds
    s_add_u32 m0, s32, 17408
    s_add_u32 s38, s38, s39
    buffer_load_dwordx4 v6, s[8:11], s38 offen lds
    s_waitcnt vmcnt(28)
    ds_read_b64_tr_b16 a[80:81], v7 offset:20480
    ds_read_b64_tr_b16 a[82:83], v7 offset:20736
    ds_read_b64_tr_b16 a[84:85], v7 offset:20496
    ds_read_b64_tr_b16 a[86:87], v7 offset:20752
    s_waitcnt lgkmcnt(4)
    s_add_u32 m0, s32, 18432
    s_add_u32 s38, s38, s39
    buffer_load_dwordx4 v6, s[8:11], s38 offen lds
    s_add_u32 m0, s32, 19456
    s_add_u32 s38, s38, s39
    buffer_load_dwordx4 v6, s[8:11], s38 offen lds
    s_waitcnt vmcnt(28)
    ds_read_b64_tr_b16 a[88:89], v7 offset:22528
    ds_read_b64_tr_b16 a[90:91], v7 offset:22784
    ds_read_b64_tr_b16 a[92:93], v7 offset:22544
    ds_read_b64_tr_b16 a[94:95], v7 offset:22800
    s_waitcnt lgkmcnt(4)
    s_add_u32 m0, s32, 20480
    s_add_u32 s38, s38, s39
    buffer_load_dwordx4 v6, s[8:11], s38 offen lds
    s_add_u32 m0, s32, 21504
    s_add_u32 s38, s38, s39
    buffer_load_dwordx4 v6, s[8:11], s38 offen lds
    s_waitcnt vmcnt(28)
    ds_read_b64_tr_b16 a[96:97], v7 offset:24576
    ds_read_b64_tr_b16 a[98:99], v7 offset:24832
    ds_read_b64_tr_b16 a[100:101], v7 offset:24592
    ds_read_b64_tr_b16 a[102:103], v7 offset:24848
    s_waitcnt lgkmcnt(4)
    s_add_u32 m0, s32, 22528
    s_add_u32 s38, s38, s39
    buffer_load_dwordx4 v6, s[8:11], s38 offen lds
    s_add_u32 m0, s32, 23552
    s_add_u32 s38, s38, s39
    buffer_load_dwordx4 v6, s[8:11], s38 offen lds
    s_waitcnt vmcnt(28)
    ds_read_b64_tr_b16 a[104:105], v7 offset:26624
    ds_read_b64_tr_b16 a[106:107], v7 offset:26880
    ds_read_b64_tr_b16 a[108:109], v7 offset:26640
    ds_read_b64_tr_b16 a[110:111], v7 offset:26896
    s_waitcnt lgkmcnt(4)
    s_add_u32 m0, s32, 24576
    s_add_u32 s38, s38, s39
    buffer_load_dwordx4 v6, s[8:11], s38 offen lds
    s_add_u32 m0, s32, 25600
    s_add_u32 s38, s38, s39
    buffer_load_dwordx4 v6, s[8:11], s38 offen lds
    s_waitcnt vmcnt(28)
    ds_read_b64_tr_b16 a[112:113], v7 offset:28672
    ds_read_b64_tr_b16 a[114:115], v7 offset:28928
    ds_read_b64_tr_b16 a[116:117], v7 offset:28688
    ds_read_b64_tr_b16 a[118:119], v7 offset:28944
    s_waitcnt lgkmcnt(4)
    s_add_u32 m0, s32, 26624
    s_add_u32 s38, s38, s39
    buffer_load_dwordx4 v6, s[8:11], s38 offen lds
    s_add_u32 m0, s32, 27648
    s_add_u32 s38, s38, s39
    buffer_load_dwordx4 v6, s[8:11], s38 offen lds
    s_waitcnt vmcnt(28)
    ds_read_b64_tr_b16 a[120:121], v7 offset:30720
    ds_read_b64_tr_b16 a[122:123], v7 offset:30976
    ds_read_b64_tr_b16 a[124:125], v7 offset:30736
    ds_read_b64_tr_b16 a[126:127], v7 offset:30992
    s_waitcnt lgkmcnt(4)
    s_add_u32 m0, s32, 28672
    s_add_u32 s38, s38, s39
    buffer_load_dwordx4 v6, s[8:11], s38 offen lds
    s_add_u32 m0, s32, 29696
    s_add_u32 s38, s38, s39
    buffer_load_dwordx4 v6, s[8:11], s38 offen lds
    s_waitcnt vmcnt(28)
    ds_read_b64_tr_b16 a[128:129], v7 offset:0
    ds_read_b64_tr_b16 a[130:131], v7 offset:256
    ds_read_b64_tr_b16 a[132:133], v7 offset:16
    ds_read_b64_tr_b16 a[134:135], v7 offset:272
    s_waitcnt lgkmcnt(4)
    s_add_u32 m0, s32, 30720
    s_add_u32 s38, s38, s39
    buffer_load_dwordx4 v6, s[8:11], s38 offen lds
    s_add_u32 m0, s32, 31744
    s_add_u32 s38, s38, s39
    buffer_load_dwordx4 v6, s[8:11], s38 offen lds
    s_waitcnt vmcnt(28)
    s_branch valc_58
val_57:
    v_mov_b32 v2, 0
    global_load_dword v31, v2, s[92:93] offset:192 sc1
    s_add_u32 s41, s41, 1
    s_cmp_ge_u32 s41, 0x80000
    s_cbranch_scc1 L_end
    s_waitcnt vmcnt(0)
valc_58:
    v_readfirstlane_b32 s31, v31
    s_cmp_eq_u32 s31, s70
    s_cbranch_scc1 valok_59
    s_cmp_eq_u32 s31, 0
    s_cbranch_scc1 val_57
    s_mov_b32 s70, s31
    s_mov_b32 s71, 65536
    s_waitcnt vmcnt(0) lgkmcnt(0)
    s_barrier
    s_branch L_role
valok_59:
    ds_read_b64_tr_b16 a[136:137], v7 offset:2048
    ds_read_b64_tr_b16 a[138:139], v7 offset:2304
    ds_read_b64_tr_b16 a[140:141], v7 offset:2064
    ds_read_b64_tr_b16 a[142:143], v7 offset:2320
    s_waitcnt vmcnt(26)
    ds_read_b64_tr_b16 a[144:145], v7 offset:4096
    ds_read_b64_tr_b16 a[146:147], v7 offset:4352
    ds_read_b64_tr_b16 a[148:149], v7 offset:4112
    ds_read_b64_tr_b16 a[150:151], v7 offset:4368
    s_waitcnt vmcnt(24)
    ds_read_b64_tr_b16 a[152:153], v7 offset:6144
    ds_read_b64_tr_b16 a[154:155], v7 offset:6400
    ds_read_b64_tr_b16 a[156:157], v7 offset:6160
    ds_read_b64_tr_b16 a[158:159], v7 offset:6416
    s_waitcnt vmcnt(22)
    ds_read_b64_tr_b16 a[160:161], v7 offset:8192
    ds_read_b64_tr_b16 a[162:163], v7 offset:8448
    ds_read_b64_tr_b16 a[164:165], v7 offset:8208
    ds_read_b64_tr_b16 a[166:167], v7 offset:8464
    s_waitcnt vmcnt(20)
    ds_read_b64_tr_b16 a[168:169], v7 offset:10240
    ds_read_b64_tr_b16 a[170:171], v7 offset:10496
    ds_read_b64_tr_b16 a[172:173], v7 offset:10256
    ds_read_b64_tr_b16 a[174:175], v7 offset:10512
    s_waitcnt vmcnt(18)
    ds_read_b64_tr_b16 a[176:177], v7 offset:12288
    ds_read_b64_tr_b16 a[178:179], v7 offset:12544
    ds_read_b64_tr_b16 a[180:181], v7 offset:12304
    ds_read_b64_tr_b16 a[182:183], v7 offset:12560
    s_waitcnt vmcnt(16)
    ds_read_b64_tr_b16 a[184:185], v7 offset:14336
    ds_read_b64_tr_b16 a[186:187], v7 offset:14592
    ds_read_b64_tr_b16 a[188:189], v7 offset:14352
    ds_read_b64_tr_b16 a[190:191], v7 offset:14608
    s_waitcnt vmcnt(14)
    ds_read_b64_tr_b16 a[192:193], v7 offset:16384
    ds_read_b64_tr_b16 a[194:195], v7 offset:16640
    ds_read_b64_tr_b16 a[196:197], v7 offset:16400
    ds_read_b64_tr_b16 a[198:199], v7 offset:16656
    s_waitcnt vmcnt(12)
    ds_read_b64_tr_b16 a[200:201], v7 offset:18432
    ds_read_b64_tr_b16 a[202:203], v7 offset:18688
    ds_read_b64_tr_b16 a[204:205], v7 offset:18448
    ds_read_b64_tr_b16 a[206:207], v7 offset:18704
    s_waitcnt vmcnt(10)
    ds_read_b64_tr_b16 a[208:209], v7 offset:20480
    ds_read_b64_tr_b16 a[210:211], v7 offset:20736
    ds_read_b64_tr_b16 a[212:213], v7 offset:20496
    ds_read_b64_tr_b16 a[214:215], v7 offset:20752
    s_waitcnt vmcnt(8)
    ds_read_b64_tr_b16 a[216:217], v7 offset:22528
    ds_read_b64_tr_b16 a[218:219], v7 offset:22784
    ds_read_b64_tr_b16 a[220:221], v7 offset:22544
    ds_read_b64_tr_b16 a[222:223], v7 offset:22800
    s_waitcnt vmcnt(6)
    ds_read_b64_tr_b16 a[224:225], v7 offset:24576
    ds_read_b64_tr_b16 a[226:227], v7 offset:24832
    ds_read_b64_tr_b16 a[228:229], v7 offset:24592
    ds_read_b64_tr_b16 a[230:231], v7 offset:24848
    s_waitcnt vmcnt(4)
    ds_read_b64_tr_b16 a[232:233], v7 offset:26624
    ds_read_b64_tr_b16 a[234:235], v7 offset:26880
    ds_read_b64_tr_b16 a[236:237], v7 offset:26640
    ds_read_b64_tr_b16 a[238:239], v7 offset:26896
    s_waitcnt vmcnt(2)
    ds_read_b64_tr_b16 a[240:241], v7 offset:28672
    ds_read_b64_tr_b16 a[242:243], v7 offset:28928
    ds_read_b64_tr_b16 a[244:245], v7 offset:28688
    ds_read_b64_tr_b16 a[246:247], v7 offset:28944
    s_waitcnt vmcnt(0)
    ds_read_b64_tr_b16 a[248:249], v7 offset:30720
    ds_read_b64_tr_b16 a[250:251], v7 offset:30976
    ds_read_b64_tr_b16 a[252:253], v7 offset:30736
    ds_read_b64_tr_b16 a[254:255], v7 offset:30992
    s_waitcnt lgkmcnt(0)
    s_lshr_b32 s31, s29, 1
    s_and_b32 s31, s31, 1
    s_lshl_b32 s31, s31, 2
    v_lshrrev_b32 v2, 4, v1
    v_add_u32 v2, s31, v2
    v_and_b32 v3, 7, v1
    v_xor_b32 v2, v2, v3
    s_lshl_b32 s31, s29, 14
    v_lshrrev_b32 v8, 3, v1
    v_lshlrev_b32 v8, 11, v8
    v_add_u32 v8, s31, v8
    v_lshl_add_u32 v8, v2, 4, v8
    v_bfe_u32 v2, v1, 1, 3
    v_lshrrev_b32 v3, 4, v1
    v_xor_b32 v2, v2, v3
    v_bfe_u32 v3, v1, 3, 1
    v_lshlrev_b32 v3, 11, v3
    v_and_b32 v4, 7, v1
    v_lshl_add_u32 v3, v4, 7, v3
    v_xor_b32 v12, 0, v2
    v_lshl_add_u32 v12, v12, 4, v3
    v_add_u32 v14, 65536, v12
    v_xor_b32 v13, 4, v2
    v_lshl_add_u32 v13, v13, 4, v3
    v_add_u32 v15, 65536, v13
    s_lshl_b32 s31, s29, 11
    v_lshrrev_b32 v9, 4, v1
    v_lshlrev_b32 v9, 9, v9
    v_bfe_u32 v4, v1, 3, 1
    v_lshl_add_u32 v9, v4, 8, v9
    v_and_b32 v4, 7, v1
    v_lshl_add_u32 v9, v4, 4, v9
    v_add_u32 v9, s31, v9
    v_mov_b32 v10, s50
    s_cmp_eq_u32 s29, 0
    s_cselect_b64 vcc, 1, 0
    v_mov_b32 v4, 2130706432
    v_cndmask_b32 v10, v4, v10, vcc
    v_mov_b32 v11, 0
    s_cmp_lt_u32 s28, 96
    s_cselect_b32 s46, s29, 1
    s_min_u32 s46, s46, 1
    s_lshl_b32 s35, s30, 16
    s_sub_u32 s36, s36, s37
    s_barrier
    s_add_u32 m0, s34, 0
    s_nop 0
    buffer_load_dwordx4 v8, s[12:15], s35 offen offset:0 lds
    s_add_u32 m0, s34, 3968
    s_nop 0
    buffer_load_dwordx4 v8, s[12:15], s35 offen offset:128 lds
    s_add_u32 m0, s34, 7936
    s_nop 0
    buffer_load_dwordx4 v8, s[12:15], s35 offen offset:256 lds
    s_add_u32 m0, s34, 11904
    s_nop 0
    buffer_load_dwordx4 v8, s[12:15], s35 offen offset:384 lds
    s_add_u32 m0, s34, 15872
    s_nop 0
    buffer_load_dwordx4 v8, s[12:15], s35 offen offset:512 lds
    s_add_u32 m0, s34, 19840
    s_nop 0
    buffer_load_dwordx4 v8, s[12:15], s35 offen offset:640 lds
    s_add_u32 m0, s34, 23808
    s_nop 0
    buffer_load_dwordx4 v8, s[12:15], s35 offen offset:768 lds
    s_add_u32 m0, s34, 27776
    s_nop 0
    buffer_load_dwordx4 v8, s[12:15], s35 offen offset:896 lds
    s_add_u32 m0, s34, 31744
    s_nop 0
    buffer_load_dwordx4 v8, s[12:15], s35 offen offset:1024 lds
    s_add_u32 m0, s34, 35712
    s_nop 0
    buffer_load_dwordx4 v8, s[12:15], s35 offen offset:1152 lds
    s_add_u32 m0, s34, 39680
    s_nop 0
    buffer_load_dwordx4 v8, s[12:15], s35 offen offset:1280 lds
    s_add_u32 m0, s34, 43648
    s_nop 0
    buffer_load_dwordx4 v8, s[12:15], s35 offen offset:1408 lds
    s_add_u32 m0, s34, 47616
    s_nop 0
    buffer_load_dwordx4 v8, s[12:15], s35 offen offset:1536 lds
    s_add_u32 m0, s34, 51584
    s_nop 0
    buffer_load_dwordx4 v8, s[12:15], s35 offen offset:1664 lds
    s_add_u32 m0, s34, 55552
    s_nop 0
    buffer_load_dwordx4 v8, s[12:15], s35 offen offset:1792 lds
    s_add_u32 m0, s34, 59520
    s_nop 0
    buffer_load_dwordx4 v8, s[12:15], s35 offen offset:1920 lds
    s_add_u32 s35, s35, 65536
    s_add_u32 m0, s34, 65536
    s_nop 0
    buffer_load_dwordx4 v8, s[12:15], s35 offen offset:0 lds
    s_add_u32 m0, s34, 69504
    s_nop 0
    buffer_load_dwordx4 v8, s[12:15], s35 offen offset:128 lds
    s_add_u32 m0, s34, 73472
    s_nop 0
    buffer_load_dwordx4 v8, s[12:15], s35 offen offset:256 lds
    s_add_u32 m0, s34, 77440
    s_nop 0
    buffer_load_dwordx4 v8, s[12:15], s35 offen offset:384 lds
    s_waitcnt vmcnt(12)
    s_barrier
    ds_read_b128 v[32:35], v12 offset:0
    ds_read_b128 v[36:39], v12 offset:1024
    ds_read_b128 v[40:43], v13 offset:0
    ds_read_b128 v[44:47], v13 offset:1024
    ds_read_b128 v[48:51], v12 offset:4096
    ds_read_b128 v[52:55], v12 offset:5120
    v_add_u32 v9, 2130706432, v9
    s_cmp_eq_u32 s44, 2
    s_cbranch_scc1 sl_v_61
sl_loop_63:
    s_waitcnt lgkmcnt(4)
    v_mfma_f32_16x16x32_bf16 v[64:67], a[0:3], v[32:35], 0
    ds_read_b128 v[56:59], v13 offset:4096
    v_mfma_f32_16x16x32_bf16 v[68:71], a[4:7], v[32:35], 0
    v_mfma_f32_16x16x32_bf16 v[72:75], a[0:3], v[36:39], 0
    ds_read_b128 v[60:63], v13 offset:5120
    s_add_u32 m0, s34, 81408
    v_mfma_f32_16x16x32_bf16 v[76:79], a[4:7], v[36:39], 0
    buffer_load_dwordx4 v8, s[12:15], s35 offen offset:512 lds
    s_waitcnt lgkmcnt(4)
    v_mfma_f32_16x16x32_bf16 v[64:67], a[8:11], v[40:43], v[64:67]
    ds_read_b128 v[32:35], v12 offset:8192
    v_mfma_f32_16x16x32_bf16 v[68:71], a[12:15], v[40:43], v[68:71]
    v_mfma_f32_16x16x32_bf16 v[72:75], a[8:11], v[44:47], v[72:75]
    ds_read_b128 v[36:39], v12 offset:9216
    v_mfma_f32_16x16x32_bf16 v[76:79], a[12:15], v[44:47], v[76:79]
    s_waitcnt lgkmcnt(4)
    v_mfma_f32_16x16x32_bf16 v[64:67], a[16:19], v[48:51], v[64:67]
    ds_read_b128 v[40:43], v13 offset:8192
    v_mfma_f32_16x16x32_bf16 v[68:71], a[20:23], v[48:51], v[68:71]
    v_cvt_pk_bf16_f32 v96, v80, v81
    v_mfma_f32_16x16x32_bf16 v[72:75], a[16:19], v[52:55], v[72:75]
    ds_read_b128 v[44:47], v13 offset:9216
    s_add_u32 m0, s34, 85376
    v_mfma_f32_16x16x32_bf16 v[76:79], a[20:23], v[52:55], v[76:79]
    buffer_load_dwordx4 v8, s[12:15], s35 offen offset:640 lds
    v_cvt_pk_bf16_f32 v97, v82, v83
    s_waitcnt lgkmcnt(4)
    v_mfma_f32_16x16x32_bf16 v[64:67], a[24:27], v[56:59], v[64:67]
    ds_read_b128 v[48:51], v12 offset:12288
    v_mfma_f32_16x16x32_bf16 v[68:71], a[28:31], v[56:59], v[68:71]
    v_cvt_pk_bf16_f32 v98, v84, v85
    v_mfma_f32_16x16x32_bf16 v[72:75], a[24:27], v[60:63], v[72:75]
    ds_read_b128 v[52:55], v12 offset:13312
    v_mfma_f32_16x16x32_bf16 v[76:79], a[28:31], v[60:63], v[76:79]
    v_cvt_pk_bf16_f32 v99, v86, v87
    s_waitcnt lgkmcnt(4)
    v_mfma_f32_16x16x32_bf16 v[64:67], a[32:35], v[32:35], v[64:67]
    ds_read_b128 v[56:59], v13 offset:12288
    v_mfma_f32_16x16x32_bf16 v[68:71], a[36:39], v[32:35], v[68:71]
    v_cvt_pk_bf16_f32 v100, v88, v89
    v_mfma_f32_16x16x32_bf16 v[72:75], a[32:35], v[36:39], v[72:75]
    ds_read_b128 v[60:63], v13 offset:13312
    s_add_u32 m0, s34, 89344
    v_mfma_f32_16x16x32_bf16 v[76:79], a[36:39], v[36:39], v[76:79]
    buffer_load_dwordx4 v8, s[12:15], s35 offen offset:768 lds
    v_cvt_pk_bf16_f32 v101, v90, v91
    s_waitcnt lgkmcnt(4)
    v_mfma_f32_16x16x32_bf16 v[64:67], a[40:43], v[40:43], v[64:67]
    ds_read_b128 v[32:35], v12 offset:16384
    v_mfma_f32_16x16x32_bf16 v[68:71], a[44:47], v[40:43], v[68:71]
    v_cvt_pk_bf16_f32 v102, v92, v93
    v_mfma_f32_16x16x32_bf16 v[72:75], a[40:43], v[44:47], v[72:75]
    ds_read_b128 v[36:39], v12 offset:17408
    v_mfma_f32_16x16x32_bf16 v[76:79], a[44:47], v[44:47], v[76:79]
    v_cvt_pk_bf16_f32 v103, v94, v95
    buffer_store_dwordx4 v[96:99], v9, s[4:7], s36 offen sc1
    s_waitcnt lgkmcnt(4)
    v_mfma_f32_16x16x32_bf16 v[64:67], a[48:51], v[48:51], v[64:67]
    ds_read_b128 v[40:43], v13 offset:16384
    v_mfma_f32_16x16x32_bf16 v[68:71], a[52:55], v[48:51], v[68:71]
    v_mfma_f32_16x16x32_bf16 v[72:75], a[48:51], v[52:55], v[72:75]
    ds_read_b128 v[44:47], v13 offset:17408
    s_add_u32 m0, s34, 93312
    v_mfma_f32_16x16x32_bf16 v[76:79], a[52:55], v[52:55], v[76:79]
    buffer_load_dwordx4 v8, s[12:15], s35 offen offset:896 lds
    s_waitcnt lgkmcnt(4)
    v_mfma_f32_16x16x32_bf16 v[64:67], a[56:59], v[56:59], v[64:67]
    ds_read_b128 v[48:51], v12 offset:20480
    v_mfma_f32_16x16x32_bf16 v[68:71], a[60:63], v[56:59], v[68:71]
    v_mfma_f32_16x16x32_bf16 v[72:75], a[56:59], v[60:63], v[72:75]
    ds_read_b128 v[52:55], v12 offset:21504
    v_mfma_f32_16x16x32_bf16 v[76:79], a[60:63], v[60:63], v[76:79]
    buffer_store_dwordx4 v[100:103], v9, s[4:7], s36 offen offset:128 sc1
    s_add_u32 s36, s36, s37
    s_waitcnt vmcnt(8)
    s_barrier
    s_waitcnt lgkmcnt(4)
    v_mfma_f32_16x16x32_bf16 v[64:67], a[64:67], v[32:35], v[64:67]
    ds_read_b128 v[56:59], v13 offset:20480
    v_mfma_f32_16x16x32_bf16 v[68:71], a[68:71], v[32:35], v[68:71]
    v_mfma_f32_16x16x32_bf16 v[72:75], a[64:67], v[36:39], v[72:75]
    ds_read_b128 v[60:63], v13 offset:21504
    s_add_u32 m0, s34, 97280
    v_mfma_f32_16x16x32_bf16 v[76:79], a[68:71], v[36:39], v[76:79]
    buffer_load_dwordx4 v8, s[12:15], s35 offen offset:1024 lds
    s_waitcnt lgkmcnt(4)
    v_mfma_f32_16x16x32_bf16 v[64:67], a[72:75], v[40:43], v[64:67]
    ds_read_b128 v[32:35], v12 offset:24576
    v_mfma_f32_16x16x32_bf16 v[68:71], a[76:79], v[40:43], v[68:71]
    v_mfma_f32_16x16x32_bf16 v[72:75], a[72:75], v[44:47], v[72:75]
    ds_read_b128 v[36:39], v12 offset:25600
    v_mfma_f32_16x16x32_bf16 v[76:79], a[76:79], v[44:47], v[76:79]
    s_waitcnt lgkmcnt(4)
    v_mfma_f32_16x16x32_bf16 v[64:67], a[80:83], v[48:51], v[64:67]
    ds_read_b128 v[40:43], v13 offset:24576
    v_mfma_f32_16x16x32_bf16 v[68:71], a[84:87], v[48:51], v[68:71]
    v_and_b32 v9, 0xffffff, v9
    v_mfma_f32_16x16x32_bf16 v[72:75], a[80:83], v[52:55], v[72:75]
    ds_read_b128 v[44:47], v13 offset:25600
    s_add_u32 m0, s34, 101248
    v_mfma_f32_16x16x32_bf16 v[76:79], a[84:87], v[52:55], v[76:79]
    buffer_load_dwordx4 v8, s[12:15], s35 offen offset:1152 lds
    s_waitcnt lgkmcnt(4)
    v_mfma_f32_16x16x32_bf16 v[64:67], a[88:91], v[56:59], v[64:67]
    ds_read_b128 v[48:51], v12 offset:28672
    v_mfma_f32_16x16x32_bf16 v[68:71], a[92:95], v[56:59], v[68:71]
    v_mfma_f32_16x16x32_bf16 v[72:75], a[88:91], v[60:63], v[72:75]
    ds_read_b128 v[52:55], v12 offset:29696
    v_mfma_f32_16x16x32_bf16 v[76:79], a[92:95], v[60:63], v[76:79]
    s_waitcnt lgkmcnt(4)
    v_mfma_f32_16x16x32_bf16 v[64:67], a[96:99], v[32:35], v[64:67]
    ds_read_b128 v[56:59], v13 offset:28672
    v_mfma_f32_16x16x32_bf16 v[68:71], a[100:103], v[32:35], v[68:71]
    v_mfma_f32_16x16x32_bf16 v[72:75], a[96:99], v[36:39], v[72:75]
    ds_read_b128 v[60:63], v13 offset:29696
    s_add_u32 m0, s34, 105216
    v_mfma_f32_16x16x32_bf16 v[76:79], a[100:103], v[36:39], v[76:79]
    buffer_load_dwordx4 v8, s[12:15], s35 offen offset:1280 lds
    s_waitcnt lgkmcnt(4)
    v_mfma_f32_16x16x32_bf16 v[64:67], a[104:107], v[40:43], v[64:67]
    ds_read_b128 v[32:35], v12 offset:32768
    v_mfma_f32_16x16x32_bf16 v[68:71], a[108:111], v[40:43], v[68:71]
    v_mfma_f32_16x16x32_bf16 v[72:75], a[104:107], v[44:47], v[72:75]
    ds_read_b128 v[36:39], v12 offset:33792
    v_mfma_f32_16x16x32_bf16 v[76:79], a[108:111], v[44:47], v[76:79]
    s_waitcnt lgkmcnt(4)
    v_mfma_f32_16x16x32_bf16 v[64:67], a[112:115], v[48:51], v[64:67]
    ds_read_b128 v[40:43], v13 offset:32768
    v_mfma_f32_16x16x32_bf16 v[68:71], a[116:119], v[48:51], v[68:71]
    v_mfma_f32_16x16x32_bf16 v[72:75], a[112:115], v[52:55], v[72:75]
    ds_read_b128 v[44:47], v13 offset:33792
    s_add_u32 m0, s34, 109184
    v_mfma_f32_16x16x32_bf16 v[76:79], a[116:119], v[52:55], v[76:79]
    buffer_load_dwordx4 v8, s[12:15], s35 offen offset:1408 lds
    s_waitcnt lgkmcnt(4)
    v_mfma_f32_16x16x32_bf16 v[64:67], a[120:123], v[56:59], v[64:67]
    ds_read_b128 v[48:51], v12 offset:36864
    v_mfma_f32_16x16x32_bf16 v[68:71], a[124:127], v[56:59], v[68:71]
    v_mfma_f32_16x16x32_bf16 v[72:75], a[120:123], v[60:63], v[72:75]
    ds_read_b128 v[52:55], v12 offset:37888
    v_mfma_f32_16x16x32_bf16 v[76:79], a[124:127], v[60:63], v[76:79]
    s_waitcnt lgkmcnt(4)
    v_mfma_f32_16x16x32_bf16 v[64:67], a[128:131], v[32:35], v[64:67]
    ds_read_b128 v[56:59], v13 offset:36864
    v_mfma_f32_16x16x32_bf16 v[68:71], a[132:135], v[32:35], v[68:71]
    v_mfma_f32_16x16x32_bf16 v[72:75], a[128:131], v[36:39], v[72:75]
    ds_read_b128 v[60:63], v13 offset:37888
    s_add_u32 m0, s34, 113152
    v_mfma_f32_16x16x32_bf16 v[76:79], a[132:135], v[36:39], v[76:79]
    buffer_load_dwordx4 v8, s[12:15], s35 offen offset:1536 lds
    s_waitcnt lgkmcnt(4)
    v_mfma_f32_16x16x32_bf16 v[64:67], a[136:139], v[40:43], v[64:67]
    ds_read_b128 v[32:35], v12 offset:40960
    v_mfma_f32_16x16x32_bf16 v[68:71], a[140:143], v[40:43], v[68:71]
    v_mfma_f32_16x16x32_bf16 v[72:75], a[136:139], v[44:47], v[72:75]
    ds_read_b128 v[36:39], v12 offset:41984
    v_mfma_f32_16x16x32_bf16 v[76:79], a[140:143], v[44:47], v[76:79]
    s_waitcnt lgkmcnt(4)
    v_mfma_f32_16x16x32_bf16 v[64:67], a[144:147], v[48:51], v[64:67]
    ds_read_b128 v[40:43], v13 offset:40960
    v_mfma_f32_16x16x32_bf16 v[68:71], a[148:151], v[48:51], v[68:71]
    v_mfma_f32_16x16x32_bf16 v[72:75], a[144:147], v[52:55], v[72:75]
    ds_read_b128 v[44:47], v13 offset:41984
    s_add_u32 m0, s34, 117120
    v_mfma_f32_16x16x32_bf16 v[76:79], a[148:151], v[52:55], v[76:79]
    buffer_load_dwordx4 v8, s[12:15], s35 offen offset:1664 lds
    s_waitcnt lgkmcnt(4)
    v_mfma_f32_16x16x32_bf16 v[64:67], a[152:155], v[56:59], v[64:67]
    ds_read_b128 v[48:51], v12 offset:45056
    v_mfma_f32_16x16x32_bf16 v[68:71], a[156:159], v[56:59], v[68:71]
    v_mfma_f32_16x16x32_bf16 v[72:75], a[152:155], v[60:63], v[72:75]
    ds_read_b128 v[52:55], v12 offset:46080
    v_mfma_f32_16x16x32_bf16 v[76:79], a[156:159], v[60:63], v[76:79]
    s_waitcnt lgkmcnt(4)
    v_mfma_f32_16x16x32_bf16 v[64:67], a[160:163], v[32:35], v[64:67]
    ds_read_b128 v[56:59], v13 offset:45056
    v_mfma_f32_16x16x32_bf16 v[68:71], a[164:167], v[32:35], v[68:71]
    v_mfma_f32_16x16x32_bf16 v[72:75], a[160:163], v[36:39], v[72:75]
    ds_read_b128 v[60:63], v13 offset:46080
    s_add_u32 m0, s34, 121088
    v_mfma_f32_16x16x32_bf16 v[76:79], a[164:167], v[36:39], v[76:79]
    buffer_load_dwordx4 v8, s[12:15], s35 offen offset:1792 lds
    s_waitcnt lgkmcnt(4)
    v_mfma_f32_16x16x32_bf16 v[64:67], a[168:171], v[40:43], v[64:67]
    ds_read_b128 v[32:35], v12 offset:49152
    v_mfma_f32_16x16x32_bf16 v[68:71], a[172:175], v[40:43], v[68:71]
    v_mfma_f32_16x16x32_bf16 v[72:75], a[168:171], v[44:47], v[72:75]
    ds_read_b128 v[36:39], v12 offset:50176
    v_mfma_f32_16x16x32_bf16 v[76:79], a[172:175], v[44:47], v[76:79]
    s_waitcnt lgkmcnt(4)
    v_mfma_f32_16x16x32_bf16 v[64:67], a[176:179], v[48:51], v[64:67]
    ds_read_b128 v[40:43], v13 offset:49152
    v_mfma_f32_16x16x32_bf16 v[68:71], a[180:183], v[48:51], v[68:71]
    v_mfma_f32_16x16x32_bf16 v[72:75], a[176:179], v[52:55], v[72:75]
    ds_read_b128 v[44:47], v13 offset:50176
    s_add_u32 m0, s34, 125056
    v_mfma_f32_16x16x32_bf16 v[76:79], a[180:183], v[52:55], v[76:79]
    buffer_load_dwordx4 v8, s[12:15], s35 offen offset:1920 lds
    s_add_u32 s35, s35, 65536
    s_min_u32 s35, s35, s52
    s_waitcnt lgkmcnt(4)
    v_mfma_f32_16x16x32_bf16 v[64:67], a[184:187], v[56:59], v[64:67]
    ds_read_b128 v[48:51], v12 offset:53248
    v_mfma_f32_16x16x32_bf16 v[68:71], a[188:191], v[56:59], v[68:71]
    v_mfma_f32_16x16x32_bf16 v[72:75], a[184:187], v[60:63], v[72:75]
    ds_read_b128 v[52:55], v12 offset:54272
    v_mfma_f32_16x16x32_bf16 v[76:79], a[188:191], v[60:63], v[76:79]
    s_waitcnt vmcnt(8)
    s_barrier
    s_waitcnt lgkmcnt(4)
    v_mfma_f32_16x16x32_bf16 v[64:67], a[192:195], v[32:35], v[64:67]
    ds_read_b128 v[56:59], v13 offset:53248
    v_mfma_f32_16x16x32_bf16 v[68:71], a[196:199], v[32:35], v[68:71]
    v_mfma_f32_16x16x32_bf16 v[72:75], a[192:195], v[36:39], v[72:75]
    ds_read_b128 v[60:63], v13 offset:54272
    s_add_u32 m0, s34, 0
    v_mfma_f32_16x16x32_bf16 v[76:79], a[196:199], v[36:39], v[76:79]
    buffer_load_dwordx4 v8, s[12:15], s35 offen offset:0 lds
    s_waitcnt lgkmcnt(4)
    v_mfma_f32_16x16x32_bf16 v[64:67], a[200:203], v[40:43], v[64:67]
    ds_read_b128 v[32:35], v12 offset:57344
    v_mfma_f32_16x16x32_bf16 v[68:71], a[204:207], v[40:43], v[68:71]
    buffer_store_dword v11, v10, s[4:7], 0 offen sc1
    v_add_u32 v11, 1, v11
    v_mfma_f32_16x16x32_bf16 v[72:75], a[200:203], v[44:47], v[72:75]
    ds_read_b128 v[36:39], v12 offset:58368
    v_mfma_f32_16x16x32_bf16 v[76:79], a[204:207], v[44:47], v[76:79]
    s_waitcnt lgkmcnt(4)
    v_mfma_f32_16x16x32_bf16 v[64:67], a[208:211], v[48:51], v[64:67]
    ds_read_b128 v[40:43], v13 offset:57344
    v_mfma_f32_16x16x32_bf16 v[68:71], a[212:215], v[48:51], v[68:71]
    v_mfma_f32_16x16x32_bf16 v[72:75], a[208:211], v[52:55], v[72:75]
    ds_read_b128 v[44:47], v13 offset:58368
    s_add_u32 m0, s34, 3968
    v_mfma_f32_16x16x32_bf16 v[76:79], a[212:215], v[52:55], v[76:79]
    buffer_load_dwordx4 v8, s[12:15], s35 offen offset:128 lds
    s_waitcnt lgkmcnt(4)
    v_mfma_f32_16x16x32_bf16 v[64:67], a[216:219], v[56:59], v[64:67]
    ds_read_b128 v[48:51], v12 offset:61440
    v_mfma_f32_16x16x32_bf16 v[68:71], a[220:223], v[56:59], v[68:71]
    v_mfma_f32_16x16x32_bf16 v[72:75], a[216:219], v[60:63], v[72:75]
    ds_read_b128 v[52:55], v12 offset:62464
    v_mfma_f32_16x16x32_bf16 v[76:79], a[220:223], v[60:63], v[76:79]
    s_waitcnt lgkmcnt(4)
    v_mfma_f32_16x16x32_bf16 v[64:67], a[224:227], v[32:35], v[64:67]
    ds_read_b128 v[56:59], v13 offset:61440
    v_mfma_f32_16x16x32_bf16 v[68:71], a[228:231], v[32:35], v[68:71]
    v_mfma_f32_16x16x32_bf16 v[72:75], a[224:227], v[36:39], v[72:75]
    ds_read_b128 v[60:63], v13 offset:62464
    s_add_u32 m0, s34, 7936
    v_mfma_f32_16x16x32_bf16 v[76:79], a[228:231], v[36:39], v[76:79]
    buffer_load_dwordx4 v8, s[12:15], s35 offen offset:256 lds
    s_waitcnt lgkmcnt(4)
    v_mfma_f32_16x16x32_bf16 v[64:67], a[232:235], v[40:43], v[64:67]
    ds_read_b128 v[32:35], v14 offset:0
    v_mfma_f32_16x16x32_bf16 v[68:71], a[236:239], v[40:43], v[68:71]
    v_mfma_f32_16x16x32_bf16 v[72:75], a[232:235], v[44:47], v[72:75]
    ds_read_b128 v[36:39], v14 offset:1024
    v_mfma_f32_16x16x32_bf16 v[76:79], a[236:239], v[44:47], v[76:79]
    s_waitcnt lgkmcnt(4)
    v_mfma_f32_16x16x32_bf16 v[64:67], a[240:243], v[48:51], v[64:67]
    ds_read_b128 v[40:43], v15 offset:0
    v_mfma_f32_16x16x32_bf16 v[68:71], a[244:247], v[48:51], v[68:71]
    v_mfma_f32_16x16x32_bf16 v[72:75], a[240:243], v[52:55], v[72:75]
    ds_read_b128 v[44:47], v15 offset:1024
    s_add_u32 m0, s34, 11904
    v_mfma_f32_16x16x32_bf16 v[76:79], a[244:247], v[52:55], v[76:79]
    buffer_load_dwordx4 v8, s[12:15], s35 offen offset:384 lds
    s_waitcnt lgkmcnt(4)
    v_mfma_f32_16x16x32_bf16 v[64:67], a[248:251], v[56:59], v[64:67]
    ds_read_b128 v[48:51], v14 offset:4096
    v_mfma_f32_16x16x32_bf16 v[68:71], a[252:255], v[56:59], v[68:71]
    v_mfma_f32_16x16x32_bf16 v[72:75], a[248:251], v[60:63], v[72:75]
    ds_read_b128 v[52:55], v14 offset:5120
    v_mfma_f32_16x16x32_bf16 v[76:79], a[252:255], v[60:63], v[76:79]
    s_waitcnt lgkmcnt(4)
    v_mfma_f32_16x16x32_bf16 v[80:83], a[0:3], v[32:35], 0
    ds_read_b128 v[56:59], v15 offset:4096
    v_mfma_f32_16x16x32_bf16 v[84:87], a[4:7], v[32:35], 0
    v_mfma_f32_16x16x32_bf16 v[88:91], a[0:3], v[36:39], 0
    ds_read_b128 v[60:63], v15 offset:5120
    s_add_u32 m0, s34, 15872
    v_mfma_f32_16x16x32_bf16 v[92:95], a[4:7], v[36:39], 0
    buffer_load_dwordx4 v8, s[12:15], s35 offen offset:512 lds
    s_waitcnt lgkmcnt(4)
    v_mfma_f32_16x16x32_bf16 v[80:83], a[8:11], v[40:43], v[80:83]
    ds_read_b128 v[32:35], v14 offset:8192
    v_mfma_f32_16x16x32_bf16 v[84:87], a[12:15], v[40:43], v[84:87]
    v_mfma_f32_16x16x32_bf16 v[88:91], a[8:11], v[44:47], v[88:91]
    ds_read_b128 v[36:39], v14 offset:9216
    v_mfma_f32_16x16x32_bf16 v[92:95], a[12:15], v[44:47], v[92:95]
    s_waitcnt lgkmcnt(4)
    v_mfma_f32_16x16x32_bf16 v[80:83], a[16:19], v[48:51], v[80:83]
    ds_read_b128 v[40:43], v15 offset:8192
    v_mfma_f32_16x16x32_bf16 v[84:87], a[20:23], v[48:51], v[84:87]
    v_cvt_pk_bf16_f32 v96, v64, v65
    v_mfma_f32_16x16x32_bf16 v[88:91], a[16:19], v[52:55], v[88:91]
    ds_read_b128 v[44:47], v15 offset:9216
    s_add_u32 m0, s34, 19840
    v_mfma_f32_16x16x32_bf16 v[92:95], a[20:23], v[52:55], v[92:95]
    buffer_load_dwordx4 v8, s[12:15], s35 offen offset:640 lds
    v_cvt_pk_bf16_f32 v97, v66, v67
    s_waitcnt lgkmcnt(4)
    v_mfma_f32_16x16x32_bf16 v[80:83], a[24:27], v[56:59], v[80:83]
    ds_read_b128 v[48:51], v14 offset:12288
    v_mfma_f32_16x16x32_bf16 v[84:87], a[28:31], v[56:59], v[84:87]
    v_cvt_pk_bf16_f32 v98, v68, v69
    v_mfma_f32_16x16x32_bf16 v[88:91], a[24:27], v[60:63], v[88:91]
    ds_read_b128 v[52:55], v14 offset:13312
    v_mfma_f32_16x16x32_bf16 v[92:95], a[28:31], v[60:63], v[92:95]
    v_cvt_pk_bf16_f32 v99, v70, v71
    s_waitcnt lgkmcnt(4)
    v_mfma_f32_16x16x32_bf16 v[80:83], a[32:35], v[32:35], v[80:83]
    ds_read_b128 v[56:59], v15 offset:12288
    v_mfma_f32_16x16x32_bf16 v[84:87], a[36:39], v[32:35], v[84:87]
    v_cvt_pk_bf16_f32 v100, v72, v73
    v_mfma_f32_16x16x32_bf16 v[88:91], a[32:35], v[36:39], v[88:91]
    ds_read_b128 v[60:63], v15 offset:13312
    s_add_u32 m0, s34, 23808
    v_mfma_f32_16x16x32_bf16 v[92:95], a[36:39], v[36:39], v[92:95]
    buffer_load_dwordx4 v8, s[12:15], s35 offen offset:768 lds
    v_cvt_pk_bf16_f32 v101, v74, v75
    s_waitcnt lgkmcnt(4)
    v_mfma_f32_16x16x32_bf16 v[80:83], a[40:43], v[40:43], v[80:83]
    ds_read_b128 v[32:35], v14 offset:16384
    v_mfma_f32_16x16x32_bf16 v[84:87], a[44:47], v[40:43], v[84:87]
    v_cvt_pk_bf16_f32 v102, v76, v77
    v_mfma_f32_16x16x32_bf16 v[88:91], a[40:43], v[44:47], v[88:91]
    ds_read_b128 v[36:39], v14 offset:17408
    v_mfma_f32_16x16x32_bf16 v[92:95], a[44:47], v[44:47], v[92:95]
    v_cvt_pk_bf16_f32 v103, v78, v79
    buffer_store_dwordx4 v[96:99], v9, s[4:7], s36 offen sc1
    s_waitcnt lgkmcnt(4)
    v_mfma_f32_16x16x32_bf16 v[80:83], a[48:51], v[48:51], v[80:83]
    ds_read_b128 v[40:43], v15 offset:16384
    v_mfma_f32_16x16x32_bf16 v[84:87], a[52:55], v[48:51], v[84:87]
    v_mfma_f32_16x16x32_bf16 v[88:91], a[48:51], v[52:55], v[88:91]
    ds_read_b128 v[44:47], v15 offset:17408
    s_add_u32 m0, s34, 27776
    v_mfma_f32_16x16x32_bf16 v[92:95], a[52:55], v[52:55], v[92:95]
    buffer_load_dwordx4 v8, s[12:15], s35 offen offset:896 lds
    s_waitcnt lgkmcnt(4)
    v_mfma_f32_16x16x32_bf16 v[80:83], a[56:59], v[56:59], v[80:83]
    ds_read_b128 v[48:51], v14 offset:20480
    v_mfma_f32_16x16x32_bf16 v[84:87], a[60:63], v[56:59], v[84:87]
    v_mfma_f32_16x16x32_bf16 v[88:91], a[56:59], v[60:63], v[88:91]
    ds_read_b128 v[52:55], v14 offset:21504
    v_mfma_f32_16x16x32_bf16 v[92:95], a[60:63], v[60:63], v[92:95]
    buffer_store_dwordx4 v[100:103], v9, s[4:7], s36 offen offset:128 sc1
    s_add_u32 s36, s36, s37
    s_waitcnt vmcnt(8)
    s_barrier
    s_waitcnt lgkmcnt(4)
    v_mfma_f32_16x16x32_bf16 v[80:83], a[64:67], v[32:35], v[80:83]
    ds_read_b128 v[56:59], v15 offset:20480
    v_mfma_f32_16x16x32_bf16 v[84:87], a[68:71], v[32:35], v[84:87]
    v_mfma_f32_16x16x32_bf16 v[88:91], a[64:67], v[36:39], v[88:91]
    ds_read_b128 v[60:63], v15 offset:21504
    s_add_u32 m0, s34, 31744
    v_mfma_f32_16x16x32_bf16 v[92:95], a[68:71], v[36:39], v[92:95]
    buffer_load_dwordx4 v8, s[12:15], s35 offen offset:1024 lds
    s_waitcnt lgkmcnt(4)
    v_mfma_f32_16x16x32_bf16 v[80:83], a[72:75], v[40:43], v[80:83]
    ds_read_b128 v[32:35], v14 offset:24576
    v_mfma_f32_16x16x32_bf16 v[84:87], a[76:79], v[40:43], v[84:87]
    v_mfma_f32_16x16x32_bf16 v[88:91], a[72:75], v[44:47], v[88:91]
    ds_read_b128 v[36:39], v14 offset:25600
    v_mfma_f32_16x16x32_bf16 v[92:95], a[76:79], v[44:47], v[92:95]
    s_waitcnt lgkmcnt(4)
    v_mfma_f32_16x16x32_bf16 v[80:83], a[80:83], v[48:51], v[80:83]
    ds_read_b128 v[40:43], v15 offset:24576
    v_mfma_f32_16x16x32_bf16 v[84:87], a[84:87], v[48:51], v[84:87]
    v_mfma_f32_16x16x32_bf16 v[88:91], a[80:83], v[52:55], v[88:91]
    ds_read_b128 v[44:47], v15 offset:25600
    s_add_u32 m0, s34, 35712
    v_mfma_f32_16x16x32_bf16 v[92:95], a[84:87], v[52:55], v[92:95]
    buffer_load_dwordx4 v8, s[12:15], s35 offen offset:1152 lds
    s_waitcnt lgkmcnt(4)
    v_mfma_f32_16x16x32_bf16 v[80:83], a[88:91], v[56:59], v[80:83]
    ds_read_b128 v[48:51], v14 offset:28672
    v_mfma_f32_16x16x32_bf16 v[84:87], a[92:95], v[56:59], v[84:87]
    v_mfma_f32_16x16x32_bf16 v[88:91], a[88:91], v[60:63], v[88:91]
    ds_read_b128 v[52:55], v14 offset:29696
    v_mfma_f32_16x16x32_bf16 v[92:95], a[92:95], v[60:63], v[92:95]
    s_waitcnt lgkmcnt(4)
    v_mfma_f32_16x16x32_bf16 v[80:83], a[96:99], v[32:35], v[80:83]
    ds_read_b128 v[56:59], v15 offset:28672
    v_mfma_f32_16x16x32_bf16 v[84:87], a[100:103], v[32:35], v[84:87]
    v_mfma_f32_16x16x32_bf16 v[88:91], a[96:99], v[36:39], v[88:91]
    ds_read_b128 v[60:63], v15 offset:29696
    s_add_u32 m0, s34, 39680
    v_mfma_f32_16x16x32_bf16 v[92:95], a[100:103], v[36:39], v[92:95]
    buffer_load_dwordx4 v8, s[12:15], s35 offen offset:1280 lds
    s_waitcnt lgkmcnt(4)
    v_mfma_f32_16x16x32_bf16 v[80:83], a[104:107], v[40:43], v[80:83]
    ds_read_b128 v[32:35], v14 offset:32768
    v_mfma_f32_16x16x32_bf16 v[84:87], a[108:111], v[40:43], v[84:87]
    v_mfma_f32_16x16x32_bf16 v[88:91], a[104:107], v[44:47], v[88:91]
    ds_read_b128 v[36:39], v14 offset:33792
    v_mfma_f32_16x16x32_bf16 v[92:95], a[108:111], v[44:47], v[92:95]
    s_waitcnt lgkmcnt(4)
    v_mfma_f32_16x16x32_bf16 v[80:83], a[112:115], v[48:51], v[80:83]
    ds_read_b128 v[40:43], v15 offset:32768
    v_mfma_f32_16x16x32_bf16 v[84:87], a[116:119], v[48:51], v[84:87]
    v_mfma_f32_16x16x32_bf16 v[88:91], a[112:115], v[52:55], v[88:91]
    ds_read_b128 v[44:47], v15 offset:33792
    s_add_u32 m0, s34, 43648
    v_mfma_f32_16x16x32_bf16 v[92:95], a[116:119], v[52:55], v[92:95]
    buffer_load_dwordx4 v8, s[12:15], s35 offen offset:1408 lds
    s_waitcnt lgkmcnt(4)
    v_mfma_f32_16x16x32_bf16 v[80:83], a[120:123], v[56:59], v[80:83]
    ds_read_b128 v[48:51], v14 offset:36864
    v_mfma_f32_16x16x32_bf16 v[84:87], a[124:127], v[56:59], v[84:87]
    v_mfma_f32_16x16x32_bf16 v[88:91], a[120:123], v[60:63], v[88:91]
    ds_read_b128 v[52:55], v14 offset:37888
    v_mfma_f32_16x16x32_bf16 v[92:95], a[124:127], v[60:63], v[92:95]
    s_waitcnt lgkmcnt(4)
    v_mfma_f32_16x16x32_bf16 v[80:83], a[128:131], v[32:35], v[80:83]
    ds_read_b128 v[56:59], v15 offset:36864
    v_mfma_f32_16x16x32_bf16 v[84:87], a[132:135], v[32:35], v[84:87]
    v_mfma_f32_16x16x32_bf16 v[88:91], a[128:131], v[36:39], v[88:91]
    ds_read_b128 v[60:63], v15 offset:37888
    s_add_u32 m0, s34, 47616
    v_mfma_f32_16x16x32_bf16 v[92:95], a[132:135], v[36:39], v[92:95]
    buffer_load_dwordx4 v8, s[12:15], s35 offen offset:1536 lds
    s_waitcnt lgkmcnt(4)
    v_mfma_f32_16x16x32_bf16 v[80:83], a[136:139], v[40:43], v[80:83]
    ds_read_b128 v[32:35], v14 offset:40960
    v_mfma_f32_16x16x32_bf16 v[84:87], a[140:143], v[40:43], v[84:87]
    v_mfma_f32_16x16x32_bf16 v[88:91], a[136:139], v[44:47], v[88:91]
    ds_read_b128 v[36:39], v14 offset:41984
    v_mfma_f32_16x16x32_bf16 v[92:95], a[140:143], v[44:47], v[92:95]
    s_waitcnt lgkmcnt(4)
    v_mfma_f32_16x16x32_bf16 v[80:83], a[144:147], v[48:51], v[80:83]
    ds_read_b128 v[40:43], v15 offset:40960
    v_mfma_f32_16x16x32_bf16 v[84:87], a[148:151], v[48:51], v[84:87]
    v_mfma_f32_16x16x32_bf16 v[88:91], a[144:147], v[52:55], v[88:91]
    ds_read_b128 v[44:47], v15 offset:41984
    s_add_u32 m0, s34, 51584
    v_mfma_f32_16x16x32_bf16 v[92:95], a[148:151], v[52:55], v[92:95]
    buffer_load_dwordx4 v8, s[12:15], s35 offen offset:1664 lds
    s_waitcnt lgkmcnt(4)
    v_mfma_f32_16x16x32_bf16 v[80:83], a[152:155], v[56:59], v[80:83]
    ds_read_b128 v[48:51], v14 offset:45056
    v_mfma_f32_16x16x32_bf16 v[84:87], a[156:159], v[56:59], v[84:87]
    v_mfma_f32_16x16x32_bf16 v[88:91], a[152:155], v[60:63], v[88:91]
    ds_read_b128 v[52:55], v14 offset:46080
    v_mfma_f32_16x16x32_bf16 v[92:95], a[156:159], v[60:63], v[92:95]
    s_waitcnt lgkmcnt(4)
    v_mfma_f32_16x16x32_bf16 v[80:83], a[160:163], v[32:35], v[80:83]
    ds_read_b128 v[56:59], v15 offset:45056
    v_mfma_f32_16x16x32_bf16 v[84:87], a[164:167], v[32:35], v[84:87]
    v_mfma_f32_16x16x32_bf16 v[88:91], a[160:163], v[36:39], v[88:91]
    ds_read_b128 v[60:63], v15 offset:46080
    s_add_u32 m0, s34, 55552
    v_mfma_f32_16x16x32_bf16 v[92:95], a[164:167], v[36:39], v[92:95]
    buffer_load_dwordx4 v8, s[12:15], s35 offen offset:1792 lds
    s_waitcnt lgkmcnt(4)
    v_mfma_f32_16x16x32_bf16 v[80:83], a[168:171], v[40:43], v[80:83]
    ds_read_b128 v[32:35], v14 offset:49152
    v_mfma_f32_16x16x32_bf16 v[84:87], a[172:175], v[40:43], v[84:87]
    v_mfma_f32_16x16x32_bf16 v[88:91], a[168:171], v[44:47], v[88:91]
    ds_read_b128 v[36:39], v14 offset:50176
    v_mfma_f32_16x16x32_bf16 v[92:95], a[172:175], v[44:47], v[92:95]
    s_waitcnt lgkmcnt(4)
    v_mfma_f32_16x16x32_bf16 v[80:83], a[176:179], v[48:51], v[80:83]
    ds_read_b128 v[40:43], v15 offset:49152
    v_mfma_f32_16x16x32_bf16 v[84:87], a[180:183], v[48:51], v[84:87]
    v_mfma_f32_16x16x32_bf16 v[88:91], a[176:179], v[52:55], v[88:91]
    ds_read_b128 v[44:47], v15 offset:50176
    s_add_u32 m0, s34, 59520
    v_mfma_f32_16x16x32_bf16 v[92:95], a[180:183], v[52:55], v[92:95]
    buffer_load_dwordx4 v8, s[12:15], s35 offen offset:1920 lds
    s_add_u32 s35, s35, 65536
    s_min_u32 s35, s35, s52
    s_waitcnt lgkmcnt(4)
    v_mfma_f32_16x16x32_bf16 v[80:83], a[184:187], v[56:59], v[80:83]
    ds_read_b128 v[48:51], v14 offset:53248
    v_mfma_f32_16x16x32_bf16 v[84:87], a[188:191], v[56:59], v[84:87]
    v_mfma_f32_16x16x32_bf16 v[88:91], a[184:187], v[60:63], v[88:91]
    ds_read_b128 v[52:55], v14 offset:54272
    v_mfma_f32_16x16x32_bf16 v[92:95], a[188:191], v[60:63], v[92:95]
    s_waitcnt vmcnt(8)
    s_barrier
    s_waitcnt lgkmcnt(4)
    v_mfma_f32_16x16x32_bf16 v[80:83], a[192:195], v[32:35], v[80:83]
    ds_read_b128 v[56:59], v15 offset:53248
    v_mfma_f32_16x16x32_bf16 v[84:87], a[196:199], v[32:35], v[84:87]
    v_mfma_f32_16x16x32_bf16 v[88:91], a[192:195], v[36:39], v[88:91]
    ds_read_b128 v[60:63], v15 offset:54272
    s_add_u32 m0, s34, 65536
    v_mfma_f32_16x16x32_bf16 v[92:95], a[196:199], v[36:39], v[92:95]
    buffer_load_dwordx4 v8, s[12:15], s35 offen offset:0 lds
    s_waitcnt lgkmcnt(4)
    v_mfma_f32_16x16x32_bf16 v[80:83], a[200:203], v[40:43], v[80:83]
    ds_read_b128 v[32:35], v14 offset:57344
    v_mfma_f32_16x16x32_bf16 v[84:87], a[204:207], v[40:43], v[84:87]
    buffer_store_dword v11, v10, s[4:7], 0 offen sc1
    v_add_u32 v11, 1, v11
    s_cmp_lg_u32 s30, s46
    s_cbranch_scc1 sl_ar_64
    s_mov_b64 exec, 1
    v_mov_b32 v4, 0
    v_mov_b32 v2, 1
    v_mov_b32 v3, s71
    global_atomic_add_x2 v4, v[2:3], s[92:93] offset:0 sc1
    s_mov_b64 exec, -1
sl_ar_64:
    v_mfma_f32_16x16x32_bf16 v[88:91], a[200:203], v[44:47], v[88:91]
    ds_read_b128 v[36:39], v14 offset:58368
    v_mfma_f32_16x16x32_bf16 v[92:95], a[204:207], v[44:47], v[92:95]
    s_waitcnt lgkmcnt(4)
    v_mfma_f32_16x16x32_bf16 v[80:83], a[208:211], v[48:51], v[80:83]
    ds_read_b128 v[40:43], v15 offset:57344
    v_mfma_f32_16x16x32_bf16 v[84:87], a[212:215], v[48:51], v[84:87]
    v_mfma_f32_16x16x32_bf16 v[88:91], a[208:211], v[52:55], v[88:91]
    ds_read_b128 v[44:47], v15 offset:58368
    s_add_u32 m0, s34, 69504
    v_mfma_f32_16x16x32_bf16 v[92:95], a[212:215], v[52:55], v[92:95]
    buffer_load_dwordx4 v8, s[12:15], s35 offen offset:128 lds
    s_waitcnt lgkmcnt(4)
    v_mfma_f32_16x16x32_bf16 v[80:83], a[216:219], v[56:59], v[80:83]
    ds_read_b128 v[48:51], v14 offset:61440
    v_mfma_f32_16x16x32_bf16 v[84:87], a[220:223], v[56:59], v[84:87]
    v_mfma_f32_16x16x32_bf16 v[88:91], a[216:219], v[60:63], v[88:91]
    ds_read_b128 v[52:55], v14 offset:62464
    v_mfma_f32_16x16x32_bf16 v[92:95], a[220:223], v[60:63], v[92:95]
    s_waitcnt lgkmcnt(4)
    v_mfma_f32_16x16x32_bf16 v[80:83], a[224:227], v[32:35], v[80:83]
    ds_read_b128 v[56:59], v15 offset:61440
    v_mfma_f32_16x16x32_bf16 v[84:87], a[228:231], v[32:35], v[84:87]
    v_mfma_f32_16x16x32_bf16 v[88:91], a[224:227], v[36:39], v[88:91]
    ds_read_b128 v[60:63], v15 offset:62464
    s_add_u32 m0, s34, 73472
    v_mfma_f32_16x16x32_bf16 v[92:95], a[228:231], v[36:39], v[92:95]
    buffer_load_dwordx4 v8, s[12:15], s35 offen offset:256 lds
    s_waitcnt lgkmcnt(4)
    v_mfma_f32_16x16x32_bf16 v[80:83], a[232:235], v[40:43], v[80:83]
    ds_read_b128 v[32:35], v12 offset:0
    v_mfma_f32_16x16x32_bf16 v[84:87], a[236:239], v[40:43], v[84:87]
    v_mfma_f32_16x16x32_bf16 v[88:91], a[232:235], v[44:47], v[88:91]
    ds_read_b128 v[36:39], v12 offset:1024
    v_mfma_f32_16x16x32_bf16 v[92:95], a[236:239], v[44:47], v[92:95]
    s_waitcnt lgkmcnt(4)
    v_mfma_f32_16x16x32_bf16 v[80:83], a[240:243], v[48:51], v[80:83]
    ds_read_b128 v[40:43], v13 offset:0
    v_mfma_f32_16x16x32_bf16 v[84:87], a[244:247], v[48:51], v[84:87]
    v_mfma_f32_16x16x32_bf16 v[88:91], a[240:243], v[52:55], v[88:91]
    ds_read_b128 v[44:47], v13 offset:1024
    s_add_u32 m0, s34, 77440
    v_mfma_f32_16x16x32_bf16 v[92:95], a[244:247], v[52:55], v[92:95]
    buffer_load_dwordx4 v8, s[12:15], s35 offen offset:384 lds
    s_waitcnt lgkmcnt(4)
    v_mfma_f32_16x16x32_bf16 v[80:83], a[248:251], v[56:59], v[80:83]
    ds_read_b128 v[48:51], v12 offset:4096
    v_mfma_f32_16x16x32_bf16 v[84:87], a[252:255], v[56:59], v[84:87]
    v_mfma_f32_16x16x32_bf16 v[88:91], a[248:251], v[60:63], v[88:91]
    ds_read_b128 v[52:55], v12 offset:5120
    v_mfma_f32_16x16x32_bf16 v[92:95], a[252:255], v[60:63], v[92:95]
    s_add_u32 s30, s30, 2
    s_cmp_lt_u32 s30, s51
    s_cbranch_scc1 sl_loop_63
    v_cvt_pk_bf16_f32 v96, v80, v81
    v_cvt_pk_bf16_f32 v97, v82, v83
    v_cvt_pk_bf16_f32 v98, v84, v85
    v_cvt_pk_bf16_f32 v99, v86, v87
    v_cvt_pk_bf16_f32 v100, v88, v89
    v_cvt_pk_bf16_f32 v101, v90, v91
    v_cvt_pk_bf16_f32 v102, v92, v93
    v_cvt_pk_bf16_f32 v103, v94, v95
    s_branch sl_e_62
sl_v_61:
sl_loop_65:
    s_waitcnt lgkmcnt(4)
    v_mfma_f32_16x16x32_bf16 v[64:67], v[32:35], a[0:3], 0
    ds_read_b128 v[56:59], v13 offset:4096
    v_mfma_f32_16x16x32_bf16 v[68:71], v[32:35], a[4:7], 0
    v_mfma_f32_16x16x32_bf16 v[72:75], v[36:39], a[0:3], 0
    ds_read_b128 v[60:63], v13 offset:5120
    s_add_u32 m0, s34, 81408
    v_mfma_f32_16x16x32_bf16 v[76:79], v[36:39], a[4:7], 0
    buffer_load_dwordx4 v8, s[12:15], s35 offen offset:512 lds
    s_waitcnt lgkmcnt(4)
    v_mfma_f32_16x16x32_bf16 v[64:67], v[40:43], a[8:11], v[64:67]
    ds_read_b128 v[32:35], v12 offset:8192
    v_mfma_f32_16x16x32_bf16 v[68:71], v[40:43], a[12:15], v[68:71]
    v_mfma_f32_16x16x32_bf16 v[72:75], v[44:47], a[8:11], v[72:75]
    ds_read_b128 v[36:39], v12 offset:9216
    v_mfma_f32_16x16x32_bf16 v[76:79], v[44:47], a[12:15], v[76:79]
    s_waitcnt lgkmcnt(4)
    v_mfma_f32_16x16x32_bf16 v[64:67], v[48:51], a[16:19], v[64:67]
    ds_read_b128 v[40:43], v13 offset:8192
    v_mfma_f32_16x16x32_bf16 v[68:71], v[48:51], a[20:23], v[68:71]
    v_cvt_pk_bf16_f32 v96, v80, v81
    v_mfma_f32_16x16x32_bf16 v[72:75], v[52:55], a[16:19], v[72:75]
    ds_read_b128 v[44:47], v13 offset:9216
    s_add_u32 m0, s34, 85376
    v_mfma_f32_16x16x32_bf16 v[76:79], v[52:55], a[20:23], v[76:79]
    buffer_load_dwordx4 v8, s[12:15], s35 offen offset:640 lds
    v_cvt_pk_bf16_f32 v97, v82, v83
    s_waitcnt lgkmcnt(4)
    v_mfma_f32_16x16x32_bf16 v[64:67], v[56:59], a[24:27], v[64:67]
    ds_read_b128 v[48:51], v12 offset:12288
    v_mfma_f32_16x16x32_bf16 v[68:71], v[56:59], a[28:31], v[68:71]
    v_cvt_pk_bf16_f32 v98, v88, v89
    v_mfma_f32_16x16x32_bf16 v[72:75], v[60:63], a[24:27], v[72:75]
    ds_read_b128 v[52:55], v12 offset:13312
    v_mfma_f32_16x16x32_bf16 v[76:79], v[60:63], a[28:31], v[76:79]
    v_cvt_pk_bf16_f32 v99, v90, v91
    s_waitcnt lgkmcnt(4)
    v_mfma_f32_16x16x32_bf16 v[64:67], v[32:35], a[32:35], v[64:67]
    ds_read_b128 v[56:59], v13 offset:12288
    v_mfma_f32_16x16x32_bf16 v[68:71], v[32:35], a[36:39], v[68:71]
    v_cvt_pk_bf16_f32 v100, v84, v85
    v_mfma_f32_16x16x32_bf16 v[72:75], v[36:39], a[32:35], v[72:75]
    ds_read_b128 v[60:63], v13 offset:13312
    s_add_u32 m0, s34, 89344
    v_mfma_f32_16x16x32_bf16 v[76:79], v[36:39], a[36:39], v[76:79]
    buffer_load_dwordx4 v8, s[12:15], s35 offen offset:768 lds
    v_cvt_pk_bf16_f32 v101, v86, v87
    s_waitcnt lgkmcnt(4)
    v_mfma_f32_16x16x32_bf16 v[64:67], v[40:43], a[40:43], v[64:67]
    ds_read_b128 v[32:35], v12 offset:16384
    v_mfma_f32_16x16x32_bf16 v[68:71], v[40:43], a[44:47], v[68:71]
    v_cvt_pk_bf16_f32 v102, v92, v93
    v_mfma_f32_16x16x32_bf16 v[72:75], v[44:47], a[40:43], v[72:75]
    ds_read_b128 v[36:39], v12 offset:17408
    v_mfma_f32_16x16x32_bf16 v[76:79], v[44:47], a[44:47], v[76:79]
    v_cvt_pk_bf16_f32 v103, v94, v95
    buffer_store_dwordx4 v[96:99], v9, s[4:7], s36 offen sc1
    s_waitcnt lgkmcnt(4)
    v_mfma_f32_16x16x32_bf16 v[64:67], v[48:51], a[48:51], v[64:67]
    ds_read_b128 v[40:43], v13 offset:16384
    v_mfma_f32_16x16x32_bf16 v[68:71], v[48:51], a[52:55], v[68:71]
    v_mfma_f32_16x16x32_bf16 v[72:75], v[52:55], a[48:51], v[72:75]
    ds_read_b128 v[44:47], v13 offset:17408
    s_add_u32 m0, s34, 93312
    v_mfma_f32_16x16x32_bf16 v[76:79], v[52:55], a[52:55], v[76:79]
    buffer_load_dwordx4 v8, s[12:15], s35 offen offset:896 lds
    s_waitcnt lgkmcnt(4)
    v_mfma_f32_16x16x32_bf16 v[64:67], v[56:59], a[56:59], v[64:67]
    ds_read_b128 v[48:51], v12 offset:20480
    v_mfma_f32_16x16x32_bf16 v[68:71], v[56:59], a[60:63], v[68:71]
    v_mfma_f32_16x16x32_bf16 v[72:75], v[60:63], a[56:59], v[72:75]
    ds_read_b128 v[52:55], v12 offset:21504
    v_mfma_f32_16x16x32_bf16 v[76:79], v[60:63], a[60:63], v[76:79]
    buffer_store_dwordx4 v[100:103], v9, s[4:7], s36 offen offset:128 sc1
    s_add_u32 s36, s36, s37
    s_waitcnt vmcnt(8)
    s_barrier
    s_waitcnt lgkmcnt(4)
    v_mfma_f32_16x16x32_bf16 v[64:67], v[32:35], a[64:67], v[64:67]
    ds_read_b128 v[56:59], v13 offset:20480
    v_mfma_f32_16x16x32_bf16 v[68:71], v[32:35], a[68:71], v[68:71]
    v_mfma_f32_16x16x32_bf16 v[72:75], v[36:39], a[64:67], v[72:75]
    ds_read_b128 v[60:63], v13 offset:21504
    s_add_u32 m0, s34, 97280
    v_mfma_f32_16x16x32_bf16 v[76:79], v[36:39], a[68:71], v[76:79]
    buffer_load_dwordx4 v8, s[12:15], s35 offen offset:1024 lds
    s_waitcnt lgkmcnt(4)
    v_mfma_f32_16x16x32_bf16 v[64:67], v[40:43], a[72:75], v[64:67]
    ds_read_b128 v[32:35], v12 offset:24576
    v_mfma_f32_16x16x32_bf16 v[68:71], v[40:43], a[76:79], v[68:71]
    v_mfma_f32_16x16x32_bf16 v[72:75], v[44:47], a[72:75], v[72:75]
    ds_read_b128 v[36:39], v12 offset:25600
    v_mfma_f32_16x16x32_bf16 v[76:79], v[44:47], a[76:79], v[76:79]
    s_waitcnt lgkmcnt(4)
    v_mfma_f32_16x16x32_bf16 v[64:67], v[48:51], a[80:83], v[64:67]
    ds_read_b128 v[40:43], v13 offset:24576
    v_mfma_f32_16x16x32_bf16 v[68:71], v[48:51], a[84:87], v[68:71]
    v_and_b32 v9, 0xffffff, v9
    v_mfma_f32_16x16x32_bf16 v[72:75], v[52:55], a[80:83], v[72:75]
    ds_read_b128 v[44:47], v13 offset:25600
    s_add_u32 m0, s34, 101248
    v_mfma_f32_16x16x32_bf16 v[76:79], v[52:55], a[84:87], v[76:79]
    buffer_load_dwordx4 v8, s[12:15], s35 offen offset:1152 lds
    s_waitcnt lgkmcnt(4)
    v_mfma_f32_16x16x32_bf16 v[64:67], v[56:59], a[88:91], v[64:67]
    ds_read_b128 v[48:51], v12 offset:28672
    v_mfma_f32_16x16x32_bf16 v[68:71], v[56:59], a[92:95], v[68:71]
    v_mfma_f32_16x16x32_bf16 v[72:75], v[60:63], a[88:91], v[72:75]
    ds_read_b128 v[52:55], v12 offset:29696
    v_mfma_f32_16x16x32_bf16 v[76:79], v[60:63], a[92:95], v[76:79]
    s_waitcnt lgkmcnt(4)
    v_mfma_f32_16x16x32_bf16 v[64:67], v[32:35], a[96:99], v[64:67]
    ds_read_b128 v[56:59], v13 offset:28672
    v_mfma_f32_16x16x32_bf16 v[68:71], v[32:35], a[100:103], v[68:71]
    v_mfma_f32_16x16x32_bf16 v[72:75], v[36:39], a[96:99], v[72:75]
    ds_read_b128 v[60:63], v13 offset:29696
    s_add_u32 m0, s34, 105216
    v_mfma_f32_16x16x32_bf16 v[76:79], v[36:39], a[100:103], v[76:79]
    buffer_load_dwordx4 v8, s[12:15], s35 offen offset:1280 lds
    s_waitcnt lgkmcnt(4)
    v_mfma_f32_16x16x32_bf16 v[64:67], v[40:43], a[104:107], v[64:67]
    ds_read_b128 v[32:35], v12 offset:32768
    v_mfma_f32_16x16x32_bf16 v[68:71], v[40:43], a[108:111], v[68:71]
    v_mfma_f32_16x16x32_bf16 v[72:75], v[44:47], a[104:107], v[72:75]
    ds_read_b128 v[36:39], v12 offset:33792
    v_mfma_f32_16x16x32_bf16 v[76:79], v[44:47], a[108:111], v[76:79]
    s_waitcnt lgkmcnt(4)
    v_mfma_f32_16x16x32_bf16 v[64:67], v[48:51], a[112:115], v[64:67]
    ds_read_b128 v[40:43], v13 offset:32768
    v_mfma_f32_16x16x32_bf16 v[68:71], v[48:51], a[116:119], v[68:71]
    v_mfma_f32_16x16x32_bf16 v[72:75], v[52:55], a[112:115], v[72:75]
    ds_read_b128 v[44:47], v13 offset:33792
    s_add_u32 m0, s34, 109184
    v_mfma_f32_16x16x32_bf16 v[76:79], v[52:55], a[116:119], v[76:79]
    buffer_load_dwordx4 v8, s[12:15], s35 offen offset:1408 lds
    s_waitcnt lgkmcnt(4)
    v_mfma_f32_16x16x32_bf16 v[64:67], v[56:59], a[120:123], v[64:67]
    ds_read_b128 v[48:51], v12 offset:36864
    v_mfma_f32_16x16x32_bf16 v[68:71], v[56:59], a[124:127], v[68:71]
    v_mfma_f32_16x16x32_bf16 v[72:75], v[60:63], a[120:123], v[72:75]
    ds_read_b128 v[52:55], v12 offset:37888
    v_mfma_f32_16x16x32_bf16 v[76:79], v[60:63], a[124:127], v[76:79]
    s_waitcnt lgkmcnt(4)
    v_mfma_f32_16x16x32_bf16 v[64:67], v[32:35], a[128:131], v[64:67]
    ds_read_b128 v[56:59], v13 offset:36864
    v_mfma_f32_16x16x32_bf16 v[68:71], v[32:35], a[132:135], v[68:71]
    v_mfma_f32_16x16x32_bf16 v[72:75], v[36:39], a[128:131], v[72:75]
    ds_read_b128 v[60:63], v13 offset:37888
    s_add_u32 m0, s34, 113152
    v_mfma_f32_16x16x32_bf16 v[76:79], v[36:39], a[132:135], v[76:79]
    buffer_load_dwordx4 v8, s[12:15], s35 offen offset:1536 lds
    s_waitcnt lgkmcnt(4)
    v_mfma_f32_16x16x32_bf16 v[64:67], v[40:43], a[136:139], v[64:67]
    ds_read_b128 v[32:35], v12 offset:40960
    v_mfma_f32_16x16x32_bf16 v[68:71], v[40:43], a[140:143], v[68:71]
    v_mfma_f32_16x16x32_bf16 v[72:75], v[44:47], a[136:139], v[72:75]
    ds_read_b128 v[36:39], v12 offset:41984
    v_mfma_f32_16x16x32_bf16 v[76:79], v[44:47], a[140:143], v[76:79]
    s_waitcnt lgkmcnt(4)
    v_mfma_f32_16x16x32_bf16 v[64:67], v[48:51], a[144:147], v[64:67]
    ds_read_b128 v[40:43], v13 offset:40960
    v_mfma_f32_16x16x32_bf16 v[68:71], v[48:51], a[148:151], v[68:71]
    v_mfma_f32_16x16x32_bf16 v[72:75], v[52:55], a[144:147], v[72:75]
    ds_read_b128 v[44:47], v13 offset:41984
    s_add_u32 m0, s34, 117120
    v_mfma_f32_16x16x32_bf16 v[76:79], v[52:55], a[148:151], v[76:79]
    buffer_load_dwordx4 v8, s[12:15], s35 offen offset:1664 lds
    s_waitcnt lgkmcnt(4)
    v_mfma_f32_16x16x32_bf16 v[64:67], v[56:59], a[152:155], v[64:67]
    ds_read_b128 v[48:51], v12 offset:45056
    v_mfma_f32_16x16x32_bf16 v[68:71], v[56:59], a[156:159], v[68:71]
    v_mfma_f32_16x16x32_bf16 v[72:75], v[60:63], a[152:155], v[72:75]
    ds_read_b128 v[52:55], v12 offset:46080
    v_mfma_f32_16x16x32_bf16 v[76:79], v[60:63], a[156:159], v[76:79]
    s_waitcnt lgkmcnt(4)
    v_mfma_f32_16x16x32_bf16 v[64:67], v[32:35], a[160:163], v[64:67]
    ds_read_b128 v[56:59], v13 offset:45056
    v_mfma_f32_16x16x32_bf16 v[68:71], v[32:35], a[164:167], v[68:71]
    v_mfma_f32_16x16x32_bf16 v[72:75], v[36:39], a[160:163], v[72:75]
    ds_read_b128 v[60:63], v13 offset:46080
    s_add_u32 m0, s34, 121088
    v_mfma_f32_16x16x32_bf16 v[76:79], v[36:39], a[164:167], v[76:79]
    buffer_load_dwordx4 v8, s[12:15], s35 offen offset:1792 lds
    s_waitcnt lgkmcnt(4)
    v_mfma_f32_16x16x32_bf16 v[64:67], v[40:43], a[168:171], v[64:67]
    ds_read_b128 v[32:35], v12 offset:49152
    v_mfma_f32_16x16x32_bf16 v[68:71], v[40:43], a[172:175], v[68:71]
    v_mfma_f32_16x16x32_bf16 v[72:75], v[44:47], a[168:171], v[72:75]
    ds_read_b128 v[36:39], v12 offset:50176
    v_mfma_f32_16x16x32_bf16 v[76:79], v[44:47], a[172:175], v[76:79]
    s_waitcnt lgkmcnt(4)
    v_mfma_f32_16x16x32_bf16 v[64:67], v[48:51], a[176:179], v[64:67]
    ds_read_b128 v[40:43], v13 offset:49152
    v_mfma_f32_16x16x32_bf16 v[68:71], v[48:51], a[180:183], v[68:71]
    v_mfma_f32_16x16x32_bf16 v[72:75], v[52:55], a[176:179], v[72:75]
    ds_read_b128 v[44:47], v13 offset:50176
    s_add_u32 m0, s34, 125056
    v_mfma_f32_16x16x32_bf16 v[76:79], v[52:55], a[180:183], v[76:79]
    buffer_load_dwordx4 v8, s[12:15], s35 offen offset:1920 lds
    s_add_u32 s35, s35, 65536
    s_min_u32 s35, s35, s52
    s_waitcnt lgkmcnt(4)
    v_mfma_f32_16x16x32_bf16 v[64:67], v[56:59], a[184:187], v[64:67]
    ds_read_b128 v[48:51], v12 offset:53248
    v_mfma_f32_16x16x32_bf16 v[68:71], v[56:59], a[188:191], v[68:71]
    v_mfma_f32_16x16x32_bf16 v[72:75], v[60:63], a[184:187], v[72:75]
    ds_read_b128 v[52:55], v12 offset:54272
    v_mfma_f32_16x16x32_bf16 v[76:79], v[60:63], a[188:191], v[76:79]
    s_waitcnt vmcnt(8)
    s_barrier
    s_waitcnt lgkmcnt(4)
    v_mfma_f32_16x16x32_bf16 v[64:67], v[32:35], a[192:195], v[64:67]
    ds_read_b128 v[56:59], v13 offset:53248
    v_mfma_f32_16x16x32_bf16 v[68:71], v[32:35], a[196:199], v[68:71]
    v_mfma_f32_16x16x32_bf16 v[72:75], v[36:39], a[192:195], v[72:75]
    ds_read_b128 v[60:63], v13 offset:54272
    s_add_u32 m0, s34, 0
    v_mfma_f32_16x16x32_bf16 v[76:79], v[36:39], a[196:199], v[76:79]
    buffer_load_dwordx4 v8, s[12:15], s35 offen offset:0 lds
    s_waitcnt lgkmcnt(4)
    v_mfma_f32_16x16x32_bf16 v[64:67], v[40:43], a[200:203], v[64:67]
    ds_read_b128 v[32:35], v12 offset:57344
    v_mfma_f32_16x16x32_bf16 v[68:71], v[40:43], a[204:207], v[68:71]
    buffer_store_dword v11, v10, s[4:7], 0 offen sc1
    v_add_u32 v11, 1, v11
    v_mfma_f32_16x16x32_bf16 v[72:75], v[44:47], a[200:203], v[72:75]
    ds_read_b128 v[36:39], v12 offset:58368
    v_mfma_f32_16x16x32_bf16 v[76:79], v[44:47], a[204:207], v[76:79]
    s_waitcnt lgkmcnt(4)
    v_mfma_f32_16x16x32_bf16 v[64:67], v[48:51], a[208:211], v[64:67]
    ds_read_b128 v[40:43], v13 offset:57344
    v_mfma_f32_16x16x32_bf16 v[68:71], v[48:51], a[212:215], v[68:71]
    v_mfma_f32_16x16x32_bf16 v[72:75], v[52:55], a[208:211], v[72:75]
    ds_read_b128 v[44:47], v13 offset:58368
    s_add_u32 m0, s34, 3968
    v_mfma_f32_16x16x32_bf16 v[76:79], v[52:55], a[212:215], v[76:79]
    buffer_load_dwordx4 v8, s[12:15], s35 offen offset:128 lds
    s_waitcnt lgkmcnt(4)
    v_mfma_f32_16x16x32_bf16 v[64:67], v[56:59], a[216:219], v[64:67]
    ds_read_b128 v[48:51], v12 offset:61440
    v_mfma_f32_16x16x32_bf16 v[68:71], v[56:59], a[220:223], v[68:71]
    v_mfma_f32_16x16x32_bf16 v[72:75], v[60:63], a[216:219], v[72:75]
    ds_read_b128 v[52:55], v12 offset:62464
    v_mfma_f32_16x16x32_bf16 v[76:79], v[60:63], a[220:223], v[76:79]
    s_waitcnt lgkmcnt(4)
    v_mfma_f32_16x16x32_bf16 v[64:67], v[32:35], a[224:227], v[64:67]
    ds_read_b128 v[56:59], v13 offset:61440
    v_mfma_f32_16x16x32_bf16 v[68:71], v[32:35], a[228:231], v[68:71]
    v_mfma_f32_16x16x32_bf16 v[72:75], v[36:39], a[224:227], v[72:75]
    ds_read_b128 v[60:63], v13 offset:62464
    s_add_u32 m0, s34, 7936
    v_mfma_f32_16x16x32_bf16 v[76:79], v[36:39], a[228:231], v[76:79]
    buffer_load_dwordx4 v8, s[12:15], s35 offen offset:256 lds
    s_waitcnt lgkmcnt(4)
    v_mfma_f32_16x16x32_bf16 v[64:67], v[40:43], a[232:235], v[64:67]
    ds_read_b128 v[32:35], v14 offset:0
    v_mfma_f32_16x16x32_bf16 v[68:71], v[40:43], a[236:239], v[68:71]
    v_mfma_f32_16x16x32_bf16 v[72:75], v[44:47], a[232:235], v[72:75]
    ds_read_b128 v[36:39], v14 offset:1024
    v_mfma_f32_16x16x32_bf16 v[76:79], v[44:47], a[236:239], v[76:79]
    s_waitcnt lgkmcnt(4)
    v_mfma_f32_16x16x32_bf16 v[64:67], v[48:51], a[240:243], v[64:67]
    ds_read_b128 v[40:43], v15 offset:0
    v_mfma_f32_16x16x32_bf16 v[68:71], v[48:51], a[244:247], v[68:71]
    v_mfma_f32_16x16x32_bf16 v[72:75], v[52:55], a[240:243], v[72:75]
    ds_read_b128 v[44:47], v15 offset:1024
    s_add_u32 m0, s34, 11904
    v_mfma_f32_16x16x32_bf16 v[76:79], v[52:55], a[244:247], v[76:79]
    buffer_load_dwordx4 v8, s[12:15], s35 offen offset:384 lds
    s_waitcnt lgkmcnt(4)
    v_mfma_f32_16x16x32_bf16 v[64:67], v[56:59], a[248:251], v[64:67]
    ds_read_b128 v[48:51], v14 offset:4096
    v_mfma_f32_16x16x32_bf16 v[68:71], v[56:59], a[252:255], v[68:71]
    v_mfma_f32_16x16x32_bf16 v[72:75], v[60:63], a[248:251], v[72:75]
    ds_read_b128 v[52:55], v14 offset:5120
    v_mfma_f32_16x16x32_bf16 v[76:79], v[60:63], a[252:255], v[76:79]
    s_waitcnt lgkmcnt(4)
    v_mfma_f32_16x16x32_bf16 v[80:83], v[32:35], a[0:3], 0
    ds_read_b128 v[56:59], v15 offset:4096
    v_mfma_f32_16x16x32_bf16 v[84:87], v[32:35], a[4:7], 0
    v_mfma_f32_16x16x32_bf16 v[88:91], v[36:39], a[0:3], 0
    ds_read_b128 v[60:63], v15 offset:5120
    s_add_u32 m0, s34, 15872
    v_mfma_f32_16x16x32_bf16 v[92:95], v[36:39], a[4:7], 0
    buffer_load_dwordx4 v8, s[12:15], s35 offen offset:512 lds
    s_waitcnt lgkmcnt(4)
    v_mfma_f32_16x16x32_bf16 v[80:83], v[40:43], a[8:11], v[80:83]
    ds_read_b128 v[32:35], v14 offset:8192
    v_mfma_f32_16x16x32_bf16 v[84:87], v[40:43], a[12:15], v[84:87]
    v_mfma_f32_16x16x32_bf16 v[88:91], v[44:47], a[8:11], v[88:91]
    ds_read_b128 v[36:39], v14 offset:9216
    v_mfma_f32_16x16x32_bf16 v[92:95], v[44:47], a[12:15], v[92:95]
    s_waitcnt lgkmcnt(4)
    v_mfma_f32_16x16x32_bf16 v[80:83], v[48:51], a[16:19], v[80:83]
    ds_read_b128 v[40:43], v15 offset:8192
    v_mfma_f32_16x16x32_bf16 v[84:87], v[48:51], a[20:23], v[84:87]
    v_cvt_pk_bf16_f32 v96, v64, v65
    v_mfma_f32_16x16x32_bf16 v[88:91], v[52:55], a[16:19], v[88:91]
    ds_read_b128 v[44:47], v15 offset:9216
    s_add_u32 m0, s34, 19840
    v_mfma_f32_16x16x32_bf16 v[92:95], v[52:55], a[20:23], v[92:95]
    buffer_load_dwordx4 v8, s[12:15], s35 offen offset:640 lds
    v_cvt_pk_bf16_f32 v97, v66, v67
    s_waitcnt lgkmcnt(4)
    v_mfma_f32_16x16x32_bf16 v[80:83], v[56:59], a[24:27], v[80:83]
    ds_read_b128 v[48:51], v14 offset:12288
    v_mfma_f32_16x16x32_bf16 v[84:87], v[56:59], a[28:31], v[84:87]
    v_cvt_pk_bf16_f32 v98, v72, v73
    v_mfma_f32_16x16x32_bf16 v[88:91], v[60:63], a[24:27], v[88:91]
    ds_read_b128 v[52:55], v14 offset:13312
    v_mfma_f32_16x16x32_bf16 v[92:95], v[60:63], a[28:31], v[92:95]
    v_cvt_pk_bf16_f32 v99, v74, v75
    s_waitcnt lgkmcnt(4)
    v_mfma_f32_16x16x32_bf16 v[80:83], v[32:35], a[32:35], v[80:83]
    ds_read_b128 v[56:59], v15 offset:12288
    v_mfma_f32_16x16x32_bf16 v[84:87], v[32:35], a[36:39], v[84:87]
    v_cvt_pk_bf16_f32 v100, v68, v69
    v_mfma_f32_16x16x32_bf16 v[88:91], v[36:39], a[32:35], v[88:91]
    ds_read_b128 v[60:63], v15 offset:13312
    s_add_u32 m0, s34, 23808
    v_mfma_f32_16x16x32_bf16 v[92:95], v[36:39], a[36:39], v[92:95]
    buffer_load_dwordx4 v8, s[12:15], s35 offen offset:768 lds
    v_cvt_pk_bf16_f32 v101, v70, v71
    s_waitcnt lgkmcnt(4)
    v_mfma_f32_16x16x32_bf16 v[80:83], v[40:43], a[40:43], v[80:83]
    ds_read_b128 v[32:35], v14 offset:16384
    v_mfma_f32_16x16x32_bf16 v[84:87], v[40:43], a[44:47], v[84:87]
    v_cvt_pk_bf16_f32 v102, v76, v77
    v_mfma_f32_16x16x32_bf16 v[88:91], v[44:47], a[40:43], v[88:91]
    ds_read_b128 v[36:39], v14 offset:17408
    v_mfma_f32_16x16x32_bf16 v[92:95], v[44:47], a[44:47], v[92:95]
    v_cvt_pk_bf16_f32 v103, v78, v79
    buffer_store_dwordx4 v[96:99], v9, s[4:7], s36 offen sc1
    s_waitcnt lgkmcnt(4)
    v_mfma_f32_16x16x32_bf16 v[80:83], v[48:51], a[48:51], v[80:83]
    ds_read_b128 v[40:43], v15 offset:16384
    v_mfma_f32_16x16x32_bf16 v[84:87], v[48:51], a[52:55], v[84:87]
    v_mfma_f32_16x16x32_bf16 v[88:91], v[52:55], a[48:51], v[88:91]
    ds_read_b128 v[44:47], v15 offset:17408
    s_add_u32 m0, s34, 27776
    v_mfma_f32_16x16x32_bf16 v[92:95], v[52:55], a[52:55], v[92:95]
    buffer_load_dwordx4 v8, s[12:15], s35 offen offset:896 lds
    s_waitcnt lgkmcnt(4)
    v_mfma_f32_16x16x32_bf16 v[80:83], v[56:59], a[56:59], v[80:83]
    ds_read_b128 v[48:51], v14 offset:20480
    v_mfma_f32_16x16x32_bf16 v[84:87], v[56:59], a[60:63], v[84:87]
    v_mfma_f32_16x16x32_bf16 v[88:91], v[60:63], a[56:59], v[88:91]
    ds_read_b128 v[52:55], v14 offset:21504
    v_mfma_f32_16x16x32_bf16 v[92:95], v[60:63], a[60:63], v[92:95]
    buffer_store_dwordx4 v[100:103], v9, s[4:7], s36 offen offset:128 sc1
    s_add_u32 s36, s36, s37
    s_waitcnt vmcnt(8)
    s_barrier
    s_waitcnt lgkmcnt(4)
    v_mfma_f32_16x16x32_bf16 v[80:83], v[32:35], a[64:67], v[80:83]
    ds_read_b128 v[56:59], v15 offset:20480
    v_mfma_f32_16x16x32_bf16 v[84:87], v[32:35], a[68:71], v[84:87]
    v_mfma_f32_16x16x32_bf16 v[88:91], v[36:39], a[64:67], v[88:91]
    ds_read_b128 v[60:63], v15 offset:21504
    s_add_u32 m0, s34, 31744
    v_mfma_f32_16x16x32_bf16 v[92:95], v[36:39], a[68:71], v[92:95]
    buffer_load_dwordx4 v8, s[12:15], s35 offen offset:1024 lds
    s_waitcnt lgkmcnt(4)
    v_mfma_f32_16x16x32_bf16 v[80:83], v[40:43], a[72:75], v[80:83]
    ds_read_b128 v[32:35], v14 offset:24576
    v_mfma_f32_16x16x32_bf16 v[84:87], v[40:43], a[76:79], v[84:87]
    v_mfma_f32_16x16x32_bf16 v[88:91], v[44:47], a[72:75], v[88:91]
    ds_read_b128 v[36:39], v14 offset:25600
    v_mfma_f32_16x16x32_bf16 v[92:95], v[44:47], a[76:79], v[92:95]
    s_waitcnt lgkmcnt(4)
    v_mfma_f32_16x16x32_bf16 v[80:83], v[48:51], a[80:83], v[80:83]
    ds_read_b128 v[40:43], v15 offset:24576
    v_mfma_f32_16x16x32_bf16 v[84:87], v[48:51], a[84:87], v[84:87]
    v_mfma_f32_16x16x32_bf16 v[88:91], v[52:55], a[80:83], v[88:91]
    ds_read_b128 v[44:47], v15 offset:25600
    s_add_u32 m0, s34, 35712
    v_mfma_f32_16x16x32_bf16 v[92:95], v[52:55], a[84:87], v[92:95]
    buffer_load_dwordx4 v8, s[12:15], s35 offen offset:1152 lds
    s_waitcnt lgkmcnt(4)
    v_mfma_f32_16x16x32_bf16 v[80:83], v[56:59], a[88:91], v[80:83]
    ds_read_b128 v[48:51], v14 offset:28672
    v_mfma_f32_16x16x32_bf16 v[84:87], v[56:59], a[92:95], v[84:87]
    v_mfma_f32_16x16x32_bf16 v[88:91], v[60:63], a[88:91], v[88:91]
    ds_read_b128 v[52:55], v14 offset:29696
    v_mfma_f32_16x16x32_bf16 v[92:95], v[60:63], a[92:95], v[92:95]
    s_waitcnt lgkmcnt(4)
    v_mfma_f32_16x16x32_bf16 v[80:83], v[32:35], a[96:99], v[80:83]
    ds_read_b128 v[56:59], v15 offset:28672
    v_mfma_f32_16x16x32_bf16 v[84:87], v[32:35], a[100:103], v[84:87]
    v_mfma_f32_16x16x32_bf16 v[88:91], v[36:39], a[96:99], v[88:91]
    ds_read_b128 v[60:63], v15 offset:29696
    s_add_u32 m0, s34, 39680
    v_mfma_f32_16x16x32_bf16 v[92:95], v[36:39], a[100:103], v[92:95]
    buffer_load_dwordx4 v8, s[12:15], s35 offen offset:1280 lds
    s_waitcnt lgkmcnt(4)
    v_mfma_f32_16x16x32_bf16 v[80:83], v[40:43], a[104:107], v[80:83]
    ds_read_b128 v[32:35], v14 offset:32768
    v_mfma_f32_16x16x32_bf16 v[84:87], v[40:43], a[108:111], v[84:87]
    v_mfma_f32_16x16x32_bf16 v[88:91], v[44:47], a[104:107], v[88:91]
    ds_read_b128 v[36:39], v14 offset:33792
    v_mfma_f32_16x16x32_bf16 v[92:95], v[44:47], a[108:111], v[92:95]
    s_waitcnt lgkmcnt(4)
    v_mfma_f32_16x16x32_bf16 v[80:83], v[48:51], a[112:115], v[80:83]
    ds_read_b128 v[40:43], v15 offset:32768
    v_mfma_f32_16x16x32_bf16 v[84:87], v[48:51], a[116:119], v[84:87]
    v_mfma_f32_16x16x32_bf16 v[88:91], v[52:55], a[112:115], v[88:91]
    ds_read_b128 v[44:47], v15 offset:33792
    s_add_u32 m0, s34, 43648
    v_mfma_f32_16x16x32_bf16 v[92:95], v[52:55], a[116:119], v[92:95]
    buffer_load_dwordx4 v8, s[12:15], s35 offen offset:1408 lds
    s_waitcnt lgkmcnt(4)
    v_mfma_f32_16x16x32_bf16 v[80:83], v[56:59], a[120:123], v[80:83]
    ds_read_b128 v[48:51], v14 offset:36864
    v_mfma_f32_16x16x32_bf16 v[84:87], v[56:59], a[124:127], v[84:87]
    v_mfma_f32_16x16x32_bf16 v[88:91], v[60:63], a[120:123], v[88:91]
    ds_read_b128 v[52:55], v14 offset:37888
    v_mfma_f32_16x16x32_bf16 v[92:95], v[60:63], a[124:127], v[92:95]
    s_waitcnt lgkmcnt(4)
    v_mfma_f32_16x16x32_bf16 v[80:83], v[32:35], a[128:131], v[80:83]
    ds_read_b128 v[56:59], v15 offset:36864
    v_mfma_f32_16x16x32_bf16 v[84:87], v[32:35], a[132:135], v[84:87]
    v_mfma_f32_16x16x32_bf16 v[88:91], v[36:39], a[128:131], v[88:91]
    ds_read_b128 v[60:63], v15 offset:37888
    s_add_u32 m0, s34, 47616
    v_mfma_f32_16x16x32_bf16 v[92:95], v[36:39], a[132:135], v[92:95]
    buffer_load_dwordx4 v8, s[12:15], s35 offen offset:1536 lds
    s_waitcnt lgkmcnt(4)
    v_mfma_f32_16x16x32_bf16 v[80:83], v[40:43], a[136:139], v[80:83]
    ds_read_b128 v[32:35], v14 offset:40960
    v_mfma_f32_16x16x32_bf16 v[84:87], v[40:43], a[140:143], v[84:87]
    v_mfma_f32_16x16x32_bf16 v[88:91], v[44:47], a[136:139], v[88:91]
    ds_read_b128 v[36:39], v14 offset:41984
    v_mfma_f32_16x16x32_bf16 v[92:95], v[44:47], a[140:143], v[92:95]
    s_waitcnt lgkmcnt(4)
    v_mfma_f32_16x16x32_bf16 v[80:83], v[48:51], a[144:147], v[80:83]
    ds_read_b128 v[40:43], v15 offset:40960
    v_mfma_f32_16x16x32_bf16 v[84:87], v[48:51], a[148:151], v[84:87]
    v_mfma_f32_16x16x32_bf16 v[88:91], v[52:55], a[144:147], v[88:91]
    ds_read_b128 v[44:47], v15 offset:41984
    s_add_u32 m0, s34, 51584
    v_mfma_f32_16x16x32_bf16 v[92:95], v[52:55], a[148:151], v[92:95]
    buffer_load_dwordx4 v8, s[12:15], s35 offen offset:1664 lds
    s_waitcnt lgkmcnt(4)
    v_mfma_f32_16x16x32_bf16 v[80:83], v[56:59], a[152:155], v[80:83]
    ds_read_b128 v[48:51], v14 offset:45056
    v_mfma_f32_16x16x32_bf16 v[84:87], v[56:59], a[156:159], v[84:87]
    v_mfma_f32_16x16x32_bf16 v[88:91], v[60:63], a[152:155], v[88:91]
    ds_read_b128 v[52:55], v14 offset:46080
    v_mfma_f32_16x16x32_bf16 v[92:95], v[60:63], a[156:159], v[92:95]
    s_waitcnt lgkmcnt(4)
    v_mfma_f32_16x16x32_bf16 v[80:83], v[32:35], a[160:163], v[80:83]
    ds_read_b128 v[56:59], v15 offset:45056
    v_mfma_f32_16x16x32_bf16 v[84:87], v[32:35], a[164:167], v[84:87]
    v_mfma_f32_16x16x32_bf16 v[88:91], v[36:39], a[160:163], v[88:91]
    ds_read_b128 v[60:63], v15 offset:46080
    s_add_u32 m0, s34, 55552
    v_mfma_f32_16x16x32_bf16 v[92:95], v[36:39], a[164:167], v[92:95]
    buffer_load_dwordx4 v8, s[12:15], s35 offen offset:1792 lds
    s_waitcnt lgkmcnt(4)
    v_mfma_f32_16x16x32_bf16 v[80:83], v[40:43], a[168:171], v[80:83]
    ds_read_b128 v[32:35], v14 offset:49152
    v_mfma_f32_16x16x32_bf16 v[84:87], v[40:43], a[172:175], v[84:87]
    v_mfma_f32_16x16x32_bf16 v[88:91], v[44:47], a[168:171], v[88:91]
    ds_read_b128 v[36:39], v14 offset:50176
    v_mfma_f32_16x16x32_bf16 v[92:95], v[44:47], a[172:175], v[92:95]
    s_waitcnt lgkmcnt(4)
    v_mfma_f32_16x16x32_bf16 v[80:83], v[48:51], a[176:179], v[80:83]
    ds_read_b128 v[40:43], v15 offset:49152
    v_mfma_f32_16x16x32_bf16 v[84:87], v[48:51], a[180:183], v[84:87]
    v_mfma_f32_16x16x32_bf16 v[88:91], v[52:55], a[176:179], v[88:91]
    ds_read_b128 v[44:47], v15 offset:50176
    s_add_u32 m0, s34, 59520
    v_mfma_f32_16x16x32_bf16 v[92:95], v[52:55], a[180:183], v[92:95]
    buffer_load_dwordx4 v8, s[12:15], s35 offen offset:1920 lds
    s_add_u32 s35, s35, 65536
    s_min_u32 s35, s35, s52
    s_waitcnt lgkmcnt(4)
    v_mfma_f32_16x16x32_bf16 v[80:83], v[56:59], a[184:187], v[80:83]
    ds_read_b128 v[48:51], v14 offset:53248
    v_mfma_f32_16x16x32_bf16 v[84:87], v[56:59], a[188:191], v[84:87]
    v_mfma_f32_16x16x32_bf16 v[88:91], v[60:63], a[184:187], v[88:91]
    ds_read_b128 v[52:55], v14 offset:54272
    v_mfma_f32_16x16x32_bf16 v[92:95], v[60:63], a[188:191], v[92:95]
    s_waitcnt vmcnt(8)
    s_barrier
    s_waitcnt lgkmcnt(4)
    v_mfma_f32_16x16x32_bf16 v[80:83], v[32:35], a[192:195], v[80:83]
    ds_read_b128 v[56:59], v15 offset:53248
    v_mfma_f32_16x16x32_bf16 v[84:87], v[32:35], a[196:199], v[84:87]
    v_mfma_f32_16x16x32_bf16 v[88:91], v[36:39], a[192:195], v[88:91]
    ds_read_b128 v[60:63], v15 offset:54272
    s_add_u32 m0, s34, 65536
    v_mfma_f32_16x16x32_bf16 v[92:95], v[36:39], a[196:199], v[92:95]
    buffer_load_dwordx4 v8, s[12:15], s35 offen offset:0 lds
    s_waitcnt lgkmcnt(4)
    v_mfma_f32_16x16x32_bf16 v[80:83], v[40:43], a[200:203], v[80:83]
    ds_read_b128 v[32:35], v14 offset:57344
    v_mfma_f32_16x16x32_bf16 v[84:87], v[40:43], a[204:207], v[84:87]
    buffer_store_dword v11, v10, s[4:7], 0 offen sc1
    v_add_u32 v11, 1, v11
    s_cmp_lg_u32 s30, s46
    s_cbranch_scc1 sl_ar_66
    s_mov_b64 exec, 1
    v_mov_b32 v4, 0
    v_mov_b32 v2, 1
    v_mov_b32 v3, s71
    global_atomic_add_x2 v4, v[2:3], s[92:93] offset:0 sc1
    s_mov_b64 exec, -1
sl_ar_66:
    v_mfma_f32_16x16x32_bf16 v[88:91], v[44:47], a[200:203], v[88:91]
    ds_read_b128 v[36:39], v14 offset:58368
    v_mfma_f32_16x16x32_bf16 v[92:95], v[44:47], a[204:207], v[92:95]
    s_waitcnt lgkmcnt(4)
    v_mfma_f32_16x16x32_bf16 v[80:83], v[48:51], a[208:211], v[80:83]
    ds_read_b128 v[40:43], v15 offset:57344
    v_mfma_f32_16x16x32_bf16 v[84:87], v[48:51], a[212:215], v[84:87]
    v_mfma_f32_16x16x32_bf16 v[88:91], v[52:55], a[208:211], v[88:91]
    ds_read_b128 v[44:47], v15 offset:58368
    s_add_u32 m0, s34, 69504
    v_mfma_f32_16x16x32_bf16 v[92:95], v[52:55], a[212:215], v[92:95]
    buffer_load_dwordx4 v8, s[12:15], s35 offen offset:128 lds
    s_waitcnt lgkmcnt(4)
    v_mfma_f32_16x16x32_bf16 v[80:83], v[56:59], a[216:219], v[80:83]
    ds_read_b128 v[48:51], v14 offset:61440
    v_mfma_f32_16x16x32_bf16 v[84:87], v[56:59], a[220:223], v[84:87]
    v_mfma_f32_16x16x32_bf16 v[88:91], v[60:63], a[216:219], v[88:91]
    ds_read_b128 v[52:55], v14 offset:62464
    v_mfma_f32_16x16x32_bf16 v[92:95], v[60:63], a[220:223], v[92:95]
    s_waitcnt lgkmcnt(4)
    v_mfma_f32_16x16x32_bf16 v[80:83], v[32:35], a[224:227], v[80:83]
    ds_read_b128 v[56:59], v15 offset:61440
    v_mfma_f32_16x16x32_bf16 v[84:87], v[32:35], a[228:231], v[84:87]
    v_mfma_f32_16x16x32_bf16 v[88:91], v[36:39], a[224:227], v[88:91]
    ds_read_b128 v[60:63], v15 offset:62464
    s_add_u32 m0, s34, 73472
    v_mfma_f32_16x16x32_bf16 v[92:95], v[36:39], a[228:231], v[92:95]
    buffer_load_dwordx4 v8, s[12:15], s35 offen offset:256 lds
    s_waitcnt lgkmcnt(4)
    v_mfma_f32_16x16x32_bf16 v[80:83], v[40:43], a[232:235], v[80:83]
    ds_read_b128 v[32:35], v12 offset:0
    v_mfma_f32_16x16x32_bf16 v[84:87], v[40:43], a[236:239], v[84:87]
    v_mfma_f32_16x16x32_bf16 v[88:91], v[44:47], a[232:235], v[88:91]
    ds_read_b128 v[36:39], v12 offset:1024
    v_mfma_f32_16x16x32_bf16 v[92:95], v[44:47], a[236:239], v[92:95]
    s_waitcnt lgkmcnt(4)
    v_mfma_f32_16x16x32_bf16 v[80:83], v[48:51], a[240:243], v[80:83]
    ds_read_b128 v[40:43], v13 offset:0
    v_mfma_f32_16x16x32_bf16 v[84:87], v[48:51], a[244:247], v[84:87]
    v_mfma_f32_16x16x32_bf16 v[88:91], v[52:55], a[240:243], v[88:91]
    ds_read_b128 v[44:47], v13 offset:1024
    s_add_u32 m0, s34, 77440
    v_mfma_f32_16x16x32_bf16 v[92:95], v[52:55], a[244:247], v[92:95]
    buffer_load_dwordx4 v8, s[12:15], s35 offen offset:384 lds
    s_waitcnt lgkmcnt(4)
    v_mfma_f32_16x16x32_bf16 v[80:83], v[56:59], a[248:251], v[80:83]
    ds_read_b128 v[48:51], v12 offset:4096
    v_mfma_f32_16x16x32_bf16 v[84:87], v[56:59], a[252:255], v[84:87]
    v_mfma_f32_16x16x32_bf16 v[88:91], v[60:63], a[248:251], v[88:91]
    ds_read_b128 v[52:55], v12 offset:5120
    v_mfma_f32_16x16x32_bf16 v[92:95], v[60:63], a[252:255], v[92:95]
    s_add_u32 s30, s30, 2
    s_cmp_lt_u32 s30, s51
    s_cbranch_scc1 sl_loop_65
    v_cvt_pk_bf16_f32 v96, v80, v81
    v_cvt_pk_bf16_f32 v97, v82, v83
    s_nop 0
    v_cvt_pk_bf16_f32 v98, v88, v89
    v_cvt_pk_bf16_f32 v99, v90, v91
    v_cvt_pk_bf16_f32 v100, v84, v85
    v_cvt_pk_bf16_f32 v101, v86, v87
    v_cvt_pk_bf16_f32 v102, v92, v93
    v_cvt_pk_bf16_f32 v103, v94, v95
    s_branch sl_e_62
sl_e_62:
    buffer_store_dwordx4 v[96:99], v9, s[4:7], s36 offen sc1
    buffer_store_dwordx4 v[100:103], v9, s[4:7], s36 offen offset:128 sc1
    s_add_u32 s36, s36, s37
    s_waitcnt vmcnt(0) lgkmcnt(0)
    s_barrier
    buffer_store_dword v11, v10, s[4:7], 0 offen sc1
    s_branch L_ph2
L_ph2:
    s_cmp_ge_u32 s28, 96
    s_cbranch_scc1 L_ob
L_att:
    s_mov_b32 s42, 0x3e0293ee
    s_mov_b32 s58, 0x3e8293ee
    s_and_b32 s44, s28, 7
    s_lshl_b32 s44, s44, 2
    s_add_u32 s44, s44, s29
    s_lshl_b32 s31, s44, 11
    v_add_u32 v6, s31, v5
    v_lshrrev_b32 v9, 5, v1
    v_lshlrev_b32 v9, 7, v9
    v_and_b32 v4, 7, v1
    v_lshl_add_u32 v9, v4, 4, v9
    v_add_u32 v9, s31, v9
    s_add_u32 s31, s31, 4194304
    v_and_b32 v10, 31, v1
    v_lshlrev_b32 v10, 4, v10
    v_lshrrev_b32 v4, 5, v1
    v_lshl_add_u32 v10, v4, 3, v10
    v_add_u32 v10, s31, v10
    s_lshl_b32 s31, s44, 13
    v_add_u32 v8, s31, v5
    v_mov_b32 v7, v8
    s_lshl_b32 s55, s44, 7
    s_add_u32 s55, s55, 115343360
    s_lshr_b32 s56, s44, 2
    s_lshl_b32 s56, s56, 7
    s_add_u32 s56, s56, 115347456
    s_lshl_b32 s57, s44, 7
    s_add_u32 s57, s57, 115351552
    s_lshl_b32 s31, s44, 7
    s_add_u32 s31, s31, 115343360
    v_mov_b32 v12, s31
    v_lshl_add_u32 v13, v1, 12, s31
    s_mov_b64 vcc, 1
    v_mov_b32 v4, 2130706432
    v_cndmask_b32 v12, v4, v12, vcc
    s_cmp_lt_u32 s28, 120
    s_cbranch_scc1 at_help_67
    s_mov_b32 s53, 0
    s_mov_b32 s54, 0
    s_mov_b32 s37, 1
    s_mov_b32 s38, 6
    s_mov_b32 s39, 32
    v_mov_b32 v2, 0
    s_mov_b32 s31, 16384
    buffer_store_dword v2, v12, s[4:7], s31 offen sc1
    s_mov_b32 s31, 32768
    buffer_store_dword v2, v13, s[4:7], s31 offen sc1
    s_mov_b64 exec, -1
    s_cmp_lt_u32 s28, 96
    s_cbranch_scc1 tw_skip_70
    s_load_dwordx2 s[72:73], s[0:1], 40
    s_and_b32 s31, s28, 31
    s_lshl_b32 s31, s31, 13
    s_lshl_b32 s33, s29, 21
    s_add_u32 s31, s31, s33
    v_lshl_add_u32 v2, v1, 7, s31
    s_waitcnt lgkmcnt(0)
    s_mov_b32 s8, s72
    s_and_b32 s9, s73, 0xffff
    s_mov_b32 s10, 8388608
    s_mov_b32 s11, 0x00020000
    s_mov_b32 s31, 0
    buffer_load_dword v128, v2, s[8:11], s31 offen
    s_mov_b32 s31, 262144
    buffer_load_dword v129, v2, s[8:11], s31 offen
    s_mov_b32 s31, 524288
    buffer_load_dword v130, v2, s[8:11], s31 offen
    s_mov_b32 s31, 786432
    buffer_load_dword v131, v2, s[8:11], s31 offen
    s_mov_b32 s31, 1048576
    buffer_load_dword v132, v2, s[8:11], s31 offen
    s_mov_b32 s31, 1310720
    buffer_load_dword v133, v2, s[8:11], s31 offen
    s_mov_b32 s31, 1572864
    buffer_load_dword v134, v2, s[8:11], s31 offen
    s_mov_b32 s31, 1835008
    buffer_load_dword v135, v2, s[8:11], s31 offen
tw_skip_70:
    s_and_b32 s59, s28, 31
    s_lshl_b32 s59, s59, 2
    s_add_u32 s59, s59, s29
    s_sub_u32 s31, 0, s90
    s_and_b32 s31, s31, 2097151
    s_and_b32 s60, s59, 7
    s_lshl_b32 s60, s60, 21
    s_lshr_b32 s33, s59, 3
    s_and_b32 s33, s33, 1
    s_lshl_b32 s33, s33, 13
    s_add_u32 s60, s60, s33
    s_lshr_b32 s33, s59, 4
    s_and_b32 s33, s33, 7
    s_lshl_b32 s33, s33, 8
    s_add_u32 s60, s60, s33
    s_add_u32 s60, s60, s31
    s_add_u32 s60, s60, 117686272
    s_lshr_b32 s32, s59, 3
    s_and_b32 s32, s32, 1
    s_lshl_b32 s32, s32, 14
    s_sub_u32 s61, s60, s32
    s_add_u32 s61, s61, 8192
    s_load_dword s68, s[90:91], s60 glc
    s_mov_b32 s62, -1
    s_load_dword s69, s[90:91], s61 glc
    s_mov_b32 s63, -1
    s_waitcnt lgkmcnt(0)
    s_memtime s[64:65]
    s_waitcnt lgkmcnt(0)
    s_load_dword s68, s[90:91], s60 glc
    s_waitcnt lgkmcnt(0)
    s_memtime s[66:67]
    s_waitcnt lgkmcnt(0)
    s_sub_u32 s31, s66, s64
    s_min_u32 s62, s62, s31
    s_waitcnt lgkmcnt(0)
    s_memtime s[64:65]
    s_waitcnt lgkmcnt(0)
    s_load_dword s68, s[90:91], s61 glc
    s_waitcnt lgkmcnt(0)
    s_memtime s[66:67]
    s_waitcnt lgkmcnt(0)
    s_sub_u32 s31, s66, s64
    s_min_u32 s63, s63, s31
    s_waitcnt lgkmcnt(0)
    s_memtime s[64:65]
    s_waitcnt lgkmcnt(0)
    s_load_dword s68, s[90:91], s60 glc
    s_waitcnt lgkmcnt(0)
    s_memtime s[66:67]
    s_waitcnt lgkmcnt(0)
    s_sub_u32 s31, s66, s64
    s_min_u32 s62, s62, s31
    s_waitcnt lgkmcnt(0)
    s_memtime s[64:65]
    s_waitcnt lgkmcnt(0)
    s_load_dword s68, s[90:91], s61 glc
    s_waitcnt lgkmcnt(0)
    s_memtime s[66:67]
    s_waitcnt lgkmcnt(0)
    s_sub_u32 s31, s66, s64
    s_min_u32 s63, s63, s31
    s_cmp_gt_u32 s63, s62
    s_cselect_b32 s31, 1, 0
    s_lshr_b32 s32, s59, 3
    s_xor_b32 s31, s31, s32
    s_xor_b32 s31, s31, s59
    s_and_b32 s31, s31, 1
    s_add_u32 s71, s71, s31
    s_waitcnt vmcnt(8)
    s_mov_b64 exec, 1
    v_mov_b32 v4, 0
    v_mov_b32 v2, 1
    v_mov_b32 v3, s71
    global_atomic_add_x2 v4, v[2:3], s[92:93] offset:0 sc1
    s_mov_b64 exec, -1
at_i_69:
    s_load_dwordx2 s[72:73], s[0:1], 0
    s_load_dwordx2 s[74:75], s[0:1], 56
    s_load_dwordx2 s[76:77], s[0:1], 72
    s_waitcnt lgkmcnt(0)
    s_mov_b32 s8, s72
    s_and_b32 s9, s73, 0xffff
    s_mov_b32 s10, 4194304
    s_mov_b32 s11, 0x00020000
    s_mov_b32 s12, s74
    s_and_b32 s13, s75, 0xffff
    s_mov_b32 s14, 4194304
    s_mov_b32 s15, 0x00020000
    s_mov_b32 s16, s76
    s_and_b32 s17, s77, 0xffff
    s_mov_b32 s18, 2097152
    s_mov_b32 s19, 0x00020000
    s_lshl_b32 s31, s44, 13
    v_lshl_add_u32 v11, v1, 7, s31
    buffer_load_dword v144, v11, s[8:11], 0 offen
    s_cmp_lt_u32 s28, 96
    s_cselect_b32 s33, 96, 96
    s_cmp_lg_u32 s29, 0
    s_cbranch_scc1 g_wdd_72
g_wd_71:
    s_load_dword s84, s[92:93], 128 glc
    s_add_u32 s41, s41, 1
    s_cmp_ge_u32 s41, 0x200000
    s_cbranch_scc1 g_wdd_72
    s_waitcnt lgkmcnt(0)
    s_cmp_ge_u32 s84, s33
    s_cbranch_scc1 g_wdd_72
    s_sleep 32
    s_branch g_wd_71
g_wdd_72:
    s_waitcnt lgkmcnt(0)
    s_barrier
    s_mov_b32 s31, 0
    buffer_load_dword v144, v11, s[8:11], s31 offen
    buffer_load_dword v145, v11, s[12:15], s31 offen
    s_waitcnt vmcnt(0)
    s_mov_b32 s31, 262144
    buffer_load_dword v146, v11, s[8:11], s31 offen
    buffer_load_dword v147, v11, s[12:15], s31 offen
    s_waitcnt vmcnt(0)
    s_mov_b32 s31, 524288
    buffer_load_dword v148, v11, s[8:11], s31 offen
    buffer_load_dword v149, v11, s[12:15], s31 offen
    s_waitcnt vmcnt(0)
    s_mov_b32 s31, 786432
    buffer_load_dword v150, v11, s[8:11], s31 offen
    buffer_load_dword v151, v11, s[12:15], s31 offen
    s_waitcnt vmcnt(0)
    s_mov_b32 s31, 1048576
    buffer_load_dword v152, v11, s[8:11], s31 offen
    buffer_load_dword v153, v11, s[12:15], s31 offen
    s_waitcnt vmcnt(0)
    s_mov_b32 s31, 1310720
    buffer_load_dword v154, v11, s[8:11], s31 offen
    buffer_load_dword v155, v11, s[12:15], s31 offen
    s_waitcnt vmcnt(0)
    s_mov_b32 s31, 1572864
    buffer_load_dword v156, v11, s[8:11], s31 offen
    buffer_load_dword v157, v11, s[12:15], s31 offen
    s_waitcnt vmcnt(0)
    s_mov_b32 s31, 1835008
    buffer_load_dword v158, v11, s[8:11], s31 offen
    buffer_load_dword v159, v11, s[12:15], s31 offen
    s_waitcnt vmcnt(0)
    s_mov_b32 s31, 2097152
    buffer_load_dword v160, v11, s[8:11], s31 offen
    buffer_load_dword v161, v11, s[12:15], s31 offen
    s_waitcnt vmcnt(0)
    s_mov_b32 s31, 2359296
    buffer_load_dword v162, v11, s[8:11], s31 offen
    buffer_load_dword v163, v11, s[12:15], s31 offen
    s_waitcnt vmcnt(0)
    s_mov_b32 s31, 2621440
    buffer_load_dword v164, v11, s[8:11], s31 offen
    buffer_load_dword v165, v11, s[12:15], s31 offen
    s_waitcnt vmcnt(0)
    s_mov_b32 s31, 2883584
    buffer_load_dword v166, v11, s[8:11], s31 offen
    buffer_load_dword v167, v11, s[12:15], s31 offen
    s_waitcnt vmcnt(0)
    s_mov_b32 s31, 3145728
    buffer_load_dword v168, v11, s[8:11], s31 offen
    buffer_load_dword v169, v11, s[12:15], s31 offen
    s_waitcnt vmcnt(0)
    s_mov_b32 s31, 3407872
    buffer_load_dword v170, v11, s[8:11], s31 offen
    buffer_load_dword v171, v11, s[12:15], s31 offen
    s_waitcnt vmcnt(0)
    s_mov_b32 s31, 3670016
    buffer_load_dword v172, v11, s[8:11], s31 offen
    buffer_load_dword v173, v11, s[12:15], s31 offen
    s_waitcnt vmcnt(0)
    s_mov_b32 s31, 3932160
    buffer_load_dword v174, v11, s[8:11], s31 offen
    buffer_load_dword v175, v11, s[12:15], s31 offen
    s_waitcnt vmcnt(0)
    s_waitcnt vmcnt(0)
    s_mov_b32 s31, 0
    buffer_load_dword v176, v11, s[16:19], s31 offen
    s_mov_b32 s31, 262144
    buffer_load_dword v177, v11, s[16:19], s31 offen
    s_waitcnt vmcnt(0)
    s_mov_b32 s31, 524288
    buffer_load_dword v178, v11, s[16:19], s31 offen
    s_mov_b32 s31, 786432
    buffer_load_dword v179, v11, s[16:19], s31 offen
    s_waitcnt vmcnt(0)
    s_mov_b32 s31, 1048576
    buffer_load_dword v180, v11, s[16:19], s31 offen
    s_mov_b32 s31, 1310720
    buffer_load_dword v181, v11, s[16:19], s31 offen
    s_waitcnt vmcnt(0)
    s_mov_b32 s31, 1572864
    buffer_load_dword v182, v11, s[16:19], s31 offen
    s_mov_b32 s31, 1835008
    buffer_load_dword v183, v11, s[16:19], s31 offen
    s_branch at_com_68
at_help_67:
    s_lshr_b32 s53, s28, 3
    s_add_u32 s53, s53, 6
    s_mov_b32 s54, 64
    s_mov_b32 s37, 12
    s_mov_b32 s38, 30
    s_lshr_b32 s39, s28, 3
    s_and_b32 s39, s39, 1
    s_add_u32 s39, s39, 30
    s_cmp_lt_u32 s28, 80
    s_cselect_b32 s39, 64, s39
at_com_68:
    v_and_b32 v11, 31, v1
    v_lshrrev_b32 v3, 5, v1
    v_lshlrev_b32 v3, 2, v3
    v_sub_u32 v11, v11, v3
    v_mov_b32 v14, 0xf149f2ca
    v_add_u32 v3, 0, v11
    v_and_b32 v3, 0xfffffff1, v3
    v_cmp_ne_u32 vcc, 0, v3
    s_nop 1
    v_cndmask_b32 v64, 0, v14, vcc
    v_add_u32 v3, -1, v11
    v_and_b32 v3, 0xfffffff1, v3
    v_cmp_ne_u32 vcc, 0, v3
    s_nop 1
    v_cndmask_b32 v65, 0, v14, vcc
    v_add_u32 v3, -2, v11
    v_and_b32 v3, 0xfffffff1, v3
    v_cmp_ne_u32 vcc, 0, v3
    s_nop 1
    v_cndmask_b32 v66, 0, v14, vcc
    v_add_u32 v3, -3, v11
    v_and_b32 v3, 0xfffffff1, v3
    v_cmp_ne_u32 vcc, 0, v3
    s_nop 1
    v_cndmask_b32 v67, 0, v14, vcc
    v_add_u32 v3, -8, v11
    v_and_b32 v3, 0xfffffff1, v3
    v_cmp_ne_u32 vcc, 0, v3
    s_nop 1
    v_cndmask_b32 v68, 0, v14, vcc
    v_add_u32 v3, -9, v11
    v_and_b32 v3, 0xfffffff1, v3
    v_cmp_ne_u32 vcc, 0, v3
    s_nop 1
    v_cndmask_b32 v69, 0, v14, vcc
    v_add_u32 v3, -10, v11
    v_and_b32 v3, 0xfffffff1, v3
    v_cmp_ne_u32 vcc, 0, v3
    s_nop 1
    v_cndmask_b32 v70, 0, v14, vcc
    v_add_u32 v3, -11, v11
    v_and_b32 v3, 0xfffffff1, v3
    v_cmp_ne_u32 vcc, 0, v3
    s_nop 1
    v_cndmask_b32 v71, 0, v14, vcc
    v_add_u32 v3, -16, v11
    v_and_b32 v3, 0xfffffff1, v3
    v_cmp_ne_u32 vcc, 0, v3
    s_nop 1
    v_cndmask_b32 v72, 0, v14, vcc
    v_add_u32 v3, -17, v11
    v_and_b32 v3, 0xfffffff1, v3
    v_cmp_ne_u32 vcc, 0, v3
    s_nop 1
    v_cndmask_b32 v73, 0, v14, vcc
    v_add_u32 v3, -18, v11
    v_and_b32 v3, 0xfffffff1, v3
    v_cmp_ne_u32 vcc, 0, v3
    s_nop 1
    v_cndmask_b32 v74, 0, v14, vcc
    v_add_u32 v3, -19, v11
    v_and_b32 v3, 0xfffffff1, v3
    v_cmp_ne_u32 vcc, 0, v3
    s_nop 1
    v_cndmask_b32 v75, 0, v14, vcc
    v_add_u32 v3, -24, v11
    v_and_b32 v3, 0xfffffff1, v3
    v_cmp_ne_u32 vcc, 0, v3
    s_nop 1
    v_cndmask_b32 v76, 0, v14, vcc
    v_add_u32 v3, -25, v11
    v_and_b32 v3, 0xfffffff1, v3
    v_cmp_ne_u32 vcc, 0, v3
    s_nop 1
    v_cndmask_b32 v77, 0, v14, vcc
    v_add_u32 v3, -26, v11
    v_and_b32 v3, 0xfffffff1, v3
    v_cmp_ne_u32 vcc, 0, v3
    s_nop 1
    v_cndmask_b32 v78, 0, v14, vcc
    v_add_u32 v3, -27, v11
    v_and_b32 v3, 0xfffffff1, v3
    v_cmp_ne_u32 vcc, 0, v3
    s_nop 1
    v_cndmask_b32 v79, 0, v14, vcc
    v_cmp_gt_i32 vcc, 0, v11
    s_nop 1
    v_cndmask_b32 v96, 0, v14, vcc
    v_cmp_gt_i32 vcc, 1, v11
    s_nop 1
    v_cndmask_b32 v97, 0, v14, vcc
    v_cmp_gt_i32 vcc, 2, v11
    s_nop 1
    v_cndmask_b32 v98, 0, v14, vcc
    v_cmp_gt_i32 vcc, 3, v11
    s_nop 1
    v_cndmask_b32 v99, 0, v14, vcc
    v_cmp_gt_i32 vcc, 8, v11
    s_nop 1
    v_cndmask_b32 v100, 0, v14, vcc
    v_cmp_gt_i32 vcc, 9, v11
    s_nop 1
    v_cndmask_b32 v101, 0, v14, vcc
    v_cmp_gt_i32 vcc, 10, v11
    s_nop 1
    v_cndmask_b32 v102, 0, v14, vcc
    v_cmp_gt_i32 vcc, 11, v11
    s_nop 1
    v_cndmask_b32 v103, 0, v14, vcc
    v_cmp_gt_i32 vcc, 16, v11
    s_nop 1
    v_cndmask_b32 v104, 0, v14, vcc
    v_cmp_gt_i32 vcc, 17, v11
    s_nop 1
    v_cndmask_b32 v105, 0, v14, vcc
    v_cmp_gt_i32 vcc, 18, v11
    s_nop 1
    v_cndmask_b32 v106, 0, v14, vcc
    v_cmp_gt_i32 vcc, 19, v11
    s_nop 1
    v_cndmask_b32 v107, 0, v14, vcc
    v_cmp_gt_i32 vcc, 24, v11
    s_nop 1
    v_cndmask_b32 v108, 0, v14, vcc
    v_cmp_gt_i32 vcc, 25, v11
    s_nop 1
    v_cndmask_b32 v109, 0, v14, vcc
    v_cmp_gt_i32 vcc, 26, v11
    s_nop 1
    v_cndmask_b32 v110, 0, v14, vcc
    v_cmp_gt_i32 vcc, 27, v11
    s_nop 1
    v_cndmask_b32 v111, 0, v14, vcc
    v_mov_b32 v80, 0xf149f2ca
    v_mov_b32 v81, 0xf149f2ca
    v_mov_b32 v82, 0xf149f2ca
    v_mov_b32 v83, 0xf149f2ca
    v_mov_b32 v84, 0xf149f2ca
    v_mov_b32 v85, 0xf149f2ca
    v_mov_b32 v86, 0xf149f2ca
    v_mov_b32 v87, 0xf149f2ca
    v_mov_b32 v88, 0xf149f2ca
    v_mov_b32 v89, 0xf149f2ca
    v_mov_b32 v90, 0xf149f2ca
    v_mov_b32 v91, 0xf149f2ca
    v_mov_b32 v92, 0xf149f2ca
    v_mov_b32 v93, 0xf149f2ca
    v_mov_b32 v94, 0xf149f2ca
    v_mov_b32 v95, 0xf149f2ca
    v_accvgpr_write_b32 a184, 0
    v_accvgpr_write_b32 a185, 0
    v_accvgpr_write_b32 a186, 0
    v_accvgpr_write_b32 a187, 0
    v_accvgpr_write_b32 a188, 0
    v_accvgpr_write_b32 a189, 0
    v_accvgpr_write_b32 a190, 0
    v_accvgpr_write_b32 a191, 0
    v_accvgpr_write_b32 a192, 0
    v_accvgpr_write_b32 a193, 0
    v_accvgpr_write_b32 a194, 0
    v_accvgpr_write_b32 a195, 0
    v_accvgpr_write_b32 a128, 0
    v_accvgpr_write_b32 a129, 0
    v_accvgpr_write_b32 a130, 0
    v_accvgpr_write_b32 a131, 0
    v_accvgpr_write_b32 a132, 0
    v_accvgpr_write_b32 a133, 0
    v_accvgpr_write_b32 a134, 0
    v_accvgpr_write_b32 a135, 0
    v_accvgpr_write_b32 a136, 0
    v_accvgpr_write_b32 a137, 0
    v_accvgpr_write_b32 a138, 0
    v_accvgpr_write_b32 a139, 0
    v_accvgpr_write_b32 a140, 0
    v_accvgpr_write_b32 a141, 0
    v_accvgpr_write_b32 a142, 0
    v_accvgpr_write_b32 a143, 0
    v_mov_b32 v40, 0
    v_mov_b32 v41, 0
    v_mov_b32 v42, 0
    v_mov_b32 v43, 0
    s_cmp_lg_u32 s29, 0
    s_cbranch_scc1 g_wdd_74
g_wd_73:
    s_load_dword s72, s[92:93], 0 glc
    s_add_u32 s41, s41, 1
    s_cmp_ge_u32 s41, 0x200000
    s_cbranch_scc1 g_wdd_74
    s_waitcnt lgkmcnt(0)
    s_cmp_ge_u32 s72, 352
    s_cbranch_scc1 g_wdd_74
    s_sleep 32
    s_branch g_wd_73
g_wdd_74:
    s_waitcnt lgkmcnt(0)
    s_barrier
    s_add_u32 s49, s53, s37
    s_cmp_lt_u32 s49, s38
    s_cbranch_scc1 at_nx_82
    s_max_u32 s49, s49, s39
    s_cmp_eq_u32 s38, 255
    s_cselect_b32 s49, s49, s39
    s_mov_b32 s37, 3
    s_mov_b32 s38, 255
at_nx_82:
g_wf_83:
    s_load_dwordx4 s[72:75], s[90:91], s56 glc
    s_add_u32 s41, s41, 1
    s_cmp_ge_u32 s41, 0x200000
    s_cbranch_scc1 g_wfd_84
    s_waitcnt lgkmcnt(0)
    s_min_u32 s76, s72, s73
    s_min_u32 s76, s76, s74
    s_cmp_ge_u32 s76, 1
    s_cbranch_scc1 g_wfd_84
    s_sleep 4
    s_branch g_wf_83
g_wfd_84:
    s_waitcnt lgkmcnt(0)
    s_mov_b32 s35, 0
    s_add_u32 s31, s35, 50331648
    buffer_load_dwordx4 a[160:163], v6, s[4:7], s31 offen offset:0 sc1
    buffer_load_dwordx4 a[164:167], v6, s[4:7], s31 offen offset:1024 sc1
    s_add_u32 s31, s35, 54525952
    buffer_load_dwordx4 a[168:171], v6, s[4:7], s31 offen offset:0 sc1
    buffer_load_dwordx4 a[172:175], v6, s[4:7], s31 offen offset:1024 sc1
    s_add_u32 s31, s35, 58720256
    buffer_load_dwordx4 a[176:179], v6, s[4:7], s31 offen offset:0 sc1
    buffer_load_dwordx4 a[180:183], v6, s[4:7], s31 offen offset:1024 sc1
    s_add_u32 s32, s53, 1
g_wf_85:
    s_load_dwordx4 s[72:75], s[90:91], s55 glc
    s_add_u32 s41, s41, 1
    s_cmp_ge_u32 s41, 0x200000
    s_cbranch_scc1 g_wfd_86
    s_waitcnt lgkmcnt(0)
    s_min_u32 s76, s72, s73
    s_min_u32 s76, s76, s74
    s_cmp_ge_u32 s76, s32
    s_cbranch_scc1 g_wfd_86
    s_sleep 4
    s_branch g_wf_85
g_wfd_86:
    s_waitcnt lgkmcnt(0)
    s_lshl_b32 s36, s53, 18
    s_add_u32 s31, s36, 0
    buffer_load_dwordx4 a[0:3], v7, s[4:7], s31 offen offset:0 sc1
    buffer_load_dwordx4 a[4:7], v7, s[4:7], s31 offen offset:1024 sc1
    buffer_load_dwordx4 a[8:11], v7, s[4:7], s31 offen offset:2048 sc1
    buffer_load_dwordx4 a[12:15], v7, s[4:7], s31 offen offset:3072 sc1
    s_add_u32 s31, s36, 4096
    buffer_load_dwordx4 a[16:19], v7, s[4:7], s31 offen offset:0 sc1
    buffer_load_dwordx4 a[20:23], v7, s[4:7], s31 offen offset:1024 sc1
    buffer_load_dwordx4 a[24:27], v7, s[4:7], s31 offen offset:2048 sc1
    buffer_load_dwordx4 a[28:31], v7, s[4:7], s31 offen offset:3072 sc1
    s_add_u32 s31, s36, 16777216
    buffer_load_dwordx4 a[32:35], v7, s[4:7], s31 offen offset:0 sc1
    buffer_load_dwordx4 a[36:39], v7, s[4:7], s31 offen offset:1024 sc1
    buffer_load_dwordx4 a[40:43], v7, s[4:7], s31 offen offset:2048 sc1
    buffer_load_dwordx4 a[44:47], v7, s[4:7], s31 offen offset:3072 sc1
    s_add_u32 s31, s36, 16781312
    buffer_load_dwordx4 a[48:51], v7, s[4:7], s31 offen offset:0 sc1
    buffer_load_dwordx4 a[52:55], v7, s[4:7], s31 offen offset:1024 sc1
    buffer_load_dwordx4 a[56:59], v7, s[4:7], s31 offen offset:2048 sc1
    buffer_load_dwordx4 a[60:63], v7, s[4:7], s31 offen offset:3072 sc1
    s_add_u32 s31, s36, 33554432
    buffer_load_dwordx4 a[96:99], v7, s[4:7], s31 offen offset:0 sc1
    buffer_load_dwordx4 a[100:103], v7, s[4:7], s31 offen offset:1024 sc1
    buffer_load_dwordx4 a[104:107], v7, s[4:7], s31 offen offset:2048 sc1
    buffer_load_dwordx4 a[108:111], v7, s[4:7], s31 offen offset:3072 sc1
    s_add_u32 s31, s36, 33558528
    buffer_load_dwordx4 a[112:115], v7, s[4:7], s31 offen offset:0 sc1
    buffer_load_dwordx4 a[116:119], v7, s[4:7], s31 offen offset:1024 sc1
    buffer_load_dwordx4 a[120:123], v7, s[4:7], s31 offen offset:2048 sc1
    buffer_load_dwordx4 a[124:127], v7, s[4:7], s31 offen offset:3072 sc1
    s_mov_b32 s43, 20480
    s_mov_b32 s45, 0
    s_mov_b32 s51, 0
    s_waitcnt vmcnt(0)
at_poll_80:
    s_load_dwordx16 s[8:23], s[90:91], s57 glc
    s_load_dwordx4 s[76:79], s[90:91], s55 glc
    s_load_dwordx4 s[80:83], s[90:91], s56 glc
at_top_75:
    s_waitcnt lgkmcnt(0)
    s_min_u32 s72, s8, s12
    s_min_u32 s72, s72, s16
    s_min_u32 s72, s72, s20
    s_min_u32 s76, s76, s77
    s_min_u32 s76, s76, s78
    s_min_u32 s80, s80, s81
    s_min_u32 s80, s80, s82
    s_min_u32 s77, s49, 63
    s_cmp_gt_u32 s76, s77
    s_cselect_b32 s72, s72, 0
    s_min_u32 s72, s72, 64
    s_sub_u32 s81, s80, 1
    s_cmp_ge_u32 s80, 64
    s_cselect_b32 s80, 64, s81
    s_cmp_lt_u32 s54, s80
    s_cbranch_scc1 at_b_77
    s_cmp_lt_u32 s53, s72
    s_cbranch_scc1 at_a_76
    s_cmp_eq_u32 s43, 20480
    s_cbranch_scc1 at_nf_81
    s_waitcnt vmcnt(0)
    v_mov_b32 v2, s45
    buffer_store_dword v2, v12, s[4:7], s43 offen sc1
    s_mov_b32 s43, 20480
at_nf_81:
    s_cmp_ge_u32 s53, 64
    s_cselect_b32 s31, s54, 0
    s_cmp_ge_u32 s31, 64
    s_cbranch_scc1 at_end_78
    s_add_u32 s41, s41, 1
    s_cmp_ge_u32 s41, 0x200000
    s_cbranch_scc1 at_end_78
    s_sleep 1
    s_branch at_poll_80
at_a_76:
    s_lshl_b32 s46, s53, 16
    s_add_u32 s46, s46, 88080384
    s_cmp_lg_u32 s51, 0
    s_cbranch_scc1 at_k1_87
    s_mov_b32 exec_lo, 0xff
    s_mov_b32 exec_hi, 0xff
    buffer_load_dwordx4 a[64:67], v9, s[4:7], s46 offen offset:0 sc1
    buffer_load_dwordx4 a[68:71], v9, s[4:7], s46 offen offset:256 sc1
    buffer_load_dwordx4 a[72:75], v9, s[4:7], s46 offen offset:512 sc1
    buffer_load_dwordx4 a[76:79], v9, s[4:7], s46 offen offset:768 sc1
    buffer_load_dwordx4 a[80:83], v9, s[4:7], s46 offen offset:1024 sc1
    buffer_load_dwordx4 a[84:87], v9, s[4:7], s46 offen offset:1280 sc1
    buffer_load_dwordx4 a[88:91], v9, s[4:7], s46 offen offset:1536 sc1
    buffer_load_dwordx4 a[92:95], v9, s[4:7], s46 offen offset:1792 sc1
    s_mov_b64 exec, -1
    buffer_load_dwordx2 a[128:129], v10, s[4:7], s46 offen offset:0 sc1
    buffer_load_dwordx2 a[132:133], v10, s[4:7], s46 offen offset:512 sc1
    buffer_load_dwordx2 a[136:137], v10, s[4:7], s46 offen offset:1024 sc1
    buffer_load_dwordx2 a[140:141], v10, s[4:7], s46 offen offset:1536 sc1
at_k1_87:
    s_lshl_b32 s47, s53, 18
    s_add_u32 s47, s47, 67108864
    s_cmp_lt_u32 s49, s72
    s_cselect_b32 s52, 1, 0
    s_cmp_lt_u32 s49, 64
    s_cselect_b32 s32, s49, s53
    s_cselect_b32 s31, 0, 2130706432
    v_or_b32 v7, s31, v8
    s_lshl_b32 s36, s32, 18
    s_lshl_b32 s46, s32, 16
    s_add_u32 s46, s46, 88080384
    s_load_dwordx16 s[8:23], s[90:91], s57 glc
    s_load_dwordx4 s[76:79], s[90:91], s55 glc
    s_load_dwordx4 s[80:83], s[90:91], s56 glc
    v_mfma_f32_32x32x16_bf16 v[112:127], a[32:35], a[0:3], v[96:111]
    v_mfma_f32_32x32x16_bf16 v[112:127], a[36:39], a[4:7], v[112:127]
    v_mfma_f32_32x32x16_bf16 v[112:127], a[40:43], a[8:11], v[112:127]
    v_mfma_f32_32x32x16_bf16 v[112:127], a[44:47], a[12:15], v[112:127]
    v_mfma_f32_32x32x16_bf16 v[112:127], a[48:51], a[16:19], v[112:127]
    v_mfma_f32_32x32x16_bf16 v[112:127], a[52:55], a[20:23], v[112:127]
    v_mfma_f32_32x32x16_bf16 v[112:127], a[56:59], a[24:27], v[112:127]
    v_mfma_f32_32x32x16_bf16 v[112:127], a[60:63], a[28:31], v[112:127]
    s_cmp_lg_u32 s51, 0
    s_cbranch_scc1 at_k2_88
    s_waitcnt vmcnt(4)
at_k2_88:
    s_add_u32 s31, s36, 16777216
    buffer_load_dwordx4 a[32:35], v7, s[4:7], s31 offen offset:0 sc1
    buffer_load_dwordx4 a[36:39], v7, s[4:7], s31 offen offset:1024 sc1
    buffer_load_dwordx4 a[40:43], v7, s[4:7], s31 offen offset:2048 sc1
    buffer_load_dwordx4 a[44:47], v7, s[4:7], s31 offen offset:3072 sc1
    s_add_u32 s31, s36, 16781312
    buffer_load_dwordx4 a[48:51], v7, s[4:7], s31 offen offset:0 sc1
    buffer_load_dwordx4 a[52:55], v7, s[4:7], s31 offen offset:1024 sc1
    buffer_load_dwordx4 a[56:59], v7, s[4:7], s31 offen offset:2048 sc1
    buffer_load_dwordx4 a[60:63], v7, s[4:7], s31 offen offset:3072 sc1
    v_mfma_f32_32x32x16_bf16 v[128:143], a[64:67], a[0:3], 0
    v_mfma_f32_32x32x16_bf16 v[128:143], a[68:71], a[4:7], v[128:143]
    v_mfma_f32_32x32x16_bf16 v[128:143], a[72:75], a[8:11], v[128:143]
    v_mfma_f32_32x32x16_bf16 v[128:143], a[76:79], a[12:15], v[128:143]
    v_mfma_f32_32x32x16_bf16 v[128:143], a[80:83], a[16:19], v[128:143]
    v_mfma_f32_32x32x16_bf16 v[128:143], a[84:87], a[20:23], v[128:143]
    v_mfma_f32_32x32x16_bf16 v[128:143], a[88:91], a[24:27], v[128:143]
    v_mfma_f32_32x32x16_bf16 v[128:143], a[92:95], a[28:31], v[128:143]
    s_mov_b32 s51, s52
    s_add_u32 s31, s36, 0
    buffer_load_dwordx4 a[0:3], v7, s[4:7], s31 offen offset:0 sc1
    buffer_load_dwordx4 a[4:7], v7, s[4:7], s31 offen offset:1024 sc1
    buffer_load_dwordx4 a[8:11], v7, s[4:7], s31 offen offset:2048 sc1
    buffer_load_dwordx4 a[12:15], v7, s[4:7], s31 offen offset:3072 sc1
    s_add_u32 s31, s36, 4096
    buffer_load_dwordx4 a[16:19], v7, s[4:7], s31 offen offset:0 sc1
    buffer_load_dwordx4 a[20:23], v7, s[4:7], s31 offen offset:1024 sc1
    buffer_load_dwordx4 a[24:27], v7, s[4:7], s31 offen offset:2048 sc1
    buffer_load_dwordx4 a[28:31], v7, s[4:7], s31 offen offset:3072 sc1
    s_cmp_eq_u32 s51, 0
    s_cbranch_scc1 at_k3_89
    s_mov_b32 exec_lo, 0xff
    s_mov_b32 exec_hi, 0xff
    buffer_load_dwordx4 a[64:67], v9, s[4:7], s46 offen offset:0 sc1
    buffer_load_dwordx4 a[68:71], v9, s[4:7], s46 offen offset:256 sc1
    buffer_load_dwordx4 a[72:75], v9, s[4:7], s46 offen offset:512 sc1
    buffer_load_dwordx4 a[76:79], v9, s[4:7], s46 offen offset:768 sc1
    buffer_load_dwordx4 a[80:83], v9, s[4:7], s46 offen offset:1024 sc1
    buffer_load_dwordx4 a[84:87], v9, s[4:7], s46 offen offset:1280 sc1
    buffer_load_dwordx4 a[88:91], v9, s[4:7], s46 offen offset:1536 sc1
    buffer_load_dwordx4 a[92:95], v9, s[4:7], s46 offen offset:1792 sc1
    s_mov_b64 exec, -1
at_k3_89:
    v_max3_f32 v14, v112, v113, v114
    v_max3_f32 v14, v14, v115, v116
    v_max3_f32 v14, v14, v117, v118
    v_max3_f32 v14, v14, v119, v120
    v_max3_f32 v14, v14, v121, v122
    v_max3_f32 v14, v14, v123, v124
    v_max3_f32 v14, v14, v125, v126
    v_max3_f32 v14, v14, v127, v128
    v_max3_f32 v14, v14, v129, v130
    v_max_f32 v14, v14, v131
    v_mov_b32 v15, v14
    s_nop 1
    v_permlane32_swap_b32 v14, v15
    v_max_f32 v14, v14, v15
    v_mul_f32 v14, s42, v14
    v_fma_f32 v112, v112, s42, -v14
    v_fma_f32 v113, v113, s42, -v14
    v_fma_f32 v114, v114, s42, -v14
    v_fma_f32 v115, v115, s42, -v14
    v_fma_f32 v116, v116, s42, -v14
    v_fma_f32 v117, v117, s42, -v14
    v_fma_f32 v118, v118, s42, -v14
    v_fma_f32 v119, v119, s42, -v14
    v_fma_f32 v120, v120, s42, -v14
    v_fma_f32 v121, v121, s42, -v14
    v_fma_f32 v122, v122, s42, -v14
    v_fma_f32 v123, v123, s42, -v14
    v_fma_f32 v124, v124, s42, -v14
    v_fma_f32 v125, v125, s42, -v14
    v_fma_f32 v126, v126, s42, -v14
    v_fma_f32 v127, v127, s42, -v14
    v_fma_f32 v128, v128, s42, -v14
    v_fma_f32 v129, v129, s42, -v14
    v_fma_f32 v130, v130, s42, -v14
    v_fma_f32 v131, v131, s42, -v14
    v_exp_f32 v112, v112
    v_exp_f32 v113, v113
    v_exp_f32 v114, v114
    v_exp_f32 v115, v115
    v_exp_f32 v116, v116
    v_exp_f32 v117, v117
    v_exp_f32 v118, v118
    v_exp_f32 v119, v119
    v_exp_f32 v120, v120
    v_exp_f32 v121, v121
    v_exp_f32 v122, v122
    v_exp_f32 v123, v123
    v_exp_f32 v124, v124
    v_exp_f32 v125, v125
    v_exp_f32 v126, v126
    v_exp_f32 v127, v127
    v_exp_f32 v128, v128
    v_exp_f32 v129, v129
    v_exp_f32 v130, v130
    v_exp_f32 v131, v131
    v_add_f32 v26, v112, v113
    v_add_f32 v15, v114, v115
    v_add_f32 v26, v26, v116
    v_add_f32 v15, v15, v117
    v_add_f32 v26, v26, v118
    v_add_f32 v15, v15, v119
    v_add_f32 v26, v26, v120
    v_add_f32 v15, v15, v121
    v_add_f32 v26, v26, v122
    v_add_f32 v15, v15, v123
    v_add_f32 v26, v26, v124
    v_add_f32 v15, v15, v125
    v_add_f32 v26, v26, v126
    v_add_f32 v15, v15, v127
    v_add_f32 v26, v26, v128
    v_add_f32 v15, v15, v129
    v_add_f32 v26, v26, v130
    v_add_f32 v15, v15, v131
    v_add_f32 v26, v26, v15
    v_mov_b32 v15, v26
    s_nop 1
    v_permlane32_swap_b32 v26, v15
    v_add_f32 v26, v26, v15
    v_rcp_f32 v26, v26
    v_cvt_pk_bf16_f32 v28, v112, v113
    v_cvt_pk_bf16_f32 v29, v114, v115
    v_cvt_pk_bf16_f32 v30, v116, v117
    v_cvt_pk_bf16_f32 v31, v118, v119
    v_cvt_pk_bf16_f32 v32, v120, v121
    v_cvt_pk_bf16_f32 v33, v122, v123
    v_cvt_pk_bf16_f32 v34, v124, v125
    v_cvt_pk_bf16_f32 v35, v126, v127
    v_cvt_pk_bf16_f32 v40, v128, v129
    v_cvt_pk_bf16_f32 v41, v130, v131
    s_waitcnt vmcnt(16)
    v_mov_b32 v2, s45
    buffer_store_dword v2, v12, s[4:7], s43 offen sc1
    v_mfma_f32_32x32x16_bf16 v[144:159], a[96:99], v[28:31], 0
    v_mfma_f32_32x32x16_bf16 v[144:159], a[100:103], v[32:35], v[144:159]
    v_mfma_f32_32x32x16_bf16 v[144:159], a[128:131], v[40:43], v[144:159]
    v_mfma_f32_32x32x16_bf16 v[160:175], a[104:107], v[28:31], 0
    v_mfma_f32_32x32x16_bf16 v[160:175], a[108:111], v[32:35], v[160:175]
    v_mfma_f32_32x32x16_bf16 v[160:175], a[132:135], v[40:43], v[160:175]
    v_mfma_f32_32x32x16_bf16 v[176:191], a[112:115], v[28:31], 0
    s_nop 7
    v_mul_f32 v144, v144, v26
    v_mul_f32 v145, v145, v26
    v_mul_f32 v146, v146, v26
    v_mul_f32 v147, v147, v26
    v_mul_f32 v148, v148, v26
    v_mul_f32 v149, v149, v26
    v_mfma_f32_32x32x16_bf16 v[176:191], a[116:119], v[32:35], v[176:191]
    v_mul_f32 v150, v150, v26
    v_mul_f32 v151, v151, v26
    v_mul_f32 v152, v152, v26
    v_mul_f32 v153, v153, v26
    v_mul_f32 v154, v154, v26
    v_mul_f32 v155, v155, v26
    v_mfma_f32_32x32x16_bf16 v[176:191], a[136:139], v[40:43], v[176:191]
    v_mul_f32 v156, v156, v26
    v_mul_f32 v157, v157, v26
    v_mul_f32 v158, v158, v26
    v_mul_f32 v159, v159, v26
    v_cvt_pk_bf16_f32 v208, v144, v145
    v_cvt_pk_bf16_f32 v209, v146, v147
    v_mfma_f32_32x32x16_bf16 v[192:207], a[120:123], v[28:31], 0
    v_cvt_pk_bf16_f32 v210, v148, v149
    v_cvt_pk_bf16_f32 v211, v150, v151
    v_cvt_pk_bf16_f32 v212, v152, v153
    v_cvt_pk_bf16_f32 v213, v154, v155
    v_cvt_pk_bf16_f32 v214, v156, v157
    v_cvt_pk_bf16_f32 v215, v158, v159
    v_mfma_f32_32x32x16_bf16 v[192:207], a[124:127], v[32:35], v[192:207]
    v_mul_f32 v160, v160, v26
    v_mul_f32 v161, v161, v26
    v_mul_f32 v162, v162, v26
    v_mul_f32 v163, v163, v26
    v_mul_f32 v164, v164, v26
    v_mul_f32 v165, v165, v26
    v_mfma_f32_32x32x16_bf16 v[192:207], a[140:143], v[40:43], v[192:207]
    v_mul_f32 v166, v166, v26
    v_mul_f32 v167, v167, v26
    v_mul_f32 v168, v168, v26
    v_mul_f32 v169, v169, v26
    v_mul_f32 v170, v170, v26
    v_mul_f32 v171, v171, v26
    s_add_u32 s31, s36, 33554432
    buffer_load_dwordx4 a[96:99], v7, s[4:7], s31 offen offset:0 sc1
    buffer_load_dwordx4 a[100:103], v7, s[4:7], s31 offen offset:1024 sc1
    buffer_load_dwordx4 a[104:107], v7, s[4:7], s31 offen offset:2048 sc1
    buffer_load_dwordx4 a[108:111], v7, s[4:7], s31 offen offset:3072 sc1
    s_add_u32 s31, s36, 33558528
    buffer_load_dwordx4 a[112:115], v7, s[4:7], s31 offen offset:0 sc1
    buffer_load_dwordx4 a[116:119], v7, s[4:7], s31 offen offset:1024 sc1
    buffer_load_dwordx4 a[120:123], v7, s[4:7], s31 offen offset:2048 sc1
    buffer_load_dwordx4 a[124:127], v7, s[4:7], s31 offen offset:3072 sc1
    s_cmp_eq_u32 s51, 0
    s_cbranch_scc1 at_k4_90
    buffer_load_dwordx2 a[128:129], v10, s[4:7], s46 offen offset:0 sc1
    buffer_load_dwordx2 a[132:133], v10, s[4:7], s46 offen offset:512 sc1
    buffer_load_dwordx2 a[136:137], v10, s[4:7], s46 offen offset:1024 sc1
    buffer_load_dwordx2 a[140:141], v10, s[4:7], s46 offen offset:1536 sc1
at_k4_90:
    v_mul_f32 v172, v172, v26
    v_mul_f32 v173, v173, v26
    v_mul_f32 v174, v174, v26
    v_mul_f32 v175, v175, v26
    v_cvt_pk_bf16_f32 v216, v160, v161
    v_cvt_pk_bf16_f32 v217, v162, v163
    v_cvt_pk_bf16_f32 v218, v164, v165
    v_cvt_pk_bf16_f32 v219, v166, v167
    v_cvt_pk_bf16_f32 v220, v168, v169
    v_cvt_pk_bf16_f32 v221, v170, v171
    v_cvt_pk_bf16_f32 v222, v172, v173
    v_cvt_pk_bf16_f32 v223, v174, v175
    v_mul_f32 v176, v176, v26
    v_mul_f32 v177, v177, v26
    v_mul_f32 v178, v178, v26
    v_mul_f32 v179, v179, v26
    v_mul_f32 v180, v180, v26
    v_mul_f32 v181, v181, v26
    v_mul_f32 v182, v182, v26
    v_mul_f32 v183, v183, v26
    v_mul_f32 v184, v184, v26
    v_mul_f32 v185, v185, v26
    v_mul_f32 v186, v186, v26
    v_mul_f32 v187, v187, v26
    v_mul_f32 v188, v188, v26
    v_mul_f32 v189, v189, v26
    v_mul_f32 v190, v190, v26
    v_mul_f32 v191, v191, v26
    v_cvt_pk_bf16_f32 v224, v176, v177
    v_cvt_pk_bf16_f32 v225, v178, v179
    v_cvt_pk_bf16_f32 v226, v180, v181
    v_cvt_pk_bf16_f32 v227, v182, v183
    v_cvt_pk_bf16_f32 v228, v184, v185
    v_cvt_pk_bf16_f32 v229, v186, v187
    v_cvt_pk_bf16_f32 v230, v188, v189
    v_cvt_pk_bf16_f32 v231, v190, v191
    v_mul_f32 v192, v192, v26
    v_mul_f32 v193, v193, v26
    v_mul_f32 v194, v194, v26
    v_mul_f32 v195, v195, v26
    v_mul_f32 v196, v196, v26
    v_mul_f32 v197, v197, v26
    v_mul_f32 v198, v198, v26
    v_mul_f32 v199, v199, v26
    v_mul_f32 v200, v200, v26
    v_mul_f32 v201, v201, v26
    v_mul_f32 v202, v202, v26
    v_mul_f32 v203, v203, v26
    v_mul_f32 v204, v204, v26
    v_mul_f32 v205, v205, v26
    v_mul_f32 v206, v206, v26
    v_mul_f32 v207, v207, v26
    v_cvt_pk_bf16_f32 v232, v192, v193
    v_cvt_pk_bf16_f32 v233, v194, v195
    v_cvt_pk_bf16_f32 v234, v196, v197
    v_cvt_pk_bf16_f32 v235, v198, v199
    v_cvt_pk_bf16_f32 v236, v200, v201
    v_cvt_pk_bf16_f32 v237, v202, v203
    v_cvt_pk_bf16_f32 v238, v204, v205
    v_cvt_pk_bf16_f32 v239, v206, v207
    s_add_u32 s31, s47, 0
    buffer_store_dwordx4 v[208:211], v8, s[4:7], s31 offen offset:0 sc1
    buffer_store_dwordx4 v[212:215], v8, s[4:7], s31 offen offset:1024 sc1
    buffer_store_dwordx4 v[216:219], v8, s[4:7], s31 offen offset:2048 sc1
    buffer_store_dwordx4 v[220:223], v8, s[4:7], s31 offen offset:3072 sc1
    s_add_u32 s31, s47, 4096
    buffer_store_dwordx4 v[224:227], v8, s[4:7], s31 offen offset:0 sc1
    buffer_store_dwordx4 v[228:231], v8, s[4:7], s31 offen offset:1024 sc1
    buffer_store_dwordx4 v[232:235], v8, s[4:7], s31 offen offset:2048 sc1
    buffer_store_dwordx4 v[236:239], v8, s[4:7], s31 offen offset:3072 sc1
    s_mov_b32 s45, 1
    s_lshl_b32 s43, s53, 12
    s_add_u32 s43, s43, 32768
    s_mov_b32 s53, s49
    s_add_u32 s49, s53, s37
    s_cmp_lt_u32 s49, s38
    s_cbranch_scc1 at_nx_91
    s_max_u32 s49, s49, s39
    s_cmp_eq_u32 s38, 255
    s_cselect_b32 s49, s49, s39
    s_mov_b32 s37, 3
    s_mov_b32 s38, 255
at_nx_91:
    s_waitcnt vmcnt(17)
    s_branch at_top_75
at_b_77:
    s_load_dwordx16 s[8:23], s[90:91], s57 glc
    s_load_dwordx4 s[76:79], s[90:91], s55 glc
    s_load_dwordx4 s[80:83], s[90:91], s56 glc
    s_lshl_b32 s48, s54, 16
    s_add_u32 s48, s48, 83886080
    s_add_u32 s32, s54, 1
    s_min_u32 s32, s32, 63
    s_lshl_b32 s35, s32, 16
    v_mfma_f32_32x32x16_bf16 v[128:143], a[184:187], a[160:163], v[80:95]
    v_mfma_f32_32x32x16_bf16 v[128:143], a[188:191], a[164:167], v[128:143]
    v_mfma_f32_32x32x16_bf16 v[112:127], a[168:171], a[160:163], v[64:79]
    v_mfma_f32_32x32x16_bf16 v[112:127], a[172:175], a[164:167], v[112:127]
    v_accvgpr_mov_b32 a184, a168
    v_accvgpr_mov_b32 a185, a169
    v_accvgpr_mov_b32 a186, a170
    v_accvgpr_mov_b32 a187, a171
    v_accvgpr_mov_b32 a188, a172
    v_accvgpr_mov_b32 a189, a173
    v_accvgpr_mov_b32 a190, a174
    v_accvgpr_mov_b32 a191, a175
    v_accvgpr_mov_b32 a196, a176
    v_accvgpr_mov_b32 a197, a177
    v_accvgpr_mov_b32 a198, a178
    v_accvgpr_mov_b32 a199, a179
    v_accvgpr_mov_b32 a200, a180
    v_accvgpr_mov_b32 a201, a181
    v_accvgpr_mov_b32 a202, a182
    v_accvgpr_mov_b32 a203, a183
    s_add_u32 s31, s35, 50331648
    buffer_load_dwordx4 a[160:163], v6, s[4:7], s31 offen offset:0 sc1
    buffer_load_dwordx4 a[164:167], v6, s[4:7], s31 offen offset:1024 sc1
    s_add_u32 s31, s35, 54525952
    buffer_load_dwordx4 a[168:171], v6, s[4:7], s31 offen offset:0 sc1
    buffer_load_dwordx4 a[172:175], v6, s[4:7], s31 offen offset:1024 sc1
    s_add_u32 s31, s35, 58720256
    buffer_load_dwordx4 a[176:179], v6, s[4:7], s31 offen offset:0 sc1
    buffer_load_dwordx4 a[180:183], v6, s[4:7], s31 offen offset:1024 sc1
    v_max3_f32 v14, v136, v137, v138
    v_max3_f32 v14, v14, v139, v140
    v_max3_f32 v14, v14, v141, v142
    v_max3_f32 v14, v14, v143, v112
    v_max3_f32 v14, v14, v113, v114
    v_max3_f32 v14, v14, v115, v116
    v_max3_f32 v14, v14, v117, v118
    v_max3_f32 v14, v14, v119, v120
    v_max3_f32 v14, v14, v121, v122
    v_max3_f32 v14, v14, v123, v124
    v_max3_f32 v14, v14, v125, v126
    v_max_f32 v14, v14, v127
    v_mov_b32 v15, v14
    s_nop 1
    v_permlane32_swap_b32 v14, v15
    v_max_f32 v14, v14, v15
    v_mul_f32 v14, s58, v14
    v_fma_f32 v136, v136, s58, -v14
    v_fma_f32 v137, v137, s58, -v14
    v_fma_f32 v138, v138, s58, -v14
    v_fma_f32 v139, v139, s58, -v14
    v_fma_f32 v140, v140, s58, -v14
    v_fma_f32 v141, v141, s58, -v14
    v_fma_f32 v142, v142, s58, -v14
    v_fma_f32 v143, v143, s58, -v14
    v_fma_f32 v112, v112, s58, -v14
    v_fma_f32 v113, v113, s58, -v14
    v_fma_f32 v114, v114, s58, -v14
    v_fma_f32 v115, v115, s58, -v14
    v_fma_f32 v116, v116, s58, -v14
    v_fma_f32 v117, v117, s58, -v14
    v_fma_f32 v118, v118, s58, -v14
    v_fma_f32 v119, v119, s58, -v14
    v_fma_f32 v120, v120, s58, -v14
    v_fma_f32 v121, v121, s58, -v14
    v_fma_f32 v122, v122, s58, -v14
    v_fma_f32 v123, v123, s58, -v14
    v_fma_f32 v124, v124, s58, -v14
    v_fma_f32 v125, v125, s58, -v14
    v_fma_f32 v126, v126, s58, -v14
    v_fma_f32 v127, v127, s58, -v14
    v_exp_f32 v136, v136
    v_exp_f32 v137, v137
    v_exp_f32 v138, v138
    v_exp_f32 v139, v139
    v_exp_f32 v140, v140
    v_exp_f32 v141, v141
    v_exp_f32 v142, v142
    v_exp_f32 v143, v143
    v_exp_f32 v112, v112
    v_exp_f32 v113, v113
    v_exp_f32 v114, v114
    v_exp_f32 v115, v115
    v_exp_f32 v116, v116
    v_exp_f32 v117, v117
    v_exp_f32 v118, v118
    v_exp_f32 v119, v119
    v_exp_f32 v120, v120
    v_exp_f32 v121, v121
    v_exp_f32 v122, v122
    v_exp_f32 v123, v123
    v_exp_f32 v124, v124
    v_exp_f32 v125, v125
    v_exp_f32 v126, v126
    v_exp_f32 v127, v127
    v_add_f32 v26, v136, v137
    v_add_f32 v15, v138, v139
    v_add_f32 v26, v26, v140
    v_add_f32 v15, v15, v141
    v_add_f32 v26, v26, v142
    v_add_f32 v15, v15, v143
    v_add_f32 v26, v26, v112
    v_add_f32 v15, v15, v113
    v_add_f32 v26, v26, v114
    v_add_f32 v15, v15, v115
    v_add_f32 v26, v26, v116
    v_add_f32 v15, v15, v117
    v_add_f32 v26, v26, v118
    v_add_f32 v15, v15, v119
    v_add_f32 v26, v26, v120
    v_add_f32 v15, v15, v121
    v_add_f32 v26, v26, v122
    v_add_f32 v15, v15, v123
    v_add_f32 v26, v26, v124
    v_add_f32 v15, v15, v125
    v_add_f32 v26, v26, v126
    v_add_f32 v15, v15, v127
    v_add_f32 v26, v26, v15
    v_mov_b32 v15, v26
    s_nop 1
    v_permlane32_swap_b32 v26, v15
    v_add_f32 v26, v26, v15
    v_rcp_f32 v26, v26
    v_cvt_pk_bf16_f32 v28, v112, v113
    v_cvt_pk_bf16_f32 v29, v114, v115
    v_cvt_pk_bf16_f32 v30, v116, v117
    v_cvt_pk_bf16_f32 v31, v118, v119
    v_cvt_pk_bf16_f32 v32, v120, v121
    v_cvt_pk_bf16_f32 v33, v122, v123
    v_cvt_pk_bf16_f32 v34, v124, v125
    v_cvt_pk_bf16_f32 v35, v126, v127
    v_cvt_pk_bf16_f32 v36, v136, v137
    v_cvt_pk_bf16_f32 v37, v138, v139
    v_cvt_pk_bf16_f32 v38, v140, v141
    v_cvt_pk_bf16_f32 v39, v142, v143
    v_mfma_f32_32x32x16_bf16 v[144:159], a[196:199], v[28:31], 0
    v_mfma_f32_32x32x16_bf16 v[144:159], a[200:203], v[32:35], v[144:159]
    v_mfma_f32_32x32x16_bf16 v[144:159], a[192:195], v[36:39], v[144:159]
    v_accvgpr_mov_b32 a192, a200
    v_accvgpr_mov_b32 a193, a201
    v_accvgpr_mov_b32 a194, a202
    v_accvgpr_mov_b32 a195, a203
    s_waitcnt vmcnt(6)
    v_mov_b32 v2, s45
    buffer_store_dword v2, v12, s[4:7], s43 offen sc1
    s_cmp_lg_u32 s54, 0
    s_cbranch_scc1 at_nb_79
    v_mov_b32 v14, 0xf149f2ca
    v_add_u32 v3, 32, v11
    v_and_b32 v3, 0xfffffff1, v3
    v_cmp_ne_u32 vcc, 0, v3
    s_nop 1
    v_cndmask_b32 v80, 0, v14, vcc
    v_add_u32 v3, 31, v11
    v_and_b32 v3, 0xfffffff1, v3
    v_cmp_ne_u32 vcc, 0, v3
    s_nop 1
    v_cndmask_b32 v81, 0, v14, vcc
    v_add_u32 v3, 30, v11
    v_and_b32 v3, 0xfffffff1, v3
    v_cmp_ne_u32 vcc, 0, v3
    s_nop 1
    v_cndmask_b32 v82, 0, v14, vcc
    v_add_u32 v3, 29, v11
    v_and_b32 v3, 0xfffffff1, v3
    v_cmp_ne_u32 vcc, 0, v3
    s_nop 1
    v_cndmask_b32 v83, 0, v14, vcc
    v_add_u32 v3, 24, v11
    v_and_b32 v3, 0xfffffff1, v3
    v_cmp_ne_u32 vcc, 0, v3
    s_nop 1
    v_cndmask_b32 v84, 0, v14, vcc
    v_add_u32 v3, 23, v11
    v_and_b32 v3, 0xfffffff1, v3
    v_cmp_ne_u32 vcc, 0, v3
    s_nop 1
    v_cndmask_b32 v85, 0, v14, vcc
    v_add_u32 v3, 22, v11
    v_and_b32 v3, 0xfffffff1, v3
    v_cmp_ne_u32 vcc, 0, v3
    s_nop 1
    v_cndmask_b32 v86, 0, v14, vcc
    v_add_u32 v3, 21, v11
    v_and_b32 v3, 0xfffffff1, v3
    v_cmp_ne_u32 vcc, 0, v3
    s_nop 1
    v_cndmask_b32 v87, 0, v14, vcc
    v_add_u32 v3, 16, v11
    v_and_b32 v3, 0xfffffff1, v3
    v_cmp_ne_u32 vcc, 0, v3
    s_nop 1
    v_cndmask_b32 v88, 0, v14, vcc
    v_add_u32 v3, 15, v11
    v_and_b32 v3, 0xfffffff1, v3
    v_cmp_ne_u32 vcc, 0, v3
    s_nop 1
    v_cndmask_b32 v89, 0, v14, vcc
    v_add_u32 v3, 14, v11
    v_and_b32 v3, 0xfffffff1, v3
    v_cmp_ne_u32 vcc, 0, v3
    s_nop 1
    v_cndmask_b32 v90, 0, v14, vcc
    v_add_u32 v3, 13, v11
    v_and_b32 v3, 0xfffffff1, v3
    v_cmp_ne_u32 vcc, 0, v3
    s_nop 1
    v_cndmask_b32 v91, 0, v14, vcc
    v_add_u32 v3, 8, v11
    v_and_b32 v3, 0xfffffff1, v3
    v_cmp_ne_u32 vcc, 0, v3
    s_nop 1
    v_cndmask_b32 v92, 0, v14, vcc
    v_add_u32 v3, 7, v11
    v_and_b32 v3, 0xfffffff1, v3
    v_cmp_ne_u32 vcc, 0, v3
    s_nop 1
    v_cndmask_b32 v93, 0, v14, vcc
    v_add_u32 v3, 6, v11
    v_and_b32 v3, 0xfffffff1, v3
    v_cmp_ne_u32 vcc, 0, v3
    s_nop 1
    v_cndmask_b32 v94, 0, v14, vcc
    v_add_u32 v3, 5, v11
    v_and_b32 v3, 0xfffffff1, v3
    v_cmp_ne_u32 vcc, 0, v3
    s_nop 1
    v_cndmask_b32 v95, 0, v14, vcc
at_nb_79:
    s_nop 2
    v_mul_f32 v144, v144, v26
    v_mul_f32 v145, v145, v26
    v_mul_f32 v146, v146, v26
    v_mul_f32 v147, v147, v26
    v_mul_f32 v148, v148, v26
    v_mul_f32 v149, v149, v26
    v_mul_f32 v150, v150, v26
    v_mul_f32 v151, v151, v26
    v_mul_f32 v152, v152, v26
    v_mul_f32 v153, v153, v26
    v_mul_f32 v154, v154, v26
    v_mul_f32 v155, v155, v26
    v_mul_f32 v156, v156, v26
    v_mul_f32 v157, v157, v26
    v_mul_f32 v158, v158, v26
    v_mul_f32 v159, v159, v26
    v_cvt_pk_bf16_f32 v208, v144, v145
    v_cvt_pk_bf16_f32 v209, v146, v147
    v_cvt_pk_bf16_f32 v210, v148, v149
    v_cvt_pk_bf16_f32 v211, v150, v151
    v_cvt_pk_bf16_f32 v212, v152, v153
    v_cvt_pk_bf16_f32 v213, v154, v155
    v_cvt_pk_bf16_f32 v214, v156, v157
    v_cvt_pk_bf16_f32 v215, v158, v159
    v_permlane32_swap_b32 v208, v210
    v_permlane32_swap_b32 v209, v211
    v_permlane32_swap_b32 v212, v214
    v_permlane32_swap_b32 v213, v215
    buffer_store_dwordx4 v[208:211], v6, s[4:7], s48 offen offset:0 sc1
    buffer_store_dwordx4 v[212:215], v6, s[4:7], s48 offen offset:1024 sc1
    s_add_u32 s54, s54, 1
    s_mov_b32 s43, 16384
    s_mov_b32 s45, s54
    s_waitcnt vmcnt(3)
    s_branch at_top_75
at_end_78:
    s_waitcnt vmcnt(0) lgkmcnt(0)
    s_branch L_o64
L_o64:
    s_cmp_ge_u32 s28, 80
    s_cbranch_scc1 L_dump
    s_load_dwordx2 s[72:73], s[0:1], 40
    s_load_dwordx2 s[74:75], s[0:1], 80
    s_mul_i32 s44, s28, 205
    s_lshr_b32 s44, s44, 10
    s_mul_i32 s31, s44, 5
    s_sub_u32 s30, s28, s31
    s_waitcnt lgkmcnt(0)
    s_mov_b32 s8, s72
    s_and_b32 s9, s73, 0xffff
    s_mov_b32 s10, 8388608
    s_mov_b32 s11, 0x00020000
    s_mov_b32 s20, s74
    s_and_b32 s21, s75, 0xffff
    s_mov_b32 s22, 8388608
    s_mov_b32 s23, 0x00020000
    s_lshl_b32 s31, s29, 21
    s_lshl_b32 s33, s44, 7
    s_add_u32 s31, s31, s33
    v_lshrrev_b32 v6, 3, v1
    v_lshlrev_b32 v6, 11, v6
    v_and_b32 v4, 7, v1
    v_lshl_add_u32 v6, v4, 4, v6
    v_add_u32 v6, s31, v6
    s_lshl_b32 s31, s29, 15
    v_lshrrev_b32 v7, 5, v1
    v_lshlrev_b32 v7, 9, v7
    v_bfe_u32 v4, v1, 2, 2
    v_lshl_add_u32 v7, v4, 7, v7
    v_bfe_u32 v4, v1, 4, 1
    v_lshl_add_u32 v7, v4, 5, v7
    v_and_b32 v4, 3, v1
    v_lshl_add_u32 v7, v4, 3, v7
    v_add_u32 v7, s31, v7
    s_lshl_b32 s32, s29, 15
    s_add_u32 m0, s32, 0
    s_mov_b32 s38, 0
    buffer_load_dwordx4 v6, s[8:11], s38 offen lds
    s_add_u32 m0, s32, 1024
    s_add_u32 s38, s38, 16384
    buffer_load_dwordx4 v6, s[8:11], s38 offen lds
    s_add_u32 m0, s32, 2048
    s_add_u32 s38, s38, 16384
    buffer_load_dwordx4 v6, s[8:11], s38 offen lds
    s_add_u32 m0, s32, 3072
    s_add_u32 s38, s38, 16384
    buffer_load_dwordx4 v6, s[8:11], s38 offen lds
    s_add_u32 m0, s32, 4096
    s_add_u32 s38, s38, 16384
    buffer_load_dwordx4 v6, s[8:11], s38 offen lds
    s_add_u32 m0, s32, 5120
    s_add_u32 s38, s38, 16384
    buffer_load_dwordx4 v6, s[8:11], s38 offen lds
    s_add_u32 m0, s32, 6144
    s_add_u32 s38, s38, 16384
    buffer_load_dwordx4 v6, s[8:11], s38 offen lds
    s_add_u32 m0, s32, 7168
    s_add_u32 s38, s38, 16384
    buffer_load_dwordx4 v6, s[8:11], s38 offen lds
    s_add_u32 m0, s32, 8192
    s_add_u32 s38, s38, 16384
    buffer_load_dwordx4 v6, s[8:11], s38 offen lds
    s_add_u32 m0, s32, 9216
    s_add_u32 s38, s38, 16384
    buffer_load_dwordx4 v6, s[8:11], s38 offen lds
    s_add_u32 m0, s32, 10240
    s_add_u32 s38, s38, 16384
    buffer_load_dwordx4 v6, s[8:11], s38 offen lds
    s_add_u32 m0, s32, 11264
    s_add_u32 s38, s38, 16384
    buffer_load_dwordx4 v6, s[8:11], s38 offen lds
    s_add_u32 m0, s32, 12288
    s_add_u32 s38, s38, 16384
    buffer_load_dwordx4 v6, s[8:11], s38 offen lds
    s_add_u32 m0, s32, 13312
    s_add_u32 s38, s38, 16384
    buffer_load_dwordx4 v6, s[8:11], s38 offen lds
    s_add_u32 m0, s32, 14336
    s_add_u32 s38, s38, 16384
    buffer_load_dwordx4 v6, s[8:11], s38 offen lds
    s_add_u32 m0, s32, 15360
    s_add_u32 s38, s38, 16384
    buffer_load_dwordx4 v6, s[8:11], s38 offen lds
    s_add_u32 m0, s32, 16384
    s_add_u32 s38, s38, 16384
    buffer_load_dwordx4 v6, s[8:11], s38 offen lds
    s_add_u32 m0, s32, 17408
    s_add_u32 s38, s38, 16384
    buffer_load_dwordx4 v6, s[8:11], s38 offen lds
    s_add_u32 m0, s32, 18432
    s_add_u32 s38, s38, 16384
    buffer_load_dwordx4 v6, s[8:11], s38 offen lds
    s_add_u32 m0, s32, 19456
    s_add_u32 s38, s38, 16384
    buffer_load_dwordx4 v6, s[8:11], s38 offen lds
    s_add_u32 m0, s32, 20480
    s_add_u32 s38, s38, 16384
    buffer_load_dwordx4 v6, s[8:11], s38 offen lds
    s_add_u32 m0, s32, 21504
    s_add_u32 s38, s38, 16384
    buffer_load_dwordx4 v6, s[8:11], s38 offen lds
    s_add_u32 m0, s32, 22528
    s_add_u32 s38, s38, 16384
    buffer_load_dwordx4 v6, s[8:11], s38 offen lds
    s_add_u32 m0, s32, 23552
    s_add_u32 s38, s38, 16384
    buffer_load_dwordx4 v6, s[8:11], s38 offen lds
    s_add_u32 m0, s32, 24576
    s_add_u32 s38, s38, 16384
    buffer_load_dwordx4 v6, s[8:11], s38 offen lds
    s_add_u32 m0, s32, 25600
    s_add_u32 s38, s38, 16384
    buffer_load_dwordx4 v6, s[8:11], s38 offen lds
    s_add_u32 m0, s32, 26624
    s_add_u32 s38, s38, 16384
    buffer_load_dwordx4 v6, s[8:11], s38 offen lds
    s_add_u32 m0, s32, 27648
    s_add_u32 s38, s38, 16384
    buffer_load_dwordx4 v6, s[8:11], s38 offen lds
    s_add_u32 m0, s32, 28672
    s_add_u32 s38, s38, 16384
    buffer_load_dwordx4 v6, s[8:11], s38 offen lds
    s_add_u32 m0, s32, 29696
    s_add_u32 s38, s38, 16384
    buffer_load_dwordx4 v6, s[8:11], s38 offen lds
    s_add_u32 m0, s32, 30720
    s_add_u32 s38, s38, 16384
    buffer_load_dwordx4 v6, s[8:11], s38 offen lds
    s_add_u32 m0, s32, 31744
    s_add_u32 s38, s38, 16384
    buffer_load_dwordx4 v6, s[8:11], s38 offen lds
    s_waitcnt vmcnt(30)
    ds_read_b64_tr_b16 a[0:1], v7 offset:0
    ds_read_b64_tr_b16 a[2:3], v7 offset:1024
    ds_read_b64_tr_b16 a[4:5], v7 offset:64
    ds_read_b64_tr_b16 a[6:7], v7 offset:1088
    s_waitcnt vmcnt(28)
    ds_read_b64_tr_b16 a[8:9], v7 offset:2048
    ds_read_b64_tr_b16 a[10:11], v7 offset:3072
    ds_read_b64_tr_b16 a[12:13], v7 offset:2112
    ds_read_b64_tr_b16 a[14:15], v7 offset:3136
    s_waitcnt lgkmcnt(4)
    s_add_u32 m0, s32, 0
    s_add_u32 s38, s38, 16384
    buffer_load_dwordx4 v6, s[8:11], s38 offen lds
    s_add_u32 m0, s32, 1024
    s_add_u32 s38, s38, 16384
    buffer_load_dwordx4 v6, s[8:11], s38 offen lds
    s_waitcnt vmcnt(28)
    ds_read_b64_tr_b16 a[16:17], v7 offset:4096
    ds_read_b64_tr_b16 a[18:19], v7 offset:5120
    ds_read_b64_tr_b16 a[20:21], v7 offset:4160
    ds_read_b64_tr_b16 a[22:23], v7 offset:5184
    s_waitcnt lgkmcnt(4)
    s_add_u32 m0, s32, 2048
    s_add_u32 s38, s38, 16384
    buffer_load_dwordx4 v6, s[8:11], s38 offen lds
    s_add_u32 m0, s32, 3072
    s_add_u32 s38, s38, 16384
    buffer_load_dwordx4 v6, s[8:11], s38 offen lds
    s_waitcnt vmcnt(28)
    ds_read_b64_tr_b16 a[24:25], v7 offset:6144
    ds_read_b64_tr_b16 a[26:27], v7 offset:7168
    ds_read_b64_tr_b16 a[28:29], v7 offset:6208
    ds_read_b64_tr_b16 a[30:31], v7 offset:7232
    s_waitcnt lgkmcnt(4)
    s_add_u32 m0, s32, 4096
    s_add_u32 s38, s38, 16384
    buffer_load_dwordx4 v6, s[8:11], s38 offen lds
    s_add_u32 m0, s32, 5120
    s_add_u32 s38, s38, 16384
    buffer_load_dwordx4 v6, s[8:11], s38 offen lds
    s_waitcnt vmcnt(28)
    ds_read_b64_tr_b16 a[32:33], v7 offset:8192
    ds_read_b64_tr_b16 a[34:35], v7 offset:9216
    ds_read_b64_tr_b16 a[36:37], v7 offset:8256
    ds_read_b64_tr_b16 a[38:39], v7 offset:9280
    s_waitcnt lgkmcnt(4)
    s_add_u32 m0, s32, 6144
    s_add_u32 s38, s38, 16384
    buffer_load_dwordx4 v6, s[8:11], s38 offen lds
    s_add_u32 m0, s32, 7168
    s_add_u32 s38, s38, 16384
    buffer_load_dwordx4 v6, s[8:11], s38 offen lds
    s_waitcnt vmcnt(28)
    ds_read_b64_tr_b16 a[40:41], v7 offset:10240
    ds_read_b64_tr_b16 a[42:43], v7 offset:11264
    ds_read_b64_tr_b16 a[44:45], v7 offset:10304
    ds_read_b64_tr_b16 a[46:47], v7 offset:11328
    s_waitcnt lgkmcnt(4)
    s_add_u32 m0, s32, 8192
    s_add_u32 s38, s38, 16384
    buffer_load_dwordx4 v6, s[8:11], s38 offen lds
    s_add_u32 m0, s32, 9216
    s_add_u32 s38, s38, 16384
    buffer_load_dwordx4 v6, s[8:11], s38 offen lds
    s_waitcnt vmcnt(28)
    ds_read_b64_tr_b16 a[48:49], v7 offset:12288
    ds_read_b64_tr_b16 a[50:51], v7 offset:13312
    ds_read_b64_tr_b16 a[52:53], v7 offset:12352
    ds_read_b64_tr_b16 a[54:55], v7 offset:13376
    s_waitcnt lgkmcnt(4)
    s_add_u32 m0, s32, 10240
    s_add_u32 s38, s38, 16384
    buffer_load_dwordx4 v6, s[8:11], s38 offen lds
    s_add_u32 m0, s32, 11264
    s_add_u32 s38, s38, 16384
    buffer_load_dwordx4 v6, s[8:11], s38 offen lds
    s_waitcnt vmcnt(28)
    ds_read_b64_tr_b16 a[56:57], v7 offset:14336
    ds_read_b64_tr_b16 a[58:59], v7 offset:15360
    ds_read_b64_tr_b16 a[60:61], v7 offset:14400
    ds_read_b64_tr_b16 a[62:63], v7 offset:15424
    s_waitcnt lgkmcnt(4)
    s_add_u32 m0, s32, 12288
    s_add_u32 s38, s38, 16384
    buffer_load_dwordx4 v6, s[8:11], s38 offen lds
    s_add_u32 m0, s32, 13312
    s_add_u32 s38, s38, 16384
    buffer_load_dwordx4 v6, s[8:11], s38 offen lds
    s_waitcnt vmcnt(28)
    ds_read_b64_tr_b16 a[64:65], v7 offset:16384
    ds_read_b64_tr_b16 a[66:67], v7 offset:17408
    ds_read_b64_tr_b16 a[68:69], v7 offset:16448
    ds_read_b64_tr_b16 a[70:71], v7 offset:17472
    s_waitcnt lgkmcnt(4)
    s_add_u32 m0, s32, 14336
    s_add_u32 s38, s38, 16384
    buffer_load_dwordx4 v6, s[8:11], s38 offen lds
    s_add_u32 m0, s32, 15360
    s_add_u32 s38, s38, 16384
    buffer_load_dwordx4 v6, s[8:11], s38 offen lds
    s_waitcnt vmcnt(28)
    ds_read_b64_tr_b16 a[72:73], v7 offset:18432
    ds_read_b64_tr_b16 a[74:75], v7 offset:19456
    ds_read_b64_tr_b16 a[76:77], v7 offset:18496
    ds_read_b64_tr_b16 a[78:79], v7 offset:19520
    s_waitcnt lgkmcnt(4)
    s_add_u32 m0, s32, 16384
    s_add_u32 s38, s38, 16384
    buffer_load_dwordx4 v6, s[8:11], s38 offen lds
    s_add_u32 m0, s32, 17408
    s_add_u32 s38, s38, 16384
    buffer_load_dwordx4 v6, s[8:11], s38 offen lds
    s_waitcnt vmcnt(28)
    ds_read_b64_tr_b16 a[80:81], v7 offset:20480
    ds_read_b64_tr_b16 a[82:83], v7 offset:21504
    ds_read_b64_tr_b16 a[84:85], v7 offset:20544
    ds_read_b64_tr_b16 a[86:87], v7 offset:21568
    s_waitcnt lgkmcnt(4)
    s_add_u32 m0, s32, 18432
    s_add_u32 s38, s38, 16384
    buffer_load_dwordx4 v6, s[8:11], s38 offen lds
    s_add_u32 m0, s32, 19456
    s_add_u32 s38, s38, 16384
    buffer_load_dwordx4 v6, s[8:11], s38 offen lds
    s_waitcnt vmcnt(28)
    ds_read_b64_tr_b16 a[88:89], v7 offset:22528
    ds_read_b64_tr_b16 a[90:91], v7 offset:23552
    ds_read_b64_tr_b16 a[92:93], v7 offset:22592
    ds_read_b64_tr_b16 a[94:95], v7 offset:23616
    s_waitcnt lgkmcnt(4)
    s_add_u32 m0, s32, 20480
    s_add_u32 s38, s38, 16384
    buffer_load_dwordx4 v6, s[8:11], s38 offen lds
    s_add_u32 m0, s32, 21504
    s_add_u32 s38, s38, 16384
    buffer_load_dwordx4 v6, s[8:11], s38 offen lds
    s_waitcnt vmcnt(28)
    ds_read_b64_tr_b16 a[96:97], v7 offset:24576
    ds_read_b64_tr_b16 a[98:99], v7 offset:25600
    ds_read_b64_tr_b16 a[100:101], v7 offset:24640
    ds_read_b64_tr_b16 a[102:103], v7 offset:25664
    s_waitcnt lgkmcnt(4)
    s_add_u32 m0, s32, 22528
    s_add_u32 s38, s38, 16384
    buffer_load_dwordx4 v6, s[8:11], s38 offen lds
    s_add_u32 m0, s32, 23552
    s_add_u32 s38, s38, 16384
    buffer_load_dwordx4 v6, s[8:11], s38 offen lds
    s_waitcnt vmcnt(28)
    ds_read_b64_tr_b16 a[104:105], v7 offset:26624
    ds_read_b64_tr_b16 a[106:107], v7 offset:27648
    ds_read_b64_tr_b16 a[108:109], v7 offset:26688
    ds_read_b64_tr_b16 a[110:111], v7 offset:27712
    s_waitcnt lgkmcnt(4)
    s_add_u32 m0, s32, 24576
    s_add_u32 s38, s38, 16384
    buffer_load_dwordx4 v6, s[8:11], s38 offen lds
    s_add_u32 m0, s32, 25600
    s_add_u32 s38, s38, 16384
    buffer_load_dwordx4 v6, s[8:11], s38 offen lds
    s_waitcnt vmcnt(28)
    ds_read_b64_tr_b16 a[112:113], v7 offset:28672
    ds_read_b64_tr_b16 a[114:115], v7 offset:29696
    ds_read_b64_tr_b16 a[116:117], v7 offset:28736
    ds_read_b64_tr_b16 a[118:119], v7 offset:29760
    s_waitcnt lgkmcnt(4)
    s_add_u32 m0, s32, 26624
    s_add_u32 s38, s38, 16384
    buffer_load_dwordx4 v6, s[8:11], s38 offen lds
    s_add_u32 m0, s32, 27648
    s_add_u32 s38, s38, 16384
    buffer_load_dwordx4 v6, s[8:11], s38 offen lds
    s_waitcnt vmcnt(28)
    ds_read_b64_tr_b16 a[120:121], v7 offset:30720
    ds_read_b64_tr_b16 a[122:123], v7 offset:31744
    ds_read_b64_tr_b16 a[124:125], v7 offset:30784
    ds_read_b64_tr_b16 a[126:127], v7 offset:31808
    s_waitcnt lgkmcnt(4)
    s_add_u32 m0, s32, 28672
    s_add_u32 s38, s38, 16384
    buffer_load_dwordx4 v6, s[8:11], s38 offen lds
    s_add_u32 m0, s32, 29696
    s_add_u32 s38, s38, 16384
    buffer_load_dwordx4 v6, s[8:11], s38 offen lds
    s_waitcnt vmcnt(28)
    ds_read_b64_tr_b16 a[128:129], v7 offset:0
    ds_read_b64_tr_b16 a[130:131], v7 offset:1024
    ds_read_b64_tr_b16 a[132:133], v7 offset:64
    ds_read_b64_tr_b16 a[134:135], v7 offset:1088
    s_waitcnt lgkmcnt(4)
    s_add_u32 m0, s32, 30720
    s_add_u32 s38, s38, 16384
    buffer_load_dwordx4 v6, s[8:11], s38 offen lds
    s_add_u32 m0, s32, 31744
    s_add_u32 s38, s38, 16384
    buffer_load_dwordx4 v6, s[8:11], s38 offen lds
    s_waitcnt vmcnt(28)
    ds_read_b64_tr_b16 a[136:137], v7 offset:2048
    ds_read_b64_tr_b16 a[138:139], v7 offset:3072
    ds_read_b64_tr_b16 a[140:141], v7 offset:2112
    ds_read_b64_tr_b16 a[142:143], v7 offset:3136
    s_waitcnt lgkmcnt(4)
    s_add_u32 m0, s32, 0
    s_add_u32 s38, s38, 16384
    buffer_load_dwordx4 v6, s[8:11], s38 offen lds
    s_add_u32 m0, s32, 1024
    s_add_u32 s38, s38, 16384
    buffer_load_dwordx4 v6, s[8:11], s38 offen lds
    s_waitcnt vmcnt(28)
    ds_read_b64_tr_b16 a[144:145], v7 offset:4096
    ds_read_b64_tr_b16 a[146:147], v7 offset:5120
    ds_read_b64_tr_b16 a[148:149], v7 offset:4160
    ds_read_b64_tr_b16 a[150:151], v7 offset:5184
    s_waitcnt lgkmcnt(4)
    s_add_u32 m0, s32, 2048
    s_add_u32 s38, s38, 16384
    buffer_load_dwordx4 v6, s[8:11], s38 offen lds
    s_add_u32 m0, s32, 3072
    s_add_u32 s38, s38, 16384
    buffer_load_dwordx4 v6, s[8:11], s38 offen lds
    s_waitcnt vmcnt(28)
    ds_read_b64_tr_b16 a[152:153], v7 offset:6144
    ds_read_b64_tr_b16 a[154:155], v7 offset:7168
    ds_read_b64_tr_b16 a[156:157], v7 offset:6208
    ds_read_b64_tr_b16 a[158:159], v7 offset:7232
    s_waitcnt lgkmcnt(4)
    s_add_u32 m0, s32, 4096
    s_add_u32 s38, s38, 16384
    buffer_load_dwordx4 v6, s[8:11], s38 offen lds
    s_add_u32 m0, s32, 5120
    s_add_u32 s38, s38, 16384
    buffer_load_dwordx4 v6, s[8:11], s38 offen lds
    s_waitcnt vmcnt(28)
    ds_read_b64_tr_b16 a[160:161], v7 offset:8192
    ds_read_b64_tr_b16 a[162:163], v7 offset:9216
    ds_read_b64_tr_b16 a[164:165], v7 offset:8256
    ds_read_b64_tr_b16 a[166:167], v7 offset:9280
    s_waitcnt lgkmcnt(4)
    s_add_u32 m0, s32, 6144
    s_add_u32 s38, s38, 16384
    buffer_load_dwordx4 v6, s[8:11], s38 offen lds
    s_add_u32 m0, s32, 7168
    s_add_u32 s38, s38, 16384
    buffer_load_dwordx4 v6, s[8:11], s38 offen lds
    s_waitcnt vmcnt(28)
    ds_read_b64_tr_b16 a[168:169], v7 offset:10240
    ds_read_b64_tr_b16 a[170:171], v7 offset:11264
    ds_read_b64_tr_b16 a[172:173], v7 offset:10304
    ds_read_b64_tr_b16 a[174:175], v7 offset:11328
    s_waitcnt lgkmcnt(4)
    s_add_u32 m0, s32, 8192
    s_add_u32 s38, s38, 16384
    buffer_load_dwordx4 v6, s[8:11], s38 offen lds
    s_add_u32 m0, s32, 9216
    s_add_u32 s38, s38, 16384
    buffer_load_dwordx4 v6, s[8:11], s38 offen lds
    s_waitcnt vmcnt(28)
    ds_read_b64_tr_b16 a[176:177], v7 offset:12288
    ds_read_b64_tr_b16 a[178:179], v7 offset:13312
    ds_read_b64_tr_b16 a[180:181], v7 offset:12352
    ds_read_b64_tr_b16 a[182:183], v7 offset:13376
    s_waitcnt lgkmcnt(4)
    s_add_u32 m0, s32, 10240
    s_add_u32 s38, s38, 16384
    buffer_load_dwordx4 v6, s[8:11], s38 offen lds
    s_add_u32 m0, s32, 11264
    s_add_u32 s38, s38, 16384
    buffer_load_dwordx4 v6, s[8:11], s38 offen lds
    s_waitcnt vmcnt(28)
    ds_read_b64_tr_b16 a[184:185], v7 offset:14336
    ds_read_b64_tr_b16 a[186:187], v7 offset:15360
    ds_read_b64_tr_b16 a[188:189], v7 offset:14400
    ds_read_b64_tr_b16 a[190:191], v7 offset:15424
    s_waitcnt lgkmcnt(4)
    s_add_u32 m0, s32, 12288
    s_add_u32 s38, s38, 16384
    buffer_load_dwordx4 v6, s[8:11], s38 offen lds
    s_add_u32 m0, s32, 13312
    s_add_u32 s38, s38, 16384
    buffer_load_dwordx4 v6, s[8:11], s38 offen lds
    s_waitcnt vmcnt(28)
    ds_read_b64_tr_b16 a[192:193], v7 offset:16384
    ds_read_b64_tr_b16 a[194:195], v7 offset:17408
    ds_read_b64_tr_b16 a[196:197], v7 offset:16448
    ds_read_b64_tr_b16 a[198:199], v7 offset:17472
    s_waitcnt lgkmcnt(4)
    s_add_u32 m0, s32, 14336
    s_add_u32 s38, s38, 16384
    buffer_load_dwordx4 v6, s[8:11], s38 offen lds
    s_add_u32 m0, s32, 15360
    s_add_u32 s38, s38, 16384
    buffer_load_dwordx4 v6, s[8:11], s38 offen lds
    s_waitcnt vmcnt(28)
    ds_read_b64_tr_b16 a[200:201], v7 offset:18432
    ds_read_b64_tr_b16 a[202:203], v7 offset:19456
    ds_read_b64_tr_b16 a[204:205], v7 offset:18496
    ds_read_b64_tr_b16 a[206:207], v7 offset:19520
    s_waitcnt lgkmcnt(4)
    s_add_u32 m0, s32, 16384
    s_add_u32 s38, s38, 16384
    buffer_load_dwordx4 v6, s[8:11], s38 offen lds
    s_add_u32 m0, s32, 17408
    s_add_u32 s38, s38, 16384
    buffer_load_dwordx4 v6, s[8:11], s38 offen lds
    s_waitcnt vmcnt(28)
    ds_read_b64_tr_b16 a[208:209], v7 offset:20480
    ds_read_b64_tr_b16 a[210:211], v7 offset:21504
    ds_read_b64_tr_b16 a[212:213], v7 offset:20544
    ds_read_b64_tr_b16 a[214:215], v7 offset:21568
    s_waitcnt lgkmcnt(4)
    s_add_u32 m0, s32, 18432
    s_add_u32 s38, s38, 16384
    buffer_load_dwordx4 v6, s[8:11], s38 offen lds
    s_add_u32 m0, s32, 19456
    s_add_u32 s38, s38, 16384
    buffer_load_dwordx4 v6, s[8:11], s38 offen lds
    s_waitcnt vmcnt(28)
    ds_read_b64_tr_b16 a[216:217], v7 offset:22528
    ds_read_b64_tr_b16 a[218:219], v7 offset:23552
    ds_read_b64_tr_b16 a[220:221], v7 offset:22592
    ds_read_b64_tr_b16 a[222:223], v7 offset:23616
    s_waitcnt lgkmcnt(4)
    s_add_u32 m0, s32, 20480
    s_add_u32 s38, s38, 16384
    buffer_load_dwordx4 v6, s[8:11], s38 offen lds
    s_add_u32 m0, s32, 21504
    s_add_u32 s38, s38, 16384
    buffer_load_dwordx4 v6, s[8:11], s38 offen lds
    s_waitcnt vmcnt(28)
    ds_read_b64_tr_b16 a[224:225], v7 offset:24576
    ds_read_b64_tr_b16 a[226:227], v7 offset:25600
    ds_read_b64_tr_b16 a[228:229], v7 offset:24640
    ds_read_b64_tr_b16 a[230:231], v7 offset:25664
    s_waitcnt lgkmcnt(4)
    s_add_u32 m0, s32, 22528
    s_add_u32 s38, s38, 16384
    buffer_load_dwordx4 v6, s[8:11], s38 offen lds
    s_add_u32 m0, s32, 23552
    s_add_u32 s38, s38, 16384
    buffer_load_dwordx4 v6, s[8:11], s38 offen lds
    s_waitcnt vmcnt(28)
    ds_read_b64_tr_b16 a[232:233], v7 offset:26624
    ds_read_b64_tr_b16 a[234:235], v7 offset:27648
    ds_read_b64_tr_b16 a[236:237], v7 offset:26688
    ds_read_b64_tr_b16 a[238:239], v7 offset:27712
    s_waitcnt lgkmcnt(4)
    s_add_u32 m0, s32, 24576
    s_add_u32 s38, s38, 16384
    buffer_load_dwordx4 v6, s[8:11], s38 offen lds
    s_add_u32 m0, s32, 25600
    s_add_u32 s38, s38, 16384
    buffer_load_dwordx4 v6, s[8:11], s38 offen lds
    s_waitcnt vmcnt(28)
    ds_read_b64_tr_b16 a[240:241], v7 offset:28672
    ds_read_b64_tr_b16 a[242:243], v7 offset:29696
    ds_read_b64_tr_b16 a[244:245], v7 offset:28736
    ds_read_b64_tr_b16 a[246:247], v7 offset:29760
    s_waitcnt lgkmcnt(4)
    s_add_u32 m0, s32, 26624
    s_add_u32 s38, s38, 16384
    buffer_load_dwordx4 v6, s[8:11], s38 offen lds
    s_add_u32 m0, s32, 27648
    s_add_u32 s38, s38, 16384
    buffer_load_dwordx4 v6, s[8:11], s38 offen lds
    s_waitcnt vmcnt(28)
    ds_read_b64_tr_b16 a[248:249], v7 offset:30720
    ds_read_b64_tr_b16 a[250:251], v7 offset:31744
    ds_read_b64_tr_b16 a[252:253], v7 offset:30784
    ds_read_b64_tr_b16 a[254:255], v7 offset:31808
    s_waitcnt lgkmcnt(4)
    s_add_u32 m0, s32, 28672
    s_add_u32 s38, s38, 16384
    buffer_load_dwordx4 v6, s[8:11], s38 offen lds
    s_add_u32 m0, s32, 29696
    s_add_u32 s38, s38, 16384
    buffer_load_dwordx4 v6, s[8:11], s38 offen lds
    s_waitcnt vmcnt(28)
    ds_read_b64_tr_b16 v[128:129], v7 offset:0
    ds_read_b64_tr_b16 v[130:131], v7 offset:1024
    ds_read_b64_tr_b16 v[132:133], v7 offset:64
    ds_read_b64_tr_b16 v[134:135], v7 offset:1088
    s_waitcnt lgkmcnt(4)
    s_add_u32 m0, s32, 30720
    s_add_u32 s38, s38, 16384
    buffer_load_dwordx4 v6, s[8:11], s38 offen lds
    s_add_u32 m0, s32, 31744
    s_add_u32 s38, s38, 16384
    buffer_load_dwordx4 v6, s[8:11], s38 offen lds
    s_waitcnt vmcnt(28)
    ds_read_b64_tr_b16 v[136:137], v7 offset:2048
    ds_read_b64_tr_b16 v[138:139], v7 offset:3072
    ds_read_b64_tr_b16 v[140:141], v7 offset:2112
    ds_read_b64_tr_b16 v[142:143], v7 offset:3136
    s_waitcnt lgkmcnt(4)
    s_add_u32 m0, s32, 0
    s_add_u32 s38, s38, 16384
    buffer_load_dwordx4 v6, s[8:11], s38 offen lds
    s_add_u32 m0, s32, 1024
    s_add_u32 s38, s38, 16384
    buffer_load_dwordx4 v6, s[8:11], s38 offen lds
    s_waitcnt vmcnt(28)
    ds_read_b64_tr_b16 v[144:145], v7 offset:4096
    ds_read_b64_tr_b16 v[146:147], v7 offset:5120
    ds_read_b64_tr_b16 v[148:149], v7 offset:4160
    ds_read_b64_tr_b16 v[150:151], v7 offset:5184
    s_waitcnt lgkmcnt(4)
    s_add_u32 m0, s32, 2048
    s_add_u32 s38, s38, 16384
    buffer_load_dwordx4 v6, s[8:11], s38 offen lds
    s_add_u32 m0, s32, 3072
    s_add_u32 s38, s38, 16384
    buffer_load_dwordx4 v6, s[8:11], s38 offen lds
    s_waitcnt vmcnt(28)
    ds_read_b64_tr_b16 v[152:153], v7 offset:6144
    ds_read_b64_tr_b16 v[154:155], v7 offset:7168
    ds_read_b64_tr_b16 v[156:157], v7 offset:6208
    ds_read_b64_tr_b16 v[158:159], v7 offset:7232
    s_waitcnt lgkmcnt(4)
    s_add_u32 m0, s32, 4096
    s_add_u32 s38, s38, 16384
    buffer_load_dwordx4 v6, s[8:11], s38 offen lds
    s_add_u32 m0, s32, 5120
    s_add_u32 s38, s38, 16384
    buffer_load_dwordx4 v6, s[8:11], s38 offen lds
    s_waitcnt vmcnt(28)
    ds_read_b64_tr_b16 v[160:161], v7 offset:8192
    ds_read_b64_tr_b16 v[162:163], v7 offset:9216
    ds_read_b64_tr_b16 v[164:165], v7 offset:8256
    ds_read_b64_tr_b16 v[166:167], v7 offset:9280
    s_waitcnt lgkmcnt(4)
    s_add_u32 m0, s32, 6144
    s_add_u32 s38, s38, 16384
    buffer_load_dwordx4 v6, s[8:11], s38 offen lds
    s_add_u32 m0, s32, 7168
    s_add_u32 s38, s38, 16384
    buffer_load_dwordx4 v6, s[8:11], s38 offen lds
    s_waitcnt vmcnt(28)
    ds_read_b64_tr_b16 v[168:169], v7 offset:10240
    ds_read_b64_tr_b16 v[170:171], v7 offset:11264
    ds_read_b64_tr_b16 v[172:173], v7 offset:10304
    ds_read_b64_tr_b16 v[174:175], v7 offset:11328
    s_waitcnt lgkmcnt(4)
    s_add_u32 m0, s32, 8192
    s_add_u32 s38, s38, 16384
    buffer_load_dwordx4 v6, s[8:11], s38 offen lds
    s_add_u32 m0, s32, 9216
    s_add_u32 s38, s38, 16384
    buffer_load_dwordx4 v6, s[8:11], s38 offen lds
    s_waitcnt vmcnt(28)
    ds_read_b64_tr_b16 v[176:177], v7 offset:12288
    ds_read_b64_tr_b16 v[178:179], v7 offset:13312
    ds_read_b64_tr_b16 v[180:181], v7 offset:12352
    ds_read_b64_tr_b16 v[182:183], v7 offset:13376
    s_waitcnt lgkmcnt(4)
    s_add_u32 m0, s32, 10240
    s_add_u32 s38, s38, 16384
    buffer_load_dwordx4 v6, s[8:11], s38 offen lds
    s_add_u32 m0, s32, 11264
    s_add_u32 s38, s38, 16384
    buffer_load_dwordx4 v6, s[8:11], s38 offen lds
    s_waitcnt vmcnt(28)
    ds_read_b64_tr_b16 v[184:185], v7 offset:14336
    ds_read_b64_tr_b16 v[186:187], v7 offset:15360
    ds_read_b64_tr_b16 v[188:189], v7 offset:14400
    ds_read_b64_tr_b16 v[190:191], v7 offset:15424
    s_waitcnt lgkmcnt(4)
    s_add_u32 m0, s32, 12288
    s_add_u32 s38, s38, 16384
    buffer_load_dwordx4 v6, s[8:11], s38 offen lds
    s_add_u32 m0, s32, 13312
    s_add_u32 s38, s38, 16384
    buffer_load_dwordx4 v6, s[8:11], s38 offen lds
    s_waitcnt vmcnt(28)
    ds_read_b64_tr_b16 v[192:193], v7 offset:16384
    ds_read_b64_tr_b16 v[194:195], v7 offset:17408
    ds_read_b64_tr_b16 v[196:197], v7 offset:16448
    ds_read_b64_tr_b16 v[198:199], v7 offset:17472
    s_waitcnt lgkmcnt(4)
    s_add_u32 m0, s32, 14336
    s_add_u32 s38, s38, 16384
    buffer_load_dwordx4 v6, s[8:11], s38 offen lds
    s_add_u32 m0, s32, 15360
    s_add_u32 s38, s38, 16384
    buffer_load_dwordx4 v6, s[8:11], s38 offen lds
    s_waitcnt vmcnt(28)
    ds_read_b64_tr_b16 v[200:201], v7 offset:18432
    ds_read_b64_tr_b16 v[202:203], v7 offset:19456
    ds_read_b64_tr_b16 v[204:205], v7 offset:18496
    ds_read_b64_tr_b16 v[206:207], v7 offset:19520
    s_waitcnt lgkmcnt(4)
    s_add_u32 m0, s32, 16384
    s_add_u32 s38, s38, 16384
    buffer_load_dwordx4 v6, s[8:11], s38 offen lds
    s_add_u32 m0, s32, 17408
    s_add_u32 s38, s38, 16384
    buffer_load_dwordx4 v6, s[8:11], s38 offen lds
    s_waitcnt vmcnt(28)
    ds_read_b64_tr_b16 v[208:209], v7 offset:20480
    ds_read_b64_tr_b16 v[210:211], v7 offset:21504
    ds_read_b64_tr_b16 v[212:213], v7 offset:20544
    ds_read_b64_tr_b16 v[214:215], v7 offset:21568
    s_waitcnt lgkmcnt(4)
    s_add_u32 m0, s32, 18432
    s_add_u32 s38, s38, 16384
    buffer_load_dwordx4 v6, s[8:11], s38 offen lds
    s_add_u32 m0, s32, 19456
    s_add_u32 s38, s38, 16384
    buffer_load_dwordx4 v6, s[8:11], s38 offen lds
    s_waitcnt vmcnt(28)
    ds_read_b64_tr_b16 v[216:217], v7 offset:22528
    ds_read_b64_tr_b16 v[218:219], v7 offset:23552
    ds_read_b64_tr_b16 v[220:221], v7 offset:22592
    ds_read_b64_tr_b16 v[222:223], v7 offset:23616
    s_waitcnt lgkmcnt(4)
    s_add_u32 m0, s32, 20480
    s_add_u32 s38, s38, 16384
    buffer_load_dwordx4 v6, s[8:11], s38 offen lds
    s_add_u32 m0, s32, 21504
    s_add_u32 s38, s38, 16384
    buffer_load_dwordx4 v6, s[8:11], s38 offen lds
    s_waitcnt vmcnt(28)
    ds_read_b64_tr_b16 v[224:225], v7 offset:24576
    ds_read_b64_tr_b16 v[226:227], v7 offset:25600
    ds_read_b64_tr_b16 v[228:229], v7 offset:24640
    ds_read_b64_tr_b16 v[230:231], v7 offset:25664
    s_waitcnt lgkmcnt(4)
    s_add_u32 m0, s32, 22528
    s_add_u32 s38, s38, 16384
    buffer_load_dwordx4 v6, s[8:11], s38 offen lds
    s_add_u32 m0, s32, 23552
    s_add_u32 s38, s38, 16384
    buffer_load_dwordx4 v6, s[8:11], s38 offen lds
    s_waitcnt vmcnt(28)
    ds_read_b64_tr_b16 v[232:233], v7 offset:26624
    ds_read_b64_tr_b16 v[234:235], v7 offset:27648
    ds_read_b64_tr_b16 v[236:237], v7 offset:26688
    ds_read_b64_tr_b16 v[238:239], v7 offset:27712
    s_waitcnt lgkmcnt(4)
    s_add_u32 m0, s32, 24576
    s_add_u32 s38, s38, 16384
    buffer_load_dwordx4 v6, s[8:11], s38 offen lds
    s_add_u32 m0, s32, 25600
    s_add_u32 s38, s38, 16384
    buffer_load_dwordx4 v6, s[8:11], s38 offen lds
    s_waitcnt vmcnt(28)
    ds_read_b64_tr_b16 v[240:241], v7 offset:28672
    ds_read_b64_tr_b16 v[242:243], v7 offset:29696
    ds_read_b64_tr_b16 v[244:245], v7 offset:28736
    ds_read_b64_tr_b16 v[246:247], v7 offset:29760
    s_waitcnt lgkmcnt(4)
    s_add_u32 m0, s32, 26624
    s_add_u32 s38, s38, 16384
    buffer_load_dwordx4 v6, s[8:11], s38 offen lds
    s_add_u32 m0, s32, 27648
    s_add_u32 s38, s38, 16384
    buffer_load_dwordx4 v6, s[8:11], s38 offen lds
    s_waitcnt vmcnt(28)
    ds_read_b64_tr_b16 v[248:249], v7 offset:30720
    ds_read_b64_tr_b16 v[250:251], v7 offset:31744
    ds_read_b64_tr_b16 v[252:253], v7 offset:30784
    ds_read_b64_tr_b16 v[254:255], v7 offset:31808
    s_waitcnt lgkmcnt(4)
    s_add_u32 m0, s32, 28672
    s_add_u32 s38, s38, 16384
    buffer_load_dwordx4 v6, s[8:11], s38 offen lds
    s_add_u32 m0, s32, 29696
    s_add_u32 s38, s38, 16384
    buffer_load_dwordx4 v6, s[8:11], s38 offen lds
    s_waitcnt vmcnt(28)
    s_waitcnt lgkmcnt(0)
    s_add_u32 m0, s32, 30720
    s_add_u32 s38, s38, 16384
    buffer_load_dwordx4 v6, s[8:11], s38 offen lds
    s_add_u32 m0, s32, 31744
    s_add_u32 s38, s38, 16384
    buffer_load_dwordx4 v6, s[8:11], s38 offen lds
    s_waitcnt vmcnt(28)
    s_waitcnt vmcnt(26)
    s_waitcnt vmcnt(24)
    s_waitcnt vmcnt(22)
    s_waitcnt vmcnt(20)
    s_waitcnt vmcnt(18)
    s_waitcnt vmcnt(16)
    s_waitcnt vmcnt(14)
    s_waitcnt vmcnt(12)
    s_waitcnt vmcnt(10)
    s_waitcnt vmcnt(8)
    s_waitcnt vmcnt(6)
    s_waitcnt vmcnt(4)
    s_waitcnt vmcnt(2)
    s_waitcnt vmcnt(0)
    s_waitcnt lgkmcnt(0)
    s_lshl_b32 s31, s29, 16
    v_add_u32 v8, s31, v5
    s_lshl_b32 s31, s29, 13
    s_add_u32 s31, s31, 131072
    v_add_u32 v9, s31, v5
    s_lshl_b32 s31, s29, 7
    s_add_u32 s31, s31, 131072
    v_bfe_u32 v10, v1, 1, 2
    v_lshlrev_b32 v10, 10, v10
    v_and_b32 v4, 1, v1
    v_lshl_add_u32 v10, v4, 9, v10
    v_lshrrev_b32 v4, 3, v1
    v_lshl_add_u32 v10, v4, 4, v10
    v_add_u32 v10, s31, v10
    s_lshl_b32 s31, s29, 15
    s_lshl_b32 s33, s44, 7
    s_add_u32 s31, s31, s33
    v_lshrrev_b32 v11, 3, v1
    v_lshlrev_b32 v11, 12, v11
    v_and_b32 v4, 7, v1
    v_lshl_add_u32 v11, v4, 3, v11
    v_add_u32 v11, s31, v11
    v_and_b32 v12, 31, v1
    v_lshlrev_b32 v12, 7, v12
    v_add_u32 v12, 115343360, v12
    s_lshl_b32 s31, s29, 16
    s_and_b32 s33, s44, 7
    s_lshl_b32 s33, s33, 13
    s_add_u32 s31, s31, s33
    v_lshl_add_u32 v14, v1, 7, s31
    s_cmp_lg_u32 s29, 0
    s_cbranch_scc1 g_wdd_93
g_wd_92:
    s_load_dword s72, s[92:93], 0 glc
    s_add_u32 s41, s41, 1
    s_cmp_ge_u32 s41, 0x200000
    s_cbranch_scc1 g_wdd_93
    s_waitcnt lgkmcnt(0)
    s_cmp_ge_u32 s72, 352
    s_cbranch_scc1 g_wdd_93
    s_sleep 32
    s_branch g_wd_92
g_wdd_93:
    s_waitcnt lgkmcnt(0)
    s_barrier
o6_loop_94:
    s_lshl_b32 s47, s30, 18
    s_add_u32 s47, s47, 67108864
    s_and_b32 s52, s30, 63
    s_lshl_b32 s52, s52, 12
    s_add_u32 s52, s52, 32768
o6_w_96:
    buffer_load_dword v13, v12, s[4:7], s52 offen sc1
    s_add_u32 s41, s41, 1
    s_cmp_ge_u32 s41, 0x200000
    s_cbranch_scc1 o6_wd_97
    s_waitcnt vmcnt(0)
    v_cmp_eq_u32 vcc, 0, v13
    s_cbranch_vccz o6_wd_97
    s_sleep 10
    s_branch o6_w_96
o6_wd_97:
    buffer_load_dword v3, v14, s[4:7], s47 offen sc1
    s_add_u32 s31, s47, 0
    buffer_load_dwordx4 v[64:67], v8, s[4:7], s31 offen sc1
    s_add_u32 s31, s47, 1024
    buffer_load_dwordx4 v[68:71], v8, s[4:7], s31 offen sc1
    s_add_u32 s31, s47, 2048
    buffer_load_dwordx4 v[72:75], v8, s[4:7], s31 offen sc1
    s_add_u32 s31, s47, 49152
    buffer_load_dwordx4 v[76:79], v8, s[4:7], s31 offen sc1
    s_add_u32 s31, s47, 3072
    buffer_load_dwordx4 v[80:83], v8, s[4:7], s31 offen sc1
    s_add_u32 s31, s47, 4096
    buffer_load_dwordx4 v[84:87], v8, s[4:7], s31 offen sc1
    s_add_u32 s31, s47, 5120
    buffer_load_dwordx4 v[88:91], v8, s[4:7], s31 offen sc1
    s_add_u32 s31, s47, 50176
    buffer_load_dwordx4 v[92:95], v8, s[4:7], s31 offen sc1
    s_add_u32 s31, s47, 6144
    buffer_load_dwordx4 v[96:99], v8, s[4:7], s31 offen sc1
    s_add_u32 s31, s47, 7168
    buffer_load_dwordx4 v[100:103], v8, s[4:7], s31 offen sc1
    s_add_u32 s31, s47, 8192
    buffer_load_dwordx4 v[104:107], v8, s[4:7], s31 offen sc1
    s_add_u32 s31, s47, 51200
    buffer_load_dwordx4 v[108:111], v8, s[4:7], s31 offen sc1
    s_add_u32 s31, s47, 9216
    buffer_load_dwordx4 v[112:115], v8, s[4:7], s31 offen sc1
    s_add_u32 s31, s47, 10240
    buffer_load_dwordx4 v[116:119], v8, s[4:7], s31 offen sc1
    s_add_u32 s31, s47, 11264
    buffer_load_dwordx4 v[120:123], v8, s[4:7], s31 offen sc1
o6_go_95:
    s_lshl_b32 s49, s30, 17
    s_add_u32 s35, s30, 5
    s_and_b32 s52, s35, 63
    s_lshl_b32 s52, s52, 12
    s_add_u32 s52, s52, 32768
    ds_read_b64_tr_b16 v[16:17], v7 offset:0
    ds_read_b64_tr_b16 v[18:19], v7 offset:1024
    ds_read_b64_tr_b16 v[20:21], v7 offset:64
    ds_read_b64_tr_b16 v[22:23], v7 offset:1088
    s_waitcnt vmcnt(14)
    v_mfma_f32_32x32x16_bf16 v[32:47], a[0:3], v[64:67], 0
    s_add_u32 s31, s47, 52224
    buffer_load_dwordx4 v[124:127], v8, s[4:7], s31 offen sc1
    v_mfma_f32_32x32x16_bf16 v[48:63], a[4:7], v[64:67], 0
    s_waitcnt vmcnt(14)
    v_mfma_f32_32x32x16_bf16 v[32:47], a[8:11], v[68:71], v[32:47]
    s_add_u32 s31, s47, 12288
    buffer_load_dwordx4 v[64:67], v8, s[4:7], s31 offen sc1
    v_mfma_f32_32x32x16_bf16 v[48:63], a[12:15], v[68:71], v[48:63]
    s_waitcnt vmcnt(14)
    v_mfma_f32_32x32x16_bf16 v[32:47], a[16:19], v[72:75], v[32:47]
    s_add_u32 s31, s47, 13312
    buffer_load_dwordx4 v[68:71], v8, s[4:7], s31 offen sc1
    v_mfma_f32_32x32x16_bf16 v[48:63], a[20:23], v[72:75], v[48:63]
    s_waitcnt vmcnt(14)
    s_waitcnt lgkmcnt(0)
    v_mfma_f32_32x32x16_bf16 v[32:47], v[16:19], v[76:79], v[32:47]
    s_add_u32 s31, s47, 14336
    buffer_load_dwordx4 v[72:75], v8, s[4:7], s31 offen sc1
    v_mfma_f32_32x32x16_bf16 v[48:63], v[20:23], v[76:79], v[48:63]
    ds_read_b64_tr_b16 v[24:25], v7 offset:2048
    ds_read_b64_tr_b16 v[26:27], v7 offset:3072
    ds_read_b64_tr_b16 v[28:29], v7 offset:2112
    ds_read_b64_tr_b16 v[30:31], v7 offset:3136
    s_waitcnt vmcnt(14)
    v_mfma_f32_32x32x16_bf16 v[32:47], a[24:27], v[80:83], v[32:47]
    s_add_u32 s31, s47, 53248
    buffer_load_dwordx4 v[76:79], v8, s[4:7], s31 offen sc1
    v_mfma_f32_32x32x16_bf16 v[48:63], a[28:31], v[80:83], v[48:63]
    s_waitcnt vmcnt(14)
    v_mfma_f32_32x32x16_bf16 v[32:47], a[32:35], v[84:87], v[32:47]
    s_add_u32 s31, s47, 15360
    buffer_load_dwordx4 v[80:83], v8, s[4:7], s31 offen sc1
    v_mfma_f32_32x32x16_bf16 v[48:63], a[36:39], v[84:87], v[48:63]
    s_waitcnt vmcnt(14)
    v_mfma_f32_32x32x16_bf16 v[32:47], a[40:43], v[88:91], v[32:47]
    s_add_u32 s31, s47, 16384
    buffer_load_dwordx4 v[84:87], v8, s[4:7], s31 offen sc1
    v_mfma_f32_32x32x16_bf16 v[48:63], a[44:47], v[88:91], v[48:63]
    s_waitcnt vmcnt(14)
    s_waitcnt lgkmcnt(0)
    v_mfma_f32_32x32x16_bf16 v[32:47], v[24:27], v[92:95], v[32:47]
    s_add_u32 s31, s47, 17408
    buffer_load_dwordx4 v[88:91], v8, s[4:7], s31 offen sc1
    v_mfma_f32_32x32x16_bf16 v[48:63], v[28:31], v[92:95], v[48:63]
    ds_read_b64_tr_b16 v[16:17], v7 offset:4096
    ds_read_b64_tr_b16 v[18:19], v7 offset:5120
    ds_read_b64_tr_b16 v[20:21], v7 offset:4160
    ds_read_b64_tr_b16 v[22:23], v7 offset:5184
    s_waitcnt vmcnt(14)
    v_mfma_f32_32x32x16_bf16 v[32:47], a[48:51], v[96:99], v[32:47]
    s_add_u32 s31, s47, 54272
    buffer_load_dwordx4 v[92:95], v8, s[4:7], s31 offen sc1
    v_mfma_f32_32x32x16_bf16 v[48:63], a[52:55], v[96:99], v[48:63]
    s_waitcnt vmcnt(14)
    v_mfma_f32_32x32x16_bf16 v[32:47], a[56:59], v[100:103], v[32:47]
    s_add_u32 s31, s47, 18432
    buffer_load_dwordx4 v[96:99], v8, s[4:7], s31 offen sc1
    v_mfma_f32_32x32x16_bf16 v[48:63], a[60:63], v[100:103], v[48:63]
    s_waitcnt vmcnt(14)
    v_mfma_f32_32x32x16_bf16 v[32:47], a[64:67], v[104:107], v[32:47]
    s_add_u32 s31, s47, 19456
    buffer_load_dwordx4 v[100:103], v8, s[4:7], s31 offen sc1
    v_mfma_f32_32x32x16_bf16 v[48:63], a[68:71], v[104:107], v[48:63]
    s_waitcnt vmcnt(14)
    s_waitcnt lgkmcnt(0)
    v_mfma_f32_32x32x16_bf16 v[32:47], v[16:19], v[108:111], v[32:47]
    s_add_u32 s31, s47, 20480
    buffer_load_dwordx4 v[104:107], v8, s[4:7], s31 offen sc1
    v_mfma_f32_32x32x16_bf16 v[48:63], v[20:23], v[108:111], v[48:63]
    ds_read_b64_tr_b16 v[24:25], v7 offset:6144
    ds_read_b64_tr_b16 v[26:27], v7 offset:7168
    ds_read_b64_tr_b16 v[28:29], v7 offset:6208
    ds_read_b64_tr_b16 v[30:31], v7 offset:7232
    s_waitcnt vmcnt(14)
    v_mfma_f32_32x32x16_bf16 v[32:47], a[72:75], v[112:115], v[32:47]
    s_add_u32 s31, s47, 55296
    buffer_load_dwordx4 v[108:111], v8, s[4:7], s31 offen sc1
    v_mfma_f32_32x32x16_bf16 v[48:63], a[76:79], v[112:115], v[48:63]
    s_waitcnt vmcnt(14)
    v_mfma_f32_32x32x16_bf16 v[32:47], a[80:83], v[116:119], v[32:47]
    s_add_u32 s31, s47, 21504
    buffer_load_dwordx4 v[112:115], v8, s[4:7], s31 offen sc1
    v_mfma_f32_32x32x16_bf16 v[48:63], a[84:87], v[116:119], v[48:63]
    s_waitcnt vmcnt(14)
    v_mfma_f32_32x32x16_bf16 v[32:47], a[88:91], v[120:123], v[32:47]
    s_add_u32 s31, s47, 22528
    buffer_load_dwordx4 v[116:119], v8, s[4:7], s31 offen sc1
    v_mfma_f32_32x32x16_bf16 v[48:63], a[92:95], v[120:123], v[48:63]
    s_waitcnt vmcnt(14)
    s_waitcnt lgkmcnt(0)
    v_mfma_f32_32x32x16_bf16 v[32:47], v[24:27], v[124:127], v[32:47]
    s_add_u32 s31, s47, 23552
    buffer_load_dwordx4 v[120:123], v8, s[4:7], s31 offen sc1
    v_mfma_f32_32x32x16_bf16 v[48:63], v[28:31], v[124:127], v[48:63]
    ds_read_b64_tr_b16 v[16:17], v7 offset:8192
    ds_read_b64_tr_b16 v[18:19], v7 offset:9216
    ds_read_b64_tr_b16 v[20:21], v7 offset:8256
    ds_read_b64_tr_b16 v[22:23], v7 offset:9280
    s_waitcnt vmcnt(14)
    v_mfma_f32_32x32x16_bf16 v[32:47], a[96:99], v[64:67], v[32:47]
    s_add_u32 s31, s47, 56320
    buffer_load_dwordx4 v[124:127], v8, s[4:7], s31 offen sc1
    v_mfma_f32_32x32x16_bf16 v[48:63], a[100:103], v[64:67], v[48:63]
    s_waitcnt vmcnt(14)
    v_mfma_f32_32x32x16_bf16 v[32:47], a[104:107], v[68:71], v[32:47]
    s_add_u32 s31, s47, 24576
    buffer_load_dwordx4 v[64:67], v8, s[4:7], s31 offen sc1
    v_mfma_f32_32x32x16_bf16 v[48:63], a[108:111], v[68:71], v[48:63]
    s_waitcnt vmcnt(14)
    v_mfma_f32_32x32x16_bf16 v[32:47], a[112:115], v[72:75], v[32:47]
    s_add_u32 s31, s47, 25600
    buffer_load_dwordx4 v[68:71], v8, s[4:7], s31 offen sc1
    v_mfma_f32_32x32x16_bf16 v[48:63], a[116:119], v[72:75], v[48:63]
    s_waitcnt vmcnt(14)
    s_waitcnt lgkmcnt(0)
    v_mfma_f32_32x32x16_bf16 v[32:47], v[16:19], v[76:79], v[32:47]
    s_add_u32 s31, s47, 26624
    buffer_load_dwordx4 v[72:75], v8, s[4:7], s31 offen sc1
    v_mfma_f32_32x32x16_bf16 v[48:63], v[20:23], v[76:79], v[48:63]
    ds_read_b64_tr_b16 v[24:25], v7 offset:10240
    ds_read_b64_tr_b16 v[26:27], v7 offset:11264
    ds_read_b64_tr_b16 v[28:29], v7 offset:10304
    ds_read_b64_tr_b16 v[30:31], v7 offset:11328
    s_waitcnt vmcnt(14)
    v_mfma_f32_32x32x16_bf16 v[32:47], a[120:123], v[80:83], v[32:47]
    s_add_u32 s31, s47, 57344
    buffer_load_dwordx4 v[76:79], v8, s[4:7], s31 offen sc1
    v_mfma_f32_32x32x16_bf16 v[48:63], a[124:127], v[80:83], v[48:63]
    s_waitcnt vmcnt(14)
    v_mfma_f32_32x32x16_bf16 v[32:47], a[128:131], v[84:87], v[32:47]
    s_add_u32 s31, s47, 27648
    buffer_load_dwordx4 v[80:83], v8, s[4:7], s31 offen sc1
    v_mfma_f32_32x32x16_bf16 v[48:63], a[132:135], v[84:87], v[48:63]
    s_waitcnt vmcnt(14)
    v_mfma_f32_32x32x16_bf16 v[32:47], a[136:139], v[88:91], v[32:47]
    s_add_u32 s31, s47, 28672
    buffer_load_dwordx4 v[84:87], v8, s[4:7], s31 offen sc1
    v_mfma_f32_32x32x16_bf16 v[48:63], a[140:143], v[88:91], v[48:63]
    s_waitcnt vmcnt(14)
    s_waitcnt lgkmcnt(0)
    v_mfma_f32_32x32x16_bf16 v[32:47], v[24:27], v[92:95], v[32:47]
    s_add_u32 s31, s47, 29696
    buffer_load_dwordx4 v[88:91], v8, s[4:7], s31 offen sc1
    v_mfma_f32_32x32x16_bf16 v[48:63], v[28:31], v[92:95], v[48:63]
    ds_read_b64_tr_b16 v[16:17], v7 offset:12288
    ds_read_b64_tr_b16 v[18:19], v7 offset:13312
    ds_read_b64_tr_b16 v[20:21], v7 offset:12352
    ds_read_b64_tr_b16 v[22:23], v7 offset:13376
    s_waitcnt vmcnt(14)
    v_mfma_f32_32x32x16_bf16 v[32:47], a[144:147], v[96:99], v[32:47]
    s_add_u32 s31, s47, 58368
    buffer_load_dwordx4 v[92:95], v8, s[4:7], s31 offen sc1
    buffer_load_dword v13, v12, s[4:7], s52 offen sc1
    v_mfma_f32_32x32x16_bf16 v[48:63], a[148:151], v[96:99], v[48:63]
    s_waitcnt vmcnt(15)
    v_mfma_f32_32x32x16_bf16 v[32:47], a[152:155], v[100:103], v[32:47]
    s_add_u32 s31, s47, 30720
    buffer_load_dwordx4 v[96:99], v8, s[4:7], s31 offen sc1
    v_mfma_f32_32x32x16_bf16 v[48:63], a[156:159], v[100:103], v[48:63]
    s_waitcnt vmcnt(15)
    v_mfma_f32_32x32x16_bf16 v[32:47], a[160:163], v[104:107], v[32:47]
    s_add_u32 s31, s47, 31744
    buffer_load_dwordx4 v[100:103], v8, s[4:7], s31 offen sc1
    v_mfma_f32_32x32x16_bf16 v[48:63], a[164:167], v[104:107], v[48:63]
    s_waitcnt vmcnt(15)
    s_waitcnt lgkmcnt(0)
    v_mfma_f32_32x32x16_bf16 v[32:47], v[16:19], v[108:111], v[32:47]
    s_add_u32 s31, s47, 32768
    buffer_load_dwordx4 v[104:107], v8, s[4:7], s31 offen sc1
    v_mfma_f32_32x32x16_bf16 v[48:63], v[20:23], v[108:111], v[48:63]
    ds_read_b64_tr_b16 v[24:25], v7 offset:14336
    ds_read_b64_tr_b16 v[26:27], v7 offset:15360
    ds_read_b64_tr_b16 v[28:29], v7 offset:14400
    ds_read_b64_tr_b16 v[30:31], v7 offset:15424
    s_waitcnt vmcnt(15)
    v_mfma_f32_32x32x16_bf16 v[32:47], a[168:171], v[112:115], v[32:47]
    s_add_u32 s31, s47, 59392
    buffer_load_dwordx4 v[108:111], v8, s[4:7], s31 offen sc1
    v_mfma_f32_32x32x16_bf16 v[48:63], a[172:175], v[112:115], v[48:63]
    s_waitcnt vmcnt(15)
    v_mfma_f32_32x32x16_bf16 v[32:47], a[176:179], v[116:119], v[32:47]
    s_add_u32 s31, s47, 33792
    buffer_load_dwordx4 v[112:115], v8, s[4:7], s31 offen sc1
    v_mfma_f32_32x32x16_bf16 v[48:63], a[180:183], v[116:119], v[48:63]
    s_waitcnt vmcnt(15)
    v_mfma_f32_32x32x16_bf16 v[32:47], a[184:187], v[120:123], v[32:47]
    s_add_u32 s31, s47, 34816
    buffer_load_dwordx4 v[116:119], v8, s[4:7], s31 offen sc1
    v_mfma_f32_32x32x16_bf16 v[48:63], a[188:191], v[120:123], v[48:63]
    s_waitcnt vmcnt(15)
    s_waitcnt lgkmcnt(0)
    v_mfma_f32_32x32x16_bf16 v[32:47], v[24:27], v[124:127], v[32:47]
    s_add_u32 s31, s47, 35840
    buffer_load_dwordx4 v[120:123], v8, s[4:7], s31 offen sc1
    v_mfma_f32_32x32x16_bf16 v[48:63], v[28:31], v[124:127], v[48:63]
    ds_read_b64_tr_b16 v[16:17], v7 offset:16384
    ds_read_b64_tr_b16 v[18:19], v7 offset:17408
    ds_read_b64_tr_b16 v[20:21], v7 offset:16448
    ds_read_b64_tr_b16 v[22:23], v7 offset:17472
    s_waitcnt vmcnt(15)
    v_mfma_f32_32x32x16_bf16 v[32:47], a[192:195], v[64:67], v[32:47]
    s_add_u32 s31, s47, 60416
    buffer_load_dwordx4 v[124:127], v8, s[4:7], s31 offen sc1
    v_mfma_f32_32x32x16_bf16 v[48:63], a[196:199], v[64:67], v[48:63]
    s_waitcnt vmcnt(15)
    v_mfma_f32_32x32x16_bf16 v[32:47], a[200:203], v[68:71], v[32:47]
    s_add_u32 s31, s47, 36864
    buffer_load_dwordx4 v[64:67], v8, s[4:7], s31 offen sc1
    v_mfma_f32_32x32x16_bf16 v[48:63], a[204:207], v[68:71], v[48:63]
    s_waitcnt vmcnt(15)
    v_mfma_f32_32x32x16_bf16 v[32:47], a[208:211], v[72:75], v[32:47]
    s_add_u32 s31, s47, 37888
    buffer_load_dwordx4 v[68:71], v8, s[4:7], s31 offen sc1
    v_mfma_f32_32x32x16_bf16 v[48:63], a[212:215], v[72:75], v[48:63]
    s_waitcnt vmcnt(15)
    s_waitcnt lgkmcnt(0)
    v_mfma_f32_32x32x16_bf16 v[32:47], v[16:19], v[76:79], v[32:47]
    s_add_u32 s31, s47, 38912
    buffer_load_dwordx4 v[72:75], v8, s[4:7], s31 offen sc1
    v_mfma_f32_32x32x16_bf16 v[48:63], v[20:23], v[76:79], v[48:63]
    ds_read_b64_tr_b16 v[24:25], v7 offset:18432
    ds_read_b64_tr_b16 v[26:27], v7 offset:19456
    ds_read_b64_tr_b16 v[28:29], v7 offset:18496
    ds_read_b64_tr_b16 v[30:31], v7 offset:19520
    s_waitcnt vmcnt(15)
    v_mfma_f32_32x32x16_bf16 v[32:47], a[216:219], v[80:83], v[32:47]
    s_add_u32 s31, s47, 61440
    buffer_load_dwordx4 v[76:79], v8, s[4:7], s31 offen sc1
    v_mfma_f32_32x32x16_bf16 v[48:63], a[220:223], v[80:83], v[48:63]
    s_waitcnt vmcnt(15)
    v_mfma_f32_32x32x16_bf16 v[32:47], a[224:227], v[84:87], v[32:47]
    s_add_u32 s31, s47, 39936
    buffer_load_dwordx4 v[80:83], v8, s[4:7], s31 offen sc1
    v_mfma_f32_32x32x16_bf16 v[48:63], a[228:231], v[84:87], v[48:63]
    s_waitcnt vmcnt(15)
    v_mfma_f32_32x32x16_bf16 v[32:47], a[232:235], v[88:91], v[32:47]
    s_add_u32 s31, s47, 40960
    buffer_load_dwordx4 v[84:87], v8, s[4:7], s31 offen sc1
    v_mfma_f32_32x32x16_bf16 v[48:63], a[236:239], v[88:91], v[48:63]
    s_waitcnt vmcnt(15)
    s_waitcnt lgkmcnt(0)
    v_mfma_f32_32x32x16_bf16 v[32:47], v[24:27], v[92:95], v[32:47]
    s_add_u32 s31, s47, 41984
    buffer_load_dwordx4 v[88:91], v8, s[4:7], s31 offen sc1
    v_mfma_f32_32x32x16_bf16 v[48:63], v[28:31], v[92:95], v[48:63]
    ds_read_b64_tr_b16 v[16:17], v7 offset:20480
    ds_read_b64_tr_b16 v[18:19], v7 offset:21504
    ds_read_b64_tr_b16 v[20:21], v7 offset:20544
    ds_read_b64_tr_b16 v[22:23], v7 offset:21568
    s_waitcnt vmcnt(14)
    v_mfma_f32_32x32x16_bf16 v[32:47], a[240:243], v[96:99], v[32:47]
    s_add_u32 s31, s47, 62464
    buffer_load_dwordx4 v[92:95], v8, s[4:7], s31 offen sc1
    v_mfma_f32_32x32x16_bf16 v[48:63], a[244:247], v[96:99], v[48:63]
    s_waitcnt vmcnt(14)
    v_mfma_f32_32x32x16_bf16 v[32:47], a[248:251], v[100:103], v[32:47]
    s_add_u32 s31, s47, 43008
    buffer_load_dwordx4 v[96:99], v8, s[4:7], s31 offen sc1
    v_mfma_f32_32x32x16_bf16 v[48:63], a[252:255], v[100:103], v[48:63]
    s_waitcnt vmcnt(14)
    v_mfma_f32_32x32x16_bf16 v[32:47], v[128:131], v[104:107], v[32:47]
    s_add_u32 s31, s47, 44032
    buffer_load_dwordx4 v[100:103], v8, s[4:7], s31 offen sc1
    v_mfma_f32_32x32x16_bf16 v[48:63], v[132:135], v[104:107], v[48:63]
    s_waitcnt vmcnt(14)
    s_waitcnt lgkmcnt(0)
    v_mfma_f32_32x32x16_bf16 v[32:47], v[16:19], v[108:111], v[32:47]
    s_add_u32 s31, s47, 45056
    buffer_load_dwordx4 v[104:107], v8, s[4:7], s31 offen sc1
    v_mfma_f32_32x32x16_bf16 v[48:63], v[20:23], v[108:111], v[48:63]
    ds_read_b64_tr_b16 v[24:25], v7 offset:22528
    ds_read_b64_tr_b16 v[26:27], v7 offset:23552
    ds_read_b64_tr_b16 v[28:29], v7 offset:22592
    ds_read_b64_tr_b16 v[30:31], v7 offset:23616
    s_waitcnt vmcnt(14)
    v_mfma_f32_32x32x16_bf16 v[32:47], v[136:139], v[112:115], v[32:47]
    s_add_u32 s31, s47, 63488
    buffer_load_dwordx4 v[108:111], v8, s[4:7], s31 offen sc1
    v_mfma_f32_32x32x16_bf16 v[48:63], v[140:143], v[112:115], v[48:63]
    s_waitcnt vmcnt(14)
    v_mfma_f32_32x32x16_bf16 v[32:47], v[144:147], v[116:119], v[32:47]
    s_add_u32 s31, s47, 46080
    buffer_load_dwordx4 v[112:115], v8, s[4:7], s31 offen sc1
    v_mfma_f32_32x32x16_bf16 v[48:63], v[148:151], v[116:119], v[48:63]
    s_waitcnt vmcnt(14)
    v_mfma_f32_32x32x16_bf16 v[32:47], v[152:155], v[120:123], v[32:47]
    s_add_u32 s31, s47, 47104
    buffer_load_dwordx4 v[116:119], v8, s[4:7], s31 offen sc1
    v_mfma_f32_32x32x16_bf16 v[48:63], v[156:159], v[120:123], v[48:63]
    s_waitcnt vmcnt(14)
    s_waitcnt lgkmcnt(0)
    v_mfma_f32_32x32x16_bf16 v[32:47], v[24:27], v[124:127], v[32:47]
    s_add_u32 s31, s47, 48128
    buffer_load_dwordx4 v[120:123], v8, s[4:7], s31 offen sc1
    v_mfma_f32_32x32x16_bf16 v[48:63], v[28:31], v[124:127], v[48:63]
    ds_read_b64_tr_b16 v[16:17], v7 offset:24576
    ds_read_b64_tr_b16 v[18:19], v7 offset:25600
    ds_read_b64_tr_b16 v[20:21], v7 offset:24640
    ds_read_b64_tr_b16 v[22:23], v7 offset:25664
    s_waitcnt vmcnt(14)
    v_mfma_f32_32x32x16_bf16 v[32:47], v[160:163], v[64:67], v[32:47]
    s_add_u32 s31, s47, 64512
    buffer_load_dwordx4 v[124:127], v8, s[4:7], s31 offen sc1
    v_mfma_f32_32x32x16_bf16 v[48:63], v[164:167], v[64:67], v[48:63]
    s_waitcnt vmcnt(14)
    v_mfma_f32_32x32x16_bf16 v[32:47], v[168:171], v[68:71], v[32:47]
    v_cmp_eq_u32 vcc, 0, v13
    s_lshl_b32 s46, s35, 18
    s_add_u32 s46, s46, 67108864
    s_cmp_eq_u64 vcc, 0
    s_cselect_b32 s51, 1, 0
    s_cmp_ge_u32 s35, 64
    s_cselect_b32 s51, 0, s51
    s_cmp_eq_u32 s51, 0
    s_cselect_b32 s46, s47, s46
    s_add_u32 s31, s46, 0
    buffer_load_dwordx4 v[64:67], v8, s[4:7], s31 offen sc1
    v_mfma_f32_32x32x16_bf16 v[48:63], v[172:175], v[68:71], v[48:63]
    s_waitcnt vmcnt(14)
    v_mfma_f32_32x32x16_bf16 v[32:47], v[176:179], v[72:75], v[32:47]
    s_add_u32 s31, s46, 1024
    buffer_load_dwordx4 v[68:71], v8, s[4:7], s31 offen sc1
    v_mfma_f32_32x32x16_bf16 v[48:63], v[180:183], v[72:75], v[48:63]
    s_waitcnt vmcnt(14)
    s_waitcnt lgkmcnt(0)
    v_mfma_f32_32x32x16_bf16 v[32:47], v[16:19], v[76:79], v[32:47]
    s_add_u32 s31, s46, 2048
    buffer_load_dwordx4 v[72:75], v8, s[4:7], s31 offen sc1
    v_mfma_f32_32x32x16_bf16 v[48:63], v[20:23], v[76:79], v[48:63]
    ds_read_b64_tr_b16 v[24:25], v7 offset:26624
    ds_read_b64_tr_b16 v[26:27], v7 offset:27648
    ds_read_b64_tr_b16 v[28:29], v7 offset:26688
    ds_read_b64_tr_b16 v[30:31], v7 offset:27712
    s_waitcnt vmcnt(14)
    v_mfma_f32_32x32x16_bf16 v[32:47], v[184:187], v[80:83], v[32:47]
    s_add_u32 s31, s46, 49152
    buffer_load_dwordx4 v[76:79], v8, s[4:7], s31 offen sc1
    v_mfma_f32_32x32x16_bf16 v[48:63], v[188:191], v[80:83], v[48:63]
    s_waitcnt vmcnt(14)
    v_mfma_f32_32x32x16_bf16 v[32:47], v[192:195], v[84:87], v[32:47]
    s_add_u32 s31, s46, 3072
    buffer_load_dwordx4 v[80:83], v8, s[4:7], s31 offen sc1
    v_mfma_f32_32x32x16_bf16 v[48:63], v[196:199], v[84:87], v[48:63]
    s_waitcnt vmcnt(14)
    v_mfma_f32_32x32x16_bf16 v[32:47], v[200:203], v[88:91], v[32:47]
    s_add_u32 s31, s46, 4096
    buffer_load_dwordx4 v[84:87], v8, s[4:7], s31 offen sc1
    v_mfma_f32_32x32x16_bf16 v[48:63], v[204:207], v[88:91], v[48:63]
    s_waitcnt vmcnt(14)
    s_waitcnt lgkmcnt(0)
    v_mfma_f32_32x32x16_bf16 v[32:47], v[24:27], v[92:95], v[32:47]
    s_add_u32 s31, s46, 5120
    buffer_load_dwordx4 v[88:91], v8, s[4:7], s31 offen sc1
    v_mfma_f32_32x32x16_bf16 v[48:63], v[28:31], v[92:95], v[48:63]
    ds_read_b64_tr_b16 v[16:17], v7 offset:28672
    ds_read_b64_tr_b16 v[18:19], v7 offset:29696
    ds_read_b64_tr_b16 v[20:21], v7 offset:28736
    ds_read_b64_tr_b16 v[22:23], v7 offset:29760
    s_waitcnt vmcnt(14)
    v_mfma_f32_32x32x16_bf16 v[32:47], v[208:211], v[96:99], v[32:47]
    s_add_u32 s31, s46, 50176
    buffer_load_dwordx4 v[92:95], v8, s[4:7], s31 offen sc1
    v_mfma_f32_32x32x16_bf16 v[48:63], v[212:215], v[96:99], v[48:63]
    s_waitcnt vmcnt(14)
    v_mfma_f32_32x32x16_bf16 v[32:47], v[216:219], v[100:103], v[32:47]
    s_add_u32 s31, s46, 6144
    buffer_load_dwordx4 v[96:99], v8, s[4:7], s31 offen sc1
    v_mfma_f32_32x32x16_bf16 v[48:63], v[220:223], v[100:103], v[48:63]
    s_waitcnt vmcnt(14)
    v_mfma_f32_32x32x16_bf16 v[32:47], v[224:227], v[104:107], v[32:47]
    s_add_u32 s31, s46, 7168
    buffer_load_dwordx4 v[100:103], v8, s[4:7], s31 offen sc1
    v_mfma_f32_32x32x16_bf16 v[48:63], v[228:231], v[104:107], v[48:63]
    s_waitcnt vmcnt(14)
    s_waitcnt lgkmcnt(0)
    v_mfma_f32_32x32x16_bf16 v[32:47], v[16:19], v[108:111], v[32:47]
    s_add_u32 s31, s46, 8192
    buffer_load_dwordx4 v[104:107], v8, s[4:7], s31 offen sc1
    v_mfma_f32_32x32x16_bf16 v[48:63], v[20:23], v[108:111], v[48:63]
    ds_read_b64_tr_b16 v[24:25], v7 offset:30720
    ds_read_b64_tr_b16 v[26:27], v7 offset:31744
    ds_read_b64_tr_b16 v[28:29], v7 offset:30784
    ds_read_b64_tr_b16 v[30:31], v7 offset:31808
    s_waitcnt vmcnt(14)
    v_mfma_f32_32x32x16_bf16 v[32:47], v[232:235], v[112:115], v[32:47]
    s_add_u32 s31, s46, 51200
    buffer_load_dwordx4 v[108:111], v8, s[4:7], s31 offen sc1
    v_mfma_f32_32x32x16_bf16 v[48:63], v[236:239], v[112:115], v[48:63]
    s_waitcnt vmcnt(14)
    v_mfma_f32_32x32x16_bf16 v[32:47], v[240:243], v[116:119], v[32:47]
    s_add_u32 s31, s46, 9216
    buffer_load_dwordx4 v[112:115], v8, s[4:7], s31 offen sc1
    v_mfma_f32_32x32x16_bf16 v[48:63], v[244:247], v[116:119], v[48:63]
    s_waitcnt vmcnt(14)
    v_mfma_f32_32x32x16_bf16 v[32:47], v[248:251], v[120:123], v[32:47]
    s_add_u32 s31, s46, 10240
    buffer_load_dwordx4 v[116:119], v8, s[4:7], s31 offen sc1
    v_mfma_f32_32x32x16_bf16 v[48:63], v[252:255], v[120:123], v[48:63]
    s_waitcnt vmcnt(14)
    s_waitcnt lgkmcnt(0)
    v_mfma_f32_32x32x16_bf16 v[32:47], v[24:27], v[124:127], v[32:47]
    s_add_u32 s31, s46, 11264
    buffer_load_dwordx4 v[120:123], v8, s[4:7], s31 offen sc1
    v_mfma_f32_32x32x16_bf16 v[48:63], v[28:31], v[124:127], v[48:63]
    s_barrier
    s_nop 7
    ds_write_b128 v9, v[32:35] offset:0
    ds_write_b128 v9, v[36:39] offset:1024
    ds_write_b128 v9, v[40:43] offset:2048
    ds_write_b128 v9, v[44:47] offset:3072
    ds_write_b128 v9, v[48:51] offset:4096
    ds_write_b128 v9, v[52:55] offset:5120
    ds_write_b128 v9, v[56:59] offset:6144
    ds_write_b128 v9, v[60:63] offset:7168
    s_waitcnt lgkmcnt(0)
    s_barrier
    ds_read_b128 v[32:35], v10 offset:0
    ds_read_b128 v[36:39], v10 offset:8192
    ds_read_b128 v[40:43], v10 offset:16384
    ds_read_b128 v[44:47], v10 offset:24576
    ds_read_b128 v[48:51], v10 offset:4096
    ds_read_b128 v[52:55], v10 offset:12288
    ds_read_b128 v[56:59], v10 offset:20480
    ds_read_b128 v[60:63], v10 offset:28672
    s_waitcnt lgkmcnt(4)
    v_pk_add_f32 v[32:33], v[32:33], v[36:37]
    v_pk_add_f32 v[34:35], v[34:35], v[38:39]
    v_pk_add_f32 v[40:41], v[40:41], v[44:45]
    v_pk_add_f32 v[42:43], v[42:43], v[46:47]
    v_pk_add_f32 v[32:33], v[32:33], v[40:41]
    v_pk_add_f32 v[34:35], v[34:35], v[42:43]
    v_cvt_pk_bf16_f32 v24, v32, v33
    v_cvt_pk_bf16_f32 v25, v34, v35
    buffer_store_dwordx2 v[24:25], v11, s[20:23], s49 offen offset:0
    s_waitcnt lgkmcnt(0)
    v_pk_add_f32 v[48:49], v[48:49], v[52:53]
    v_pk_add_f32 v[50:51], v[50:51], v[54:55]
    v_pk_add_f32 v[56:57], v[56:57], v[60:61]
    v_pk_add_f32 v[58:59], v[58:59], v[62:63]
    v_pk_add_f32 v[48:49], v[48:49], v[56:57]
    v_pk_add_f32 v[50:51], v[50:51], v[58:59]
    v_cvt_pk_bf16_f32 v26, v48, v49
    v_cvt_pk_bf16_f32 v27, v50, v51
    buffer_store_dwordx2 v[26:27], v11, s[20:23], s49 offen offset:64
    s_mov_b32 s30, s35
    s_mov_b32 s47, s46
    s_cmp_lg_u32 s51, 0
    s_cbranch_scc1 o6_go_95
    s_cmp_lt_u32 s30, 64
    s_cbranch_scc1 o6_loop_94
    s_branch L_dump
L_ob:
    s_load_dwordx4 s[72:75], s[0:1], 72
    s_add_u32 s76, s90, 83886080
    s_addc_u32 s77, s91, 0
    s_sub_u32 s32, s28, 96
    s_lshr_b32 s32, s32, 3
    s_mul_i32 s30, s32, 22
    s_add_u32 s51, s30, 22
    s_min_u32 s51, s51, 64
    s_sub_u32 s52, s51, 1
    s_lshl_b32 s52, s52, 16
    s_waitcnt lgkmcnt(0)
    s_mov_b32 s8, s72
    s_and_b32 s9, s73, 0xffff
    s_mov_b32 s10, 2097152
    s_mov_b32 s11, 0x00020000
    s_mov_b32 s20, s74
    s_and_b32 s21, s75, 0xffff
    s_mov_b32 s22, 8388608
    s_mov_b32 s23, 0x00020000
    s_mov_b32 s12, s76
    s_and_b32 s13, s77, 0xffff
    s_mov_b32 s14, 4194304
    s_mov_b32 s15, 0x00020000
    s_and_b32 s31, s28, 7
    s_lshl_b32 s31, s31, 8
    s_lshl_b32 s33, s29, 6
    s_add_u32 s31, s31, s33
    v_lshrrev_b32 v6, 2, v1
    v_lshlrev_b32 v6, 11, v6
    v_and_b32 v4, 3, v1
    v_lshl_add_u32 v6, v4, 4, v6
    v_add_u32 v6, s31, v6
    s_mov_b32 s39, 32768
    s_lshl_b32 s36, s30, 17
    s_and_b32 s33, s28, 7
    s_lshl_b32 s33, s33, 8
    s_add_u32 s36, s36, s33
    s_add_u32 s36, s36, 2048
    s_mov_b32 s37, 131072
    s_lshl_b32 s31, s29, 15
    v_lshrrev_b32 v7, 4, v1
    v_lshlrev_b32 v7, 9, v7
    v_bfe_u32 v4, v1, 2, 2
    v_lshl_add_u32 v7, v4, 6, v7
    v_and_b32 v4, 3, v1
    v_lshl_add_u32 v7, v4, 4, v7
    v_add_u32 v7, s31, v7
    s_lshl_b32 s32, s29, 15
    s_add_u32 m0, s32, 0
    s_mov_b32 s38, 0
    buffer_load_dwordx4 v6, s[8:11], s38 offen lds
    s_add_u32 m0, s32, 1024
    s_add_u32 s38, s38, s39
    buffer_load_dwordx4 v6, s[8:11], s38 offen lds
    s_add_u32 m0, s32, 2048
    s_add_u32 s38, s38, s39
    buffer_load_dwordx4 v6, s[8:11], s38 offen lds
    s_add_u32 m0, s32, 3072
    s_add_u32 s38, s38, s39
    buffer_load_dwordx4 v6, s[8:11], s38 offen lds
    s_add_u32 m0, s32, 4096
    s_add_u32 s38, s38, s39
    buffer_load_dwordx4 v6, s[8:11], s38 offen lds
    s_add_u32 m0, s32, 5120
    s_add_u32 s38, s38, s39
    buffer_load_dwordx4 v6, s[8:11], s38 offen lds
    s_add_u32 m0, s32, 6144
    s_add_u32 s38, s38, s39
    buffer_load_dwordx4 v6, s[8:11], s38 offen lds
    s_add_u32 m0, s32, 7168
    s_add_u32 s38, s38, s39
    buffer_load_dwordx4 v6, s[8:11], s38 offen lds
    s_add_u32 m0, s32, 8192
    s_add_u32 s38, s38, s39
    buffer_load_dwordx4 v6, s[8:11], s38 offen lds
    s_add_u32 m0, s32, 9216
    s_add_u32 s38, s38, s39
    buffer_load_dwordx4 v6, s[8:11], s38 offen lds
    s_add_u32 m0, s32, 10240
    s_add_u32 s38, s38, s39
    buffer_load_dwordx4 v6, s[8:11], s38 offen lds
    s_add_u32 m0, s32, 11264
    s_add_u32 s38, s38, s39
    buffer_load_dwordx4 v6, s[8:11], s38 offen lds
    s_add_u32 m0, s32, 12288
    s_add_u32 s38, s38, s39
    buffer_load_dwordx4 v6, s[8:11], s38 offen lds
    s_add_u32 m0, s32, 13312
    s_add_u32 s38, s38, s39
    buffer_load_dwordx4 v6, s[8:11], s38 offen lds
    s_add_u32 m0, s32, 14336
    s_add_u32 s38, s38, s39
    buffer_load_dwordx4 v6, s[8:11], s38 offen lds
    s_add_u32 m0, s32, 15360
    s_add_u32 s38, s38, s39
    buffer_load_dwordx4 v6, s[8:11], s38 offen lds
    s_add_u32 m0, s32, 16384
    s_add_u32 s38, s38, s39
    buffer_load_dwordx4 v6, s[8:11], s38 offen lds
    s_add_u32 m0, s32, 17408
    s_add_u32 s38, s38, s39
    buffer_load_dwordx4 v6, s[8:11], s38 offen lds
    s_add_u32 m0, s32, 18432
    s_add_u32 s38, s38, s39
    buffer_load_dwordx4 v6, s[8:11], s38 offen lds
    s_add_u32 m0, s32, 19456
    s_add_u32 s38, s38, s39
    buffer_load_dwordx4 v6, s[8:11], s38 offen lds
    s_add_u32 m0, s32, 20480
    s_add_u32 s38, s38, s39
    buffer_load_dwordx4 v6, s[8:11], s38 offen lds
    s_add_u32 m0, s32, 21504
    s_add_u32 s38, s38, s39
    buffer_load_dwordx4 v6, s[8:11], s38 offen lds
    s_add_u32 m0, s32, 22528
    s_add_u32 s38, s38, s39
    buffer_load_dwordx4 v6, s[8:11], s38 offen lds
    s_add_u32 m0, s32, 23552
    s_add_u32 s38, s38, s39
    buffer_load_dwordx4 v6, s[8:11], s38 offen lds
    s_add_u32 m0, s32, 24576
    s_add_u32 s38, s38, s39
    buffer_load_dwordx4 v6, s[8:11], s38 offen lds
    s_add_u32 m0, s32, 25600
    s_add_u32 s38, s38, s39
    buffer_load_dwordx4 v6, s[8:11], s38 offen lds
    s_add_u32 m0, s32, 26624
    s_add_u32 s38, s38, s39
    buffer_load_dwordx4 v6, s[8:11], s38 offen lds
    s_add_u32 m0, s32, 27648
    s_add_u32 s38, s38, s39
    buffer_load_dwordx4 v6, s[8:11], s38 offen lds
    s_add_u32 m0, s32, 28672
    s_add_u32 s38, s38, s39
    buffer_load_dwordx4 v6, s[8:11], s38 offen lds
    s_add_u32 m0, s32, 29696
    s_add_u32 s38, s38, s39
    buffer_load_dwordx4 v6, s[8:11], s38 offen lds
    s_add_u32 m0, s32, 30720
    s_add_u32 s38, s38, s39
    buffer_load_dwordx4 v6, s[8:11], s38 offen lds
    s_add_u32 m0, s32, 31744
    s_add_u32 s38, s38, s39
    buffer_load_dwordx4 v6, s[8:11], s38 offen lds
    s_waitcnt vmcnt(30)
    ds_read_b64_tr_b16 a[0:1], v7 offset:0
    ds_read_b64_tr_b16 a[2:3], v7 offset:256
    ds_read_b64_tr_b16 a[4:5], v7 offset:8
    ds_read_b64_tr_b16 a[6:7], v7 offset:264
    s_waitcnt vmcnt(28)
    ds_read_b64_tr_b16 a[8:9], v7 offset:2048
    ds_read_b64_tr_b16 a[10:11], v7 offset:2304
    ds_read_b64_tr_b16 a[12:13], v7 offset:2056
    ds_read_b64_tr_b16 a[14:15], v7 offset:2312
    s_waitcnt lgkmcnt(4)
    s_add_u32 m0, s32, 0
    s_add_u32 s38, s38, s39
    buffer_load_dwordx4 v6, s[8:11], s38 offen lds
    s_add_u32 m0, s32, 1024
    s_add_u32 s38, s38, s39
    buffer_load_dwordx4 v6, s[8:11], s38 offen lds
    s_waitcnt vmcnt(28)
    ds_read_b64_tr_b16 a[16:17], v7 offset:4096
    ds_read_b64_tr_b16 a[18:19], v7 offset:4352
    ds_read_b64_tr_b16 a[20:21], v7 offset:4104
    ds_read_b64_tr_b16 a[22:23], v7 offset:4360
    s_waitcnt lgkmcnt(4)
    s_add_u32 m0, s32, 2048
    s_add_u32 s38, s38, s39
    buffer_load_dwordx4 v6, s[8:11], s38 offen lds
    s_add_u32 m0, s32, 3072
    s_add_u32 s38, s38, s39
    buffer_load_dwordx4 v6, s[8:11], s38 offen lds
    s_waitcnt vmcnt(28)
    ds_read_b64_tr_b16 a[24:25], v7 offset:6144
    ds_read_b64_tr_b16 a[26:27], v7 offset:6400
    ds_read_b64_tr_b16 a[28:29], v7 offset:6152
    ds_read_b64_tr_b16 a[30:31], v7 offset:6408
    s_waitcnt lgkmcnt(4)
    s_add_u32 m0, s32, 4096
    s_add_u32 s38, s38, s39
    buffer_load_dwordx4 v6, s[8:11], s38 offen lds
    s_add_u32 m0, s32, 5120
    s_add_u32 s38, s38, s39
    buffer_load_dwordx4 v6, s[8:11], s38 offen lds
    s_waitcnt vmcnt(28)
    ds_read_b64_tr_b16 a[32:33], v7 offset:8192
    ds_read_b64_tr_b16 a[34:35], v7 offset:8448
    ds_read_b64_tr_b16 a[36:37], v7 offset:8200
    ds_read_b64_tr_b16 a[38:39], v7 offset:8456
    s_waitcnt lgkmcnt(4)
    s_add_u32 m0, s32, 6144
    s_add_u32 s38, s38, s39
    buffer_load_dwordx4 v6, s[8:11], s38 offen lds
    s_add_u32 m0, s32, 7168
    s_add_u32 s38, s38, s39
    buffer_load_dwordx4 v6, s[8:11], s38 offen lds
    s_waitcnt vmcnt(28)
    ds_read_b64_tr_b16 a[40:41], v7 offset:10240
    ds_read_b64_tr_b16 a[42:43], v7 offset:10496
    ds_read_b64_tr_b16 a[44:45], v7 offset:10248
    ds_read_b64_tr_b16 a[46:47], v7 offset:10504
    s_waitcnt lgkmcnt(4)
    s_add_u32 m0, s32, 8192
    s_add_u32 s38, s38, s39
    buffer_load_dwordx4 v6, s[8:11], s38 offen lds
    s_add_u32 m0, s32, 9216
    s_add_u32 s38, s38, s39
    buffer_load_dwordx4 v6, s[8:11], s38 offen lds
    s_waitcnt vmcnt(28)
    ds_read_b64_tr_b16 a[48:49], v7 offset:12288
    ds_read_b64_tr_b16 a[50:51], v7 offset:12544
    ds_read_b64_tr_b16 a[52:53], v7 offset:12296
    ds_read_b64_tr_b16 a[54:55], v7 offset:12552
    s_waitcnt lgkmcnt(4)
    s_add_u32 m0, s32, 10240
    s_add_u32 s38, s38, s39
    buffer_load_dwordx4 v6, s[8:11], s38 offen lds
    s_add_u32 m0, s32, 11264
    s_add_u32 s38, s38, s39
    buffer_load_dwordx4 v6, s[8:11], s38 offen lds
    s_waitcnt vmcnt(28)
    ds_read_b64_tr_b16 a[56:57], v7 offset:14336
    ds_read_b64_tr_b16 a[58:59], v7 offset:14592
    ds_read_b64_tr_b16 a[60:61], v7 offset:14344
    ds_read_b64_tr_b16 a[62:63], v7 offset:14600
    s_waitcnt lgkmcnt(4)
    s_add_u32 m0, s32, 12288
    s_add_u32 s38, s38, s39
    buffer_load_dwordx4 v6, s[8:11], s38 offen lds
    s_add_u32 m0, s32, 13312
    s_add_u32 s38, s38, s39
    buffer_load_dwordx4 v6, s[8:11], s38 offen lds
    s_waitcnt vmcnt(28)
    ds_read_b64_tr_b16 a[64:65], v7 offset:16384
    ds_read_b64_tr_b16 a[66:67], v7 offset:16640
    ds_read_b64_tr_b16 a[68:69], v7 offset:16392
    ds_read_b64_tr_b16 a[70:71], v7 offset:16648
    s_waitcnt lgkmcnt(4)
    s_add_u32 m0, s32, 14336
    s_add_u32 s38, s38, s39
    buffer_load_dwordx4 v6, s[8:11], s38 offen lds
    s_add_u32 m0, s32, 15360
    s_add_u32 s38, s38, s39
    buffer_load_dwordx4 v6, s[8:11], s38 offen lds
    s_waitcnt vmcnt(28)
    ds_read_b64_tr_b16 a[72:73], v7 offset:18432
    ds_read_b64_tr_b16 a[74:75], v7 offset:18688
    ds_read_b64_tr_b16 a[76:77], v7 offset:18440
    ds_read_b64_tr_b16 a[78:79], v7 offset:18696
    s_waitcnt lgkmcnt(4)
    s_add_u32 m0, s32, 16384
    s_add_u32 s38, s38, s39
    buffer_load_dwordx4 v6, s[8:11], s38 offen lds
    s_add_u32 m0, s32, 17408
    s_add_u32 s38, s38, s39
    buffer_load_dwordx4 v6, s[8:11], s38 offen lds
    s_waitcnt vmcnt(28)
    ds_read_b64_tr_b16 a[80:81], v7 offset:20480
    ds_read_b64_tr_b16 a[82:83], v7 offset:20736
    ds_read_b64_tr_b16 a[84:85], v7 offset:20488
    ds_read_b64_tr_b16 a[86:87], v7 offset:20744
    s_waitcnt lgkmcnt(4)
    s_add_u32 m0, s32, 18432
    s_add_u32 s38, s38, s39
    buffer_load_dwordx4 v6, s[8:11], s38 offen lds
    s_add_u32 m0, s32, 19456
    s_add_u32 s38, s38, s39
    buffer_load_dwordx4 v6, s[8:11], s38 offen lds
    s_waitcnt vmcnt(28)
    ds_read_b64_tr_b16 a[88:89], v7 offset:22528
    ds_read_b64_tr_b16 a[90:91], v7 offset:22784
    ds_read_b64_tr_b16 a[92:93], v7 offset:22536
    ds_read_b64_tr_b16 a[94:95], v7 offset:22792
    s_waitcnt lgkmcnt(4)
    s_add_u32 m0, s32, 20480
    s_add_u32 s38, s38, s39
    buffer_load_dwordx4 v6, s[8:11], s38 offen lds
    s_add_u32 m0, s32, 21504
    s_add_u32 s38, s38, s39
    buffer_load_dwordx4 v6, s[8:11], s38 offen lds
    s_waitcnt vmcnt(28)
    ds_read_b64_tr_b16 a[96:97], v7 offset:24576
    ds_read_b64_tr_b16 a[98:99], v7 offset:24832
    ds_read_b64_tr_b16 a[100:101], v7 offset:24584
    ds_read_b64_tr_b16 a[102:103], v7 offset:24840
    s_waitcnt lgkmcnt(4)
    s_add_u32 m0, s32, 22528
    s_add_u32 s38, s38, s39
    buffer_load_dwordx4 v6, s[8:11], s38 offen lds
    s_add_u32 m0, s32, 23552
    s_add_u32 s38, s38, s39
    buffer_load_dwordx4 v6, s[8:11], s38 offen lds
    s_waitcnt vmcnt(28)
    ds_read_b64_tr_b16 a[104:105], v7 offset:26624
    ds_read_b64_tr_b16 a[106:107], v7 offset:26880
    ds_read_b64_tr_b16 a[108:109], v7 offset:26632
    ds_read_b64_tr_b16 a[110:111], v7 offset:26888
    s_waitcnt lgkmcnt(4)
    s_add_u32 m0, s32, 24576
    s_add_u32 s38, s38, s39
    buffer_load_dwordx4 v6, s[8:11], s38 offen lds
    s_add_u32 m0, s32, 25600
    s_add_u32 s38, s38, s39
    buffer_load_dwordx4 v6, s[8:11], s38 offen lds
    s_waitcnt vmcnt(28)
    ds_read_b64_tr_b16 a[112:113], v7 offset:28672
    ds_read_b64_tr_b16 a[114:115], v7 offset:28928
    ds_read_b64_tr_b16 a[116:117], v7 offset:28680
    ds_read_b64_tr_b16 a[118:119], v7 offset:28936
    s_waitcnt lgkmcnt(4)
    s_add_u32 m0, s32, 26624
    s_add_u32 s38, s38, s39
    buffer_load_dwordx4 v6, s[8:11], s38 offen lds
    s_add_u32 m0, s32, 27648
    s_add_u32 s38, s38, s39
    buffer_load_dwordx4 v6, s[8:11], s38 offen lds
    s_waitcnt vmcnt(28)
    ds_read_b64_tr_b16 a[120:121], v7 offset:30720
    ds_read_b64_tr_b16 a[122:123], v7 offset:30976
    ds_read_b64_tr_b16 a[124:125], v7 offset:30728
    ds_read_b64_tr_b16 a[126:127], v7 offset:30984
    s_waitcnt lgkmcnt(4)
    s_add_u32 m0, s32, 28672
    s_add_u32 s38, s38, s39
    buffer_load_dwordx4 v6, s[8:11], s38 offen lds
    s_add_u32 m0, s32, 29696
    s_add_u32 s38, s38, s39
    buffer_load_dwordx4 v6, s[8:11], s38 offen lds
    s_waitcnt vmcnt(28)
    ds_read_b64_tr_b16 a[128:129], v7 offset:0
    ds_read_b64_tr_b16 a[130:131], v7 offset:256
    ds_read_b64_tr_b16 a[132:133], v7 offset:8
    ds_read_b64_tr_b16 a[134:135], v7 offset:264
    s_waitcnt lgkmcnt(4)
    s_add_u32 m0, s32, 30720
    s_add_u32 s38, s38, s39
    buffer_load_dwordx4 v6, s[8:11], s38 offen lds
    s_add_u32 m0, s32, 31744
    s_add_u32 s38, s38, s39
    buffer_load_dwordx4 v6, s[8:11], s38 offen lds
    s_waitcnt vmcnt(28)
    ds_read_b64_tr_b16 a[136:137], v7 offset:2048
    ds_read_b64_tr_b16 a[138:139], v7 offset:2304
    ds_read_b64_tr_b16 a[140:141], v7 offset:2056
    ds_read_b64_tr_b16 a[142:143], v7 offset:2312
    s_waitcnt vmcnt(26)
    ds_read_b64_tr_b16 a[144:145], v7 offset:4096
    ds_read_b64_tr_b16 a[146:147], v7 offset:4352
    ds_read_b64_tr_b16 a[148:149], v7 offset:4104
    ds_read_b64_tr_b16 a[150:151], v7 offset:4360
    s_waitcnt vmcnt(24)
    ds_read_b64_tr_b16 a[152:153], v7 offset:6144
    ds_read_b64_tr_b16 a[154:155], v7 offset:6400
    ds_read_b64_tr_b16 a[156:157], v7 offset:6152
    ds_read_b64_tr_b16 a[158:159], v7 offset:6408
    s_waitcnt vmcnt(22)
    ds_read_b64_tr_b16 a[160:161], v7 offset:8192
    ds_read_b64_tr_b16 a[162:163], v7 offset:8448
    ds_read_b64_tr_b16 a[164:165], v7 offset:8200
    ds_read_b64_tr_b16 a[166:167], v7 offset:8456
    s_waitcnt vmcnt(20)
    ds_read_b64_tr_b16 a[168:169], v7 offset:10240
    ds_read_b64_tr_b16 a[170:171], v7 offset:10496
    ds_read_b64_tr_b16 a[172:173], v7 offset:10248
    ds_read_b64_tr_b16 a[174:175], v7 offset:10504
    s_waitcnt vmcnt(18)
    ds_read_b64_tr_b16 a[176:177], v7 offset:12288
    ds_read_b64_tr_b16 a[178:179], v7 offset:12544
    ds_read_b64_tr_b16 a[180:181], v7 offset:12296
    ds_read_b64_tr_b16 a[182:183], v7 offset:12552
    s_waitcnt vmcnt(16)
    ds_read_b64_tr_b16 a[184:185], v7 offset:14336
    ds_read_b64_tr_b16 a[186:187], v7 offset:14592
    ds_read_b64_tr_b16 a[188:189], v7 offset:14344
    ds_read_b64_tr_b16 a[190:191], v7 offset:14600
    s_waitcnt vmcnt(14)
    ds_read_b64_tr_b16 a[192:193], v7 offset:16384
    ds_read_b64_tr_b16 a[194:195], v7 offset:16640
    ds_read_b64_tr_b16 a[196:197], v7 offset:16392
    ds_read_b64_tr_b16 a[198:199], v7 offset:16648
    s_waitcnt vmcnt(12)
    ds_read_b64_tr_b16 a[200:201], v7 offset:18432
    ds_read_b64_tr_b16 a[202:203], v7 offset:18688
    ds_read_b64_tr_b16 a[204:205], v7 offset:18440
    ds_read_b64_tr_b16 a[206:207], v7 offset:18696
    s_waitcnt vmcnt(10)
    ds_read_b64_tr_b16 a[208:209], v7 offset:20480
    ds_read_b64_tr_b16 a[210:211], v7 offset:20736
    ds_read_b64_tr_b16 a[212:213], v7 offset:20488
    ds_read_b64_tr_b16 a[214:215], v7 offset:20744
    s_waitcnt vmcnt(8)
    ds_read_b64_tr_b16 a[216:217], v7 offset:22528
    ds_read_b64_tr_b16 a[218:219], v7 offset:22784
    ds_read_b64_tr_b16 a[220:221], v7 offset:22536
    ds_read_b64_tr_b16 a[222:223], v7 offset:22792
    s_waitcnt vmcnt(6)
    ds_read_b64_tr_b16 a[224:225], v7 offset:24576
    ds_read_b64_tr_b16 a[226:227], v7 offset:24832
    ds_read_b64_tr_b16 a[228:229], v7 offset:24584
    ds_read_b64_tr_b16 a[230:231], v7 offset:24840
    s_waitcnt vmcnt(4)
    ds_read_b64_tr_b16 a[232:233], v7 offset:26624
    ds_read_b64_tr_b16 a[234:235], v7 offset:26880
    ds_read_b64_tr_b16 a[236:237], v7 offset:26632
    ds_read_b64_tr_b16 a[238:239], v7 offset:26888
    s_waitcnt vmcnt(2)
    ds_read_b64_tr_b16 a[240:241], v7 offset:28672
    ds_read_b64_tr_b16 a[242:243], v7 offset:28928
    ds_read_b64_tr_b16 a[244:245], v7 offset:28680
    ds_read_b64_tr_b16 a[246:247], v7 offset:28936
    s_waitcnt vmcnt(0)
    ds_read_b64_tr_b16 a[248:249], v7 offset:30720
    ds_read_b64_tr_b16 a[250:251], v7 offset:30976
    ds_read_b64_tr_b16 a[252:253], v7 offset:30728
    ds_read_b64_tr_b16 a[254:255], v7 offset:30984
    s_waitcnt lgkmcnt(0)
    s_lshr_b32 s31, s29, 1
    s_and_b32 s31, s31, 1
    s_lshl_b32 s31, s31, 2
    v_lshrrev_b32 v2, 4, v1
    v_add_u32 v2, s31, v2
    v_and_b32 v3, 7, v1
    v_xor_b32 v2, v2, v3
    s_lshl_b32 s31, s29, 14
    v_lshrrev_b32 v8, 3, v1
    v_lshlrev_b32 v8, 11, v8
    v_add_u32 v8, s31, v8
    v_lshl_add_u32 v8, v2, 4, v8
    v_bfe_u32 v2, v1, 1, 3
    v_lshrrev_b32 v3, 4, v1
    v_xor_b32 v2, v2, v3
    v_bfe_u32 v3, v1, 3, 1
    v_lshlrev_b32 v3, 11, v3
    v_and_b32 v4, 7, v1
    v_lshl_add_u32 v3, v4, 7, v3
    v_xor_b32 v12, 0, v2
    v_lshl_add_u32 v12, v12, 4, v3
    v_add_u32 v14, 65536, v12
    v_xor_b32 v13, 4, v2
    v_lshl_add_u32 v13, v13, 4, v3
    v_add_u32 v15, 65536, v13
    s_lshl_b32 s31, s29, 6
    v_and_b32 v9, 15, v1
    v_lshlrev_b32 v9, 12, v9
    v_lshrrev_b32 v4, 4, v1
    v_lshl_add_u32 v9, v4, 4, v9
    v_add_u32 v9, s31, v9
    v_add_u32 v8, s34, v5
    v_lshrrev_b32 v12, 4, v1
    v_lshlrev_b32 v12, 9, v12
    v_and_b32 v4, 15, v1
    v_lshl_add_u32 v12, v4, 4, v12
    v_add_u32 v14, 65536, v12
    s_cmp_lg_u32 s29, 0
    s_cbranch_scc1 g_wdd_99
g_wd_98:
    s_load_dword s72, s[92:93], 0 glc
    s_add_u32 s41, s41, 1
    s_cmp_ge_u32 s41, 0x200000
    s_cbranch_scc1 g_wdd_99
    s_waitcnt lgkmcnt(0)
    s_cmp_ge_u32 s72, 352
    s_cbranch_scc1 g_wdd_99
    s_sleep 32
    s_branch g_wd_98
g_wdd_99:
    s_waitcnt lgkmcnt(0)
    s_barrier
    v_and_b32 v2, 31, v1
    v_lshlrev_b32 v2, 7, v2
    v_add_u32 v2, 115359744, v2
    s_cmp_lg_u32 s29, 0
    s_cbranch_scc1 g_wld_101
g_wl_100:
    buffer_load_dword v3, v2, s[4:7], 0 offen sc1
    s_add_u32 s41, s41, 1
    s_cmp_ge_u32 s41, 0x200000
    s_cbranch_scc1 g_wld_101
    s_waitcnt vmcnt(0)
    v_cmp_gt_u32 vcc, s51, v3
    s_cbranch_vccz g_wld_101
    s_sleep 8
    s_branch g_wl_100
g_wld_101:
    s_barrier
    s_lshl_b32 s35, s30, 16
    s_sub_u32 s36, s36, s37
    s_barrier
    s_add_u32 m0, s34, 0
    s_add_u32 s32, s35, 0
    buffer_load_dwordx4 v8, s[12:15], s32 offen sc1 lds
    s_add_u32 m0, s34, 4096
    s_add_u32 s32, s35, 4096
    buffer_load_dwordx4 v8, s[12:15], s32 offen sc1 lds
    s_add_u32 m0, s34, 8192
    s_add_u32 s32, s35, 8192
    buffer_load_dwordx4 v8, s[12:15], s32 offen sc1 lds
    s_add_u32 m0, s34, 12288
    s_add_u32 s32, s35, 12288
    buffer_load_dwordx4 v8, s[12:15], s32 offen sc1 lds
    s_add_u32 m0, s34, 16384
    s_add_u32 s32, s35, 16384
    buffer_load_dwordx4 v8, s[12:15], s32 offen sc1 lds
    s_add_u32 m0, s34, 20480
    s_add_u32 s32, s35, 20480
    buffer_load_dwordx4 v8, s[12:15], s32 offen sc1 lds
    s_add_u32 m0, s34, 24576
    s_add_u32 s32, s35, 24576
    buffer_load_dwordx4 v8, s[12:15], s32 offen sc1 lds
    s_add_u32 m0, s34, 28672
    s_add_u32 s32, s35, 28672
    buffer_load_dwordx4 v8, s[12:15], s32 offen sc1 lds
    s_add_u32 m0, s34, 32768
    s_add_u32 s32, s35, 32768
    buffer_load_dwordx4 v8, s[12:15], s32 offen sc1 lds
    s_add_u32 m0, s34, 36864
    s_add_u32 s32, s35, 36864
    buffer_load_dwordx4 v8, s[12:15], s32 offen sc1 lds
    s_add_u32 m0, s34, 40960
    s_add_u32 s32, s35, 40960
    buffer_load_dwordx4 v8, s[12:15], s32 offen sc1 lds
    s_add_u32 m0, s34, 45056
    s_add_u32 s32, s35, 45056
    buffer_load_dwordx4 v8, s[12:15], s32 offen sc1 lds
    s_add_u32 m0, s34, 49152
    s_add_u32 s32, s35, 49152
    buffer_load_dwordx4 v8, s[12:15], s32 offen sc1 lds
    s_add_u32 m0, s34, 53248
    s_add_u32 s32, s35, 53248
    buffer_load_dwordx4 v8, s[12:15], s32 offen sc1 lds
    s_add_u32 m0, s34, 57344
    s_add_u32 s32, s35, 57344
    buffer_load_dwordx4 v8, s[12:15], s32 offen sc1 lds
    s_add_u32 m0, s34, 61440
    s_add_u32 s32, s35, 61440
    buffer_load_dwordx4 v8, s[12:15], s32 offen sc1 lds
    s_add_u32 s35, s35, 65536
    s_add_u32 m0, s34, 65536
    s_add_u32 s32, s35, 0
    buffer_load_dwordx4 v8, s[12:15], s32 offen sc1 lds
    s_add_u32 m0, s34, 69632
    s_add_u32 s32, s35, 4096
    buffer_load_dwordx4 v8, s[12:15], s32 offen sc1 lds
    s_add_u32 m0, s34, 73728
    s_add_u32 s32, s35, 8192
    buffer_load_dwordx4 v8, s[12:15], s32 offen sc1 lds
    s_add_u32 m0, s34, 77824
    s_add_u32 s32, s35, 12288
    buffer_load_dwordx4 v8, s[12:15], s32 offen sc1 lds
    s_waitcnt vmcnt(12)
    s_barrier
    ds_read_b128 v[32:35], v12 offset:0
    ds_read_b128 v[36:39], v12 offset:256
    ds_read_b128 v[40:43], v12 offset:2048
    ds_read_b128 v[44:47], v12 offset:2304
    ds_read_b128 v[48:51], v12 offset:4096
    ds_read_b128 v[52:55], v12 offset:4352
    v_add_u32 v9, 2130706432, v9
sl_loop_104:
    s_waitcnt lgkmcnt(4)
    v_mfma_f32_16x16x32_bf16 v[64:67], a[0:3], v[32:35], 0
    ds_read_b128 v[56:59], v12 offset:6144
    v_mfma_f32_16x16x32_bf16 v[68:71], a[4:7], v[32:35], 0
    v_mfma_f32_16x16x32_bf16 v[72:75], a[0:3], v[36:39], 0
    ds_read_b128 v[60:63], v12 offset:6400
    s_add_u32 m0, s34, 81920
    s_add_u32 s32, s35, 16384
    v_mfma_f32_16x16x32_bf16 v[76:79], a[4:7], v[36:39], 0
    buffer_load_dwordx4 v8, s[12:15], s32 offen sc1 lds
    s_waitcnt lgkmcnt(4)
    v_mfma_f32_16x16x32_bf16 v[64:67], a[8:11], v[40:43], v[64:67]
    ds_read_b128 v[32:35], v12 offset:8192
    v_mfma_f32_16x16x32_bf16 v[68:71], a[12:15], v[40:43], v[68:71]
    v_mfma_f32_16x16x32_bf16 v[72:75], a[8:11], v[44:47], v[72:75]
    ds_read_b128 v[36:39], v12 offset:8448
    v_mfma_f32_16x16x32_bf16 v[76:79], a[12:15], v[44:47], v[76:79]
    s_waitcnt lgkmcnt(4)
    v_mfma_f32_16x16x32_bf16 v[64:67], a[16:19], v[48:51], v[64:67]
    ds_read_b128 v[40:43], v12 offset:10240
    v_mfma_f32_16x16x32_bf16 v[68:71], a[20:23], v[48:51], v[68:71]
    v_cvt_pk_bf16_f32 v96, v80, v81
    v_mfma_f32_16x16x32_bf16 v[72:75], a[16:19], v[52:55], v[72:75]
    ds_read_b128 v[44:47], v12 offset:10496
    s_add_u32 m0, s34, 86016
    s_add_u32 s32, s35, 20480
    v_mfma_f32_16x16x32_bf16 v[76:79], a[20:23], v[52:55], v[76:79]
    buffer_load_dwordx4 v8, s[12:15], s32 offen sc1 lds
    v_cvt_pk_bf16_f32 v97, v82, v83
    s_waitcnt lgkmcnt(4)
    v_mfma_f32_16x16x32_bf16 v[64:67], a[24:27], v[56:59], v[64:67]
    ds_read_b128 v[48:51], v12 offset:12288
    v_mfma_f32_16x16x32_bf16 v[68:71], a[28:31], v[56:59], v[68:71]
    v_cvt_pk_bf16_f32 v98, v84, v85
    v_mfma_f32_16x16x32_bf16 v[72:75], a[24:27], v[60:63], v[72:75]
    ds_read_b128 v[52:55], v12 offset:12544
    v_mfma_f32_16x16x32_bf16 v[76:79], a[28:31], v[60:63], v[76:79]
    v_cvt_pk_bf16_f32 v99, v86, v87
    s_waitcnt lgkmcnt(4)
    v_mfma_f32_16x16x32_bf16 v[64:67], a[32:35], v[32:35], v[64:67]
    ds_read_b128 v[56:59], v12 offset:14336
    v_mfma_f32_16x16x32_bf16 v[68:71], a[36:39], v[32:35], v[68:71]
    v_cvt_pk_bf16_f32 v100, v88, v89
    v_mfma_f32_16x16x32_bf16 v[72:75], a[32:35], v[36:39], v[72:75]
    ds_read_b128 v[60:63], v12 offset:14592
    s_add_u32 m0, s34, 90112
    s_add_u32 s32, s35, 24576
    v_mfma_f32_16x16x32_bf16 v[76:79], a[36:39], v[36:39], v[76:79]
    buffer_load_dwordx4 v8, s[12:15], s32 offen sc1 lds
    v_cvt_pk_bf16_f32 v101, v90, v91
    s_waitcnt lgkmcnt(4)
    v_mfma_f32_16x16x32_bf16 v[64:67], a[40:43], v[40:43], v[64:67]
    ds_read_b128 v[32:35], v12 offset:16384
    v_mfma_f32_16x16x32_bf16 v[68:71], a[44:47], v[40:43], v[68:71]
    v_cvt_pk_bf16_f32 v102, v92, v93
    v_mfma_f32_16x16x32_bf16 v[72:75], a[40:43], v[44:47], v[72:75]
    ds_read_b128 v[36:39], v12 offset:16640
    v_mfma_f32_16x16x32_bf16 v[76:79], a[44:47], v[44:47], v[76:79]
    v_cvt_pk_bf16_f32 v103, v94, v95
    buffer_store_dwordx4 v[96:99], v9, s[20:23], s36 offen
    s_add_u32 s31, s36, 65536
    s_waitcnt lgkmcnt(4)
    v_mfma_f32_16x16x32_bf16 v[64:67], a[48:51], v[48:51], v[64:67]
    ds_read_b128 v[40:43], v12 offset:18432
    v_mfma_f32_16x16x32_bf16 v[68:71], a[52:55], v[48:51], v[68:71]
    v_mfma_f32_16x16x32_bf16 v[72:75], a[48:51], v[52:55], v[72:75]
    ds_read_b128 v[44:47], v12 offset:18688
    s_add_u32 m0, s34, 94208
    s_add_u32 s32, s35, 28672
    v_mfma_f32_16x16x32_bf16 v[76:79], a[52:55], v[52:55], v[76:79]
    buffer_load_dwordx4 v8, s[12:15], s32 offen sc1 lds
    s_waitcnt lgkmcnt(4)
    v_mfma_f32_16x16x32_bf16 v[64:67], a[56:59], v[56:59], v[64:67]
    ds_read_b128 v[48:51], v12 offset:20480
    v_mfma_f32_16x16x32_bf16 v[68:71], a[60:63], v[56:59], v[68:71]
    v_mfma_f32_16x16x32_bf16 v[72:75], a[56:59], v[60:63], v[72:75]
    ds_read_b128 v[52:55], v12 offset:20736
    v_mfma_f32_16x16x32_bf16 v[76:79], a[60:63], v[60:63], v[76:79]
    buffer_store_dwordx4 v[100:103], v9, s[20:23], s31 offen
    s_add_u32 s36, s36, s37
    s_waitcnt vmcnt(8)
    s_barrier
    s_waitcnt lgkmcnt(4)
    v_mfma_f32_16x16x32_bf16 v[64:67], a[64:67], v[32:35], v[64:67]
    ds_read_b128 v[56:59], v12 offset:22528
    v_mfma_f32_16x16x32_bf16 v[68:71], a[68:71], v[32:35], v[68:71]
    v_mfma_f32_16x16x32_bf16 v[72:75], a[64:67], v[36:39], v[72:75]
    ds_read_b128 v[60:63], v12 offset:22784
    s_add_u32 m0, s34, 98304
    s_add_u32 s32, s35, 32768
    v_mfma_f32_16x16x32_bf16 v[76:79], a[68:71], v[36:39], v[76:79]
    buffer_load_dwordx4 v8, s[12:15], s32 offen sc1 lds
    s_waitcnt lgkmcnt(4)
    v_mfma_f32_16x16x32_bf16 v[64:67], a[72:75], v[40:43], v[64:67]
    ds_read_b128 v[32:35], v12 offset:24576
    v_mfma_f32_16x16x32_bf16 v[68:71], a[76:79], v[40:43], v[68:71]
    v_mfma_f32_16x16x32_bf16 v[72:75], a[72:75], v[44:47], v[72:75]
    ds_read_b128 v[36:39], v12 offset:24832
    v_mfma_f32_16x16x32_bf16 v[76:79], a[76:79], v[44:47], v[76:79]
    s_waitcnt lgkmcnt(4)
    v_mfma_f32_16x16x32_bf16 v[64:67], a[80:83], v[48:51], v[64:67]
    ds_read_b128 v[40:43], v12 offset:26624
    v_mfma_f32_16x16x32_bf16 v[68:71], a[84:87], v[48:51], v[68:71]
    v_and_b32 v9, 0xffffff, v9
    v_mfma_f32_16x16x32_bf16 v[72:75], a[80:83], v[52:55], v[72:75]
    ds_read_b128 v[44:47], v12 offset:26880
    s_add_u32 m0, s34, 102400
    s_add_u32 s32, s35, 36864
    v_mfma_f32_16x16x32_bf16 v[76:79], a[84:87], v[52:55], v[76:79]
    buffer_load_dwordx4 v8, s[12:15], s32 offen sc1 lds
    s_waitcnt lgkmcnt(4)
    v_mfma_f32_16x16x32_bf16 v[64:67], a[88:91], v[56:59], v[64:67]
    ds_read_b128 v[48:51], v12 offset:28672
    v_mfma_f32_16x16x32_bf16 v[68:71], a[92:95], v[56:59], v[68:71]
    v_mfma_f32_16x16x32_bf16 v[72:75], a[88:91], v[60:63], v[72:75]
    ds_read_b128 v[52:55], v12 offset:28928
    v_mfma_f32_16x16x32_bf16 v[76:79], a[92:95], v[60:63], v[76:79]
    s_waitcnt lgkmcnt(4)
    v_mfma_f32_16x16x32_bf16 v[64:67], a[96:99], v[32:35], v[64:67]
    ds_read_b128 v[56:59], v12 offset:30720
    v_mfma_f32_16x16x32_bf16 v[68:71], a[100:103], v[32:35], v[68:71]
    v_mfma_f32_16x16x32_bf16 v[72:75], a[96:99], v[36:39], v[72:75]
    ds_read_b128 v[60:63], v12 offset:30976
    s_add_u32 m0, s34, 106496
    s_add_u32 s32, s35, 40960
    v_mfma_f32_16x16x32_bf16 v[76:79], a[100:103], v[36:39], v[76:79]
    buffer_load_dwordx4 v8, s[12:15], s32 offen sc1 lds
    s_waitcnt lgkmcnt(4)
    v_mfma_f32_16x16x32_bf16 v[64:67], a[104:107], v[40:43], v[64:67]
    ds_read_b128 v[32:35], v12 offset:32768
    v_mfma_f32_16x16x32_bf16 v[68:71], a[108:111], v[40:43], v[68:71]
    v_mfma_f32_16x16x32_bf16 v[72:75], a[104:107], v[44:47], v[72:75]
    ds_read_b128 v[36:39], v12 offset:33024
    v_mfma_f32_16x16x32_bf16 v[76:79], a[108:111], v[44:47], v[76:79]
    s_waitcnt lgkmcnt(4)
    v_mfma_f32_16x16x32_bf16 v[64:67], a[112:115], v[48:51], v[64:67]
    ds_read_b128 v[40:43], v12 offset:34816
    v_mfma_f32_16x16x32_bf16 v[68:71], a[116:119], v[48:51], v[68:71]
    v_mfma_f32_16x16x32_bf16 v[72:75], a[112:115], v[52:55], v[72:75]
    ds_read_b128 v[44:47], v12 offset:35072
    s_add_u32 m0, s34, 110592
    s_add_u32 s32, s35, 45056
    v_mfma_f32_16x16x32_bf16 v[76:79], a[116:119], v[52:55], v[76:79]
    buffer_load_dwordx4 v8, s[12:15], s32 offen sc1 lds
    s_waitcnt lgkmcnt(4)
    v_mfma_f32_16x16x32_bf16 v[64:67], a[120:123], v[56:59], v[64:67]
    ds_read_b128 v[48:51], v12 offset:36864
    v_mfma_f32_16x16x32_bf16 v[68:71], a[124:127], v[56:59], v[68:71]
    v_mfma_f32_16x16x32_bf16 v[72:75], a[120:123], v[60:63], v[72:75]
    ds_read_b128 v[52:55], v12 offset:37120
    v_mfma_f32_16x16x32_bf16 v[76:79], a[124:127], v[60:63], v[76:79]
    s_waitcnt lgkmcnt(4)
    v_mfma_f32_16x16x32_bf16 v[64:67], a[128:131], v[32:35], v[64:67]
    ds_read_b128 v[56:59], v12 offset:38912
    v_mfma_f32_16x16x32_bf16 v[68:71], a[132:135], v[32:35], v[68:71]
    v_mfma_f32_16x16x32_bf16 v[72:75], a[128:131], v[36:39], v[72:75]
    ds_read_b128 v[60:63], v12 offset:39168
    s_add_u32 m0, s34, 114688
    s_add_u32 s32, s35, 49152
    v_mfma_f32_16x16x32_bf16 v[76:79], a[132:135], v[36:39], v[76:79]
    buffer_load_dwordx4 v8, s[12:15], s32 offen sc1 lds
    s_waitcnt lgkmcnt(4)
    v_mfma_f32_16x16x32_bf16 v[64:67], a[136:139], v[40:43], v[64:67]
    ds_read_b128 v[32:35], v12 offset:40960
    v_mfma_f32_16x16x32_bf16 v[68:71], a[140:143], v[40:43], v[68:71]
    v_mfma_f32_16x16x32_bf16 v[72:75], a[136:139], v[44:47], v[72:75]
    ds_read_b128 v[36:39], v12 offset:41216
    v_mfma_f32_16x16x32_bf16 v[76:79], a[140:143], v[44:47], v[76:79]
    s_waitcnt lgkmcnt(4)
    v_mfma_f32_16x16x32_bf16 v[64:67], a[144:147], v[48:51], v[64:67]
    ds_read_b128 v[40:43], v12 offset:43008
    v_mfma_f32_16x16x32_bf16 v[68:71], a[148:151], v[48:51], v[68:71]
    v_mfma_f32_16x16x32_bf16 v[72:75], a[144:147], v[52:55], v[72:75]
    ds_read_b128 v[44:47], v12 offset:43264
    s_add_u32 m0, s34, 118784
    s_add_u32 s32, s35, 53248
    v_mfma_f32_16x16x32_bf16 v[76:79], a[148:151], v[52:55], v[76:79]
    buffer_load_dwordx4 v8, s[12:15], s32 offen sc1 lds
    s_waitcnt lgkmcnt(4)
    v_mfma_f32_16x16x32_bf16 v[64:67], a[152:155], v[56:59], v[64:67]
    ds_read_b128 v[48:51], v12 offset:45056
    v_mfma_f32_16x16x32_bf16 v[68:71], a[156:159], v[56:59], v[68:71]
    v_mfma_f32_16x16x32_bf16 v[72:75], a[152:155], v[60:63], v[72:75]
    ds_read_b128 v[52:55], v12 offset:45312
    v_mfma_f32_16x16x32_bf16 v[76:79], a[156:159], v[60:63], v[76:79]
    s_waitcnt lgkmcnt(4)
    v_mfma_f32_16x16x32_bf16 v[64:67], a[160:163], v[32:35], v[64:67]
    ds_read_b128 v[56:59], v12 offset:47104
    v_mfma_f32_16x16x32_bf16 v[68:71], a[164:167], v[32:35], v[68:71]
    v_mfma_f32_16x16x32_bf16 v[72:75], a[160:163], v[36:39], v[72:75]
    ds_read_b128 v[60:63], v12 offset:47360
    s_add_u32 m0, s34, 122880
    s_add_u32 s32, s35, 57344
    v_mfma_f32_16x16x32_bf16 v[76:79], a[164:167], v[36:39], v[76:79]
    buffer_load_dwordx4 v8, s[12:15], s32 offen sc1 lds
    s_waitcnt lgkmcnt(4)
    v_mfma_f32_16x16x32_bf16 v[64:67], a[168:171], v[40:43], v[64:67]
    ds_read_b128 v[32:35], v12 offset:49152
    v_mfma_f32_16x16x32_bf16 v[68:71], a[172:175], v[40:43], v[68:71]
    v_mfma_f32_16x16x32_bf16 v[72:75], a[168:171], v[44:47], v[72:75]
    ds_read_b128 v[36:39], v12 offset:49408
    v_mfma_f32_16x16x32_bf16 v[76:79], a[172:175], v[44:47], v[76:79]
    s_waitcnt lgkmcnt(4)
    v_mfma_f32_16x16x32_bf16 v[64:67], a[176:179], v[48:51], v[64:67]
    ds_read_b128 v[40:43], v12 offset:51200
    v_mfma_f32_16x16x32_bf16 v[68:71], a[180:183], v[48:51], v[68:71]
    v_mfma_f32_16x16x32_bf16 v[72:75], a[176:179], v[52:55], v[72:75]
    ds_read_b128 v[44:47], v12 offset:51456
    s_add_u32 m0, s34, 126976
    s_add_u32 s32, s35, 61440
    v_mfma_f32_16x16x32_bf16 v[76:79], a[180:183], v[52:55], v[76:79]
    buffer_load_dwordx4 v8, s[12:15], s32 offen sc1 lds
    s_add_u32 s35, s35, 65536
    s_min_u32 s35, s35, s52
    s_waitcnt lgkmcnt(4)
    v_mfma_f32_16x16x32_bf16 v[64:67], a[184:187], v[56:59], v[64:67]
    ds_read_b128 v[48:51], v12 offset:53248
    v_mfma_f32_16x16x32_bf16 v[68:71], a[188:191], v[56:59], v[68:71]
    v_mfma_f32_16x16x32_bf16 v[72:75], a[184:187], v[60:63], v[72:75]
    ds_read_b128 v[52:55], v12 offset:53504
    v_mfma_f32_16x16x32_bf16 v[76:79], a[188:191], v[60:63], v[76:79]
    s_waitcnt vmcnt(8)
    s_barrier
    s_waitcnt lgkmcnt(4)
    v_mfma_f32_16x16x32_bf16 v[64:67], a[192:195], v[32:35], v[64:67]
    ds_read_b128 v[56:59], v12 offset:55296
    v_mfma_f32_16x16x32_bf16 v[68:71], a[196:199], v[32:35], v[68:71]
    v_mfma_f32_16x16x32_bf16 v[72:75], a[192:195], v[36:39], v[72:75]
    ds_read_b128 v[60:63], v12 offset:55552
    s_add_u32 m0, s34, 0
    s_add_u32 s32, s35, 0
    v_mfma_f32_16x16x32_bf16 v[76:79], a[196:199], v[36:39], v[76:79]
    buffer_load_dwordx4 v8, s[12:15], s32 offen sc1 lds
    s_waitcnt lgkmcnt(4)
    v_mfma_f32_16x16x32_bf16 v[64:67], a[200:203], v[40:43], v[64:67]
    ds_read_b128 v[32:35], v12 offset:57344
    v_mfma_f32_16x16x32_bf16 v[68:71], a[204:207], v[40:43], v[68:71]
    v_mfma_f32_16x16x32_bf16 v[72:75], a[200:203], v[44:47], v[72:75]
    ds_read_b128 v[36:39], v12 offset:57600
    v_mfma_f32_16x16x32_bf16 v[76:79], a[204:207], v[44:47], v[76:79]
    s_waitcnt lgkmcnt(4)
    v_mfma_f32_16x16x32_bf16 v[64:67], a[208:211], v[48:51], v[64:67]
    ds_read_b128 v[40:43], v12 offset:59392
    v_mfma_f32_16x16x32_bf16 v[68:71], a[212:215], v[48:51], v[68:71]
    v_mfma_f32_16x16x32_bf16 v[72:75], a[208:211], v[52:55], v[72:75]
    ds_read_b128 v[44:47], v12 offset:59648
    s_add_u32 m0, s34, 4096
    s_add_u32 s32, s35, 4096
    v_mfma_f32_16x16x32_bf16 v[76:79], a[212:215], v[52:55], v[76:79]
    buffer_load_dwordx4 v8, s[12:15], s32 offen sc1 lds
    s_waitcnt lgkmcnt(4)
    v_mfma_f32_16x16x32_bf16 v[64:67], a[216:219], v[56:59], v[64:67]
    ds_read_b128 v[48:51], v12 offset:61440
    v_mfma_f32_16x16x32_bf16 v[68:71], a[220:223], v[56:59], v[68:71]
    v_mfma_f32_16x16x32_bf16 v[72:75], a[216:219], v[60:63], v[72:75]
    ds_read_b128 v[52:55], v12 offset:61696
    v_mfma_f32_16x16x32_bf16 v[76:79], a[220:223], v[60:63], v[76:79]
    s_waitcnt lgkmcnt(4)
    v_mfma_f32_16x16x32_bf16 v[64:67], a[224:227], v[32:35], v[64:67]
    ds_read_b128 v[56:59], v12 offset:63488
    v_mfma_f32_16x16x32_bf16 v[68:71], a[228:231], v[32:35], v[68:71]
    v_mfma_f32_16x16x32_bf16 v[72:75], a[224:227], v[36:39], v[72:75]
    ds_read_b128 v[60:63], v12 offset:63744
    s_add_u32 m0, s34, 8192
    s_add_u32 s32, s35, 8192
    v_mfma_f32_16x16x32_bf16 v[76:79], a[228:231], v[36:39], v[76:79]
    buffer_load_dwordx4 v8, s[12:15], s32 offen sc1 lds
    s_waitcnt lgkmcnt(4)
    v_mfma_f32_16x16x32_bf16 v[64:67], a[232:235], v[40:43], v[64:67]
    ds_read_b128 v[32:35], v14 offset:0
    v_mfma_f32_16x16x32_bf16 v[68:71], a[236:239], v[40:43], v[68:71]
    v_mfma_f32_16x16x32_bf16 v[72:75], a[232:235], v[44:47], v[72:75]
    ds_read_b128 v[36:39], v14 offset:256
    v_mfma_f32_16x16x32_bf16 v[76:79], a[236:239], v[44:47], v[76:79]
    s_waitcnt lgkmcnt(4)
    v_mfma_f32_16x16x32_bf16 v[64:67], a[240:243], v[48:51], v[64:67]
    ds_read_b128 v[40:43], v14 offset:2048
    v_mfma_f32_16x16x32_bf16 v[68:71], a[244:247], v[48:51], v[68:71]
    v_mfma_f32_16x16x32_bf16 v[72:75], a[240:243], v[52:55], v[72:75]
    ds_read_b128 v[44:47], v14 offset:2304
    s_add_u32 m0, s34, 12288
    s_add_u32 s32, s35, 12288
    v_mfma_f32_16x16x32_bf16 v[76:79], a[244:247], v[52:55], v[76:79]
    buffer_load_dwordx4 v8, s[12:15], s32 offen sc1 lds
    s_waitcnt lgkmcnt(4)
    v_mfma_f32_16x16x32_bf16 v[64:67], a[248:251], v[56:59], v[64:67]
    ds_read_b128 v[48:51], v14 offset:4096
    v_mfma_f32_16x16x32_bf16 v[68:71], a[252:255], v[56:59], v[68:71]
    v_mfma_f32_16x16x32_bf16 v[72:75], a[248:251], v[60:63], v[72:75]
    ds_read_b128 v[52:55], v14 offset:4352
    v_mfma_f32_16x16x32_bf16 v[76:79], a[252:255], v[60:63], v[76:79]
    s_waitcnt lgkmcnt(4)
    v_mfma_f32_16x16x32_bf16 v[80:83], a[0:3], v[32:35], 0
    ds_read_b128 v[56:59], v14 offset:6144
    v_mfma_f32_16x16x32_bf16 v[84:87], a[4:7], v[32:35], 0
    v_mfma_f32_16x16x32_bf16 v[88:91], a[0:3], v[36:39], 0
    ds_read_b128 v[60:63], v14 offset:6400
    s_add_u32 m0, s34, 16384
    s_add_u32 s32, s35, 16384
    v_mfma_f32_16x16x32_bf16 v[92:95], a[4:7], v[36:39], 0
    buffer_load_dwordx4 v8, s[12:15], s32 offen sc1 lds
    s_waitcnt lgkmcnt(4)
    v_mfma_f32_16x16x32_bf16 v[80:83], a[8:11], v[40:43], v[80:83]
    ds_read_b128 v[32:35], v14 offset:8192
    v_mfma_f32_16x16x32_bf16 v[84:87], a[12:15], v[40:43], v[84:87]
    v_mfma_f32_16x16x32_bf16 v[88:91], a[8:11], v[44:47], v[88:91]
    ds_read_b128 v[36:39], v14 offset:8448
    v_mfma_f32_16x16x32_bf16 v[92:95], a[12:15], v[44:47], v[92:95]
    s_waitcnt lgkmcnt(4)
    v_mfma_f32_16x16x32_bf16 v[80:83], a[16:19], v[48:51], v[80:83]
    ds_read_b128 v[40:43], v14 offset:10240
    v_mfma_f32_16x16x32_bf16 v[84:87], a[20:23], v[48:51], v[84:87]
    v_cvt_pk_bf16_f32 v96, v64, v65
    v_mfma_f32_16x16x32_bf16 v[88:91], a[16:19], v[52:55], v[88:91]
    ds_read_b128 v[44:47], v14 offset:10496
    s_add_u32 m0, s34, 20480
    s_add_u32 s32, s35, 20480
    v_mfma_f32_16x16x32_bf16 v[92:95], a[20:23], v[52:55], v[92:95]
    buffer_load_dwordx4 v8, s[12:15], s32 offen sc1 lds
    v_cvt_pk_bf16_f32 v97, v66, v67
    s_waitcnt lgkmcnt(4)
    v_mfma_f32_16x16x32_bf16 v[80:83], a[24:27], v[56:59], v[80:83]
    ds_read_b128 v[48:51], v14 offset:12288
    v_mfma_f32_16x16x32_bf16 v[84:87], a[28:31], v[56:59], v[84:87]
    v_cvt_pk_bf16_f32 v98, v68, v69
    v_mfma_f32_16x16x32_bf16 v[88:91], a[24:27], v[60:63], v[88:91]
    ds_read_b128 v[52:55], v14 offset:12544
    v_mfma_f32_16x16x32_bf16 v[92:95], a[28:31], v[60:63], v[92:95]
    v_cvt_pk_bf16_f32 v99, v70, v71
    s_waitcnt lgkmcnt(4)
    v_mfma_f32_16x16x32_bf16 v[80:83], a[32:35], v[32:35], v[80:83]
    ds_read_b128 v[56:59], v14 offset:14336
    v_mfma_f32_16x16x32_bf16 v[84:87], a[36:39], v[32:35], v[84:87]
    v_cvt_pk_bf16_f32 v100, v72, v73
    v_mfma_f32_16x16x32_bf16 v[88:91], a[32:35], v[36:39], v[88:91]
    ds_read_b128 v[60:63], v14 offset:14592
    s_add_u32 m0, s34, 24576
    s_add_u32 s32, s35, 24576
    v_mfma_f32_16x16x32_bf16 v[92:95], a[36:39], v[36:39], v[92:95]
    buffer_load_dwordx4 v8, s[12:15], s32 offen sc1 lds
    v_cvt_pk_bf16_f32 v101, v74, v75
    s_waitcnt lgkmcnt(4)
    v_mfma_f32_16x16x32_bf16 v[80:83], a[40:43], v[40:43], v[80:83]
    ds_read_b128 v[32:35], v14 offset:16384
    v_mfma_f32_16x16x32_bf16 v[84:87], a[44:47], v[40:43], v[84:87]
    v_cvt_pk_bf16_f32 v102, v76, v77
    v_mfma_f32_16x16x32_bf16 v[88:91], a[40:43], v[44:47], v[88:91]
    ds_read_b128 v[36:39], v14 offset:16640
    v_mfma_f32_16x16x32_bf16 v[92:95], a[44:47], v[44:47], v[92:95]
    v_cvt_pk_bf16_f32 v103, v78, v79
    buffer_store_dwordx4 v[96:99], v9, s[20:23], s36 offen
    s_add_u32 s31, s36, 65536
    s_waitcnt lgkmcnt(4)
    v_mfma_f32_16x16x32_bf16 v[80:83], a[48:51], v[48:51], v[80:83]
    ds_read_b128 v[40:43], v14 offset:18432
    v_mfma_f32_16x16x32_bf16 v[84:87], a[52:55], v[48:51], v[84:87]
    v_mfma_f32_16x16x32_bf16 v[88:91], a[48:51], v[52:55], v[88:91]
    ds_read_b128 v[44:47], v14 offset:18688
    s_add_u32 m0, s34, 28672
    s_add_u32 s32, s35, 28672
    v_mfma_f32_16x16x32_bf16 v[92:95], a[52:55], v[52:55], v[92:95]
    buffer_load_dwordx4 v8, s[12:15], s32 offen sc1 lds
    s_waitcnt lgkmcnt(4)
    v_mfma_f32_16x16x32_bf16 v[80:83], a[56:59], v[56:59], v[80:83]
    ds_read_b128 v[48:51], v14 offset:20480
    v_mfma_f32_16x16x32_bf16 v[84:87], a[60:63], v[56:59], v[84:87]
    v_mfma_f32_16x16x32_bf16 v[88:91], a[56:59], v[60:63], v[88:91]
    ds_read_b128 v[52:55], v14 offset:20736
    v_mfma_f32_16x16x32_bf16 v[92:95], a[60:63], v[60:63], v[92:95]
    buffer_store_dwordx4 v[100:103], v9, s[20:23], s31 offen
    s_add_u32 s36, s36, s37
    s_waitcnt vmcnt(8)
    s_barrier
    s_waitcnt lgkmcnt(4)
    v_mfma_f32_16x16x32_bf16 v[80:83], a[64:67], v[32:35], v[80:83]
    ds_read_b128 v[56:59], v14 offset:22528
    v_mfma_f32_16x16x32_bf16 v[84:87], a[68:71], v[32:35], v[84:87]
    v_mfma_f32_16x16x32_bf16 v[88:91], a[64:67], v[36:39], v[88:91]
    ds_read_b128 v[60:63], v14 offset:22784
    s_add_u32 m0, s34, 32768
    s_add_u32 s32, s35, 32768
    v_mfma_f32_16x16x32_bf16 v[92:95], a[68:71], v[36:39], v[92:95]
    buffer_load_dwordx4 v8, s[12:15], s32 offen sc1 lds
    s_waitcnt lgkmcnt(4)
    v_mfma_f32_16x16x32_bf16 v[80:83], a[72:75], v[40:43], v[80:83]
    ds_read_b128 v[32:35], v14 offset:24576
    v_mfma_f32_16x16x32_bf16 v[84:87], a[76:79], v[40:43], v[84:87]
    v_mfma_f32_16x16x32_bf16 v[88:91], a[72:75], v[44:47], v[88:91]
    ds_read_b128 v[36:39], v14 offset:24832
    v_mfma_f32_16x16x32_bf16 v[92:95], a[76:79], v[44:47], v[92:95]
    s_waitcnt lgkmcnt(4)
    v_mfma_f32_16x16x32_bf16 v[80:83], a[80:83], v[48:51], v[80:83]
    ds_read_b128 v[40:43], v14 offset:26624
    v_mfma_f32_16x16x32_bf16 v[84:87], a[84:87], v[48:51], v[84:87]
    v_mfma_f32_16x16x32_bf16 v[88:91], a[80:83], v[52:55], v[88:91]
    ds_read_b128 v[44:47], v14 offset:26880
    s_add_u32 m0, s34, 36864
    s_add_u32 s32, s35, 36864
    v_mfma_f32_16x16x32_bf16 v[92:95], a[84:87], v[52:55], v[92:95]
    buffer_load_dwordx4 v8, s[12:15], s32 offen sc1 lds
    s_waitcnt lgkmcnt(4)
    v_mfma_f32_16x16x32_bf16 v[80:83], a[88:91], v[56:59], v[80:83]
    ds_read_b128 v[48:51], v14 offset:28672
    v_mfma_f32_16x16x32_bf16 v[84:87], a[92:95], v[56:59], v[84:87]
    v_mfma_f32_16x16x32_bf16 v[88:91], a[88:91], v[60:63], v[88:91]
    ds_read_b128 v[52:55], v14 offset:28928
    v_mfma_f32_16x16x32_bf16 v[92:95], a[92:95], v[60:63], v[92:95]
    s_waitcnt lgkmcnt(4)
    v_mfma_f32_16x16x32_bf16 v[80:83], a[96:99], v[32:35], v[80:83]
    ds_read_b128 v[56:59], v14 offset:30720
    v_mfma_f32_16x16x32_bf16 v[84:87], a[100:103], v[32:35], v[84:87]
    v_mfma_f32_16x16x32_bf16 v[88:91], a[96:99], v[36:39], v[88:91]
    ds_read_b128 v[60:63], v14 offset:30976
    s_add_u32 m0, s34, 40960
    s_add_u32 s32, s35, 40960
    v_mfma_f32_16x16x32_bf16 v[92:95], a[100:103], v[36:39], v[92:95]
    buffer_load_dwordx4 v8, s[12:15], s32 offen sc1 lds
    s_waitcnt lgkmcnt(4)
    v_mfma_f32_16x16x32_bf16 v[80:83], a[104:107], v[40:43], v[80:83]
    ds_read_b128 v[32:35], v14 offset:32768
    v_mfma_f32_16x16x32_bf16 v[84:87], a[108:111], v[40:43], v[84:87]
    v_mfma_f32_16x16x32_bf16 v[88:91], a[104:107], v[44:47], v[88:91]
    ds_read_b128 v[36:39], v14 offset:33024
    v_mfma_f32_16x16x32_bf16 v[92:95], a[108:111], v[44:47], v[92:95]
    s_waitcnt lgkmcnt(4)
    v_mfma_f32_16x16x32_bf16 v[80:83], a[112:115], v[48:51], v[80:83]
    ds_read_b128 v[40:43], v14 offset:34816
    v_mfma_f32_16x16x32_bf16 v[84:87], a[116:119], v[48:51], v[84:87]
    v_mfma_f32_16x16x32_bf16 v[88:91], a[112:115], v[52:55], v[88:91]
    ds_read_b128 v[44:47], v14 offset:35072
    s_add_u32 m0, s34, 45056
    s_add_u32 s32, s35, 45056
    v_mfma_f32_16x16x32_bf16 v[92:95], a[116:119], v[52:55], v[92:95]
    buffer_load_dwordx4 v8, s[12:15], s32 offen sc1 lds
    s_waitcnt lgkmcnt(4)
    v_mfma_f32_16x16x32_bf16 v[80:83], a[120:123], v[56:59], v[80:83]
    ds_read_b128 v[48:51], v14 offset:36864
    v_mfma_f32_16x16x32_bf16 v[84:87], a[124:127], v[56:59], v[84:87]
    v_mfma_f32_16x16x32_bf16 v[88:91], a[120:123], v[60:63], v[88:91]
    ds_read_b128 v[52:55], v14 offset:37120
    v_mfma_f32_16x16x32_bf16 v[92:95], a[124:127], v[60:63], v[92:95]
    s_waitcnt lgkmcnt(4)
    v_mfma_f32_16x16x32_bf16 v[80:83], a[128:131], v[32:35], v[80:83]
    ds_read_b128 v[56:59], v14 offset:38912
    v_mfma_f32_16x16x32_bf16 v[84:87], a[132:135], v[32:35], v[84:87]
    v_mfma_f32_16x16x32_bf16 v[88:91], a[128:131], v[36:39], v[88:91]
    ds_read_b128 v[60:63], v14 offset:39168
    s_add_u32 m0, s34, 49152
    s_add_u32 s32, s35, 49152
    v_mfma_f32_16x16x32_bf16 v[92:95], a[132:135], v[36:39], v[92:95]
    buffer_load_dwordx4 v8, s[12:15], s32 offen sc1 lds
    s_waitcnt lgkmcnt(4)
    v_mfma_f32_16x16x32_bf16 v[80:83], a[136:139], v[40:43], v[80:83]
    ds_read_b128 v[32:35], v14 offset:40960
    v_mfma_f32_16x16x32_bf16 v[84:87], a[140:143], v[40:43], v[84:87]
    v_mfma_f32_16x16x32_bf16 v[88:91], a[136:139], v[44:47], v[88:91]
    ds_read_b128 v[36:39], v14 offset:41216
    v_mfma_f32_16x16x32_bf16 v[92:95], a[140:143], v[44:47], v[92:95]
    s_waitcnt lgkmcnt(4)
    v_mfma_f32_16x16x32_bf16 v[80:83], a[144:147], v[48:51], v[80:83]
    ds_read_b128 v[40:43], v14 offset:43008
    v_mfma_f32_16x16x32_bf16 v[84:87], a[148:151], v[48:51], v[84:87]
    v_mfma_f32_16x16x32_bf16 v[88:91], a[144:147], v[52:55], v[88:91]
    ds_read_b128 v[44:47], v14 offset:43264
    s_add_u32 m0, s34, 53248
    s_add_u32 s32, s35, 53248
    v_mfma_f32_16x16x32_bf16 v[92:95], a[148:151], v[52:55], v[92:95]
    buffer_load_dwordx4 v8, s[12:15], s32 offen sc1 lds
    s_waitcnt lgkmcnt(4)
    v_mfma_f32_16x16x32_bf16 v[80:83], a[152:155], v[56:59], v[80:83]
    ds_read_b128 v[48:51], v14 offset:45056
    v_mfma_f32_16x16x32_bf16 v[84:87], a[156:159], v[56:59], v[84:87]
    v_mfma_f32_16x16x32_bf16 v[88:91], a[152:155], v[60:63], v[88:91]
    ds_read_b128 v[52:55], v14 offset:45312
    v_mfma_f32_16x16x32_bf16 v[92:95], a[156:159], v[60:63], v[92:95]
    s_waitcnt lgkmcnt(4)
    v_mfma_f32_16x16x32_bf16 v[80:83], a[160:163], v[32:35], v[80:83]
    ds_read_b128 v[56:59], v14 offset:47104
    v_mfma_f32_16x16x32_bf16 v[84:87], a[164:167], v[32:35], v[84:87]
    v_mfma_f32_16x16x32_bf16 v[88:91], a[160:163], v[36:39], v[88:91]
    ds_read_b128 v[60:63], v14 offset:47360
    s_add_u32 m0, s34, 57344
    s_add_u32 s32, s35, 57344
    v_mfma_f32_16x16x32_bf16 v[92:95], a[164:167], v[36:39], v[92:95]
    buffer_load_dwordx4 v8, s[12:15], s32 offen sc1 lds
    s_waitcnt lgkmcnt(4)
    v_mfma_f32_16x16x32_bf16 v[80:83], a[168:171], v[40:43], v[80:83]
    ds_read_b128 v[32:35], v14 offset:49152
    v_mfma_f32_16x16x32_bf16 v[84:87], a[172:175], v[40:43], v[84:87]
    v_mfma_f32_16x16x32_bf16 v[88:91], a[168:171], v[44:47], v[88:91]
    ds_read_b128 v[36:39], v14 offset:49408
    v_mfma_f32_16x16x32_bf16 v[92:95], a[172:175], v[44:47], v[92:95]
    s_waitcnt lgkmcnt(4)
    v_mfma_f32_16x16x32_bf16 v[80:83], a[176:179], v[48:51], v[80:83]
    ds_read_b128 v[40:43], v14 offset:51200
    v_mfma_f32_16x16x32_bf16 v[84:87], a[180:183], v[48:51], v[84:87]
    v_mfma_f32_16x16x32_bf16 v[88:91], a[176:179], v[52:55], v[88:91]
    ds_read_b128 v[44:47], v14 offset:51456
    s_add_u32 m0, s34, 61440
    s_add_u32 s32, s35, 61440
    v_mfma_f32_16x16x32_bf16 v[92:95], a[180:183], v[52:55], v[92:95]
    buffer_load_dwordx4 v8, s[12:15], s32 offen sc1 lds
    s_add_u32 s35, s35, 65536
    s_min_u32 s35, s35, s52
    s_waitcnt lgkmcnt(4)
    v_mfma_f32_16x16x32_bf16 v[80:83], a[184:187], v[56:59], v[80:83]
    ds_read_b128 v[48:51], v14 offset:53248
    v_mfma_f32_16x16x32_bf16 v[84:87], a[188:191], v[56:59], v[84:87]
    v_mfma_f32_16x16x32_bf16 v[88:91], a[184:187], v[60:63], v[88:91]
    ds_read_b128 v[52:55], v14 offset:53504
    v_mfma_f32_16x16x32_bf16 v[92:95], a[188:191], v[60:63], v[92:95]
    s_waitcnt vmcnt(8)
    s_barrier
    s_waitcnt lgkmcnt(4)
    v_mfma_f32_16x16x32_bf16 v[80:83], a[192:195], v[32:35], v[80:83]
    ds_read_b128 v[56:59], v14 offset:55296
    v_mfma_f32_16x16x32_bf16 v[84:87], a[196:199], v[32:35], v[84:87]
    v_mfma_f32_16x16x32_bf16 v[88:91], a[192:195], v[36:39], v[88:91]
    ds_read_b128 v[60:63], v14 offset:55552
    s_add_u32 m0, s34, 65536
    s_add_u32 s32, s35, 0
    v_mfma_f32_16x16x32_bf16 v[92:95], a[196:199], v[36:39], v[92:95]
    buffer_load_dwordx4 v8, s[12:15], s32 offen sc1 lds
    s_waitcnt lgkmcnt(4)
    v_mfma_f32_16x16x32_bf16 v[80:83], a[200:203], v[40:43], v[80:83]
    ds_read_b128 v[32:35], v14 offset:57344
    v_mfma_f32_16x16x32_bf16 v[84:87], a[204:207], v[40:43], v[84:87]
    v_mfma_f32_16x16x32_bf16 v[88:91], a[200:203], v[44:47], v[88:91]
    ds_read_b128 v[36:39], v14 offset:57600
    v_mfma_f32_16x16x32_bf16 v[92:95], a[204:207], v[44:47], v[92:95]
    s_waitcnt lgkmcnt(4)
    v_mfma_f32_16x16x32_bf16 v[80:83], a[208:211], v[48:51], v[80:83]
    ds_read_b128 v[40:43], v14 offset:59392
    v_mfma_f32_16x16x32_bf16 v[84:87], a[212:215], v[48:51], v[84:87]
    v_mfma_f32_16x16x32_bf16 v[88:91], a[208:211], v[52:55], v[88:91]
    ds_read_b128 v[44:47], v14 offset:59648
    s_add_u32 m0, s34, 69632
    s_add_u32 s32, s35, 4096
    v_mfma_f32_16x16x32_bf16 v[92:95], a[212:215], v[52:55], v[92:95]
    buffer_load_dwordx4 v8, s[12:15], s32 offen sc1 lds
    s_waitcnt lgkmcnt(4)
    v_mfma_f32_16x16x32_bf16 v[80:83], a[216:219], v[56:59], v[80:83]
    ds_read_b128 v[48:51], v14 offset:61440
    v_mfma_f32_16x16x32_bf16 v[84:87], a[220:223], v[56:59], v[84:87]
    v_mfma_f32_16x16x32_bf16 v[88:91], a[216:219], v[60:63], v[88:91]
    ds_read_b128 v[52:55], v14 offset:61696
    v_mfma_f32_16x16x32_bf16 v[92:95], a[220:223], v[60:63], v[92:95]
    s_waitcnt lgkmcnt(4)
    v_mfma_f32_16x16x32_bf16 v[80:83], a[224:227], v[32:35], v[80:83]
    ds_read_b128 v[56:59], v14 offset:63488
    v_mfma_f32_16x16x32_bf16 v[84:87], a[228:231], v[32:35], v[84:87]
    v_mfma_f32_16x16x32_bf16 v[88:91], a[224:227], v[36:39], v[88:91]
    ds_read_b128 v[60:63], v14 offset:63744
    s_add_u32 m0, s34, 73728
    s_add_u32 s32, s35, 8192
    v_mfma_f32_16x16x32_bf16 v[92:95], a[228:231], v[36:39], v[92:95]
    buffer_load_dwordx4 v8, s[12:15], s32 offen sc1 lds
    s_waitcnt lgkmcnt(4)
    v_mfma_f32_16x16x32_bf16 v[80:83], a[232:235], v[40:43], v[80:83]
    ds_read_b128 v[32:35], v12 offset:0
    v_mfma_f32_16x16x32_bf16 v[84:87], a[236:239], v[40:43], v[84:87]
    v_mfma_f32_16x16x32_bf16 v[88:91], a[232:235], v[44:47], v[88:91]
    ds_read_b128 v[36:39], v12 offset:256
    v_mfma_f32_16x16x32_bf16 v[92:95], a[236:239], v[44:47], v[92:95]
    s_waitcnt lgkmcnt(4)
    v_mfma_f32_16x16x32_bf16 v[80:83], a[240:243], v[48:51], v[80:83]
    ds_read_b128 v[40:43], v12 offset:2048
    v_mfma_f32_16x16x32_bf16 v[84:87], a[244:247], v[48:51], v[84:87]
    v_mfma_f32_16x16x32_bf16 v[88:91], a[240:243], v[52:55], v[88:91]
    ds_read_b128 v[44:47], v12 offset:2304
    s_add_u32 m0, s34, 77824
    s_add_u32 s32, s35, 12288
    v_mfma_f32_16x16x32_bf16 v[92:95], a[244:247], v[52:55], v[92:95]
    buffer_load_dwordx4 v8, s[12:15], s32 offen sc1 lds
    s_waitcnt lgkmcnt(4)
    v_mfma_f32_16x16x32_bf16 v[80:83], a[248:251], v[56:59], v[80:83]
    ds_read_b128 v[48:51], v12 offset:4096
    v_mfma_f32_16x16x32_bf16 v[84:87], a[252:255], v[56:59], v[84:87]
    v_mfma_f32_16x16x32_bf16 v[88:91], a[248:251], v[60:63], v[88:91]
    ds_read_b128 v[52:55], v12 offset:4352
    v_mfma_f32_16x16x32_bf16 v[92:95], a[252:255], v[60:63], v[92:95]
    s_add_u32 s30, s30, 2
    s_cmp_lt_u32 s30, s51
    s_cbranch_scc1 sl_loop_104
    v_cvt_pk_bf16_f32 v96, v80, v81
    v_cvt_pk_bf16_f32 v97, v82, v83
    v_cvt_pk_bf16_f32 v98, v84, v85
    v_cvt_pk_bf16_f32 v99, v86, v87
    v_cvt_pk_bf16_f32 v100, v88, v89
    v_cvt_pk_bf16_f32 v101, v90, v91
    v_cvt_pk_bf16_f32 v102, v92, v93
    v_cvt_pk_bf16_f32 v103, v94, v95
    s_branch sl_e_103
sl_e_103:
    buffer_store_dwordx4 v[96:99], v9, s[20:23], s36 offen
    s_add_u32 s31, s36, 65536
    buffer_store_dwordx4 v[100:103], v9, s[20:23], s31 offen
    s_add_u32 s36, s36, s37
    s_waitcnt vmcnt(0) lgkmcnt(0)
    s_barrier
    s_branch L_dump
L_dump:
L_end:
    s_endpgm
.section .rodata,"a"
.p2align 6
.amdhsa_kernel concat_heads__memory_aug_recurrent_mem_tr__sliding_local_dilated__prompt_kernel
  .amdhsa_next_free_vgpr 512
  .amdhsa_next_free_sgpr 102
  .amdhsa_accum_offset 256
  .amdhsa_group_segment_fixed_size 0
  .amdhsa_kernarg_size 104
  .amdhsa_user_sgpr_count 2
  .amdhsa_user_sgpr_kernarg_segment_ptr 1
  .amdhsa_system_sgpr_workgroup_id_x 1
.end_amdhsa_kernel
```

```asm
; @launch grid=(256,1,1) block=(256,1,1) lds=163840
.amdgcn_target "amdgcn-amd-amdhsa--gfx950"
.text
.globl concat_heads__memory_aug_recurrent_mem_tr__sliding_local_dilated__prompt_kernel
.p2align 8
.type concat_heads__memory_aug_recurrent_mem_tr__sliding_local_dilated__prompt_kernel,@function
concat_heads__memory_aug_recurrent_mem_tr__sliding_local_dilated__prompt_kernel:
    s_cmp_ge_u32 s2, 256
    s_cbranch_scc1 L_end
    s_getreg_b32 s6, hwreg(HW_REG_XCC_ID)
    s_sub_u32 s6, s6, s2
    s_and_b32 s6, s6, 7
    s_or_b32 s70, s6, 8
    s_mov_b32 s71, 0
    s_cmp_lg_u32 s2, 0
    s_cbranch_scc1 L_role
    s_load_dwordx2 s[4:5], s[0:1], 88
    v_mov_b32 v1, 0
    v_mov_b32 v2, s70
    s_waitcnt lgkmcnt(0)
    s_mov_b64 exec, 1
    global_store_dword v1, v2, s[4:5] offset:192 sc1
    s_mov_b64 exec, -1
L_role:
    s_add_u32 s7, s2, s70
    s_and_b32 s3, s7, 3
    s_lshl_b32 s3, s3, 5
    s_lshr_b32 s28, s2, 3
    s_add_u32 s28, s28, s3
    s_bitcmp1_b32 s7, 2
    s_cbranch_scc1 L_gem
L_rec:
    s_mov_b32 s6, L_gem - L_rec - 16
    s_load_dwordx2 s[72:73], s[0:1], 8
    s_load_dwordx4 s[76:79], s[0:1], 16
    s_load_dwordx4 s[80:83], s[0:1], 32
    s_load_dwordx2 s[90:91], s[0:1], 96
    s_load_dwordx2 s[92:93], s[0:1], 88
    v_and_b32 v1, 63, v0
    v_lshrrev_b32 v2, 6, v0
    s_nop 0
    v_readfirstlane_b32 s31, v2
    s_lshr_b32 s29, s28, 2
    s_and_b32 s30, s28, 3
    s_mov_b32 s41, 0
    s_waitcnt lgkmcnt(0)
    s_mov_b32 s24, s72
    s_and_b32 s25, s73, 0xffff
    s_mov_b32 s26, 16384
    s_mov_b32 s27, 0x00020000
    s_mov_b32 s8, s76
    s_and_b32 s9, s77, 0xffff
    s_mov_b32 s10, 8388608
    s_mov_b32 s11, 0x00020000
    s_mov_b32 s12, s78
    s_and_b32 s13, s79, 0xffff
    s_mov_b32 s14, 8388608
    s_mov_b32 s15, 0x00020000
    s_mov_b32 s16, s80
    s_and_b32 s17, s81, 0xffff
    s_mov_b32 s18, 8388608
    s_mov_b32 s19, 0x00020000
    s_mov_b32 s20, s82
    s_and_b32 s21, s83, 0xffff
    s_mov_b32 s22, 8388608
    s_mov_b32 s23, 0x00020000
    s_mov_b32 s4, s90
    s_and_b32 s5, s91, 0xffff
    s_mov_b32 s6, 268435456
    s_mov_b32 s7, 0x00020000
    s_sub_u32 s49, 0, s90
    s_and_b32 s49, s49, 2097151
    s_add_u32 s49, s49, 117440512
    s_mov_b32 s48, 0
rec_cal_1:
    s_lshl_b32 s38, s31, 21
    s_lshl_b32 s40, s28, 6
    s_add_u32 s38, s38, s40
    v_lshrrev_b32 v184, 2, v1
    v_lshlrev_b32 v184, 13, v184
    v_and_b32 v4, 3, v1
    v_lshl_add_u32 v184, v4, 4, v184
    v_add_u32 v184, s38, v184
    s_lshl_b32 s38, s31, 21
    s_lshr_b32 s40, s28, 1
    s_lshl_b32 s40, s40, 5
    s_add_u32 s38, s38, s40
    v_lshrrev_b32 v185, 1, v1
    v_lshlrev_b32 v185, 11, v185
    v_and_b32 v4, 1, v1
    v_lshl_add_u32 v185, v4, 4, v185
    v_add_u32 v185, s38, v185
    s_lshl_b32 s33, s31, 15
    v_lshrrev_b32 v186, 4, v1
    v_lshlrev_b32 v186, 9, v186
    v_bfe_u32 v4, v1, 2, 2
    v_lshl_add_u32 v186, v4, 6, v186
    v_and_b32 v4, 3, v1
    v_lshl_add_u32 v186, v4, 3, v186
    v_add_u32 v186, s33, v186
    v_lshrrev_b32 v187, 4, v1
    v_lshlrev_b32 v187, 8, v187
    v_bfe_u32 v4, v1, 2, 2
    v_lshl_add_u32 v187, v4, 5, v187
    v_and_b32 v4, 3, v1
    v_lshl_add_u32 v187, v4, 3, v187
    v_add_u32 v187, s33, v187
    s_lshl_b32 s38, s31, 21
    s_and_b32 s40, s28, 7
    s_lshl_b32 s40, s40, 14
    s_add_u32 s38, s38, s40
    s_lshr_b32 s40, s28, 3
    s_lshl_b32 s40, s40, 7
    s_add_u32 s38, s38, s40
    v_lshrrev_b32 v96, 3, v1
    v_lshlrev_b32 v96, 11, v96
    v_and_b32 v4, 7, v1
    v_lshl_add_u32 v96, v4, 4, v96
    v_add_u32 v96, s38, v96
    s_and_b32 s60, s28, 7
    s_lshl_b32 s60, s60, 18
    s_and_b32 s61, s28, 1
    s_lshl_b32 s61, s61, 20
    s_add_u32 m0, s33, 0
    s_mov_b32 s38, 0
    buffer_load_dwordx4 v184, s[8:11], s38 offen lds
    s_add_u32 m0, s33, 1024
    s_mov_b32 s38, 131072
    buffer_load_dwordx4 v184, s[8:11], s38 offen lds
    s_add_u32 m0, s33, 2048
    s_mov_b32 s38, 0
    buffer_load_dwordx4 v184, s[12:15], s38 offen lds
    s_add_u32 m0, s33, 3072
    s_mov_b32 s38, 131072
    buffer_load_dwordx4 v184, s[12:15], s38 offen lds
    s_add_u32 m0, s33, 4096
    s_mov_b32 s38, 0
    buffer_load_dwordx4 v184, s[16:19], s38 offen lds
    s_add_u32 m0, s33, 5120
    s_mov_b32 s38, 131072
    buffer_load_dwordx4 v184, s[16:19], s38 offen lds
    s_add_u32 m0, s33, 6144
    s_mov_b32 s38, 262144
    buffer_load_dwordx4 v184, s[8:11], s38 offen lds
    s_add_u32 m0, s33, 7168
    s_mov_b32 s38, 393216
    buffer_load_dwordx4 v184, s[8:11], s38 offen lds
    s_add_u32 m0, s33, 8192
    s_mov_b32 s38, 262144
    buffer_load_dwordx4 v184, s[12:15], s38 offen lds
    s_add_u32 m0, s33, 9216
    s_mov_b32 s38, 393216
    buffer_load_dwordx4 v184, s[12:15], s38 offen lds
    s_add_u32 m0, s33, 10240
    s_mov_b32 s38, 262144
    buffer_load_dwordx4 v184, s[16:19], s38 offen lds
    s_add_u32 m0, s33, 11264
    s_mov_b32 s38, 393216
    buffer_load_dwordx4 v184, s[16:19], s38 offen lds
    v_bfe_u32 v2, v1, 1, 1
    v_mov_b32 v3, 0xaaaa
    v_mul_u32_u24 v2, v2, v3
    v_add_u32 v5, 0x4444, v2
    v_lshlrev_b32 v16, 4, v1
    s_lshr_b32 s38, s28, 6
    s_lshl_b32 s38, s38, 14
    s_and_b32 s40, s28, 63
    s_lshl_b32 s40, s40, 7
    s_add_u32 s38, s38, s40
    s_add_u32 s38, s38, 131072
    v_lshl_add_u32 v6, v1, 2, s38
    s_lshr_b32 s38, s31, 1
    s_lshl_b32 s38, s38, 14
    s_and_b32 s40, s31, 1
    s_lshl_b32 s40, s40, 12
    s_add_u32 s38, s38, s40
    s_add_u32 s38, s38, 131072
    v_add_u32 v7, s38, v16
    s_and_b32 s38, s28, 1
    s_lshl_b32 s38, s38, 16
    s_lshl_b32 s40, s31, 14
    s_add_u32 s38, s38, s40
    v_add_u32 v12, s38, v16
    v_add_u32 v13, 4096, v12
    v_lshrrev_b32 v2, 4, v1
    v_mul_u32_u24 v2, 320, v2
    v_and_b32 v3, 15, v1
    v_lshl_add_u32 v2, v3, 2, v2
    s_mul_i32 s38, s31, 2560
    v_add_u32 v14, s38, v2
    v_add_u32 v15, 1280, v14
    s_lshl_b32 s38, s31, 10
    s_add_u32 s38, s38, 10240
    v_add_u32 v17, s38, v16
    v_and_b32 v2, 3, v1
    v_lshlrev_b32 v2, 1, v2
    v_bfe_u32 v4, v1, 2, 1
    v_lshl_add_u32 v2, v4, 0, v2
    v_add_u32 v2, 8, v2
    v_and_b32 v3, 15, v1
    v_cmp_gt_u32 vcc, 8, v3
    s_nop 1
    v_cndmask_b32 v3, v2, v3, vcc
    v_mul_u32_u24 v3, 160, v3
    v_lshrrev_b32 v2, 5, v1
    v_lshlrev_b32 v2, 6, v2
    v_bfe_u32 v4, v1, 4, 1
    v_lshl_add_u32 v2, v4, 4, v2
    v_add_u32 v18, v2, v3
    s_lshl_b32 s38, s28, 11
    v_add_u32 v19, s38, v16
    v_bfe_u32 v20, v1, 4, 1
    v_lshlrev_b32 v20, 7, v20
    v_and_b32 v4, 7, v1
    v_lshl_add_u32 v20, v4, 4, v20
    v_add_u32 v20, s38, v20
    s_add_u32 s39, s30, 1
    s_and_b32 s38, s39, 3
    s_lshl_b32 s38, s38, 11
    s_lshl_b32 s40, s29, 13
    s_add_u32 s38, s38, s40
    v_add_u32 v22, s38, v16
    s_add_u32 s39, s30, 2
    s_and_b32 s38, s39, 3
    s_lshl_b32 s38, s38, 11
    s_lshl_b32 s40, s29, 13
    s_add_u32 s38, s38, s40
    v_add_u32 v23, s38, v16
    s_add_u32 s39, s30, 3
    s_and_b32 s38, s39, 3
    s_lshl_b32 s38, s38, 11
    s_lshl_b32 s40, s29, 13
    s_add_u32 s38, s38, s40
    v_add_u32 v24, s38, v16
    s_lshl_b32 s38, s29, 13
    v_lshrrev_b32 v21, 4, v1
    v_lshlrev_b32 v21, 11, v21
    v_and_b32 v4, 15, v1
    v_lshl_add_u32 v21, v4, 4, v21
    v_add_u32 v21, s38, v21
    v_lshrrev_b32 v25, 4, v1
    v_lshlrev_b32 v25, 8, v25
    v_bfe_u32 v4, v1, 3, 1
    v_lshl_add_u32 v25, v4, 3, v25
    v_bfe_u32 v4, v1, 1, 1
    v_lshl_add_u32 v25, v4, 6, v25
    v_bfe_u32 v4, v1, 2, 1
    v_lshl_add_u32 v25, v4, 5, v25
    v_and_b32 v4, 1, v1
    v_lshl_add_u32 v25, v4, 4, v25
    v_add_u32 v25, 10240, v25
    s_lshl_b32 s38, s28, 11
    s_and_b32 s40, s31, 1
    s_lshl_b32 s40, s40, 7
    s_add_u32 s38, s38, s40
    s_add_u32 s38, s38, 16777216
    v_bfe_u32 v2, v1, 3, 1
    v_lshlrev_b32 v2, 8, v2
    v_and_b32 v4, 7, v1
    v_lshl_add_u32 v2, v4, 4, v2
    v_bfe_u32 v4, v1, 4, 1
    v_lshl_add_u32 v2, v4, 9, v2
    v_lshrrev_b32 v4, 5, v1
    v_lshl_add_u32 v2, v4, 10, v2
    v_add_u32 v2, s38, v2
    s_add_u32 s38, s38, 16777216
    v_bfe_u32 v3, v1, 3, 1
    v_lshlrev_b32 v3, 8, v3
    v_bfe_u32 v4, v1, 1, 1
    v_lshl_add_u32 v3, v4, 6, v3
    v_bfe_u32 v4, v1, 2, 1
    v_lshl_add_u32 v3, v4, 5, v3
    v_and_b32 v4, 1, v1
    v_lshl_add_u32 v3, v4, 4, v3
    v_bfe_u32 v4, v1, 4, 1
    v_lshl_add_u32 v3, v4, 9, v3
    v_lshrrev_b32 v4, 5, v1
    v_lshl_add_u32 v3, v4, 10, v3
    v_add_u32 v3, s38, v3
    s_cmp_lt_u32 s31, 2
    s_cselect_b64 vcc, -1, 0
    v_cndmask_b32 v30, v3, v2, vcc
    s_lshl_b32 s3, s31, 10
    s_lshr_b32 s38, s29, 3
    s_lshl_b32 s38, s38, 14
    s_and_b32 s40, s29, 7
    s_lshl_b32 s40, s40, 10
    s_add_u32 s38, s38, s40
    s_and_b32 s40, s30, 1
    s_lshl_b32 s40, s40, 9
    s_add_u32 s38, s38, s40
    s_lshr_b32 s40, s30, 1
    s_lshl_b32 s40, s40, 7
    s_add_u32 s38, s38, s40
    v_bfe_u32 v27, v1, 2, 1
    v_lshlrev_b32 v27, 16, v27
    v_lshrrev_b32 v4, 5, v1
    v_lshl_add_u32 v27, v4, 8, v27
    v_bfe_u32 v4, v1, 1, 1
    v_lshl_add_u32 v27, v4, 6, v27
    v_bfe_u32 v4, v1, 4, 1
    v_lshl_add_u32 v27, v4, 5, v27
    v_and_b32 v4, 1, v1
    v_lshl_add_u32 v27, v4, 4, v27
    v_add_u32 v27, s38, v27
    s_lshr_b32 s39, s31, 1
    s_lshl_b32 s39, s39, 16
    s_and_b32 s40, s31, 1
    s_lshl_b32 s40, s40, 8
    s_add_u32 s39, s39, s40
    s_add_u32 s39, s39, s38
    v_add_u32 v95, s39, v16
    v_cmp_gt_u32 vcc, 8, v1
    v_mov_b32 v4, 2130706432
    s_nop 0
    v_cndmask_b32 v95, v4, v95, vcc
    s_lshl_b32 s38, s31, 8
    s_add_u32 s38, s38, 14336
    v_lshl_add_u32 v28, v1, 2, s38
    v_bfe_u32 v29, v1, 2, 1
    v_lshlrev_b32 v29, 7, v29
    v_bfe_u32 v4, v1, 4, 1
    v_lshl_add_u32 v29, v4, 6, v29
    v_and_b32 v4, 3, v1
    v_lshl_add_u32 v29, v4, 4, v29
    v_bfe_u32 v4, v1, 3, 1
    v_lshl_add_u32 v29, v4, 3, v29
    v_add_u32 v29, 14336, v29
    s_mul_i32 s39, s31, 320
    s_lshl_b32 s38, s28, 11
    s_add_u32 s38, s38, s39
    v_add_u32 v94, s38, v16
    v_cmp_gt_u32 vcc, 20, v1
    v_mov_b32 v4, 2130706432
    s_nop 0
    v_cndmask_b32 v94, v4, v94, vcc
    s_mul_i32 s38, s31, 3
    v_min_u32 v2, 2, v1
    v_add_u32 v2, s38, v2
    v_min_u32 v2, 9, v2
    s_lshl_b32 s38, s28, 11
    s_add_u32 s38, s38, 262144
    v_lshl_add_u32 v92, v2, 7, s38
    s_lshl_b32 s38, s28, 9
    v_lshrrev_b32 v93, 4, v1
    v_lshlrev_b32 v93, 7, v93
    v_and_b32 v4, 3, v1
    v_lshl_add_u32 v93, v4, 5, v93
    v_bfe_u32 v4, v1, 2, 1
    v_lshl_add_u32 v93, v4, 4, v93
    v_add_u32 v93, s38, v93
    s_mov_b32 vcc_lo, 0xff00ff00
    s_mov_b32 vcc_hi, 0xff00ff00
    s_cmp_eq_u32 s31, 1
    s_cbranch_scc1 rec_ns_2
    s_add_u32 s38, s38, 4194304
    v_add_u32 v93, s38, v16
    s_mov_b32 vcc_lo, -1
    s_mov_b32 vcc_hi, 0
    s_cmp_eq_u32 s31, 2
    s_cbranch_scc1 rec_ns_2
    s_lshr_b32 s38, s28, 6
    s_lshl_b32 s38, s38, 14
    s_and_b32 s40, s28, 63
    s_lshl_b32 s40, s40, 7
    s_add_u32 s38, s38, s40
    s_add_u32 s38, s38, 131072
    v_add_u32 v93, s38, v16
    s_cmp_eq_u32 s31, 3
    s_cselect_b32 vcc_lo, 0xff, 0
rec_ns_2:
    s_nop 0
    v_mov_b32 v4, 2130706432
    v_cndmask_b32 v93, v4, v93, vcc
    v_mov_b32 v32, 0x3f803f80
    v_mov_b32 v33, 0x3f803f80
    v_mov_b32 v34, 0x3f803f80
    v_mov_b32 v35, 0x3f803f80
    v_mov_b32 v8, -1
    v_mov_b32 v9, -1
    v_mov_b32 v10, -1
    v_mov_b32 v11, -1
    v_mov_b32 v144, 0
    v_mov_b32 v145, 0
    v_mov_b32 v146, 0
    v_mov_b32 v147, 0
    v_mov_b32 v180, 0
    v_mov_b32 v181, 0
    v_mov_b32 v182, 0
    v_mov_b32 v183, 0
    v_mov_b32 v161, 0
    v_mov_b32 v162, 0
    v_mov_b32 v163, 0
    v_mov_b32 v138, 0
    v_mov_b32 v139, 0
    v_mov_b32 v140, 0
    v_mov_b32 v141, 0
    v_mov_b32 v142, 0
    v_mov_b32 v143, 0
    s_mov_b32 s42, 0x00ff00ff
    s_mov_b32 s43, 0x00ff00ff
    s_mov_b32 s44, 0
    s_mov_b32 s45, -1
    s_mov_b32 s46, 0
    s_mov_b32 s47, 0x00ff00ff
    s_mov_b32 s50, 0x3e0293ee
    s_mov_b32 s36, 96468992
    s_mov_b32 s37, 0
    s_mov_b32 s32, 0
    s_mov_b32 s51, 131072
    s_mov_b32 s54, 1
    s_min_u32 s38, s31, 1
    s_add_u32 s38, s38, 1
    v_mov_b32 v134, s38
    s_lshl_b32 s95, s29, 7
    s_lshr_b32 s40, s31, 1
    s_lshl_b32 s40, s40, 2
    s_add_u32 s95, s95, s40
    s_lshr_b32 s40, s31, 1
    s_lshl_b32 s40, s40, 12
    s_add_u32 s95, s95, s40
    s_lshl_b32 s40, s30, 14
    s_add_u32 s95, s95, s40
    s_add_u32 s95, s95, 115638276
    s_lshl_b32 s97, s29, 7
    s_add_u32 s97, s97, 115351552
    s_lshl_b32 s38, s30, 4
    s_add_u32 s38, s38, s97
    v_mov_b32 v137, s38
    s_cmp_eq_u32 s31, 2
    s_cselect_b64 vcc, 1, 0
    v_mov_b32 v4, 2130706432
    v_cndmask_b32 v137, v4, v137, vcc
    s_mov_b32 s94, 0
    s_add_u32 s38, s49, 0
    buffer_store_dwordx4 v[144:147], v95, s[4:7], s38 offen sc1
    s_add_u32 s38, s49, 262144
    buffer_store_dwordx4 v[144:147], v95, s[4:7], s38 offen sc1
    s_add_u32 s38, s49, 8192
    buffer_store_dwordx4 v[144:147], v95, s[4:7], s38 offen sc1
    s_add_u32 s38, s49, 270336
    buffer_store_dwordx4 v[144:147], v95, s[4:7], s38 offen sc1
    buffer_store_dwordx4 v[8:11], v94, s[4:7], s36 offen sc1
    v_add_u32 v94, 262144, v94
    buffer_store_dwordx4 v[8:11], v94, s[4:7], s36 offen sc1
    v_add_u32 v94, 262144, v94
    buffer_store_dwordx4 v[8:11], v94, s[4:7], s36 offen sc1
    buffer_store_dword v144, v137, s[4:7], 0 offen sc1
    s_cmp_lg_u32 s31, 3
    s_cbranch_scc1 rec_i3_3
    s_add_u32 s38, s49, 262144
    buffer_store_dwordx4 v[144:147], v93, s[4:7], s38 offen sc1
    s_add_u32 s38, s49, 270336
    buffer_store_dwordx4 v[144:147], v93, s[4:7], s38 offen sc1
    s_lshr_b32 s39, s28, 5
    s_lshl_b32 s39, s39, 14
    s_and_b32 s40, s28, 31
    s_lshl_b32 s40, s40, 8
    s_add_u32 s39, s39, s40
    s_add_u32 s39, s39, s49
    s_add_u32 s39, s39, 163840
    s_mov_b64 exec, 0xffff
    s_add_u32 s38, s39, 0
    buffer_store_dwordx4 v[144:147], v16, s[4:7], s38 offen sc1
    s_add_u32 s38, s39, 8192
    buffer_store_dwordx4 v[144:147], v16, s[4:7], s38 offen sc1
    s_mov_b64 exec, -1
rec_i3_3:
    s_lshl_b32 s38, s31, 9
    v_bfe_u32 v2, v1, 2, 2
    v_lshlrev_b32 v2, 12, v2
    v_and_b32 v4, 1, v1
    v_lshl_add_u32 v2, v4, 11, v2
    v_lshrrev_b32 v4, 4, v1
    v_lshl_add_u32 v2, v4, 5, v2
    v_bfe_u32 v4, v1, 1, 1
    v_lshl_add_u32 v2, v4, 2, v2
    v_add_u32 v2, s38, v2
    s_mov_b32 s38, 0
    s_xor_b32 s38, s38, 0
    buffer_load_dword v36, v2, s[24:27], s38 offen offset:0
    buffer_load_dword v37, v2, s[24:27], s38 offen offset:8
    buffer_load_dword v38, v2, s[24:27], s38 offen offset:16
    buffer_load_dword v39, v2, s[24:27], s38 offen offset:24
    buffer_load_dword v40, v2, s[24:27], s38 offen offset:128
    buffer_load_dword v41, v2, s[24:27], s38 offen offset:136
    buffer_load_dword v42, v2, s[24:27], s38 offen offset:144
    buffer_load_dword v43, v2, s[24:27], s38 offen offset:152
    s_mov_b32 s38, 0
    s_xor_b32 s38, s38, 256
    buffer_load_dword v44, v2, s[24:27], s38 offen offset:0
    buffer_load_dword v45, v2, s[24:27], s38 offen offset:8
    buffer_load_dword v46, v2, s[24:27], s38 offen offset:16
    buffer_load_dword v47, v2, s[24:27], s38 offen offset:24
    buffer_load_dword v48, v2, s[24:27], s38 offen offset:128
    buffer_load_dword v49, v2, s[24:27], s38 offen offset:136
    buffer_load_dword v50, v2, s[24:27], s38 offen offset:144
    buffer_load_dword v51, v2, s[24:27], s38 offen offset:152
    s_add_u32 m0, s33, 12288
    s_mov_b32 s38, 524288
    buffer_load_dwordx4 v184, s[8:11], s38 offen lds
    s_add_u32 m0, s33, 13312
    s_mov_b32 s38, 655360
    buffer_load_dwordx4 v184, s[8:11], s38 offen lds
    s_add_u32 m0, s33, 14336
    s_mov_b32 s38, 524288
    buffer_load_dwordx4 v184, s[12:15], s38 offen lds
    s_add_u32 m0, s33, 15360
    s_mov_b32 s38, 655360
    buffer_load_dwordx4 v184, s[12:15], s38 offen lds
    s_add_u32 m0, s33, 16384
    s_mov_b32 s38, 524288
    buffer_load_dwordx4 v184, s[16:19], s38 offen lds
    s_add_u32 m0, s33, 17408
    s_mov_b32 s38, 655360
    buffer_load_dwordx4 v184, s[16:19], s38 offen lds
    s_add_u32 m0, s33, 18432
    s_mov_b32 s38, 786432
    buffer_load_dwordx4 v184, s[8:11], s38 offen lds
    s_add_u32 m0, s33, 19456
    s_mov_b32 s38, 917504
    buffer_load_dwordx4 v184, s[8:11], s38 offen lds
    s_add_u32 m0, s33, 20480
    s_mov_b32 s38, 786432
    buffer_load_dwordx4 v184, s[12:15], s38 offen lds
    s_add_u32 m0, s33, 21504
    s_mov_b32 s38, 917504
    buffer_load_dwordx4 v184, s[12:15], s38 offen lds
    s_add_u32 m0, s33, 22528
    s_mov_b32 s38, 786432
    buffer_load_dwordx4 v184, s[16:19], s38 offen lds
    s_add_u32 m0, s33, 23552
    s_mov_b32 s38, 917504
    buffer_load_dwordx4 v184, s[16:19], s38 offen lds
    s_add_u32 m0, s33, 24576
    s_mov_b32 s38, 1048576
    buffer_load_dwordx4 v184, s[8:11], s38 offen lds
    s_add_u32 m0, s33, 25600
    s_mov_b32 s38, 1179648
    buffer_load_dwordx4 v184, s[8:11], s38 offen lds
    s_add_u32 m0, s33, 26624
    s_mov_b32 s38, 1048576
    buffer_load_dwordx4 v184, s[12:15], s38 offen lds
    s_add_u32 m0, s33, 27648
    s_mov_b32 s38, 1179648
    buffer_load_dwordx4 v184, s[12:15], s38 offen lds
    s_add_u32 m0, s33, 28672
    s_mov_b32 s38, 1048576
    buffer_load_dwordx4 v184, s[16:19], s38 offen lds
    s_add_u32 m0, s33, 29696
    s_mov_b32 s38, 1179648
    buffer_load_dwordx4 v184, s[16:19], s38 offen lds
    s_add_u32 m0, s33, 30720
    s_mov_b32 s38, 1310720
    buffer_load_dwordx4 v184, s[8:11], s38 offen lds
    s_add_u32 m0, s33, 31744
    s_mov_b32 s38, 1441792
    buffer_load_dwordx4 v184, s[8:11], s38 offen lds
rec_wv_4:
    s_waitcnt vmcnt(54)
    ds_read_b64_tr_b16 a[0:1], v186 offset:0
    ds_read_b64_tr_b16 a[2:3], v186 offset:256
    ds_read_b64_tr_b16 a[8:9], v186 offset:32
    ds_read_b64_tr_b16 a[10:11], v186 offset:288
    s_waitcnt vmcnt(52)
    ds_read_b64_tr_b16 a[16:17], v186 offset:2048
    ds_read_b64_tr_b16 a[18:19], v186 offset:2304
    ds_read_b64_tr_b16 a[24:25], v186 offset:2080
    ds_read_b64_tr_b16 a[26:27], v186 offset:2336
    s_waitcnt lgkmcnt(4)
    s_add_u32 m0, s33, 0
    s_mov_b32 s38, 1310720
    buffer_load_dwordx4 v184, s[12:15], s38 offen lds
    s_add_u32 m0, s33, 1024
    s_mov_b32 s38, 1441792
    buffer_load_dwordx4 v184, s[12:15], s38 offen lds
    s_waitcnt vmcnt(52)
    global_load_dword v31, v144, s[92:93] offset:192 sc1
    ds_read_b64_tr_b16 a[32:33], v186 offset:4096
    ds_read_b64_tr_b16 a[34:35], v186 offset:4352
    ds_read_b64_tr_b16 a[40:41], v186 offset:4128
    ds_read_b64_tr_b16 a[42:43], v186 offset:4384
    s_waitcnt lgkmcnt(4)
    s_add_u32 m0, s33, 2048
    s_mov_b32 s38, 1310720
    buffer_load_dwordx4 v184, s[16:19], s38 offen lds
    s_add_u32 m0, s33, 3072
    s_mov_b32 s38, 1441792
    buffer_load_dwordx4 v184, s[16:19], s38 offen lds
    s_waitcnt vmcnt(53)
    ds_read_b64_tr_b16 a[4:5], v186 offset:6144
    ds_read_b64_tr_b16 a[6:7], v186 offset:6400
    ds_read_b64_tr_b16 a[12:13], v186 offset:6176
    ds_read_b64_tr_b16 a[14:15], v186 offset:6432
    s_waitcnt lgkmcnt(4)
    s_add_u32 m0, s33, 4096
    s_mov_b32 s38, 1572864
    buffer_load_dwordx4 v184, s[8:11], s38 offen lds
    s_add_u32 m0, s33, 5120
    s_mov_b32 s38, 1703936
    buffer_load_dwordx4 v184, s[8:11], s38 offen lds
    s_waitcnt vmcnt(53)
    ds_read_b64_tr_b16 a[20:21], v186 offset:8192
    ds_read_b64_tr_b16 a[22:23], v186 offset:8448
    ds_read_b64_tr_b16 a[28:29], v186 offset:8224
    ds_read_b64_tr_b16 a[30:31], v186 offset:8480
    s_waitcnt lgkmcnt(4)
    s_add_u32 m0, s33, 6144
    s_mov_b32 s38, 1572864
    buffer_load_dwordx4 v184, s[12:15], s38 offen lds
    s_add_u32 m0, s33, 7168
    s_mov_b32 s38, 1703936
    buffer_load_dwordx4 v184, s[12:15], s38 offen lds
    s_waitcnt vmcnt(53)
    ds_read_b64_tr_b16 a[36:37], v186 offset:10240
    ds_read_b64_tr_b16 a[38:39], v186 offset:10496
    ds_read_b64_tr_b16 a[44:45], v186 offset:10272
    ds_read_b64_tr_b16 a[46:47], v186 offset:10528
    s_waitcnt lgkmcnt(4)
    s_add_u32 m0, s33, 8192
    s_mov_b32 s38, 1572864
    buffer_load_dwordx4 v184, s[16:19], s38 offen lds
    s_add_u32 m0, s33, 9216
    s_mov_b32 s38, 1703936
    buffer_load_dwordx4 v184, s[16:19], s38 offen lds
    s_waitcnt vmcnt(29)
    ds_read_b64_tr_b16 a[48:49], v186 offset:12288
    ds_read_b64_tr_b16 a[50:51], v186 offset:12544
    ds_read_b64_tr_b16 a[56:57], v186 offset:12320
    ds_read_b64_tr_b16 a[58:59], v186 offset:12576
    s_waitcnt lgkmcnt(4)
    s_add_u32 m0, s33, 10240
    s_mov_b32 s38, 1835008
    buffer_load_dwordx4 v184, s[8:11], s38 offen lds
    s_add_u32 m0, s33, 11264
    s_mov_b32 s38, 1966080
    buffer_load_dwordx4 v184, s[8:11], s38 offen lds
    s_waitcnt vmcnt(29)
    ds_read_b64_tr_b16 a[64:65], v186 offset:14336
    ds_read_b64_tr_b16 a[66:67], v186 offset:14592
    ds_read_b64_tr_b16 a[72:73], v186 offset:14368
    ds_read_b64_tr_b16 a[74:75], v186 offset:14624
    s_waitcnt lgkmcnt(4)
    s_add_u32 m0, s33, 12288
    s_mov_b32 s38, 1835008
    buffer_load_dwordx4 v184, s[12:15], s38 offen lds
    s_add_u32 m0, s33, 13312
    s_mov_b32 s38, 1966080
    buffer_load_dwordx4 v184, s[12:15], s38 offen lds
    s_waitcnt vmcnt(29)
    ds_read_b64_tr_b16 a[80:81], v186 offset:16384
    ds_read_b64_tr_b16 a[82:83], v186 offset:16640
    ds_read_b64_tr_b16 a[88:89], v186 offset:16416
    ds_read_b64_tr_b16 a[90:91], v186 offset:16672
    s_waitcnt lgkmcnt(4)
    s_add_u32 m0, s33, 14336
    s_mov_b32 s38, 1835008
    buffer_load_dwordx4 v184, s[16:19], s38 offen lds
    s_add_u32 m0, s33, 15360
    s_mov_b32 s38, 1966080
    buffer_load_dwordx4 v184, s[16:19], s38 offen lds
    s_waitcnt vmcnt(29)
    ds_read_b64_tr_b16 a[52:53], v186 offset:18432
    ds_read_b64_tr_b16 a[54:55], v186 offset:18688
    ds_read_b64_tr_b16 a[60:61], v186 offset:18464
    ds_read_b64_tr_b16 a[62:63], v186 offset:18720
    s_waitcnt lgkmcnt(4)
    s_add_u32 m0, s33, 16384
    s_mov_b32 s38, 0
    buffer_load_dwordx4 v185, s[20:23], s38 offen lds
    s_add_u32 m0, s33, 17408
    s_mov_b32 s38, 65536
    buffer_load_dwordx4 v185, s[20:23], s38 offen lds
    s_waitcnt vmcnt(29)
    ds_read_b64_tr_b16 a[68:69], v186 offset:20480
    ds_read_b64_tr_b16 a[70:71], v186 offset:20736
    ds_read_b64_tr_b16 a[76:77], v186 offset:20512
    ds_read_b64_tr_b16 a[78:79], v186 offset:20768
    s_waitcnt lgkmcnt(4)
    s_add_u32 m0, s33, 18432
    s_mov_b32 s38, 131072
    buffer_load_dwordx4 v185, s[20:23], s38 offen lds
    s_add_u32 m0, s33, 19456
    s_mov_b32 s38, 196608
    buffer_load_dwordx4 v185, s[20:23], s38 offen lds
    s_waitcnt vmcnt(29)
    ds_read_b64_tr_b16 a[84:85], v186 offset:22528
    ds_read_b64_tr_b16 a[86:87], v186 offset:22784
    ds_read_b64_tr_b16 a[92:93], v186 offset:22560
    ds_read_b64_tr_b16 a[94:95], v186 offset:22816
    s_waitcnt lgkmcnt(4)
    s_add_u32 m0, s33, 20480
    s_mov_b32 s38, 262144
    buffer_load_dwordx4 v185, s[20:23], s38 offen lds
    s_add_u32 m0, s33, 21504
    s_mov_b32 s38, 327680
    buffer_load_dwordx4 v185, s[20:23], s38 offen lds
    s_waitcnt vmcnt(29)
    ds_read_b64_tr_b16 a[96:97], v186 offset:24576
    ds_read_b64_tr_b16 a[98:99], v186 offset:24832
    ds_read_b64_tr_b16 a[104:105], v186 offset:24608
    ds_read_b64_tr_b16 a[106:107], v186 offset:24864
    s_waitcnt lgkmcnt(4)
    s_add_u32 m0, s33, 22528
    s_mov_b32 s38, 393216
    buffer_load_dwordx4 v185, s[20:23], s38 offen lds
    s_add_u32 m0, s33, 23552
    s_mov_b32 s38, 458752
    buffer_load_dwordx4 v185, s[20:23], s38 offen lds
    s_waitcnt vmcnt(29)
    ds_read_b64_tr_b16 a[112:113], v186 offset:26624
    ds_read_b64_tr_b16 a[114:115], v186 offset:26880
    ds_read_b64_tr_b16 a[120:121], v186 offset:26656
    ds_read_b64_tr_b16 a[122:123], v186 offset:26912
    s_waitcnt lgkmcnt(4)
    s_add_u32 m0, s33, 24576
    s_mov_b32 s38, 524288
    buffer_load_dwordx4 v185, s[20:23], s38 offen lds
    s_add_u32 m0, s33, 25600
    s_mov_b32 s38, 589824
    buffer_load_dwordx4 v185, s[20:23], s38 offen lds
    s_waitcnt vmcnt(29)
    ds_read_b64_tr_b16 a[128:129], v186 offset:28672
    ds_read_b64_tr_b16 a[130:131], v186 offset:28928
    ds_read_b64_tr_b16 a[136:137], v186 offset:28704
    ds_read_b64_tr_b16 a[138:139], v186 offset:28960
    s_waitcnt lgkmcnt(4)
    s_add_u32 m0, s33, 26624
    s_mov_b32 s38, 655360
    buffer_load_dwordx4 v185, s[20:23], s38 offen lds
    s_add_u32 m0, s33, 27648
    s_mov_b32 s38, 720896
    buffer_load_dwordx4 v185, s[20:23], s38 offen lds
    s_waitcnt vmcnt(29)
    ds_read_b64_tr_b16 a[100:101], v186 offset:30720
    ds_read_b64_tr_b16 a[102:103], v186 offset:30976
    ds_read_b64_tr_b16 a[108:109], v186 offset:30752
    ds_read_b64_tr_b16 a[110:111], v186 offset:31008
    s_waitcnt lgkmcnt(4)
    s_add_u32 m0, s33, 28672
    s_mov_b32 s38, 786432
    buffer_load_dwordx4 v185, s[20:23], s38 offen lds
    s_add_u32 m0, s33, 29696
    s_mov_b32 s38, 851968
    buffer_load_dwordx4 v185, s[20:23], s38 offen lds
    s_waitcnt vmcnt(29)
    ds_read_b64_tr_b16 a[116:117], v186 offset:0
    ds_read_b64_tr_b16 a[118:119], v186 offset:256
    ds_read_b64_tr_b16 a[124:125], v186 offset:32
    ds_read_b64_tr_b16 a[126:127], v186 offset:288
    s_waitcnt lgkmcnt(4)
    s_add_u32 m0, s33, 30720
    s_mov_b32 s38, 917504
    buffer_load_dwordx4 v185, s[20:23], s38 offen lds
    s_add_u32 m0, s33, 31744
    s_mov_b32 s38, 983040
    buffer_load_dwordx4 v185, s[20:23], s38 offen lds
    s_waitcnt vmcnt(28)
    s_branch valc_8
val_7:
    v_mov_b32 v2, 0
    global_load_dword v31, v2, s[92:93] offset:192 sc1
    s_add_u32 s41, s41, 1
    s_cmp_ge_u32 s41, 0x80000
    s_cbranch_scc1 L_end
    s_waitcnt vmcnt(0)
valc_8:
    v_readfirstlane_b32 s38, v31
    s_cmp_eq_u32 s38, s70
    s_cbranch_scc1 valok_9
    s_cmp_eq_u32 s38, 0
    s_cbranch_scc1 val_7
    s_mov_b32 s70, s38
    s_mov_b32 s71, 65536
    s_waitcnt vmcnt(0) lgkmcnt(0)
    s_barrier
    s_branch L_role
valok_9:
    s_barrier
rec_arr_6:
    ds_read_b64_tr_b16 a[132:133], v186 offset:2048
    ds_read_b64_tr_b16 a[134:135], v186 offset:2304
    ds_read_b64_tr_b16 a[140:141], v186 offset:2080
    ds_read_b64_tr_b16 a[142:143], v186 offset:2336
    s_waitcnt lgkmcnt(4)
    s_add_u32 m0, s33, 0
    s_mov_b32 s38, 1048576
    buffer_load_dwordx4 v185, s[20:23], s38 offen lds
    s_add_u32 m0, s33, 1024
    s_mov_b32 s38, 1114112
    buffer_load_dwordx4 v185, s[20:23], s38 offen lds
    s_waitcnt vmcnt(28)
    s_mov_b32 s24, s92
    s_and_b32 s25, s93, 0xffff
    s_mov_b32 s26, 256
    s_mov_b32 s27, 0x00020000
    s_add_u32 s48, s48, s71
    s_mov_b32 s38, 2130706432
    s_cmp_eq_u32 s31, 0
    s_cselect_b32 s38, 128, s38
    s_cselect_b32 s39, 0, s48
    s_cmp_eq_u32 s31, 3
    s_cselect_b32 s38, 0, s38
    v_mov_b32 v4, s38
    v_mov_b32 v2, 1
    v_mov_b32 v3, s39
    s_mov_b64 exec, 1
    buffer_atomic_add_x2 v[2:3], v4, s[24:27], 0 offen sc1
    s_mov_b64 exec, -1
    ds_read_b64_tr_b16 a[144:145], v186 offset:4096
    ds_read_b64_tr_b16 a[146:147], v186 offset:4352
    ds_read_b64_tr_b16 a[152:153], v186 offset:4128
    ds_read_b64_tr_b16 a[154:155], v186 offset:4384
    s_waitcnt lgkmcnt(4)
    s_add_u32 m0, s33, 2048
    s_mov_b32 s38, 1179648
    buffer_load_dwordx4 v185, s[20:23], s38 offen lds
    s_add_u32 m0, s33, 3072
    s_mov_b32 s38, 1245184
    buffer_load_dwordx4 v185, s[20:23], s38 offen lds
    s_waitcnt vmcnt(29)
    ds_read_b64_tr_b16 a[160:161], v186 offset:6144
    ds_read_b64_tr_b16 a[162:163], v186 offset:6400
    ds_read_b64_tr_b16 a[168:169], v186 offset:6176
    ds_read_b64_tr_b16 a[170:171], v186 offset:6432
    s_waitcnt lgkmcnt(4)
    s_add_u32 m0, s33, 4096
    s_mov_b32 s38, 1310720
    buffer_load_dwordx4 v185, s[20:23], s38 offen lds
    s_add_u32 m0, s33, 5120
    s_mov_b32 s38, 1376256
    buffer_load_dwordx4 v185, s[20:23], s38 offen lds
    s_waitcnt vmcnt(29)
    ds_read_b64_tr_b16 a[176:177], v186 offset:8192
    ds_read_b64_tr_b16 a[178:179], v186 offset:8448
    ds_read_b64_tr_b16 a[184:185], v186 offset:8224
    ds_read_b64_tr_b16 a[186:187], v186 offset:8480
    s_waitcnt lgkmcnt(4)
    s_add_u32 m0, s33, 6144
    s_mov_b32 s38, 1441792
    buffer_load_dwordx4 v185, s[20:23], s38 offen lds
    s_add_u32 m0, s33, 7168
    s_mov_b32 s38, 1507328
    buffer_load_dwordx4 v185, s[20:23], s38 offen lds
    s_waitcnt vmcnt(29)
    ds_read_b64_tr_b16 a[148:149], v186 offset:10240
    ds_read_b64_tr_b16 a[150:151], v186 offset:10496
    ds_read_b64_tr_b16 a[156:157], v186 offset:10272
    ds_read_b64_tr_b16 a[158:159], v186 offset:10528
    s_waitcnt lgkmcnt(4)
    s_add_u32 m0, s33, 8192
    s_mov_b32 s38, 1572864
    buffer_load_dwordx4 v185, s[20:23], s38 offen lds
    s_add_u32 m0, s33, 9216
    s_mov_b32 s38, 1638400
    buffer_load_dwordx4 v185, s[20:23], s38 offen lds
    s_waitcnt vmcnt(29)
    ds_read_b64_tr_b16 a[164:165], v186 offset:12288
    ds_read_b64_tr_b16 a[166:167], v186 offset:12544
    ds_read_b64_tr_b16 a[172:173], v186 offset:12320
    ds_read_b64_tr_b16 a[174:175], v186 offset:12576
    s_waitcnt lgkmcnt(4)
    s_add_u32 m0, s33, 10240
    s_mov_b32 s38, 1703936
    buffer_load_dwordx4 v185, s[20:23], s38 offen lds
    s_add_u32 m0, s33, 11264
    s_mov_b32 s38, 1769472
    buffer_load_dwordx4 v185, s[20:23], s38 offen lds
    s_waitcnt vmcnt(29)
    ds_read_b64_tr_b16 a[180:181], v186 offset:14336
    ds_read_b64_tr_b16 a[182:183], v186 offset:14592
    ds_read_b64_tr_b16 a[188:189], v186 offset:14368
    ds_read_b64_tr_b16 a[190:191], v186 offset:14624
    s_waitcnt lgkmcnt(4)
    s_add_u32 m0, s33, 12288
    s_mov_b32 s38, 1835008
    buffer_load_dwordx4 v185, s[20:23], s38 offen lds
    s_add_u32 m0, s33, 13312
    s_mov_b32 s38, 1900544
    buffer_load_dwordx4 v185, s[20:23], s38 offen lds
    s_waitcnt vmcnt(29)
    ds_read_b64_tr_b16 a[192:193], v187 offset:16384
    ds_read_b64_tr_b16 a[194:195], v187 offset:16512
    ds_read_b64_tr_b16 a[196:197], v187 offset:17408
    ds_read_b64_tr_b16 a[198:199], v187 offset:17536
    s_waitcnt lgkmcnt(4)
    s_add_u32 m0, s33, 14336
    s_mov_b32 s38, 1966080
    buffer_load_dwordx4 v185, s[20:23], s38 offen lds
    s_add_u32 m0, s33, 15360
    s_mov_b32 s38, 2031616
    buffer_load_dwordx4 v185, s[20:23], s38 offen lds
    s_waitcnt vmcnt(29)
    ds_read_b64_tr_b16 a[200:201], v187 offset:18432
    ds_read_b64_tr_b16 a[202:203], v187 offset:18560
    ds_read_b64_tr_b16 a[204:205], v187 offset:19456
    ds_read_b64_tr_b16 a[206:207], v187 offset:19584
    s_waitcnt vmcnt(27)
    ds_read_b64_tr_b16 a[208:209], v187 offset:20480
    ds_read_b64_tr_b16 a[210:211], v187 offset:20608
    ds_read_b64_tr_b16 a[212:213], v187 offset:21504
    ds_read_b64_tr_b16 a[214:215], v187 offset:21632
    s_waitcnt vmcnt(25)
    ds_read_b64_tr_b16 a[216:217], v187 offset:22528
    ds_read_b64_tr_b16 a[218:219], v187 offset:22656
    ds_read_b64_tr_b16 a[220:221], v187 offset:23552
    ds_read_b64_tr_b16 a[222:223], v187 offset:23680
    s_waitcnt vmcnt(23)
    ds_read_b64_tr_b16 a[224:225], v187 offset:24576
    ds_read_b64_tr_b16 a[226:227], v187 offset:24704
    ds_read_b64_tr_b16 a[228:229], v187 offset:25600
    ds_read_b64_tr_b16 a[230:231], v187 offset:25728
    s_waitcnt vmcnt(21)
    ds_read_b64_tr_b16 a[232:233], v187 offset:26624
    ds_read_b64_tr_b16 a[234:235], v187 offset:26752
    ds_read_b64_tr_b16 a[236:237], v187 offset:27648
    ds_read_b64_tr_b16 a[238:239], v187 offset:27776
    s_waitcnt vmcnt(19)
    ds_read_b64_tr_b16 a[240:241], v187 offset:28672
    ds_read_b64_tr_b16 a[242:243], v187 offset:28800
    ds_read_b64_tr_b16 a[244:245], v187 offset:29696
    ds_read_b64_tr_b16 a[246:247], v187 offset:29824
    s_waitcnt vmcnt(17)
    ds_read_b64_tr_b16 a[248:249], v187 offset:30720
    ds_read_b64_tr_b16 a[250:251], v187 offset:30848
    ds_read_b64_tr_b16 a[252:253], v187 offset:31744
    ds_read_b64_tr_b16 a[254:255], v187 offset:31872
    s_waitcnt vmcnt(15)
    ds_read_b64_tr_b16 v[192:193], v187 offset:0
    ds_read_b64_tr_b16 v[194:195], v187 offset:128
    ds_read_b64_tr_b16 v[196:197], v187 offset:1024
    ds_read_b64_tr_b16 v[198:199], v187 offset:1152
    s_waitcnt vmcnt(12)
    ds_read_b64_tr_b16 v[200:201], v187 offset:2048
    ds_read_b64_tr_b16 v[202:203], v187 offset:2176
    ds_read_b64_tr_b16 v[204:205], v187 offset:3072
    ds_read_b64_tr_b16 v[206:207], v187 offset:3200
    s_waitcnt vmcnt(10)
    ds_read_b64_tr_b16 v[208:209], v187 offset:4096
    ds_read_b64_tr_b16 v[210:211], v187 offset:4224
    ds_read_b64_tr_b16 v[212:213], v187 offset:5120
    ds_read_b64_tr_b16 v[214:215], v187 offset:5248
    s_waitcnt vmcnt(8)
    ds_read_b64_tr_b16 v[216:217], v187 offset:6144
    ds_read_b64_tr_b16 v[218:219], v187 offset:6272
    ds_read_b64_tr_b16 v[220:221], v187 offset:7168
    ds_read_b64_tr_b16 v[222:223], v187 offset:7296
    s_waitcnt vmcnt(6)
    ds_read_b64_tr_b16 v[224:225], v187 offset:8192
    ds_read_b64_tr_b16 v[226:227], v187 offset:8320
    ds_read_b64_tr_b16 v[228:229], v187 offset:9216
    ds_read_b64_tr_b16 v[230:231], v187 offset:9344
    s_waitcnt vmcnt(4)
    ds_read_b64_tr_b16 v[232:233], v187 offset:10240
    ds_read_b64_tr_b16 v[234:235], v187 offset:10368
    ds_read_b64_tr_b16 v[236:237], v187 offset:11264
    ds_read_b64_tr_b16 v[238:239], v187 offset:11392
    s_waitcnt vmcnt(2)
    global_load_dwordx2 v[98:99], v144, s[92:93] offset:0 sc1
    ds_read_b64_tr_b16 v[240:241], v187 offset:12288
    ds_read_b64_tr_b16 v[242:243], v187 offset:12416
    ds_read_b64_tr_b16 v[244:245], v187 offset:13312
    ds_read_b64_tr_b16 v[246:247], v187 offset:13440
    s_waitcnt vmcnt(1)
    ds_read_b64_tr_b16 v[248:249], v187 offset:14336
    ds_read_b64_tr_b16 v[250:251], v187 offset:14464
    ds_read_b64_tr_b16 v[252:253], v187 offset:15360
    ds_read_b64_tr_b16 v[254:255], v187 offset:15488
rec_wj_5:
    s_waitcnt lgkmcnt(0)
    v_max_u32 v36, 1, v36
    v_max_u32 v37, 1, v37
    v_max_u32 v38, 1, v38
    v_max_u32 v39, 1, v39
    v_max_u32 v40, 1, v40
    v_max_u32 v41, 1, v41
    v_max_u32 v42, 1, v42
    v_max_u32 v43, 1, v43
    v_max_u32 v44, 1, v44
    v_max_u32 v45, 1, v45
    v_max_u32 v46, 1, v46
    v_max_u32 v47, 1, v47
    v_max_u32 v48, 1, v48
    v_max_u32 v49, 1, v49
    v_max_u32 v50, 1, v50
    v_max_u32 v51, 1, v51
    v_mov_b32 v68, 0
    v_mov_b32 v69, 0
    v_mov_b32 v70, 0
    v_mov_b32 v71, 0
    v_mov_b32 v72, 0
    v_mov_b32 v73, 0
    v_mov_b32 v74, 0
    v_mov_b32 v75, 0
    v_mov_b32 v76, 0
    v_mov_b32 v77, 0
    v_mov_b32 v78, 0
    v_mov_b32 v79, 0
    v_mov_b32 v80, 0
    v_mov_b32 v81, 0
    v_mov_b32 v82, 0
    v_mov_b32 v83, 0
    v_mov_b32 v84, 0
    v_mov_b32 v85, 0
    v_mov_b32 v86, 0
    v_mov_b32 v87, 0
    v_mov_b32 v88, 0
    v_mov_b32 v89, 0
    v_mov_b32 v90, 0
    v_mov_b32 v91, 0
    s_mov_b32 s72, 0
    s_mov_b32 s73, 0
    s_mov_b32 s74, 0
    s_mov_b32 s75, 0
    s_mov_b32 s76, 0
    s_mov_b32 s77, 0
    s_mov_b32 s78, 0
    s_mov_b32 s79, 0
    s_mov_b32 s80, 0
    s_mov_b32 s81, 0
    s_mov_b32 s82, 0
    s_mov_b32 s83, 0
    s_mov_b32 s84, 0
    s_mov_b32 s85, 0
    s_mov_b32 s86, 0
    s_mov_b32 s87, 0
    v_mov_b32 v2, 0
    s_branch rec_ibq_12
rec_ibp_11:
    s_sleep 16
    global_load_dwordx2 v[98:99], v144, s[92:93] offset:0 sc1
    s_add_u32 s41, s41, 1
    s_cmp_ge_u32 s41, 0x80000
    s_cbranch_scc1 rec_ib_10
rec_ibq_12:
    s_waitcnt vmcnt(0)
    v_readfirstlane_b32 s39, v98
    v_readfirstlane_b32 s38, v99
    s_cmp_lt_u32 s39, 352
    s_cbranch_scc1 rec_ibp_11
rec_ib_10:
    s_mov_b32 s94, 1
    s_add_u32 m0, s51, s3
    s_nop 0
    buffer_load_dwordx4 v30, s[4:7], s37 offen sc1 lds
    s_lshr_b32 s96, s38, 16
    s_and_b32 s38, s38, 0xffff
    s_cmp_ge_u32 s38, 64
    s_cselect_b32 s48, -1, 0
    s_xor_b32 s48, s48, 0xaaa
    s_and_b32 s33, s48, 1
    s_lshl_b32 s33, s33, 13
    s_add_u32 s33, s33, s49
    s_add_u32 s38, s90, s95
    s_add_u32 s39, s90, s33
    s_xor_b32 s38, s38, s39
    s_lshr_b32 s39, s38, 8
    s_xor_b32 s38, s38, s39
    s_and_b32 s38, s38, 8192
    s_add_u32 s95, s95, s38
    s_add_u32 s34, s33, 262144
    s_add_u32 s35, s33, 524288
    s_lshr_b32 s38, s28, 5
    s_lshl_b32 s38, s38, 4
    s_lshl_b32 s40, s30, 14
    s_add_u32 s38, s38, s40
    s_add_u32 s38, s38, s33
    s_add_u32 s38, s38, 163840
    v_and_b32 v132, 31, v1
    v_lshlrev_b32 v132, 8, v132
    v_add_u32 v132, s38, v132
    s_and_b32 s39, s29, 23
    s_cmp_eq_u32 s39, 3
    s_mov_b32 vcc_hi, 0
    s_cselect_b32 vcc_lo, -1, 0
    v_mov_b32 v4, 2130706432
    v_cndmask_b32 v132, v4, v132, vcc
    v_add_u32 v133, 128, v132
    s_and_b32 s39, s29, 31
    s_cmp_eq_u32 s39, 3
    s_cselect_b32 s39, s31, 99
    s_cmp_eq_u32 s39, 1
    s_cselect_b64 vcc, -1, 0
    v_mov_b32 v4, 2130706432
    v_cndmask_b32 v133, v4, v133, vcc
    s_lshr_b32 s55, s28, 5
    s_lshl_b32 s55, s55, 14
    s_and_b32 s40, s28, 31
    s_lshl_b32 s40, s40, 8
    s_add_u32 s55, s55, s40
    s_add_u32 s55, s55, s33
    s_add_u32 s55, s55, 163840
    s_add_u32 s44, s55, 128
    v_mov_b32 v26, 2130706432
    s_mov_b32 s98, 0
    s_mov_b32 s99, 0
    s_mov_b32 s88, 88080384
    s_mov_b32 s89, 65536
    v_mov_b32 v188, 0
    v_mov_b32 v189, 0
    v_mov_b32 v190, 0
    v_mov_b32 v191, 0
    s_cmp_eq_u32 s31, 1
    s_cbranch_scc1 rec_gs1_14
    s_cmp_eq_u32 s31, 2
    s_cbranch_scc1 rec_gs2_15
    s_cmp_eq_u32 s31, 3
    s_cbranch_scc1 rec_gs3_16
    v_mov_b32 v93, v19
    v_mov_b32 v180, -1
    v_mov_b32 v181, -1
    v_mov_b32 v182, -1
    v_mov_b32 v183, -1
    s_mov_b32 s88, 97255424
    s_mov_b32 s89, 262144
    s_branch rec_gs_13
rec_gs1_14:
    v_mov_b32 v26, v19
    s_mov_b64 vcc, 0xffff
    v_mov_b32 v4, 2130706432
    v_cndmask_b32 v26, v4, v26, vcc
    v_mov_b32 v188, -1
    v_mov_b32 v189, -1
    v_mov_b32 v190, -1
    v_mov_b32 v191, -1
    s_mov_b32 s98, 97256448
    s_mov_b32 s99, 262144
    s_branch rec_gs_13
rec_gs2_15:
    v_mov_b32 v26, v137
    s_branch rec_gs_13
rec_gs3_16:
    s_lshr_b32 s38, s29, 3
    s_lshl_b32 s38, s38, 14
    s_and_b32 s40, s29, 7
    s_lshl_b32 s40, s40, 10
    s_add_u32 s38, s38, s40
    s_and_b32 s40, s30, 1
    s_lshl_b32 s40, s40, 9
    s_add_u32 s38, s38, s40
    s_lshr_b32 s40, s30, 1
    s_lshl_b32 s40, s40, 7
    s_add_u32 s38, s38, s40
    v_bfe_u32 v2, v1, 4, 1
    v_lshlrev_b32 v2, 16, v2
    v_bfe_u32 v4, v1, 3, 1
    v_lshl_add_u32 v2, v4, 8, v2
    v_and_b32 v4, 7, v1
    v_lshl_add_u32 v2, v4, 4, v2
    v_add_u32 v2, s38, v2
    s_mov_b32 vcc_lo, 0
    s_mov_b32 vcc_hi, -1
    v_cndmask_b32 v93, v93, v2, vcc
    s_mov_b32 s88, s35
rec_gs_13:
    s_cmp_eq_u32 s31, 2
    s_cselect_b32 s45, 1, 0
    s_mov_b32 s72, 0
    s_mov_b32 s73, 0
    s_mov_b32 s74, 0
    s_mov_b32 s75, 0
    s_mov_b32 s76, 0
    s_mov_b32 s77, 0
    s_mov_b32 s78, 0
    s_mov_b32 s79, 0
    s_mov_b32 s80, 0
    s_mov_b32 s81, 0
    s_mov_b32 s82, 0
    s_mov_b32 s83, 0
    s_mov_b32 s84, 0
    s_mov_b32 s85, 0
    s_mov_b32 s86, 0
    s_mov_b32 s87, 0
    s_waitcnt vmcnt(0)
    s_barrier
    s_branch rec_entry_17
rec_loop_18:
    s_barrier
    buffer_load_dwordx4 v[36:39], v7, s[4:7], s33 offen offset:0 sc1
    s_nop 3
    buffer_load_dwordx4 v[40:43], v7, s[4:7], s33 offen offset:1024 sc1
    s_nop 3
    buffer_load_dwordx4 v[44:47], v7, s[4:7], s33 offen offset:2048 sc1
    s_nop 3
    buffer_load_dwordx4 v[48:51], v7, s[4:7], s33 offen offset:3072 sc1
rec_entry_17:
    v_add_u32 v2, s51, v16
    ds_read_b128 v[60:63], v2 offset:0
    ds_read_b128 v[64:67], v2 offset:1024
    ds_read_b128 v[52:55], v2 offset:2048
    ds_read_b128 v[56:59], v2 offset:3072
    s_waitcnt vmcnt(3)
    v_smfmac_f32_16x16x64_bf16 v[68:71], v[36:39], a[0:7], v5
    v_min_u32 v31, v36, v37
    v_smfmac_f32_16x16x64_bf16 v[72:75], v[36:39], a[8:15], v5
    v_min_u32 v4, v38, v39
    v_smfmac_f32_16x16x64_bf16 v[76:79], v[36:39], a[16:23], v5
    v_smfmac_f32_16x16x64_bf16 v[80:83], v[36:39], a[24:31], v5
    s_waitcnt vmcnt(2)
    v_smfmac_f32_16x16x64_bf16 v[68:71], v[40:43], a[48:55], v5
    v_min3_u32 v31, v31, v40, v41
    v_smfmac_f32_16x16x64_bf16 v[72:75], v[40:43], a[56:63], v5
    v_min3_u32 v4, v4, v42, v43
    v_smfmac_f32_16x16x64_bf16 v[76:79], v[40:43], a[64:71], v5
    v_smfmac_f32_16x16x64_bf16 v[80:83], v[40:43], a[72:79], v5
    s_waitcnt vmcnt(1)
    v_smfmac_f32_16x16x64_bf16 v[68:71], v[44:47], a[96:103], v5
    v_min3_u32 v31, v31, v44, v45
    v_smfmac_f32_16x16x64_bf16 v[72:75], v[44:47], a[104:111], v5
    v_min3_u32 v4, v4, v46, v47
    v_smfmac_f32_16x16x64_bf16 v[76:79], v[44:47], a[112:119], v5
    v_min_u32 v31, v31, v4
    v_smfmac_f32_16x16x64_bf16 v[80:83], v[44:47], a[120:127], v5
    s_waitcnt vmcnt(0)
    v_min3_u32 v31, v31, v48, v49
    v_smfmac_f32_16x16x64_bf16 v[68:71], v[48:51], a[144:151], v5
    v_min3_u32 v31, v31, v50, v51
    v_smfmac_f32_16x16x64_bf16 v[72:75], v[48:51], a[152:159], v5
    v_cmp_eq_u32 vcc, 0, v31
    v_smfmac_f32_16x16x64_bf16 v[76:79], v[48:51], a[160:167], v5
    v_smfmac_f32_16x16x64_bf16 v[80:83], v[48:51], a[168:175], v5
    s_cbranch_vccnz rec_gafix_21
rec_gaok_20:
    s_nop 1
    v_pk_add_f32 v[68:69], v[68:69], v[70:71]
    s_nop 0
    v_pk_add_f32 v[70:71], v[72:73], v[74:75]
    ds_write2_b32 v14, v68, v69 offset0:0 offset1:40
    ds_write2_b32 v14, v70, v71 offset0:16 offset1:56
    v_pk_add_f32 v[76:77], v[76:77], v[78:79]
    v_pk_add_f32 v[78:79], v[80:81], v[82:83]
    ds_write2_b32 v15, v76, v77 offset0:0 offset1:40
    ds_write2_b32 v15, v78, v79 offset0:16 offset1:56
    s_cmp_lg_u32 s31, 0
    s_cbranch_scc1 rec_w1_24
    s_waitcnt lgkmcnt(0)
    s_barrier
    ds_read_b128 v[100:103], v18 offset:0
    v_smfmac_f32_16x16x64_bf16 v[84:87], v[36:39], a[32:39], v5
    ds_read_b128 v[104:107], v18 offset:32
    v_smfmac_f32_16x16x64_bf16 v[88:91], v[36:39], a[40:47], v5
    ds_read_b128 v[108:111], v18 offset:2560
    v_smfmac_f32_16x16x64_bf16 v[84:87], v[40:43], a[80:87], v5
    ds_read_b128 v[112:115], v18 offset:2592
    v_smfmac_f32_16x16x64_bf16 v[88:91], v[40:43], a[88:95], v5
    ds_read_b128 v[116:119], v18 offset:5120
    v_smfmac_f32_16x16x64_bf16 v[84:87], v[44:47], a[128:135], v5
    ds_read_b128 v[120:123], v18 offset:5152
    v_smfmac_f32_16x16x64_bf16 v[88:91], v[44:47], a[136:143], v5
    ds_read_b128 v[124:127], v18 offset:7680
    v_smfmac_f32_16x16x64_bf16 v[84:87], v[48:51], a[176:183], v5
    ds_read_b128 v[128:131], v18 offset:7712
    v_smfmac_f32_16x16x64_bf16 v[88:91], v[48:51], a[184:191], v5
    s_waitcnt lgkmcnt(4)
    v_pk_add_f32 v[100:101], v[100:101], v[108:109]
    v_pk_add_f32 v[102:103], v[102:103], v[110:111]
    v_pk_add_f32 v[104:105], v[104:105], v[112:113]
    v_pk_add_f32 v[106:107], v[106:107], v[114:115]
    s_waitcnt lgkmcnt(2)
    v_pk_add_f32 v[100:101], v[100:101], v[116:117]
    v_pk_add_f32 v[102:103], v[102:103], v[118:119]
    v_pk_add_f32 v[104:105], v[104:105], v[120:121]
    v_pk_add_f32 v[106:107], v[106:107], v[122:123]
    s_waitcnt lgkmcnt(0)
    v_pk_add_f32 v[100:101], v[100:101], v[124:125]
    v_pk_add_f32 v[102:103], v[102:103], v[126:127]
    v_pk_add_f32 v[104:105], v[104:105], v[128:129]
    v_pk_add_f32 v[106:107], v[106:107], v[130:131]
    v_cvt_pk_bf16_f32 v96, v100, v101
    v_cvt_pk_bf16_f32 v97, v102, v103
    v_cvt_pk_bf16_f32 v98, v104, v105
    v_cvt_pk_bf16_f32 v99, v106, v107
    s_nop 1
    v_mfma_f32_16x16x32_bf16 v[68:71], v[60:63], v[96:99], 0
    v_mfma_f32_16x16x32_bf16 v[72:75], v[64:67], v[96:99], 0
    v_mfma_f32_16x16x32_bf16 v[76:79], v[96:99], v[96:99], 0
    s_cmp_lg_u32 s96, 0
    v_pk_add_f32 v[84:85], v[84:85], v[86:87]
    v_pk_add_f32 v[86:87], v[88:89], v[90:91]
    s_cbranch_scc1 rec_slow_25
    s_mov_b64 exec, s[42:43]
    s_nop 0
    buffer_store_dwordx4 v[68:71], v19, s[4:7], s36 offen
    buffer_store_dwordx4 v[72:75], v19, s[4:7], s36 offen offset:128
    s_mov_b64 exec, s[46:47]
    buffer_store_dwordx4 v[76:79], v20, s[4:7], s36 offen offset:1024
    s_mov_b64 exec, -1
rec_slowr_26:
    ds_write_b128 v17, v[84:87]
    ds_write_b128 v16, v[96:99] offset:15360
    s_waitcnt lgkmcnt(0)
    s_barrier
    ds_read_b64 v[100:101], v25 offset:0
    ds_read_b64 v[102:103], v25 offset:128
    ds_read_b64 v[104:105], v25 offset:1024
    ds_read_b64 v[106:107], v25 offset:1152
    ds_read_b64 v[108:109], v25 offset:2048
    ds_read_b64 v[110:111], v25 offset:2176
    ds_read_b64 v[112:113], v25 offset:3072
    ds_read_b64 v[114:115], v25 offset:3200
    v_mov_b32_dpp v68, v72 row_ror:8 row_mask:0xf bank_mask:0xc
    v_mov_b32_dpp v69, v73 row_ror:8 row_mask:0xf bank_mask:0xc
    v_mov_b32_dpp v70, v74 row_ror:8 row_mask:0xf bank_mask:0xc
    v_mov_b32_dpp v71, v75 row_ror:8 row_mask:0xf bank_mask:0xc
    buffer_load_dwordx4 v[176:179], v21, s[4:7], s36 offen offset:1024 sc1
    buffer_load_dwordx4 v[164:167], v22, s[4:7], s36 offen sc1
    buffer_load_dwordx4 v[168:171], v23, s[4:7], s36 offen sc1
    buffer_load_dwordx4 v[172:175], v24, s[4:7], s36 offen sc1
    s_waitcnt lgkmcnt(0)
    v_pk_add_f32 v[100:101], v[100:101], v[104:105]
    v_pk_add_f32 v[102:103], v[102:103], v[106:107]
    v_pk_add_f32 v[108:109], v[108:109], v[112:113]
    v_pk_add_f32 v[110:111], v[110:111], v[114:115]
    v_pk_add_f32 v[100:101], v[100:101], v[108:109]
    v_pk_add_f32 v[102:103], v[102:103], v[110:111]
    v_cvt_pk_bf16_f32 v138, v100, v101
    v_cvt_pk_bf16_f32 v140, v102, v103
    s_nop 15
    buffer_load_dwordx4 v[48:51], v21, s[4:7], s36 offen offset:1024 sc1
    buffer_load_dwordx4 v[36:39], v22, s[4:7], s36 offen sc1
    buffer_load_dwordx4 v[40:43], v23, s[4:7], s36 offen sc1
    buffer_load_dwordx4 v[44:47], v24, s[4:7], s36 offen sc1
    s_cmp_eq_u32 s32, 63
    s_cbranch_scc1 rec_b2_23
    s_waitcnt vmcnt(7)
    v_permlane32_swap_b32 v176, v178
    v_permlane32_swap_b32 v177, v179
    v_pk_add_f32 v[124:125], v[176:177], v[178:179]
    s_waitcnt vmcnt(6)
    v_pk_add_f32 v[120:121], v[68:69], v[164:165]
    v_pk_add_f32 v[122:123], v[70:71], v[166:167]
    v_permlane16_swap_b32 v124, v125
    s_waitcnt vmcnt(5)
    v_pk_add_f32 v[120:121], v[120:121], v[168:169]
    v_pk_add_f32 v[122:123], v[122:123], v[170:171]
    v_add_f32 v124, v124, v125
    s_waitcnt vmcnt(4)
    v_pk_add_f32 v[120:121], v[120:121], v[172:173]
    v_pk_add_f32 v[122:123], v[122:123], v[174:175]
    v_maximum3_f32 v135, v120, v121, v124
    v_maximum3_f32 v135, v135, v122, v123
    v_cmp_u_f32 vcc, v135, v135
    s_nop 0
    v_max_f32_dpp v135, v135, v135 row_ror:8 row_mask:0xf bank_mask:0xf
    v_mov_b32 v136, v135
    s_cbranch_vccnz rec_gbr_27
rec_gbo_28:
    buffer_store_dword v134, v132, s[4:7], 0 offen sc1
    v_permlane16_swap_b32 v135, v136
    v_max_f32 v135, v135, v136
    v_mov_b32 v136, v135
    s_nop 1
    v_permlane32_swap_b32 v135, v136
    v_max_f32 v135, v135, v136
    v_mul_f32 v135, s50, v135
    v_fma_f32 v124, v124, s50, -v135
    v_fma_f32 v120, v120, s50, -v135
    v_fma_f32 v121, v121, s50, -v135
    v_fma_f32 v122, v122, s50, -v135
    v_fma_f32 v123, v123, s50, -v135
    v_exp_f32 v124, v124
    v_exp_f32 v120, v120
    v_exp_f32 v121, v121
    v_exp_f32 v122, v122
    v_exp_f32 v123, v123
    v_mov_b32_dpp v125, v124 row_ror:8 row_mask:0xf bank_mask:0xf
    v_cvt_pk_bf16_f32 v156, v120, v121
    v_cvt_pk_bf16_f32 v157, v122, v123
    v_cvt_pk_bf16_f32 v160, v124, v125
    v_mov_b32_dpp v158, v156 row_ror:8 row_mask:0xf bank_mask:0xf
    v_mov_b32_dpp v159, v157 row_ror:8 row_mask:0xf bank_mask:0xf
    v_mfma_f32_16x16x32_bf16 v[116:119], v[32:35], v[160:163], 0
    s_nop 0
    v_mfma_f32_16x16x32_bf16 v[116:119], v[32:35], v[156:159], v[116:119]
    v_mfma_f32_16x16x32_bf16 v[108:111], v[52:55], v[156:159], 0
    v_mfma_f32_16x16x32_bf16 v[108:111], v[138:141], v[160:163], v[108:111]
    v_mfma_f32_16x16x32_bf16 v[112:115], v[56:59], v[156:159], 0
    v_mfma_f32_16x16x32_bf16 v[112:115], v[140:143], v[160:163], v[112:115]
    s_nop 3
    v_rcp_f32 v100, v116
    s_nop 0
    v_mov_b32 v101, v100
    v_pk_mul_f32 v[108:109], v[108:109], v[100:101]
    v_pk_mul_f32 v[110:111], v[110:111], v[100:101]
    v_pk_mul_f32 v[112:113], v[112:113], v[100:101]
    v_pk_mul_f32 v[114:115], v[114:115], v[100:101]
    v_cvt_pk_bf16_f32 v108, v108, v109
    v_cvt_pk_bf16_f32 v109, v110, v111
    v_cvt_pk_bf16_f32 v110, v112, v113
    v_cvt_pk_bf16_f32 v111, v114, v115
    v_max_u32 v108, 1, v108
    v_max_u32 v109, 1, v109
    v_max_u32 v110, 1, v110
    v_max_u32 v111, 1, v111
    s_mov_b64 exec, s[42:43]
    buffer_store_dwordx4 v[108:111], v27, s[4:7], s33 offen sc1
    s_mov_b64 exec, -1
    v_mov_b64 v[68:69], 0
    v_mov_b64 v[70:71], 0
    v_mov_b64 v[72:73], 0
    v_mov_b64 v[74:75], 0
    v_mov_b64 v[76:77], 0
    v_mov_b64 v[78:79], 0
    v_mov_b64 v[80:81], 0
    v_mov_b64 v[82:83], 0
    v_mov_b64 v[84:85], 0
    v_mov_b64 v[86:87], 0
    v_mov_b64 v[88:89], 0
    v_mov_b64 v[90:91], 0
rec_cs_30:
    s_barrier
    buffer_load_dwordx4 v[36:39], v12, s[4:7], s33 offen offset:0 sc1
    s_nop 3
    buffer_load_dwordx4 v[40:43], v12, s[4:7], s33 offen offset:1024 sc1
    s_nop 3
    buffer_load_dwordx4 v[44:47], v12, s[4:7], s33 offen offset:2048 sc1
    s_nop 3
    buffer_load_dwordx4 v[48:51], v12, s[4:7], s33 offen offset:3072 sc1
    s_nop 3
    buffer_load_dwordx4 v[52:55], v13, s[4:7], s33 offen offset:0 sc1
    s_nop 3
    buffer_load_dwordx4 v[56:59], v13, s[4:7], s33 offen offset:1024 sc1
    s_nop 3
    buffer_load_dwordx4 v[60:63], v13, s[4:7], s33 offen offset:2048 sc1
    s_nop 3
    buffer_load_dwordx4 v[64:67], v13, s[4:7], s33 offen offset:3072 sc1
    s_waitcnt vmcnt(7)
    v_smfmac_f32_16x16x64_bf16 v[68:71], v[36:39], a[192:199], v5
    v_min_u32 v31, v36, v37
    v_smfmac_f32_16x16x64_bf16 v[72:75], v[36:39], a[200:207], v5
    v_min_u32 v4, v38, v39
    s_add_u32 s38, s32, 1
    s_cmp_gt_u32 s94, s38
    s_cbranch_scc0 rec_kv_34
rec_kvd_35:
    s_xor_b32 s51, s51, 4096
    s_add_u32 m0, s51, s3
    s_add_u32 s37, s37, 262144
    buffer_load_dwordx4 v30, s[4:7], s37 offen sc1 lds
    s_waitcnt vmcnt(7)
    v_smfmac_f32_16x16x64_bf16 v[68:71], v[40:43], a[208:215], v5
    v_min3_u32 v31, v31, v40, v41
    v_smfmac_f32_16x16x64_bf16 v[72:75], v[40:43], a[216:223], v5
    v_min3_u32 v4, v4, v42, v43
    buffer_load_dword v3, v92, s[4:7], s36 offen sc1
    s_waitcnt vmcnt(7)
    v_smfmac_f32_16x16x64_bf16 v[68:71], v[44:47], a[224:231], v5
    v_min3_u32 v31, v31, v44, v45
    v_smfmac_f32_16x16x64_bf16 v[72:75], v[44:47], a[232:239], v5
    v_min3_u32 v4, v4, v46, v47
    s_waitcnt vmcnt(6)
    v_smfmac_f32_16x16x64_bf16 v[68:71], v[48:51], a[240:247], v5
    v_min3_u32 v31, v31, v48, v49
    v_smfmac_f32_16x16x64_bf16 v[72:75], v[48:51], a[248:255], v5
    v_min3_u32 v4, v4, v50, v51
    s_waitcnt vmcnt(5)
    v_smfmac_f32_16x16x64_bf16 v[68:71], v[52:55], v[192:199], v5
    v_min3_u32 v31, v31, v52, v53
    v_smfmac_f32_16x16x64_bf16 v[72:75], v[52:55], v[200:207], v5
    v_min3_u32 v4, v4, v54, v55
    s_waitcnt vmcnt(4)
    v_smfmac_f32_16x16x64_bf16 v[68:71], v[56:59], v[208:215], v5
    v_min3_u32 v31, v31, v56, v57
    v_smfmac_f32_16x16x64_bf16 v[72:75], v[56:59], v[216:223], v5
    v_min3_u32 v4, v4, v58, v59
    s_waitcnt vmcnt(3)
    v_smfmac_f32_16x16x64_bf16 v[68:71], v[60:63], v[224:231], v5
    v_min3_u32 v31, v31, v60, v61
    v_smfmac_f32_16x16x64_bf16 v[72:75], v[60:63], v[232:239], v5
    v_min3_u32 v4, v4, v62, v63
    v_min_u32 v31, v31, v4
    s_waitcnt vmcnt(2)
    v_min3_u32 v31, v31, v64, v65
    v_smfmac_f32_16x16x64_bf16 v[68:71], v[64:67], v[240:247], v5
    v_min3_u32 v31, v31, v66, v67
    v_smfmac_f32_16x16x64_bf16 v[72:75], v[64:67], v[248:255], v5
    v_cmp_eq_u32 vcc, 0, v31
    s_add_u32 s32, s32, 1
    s_add_u32 s38, s32, 2
    s_lshr_b32 s39, s38, 3
    s_lshr_b32 s39, s48, s39
    s_cbranch_vccnz rec_gcfix_32
rec_gcok_31:
    s_mov_b32 s33, s34
    s_mov_b32 s34, s35
    s_nop 0
    v_pk_add_f32 v[68:69], v[68:69], v[70:71]
    s_nop 1
    v_add_f32_dpp v68, v72, v74 quad_perm:[0,1,2,3] row_mask:0xc bank_mask:0xf
    v_add_f32_dpp v69, v73, v75 quad_perm:[0,1,2,3] row_mask:0xc bank_mask:0xf
    s_nop 1
    v_permlane32_swap_b32 v68, v69
    v_add_f32 v68, v68, v69
    ds_write_b32 v28, v68
    s_and_b32 s35, s39, 1
    s_lshl_b32 s35, s35, 13
    s_lshl_b32 s40, s38, 18
    s_add_u32 s35, s35, s40
    s_add_u32 s35, s35, s49
    s_add_u32 s36, s36, 262144
    s_cmp_lg_u32 s31, 0
    s_cbranch_scc1 rec_b4_36
    s_waitcnt lgkmcnt(0)
    s_barrier
    ds_read_b64 v[100:101], v29 offset:0
    ds_read_b64 v[102:103], v29 offset:256
    ds_read_b64 v[104:105], v29 offset:512
    ds_read_b64 v[106:107], v29 offset:768
    v_add_u32 v134, 2, v134
    s_waitcnt lgkmcnt(0)
    v_pk_add_f32 v[100:101], v[100:101], v[102:103]
    v_pk_add_f32 v[104:105], v[104:105], v[106:107]
    v_pk_add_f32 v[100:101], v[100:101], v[104:105]
    v_cvt_pk_bf16_f32 v100, v100, v101
    v_max_u32 v100, 1, v100
    s_nop 1
    v_mov_b32_dpp v101, v100 quad_perm:[1,1,1,1] row_mask:0xf bank_mask:0xf
    v_mov_b32_dpp v102, v100 quad_perm:[2,2,2,2] row_mask:0xf bank_mask:0xf
    v_mov_b32_dpp v103, v100 quad_perm:[3,3,3,3] row_mask:0xf bank_mask:0xf
    s_mov_b64 exec, 0x11111111
    buffer_store_dwordx4 v[100:103], v6, s[4:7], s33 offen sc1
    s_mov_b64 exec, -1
    s_barrier
    buffer_store_dwordx4 v[180:183], v93, s[4:7], s88 offen sc1
    s_add_u32 s98, s98, s99
    s_add_u32 s38, s32, 3
    s_min_u32 s38, s38, 63
    s_cmp_gt_u32 s94, s38
    s_cbranch_scc1 rec_rf_37
    s_load_dword s94, s[90:91], s95 glc
rec_rf_37:
    s_add_u32 s88, s88, s89
    s_cmp_eq_u32 s31, 3
    s_cselect_b32 s88, s35, s88
    v_mov_b64 v[68:69], 0
    v_mov_b64 v[70:71], 0
    v_mov_b64 v[72:73], 0
    v_mov_b64 v[74:75], 0
    s_waitcnt vmcnt(2)
    s_branch rec_loop_18
rec_b4_36:
    s_waitcnt lgkmcnt(0)
    s_barrier
    buffer_store_dword v134, v133, s[4:7], 0 offen sc1
    s_cmp_eq_u32 s31, 3
    s_cbranch_scc1 rec_w3b_38
    v_add_u32 v134, 2, v134
    v_mov_b64 v[68:69], 0
    v_mov_b64 v[70:71], 0
    v_mov_b64 v[72:73], 0
    v_mov_b64 v[74:75], 0
    s_barrier
    buffer_store_dwordx4 v[180:183], v93, s[4:7], s88 offen sc1
    buffer_store_dwordx4 v[188:191], v26, s[4:7], s98 offen sc1
    s_add_u32 s98, s98, s99
    s_nop 0
    v_add_u32 v188, s45, v188
    s_add_u32 s38, s32, 3
    s_min_u32 s38, s38, 63
    s_cmp_gt_u32 s94, s38
    s_cbranch_scc1 rec_rf_39
    s_load_dword s94, s[90:91], s95 glc
rec_rf_39:
    s_add_u32 s88, s88, s89
    s_cmp_eq_u32 s31, 3
    s_cselect_b32 s88, s35, s88
    s_waitcnt vmcnt(2)
    s_branch rec_loop_18
rec_w3b_38:
    v_add_u32 v134, 2, v134
    v_mov_b64 v[68:69], 0
    v_mov_b64 v[70:71], 0
    v_mov_b64 v[72:73], 0
    v_mov_b64 v[74:75], 0
    s_load_dword s72, s[90:91], s44 glc
    s_barrier
    s_load_dword s72, s[90:91], s44 glc
    buffer_store_dwordx4 v[180:183], v93, s[4:7], s88 offen sc1
    s_add_u32 s98, s98, s99
    s_add_u32 s38, s32, 3
    s_min_u32 s38, s38, 63
    s_cmp_gt_u32 s94, s38
    s_cbranch_scc1 rec_rf_40
    s_load_dword s94, s[90:91], s95 glc
rec_rf_40:
    s_add_u32 s88, s88, s89
    s_cmp_eq_u32 s31, 3
    s_cselect_b32 s88, s35, s88
    s_load_dword s72, s[90:91], s44 glc
    s_waitcnt vmcnt(2)
    s_branch rec_tkc_43
rec_tk_41:
    s_load_dword s72, s[90:91], s44 glc
    s_add_u32 s41, s41, 1
    s_cmp_ge_u32 s41, 0x80000
    s_cbranch_scc1 rec_tkd_42
    s_sleep 1
rec_tkc_43:
    s_mov_b32 s38, s72
    s_cmp_lt_u32 s38, s54
    s_cbranch_scc1 rec_tk_41
rec_tkd_42:
    s_add_u32 s54, s54, 1
    s_sleep 1
    s_branch rec_loop_18
rec_gafix_21:
    s_add_u32 s41, s41, 1
    s_cmp_ge_u32 s41, 0x80000
    s_cbranch_scc1 rec_gaok_20
    buffer_load_dwordx4 v[36:39], v7, s[4:7], s33 offen offset:0 sc1
    buffer_load_dwordx4 v[40:43], v7, s[4:7], s33 offen offset:1024 sc1
    buffer_load_dwordx4 v[44:47], v7, s[4:7], s33 offen offset:2048 sc1
    buffer_load_dwordx4 v[48:51], v7, s[4:7], s33 offen offset:3072 sc1
    v_mov_b64 v[68:69], 0
    v_mov_b64 v[70:71], 0
    v_mov_b64 v[72:73], 0
    v_mov_b64 v[74:75], 0
    v_mov_b64 v[76:77], 0
    v_mov_b64 v[78:79], 0
    v_mov_b64 v[80:81], 0
    v_mov_b64 v[82:83], 0
    s_waitcnt vmcnt(3)
    v_smfmac_f32_16x16x64_bf16 v[68:71], v[36:39], a[0:7], v5
    v_min_u32 v31, v36, v37
    v_smfmac_f32_16x16x64_bf16 v[72:75], v[36:39], a[8:15], v5
    v_min_u32 v4, v38, v39
    v_smfmac_f32_16x16x64_bf16 v[76:79], v[36:39], a[16:23], v5
    v_smfmac_f32_16x16x64_bf16 v[80:83], v[36:39], a[24:31], v5
    s_waitcnt vmcnt(2)
    v_smfmac_f32_16x16x64_bf16 v[68:71], v[40:43], a[48:55], v5
    v_min3_u32 v31, v31, v40, v41
    v_smfmac_f32_16x16x64_bf16 v[72:75], v[40:43], a[56:63], v5
    v_min3_u32 v4, v4, v42, v43
    v_smfmac_f32_16x16x64_bf16 v[76:79], v[40:43], a[64:71], v5
    v_smfmac_f32_16x16x64_bf16 v[80:83], v[40:43], a[72:79], v5
    s_waitcnt vmcnt(1)
    v_smfmac_f32_16x16x64_bf16 v[68:71], v[44:47], a[96:103], v5
    v_min3_u32 v31, v31, v44, v45
    v_smfmac_f32_16x16x64_bf16 v[72:75], v[44:47], a[104:111], v5
    v_min3_u32 v4, v4, v46, v47
    v_smfmac_f32_16x16x64_bf16 v[76:79], v[44:47], a[112:119], v5
    v_min_u32 v31, v31, v4
    v_smfmac_f32_16x16x64_bf16 v[80:83], v[44:47], a[120:127], v5
    s_waitcnt vmcnt(0)
    v_min3_u32 v31, v31, v48, v49
    v_smfmac_f32_16x16x64_bf16 v[68:71], v[48:51], a[144:151], v5
    v_min3_u32 v31, v31, v50, v51
    v_smfmac_f32_16x16x64_bf16 v[72:75], v[48:51], a[152:159], v5
    v_cmp_eq_u32 vcc, 0, v31
    v_smfmac_f32_16x16x64_bf16 v[76:79], v[48:51], a[160:167], v5
    v_smfmac_f32_16x16x64_bf16 v[80:83], v[48:51], a[168:175], v5
    s_cbranch_vccnz rec_gafix_21
    s_branch rec_gaok_20
rec_slow_25:
    s_mov_b64 exec, s[42:43]
    s_nop 0
    buffer_store_dwordx4 v[68:71], v19, s[4:7], s36 offen sc1
    buffer_store_dwordx4 v[72:75], v19, s[4:7], s36 offen offset:128 sc1
    s_mov_b64 exec, s[46:47]
    buffer_store_dwordx4 v[76:79], v20, s[4:7], s36 offen offset:1024 sc1
    s_mov_b64 exec, -1
    s_branch rec_slowr_26
rec_gbr_27:
    v_max3_u32 v31, v164, v165, v166
    v_max3_u32 v31, v31, v167, v168
    v_max3_u32 v31, v31, v169, v170
    v_max3_u32 v31, v31, v171, v172
    v_max3_u32 v31, v31, v173, v174
    v_max3_u32 v31, v31, v175, v176
    v_max3_u32 v31, v31, v177, v178
    v_max_u32 v31, v31, v179
    buffer_load_dwordx4 v[176:179], v21, s[4:7], s36 offen offset:1024 sc1
    buffer_load_dwordx4 v[164:167], v22, s[4:7], s36 offen sc1
    buffer_load_dwordx4 v[168:171], v23, s[4:7], s36 offen sc1
    buffer_load_dwordx4 v[172:175], v24, s[4:7], s36 offen sc1
    v_cmp_eq_u32 vcc, -1, v31
    s_add_u32 s41, s41, 1
    s_cmp_ge_u32 s41, 0x80000
    s_cbranch_scc1 rec_gbo_28
    s_cbranch_vccz rec_gbo_28
    s_waitcnt vmcnt(7)
    v_permlane32_swap_b32 v48, v50
    v_permlane32_swap_b32 v49, v51
    v_pk_add_f32 v[124:125], v[48:49], v[50:51]
    s_waitcnt vmcnt(6)
    v_pk_add_f32 v[120:121], v[68:69], v[36:37]
    v_pk_add_f32 v[122:123], v[70:71], v[38:39]
    v_permlane16_swap_b32 v124, v125
    s_waitcnt vmcnt(5)
    v_pk_add_f32 v[120:121], v[120:121], v[40:41]
    v_pk_add_f32 v[122:123], v[122:123], v[42:43]
    v_add_f32 v124, v124, v125
    s_waitcnt vmcnt(4)
    v_pk_add_f32 v[120:121], v[120:121], v[44:45]
    v_pk_add_f32 v[122:123], v[122:123], v[46:47]
    v_maximum3_f32 v135, v120, v121, v124
    v_maximum3_f32 v135, v135, v122, v123
    v_cmp_u_f32 vcc, v135, v135
    s_nop 0
    v_max_f32_dpp v135, v135, v135 row_ror:8 row_mask:0xf bank_mask:0xf
    v_mov_b32 v136, v135
    s_cbranch_vccz rec_gbo_28
    v_max3_u32 v31, v36, v37, v38
    v_max3_u32 v31, v31, v39, v40
    v_max3_u32 v31, v31, v41, v42
    v_max3_u32 v31, v31, v43, v44
    v_max3_u32 v31, v31, v45, v46
    v_max3_u32 v31, v31, v47, v48
    v_max3_u32 v31, v31, v49, v50
    v_max_u32 v31, v31, v51
    buffer_load_dwordx4 v[48:51], v21, s[4:7], s36 offen offset:1024 sc1
    buffer_load_dwordx4 v[36:39], v22, s[4:7], s36 offen sc1
    buffer_load_dwordx4 v[40:43], v23, s[4:7], s36 offen sc1
    buffer_load_dwordx4 v[44:47], v24, s[4:7], s36 offen sc1
    v_cmp_eq_u32 vcc, -1, v31
    s_add_u32 s41, s41, 1
    s_cmp_ge_u32 s41, 0x80000
    s_cbranch_scc1 rec_gbo_28
    s_cbranch_vccz rec_gbo_28
    s_waitcnt vmcnt(7)
    v_permlane32_swap_b32 v176, v178
    v_permlane32_swap_b32 v177, v179
    v_pk_add_f32 v[124:125], v[176:177], v[178:179]
    s_waitcnt vmcnt(6)
    v_pk_add_f32 v[120:121], v[68:69], v[164:165]
    v_pk_add_f32 v[122:123], v[70:71], v[166:167]
    v_permlane16_swap_b32 v124, v125
    s_waitcnt vmcnt(5)
    v_pk_add_f32 v[120:121], v[120:121], v[168:169]
    v_pk_add_f32 v[122:123], v[122:123], v[170:171]
    v_add_f32 v124, v124, v125
    s_waitcnt vmcnt(4)
    v_pk_add_f32 v[120:121], v[120:121], v[172:173]
    v_pk_add_f32 v[122:123], v[122:123], v[174:175]
    v_maximum3_f32 v135, v120, v121, v124
    v_maximum3_f32 v135, v135, v122, v123
    v_cmp_u_f32 vcc, v135, v135
    s_nop 0
    v_max_f32_dpp v135, v135, v135 row_ror:8 row_mask:0xf bank_mask:0xf
    v_mov_b32 v136, v135
    s_cbranch_vccz rec_gbo_28
    s_branch rec_gbr_27
rec_w1_24:
    s_waitcnt lgkmcnt(0)
    s_barrier
    v_smfmac_f32_16x16x64_bf16 v[84:87], v[36:39], a[32:39], v5
    v_smfmac_f32_16x16x64_bf16 v[88:91], v[36:39], a[40:47], v5
    v_smfmac_f32_16x16x64_bf16 v[84:87], v[40:43], a[80:87], v5
    v_smfmac_f32_16x16x64_bf16 v[88:91], v[40:43], a[88:95], v5
    v_smfmac_f32_16x16x64_bf16 v[84:87], v[44:47], a[128:135], v5
    v_smfmac_f32_16x16x64_bf16 v[88:91], v[44:47], a[136:143], v5
    v_smfmac_f32_16x16x64_bf16 v[84:87], v[48:51], a[176:183], v5
    v_smfmac_f32_16x16x64_bf16 v[88:91], v[48:51], a[184:191], v5
    s_nop 6
    v_pk_add_f32 v[84:85], v[84:85], v[86:87]
    v_pk_add_f32 v[86:87], v[88:89], v[90:91]
    ds_write_b128 v17, v[84:87]
    s_waitcnt lgkmcnt(0)
    s_barrier
    v_mov_b64 v[68:69], 0
    v_mov_b64 v[70:71], 0
    v_mov_b64 v[72:73], 0
    v_mov_b64 v[74:75], 0
    v_mov_b64 v[76:77], 0
    v_mov_b64 v[78:79], 0
    v_mov_b64 v[80:81], 0
    v_mov_b64 v[82:83], 0
    v_mov_b64 v[84:85], 0
    v_mov_b64 v[86:87], 0
    v_mov_b64 v[88:89], 0
    v_mov_b64 v[90:91], 0
    s_cmp_eq_u32 s31, 3
    s_cbranch_scc1 rec_w3_45
    s_cmp_eq_u32 s31, 2
    s_cbranch_scc1 rec_w2_44
    ds_read_b128 v[180:183], v16 offset:15360
    s_branch rec_b2_23
rec_w2_44:
    ds_read_b128 v[100:103], v16 offset:10240
    ds_read_b128 v[104:107], v16 offset:11264
    ds_read_b128 v[108:111], v16 offset:12288
    ds_read_b128 v[112:115], v16 offset:13312
    s_waitcnt lgkmcnt(0)
    v_pk_add_f32 v[100:101], v[100:101], v[104:105]
    v_pk_add_f32 v[102:103], v[102:103], v[106:107]
    v_pk_add_f32 v[108:109], v[108:109], v[112:113]
    v_pk_add_f32 v[110:111], v[110:111], v[114:115]
    v_pk_add_f32 v[100:101], v[100:101], v[108:109]
    v_pk_add_f32 v[102:103], v[102:103], v[110:111]
    v_cvt_pk_bf16_f32 v180, v100, v101
    v_cvt_pk_bf16_f32 v181, v102, v103
    s_nop 0
    v_permlane32_swap_b32 v180, v182
    v_permlane32_swap_b32 v181, v183
    s_nop 1
    v_permlane16_swap_b32 v180, v181
    v_permlane16_swap_b32 v182, v183
rec_b2_23:
    s_waitcnt lgkmcnt(0)
    s_cmp_eq_u32 s32, 63
    s_cbranch_scc1 rec_done_19
    s_branch rec_cs_30
rec_w3_45:
    s_cmp_eq_u32 s32, 63
    s_cbranch_scc1 rec_done_19
    s_branch rec_tkc_48
rec_tk_46:
    s_load_dwordx8 s[72:79], s[90:91], s55 glc
    s_add_u32 s41, s41, 1
    s_cmp_ge_u32 s41, 0x80000
    s_cbranch_scc1 rec_tkd_47
    s_sleep 1
rec_tkc_48:
    s_min_u32 s38, s72, s76
    s_cmp_lt_u32 s38, s54
    s_cbranch_scc1 rec_tk_46
rec_tkd_47:
    s_add_u32 s54, s54, 1
    s_branch rec_cs_30
rec_kv_34:
    s_load_dword s94, s[90:91], s95 glc
    s_add_u32 s41, s41, 1
    s_cmp_ge_u32 s41, 0x80000
    s_cbranch_scc1 rec_kvd_35
    s_waitcnt lgkmcnt(0)
    s_cmp_gt_u32 s94, s38
    s_cbranch_scc1 rec_kvd_35
    s_sleep 2
    s_branch rec_kv_34
rec_gcfix_32:
    s_add_u32 s41, s41, 1
    s_cmp_ge_u32 s41, 0x80000
    s_cbranch_scc1 rec_gcok_31
    buffer_load_dwordx4 v[36:39], v12, s[4:7], s33 offen offset:0 sc1
    buffer_load_dwordx4 v[40:43], v12, s[4:7], s33 offen offset:1024 sc1
    buffer_load_dwordx4 v[44:47], v12, s[4:7], s33 offen offset:2048 sc1
    buffer_load_dwordx4 v[48:51], v12, s[4:7], s33 offen offset:3072 sc1
    buffer_load_dwordx4 v[52:55], v13, s[4:7], s33 offen offset:0 sc1
    buffer_load_dwordx4 v[56:59], v13, s[4:7], s33 offen offset:1024 sc1
    buffer_load_dwordx4 v[60:63], v13, s[4:7], s33 offen offset:2048 sc1
    buffer_load_dwordx4 v[64:67], v13, s[4:7], s33 offen offset:3072 sc1
    v_mov_b64 v[68:69], 0
    v_mov_b64 v[70:71], 0
    v_mov_b64 v[72:73], 0
    v_mov_b64 v[74:75], 0
    s_waitcnt vmcnt(7)
    v_smfmac_f32_16x16x64_bf16 v[68:71], v[36:39], a[192:199], v5
    v_min_u32 v31, v36, v37
    v_smfmac_f32_16x16x64_bf16 v[72:75], v[36:39], a[200:207], v5
    v_min_u32 v4, v38, v39
    s_waitcnt vmcnt(6)
    v_smfmac_f32_16x16x64_bf16 v[68:71], v[40:43], a[208:215], v5
    v_min3_u32 v31, v31, v40, v41
    v_smfmac_f32_16x16x64_bf16 v[72:75], v[40:43], a[216:223], v5
    v_min3_u32 v4, v4, v42, v43
    s_waitcnt vmcnt(5)
    v_smfmac_f32_16x16x64_bf16 v[68:71], v[44:47], a[224:231], v5
    v_min3_u32 v31, v31, v44, v45
    v_smfmac_f32_16x16x64_bf16 v[72:75], v[44:47], a[232:239], v5
    v_min3_u32 v4, v4, v46, v47
    s_waitcnt vmcnt(4)
    v_smfmac_f32_16x16x64_bf16 v[68:71], v[48:51], a[240:247], v5
    v_min3_u32 v31, v31, v48, v49
    v_smfmac_f32_16x16x64_bf16 v[72:75], v[48:51], a[248:255], v5
    v_min3_u32 v4, v4, v50, v51
    s_waitcnt vmcnt(3)
    v_smfmac_f32_16x16x64_bf16 v[68:71], v[52:55], v[192:199], v5
    v_min3_u32 v31, v31, v52, v53
    v_smfmac_f32_16x16x64_bf16 v[72:75], v[52:55], v[200:207], v5
    v_min3_u32 v4, v4, v54, v55
    s_waitcnt vmcnt(2)
    v_smfmac_f32_16x16x64_bf16 v[68:71], v[56:59], v[208:215], v5
    v_min3_u32 v31, v31, v56, v57
    v_smfmac_f32_16x16x64_bf16 v[72:75], v[56:59], v[216:223], v5
    v_min3_u32 v4, v4, v58, v59
    s_waitcnt vmcnt(1)
    v_smfmac_f32_16x16x64_bf16 v[68:71], v[60:63], v[224:231], v5
    v_min3_u32 v31, v31, v60, v61
    v_smfmac_f32_16x16x64_bf16 v[72:75], v[60:63], v[232:239], v5
    v_min3_u32 v4, v4, v62, v63
    v_min_u32 v31, v31, v4
    s_waitcnt vmcnt(0)
    v_min3_u32 v31, v31, v64, v65
    v_smfmac_f32_16x16x64_bf16 v[68:71], v[64:67], v[240:247], v5
    v_min3_u32 v31, v31, v66, v67
    v_smfmac_f32_16x16x64_bf16 v[72:75], v[64:67], v[248:255], v5
    v_cmp_eq_u32 vcc, 0, v31
    s_cbranch_vccnz rec_gcfix_32
    s_branch rec_gcok_31
rec_done_19:
    buffer_store_dwordx4 v[180:183], v93, s[4:7], s88 offen sc1
    s_waitcnt vmcnt(0)
    s_barrier
    v_add_u32 v188, 1, v188
    buffer_store_dword v188, v137, s[4:7], 0 offen sc1
    s_endpgm
L_gem:
    s_mov_b32 s6, L_end - L_gem - 16
    s_load_dwordx2 s[90:91], s[0:1], 96
    s_load_dwordx2 s[92:93], s[0:1], 88
    v_and_b32 v1, 63, v0
    v_lshrrev_b32 v2, 6, v0
    s_nop 0
    v_readfirstlane_b32 s29, v2
    v_lshlrev_b32 v5, 4, v1
    s_mov_b32 s41, 0
    s_lshl_b32 s34, s29, 10
    s_waitcnt lgkmcnt(0)
    s_mov_b32 s4, s90
    s_and_b32 s5, s91, 0xffff
    s_mov_b32 s6, 268435456
    s_mov_b32 s7, 0x00020000
    v_mov_b32 v31, 0
    s_cmp_lt_u32 s28, 96
    s_cbranch_scc1 g_nv_49
    s_load_dwordx8 s[72:79], s[0:1], 16
    s_and_b32 s31, s28, 31
    s_lshl_b32 s31, s31, 18
    s_lshl_b32 s33, s29, 16
    s_add_u32 s31, s31, s33
    v_lshrrev_b32 v2, 3, v1
    v_lshlrev_b32 v2, 13, v2
    v_and_b32 v4, 7, v1
    v_lshl_add_u32 v2, v4, 10, v2
    v_add_u32 v2, s31, v2
    v_and_b32 v3, 7, v1
    v_lshlrev_b32 v3, 13, v3
    v_add_u32 v3, s31, v3
    s_waitcnt lgkmcnt(0)
    s_mov_b32 s8, s72
    s_and_b32 s9, s73, 0xffff
    s_mov_b32 s10, 8388608
    s_mov_b32 s11, 0x00020000
    s_sub_u32 s31, 384, s72
    s_and_b32 s31, s31, 0x380
    buffer_load_dword v120, v2, s[8:11], s31 offen
    s_mov_b32 s12, s74
    s_and_b32 s13, s75, 0xffff
    s_mov_b32 s14, 8388608
    s_mov_b32 s15, 0x00020000
    s_sub_u32 s31, 384, s74
    s_and_b32 s31, s31, 0x380
    buffer_load_dword v121, v2, s[12:15], s31 offen
    s_mov_b32 s16, s76
    s_and_b32 s17, s77, 0xffff
    s_mov_b32 s18, 8388608
    s_mov_b32 s19, 0x00020000
    s_sub_u32 s31, 384, s76
    s_and_b32 s31, s31, 0x380
    buffer_load_dword v122, v2, s[16:19], s31 offen
    s_mov_b64 exec, 0xff
    s_sub_u32 s31, 8064, s72
    s_and_b32 s31, s31, 0x1f80
    buffer_load_dword v124, v3, s[8:11], s31 offen
    s_sub_u32 s31, 8064, s74
    s_and_b32 s31, s31, 0x1f80
    buffer_load_dword v125, v3, s[12:15], s31 offen
    s_sub_u32 s31, 8064, s76
    s_and_b32 s31, s31, 0x1f80
    buffer_load_dword v126, v3, s[16:19], s31 offen
    s_mov_b64 exec, -1
    s_branch valc_51
val_50:
    v_mov_b32 v2, 0
    global_load_dword v31, v2, s[92:93] offset:192 sc1
    s_add_u32 s41, s41, 1
    s_cmp_ge_u32 s41, 0x80000
    s_cbranch_scc1 L_end
    s_waitcnt vmcnt(0)
valc_51:
    v_readfirstlane_b32 s31, v31
    s_cmp_eq_u32 s31, s70
    s_cbranch_scc1 valok_52
    s_cmp_eq_u32 s31, 0
    s_cbranch_scc1 val_50
    s_mov_b32 s70, s31
    s_mov_b32 s71, 65536
    s_waitcnt vmcnt(0) lgkmcnt(0)
    s_barrier
    s_branch L_role
valok_52:
g_nv_49:
    s_cmp_ge_u32 s28, 120
    s_cbranch_scc1 L_att
    s_cmp_ge_u32 s28, 96
    s_cbranch_scc1 sl_b_53
    s_lshr_b32 s31, s28, 5
    s_add_u32 s31, s31, 1
    s_cmp_eq_u32 s31, 3
    s_cselect_b32 s44, 0, s31
    s_lshl_b32 s31, s44, 3
    s_add_u32 s31, s31, 16
    s_load_dwordx2 s[72:73], s[0:1], s31
    s_load_dwordx2 s[74:75], s[0:1], 0
    s_mov_b32 s76, 8388608
    s_mov_b32 s39, 8192
    s_and_b32 s31, s28, 31
    s_lshl_b32 s31, s31, 8
    s_lshl_b32 s36, s44, 24
    s_and_b32 s33, s28, 31
    s_lshl_b32 s33, s33, 13
    s_add_u32 s36, s36, s33
    s_mov_b32 s37, 262144
    s_and_b32 s50, s28, 31
    s_lshl_b32 s50, s50, 7
    s_lshl_b32 s33, s44, 2
    s_add_u32 s50, s50, s33
    s_add_u32 s50, s50, 115343360
    s_branch sl_c_54
sl_b_53:
    s_sub_u32 s32, s28, 96
    s_lshr_b32 s44, s32, 3
    s_load_dwordx2 s[72:73], s[0:1], 64
    s_load_dwordx2 s[74:75], s[0:1], 56
    s_mov_b32 s76, 6291456
    s_mov_b32 s39, 6144
    s_lshl_b32 s31, s32, 8
    s_lshl_b32 s36, s44, 22
    s_and_b32 s33, s32, 7
    s_lshl_b32 s33, s33, 13
    s_add_u32 s36, s36, s33
    s_add_u32 s36, s36, 50331648
    s_mov_b32 s37, 65536
    s_and_b32 s50, s32, 7
    s_lshl_b32 s50, s50, 7
    s_lshl_b32 s33, s44, 2
    s_add_u32 s50, s50, s33
    s_add_u32 s50, s50, 115347456
sl_c_54:
    s_waitcnt lgkmcnt(0)
    s_mov_b32 s8, s72
    s_and_b32 s9, s73, 0xffff
    s_mov_b32 s10, s76
    s_mov_b32 s11, 0x00020000
    s_mov_b32 s12, s74
    s_and_b32 s13, s75, 0xffff
    s_mov_b32 s14, 4194304
    s_mov_b32 s15, 0x00020000
    s_mov_b64 s[80:81], s[72:73]
    s_mov_b32 s45, s31
    s_cmp_lt_u32 s28, 96
    s_cbranch_scc1 sl_go_55
    s_mov_b64 exec, 1
    v_mov_b32 v2, 0
    buffer_store_dword v2, v2, s[4:7], s50 offen sc1
    s_mov_b64 exec, -1
    s_cmp_lt_u32 s28, 96
    s_cbranch_scc1 tw_skip_57
    s_load_dwordx2 s[72:73], s[0:1], 40
    s_and_b32 s31, s28, 31
    s_lshl_b32 s31, s31, 13
    s_lshl_b32 s33, s29, 21
    s_add_u32 s31, s31, s33
    v_lshl_add_u32 v2, v1, 7, s31
    s_waitcnt lgkmcnt(0)
    s_mov_b32 s8, s72
    s_and_b32 s9, s73, 0xffff
    s_mov_b32 s10, 8388608
    s_mov_b32 s11, 0x00020000
    s_mov_b32 s31, 0
    buffer_load_dword v128, v2, s[8:11], s31 offen
    s_mov_b32 s31, 262144
    buffer_load_dword v129, v2, s[8:11], s31 offen
    s_mov_b32 s31, 524288
    buffer_load_dword v130, v2, s[8:11], s31 offen
    s_mov_b32 s31, 786432
    buffer_load_dword v131, v2, s[8:11], s31 offen
    s_mov_b32 s31, 1048576
    buffer_load_dword v132, v2, s[8:11], s31 offen
    s_mov_b32 s31, 1310720
    buffer_load_dword v133, v2, s[8:11], s31 offen
    s_mov_b32 s31, 1572864
    buffer_load_dword v134, v2, s[8:11], s31 offen
    s_mov_b32 s31, 1835008
    buffer_load_dword v135, v2, s[8:11], s31 offen
tw_skip_57:
    s_and_b32 s59, s28, 31
    s_lshl_b32 s59, s59, 2
    s_add_u32 s59, s59, s29
    s_sub_u32 s31, 0, s90
    s_and_b32 s31, s31, 2097151
    s_and_b32 s60, s59, 7
    s_lshl_b32 s60, s60, 21
    s_lshr_b32 s33, s59, 3
    s_and_b32 s33, s33, 1
    s_lshl_b32 s33, s33, 13
    s_add_u32 s60, s60, s33
    s_lshr_b32 s33, s59, 4
    s_and_b32 s33, s33, 7
    s_lshl_b32 s33, s33, 8
    s_add_u32 s60, s60, s33
    s_add_u32 s60, s60, s31
    s_add_u32 s60, s60, 117686272
    s_lshr_b32 s32, s59, 3
    s_and_b32 s32, s32, 1
    s_lshl_b32 s32, s32, 14
    s_sub_u32 s61, s60, s32
    s_add_u32 s61, s61, 8192
    s_load_dword s68, s[90:91], s60 glc
    s_mov_b32 s62, -1
    s_load_dword s69, s[90:91], s61 glc
    s_mov_b32 s63, -1
    s_waitcnt lgkmcnt(0)
    s_memtime s[64:65]
    s_waitcnt lgkmcnt(0)
    s_load_dword s68, s[90:91], s60 glc
    s_waitcnt lgkmcnt(0)
    s_memtime s[66:67]
    s_waitcnt lgkmcnt(0)
    s_sub_u32 s31, s66, s64
    s_min_u32 s62, s62, s31
    s_waitcnt lgkmcnt(0)
    s_memtime s[64:65]
    s_waitcnt lgkmcnt(0)
    s_load_dword s68, s[90:91], s61 glc
    s_waitcnt lgkmcnt(0)
    s_memtime s[66:67]
    s_waitcnt lgkmcnt(0)
    s_sub_u32 s31, s66, s64
    s_min_u32 s63, s63, s31
    s_waitcnt lgkmcnt(0)
    s_memtime s[64:65]
    s_waitcnt lgkmcnt(0)
    s_load_dword s68, s[90:91], s60 glc
    s_waitcnt lgkmcnt(0)
    s_memtime s[66:67]
    s_waitcnt lgkmcnt(0)
    s_sub_u32 s31, s66, s64
    s_min_u32 s62, s62, s31
    s_waitcnt lgkmcnt(0)
    s_memtime s[64:65]
    s_waitcnt lgkmcnt(0)
    s_load_dword s68, s[90:91], s61 glc
    s_waitcnt lgkmcnt(0)
    s_memtime s[66:67]
    s_waitcnt lgkmcnt(0)
    s_sub_u32 s31, s66, s64
    s_min_u32 s63, s63, s31
    s_cmp_gt_u32 s63, s62
    s_cselect_b32 s31, 1, 0
    s_lshr_b32 s32, s59, 3
    s_xor_b32 s31, s31, s32
    s_xor_b32 s31, s31, s59
    s_and_b32 s31, s31, 1
    s_add_u32 s71, s71, s31
    s_waitcnt vmcnt(8)
    s_mov_b64 exec, 1
    v_mov_b32 v4, 0
    v_mov_b32 v2, 1
    v_mov_b32 v3, s71
    global_atomic_add_x2 v4, v[2:3], s[92:93] offset:0 sc1
    s_mov_b64 exec, -1
sl_a2_56:
    s_mov_b32 s8, s80
    s_and_b32 s9, s81, 0xffff
    s_mov_b32 s10, s76
    s_mov_b32 s11, 0x00020000
    s_cmp_lt_u32 s28, 96
    s_cselect_b32 s33, 96, 96
    s_cmp_lg_u32 s29, 0
    s_cbranch_scc1 g_wdd_59
g_wd_58:
    s_load_dword s84, s[92:93], 128 glc
    s_add_u32 s41, s41, 1
    s_cmp_ge_u32 s41, 0x200000
    s_cbranch_scc1 g_wdd_59
    s_waitcnt lgkmcnt(0)
    s_cmp_ge_u32 s84, s33
    s_cbranch_scc1 g_wdd_59
    s_sleep 32
    s_branch g_wd_58
g_wdd_59:
    s_waitcnt lgkmcnt(0)
    s_barrier
sl_go_55:
    v_lshrrev_b32 v2, 2, v1
    v_mul_lo_u32 v6, v2, s39
    s_mov_b32 s31, s45
    s_lshl_b32 s33, s29, 6
    s_add_u32 s31, s31, s33
    v_and_b32 v2, 3, v1
    v_lshlrev_b32 v2, 4, v2
    v_add_u32 v2, s31, v2
    v_add_u32 v6, v6, v2
    s_lshl_b32 s39, s39, 4
    s_mov_b32 s30, 0
    s_mov_b32 s51, 64
    s_mov_b32 s52, 4128768
    s_lshl_b32 s31, s29, 15
    v_lshrrev_b32 v7, 4, v1
    v_lshlrev_b32 v7, 9, v7
    v_bfe_u32 v4, v1, 2, 2
    v_lshl_add_u32 v7, v4, 6, v7
    v_bfe_u32 v4, v1, 1, 1
    v_lshl_add_u32 v7, v4, 5, v7
    v_and_b32 v4, 1, v1
    v_lshl_add_u32 v7, v4, 3, v7
    v_add_u32 v7, s31, v7
    s_lshl_b32 s32, s29, 15
    s_add_u32 m0, s32, 0
    s_mov_b32 s38, 0
    buffer_load_dwordx4 v6, s[8:11], s38 offen lds
    s_add_u32 m0, s32, 1024
    s_add_u32 s38, s38, s39
    buffer_load_dwordx4 v6, s[8:11], s38 offen lds
    s_add_u32 m0, s32, 2048
    s_add_u32 s38, s38, s39
    buffer_load_dwordx4 v6, s[8:11], s38 offen lds
    s_add_u32 m0, s32, 3072
    s_add_u32 s38, s38, s39
    buffer_load_dwordx4 v6, s[8:11], s38 offen lds
    s_add_u32 m0, s32, 4096
    s_add_u32 s38, s38, s39
    buffer_load_dwordx4 v6, s[8:11], s38 offen lds
    s_add_u32 m0, s32, 5120
    s_add_u32 s38, s38, s39
    buffer_load_dwordx4 v6, s[8:11], s38 offen lds
    s_add_u32 m0, s32, 6144
    s_add_u32 s38, s38, s39
    buffer_load_dwordx4 v6, s[8:11], s38 offen lds
    s_add_u32 m0, s32, 7168
    s_add_u32 s38, s38, s39
    buffer_load_dwordx4 v6, s[8:11], s38 offen lds
    s_add_u32 m0, s32, 8192
    s_add_u32 s38, s38, s39
    buffer_load_dwordx4 v6, s[8:11], s38 offen lds
    s_add_u32 m0, s32, 9216
    s_add_u32 s38, s38, s39
    buffer_load_dwordx4 v6, s[8:11], s38 offen lds
    s_add_u32 m0, s32, 10240
    s_add_u32 s38, s38, s39
    buffer_load_dwordx4 v6, s[8:11], s38 offen lds
    s_add_u32 m0, s32, 11264
    s_add_u32 s38, s38, s39
    buffer_load_dwordx4 v6, s[8:11], s38 offen lds
    s_add_u32 m0, s32, 12288
    s_add_u32 s38, s38, s39
    buffer_load_dwordx4 v6, s[8:11], s38 offen lds
    s_add_u32 m0, s32, 13312
    s_add_u32 s38, s38, s39
    buffer_load_dwordx4 v6, s[8:11], s38 offen lds
    s_add_u32 m0, s32, 14336
    s_add_u32 s38, s38, s39
    buffer_load_dwordx4 v6, s[8:11], s38 offen lds
    s_add_u32 m0, s32, 15360
    s_add_u32 s38, s38, s39
    buffer_load_dwordx4 v6, s[8:11], s38 offen lds
    s_add_u32 m0, s32, 16384
    s_add_u32 s38, s38, s39
    buffer_load_dwordx4 v6, s[8:11], s38 offen lds
    s_add_u32 m0, s32, 17408
    s_add_u32 s38, s38, s39
    buffer_load_dwordx4 v6, s[8:11], s38 offen lds
    s_add_u32 m0, s32, 18432
    s_add_u32 s38, s38, s39
    buffer_load_dwordx4 v6, s[8:11], s38 offen lds
    s_add_u32 m0, s32, 19456
    s_add_u32 s38, s38, s39
    buffer_load_dwordx4 v6, s[8:11], s38 offen lds
    s_add_u32 m0, s32, 20480
    s_add_u32 s38, s38, s39
    buffer_load_dwordx4 v6, s[8:11], s38 offen lds
    s_add_u32 m0, s32, 21504
    s_add_u32 s38, s38, s39
    buffer_load_dwordx4 v6, s[8:11], s38 offen lds
    s_add_u32 m0, s32, 22528
    s_add_u32 s38, s38, s39
    buffer_load_dwordx4 v6, s[8:11], s38 offen lds
    s_add_u32 m0, s32, 23552
    s_add_u32 s38, s38, s39
    buffer_load_dwordx4 v6, s[8:11], s38 offen lds
    s_add_u32 m0, s32, 24576
    s_add_u32 s38, s38, s39
    buffer_load_dwordx4 v6, s[8:11], s38 offen lds
    s_add_u32 m0, s32, 25600
    s_add_u32 s38, s38, s39
    buffer_load_dwordx4 v6, s[8:11], s38 offen lds
    s_add_u32 m0, s32, 26624
    s_add_u32 s38, s38, s39
    buffer_load_dwordx4 v6, s[8:11], s38 offen lds
    s_add_u32 m0, s32, 27648
    s_add_u32 s38, s38, s39
    buffer_load_dwordx4 v6, s[8:11], s38 offen lds
    s_add_u32 m0, s32, 28672
    s_add_u32 s38, s38, s39
    buffer_load_dwordx4 v6, s[8:11], s38 offen lds
    s_add_u32 m0, s32, 29696
    s_add_u32 s38, s38, s39
    buffer_load_dwordx4 v6, s[8:11], s38 offen lds
    s_add_u32 m0, s32, 30720
    s_add_u32 s38, s38, s39
    buffer_load_dwordx4 v6, s[8:11], s38 offen lds
    s_add_u32 m0, s32, 31744
    s_add_u32 s38, s38, s39
    buffer_load_dwordx4 v6, s[8:11], s38 offen lds
    s_waitcnt vmcnt(30)
    ds_read_b64_tr_b16 a[0:1], v7 offset:0
    ds_read_b64_tr_b16 a[2:3], v7 offset:256
    ds_read_b64_tr_b16 a[4:5], v7 offset:16
    ds_read_b64_tr_b16 a[6:7], v7 offset:272
    s_waitcnt vmcnt(28)
    ds_read_b64_tr_b16 a[8:9], v7 offset:2048
    ds_read_b64_tr_b16 a[10:11], v7 offset:2304
    ds_read_b64_tr_b16 a[12:13], v7 offset:2064
    ds_read_b64_tr_b16 a[14:15], v7 offset:2320
    s_waitcnt lgkmcnt(4)
    s_add_u32 m0, s32, 0
    s_add_u32 s38, s38, s39
    buffer_load_dwordx4 v6, s[8:11], s38 offen lds
    s_add_u32 m0, s32, 1024
    s_add_u32 s38, s38, s39
    buffer_load_dwordx4 v6, s[8:11], s38 offen lds
    s_waitcnt vmcnt(28)
    v_mov_b32 v2, 0
    global_load_dword v31, v2, s[92:93] offset:192 sc1
    ds_read_b64_tr_b16 a[16:17], v7 offset:4096
    ds_read_b64_tr_b16 a[18:19], v7 offset:4352
    ds_read_b64_tr_b16 a[20:21], v7 offset:4112
    ds_read_b64_tr_b16 a[22:23], v7 offset:4368
    s_waitcnt lgkmcnt(4)
    s_add_u32 m0, s32, 2048
    s_add_u32 s38, s38, s39
    buffer_load_dwordx4 v6, s[8:11], s38 offen lds
    s_add_u32 m0, s32, 3072
    s_add_u32 s38, s38, s39
    buffer_load_dwordx4 v6, s[8:11], s38 offen lds
    s_waitcnt vmcnt(28)
    ds_read_b64_tr_b16 a[24:25], v7 offset:6144
    ds_read_b64_tr_b16 a[26:27], v7 offset:6400
    ds_read_b64_tr_b16 a[28:29], v7 offset:6160
    ds_read_b64_tr_b16 a[30:31], v7 offset:6416
    s_waitcnt lgkmcnt(4)
    s_add_u32 m0, s32, 4096
    s_add_u32 s38, s38, s39
    buffer_load_dwordx4 v6, s[8:11], s38 offen lds
    s_add_u32 m0, s32, 5120
    s_add_u32 s38, s38, s39
    buffer_load_dwordx4 v6, s[8:11], s38 offen lds
    s_waitcnt vmcnt(28)
    ds_read_b64_tr_b16 a[32:33], v7 offset:8192
    ds_read_b64_tr_b16 a[34:35], v7 offset:8448
    ds_read_b64_tr_b16 a[36:37], v7 offset:8208
    ds_read_b64_tr_b16 a[38:39], v7 offset:8464
    s_waitcnt lgkmcnt(4)
    s_add_u32 m0, s32, 6144
    s_add_u32 s38, s38, s39
    buffer_load_dwordx4 v6, s[8:11], s38 offen lds
    s_add_u32 m0, s32, 7168
    s_add_u32 s38, s38, s39
    buffer_load_dwordx4 v6, s[8:11], s38 offen lds
    s_waitcnt vmcnt(28)
    ds_read_b64_tr_b16 a[40:41], v7 offset:10240
    ds_read_b64_tr_b16 a[42:43], v7 offset:10496
    ds_read_b64_tr_b16 a[44:45], v7 offset:10256
    ds_read_b64_tr_b16 a[46:47], v7 offset:10512
    s_waitcnt lgkmcnt(4)
    s_add_u32 m0, s32, 8192
    s_add_u32 s38, s38, s39
    buffer_load_dwordx4 v6, s[8:11], s38 offen lds
    s_add_u32 m0, s32, 9216
    s_add_u32 s38, s38, s39
    buffer_load_dwordx4 v6, s[8:11], s38 offen lds
    s_waitcnt vmcnt(28)
    ds_read_b64_tr_b16 a[48:49], v7 offset:12288
    ds_read_b64_tr_b16 a[50:51], v7 offset:12544
    ds_read_b64_tr_b16 a[52:53], v7 offset:12304
    ds_read_b64_tr_b16 a[54:55], v7 offset:12560
    s_waitcnt lgkmcnt(4)
    s_add_u32 m0, s32, 10240
    s_add_u32 s38, s38, s39
    buffer_load_dwordx4 v6, s[8:11], s38 offen lds
    s_add_u32 m0, s32, 11264
    s_add_u32 s38, s38, s39
    buffer_load_dwordx4 v6, s[8:11], s38 offen lds
    s_waitcnt vmcnt(28)
    ds_read_b64_tr_b16 a[56:57], v7 offset:14336
    ds_read_b64_tr_b16 a[58:59], v7 offset:14592
    ds_read_b64_tr_b16 a[60:61], v7 offset:14352
    ds_read_b64_tr_b16 a[62:63], v7 offset:14608
    s_waitcnt lgkmcnt(4)
    s_add_u32 m0, s32, 12288
    s_add_u32 s38, s38, s39
    buffer_load_dwordx4 v6, s[8:11], s38 offen lds
    s_add_u32 m0, s32, 13312
    s_add_u32 s38, s38, s39
    buffer_load_dwordx4 v6, s[8:11], s38 offen lds
    s_waitcnt vmcnt(28)
    ds_read_b64_tr_b16 a[64:65], v7 offset:16384
    ds_read_b64_tr_b16 a[66:67], v7 offset:16640
    ds_read_b64_tr_b16 a[68:69], v7 offset:16400
    ds_read_b64_tr_b16 a[70:71], v7 offset:16656
    s_waitcnt lgkmcnt(4)
    s_add_u32 m0, s32, 14336
    s_add_u32 s38, s38, s39
    buffer_load_dwordx4 v6, s[8:11], s38 offen lds
    s_add_u32 m0, s32, 15360
    s_add_u32 s38, s38, s39
    buffer_load_dwordx4 v6, s[8:11], s38 offen lds
    s_waitcnt vmcnt(28)
    ds_read_b64_tr_b16 a[72:73], v7 offset:18432
    ds_read_b64_tr_b16 a[74:75], v7 offset:18688
    ds_read_b64_tr_b16 a[76:77], v7 offset:18448
    ds_read_b64_tr_b16 a[78:79], v7 offset:18704
    s_waitcnt lgkmcnt(4)
    s_add_u32 m0, s32, 16384
    s_add_u32 s38, s38, s39
    buffer_load_dwordx4 v6, s[8:11], s38 offen lds
    s_add_u32 m0, s32, 17408
    s_add_u32 s38, s38, s39
    buffer_load_dwordx4 v6, s[8:11], s38 offen lds
    s_waitcnt vmcnt(28)
    ds_read_b64_tr_b16 a[80:81], v7 offset:20480
    ds_read_b64_tr_b16 a[82:83], v7 offset:20736
    ds_read_b64_tr_b16 a[84:85], v7 offset:20496
    ds_read_b64_tr_b16 a[86:87], v7 offset:20752
    s_waitcnt lgkmcnt(4)
    s_add_u32 m0, s32, 18432
    s_add_u32 s38, s38, s39
    buffer_load_dwordx4 v6, s[8:11], s38 offen lds
    s_add_u32 m0, s32, 19456
    s_add_u32 s38, s38, s39
    buffer_load_dwordx4 v6, s[8:11], s38 offen lds
    s_waitcnt vmcnt(28)
    ds_read_b64_tr_b16 a[88:89], v7 offset:22528
    ds_read_b64_tr_b16 a[90:91], v7 offset:22784
    ds_read_b64_tr_b16 a[92:93], v7 offset:22544
    ds_read_b64_tr_b16 a[94:95], v7 offset:22800
    s_waitcnt lgkmcnt(4)
    s_add_u32 m0, s32, 20480
    s_add_u32 s38, s38, s39
    buffer_load_dwordx4 v6, s[8:11], s38 offen lds
    s_add_u32 m0, s32, 21504
    s_add_u32 s38, s38, s39
    buffer_load_dwordx4 v6, s[8:11], s38 offen lds
    s_waitcnt vmcnt(28)
    ds_read_b64_tr_b16 a[96:97], v7 offset:24576
    ds_read_b64_tr_b16 a[98:99], v7 offset:24832
    ds_read_b64_tr_b16 a[100:101], v7 offset:24592
    ds_read_b64_tr_b16 a[102:103], v7 offset:24848
    s_waitcnt lgkmcnt(4)
    s_add_u32 m0, s32, 22528
    s_add_u32 s38, s38, s39
    buffer_load_dwordx4 v6, s[8:11], s38 offen lds
    s_add_u32 m0, s32, 23552
    s_add_u32 s38, s38, s39
    buffer_load_dwordx4 v6, s[8:11], s38 offen lds
    s_waitcnt vmcnt(28)
    ds_read_b64_tr_b16 a[104:105], v7 offset:26624
    ds_read_b64_tr_b16 a[106:107], v7 offset:26880
    ds_read_b64_tr_b16 a[108:109], v7 offset:26640
    ds_read_b64_tr_b16 a[110:111], v7 offset:26896
    s_waitcnt lgkmcnt(4)
    s_add_u32 m0, s32, 24576
    s_add_u32 s38, s38, s39
    buffer_load_dwordx4 v6, s[8:11], s38 offen lds
    s_add_u32 m0, s32, 25600
    s_add_u32 s38, s38, s39
    buffer_load_dwordx4 v6, s[8:11], s38 offen lds
    s_waitcnt vmcnt(28)
    ds_read_b64_tr_b16 a[112:113], v7 offset:28672
    ds_read_b64_tr_b16 a[114:115], v7 offset:28928
    ds_read_b64_tr_b16 a[116:117], v7 offset:28688
    ds_read_b64_tr_b16 a[118:119], v7 offset:28944
    s_waitcnt lgkmcnt(4)
    s_add_u32 m0, s32, 26624
    s_add_u32 s38, s38, s39
    buffer_load_dwordx4 v6, s[8:11], s38 offen lds
    s_add_u32 m0, s32, 27648
    s_add_u32 s38, s38, s39
    buffer_load_dwordx4 v6, s[8:11], s38 offen lds
    s_waitcnt vmcnt(28)
    ds_read_b64_tr_b16 a[120:121], v7 offset:30720
    ds_read_b64_tr_b16 a[122:123], v7 offset:30976
    ds_read_b64_tr_b16 a[124:125], v7 offset:30736
    ds_read_b64_tr_b16 a[126:127], v7 offset:30992
    s_waitcnt lgkmcnt(4)
    s_add_u32 m0, s32, 28672
    s_add_u32 s38, s38, s39
    buffer_load_dwordx4 v6, s[8:11], s38 offen lds
    s_add_u32 m0, s32, 29696
    s_add_u32 s38, s38, s39
    buffer_load_dwordx4 v6, s[8:11], s38 offen lds
    s_waitcnt vmcnt(28)
    ds_read_b64_tr_b16 a[128:129], v7 offset:0
    ds_read_b64_tr_b16 a[130:131], v7 offset:256
    ds_read_b64_tr_b16 a[132:133], v7 offset:16
    ds_read_b64_tr_b16 a[134:135], v7 offset:272
    s_waitcnt lgkmcnt(4)
    s_add_u32 m0, s32, 30720
    s_add_u32 s38, s38, s39
    buffer_load_dwordx4 v6, s[8:11], s38 offen lds
    s_add_u32 m0, s32, 31744
    s_add_u32 s38, s38, s39
    buffer_load_dwordx4 v6, s[8:11], s38 offen lds
    s_waitcnt vmcnt(28)
    s_branch valc_62
val_61:
    v_mov_b32 v2, 0
    global_load_dword v31, v2, s[92:93] offset:192 sc1
    s_add_u32 s41, s41, 1
    s_cmp_ge_u32 s41, 0x80000
    s_cbranch_scc1 L_end
    s_waitcnt vmcnt(0)
valc_62:
    v_readfirstlane_b32 s31, v31
    s_cmp_eq_u32 s31, s70
    s_cbranch_scc1 valok_63
    s_cmp_eq_u32 s31, 0
    s_cbranch_scc1 val_61
    s_mov_b32 s70, s31
    s_mov_b32 s71, 65536
    s_waitcnt vmcnt(0) lgkmcnt(0)
    s_barrier
    s_branch L_role
valok_63:
    ds_read_b64_tr_b16 a[136:137], v7 offset:2048
    ds_read_b64_tr_b16 a[138:139], v7 offset:2304
    ds_read_b64_tr_b16 a[140:141], v7 offset:2064
    ds_read_b64_tr_b16 a[142:143], v7 offset:2320
    s_waitcnt vmcnt(26)
    ds_read_b64_tr_b16 a[144:145], v7 offset:4096
    ds_read_b64_tr_b16 a[146:147], v7 offset:4352
    ds_read_b64_tr_b16 a[148:149], v7 offset:4112
    ds_read_b64_tr_b16 a[150:151], v7 offset:4368
    s_waitcnt vmcnt(24)
    ds_read_b64_tr_b16 a[152:153], v7 offset:6144
    ds_read_b64_tr_b16 a[154:155], v7 offset:6400
    ds_read_b64_tr_b16 a[156:157], v7 offset:6160
    ds_read_b64_tr_b16 a[158:159], v7 offset:6416
    s_waitcnt vmcnt(22)
    ds_read_b64_tr_b16 a[160:161], v7 offset:8192
    ds_read_b64_tr_b16 a[162:163], v7 offset:8448
    ds_read_b64_tr_b16 a[164:165], v7 offset:8208
    ds_read_b64_tr_b16 a[166:167], v7 offset:8464
    s_waitcnt vmcnt(20)
    ds_read_b64_tr_b16 a[168:169], v7 offset:10240
    ds_read_b64_tr_b16 a[170:171], v7 offset:10496
    ds_read_b64_tr_b16 a[172:173], v7 offset:10256
    ds_read_b64_tr_b16 a[174:175], v7 offset:10512
    s_waitcnt vmcnt(18)
    ds_read_b64_tr_b16 a[176:177], v7 offset:12288
    ds_read_b64_tr_b16 a[178:179], v7 offset:12544
    ds_read_b64_tr_b16 a[180:181], v7 offset:12304
    ds_read_b64_tr_b16 a[182:183], v7 offset:12560
    s_waitcnt vmcnt(16)
    ds_read_b64_tr_b16 a[184:185], v7 offset:14336
    ds_read_b64_tr_b16 a[186:187], v7 offset:14592
    ds_read_b64_tr_b16 a[188:189], v7 offset:14352
    ds_read_b64_tr_b16 a[190:191], v7 offset:14608
    s_waitcnt vmcnt(14)
    ds_read_b64_tr_b16 a[192:193], v7 offset:16384
    ds_read_b64_tr_b16 a[194:195], v7 offset:16640
    ds_read_b64_tr_b16 a[196:197], v7 offset:16400
    ds_read_b64_tr_b16 a[198:199], v7 offset:16656
    s_waitcnt vmcnt(12)
    ds_read_b64_tr_b16 a[200:201], v7 offset:18432
    ds_read_b64_tr_b16 a[202:203], v7 offset:18688
    ds_read_b64_tr_b16 a[204:205], v7 offset:18448
    ds_read_b64_tr_b16 a[206:207], v7 offset:18704
    s_waitcnt vmcnt(10)
    ds_read_b64_tr_b16 a[208:209], v7 offset:20480
    ds_read_b64_tr_b16 a[210:211], v7 offset:20736
    ds_read_b64_tr_b16 a[212:213], v7 offset:20496
    ds_read_b64_tr_b16 a[214:215], v7 offset:20752
    s_waitcnt vmcnt(8)
    ds_read_b64_tr_b16 a[216:217], v7 offset:22528
    ds_read_b64_tr_b16 a[218:219], v7 offset:22784
    ds_read_b64_tr_b16 a[220:221], v7 offset:22544
    ds_read_b64_tr_b16 a[222:223], v7 offset:22800
    s_waitcnt vmcnt(6)
    ds_read_b64_tr_b16 a[224:225], v7 offset:24576
    ds_read_b64_tr_b16 a[226:227], v7 offset:24832
    ds_read_b64_tr_b16 a[228:229], v7 offset:24592
    ds_read_b64_tr_b16 a[230:231], v7 offset:24848
    s_waitcnt vmcnt(4)
    ds_read_b64_tr_b16 a[232:233], v7 offset:26624
    ds_read_b64_tr_b16 a[234:235], v7 offset:26880
    ds_read_b64_tr_b16 a[236:237], v7 offset:26640
    ds_read_b64_tr_b16 a[238:239], v7 offset:26896
    s_waitcnt vmcnt(2)
    ds_read_b64_tr_b16 a[240:241], v7 offset:28672
    ds_read_b64_tr_b16 a[242:243], v7 offset:28928
    ds_read_b64_tr_b16 a[244:245], v7 offset:28688
    ds_read_b64_tr_b16 a[246:247], v7 offset:28944
    s_waitcnt vmcnt(0)
    ds_read_b64_tr_b16 a[248:249], v7 offset:30720
    ds_read_b64_tr_b16 a[250:251], v7 offset:30976
    ds_read_b64_tr_b16 a[252:253], v7 offset:30736
    ds_read_b64_tr_b16 a[254:255], v7 offset:30992
    s_waitcnt lgkmcnt(0)
    s_lshr_b32 s31, s29, 1
    s_and_b32 s31, s31, 1
    s_lshl_b32 s31, s31, 2
    v_lshrrev_b32 v2, 4, v1
    v_add_u32 v2, s31, v2
    v_and_b32 v3, 7, v1
    v_xor_b32 v2, v2, v3
    s_lshl_b32 s31, s29, 14
    v_lshrrev_b32 v8, 3, v1
    v_lshlrev_b32 v8, 11, v8
    v_add_u32 v8, s31, v8
    v_lshl_add_u32 v8, v2, 4, v8
    v_bfe_u32 v2, v1, 1, 3
    v_lshrrev_b32 v3, 4, v1
    v_xor_b32 v2, v2, v3
    v_bfe_u32 v3, v1, 3, 1
    v_lshlrev_b32 v3, 11, v3
    v_and_b32 v4, 7, v1
    v_lshl_add_u32 v3, v4, 7, v3
    v_xor_b32 v12, 0, v2
    v_lshl_add_u32 v12, v12, 4, v3
    v_add_u32 v14, 65536, v12
    v_xor_b32 v13, 4, v2
    v_lshl_add_u32 v13, v13, 4, v3
    v_add_u32 v15, 65536, v13
    s_lshl_b32 s31, s29, 11
    v_lshrrev_b32 v9, 4, v1
    v_lshlrev_b32 v9, 9, v9
    v_bfe_u32 v4, v1, 3, 1
    v_lshl_add_u32 v9, v4, 8, v9
    v_and_b32 v4, 7, v1
    v_lshl_add_u32 v9, v4, 4, v9
    v_add_u32 v9, s31, v9
    v_mov_b32 v10, s50
    s_lshr_b32 s31, s44, 1
    s_and_b32 s31, s31, 1
    s_lshl_b32 s31, s31, 12
    s_add_u32 s31, s31, s50
    s_add_u32 s31, s31, 286720
    v_lshl_add_u32 v2, v1, 13, s31
    v_cmp_eq_u32 vcc, 0, v1
    s_nop 1
    v_cndmask_b32 v10, v2, v10, vcc
    s_cmp_lt_u32 s28, 64
    s_cselect_b32 s31, 511, 1
    s_cmp_eq_u32 s29, 0
    s_mov_b32 vcc_hi, 0
    s_cselect_b32 vcc_lo, s31, 0
    v_mov_b32 v4, 2130706432
    v_cndmask_b32 v10, v4, v10, vcc
    v_mov_b32 v11, 0
    s_cmp_lt_u32 s28, 96
    s_cselect_b32 s46, s29, 1
    s_min_u32 s46, s46, 1
    s_lshl_b32 s35, s30, 16
    s_sub_u32 s36, s36, s37
    s_barrier
    s_add_u32 m0, s34, 0
    s_nop 0
    buffer_load_dwordx4 v8, s[12:15], s35 offen offset:0 lds
    s_add_u32 m0, s34, 3968
    s_nop 0
    buffer_load_dwordx4 v8, s[12:15], s35 offen offset:128 lds
    s_add_u32 m0, s34, 7936
    s_nop 0
    buffer_load_dwordx4 v8, s[12:15], s35 offen offset:256 lds
    s_add_u32 m0, s34, 11904
    s_nop 0
    buffer_load_dwordx4 v8, s[12:15], s35 offen offset:384 lds
    s_add_u32 m0, s34, 15872
    s_nop 0
    buffer_load_dwordx4 v8, s[12:15], s35 offen offset:512 lds
    s_add_u32 m0, s34, 19840
    s_nop 0
    buffer_load_dwordx4 v8, s[12:15], s35 offen offset:640 lds
    s_add_u32 m0, s34, 23808
    s_nop 0
    buffer_load_dwordx4 v8, s[12:15], s35 offen offset:768 lds
    s_add_u32 m0, s34, 27776
    s_nop 0
    buffer_load_dwordx4 v8, s[12:15], s35 offen offset:896 lds
    s_add_u32 m0, s34, 31744
    s_nop 0
    buffer_load_dwordx4 v8, s[12:15], s35 offen offset:1024 lds
    s_add_u32 m0, s34, 35712
    s_nop 0
    buffer_load_dwordx4 v8, s[12:15], s35 offen offset:1152 lds
    s_add_u32 m0, s34, 39680
    s_nop 0
    buffer_load_dwordx4 v8, s[12:15], s35 offen offset:1280 lds
    s_add_u32 m0, s34, 43648
    s_nop 0
    buffer_load_dwordx4 v8, s[12:15], s35 offen offset:1408 lds
    s_add_u32 m0, s34, 47616
    s_nop 0
    buffer_load_dwordx4 v8, s[12:15], s35 offen offset:1536 lds
    s_add_u32 m0, s34, 51584
    s_nop 0
    buffer_load_dwordx4 v8, s[12:15], s35 offen offset:1664 lds
    s_add_u32 m0, s34, 55552
    s_nop 0
    buffer_load_dwordx4 v8, s[12:15], s35 offen offset:1792 lds
    s_add_u32 m0, s34, 59520
    s_nop 0
    buffer_load_dwordx4 v8, s[12:15], s35 offen offset:1920 lds
    s_add_u32 s35, s35, 65536
    s_add_u32 m0, s34, 65536
    s_nop 0
    buffer_load_dwordx4 v8, s[12:15], s35 offen offset:0 lds
    s_add_u32 m0, s34, 69504
    s_nop 0
    buffer_load_dwordx4 v8, s[12:15], s35 offen offset:128 lds
    s_add_u32 m0, s34, 73472
    s_nop 0
    buffer_load_dwordx4 v8, s[12:15], s35 offen offset:256 lds
    s_add_u32 m0, s34, 77440
    s_nop 0
    buffer_load_dwordx4 v8, s[12:15], s35 offen offset:384 lds
    s_waitcnt vmcnt(12)
    s_barrier
    ds_read_b128 v[32:35], v12 offset:0
    ds_read_b128 v[36:39], v12 offset:1024
    ds_read_b128 v[40:43], v13 offset:0
    ds_read_b128 v[44:47], v13 offset:1024
    ds_read_b128 v[48:51], v12 offset:4096
    ds_read_b128 v[52:55], v12 offset:5120
    v_add_u32 v9, 2130706432, v9
    s_cmp_eq_u32 s44, 2
    s_cbranch_scc1 sl_v_65
sl_loop_67:
    s_waitcnt lgkmcnt(4)
    v_mfma_f32_16x16x32_bf16 v[64:67], a[0:3], v[32:35], 0
    ds_read_b128 v[56:59], v13 offset:4096
    v_mfma_f32_16x16x32_bf16 v[68:71], a[4:7], v[32:35], 0
    v_mfma_f32_16x16x32_bf16 v[72:75], a[0:3], v[36:39], 0
    ds_read_b128 v[60:63], v13 offset:5120
    s_add_u32 m0, s34, 81408
    v_mfma_f32_16x16x32_bf16 v[76:79], a[4:7], v[36:39], 0
    buffer_load_dwordx4 v8, s[12:15], s35 offen offset:512 lds
    s_waitcnt lgkmcnt(4)
    v_mfma_f32_16x16x32_bf16 v[64:67], a[8:11], v[40:43], v[64:67]
    ds_read_b128 v[32:35], v12 offset:8192
    v_mfma_f32_16x16x32_bf16 v[68:71], a[12:15], v[40:43], v[68:71]
    v_mfma_f32_16x16x32_bf16 v[72:75], a[8:11], v[44:47], v[72:75]
    ds_read_b128 v[36:39], v12 offset:9216
    v_mfma_f32_16x16x32_bf16 v[76:79], a[12:15], v[44:47], v[76:79]
    s_waitcnt lgkmcnt(4)
    v_mfma_f32_16x16x32_bf16 v[64:67], a[16:19], v[48:51], v[64:67]
    ds_read_b128 v[40:43], v13 offset:8192
    v_mfma_f32_16x16x32_bf16 v[68:71], a[20:23], v[48:51], v[68:71]
    v_cvt_pk_bf16_f32 v96, v80, v81
    v_mfma_f32_16x16x32_bf16 v[72:75], a[16:19], v[52:55], v[72:75]
    ds_read_b128 v[44:47], v13 offset:9216
    s_add_u32 m0, s34, 85376
    v_mfma_f32_16x16x32_bf16 v[76:79], a[20:23], v[52:55], v[76:79]
    buffer_load_dwordx4 v8, s[12:15], s35 offen offset:640 lds
    v_cvt_pk_bf16_f32 v97, v82, v83
    s_waitcnt lgkmcnt(4)
    v_mfma_f32_16x16x32_bf16 v[64:67], a[24:27], v[56:59], v[64:67]
    ds_read_b128 v[48:51], v12 offset:12288
    v_mfma_f32_16x16x32_bf16 v[68:71], a[28:31], v[56:59], v[68:71]
    v_cvt_pk_bf16_f32 v98, v84, v85
    v_mfma_f32_16x16x32_bf16 v[72:75], a[24:27], v[60:63], v[72:75]
    ds_read_b128 v[52:55], v12 offset:13312
    v_mfma_f32_16x16x32_bf16 v[76:79], a[28:31], v[60:63], v[76:79]
    v_cvt_pk_bf16_f32 v99, v86, v87
    s_waitcnt lgkmcnt(4)
    v_mfma_f32_16x16x32_bf16 v[64:67], a[32:35], v[32:35], v[64:67]
    ds_read_b128 v[56:59], v13 offset:12288
    v_mfma_f32_16x16x32_bf16 v[68:71], a[36:39], v[32:35], v[68:71]
    v_cvt_pk_bf16_f32 v100, v88, v89
    v_mfma_f32_16x16x32_bf16 v[72:75], a[32:35], v[36:39], v[72:75]
    ds_read_b128 v[60:63], v13 offset:13312
    s_add_u32 m0, s34, 89344
    v_mfma_f32_16x16x32_bf16 v[76:79], a[36:39], v[36:39], v[76:79]
    buffer_load_dwordx4 v8, s[12:15], s35 offen offset:768 lds
    v_cvt_pk_bf16_f32 v101, v90, v91
    s_waitcnt lgkmcnt(4)
    v_mfma_f32_16x16x32_bf16 v[64:67], a[40:43], v[40:43], v[64:67]
    ds_read_b128 v[32:35], v12 offset:16384
    v_mfma_f32_16x16x32_bf16 v[68:71], a[44:47], v[40:43], v[68:71]
    v_cvt_pk_bf16_f32 v102, v92, v93
    v_mfma_f32_16x16x32_bf16 v[72:75], a[40:43], v[44:47], v[72:75]
    ds_read_b128 v[36:39], v12 offset:17408
    v_mfma_f32_16x16x32_bf16 v[76:79], a[44:47], v[44:47], v[76:79]
    v_cvt_pk_bf16_f32 v103, v94, v95
    buffer_store_dwordx4 v[96:99], v9, s[4:7], s36 offen sc1
    s_waitcnt lgkmcnt(4)
    v_mfma_f32_16x16x32_bf16 v[64:67], a[48:51], v[48:51], v[64:67]
    ds_read_b128 v[40:43], v13 offset:16384
    v_mfma_f32_16x16x32_bf16 v[68:71], a[52:55], v[48:51], v[68:71]
    v_mfma_f32_16x16x32_bf16 v[72:75], a[48:51], v[52:55], v[72:75]
    ds_read_b128 v[44:47], v13 offset:17408
    s_add_u32 m0, s34, 93312
    v_mfma_f32_16x16x32_bf16 v[76:79], a[52:55], v[52:55], v[76:79]
    buffer_load_dwordx4 v8, s[12:15], s35 offen offset:896 lds
    s_waitcnt lgkmcnt(4)
    v_mfma_f32_16x16x32_bf16 v[64:67], a[56:59], v[56:59], v[64:67]
    ds_read_b128 v[48:51], v12 offset:20480
    v_mfma_f32_16x16x32_bf16 v[68:71], a[60:63], v[56:59], v[68:71]
    v_mfma_f32_16x16x32_bf16 v[72:75], a[56:59], v[60:63], v[72:75]
    ds_read_b128 v[52:55], v12 offset:21504
    v_mfma_f32_16x16x32_bf16 v[76:79], a[60:63], v[60:63], v[76:79]
    buffer_store_dwordx4 v[100:103], v9, s[4:7], s36 offen offset:128 sc1
    s_add_u32 s36, s36, s37
    s_waitcnt vmcnt(8)
    s_barrier
    s_waitcnt lgkmcnt(4)
    v_mfma_f32_16x16x32_bf16 v[64:67], a[64:67], v[32:35], v[64:67]
    ds_read_b128 v[56:59], v13 offset:20480
    v_mfma_f32_16x16x32_bf16 v[68:71], a[68:71], v[32:35], v[68:71]
    v_mfma_f32_16x16x32_bf16 v[72:75], a[64:67], v[36:39], v[72:75]
    ds_read_b128 v[60:63], v13 offset:21504
    s_add_u32 m0, s34, 97280
    v_mfma_f32_16x16x32_bf16 v[76:79], a[68:71], v[36:39], v[76:79]
    buffer_load_dwordx4 v8, s[12:15], s35 offen offset:1024 lds
    s_waitcnt lgkmcnt(4)
    v_mfma_f32_16x16x32_bf16 v[64:67], a[72:75], v[40:43], v[64:67]
    ds_read_b128 v[32:35], v12 offset:24576
    v_mfma_f32_16x16x32_bf16 v[68:71], a[76:79], v[40:43], v[68:71]
    v_mfma_f32_16x16x32_bf16 v[72:75], a[72:75], v[44:47], v[72:75]
    ds_read_b128 v[36:39], v12 offset:25600
    v_mfma_f32_16x16x32_bf16 v[76:79], a[76:79], v[44:47], v[76:79]
    s_waitcnt lgkmcnt(4)
    v_mfma_f32_16x16x32_bf16 v[64:67], a[80:83], v[48:51], v[64:67]
    ds_read_b128 v[40:43], v13 offset:24576
    v_mfma_f32_16x16x32_bf16 v[68:71], a[84:87], v[48:51], v[68:71]
    v_and_b32 v9, 0xffffff, v9
    v_mfma_f32_16x16x32_bf16 v[72:75], a[80:83], v[52:55], v[72:75]
    ds_read_b128 v[44:47], v13 offset:25600
    s_add_u32 m0, s34, 101248
    v_mfma_f32_16x16x32_bf16 v[76:79], a[84:87], v[52:55], v[76:79]
    buffer_load_dwordx4 v8, s[12:15], s35 offen offset:1152 lds
    s_waitcnt lgkmcnt(4)
    v_mfma_f32_16x16x32_bf16 v[64:67], a[88:91], v[56:59], v[64:67]
    ds_read_b128 v[48:51], v12 offset:28672
    v_mfma_f32_16x16x32_bf16 v[68:71], a[92:95], v[56:59], v[68:71]
    v_mfma_f32_16x16x32_bf16 v[72:75], a[88:91], v[60:63], v[72:75]
    ds_read_b128 v[52:55], v12 offset:29696
    v_mfma_f32_16x16x32_bf16 v[76:79], a[92:95], v[60:63], v[76:79]
    s_waitcnt lgkmcnt(4)
    v_mfma_f32_16x16x32_bf16 v[64:67], a[96:99], v[32:35], v[64:67]
    ds_read_b128 v[56:59], v13 offset:28672
    v_mfma_f32_16x16x32_bf16 v[68:71], a[100:103], v[32:35], v[68:71]
    v_mfma_f32_16x16x32_bf16 v[72:75], a[96:99], v[36:39], v[72:75]
    ds_read_b128 v[60:63], v13 offset:29696
    s_add_u32 m0, s34, 105216
    v_mfma_f32_16x16x32_bf16 v[76:79], a[100:103], v[36:39], v[76:79]
    buffer_load_dwordx4 v8, s[12:15], s35 offen offset:1280 lds
    s_waitcnt lgkmcnt(4)
    v_mfma_f32_16x16x32_bf16 v[64:67], a[104:107], v[40:43], v[64:67]
    ds_read_b128 v[32:35], v12 offset:32768
    v_mfma_f32_16x16x32_bf16 v[68:71], a[108:111], v[40:43], v[68:71]
    v_mfma_f32_16x16x32_bf16 v[72:75], a[104:107], v[44:47], v[72:75]
    ds_read_b128 v[36:39], v12 offset:33792
    v_mfma_f32_16x16x32_bf16 v[76:79], a[108:111], v[44:47], v[76:79]
    s_waitcnt lgkmcnt(4)
    v_mfma_f32_16x16x32_bf16 v[64:67], a[112:115], v[48:51], v[64:67]
    ds_read_b128 v[40:43], v13 offset:32768
    v_mfma_f32_16x16x32_bf16 v[68:71], a[116:119], v[48:51], v[68:71]
    v_mfma_f32_16x16x32_bf16 v[72:75], a[112:115], v[52:55], v[72:75]
    ds_read_b128 v[44:47], v13 offset:33792
    s_add_u32 m0, s34, 109184
    v_mfma_f32_16x16x32_bf16 v[76:79], a[116:119], v[52:55], v[76:79]
    buffer_load_dwordx4 v8, s[12:15], s35 offen offset:1408 lds
    s_waitcnt lgkmcnt(4)
    v_mfma_f32_16x16x32_bf16 v[64:67], a[120:123], v[56:59], v[64:67]
    ds_read_b128 v[48:51], v12 offset:36864
    v_mfma_f32_16x16x32_bf16 v[68:71], a[124:127], v[56:59], v[68:71]
    v_mfma_f32_16x16x32_bf16 v[72:75], a[120:123], v[60:63], v[72:75]
    ds_read_b128 v[52:55], v12 offset:37888
    v_mfma_f32_16x16x32_bf16 v[76:79], a[124:127], v[60:63], v[76:79]
    s_waitcnt lgkmcnt(4)
    v_mfma_f32_16x16x32_bf16 v[64:67], a[128:131], v[32:35], v[64:67]
    ds_read_b128 v[56:59], v13 offset:36864
    v_mfma_f32_16x16x32_bf16 v[68:71], a[132:135], v[32:35], v[68:71]
    v_mfma_f32_16x16x32_bf16 v[72:75], a[128:131], v[36:39], v[72:75]
    ds_read_b128 v[60:63], v13 offset:37888
    s_add_u32 m0, s34, 113152
    v_mfma_f32_16x16x32_bf16 v[76:79], a[132:135], v[36:39], v[76:79]
    buffer_load_dwordx4 v8, s[12:15], s35 offen offset:1536 lds
    s_waitcnt lgkmcnt(4)
    v_mfma_f32_16x16x32_bf16 v[64:67], a[136:139], v[40:43], v[64:67]
    ds_read_b128 v[32:35], v12 offset:40960
    v_mfma_f32_16x16x32_bf16 v[68:71], a[140:143], v[40:43], v[68:71]
    v_mfma_f32_16x16x32_bf16 v[72:75], a[136:139], v[44:47], v[72:75]
    ds_read_b128 v[36:39], v12 offset:41984
    v_mfma_f32_16x16x32_bf16 v[76:79], a[140:143], v[44:47], v[76:79]
    s_waitcnt lgkmcnt(4)
    v_mfma_f32_16x16x32_bf16 v[64:67], a[144:147], v[48:51], v[64:67]
    ds_read_b128 v[40:43], v13 offset:40960
    v_mfma_f32_16x16x32_bf16 v[68:71], a[148:151], v[48:51], v[68:71]
    v_mfma_f32_16x16x32_bf16 v[72:75], a[144:147], v[52:55], v[72:75]
    ds_read_b128 v[44:47], v13 offset:41984
    s_add_u32 m0, s34, 117120
    v_mfma_f32_16x16x32_bf16 v[76:79], a[148:151], v[52:55], v[76:79]
    buffer_load_dwordx4 v8, s[12:15], s35 offen offset:1664 lds
    s_waitcnt lgkmcnt(4)
    v_mfma_f32_16x16x32_bf16 v[64:67], a[152:155], v[56:59], v[64:67]
    ds_read_b128 v[48:51], v12 offset:45056
    v_mfma_f32_16x16x32_bf16 v[68:71], a[156:159], v[56:59], v[68:71]
    v_mfma_f32_16x16x32_bf16 v[72:75], a[152:155], v[60:63], v[72:75]
    ds_read_b128 v[52:55], v12 offset:46080
    v_mfma_f32_16x16x32_bf16 v[76:79], a[156:159], v[60:63], v[76:79]
    s_waitcnt lgkmcnt(4)
    v_mfma_f32_16x16x32_bf16 v[64:67], a[160:163], v[32:35], v[64:67]
    ds_read_b128 v[56:59], v13 offset:45056
    v_mfma_f32_16x16x32_bf16 v[68:71], a[164:167], v[32:35], v[68:71]
    v_mfma_f32_16x16x32_bf16 v[72:75], a[160:163], v[36:39], v[72:75]
    ds_read_b128 v[60:63], v13 offset:46080
    s_add_u32 m0, s34, 121088
    v_mfma_f32_16x16x32_bf16 v[76:79], a[164:167], v[36:39], v[76:79]
    buffer_load_dwordx4 v8, s[12:15], s35 offen offset:1792 lds
    s_waitcnt lgkmcnt(4)
    v_mfma_f32_16x16x32_bf16 v[64:67], a[168:171], v[40:43], v[64:67]
    ds_read_b128 v[32:35], v12 offset:49152
    v_mfma_f32_16x16x32_bf16 v[68:71], a[172:175], v[40:43], v[68:71]
    v_mfma_f32_16x16x32_bf16 v[72:75], a[168:171], v[44:47], v[72:75]
    ds_read_b128 v[36:39], v12 offset:50176
    v_mfma_f32_16x16x32_bf16 v[76:79], a[172:175], v[44:47], v[76:79]
    s_waitcnt lgkmcnt(4)
    v_mfma_f32_16x16x32_bf16 v[64:67], a[176:179], v[48:51], v[64:67]
    ds_read_b128 v[40:43], v13 offset:49152
    v_mfma_f32_16x16x32_bf16 v[68:71], a[180:183], v[48:51], v[68:71]
    v_mfma_f32_16x16x32_bf16 v[72:75], a[176:179], v[52:55], v[72:75]
    ds_read_b128 v[44:47], v13 offset:50176
    s_add_u32 m0, s34, 125056
    v_mfma_f32_16x16x32_bf16 v[76:79], a[180:183], v[52:55], v[76:79]
    buffer_load_dwordx4 v8, s[12:15], s35 offen offset:1920 lds
    s_add_u32 s35, s35, 65536
    s_min_u32 s35, s35, s52
    s_waitcnt lgkmcnt(4)
    v_mfma_f32_16x16x32_bf16 v[64:67], a[184:187], v[56:59], v[64:67]
    ds_read_b128 v[48:51], v12 offset:53248
    v_mfma_f32_16x16x32_bf16 v[68:71], a[188:191], v[56:59], v[68:71]
    v_mfma_f32_16x16x32_bf16 v[72:75], a[184:187], v[60:63], v[72:75]
    ds_read_b128 v[52:55], v12 offset:54272
    v_mfma_f32_16x16x32_bf16 v[76:79], a[188:191], v[60:63], v[76:79]
    s_waitcnt vmcnt(8)
    s_barrier
    s_waitcnt lgkmcnt(4)
    v_mfma_f32_16x16x32_bf16 v[64:67], a[192:195], v[32:35], v[64:67]
    ds_read_b128 v[56:59], v13 offset:53248
    v_mfma_f32_16x16x32_bf16 v[68:71], a[196:199], v[32:35], v[68:71]
    v_mfma_f32_16x16x32_bf16 v[72:75], a[192:195], v[36:39], v[72:75]
    ds_read_b128 v[60:63], v13 offset:54272
    s_add_u32 m0, s34, 0
    v_mfma_f32_16x16x32_bf16 v[76:79], a[196:199], v[36:39], v[76:79]
    buffer_load_dwordx4 v8, s[12:15], s35 offen offset:0 lds
    s_waitcnt lgkmcnt(4)
    v_mfma_f32_16x16x32_bf16 v[64:67], a[200:203], v[40:43], v[64:67]
    ds_read_b128 v[32:35], v12 offset:57344
    v_mfma_f32_16x16x32_bf16 v[68:71], a[204:207], v[40:43], v[68:71]
    buffer_store_dword v11, v10, s[4:7], 0 offen sc1
    v_add_u32 v11, 1, v11
    v_mfma_f32_16x16x32_bf16 v[72:75], a[200:203], v[44:47], v[72:75]
    ds_read_b128 v[36:39], v12 offset:58368
    v_mfma_f32_16x16x32_bf16 v[76:79], a[204:207], v[44:47], v[76:79]
    s_waitcnt lgkmcnt(4)
    v_mfma_f32_16x16x32_bf16 v[64:67], a[208:211], v[48:51], v[64:67]
    ds_read_b128 v[40:43], v13 offset:57344
    v_mfma_f32_16x16x32_bf16 v[68:71], a[212:215], v[48:51], v[68:71]
    v_mfma_f32_16x16x32_bf16 v[72:75], a[208:211], v[52:55], v[72:75]
    ds_read_b128 v[44:47], v13 offset:58368
    s_add_u32 m0, s34, 3968
    v_mfma_f32_16x16x32_bf16 v[76:79], a[212:215], v[52:55], v[76:79]
    buffer_load_dwordx4 v8, s[12:15], s35 offen offset:128 lds
    s_waitcnt lgkmcnt(4)
    v_mfma_f32_16x16x32_bf16 v[64:67], a[216:219], v[56:59], v[64:67]
    ds_read_b128 v[48:51], v12 offset:61440
    v_mfma_f32_16x16x32_bf16 v[68:71], a[220:223], v[56:59], v[68:71]
    v_mfma_f32_16x16x32_bf16 v[72:75], a[216:219], v[60:63], v[72:75]
    ds_read_b128 v[52:55], v12 offset:62464
    v_mfma_f32_16x16x32_bf16 v[76:79], a[220:223], v[60:63], v[76:79]
    s_waitcnt lgkmcnt(4)
    v_mfma_f32_16x16x32_bf16 v[64:67], a[224:227], v[32:35], v[64:67]
    ds_read_b128 v[56:59], v13 offset:61440
    v_mfma_f32_16x16x32_bf16 v[68:71], a[228:231], v[32:35], v[68:71]
    v_mfma_f32_16x16x32_bf16 v[72:75], a[224:227], v[36:39], v[72:75]
    ds_read_b128 v[60:63], v13 offset:62464
    s_add_u32 m0, s34, 7936
    v_mfma_f32_16x16x32_bf16 v[76:79], a[228:231], v[36:39], v[76:79]
    buffer_load_dwordx4 v8, s[12:15], s35 offen offset:256 lds
    s_waitcnt lgkmcnt(4)
    v_mfma_f32_16x16x32_bf16 v[64:67], a[232:235], v[40:43], v[64:67]
    ds_read_b128 v[32:35], v14 offset:0
    v_mfma_f32_16x16x32_bf16 v[68:71], a[236:239], v[40:43], v[68:71]
    v_mfma_f32_16x16x32_bf16 v[72:75], a[232:235], v[44:47], v[72:75]
    ds_read_b128 v[36:39], v14 offset:1024
    v_mfma_f32_16x16x32_bf16 v[76:79], a[236:239], v[44:47], v[76:79]
    s_waitcnt lgkmcnt(4)
    v_mfma_f32_16x16x32_bf16 v[64:67], a[240:243], v[48:51], v[64:67]
    ds_read_b128 v[40:43], v15 offset:0
    v_mfma_f32_16x16x32_bf16 v[68:71], a[244:247], v[48:51], v[68:71]
    v_mfma_f32_16x16x32_bf16 v[72:75], a[240:243], v[52:55], v[72:75]
    ds_read_b128 v[44:47], v15 offset:1024
    s_add_u32 m0, s34, 11904
    v_mfma_f32_16x16x32_bf16 v[76:79], a[244:247], v[52:55], v[76:79]
    buffer_load_dwordx4 v8, s[12:15], s35 offen offset:384 lds
    s_waitcnt lgkmcnt(4)
    v_mfma_f32_16x16x32_bf16 v[64:67], a[248:251], v[56:59], v[64:67]
    ds_read_b128 v[48:51], v14 offset:4096
    v_mfma_f32_16x16x32_bf16 v[68:71], a[252:255], v[56:59], v[68:71]
    v_mfma_f32_16x16x32_bf16 v[72:75], a[248:251], v[60:63], v[72:75]
    ds_read_b128 v[52:55], v14 offset:5120
    v_mfma_f32_16x16x32_bf16 v[76:79], a[252:255], v[60:63], v[76:79]
    s_waitcnt lgkmcnt(4)
    v_mfma_f32_16x16x32_bf16 v[80:83], a[0:3], v[32:35], 0
    ds_read_b128 v[56:59], v15 offset:4096
    v_mfma_f32_16x16x32_bf16 v[84:87], a[4:7], v[32:35], 0
    v_mfma_f32_16x16x32_bf16 v[88:91], a[0:3], v[36:39], 0
    ds_read_b128 v[60:63], v15 offset:5120
    s_add_u32 m0, s34, 15872
    v_mfma_f32_16x16x32_bf16 v[92:95], a[4:7], v[36:39], 0
    buffer_load_dwordx4 v8, s[12:15], s35 offen offset:512 lds
    s_waitcnt lgkmcnt(4)
    v_mfma_f32_16x16x32_bf16 v[80:83], a[8:11], v[40:43], v[80:83]
    ds_read_b128 v[32:35], v14 offset:8192
    v_mfma_f32_16x16x32_bf16 v[84:87], a[12:15], v[40:43], v[84:87]
    v_mfma_f32_16x16x32_bf16 v[88:91], a[8:11], v[44:47], v[88:91]
    ds_read_b128 v[36:39], v14 offset:9216
    v_mfma_f32_16x16x32_bf16 v[92:95], a[12:15], v[44:47], v[92:95]
    s_waitcnt lgkmcnt(4)
    v_mfma_f32_16x16x32_bf16 v[80:83], a[16:19], v[48:51], v[80:83]
    ds_read_b128 v[40:43], v15 offset:8192
    v_mfma_f32_16x16x32_bf16 v[84:87], a[20:23], v[48:51], v[84:87]
    v_cvt_pk_bf16_f32 v96, v64, v65
    v_mfma_f32_16x16x32_bf16 v[88:91], a[16:19], v[52:55], v[88:91]
    ds_read_b128 v[44:47], v15 offset:9216
    s_add_u32 m0, s34, 19840
    v_mfma_f32_16x16x32_bf16 v[92:95], a[20:23], v[52:55], v[92:95]
    buffer_load_dwordx4 v8, s[12:15], s35 offen offset:640 lds
    v_cvt_pk_bf16_f32 v97, v66, v67
    s_waitcnt lgkmcnt(4)
    v_mfma_f32_16x16x32_bf16 v[80:83], a[24:27], v[56:59], v[80:83]
    ds_read_b128 v[48:51], v14 offset:12288
    v_mfma_f32_16x16x32_bf16 v[84:87], a[28:31], v[56:59], v[84:87]
    v_cvt_pk_bf16_f32 v98, v68, v69
    v_mfma_f32_16x16x32_bf16 v[88:91], a[24:27], v[60:63], v[88:91]
    ds_read_b128 v[52:55], v14 offset:13312
    v_mfma_f32_16x16x32_bf16 v[92:95], a[28:31], v[60:63], v[92:95]
    v_cvt_pk_bf16_f32 v99, v70, v71
    s_waitcnt lgkmcnt(4)
    v_mfma_f32_16x16x32_bf16 v[80:83], a[32:35], v[32:35], v[80:83]
    ds_read_b128 v[56:59], v15 offset:12288
    v_mfma_f32_16x16x32_bf16 v[84:87], a[36:39], v[32:35], v[84:87]
    v_cvt_pk_bf16_f32 v100, v72, v73
    v_mfma_f32_16x16x32_bf16 v[88:91], a[32:35], v[36:39], v[88:91]
    ds_read_b128 v[60:63], v15 offset:13312
    s_add_u32 m0, s34, 23808
    v_mfma_f32_16x16x32_bf16 v[92:95], a[36:39], v[36:39], v[92:95]
    buffer_load_dwordx4 v8, s[12:15], s35 offen offset:768 lds
    v_cvt_pk_bf16_f32 v101, v74, v75
    s_waitcnt lgkmcnt(4)
    v_mfma_f32_16x16x32_bf16 v[80:83], a[40:43], v[40:43], v[80:83]
    ds_read_b128 v[32:35], v14 offset:16384
    v_mfma_f32_16x16x32_bf16 v[84:87], a[44:47], v[40:43], v[84:87]
    v_cvt_pk_bf16_f32 v102, v76, v77
    v_mfma_f32_16x16x32_bf16 v[88:91], a[40:43], v[44:47], v[88:91]
    ds_read_b128 v[36:39], v14 offset:17408
    v_mfma_f32_16x16x32_bf16 v[92:95], a[44:47], v[44:47], v[92:95]
    v_cvt_pk_bf16_f32 v103, v78, v79
    buffer_store_dwordx4 v[96:99], v9, s[4:7], s36 offen sc1
    s_waitcnt lgkmcnt(4)
    v_mfma_f32_16x16x32_bf16 v[80:83], a[48:51], v[48:51], v[80:83]
    ds_read_b128 v[40:43], v15 offset:16384
    v_mfma_f32_16x16x32_bf16 v[84:87], a[52:55], v[48:51], v[84:87]
    v_mfma_f32_16x16x32_bf16 v[88:91], a[48:51], v[52:55], v[88:91]
    ds_read_b128 v[44:47], v15 offset:17408
    s_add_u32 m0, s34, 27776
    v_mfma_f32_16x16x32_bf16 v[92:95], a[52:55], v[52:55], v[92:95]
    buffer_load_dwordx4 v8, s[12:15], s35 offen offset:896 lds
    s_waitcnt lgkmcnt(4)
    v_mfma_f32_16x16x32_bf16 v[80:83], a[56:59], v[56:59], v[80:83]
    ds_read_b128 v[48:51], v14 offset:20480
    v_mfma_f32_16x16x32_bf16 v[84:87], a[60:63], v[56:59], v[84:87]
    v_mfma_f32_16x16x32_bf16 v[88:91], a[56:59], v[60:63], v[88:91]
    ds_read_b128 v[52:55], v14 offset:21504
    v_mfma_f32_16x16x32_bf16 v[92:95], a[60:63], v[60:63], v[92:95]
    buffer_store_dwordx4 v[100:103], v9, s[4:7], s36 offen offset:128 sc1
    s_add_u32 s36, s36, s37
    s_waitcnt vmcnt(8)
    s_barrier
    s_waitcnt lgkmcnt(4)
    v_mfma_f32_16x16x32_bf16 v[80:83], a[64:67], v[32:35], v[80:83]
    ds_read_b128 v[56:59], v15 offset:20480
    v_mfma_f32_16x16x32_bf16 v[84:87], a[68:71], v[32:35], v[84:87]
    v_mfma_f32_16x16x32_bf16 v[88:91], a[64:67], v[36:39], v[88:91]
    ds_read_b128 v[60:63], v15 offset:21504
    s_add_u32 m0, s34, 31744
    v_mfma_f32_16x16x32_bf16 v[92:95], a[68:71], v[36:39], v[92:95]
    buffer_load_dwordx4 v8, s[12:15], s35 offen offset:1024 lds
    s_waitcnt lgkmcnt(4)
    v_mfma_f32_16x16x32_bf16 v[80:83], a[72:75], v[40:43], v[80:83]
    ds_read_b128 v[32:35], v14 offset:24576
    v_mfma_f32_16x16x32_bf16 v[84:87], a[76:79], v[40:43], v[84:87]
    v_mfma_f32_16x16x32_bf16 v[88:91], a[72:75], v[44:47], v[88:91]
    ds_read_b128 v[36:39], v14 offset:25600
    v_mfma_f32_16x16x32_bf16 v[92:95], a[76:79], v[44:47], v[92:95]
    s_waitcnt lgkmcnt(4)
    v_mfma_f32_16x16x32_bf16 v[80:83], a[80:83], v[48:51], v[80:83]
    ds_read_b128 v[40:43], v15 offset:24576
    v_mfma_f32_16x16x32_bf16 v[84:87], a[84:87], v[48:51], v[84:87]
    v_mfma_f32_16x16x32_bf16 v[88:91], a[80:83], v[52:55], v[88:91]
    ds_read_b128 v[44:47], v15 offset:25600
    s_add_u32 m0, s34, 35712
    v_mfma_f32_16x16x32_bf16 v[92:95], a[84:87], v[52:55], v[92:95]
    buffer_load_dwordx4 v8, s[12:15], s35 offen offset:1152 lds
    s_waitcnt lgkmcnt(4)
    v_mfma_f32_16x16x32_bf16 v[80:83], a[88:91], v[56:59], v[80:83]
    ds_read_b128 v[48:51], v14 offset:28672
    v_mfma_f32_16x16x32_bf16 v[84:87], a[92:95], v[56:59], v[84:87]
    v_mfma_f32_16x16x32_bf16 v[88:91], a[88:91], v[60:63], v[88:91]
    ds_read_b128 v[52:55], v14 offset:29696
    v_mfma_f32_16x16x32_bf16 v[92:95], a[92:95], v[60:63], v[92:95]
    s_waitcnt lgkmcnt(4)
    v_mfma_f32_16x16x32_bf16 v[80:83], a[96:99], v[32:35], v[80:83]
    ds_read_b128 v[56:59], v15 offset:28672
    v_mfma_f32_16x16x32_bf16 v[84:87], a[100:103], v[32:35], v[84:87]
    v_mfma_f32_16x16x32_bf16 v[88:91], a[96:99], v[36:39], v[88:91]
    ds_read_b128 v[60:63], v15 offset:29696
    s_add_u32 m0, s34, 39680
    v_mfma_f32_16x16x32_bf16 v[92:95], a[100:103], v[36:39], v[92:95]
    buffer_load_dwordx4 v8, s[12:15], s35 offen offset:1280 lds
    s_waitcnt lgkmcnt(4)
    v_mfma_f32_16x16x32_bf16 v[80:83], a[104:107], v[40:43], v[80:83]
    ds_read_b128 v[32:35], v14 offset:32768
    v_mfma_f32_16x16x32_bf16 v[84:87], a[108:111], v[40:43], v[84:87]
    v_mfma_f32_16x16x32_bf16 v[88:91], a[104:107], v[44:47], v[88:91]
    ds_read_b128 v[36:39], v14 offset:33792
    v_mfma_f32_16x16x32_bf16 v[92:95], a[108:111], v[44:47], v[92:95]
    s_waitcnt lgkmcnt(4)
    v_mfma_f32_16x16x32_bf16 v[80:83], a[112:115], v[48:51], v[80:83]
    ds_read_b128 v[40:43], v15 offset:32768
    v_mfma_f32_16x16x32_bf16 v[84:87], a[116:119], v[48:51], v[84:87]
    v_mfma_f32_16x16x32_bf16 v[88:91], a[112:115], v[52:55], v[88:91]
    ds_read_b128 v[44:47], v15 offset:33792
    s_add_u32 m0, s34, 43648
    v_mfma_f32_16x16x32_bf16 v[92:95], a[116:119], v[52:55], v[92:95]
    buffer_load_dwordx4 v8, s[12:15], s35 offen offset:1408 lds
    s_waitcnt lgkmcnt(4)
    v_mfma_f32_16x16x32_bf16 v[80:83], a[120:123], v[56:59], v[80:83]
    ds_read_b128 v[48:51], v14 offset:36864
    v_mfma_f32_16x16x32_bf16 v[84:87], a[124:127], v[56:59], v[84:87]
    v_mfma_f32_16x16x32_bf16 v[88:91], a[120:123], v[60:63], v[88:91]
    ds_read_b128 v[52:55], v14 offset:37888
    v_mfma_f32_16x16x32_bf16 v[92:95], a[124:127], v[60:63], v[92:95]
    s_waitcnt lgkmcnt(4)
    v_mfma_f32_16x16x32_bf16 v[80:83], a[128:131], v[32:35], v[80:83]
    ds_read_b128 v[56:59], v15 offset:36864
    v_mfma_f32_16x16x32_bf16 v[84:87], a[132:135], v[32:35], v[84:87]
    v_mfma_f32_16x16x32_bf16 v[88:91], a[128:131], v[36:39], v[88:91]
    ds_read_b128 v[60:63], v15 offset:37888
    s_add_u32 m0, s34, 47616
    v_mfma_f32_16x16x32_bf16 v[92:95], a[132:135], v[36:39], v[92:95]
    buffer_load_dwordx4 v8, s[12:15], s35 offen offset:1536 lds
    s_waitcnt lgkmcnt(4)
    v_mfma_f32_16x16x32_bf16 v[80:83], a[136:139], v[40:43], v[80:83]
    ds_read_b128 v[32:35], v14 offset:40960
    v_mfma_f32_16x16x32_bf16 v[84:87], a[140:143], v[40:43], v[84:87]
    v_mfma_f32_16x16x32_bf16 v[88:91], a[136:139], v[44:47], v[88:91]
    ds_read_b128 v[36:39], v14 offset:41984
    v_mfma_f32_16x16x32_bf16 v[92:95], a[140:143], v[44:47], v[92:95]
    s_waitcnt lgkmcnt(4)
    v_mfma_f32_16x16x32_bf16 v[80:83], a[144:147], v[48:51], v[80:83]
    ds_read_b128 v[40:43], v15 offset:40960
    v_mfma_f32_16x16x32_bf16 v[84:87], a[148:151], v[48:51], v[84:87]
    v_mfma_f32_16x16x32_bf16 v[88:91], a[144:147], v[52:55], v[88:91]
    ds_read_b128 v[44:47], v15 offset:41984
    s_add_u32 m0, s34, 51584
    v_mfma_f32_16x16x32_bf16 v[92:95], a[148:151], v[52:55], v[92:95]
    buffer_load_dwordx4 v8, s[12:15], s35 offen offset:1664 lds
    s_waitcnt lgkmcnt(4)
    v_mfma_f32_16x16x32_bf16 v[80:83], a[152:155], v[56:59], v[80:83]
    ds_read_b128 v[48:51], v14 offset:45056
    v_mfma_f32_16x16x32_bf16 v[84:87], a[156:159], v[56:59], v[84:87]
    v_mfma_f32_16x16x32_bf16 v[88:91], a[152:155], v[60:63], v[88:91]
    ds_read_b128 v[52:55], v14 offset:46080
    v_mfma_f32_16x16x32_bf16 v[92:95], a[156:159], v[60:63], v[92:95]
    s_waitcnt lgkmcnt(4)
    v_mfma_f32_16x16x32_bf16 v[80:83], a[160:163], v[32:35], v[80:83]
    ds_read_b128 v[56:59], v15 offset:45056
    v_mfma_f32_16x16x32_bf16 v[84:87], a[164:167], v[32:35], v[84:87]
    v_mfma_f32_16x16x32_bf16 v[88:91], a[160:163], v[36:39], v[88:91]
    ds_read_b128 v[60:63], v15 offset:46080
    s_add_u32 m0, s34, 55552
    v_mfma_f32_16x16x32_bf16 v[92:95], a[164:167], v[36:39], v[92:95]
    buffer_load_dwordx4 v8, s[12:15], s35 offen offset:1792 lds
    s_waitcnt lgkmcnt(4)
    v_mfma_f32_16x16x32_bf16 v[80:83], a[168:171], v[40:43], v[80:83]
    ds_read_b128 v[32:35], v14 offset:49152
    v_mfma_f32_16x16x32_bf16 v[84:87], a[172:175], v[40:43], v[84:87]
    v_mfma_f32_16x16x32_bf16 v[88:91], a[168:171], v[44:47], v[88:91]
    ds_read_b128 v[36:39], v14 offset:50176
    v_mfma_f32_16x16x32_bf16 v[92:95], a[172:175], v[44:47], v[92:95]
    s_waitcnt lgkmcnt(4)
    v_mfma_f32_16x16x32_bf16 v[80:83], a[176:179], v[48:51], v[80:83]
    ds_read_b128 v[40:43], v15 offset:49152
    v_mfma_f32_16x16x32_bf16 v[84:87], a[180:183], v[48:51], v[84:87]
    v_mfma_f32_16x16x32_bf16 v[88:91], a[176:179], v[52:55], v[88:91]
    ds_read_b128 v[44:47], v15 offset:50176
    s_add_u32 m0, s34, 59520
    v_mfma_f32_16x16x32_bf16 v[92:95], a[180:183], v[52:55], v[92:95]
    buffer_load_dwordx4 v8, s[12:15], s35 offen offset:1920 lds
    s_add_u32 s35, s35, 65536
    s_min_u32 s35, s35, s52
    s_waitcnt lgkmcnt(4)
    v_mfma_f32_16x16x32_bf16 v[80:83], a[184:187], v[56:59], v[80:83]
    ds_read_b128 v[48:51], v14 offset:53248
    v_mfma_f32_16x16x32_bf16 v[84:87], a[188:191], v[56:59], v[84:87]
    v_mfma_f32_16x16x32_bf16 v[88:91], a[184:187], v[60:63], v[88:91]
    ds_read_b128 v[52:55], v14 offset:54272
    v_mfma_f32_16x16x32_bf16 v[92:95], a[188:191], v[60:63], v[92:95]
    s_waitcnt vmcnt(8)
    s_barrier
    s_waitcnt lgkmcnt(4)
    v_mfma_f32_16x16x32_bf16 v[80:83], a[192:195], v[32:35], v[80:83]
    ds_read_b128 v[56:59], v15 offset:53248
    v_mfma_f32_16x16x32_bf16 v[84:87], a[196:199], v[32:35], v[84:87]
    v_mfma_f32_16x16x32_bf16 v[88:91], a[192:195], v[36:39], v[88:91]
    ds_read_b128 v[60:63], v15 offset:54272
    s_add_u32 m0, s34, 65536
    v_mfma_f32_16x16x32_bf16 v[92:95], a[196:199], v[36:39], v[92:95]
    buffer_load_dwordx4 v8, s[12:15], s35 offen offset:0 lds
    s_waitcnt lgkmcnt(4)
    v_mfma_f32_16x16x32_bf16 v[80:83], a[200:203], v[40:43], v[80:83]
    ds_read_b128 v[32:35], v14 offset:57344
    v_mfma_f32_16x16x32_bf16 v[84:87], a[204:207], v[40:43], v[84:87]
    buffer_store_dword v11, v10, s[4:7], 0 offen sc1
    v_add_u32 v11, 1, v11
    s_cmp_lg_u32 s30, s46
    s_cbranch_scc1 sl_ar_68
    s_mov_b64 exec, 1
    v_mov_b32 v4, 0
    v_mov_b32 v2, 1
    v_mov_b32 v3, s71
    global_atomic_add_x2 v4, v[2:3], s[92:93] offset:0 sc1
    s_mov_b64 exec, -1
sl_ar_68:
    v_mfma_f32_16x16x32_bf16 v[88:91], a[200:203], v[44:47], v[88:91]
    ds_read_b128 v[36:39], v14 offset:58368
    v_mfma_f32_16x16x32_bf16 v[92:95], a[204:207], v[44:47], v[92:95]
    s_waitcnt lgkmcnt(4)
    v_mfma_f32_16x16x32_bf16 v[80:83], a[208:211], v[48:51], v[80:83]
    ds_read_b128 v[40:43], v15 offset:57344
    v_mfma_f32_16x16x32_bf16 v[84:87], a[212:215], v[48:51], v[84:87]
    v_mfma_f32_16x16x32_bf16 v[88:91], a[208:211], v[52:55], v[88:91]
    ds_read_b128 v[44:47], v15 offset:58368
    s_add_u32 m0, s34, 69504
    v_mfma_f32_16x16x32_bf16 v[92:95], a[212:215], v[52:55], v[92:95]
    buffer_load_dwordx4 v8, s[12:15], s35 offen offset:128 lds
    s_waitcnt lgkmcnt(4)
    v_mfma_f32_16x16x32_bf16 v[80:83], a[216:219], v[56:59], v[80:83]
    ds_read_b128 v[48:51], v14 offset:61440
    v_mfma_f32_16x16x32_bf16 v[84:87], a[220:223], v[56:59], v[84:87]
    v_mfma_f32_16x16x32_bf16 v[88:91], a[216:219], v[60:63], v[88:91]
    ds_read_b128 v[52:55], v14 offset:62464
    v_mfma_f32_16x16x32_bf16 v[92:95], a[220:223], v[60:63], v[92:95]
    s_waitcnt lgkmcnt(4)
    v_mfma_f32_16x16x32_bf16 v[80:83], a[224:227], v[32:35], v[80:83]
    ds_read_b128 v[56:59], v15 offset:61440
    v_mfma_f32_16x16x32_bf16 v[84:87], a[228:231], v[32:35], v[84:87]
    v_mfma_f32_16x16x32_bf16 v[88:91], a[224:227], v[36:39], v[88:91]
    ds_read_b128 v[60:63], v15 offset:62464
    s_add_u32 m0, s34, 73472
    v_mfma_f32_16x16x32_bf16 v[92:95], a[228:231], v[36:39], v[92:95]
    buffer_load_dwordx4 v8, s[12:15], s35 offen offset:256 lds
    s_waitcnt lgkmcnt(4)
    v_mfma_f32_16x16x32_bf16 v[80:83], a[232:235], v[40:43], v[80:83]
    ds_read_b128 v[32:35], v12 offset:0
    v_mfma_f32_16x16x32_bf16 v[84:87], a[236:239], v[40:43], v[84:87]
    v_mfma_f32_16x16x32_bf16 v[88:91], a[232:235], v[44:47], v[88:91]
    ds_read_b128 v[36:39], v12 offset:1024
    v_mfma_f32_16x16x32_bf16 v[92:95], a[236:239], v[44:47], v[92:95]
    s_waitcnt lgkmcnt(4)
    v_mfma_f32_16x16x32_bf16 v[80:83], a[240:243], v[48:51], v[80:83]
    ds_read_b128 v[40:43], v13 offset:0
    v_mfma_f32_16x16x32_bf16 v[84:87], a[244:247], v[48:51], v[84:87]
    v_mfma_f32_16x16x32_bf16 v[88:91], a[240:243], v[52:55], v[88:91]
    ds_read_b128 v[44:47], v13 offset:1024
    s_add_u32 m0, s34, 77440
    v_mfma_f32_16x16x32_bf16 v[92:95], a[244:247], v[52:55], v[92:95]
    buffer_load_dwordx4 v8, s[12:15], s35 offen offset:384 lds
    s_waitcnt lgkmcnt(4)
    v_mfma_f32_16x16x32_bf16 v[80:83], a[248:251], v[56:59], v[80:83]
    ds_read_b128 v[48:51], v12 offset:4096
    v_mfma_f32_16x16x32_bf16 v[84:87], a[252:255], v[56:59], v[84:87]
    v_mfma_f32_16x16x32_bf16 v[88:91], a[248:251], v[60:63], v[88:91]
    ds_read_b128 v[52:55], v12 offset:5120
    v_mfma_f32_16x16x32_bf16 v[92:95], a[252:255], v[60:63], v[92:95]
    s_add_u32 s30, s30, 2
    s_cmp_lt_u32 s30, s51
    s_cbranch_scc1 sl_loop_67
    v_cvt_pk_bf16_f32 v96, v80, v81
    v_cvt_pk_bf16_f32 v97, v82, v83
    v_cvt_pk_bf16_f32 v98, v84, v85
    v_cvt_pk_bf16_f32 v99, v86, v87
    v_cvt_pk_bf16_f32 v100, v88, v89
    v_cvt_pk_bf16_f32 v101, v90, v91
    v_cvt_pk_bf16_f32 v102, v92, v93
    v_cvt_pk_bf16_f32 v103, v94, v95
    s_branch sl_e_66
sl_v_65:
sl_loop_69:
    s_waitcnt lgkmcnt(4)
    v_mfma_f32_16x16x32_bf16 v[64:67], v[32:35], a[0:3], 0
    ds_read_b128 v[56:59], v13 offset:4096
    v_mfma_f32_16x16x32_bf16 v[68:71], v[32:35], a[4:7], 0
    v_mfma_f32_16x16x32_bf16 v[72:75], v[36:39], a[0:3], 0
    ds_read_b128 v[60:63], v13 offset:5120
    s_add_u32 m0, s34, 81408
    v_mfma_f32_16x16x32_bf16 v[76:79], v[36:39], a[4:7], 0
    buffer_load_dwordx4 v8, s[12:15], s35 offen offset:512 lds
    s_waitcnt lgkmcnt(4)
    v_mfma_f32_16x16x32_bf16 v[64:67], v[40:43], a[8:11], v[64:67]
    ds_read_b128 v[32:35], v12 offset:8192
    v_mfma_f32_16x16x32_bf16 v[68:71], v[40:43], a[12:15], v[68:71]
    v_mfma_f32_16x16x32_bf16 v[72:75], v[44:47], a[8:11], v[72:75]
    ds_read_b128 v[36:39], v12 offset:9216
    v_mfma_f32_16x16x32_bf16 v[76:79], v[44:47], a[12:15], v[76:79]
    s_waitcnt lgkmcnt(4)
    v_mfma_f32_16x16x32_bf16 v[64:67], v[48:51], a[16:19], v[64:67]
    ds_read_b128 v[40:43], v13 offset:8192
    v_mfma_f32_16x16x32_bf16 v[68:71], v[48:51], a[20:23], v[68:71]
    v_cvt_pk_bf16_f32 v96, v80, v81
    v_mfma_f32_16x16x32_bf16 v[72:75], v[52:55], a[16:19], v[72:75]
    ds_read_b128 v[44:47], v13 offset:9216
    s_add_u32 m0, s34, 85376
    v_mfma_f32_16x16x32_bf16 v[76:79], v[52:55], a[20:23], v[76:79]
    buffer_load_dwordx4 v8, s[12:15], s35 offen offset:640 lds
    v_cvt_pk_bf16_f32 v97, v82, v83
    s_waitcnt lgkmcnt(4)
    v_mfma_f32_16x16x32_bf16 v[64:67], v[56:59], a[24:27], v[64:67]
    ds_read_b128 v[48:51], v12 offset:12288
    v_mfma_f32_16x16x32_bf16 v[68:71], v[56:59], a[28:31], v[68:71]
    v_cvt_pk_bf16_f32 v98, v88, v89
    v_mfma_f32_16x16x32_bf16 v[72:75], v[60:63], a[24:27], v[72:75]
    ds_read_b128 v[52:55], v12 offset:13312
    v_mfma_f32_16x16x32_bf16 v[76:79], v[60:63], a[28:31], v[76:79]
    v_cvt_pk_bf16_f32 v99, v90, v91
    s_waitcnt lgkmcnt(4)
    v_mfma_f32_16x16x32_bf16 v[64:67], v[32:35], a[32:35], v[64:67]
    ds_read_b128 v[56:59], v13 offset:12288
    v_mfma_f32_16x16x32_bf16 v[68:71], v[32:35], a[36:39], v[68:71]
    v_cvt_pk_bf16_f32 v100, v84, v85
    v_mfma_f32_16x16x32_bf16 v[72:75], v[36:39], a[32:35], v[72:75]
    ds_read_b128 v[60:63], v13 offset:13312
    s_add_u32 m0, s34, 89344
    v_mfma_f32_16x16x32_bf16 v[76:79], v[36:39], a[36:39], v[76:79]
    buffer_load_dwordx4 v8, s[12:15], s35 offen offset:768 lds
    v_cvt_pk_bf16_f32 v101, v86, v87
    s_waitcnt lgkmcnt(4)
    v_mfma_f32_16x16x32_bf16 v[64:67], v[40:43], a[40:43], v[64:67]
    ds_read_b128 v[32:35], v12 offset:16384
    v_mfma_f32_16x16x32_bf16 v[68:71], v[40:43], a[44:47], v[68:71]
    v_cvt_pk_bf16_f32 v102, v92, v93
    v_mfma_f32_16x16x32_bf16 v[72:75], v[44:47], a[40:43], v[72:75]
    ds_read_b128 v[36:39], v12 offset:17408
    v_mfma_f32_16x16x32_bf16 v[76:79], v[44:47], a[44:47], v[76:79]
    v_cvt_pk_bf16_f32 v103, v94, v95
    buffer_store_dwordx4 v[96:99], v9, s[4:7], s36 offen sc1
    s_waitcnt lgkmcnt(4)
    v_mfma_f32_16x16x32_bf16 v[64:67], v[48:51], a[48:51], v[64:67]
    ds_read_b128 v[40:43], v13 offset:16384
    v_mfma_f32_16x16x32_bf16 v[68:71], v[48:51], a[52:55], v[68:71]
    v_mfma_f32_16x16x32_bf16 v[72:75], v[52:55], a[48:51], v[72:75]
    ds_read_b128 v[44:47], v13 offset:17408
    s_add_u32 m0, s34, 93312
    v_mfma_f32_16x16x32_bf16 v[76:79], v[52:55], a[52:55], v[76:79]
    buffer_load_dwordx4 v8, s[12:15], s35 offen offset:896 lds
    s_waitcnt lgkmcnt(4)
    v_mfma_f32_16x16x32_bf16 v[64:67], v[56:59], a[56:59], v[64:67]
    ds_read_b128 v[48:51], v12 offset:20480
    v_mfma_f32_16x16x32_bf16 v[68:71], v[56:59], a[60:63], v[68:71]
    v_mfma_f32_16x16x32_bf16 v[72:75], v[60:63], a[56:59], v[72:75]
    ds_read_b128 v[52:55], v12 offset:21504
    v_mfma_f32_16x16x32_bf16 v[76:79], v[60:63], a[60:63], v[76:79]
    buffer_store_dwordx4 v[100:103], v9, s[4:7], s36 offen offset:128 sc1
    s_add_u32 s36, s36, s37
    s_waitcnt vmcnt(8)
    s_barrier
    s_waitcnt lgkmcnt(4)
    v_mfma_f32_16x16x32_bf16 v[64:67], v[32:35], a[64:67], v[64:67]
    ds_read_b128 v[56:59], v13 offset:20480
    v_mfma_f32_16x16x32_bf16 v[68:71], v[32:35], a[68:71], v[68:71]
    v_mfma_f32_16x16x32_bf16 v[72:75], v[36:39], a[64:67], v[72:75]
    ds_read_b128 v[60:63], v13 offset:21504
    s_add_u32 m0, s34, 97280
    v_mfma_f32_16x16x32_bf16 v[76:79], v[36:39], a[68:71], v[76:79]
    buffer_load_dwordx4 v8, s[12:15], s35 offen offset:1024 lds
    s_waitcnt lgkmcnt(4)
    v_mfma_f32_16x16x32_bf16 v[64:67], v[40:43], a[72:75], v[64:67]
    ds_read_b128 v[32:35], v12 offset:24576
    v_mfma_f32_16x16x32_bf16 v[68:71], v[40:43], a[76:79], v[68:71]
    v_mfma_f32_16x16x32_bf16 v[72:75], v[44:47], a[72:75], v[72:75]
    ds_read_b128 v[36:39], v12 offset:25600
    v_mfma_f32_16x16x32_bf16 v[76:79], v[44:47], a[76:79], v[76:79]
    s_waitcnt lgkmcnt(4)
    v_mfma_f32_16x16x32_bf16 v[64:67], v[48:51], a[80:83], v[64:67]
    ds_read_b128 v[40:43], v13 offset:24576
    v_mfma_f32_16x16x32_bf16 v[68:71], v[48:51], a[84:87], v[68:71]
    v_and_b32 v9, 0xffffff, v9
    v_mfma_f32_16x16x32_bf16 v[72:75], v[52:55], a[80:83], v[72:75]
    ds_read_b128 v[44:47], v13 offset:25600
    s_add_u32 m0, s34, 101248
    v_mfma_f32_16x16x32_bf16 v[76:79], v[52:55], a[84:87], v[76:79]
    buffer_load_dwordx4 v8, s[12:15], s35 offen offset:1152 lds
    s_waitcnt lgkmcnt(4)
    v_mfma_f32_16x16x32_bf16 v[64:67], v[56:59], a[88:91], v[64:67]
    ds_read_b128 v[48:51], v12 offset:28672
    v_mfma_f32_16x16x32_bf16 v[68:71], v[56:59], a[92:95], v[68:71]
    v_mfma_f32_16x16x32_bf16 v[72:75], v[60:63], a[88:91], v[72:75]
    ds_read_b128 v[52:55], v12 offset:29696
    v_mfma_f32_16x16x32_bf16 v[76:79], v[60:63], a[92:95], v[76:79]
    s_waitcnt lgkmcnt(4)
    v_mfma_f32_16x16x32_bf16 v[64:67], v[32:35], a[96:99], v[64:67]
    ds_read_b128 v[56:59], v13 offset:28672
    v_mfma_f32_16x16x32_bf16 v[68:71], v[32:35], a[100:103], v[68:71]
    v_mfma_f32_16x16x32_bf16 v[72:75], v[36:39], a[96:99], v[72:75]
    ds_read_b128 v[60:63], v13 offset:29696
    s_add_u32 m0, s34, 105216
    v_mfma_f32_16x16x32_bf16 v[76:79], v[36:39], a[100:103], v[76:79]
    buffer_load_dwordx4 v8, s[12:15], s35 offen offset:1280 lds
    s_waitcnt lgkmcnt(4)
    v_mfma_f32_16x16x32_bf16 v[64:67], v[40:43], a[104:107], v[64:67]
    ds_read_b128 v[32:35], v12 offset:32768
    v_mfma_f32_16x16x32_bf16 v[68:71], v[40:43], a[108:111], v[68:71]
    v_mfma_f32_16x16x32_bf16 v[72:75], v[44:47], a[104:107], v[72:75]
    ds_read_b128 v[36:39], v12 offset:33792
    v_mfma_f32_16x16x32_bf16 v[76:79], v[44:47], a[108:111], v[76:79]
    s_waitcnt lgkmcnt(4)
    v_mfma_f32_16x16x32_bf16 v[64:67], v[48:51], a[112:115], v[64:67]
    ds_read_b128 v[40:43], v13 offset:32768
    v_mfma_f32_16x16x32_bf16 v[68:71], v[48:51], a[116:119], v[68:71]
    v_mfma_f32_16x16x32_bf16 v[72:75], v[52:55], a[112:115], v[72:75]
    ds_read_b128 v[44:47], v13 offset:33792
    s_add_u32 m0, s34, 109184
    v_mfma_f32_16x16x32_bf16 v[76:79], v[52:55], a[116:119], v[76:79]
    buffer_load_dwordx4 v8, s[12:15], s35 offen offset:1408 lds
    s_waitcnt lgkmcnt(4)
    v_mfma_f32_16x16x32_bf16 v[64:67], v[56:59], a[120:123], v[64:67]
    ds_read_b128 v[48:51], v12 offset:36864
    v_mfma_f32_16x16x32_bf16 v[68:71], v[56:59], a[124:127], v[68:71]
    v_mfma_f32_16x16x32_bf16 v[72:75], v[60:63], a[120:123], v[72:75]
    ds_read_b128 v[52:55], v12 offset:37888
    v_mfma_f32_16x16x32_bf16 v[76:79], v[60:63], a[124:127], v[76:79]
    s_waitcnt lgkmcnt(4)
    v_mfma_f32_16x16x32_bf16 v[64:67], v[32:35], a[128:131], v[64:67]
    ds_read_b128 v[56:59], v13 offset:36864
    v_mfma_f32_16x16x32_bf16 v[68:71], v[32:35], a[132:135], v[68:71]
    v_mfma_f32_16x16x32_bf16 v[72:75], v[36:39], a[128:131], v[72:75]
    ds_read_b128 v[60:63], v13 offset:37888
    s_add_u32 m0, s34, 113152
    v_mfma_f32_16x16x32_bf16 v[76:79], v[36:39], a[132:135], v[76:79]
    buffer_load_dwordx4 v8, s[12:15], s35 offen offset:1536 lds
    s_waitcnt lgkmcnt(4)
    v_mfma_f32_16x16x32_bf16 v[64:67], v[40:43], a[136:139], v[64:67]
    ds_read_b128 v[32:35], v12 offset:40960
    v_mfma_f32_16x16x32_bf16 v[68:71], v[40:43], a[140:143], v[68:71]
    v_mfma_f32_16x16x32_bf16 v[72:75], v[44:47], a[136:139], v[72:75]
    ds_read_b128 v[36:39], v12 offset:41984
    v_mfma_f32_16x16x32_bf16 v[76:79], v[44:47], a[140:143], v[76:79]
    s_waitcnt lgkmcnt(4)
    v_mfma_f32_16x16x32_bf16 v[64:67], v[48:51], a[144:147], v[64:67]
    ds_read_b128 v[40:43], v13 offset:40960
    v_mfma_f32_16x16x32_bf16 v[68:71], v[48:51], a[148:151], v[68:71]
    v_mfma_f32_16x16x32_bf16 v[72:75], v[52:55], a[144:147], v[72:75]
    ds_read_b128 v[44:47], v13 offset:41984
    s_add_u32 m0, s34, 117120
    v_mfma_f32_16x16x32_bf16 v[76:79], v[52:55], a[148:151], v[76:79]
    buffer_load_dwordx4 v8, s[12:15], s35 offen offset:1664 lds
    s_waitcnt lgkmcnt(4)
    v_mfma_f32_16x16x32_bf16 v[64:67], v[56:59], a[152:155], v[64:67]
    ds_read_b128 v[48:51], v12 offset:45056
    v_mfma_f32_16x16x32_bf16 v[68:71], v[56:59], a[156:159], v[68:71]
    v_mfma_f32_16x16x32_bf16 v[72:75], v[60:63], a[152:155], v[72:75]
    ds_read_b128 v[52:55], v12 offset:46080
    v_mfma_f32_16x16x32_bf16 v[76:79], v[60:63], a[156:159], v[76:79]
    s_waitcnt lgkmcnt(4)
    v_mfma_f32_16x16x32_bf16 v[64:67], v[32:35], a[160:163], v[64:67]
    ds_read_b128 v[56:59], v13 offset:45056
    v_mfma_f32_16x16x32_bf16 v[68:71], v[32:35], a[164:167], v[68:71]
    v_mfma_f32_16x16x32_bf16 v[72:75], v[36:39], a[160:163], v[72:75]
    ds_read_b128 v[60:63], v13 offset:46080
    s_add_u32 m0, s34, 121088
    v_mfma_f32_16x16x32_bf16 v[76:79], v[36:39], a[164:167], v[76:79]
    buffer_load_dwordx4 v8, s[12:15], s35 offen offset:1792 lds
    s_waitcnt lgkmcnt(4)
    v_mfma_f32_16x16x32_bf16 v[64:67], v[40:43], a[168:171], v[64:67]
    ds_read_b128 v[32:35], v12 offset:49152
    v_mfma_f32_16x16x32_bf16 v[68:71], v[40:43], a[172:175], v[68:71]
    v_mfma_f32_16x16x32_bf16 v[72:75], v[44:47], a[168:171], v[72:75]
    ds_read_b128 v[36:39], v12 offset:50176
    v_mfma_f32_16x16x32_bf16 v[76:79], v[44:47], a[172:175], v[76:79]
    s_waitcnt lgkmcnt(4)
    v_mfma_f32_16x16x32_bf16 v[64:67], v[48:51], a[176:179], v[64:67]
    ds_read_b128 v[40:43], v13 offset:49152
    v_mfma_f32_16x16x32_bf16 v[68:71], v[48:51], a[180:183], v[68:71]
    v_mfma_f32_16x16x32_bf16 v[72:75], v[52:55], a[176:179], v[72:75]
    ds_read_b128 v[44:47], v13 offset:50176
    s_add_u32 m0, s34, 125056
    v_mfma_f32_16x16x32_bf16 v[76:79], v[52:55], a[180:183], v[76:79]
    buffer_load_dwordx4 v8, s[12:15], s35 offen offset:1920 lds
    s_add_u32 s35, s35, 65536
    s_min_u32 s35, s35, s52
    s_waitcnt lgkmcnt(4)
    v_mfma_f32_16x16x32_bf16 v[64:67], v[56:59], a[184:187], v[64:67]
    ds_read_b128 v[48:51], v12 offset:53248
    v_mfma_f32_16x16x32_bf16 v[68:71], v[56:59], a[188:191], v[68:71]
    v_mfma_f32_16x16x32_bf16 v[72:75], v[60:63], a[184:187], v[72:75]
    ds_read_b128 v[52:55], v12 offset:54272
    v_mfma_f32_16x16x32_bf16 v[76:79], v[60:63], a[188:191], v[76:79]
    s_waitcnt vmcnt(8)
    s_barrier
    s_waitcnt lgkmcnt(4)
    v_mfma_f32_16x16x32_bf16 v[64:67], v[32:35], a[192:195], v[64:67]
    ds_read_b128 v[56:59], v13 offset:53248
    v_mfma_f32_16x16x32_bf16 v[68:71], v[32:35], a[196:199], v[68:71]
    v_mfma_f32_16x16x32_bf16 v[72:75], v[36:39], a[192:195], v[72:75]
    ds_read_b128 v[60:63], v13 offset:54272
    s_add_u32 m0, s34, 0
    v_mfma_f32_16x16x32_bf16 v[76:79], v[36:39], a[196:199], v[76:79]
    buffer_load_dwordx4 v8, s[12:15], s35 offen offset:0 lds
    s_waitcnt lgkmcnt(4)
    v_mfma_f32_16x16x32_bf16 v[64:67], v[40:43], a[200:203], v[64:67]
    ds_read_b128 v[32:35], v12 offset:57344
    v_mfma_f32_16x16x32_bf16 v[68:71], v[40:43], a[204:207], v[68:71]
    buffer_store_dword v11, v10, s[4:7], 0 offen sc1
    v_add_u32 v11, 1, v11
    v_mfma_f32_16x16x32_bf16 v[72:75], v[44:47], a[200:203], v[72:75]
    ds_read_b128 v[36:39], v12 offset:58368
    v_mfma_f32_16x16x32_bf16 v[76:79], v[44:47], a[204:207], v[76:79]
    s_waitcnt lgkmcnt(4)
    v_mfma_f32_16x16x32_bf16 v[64:67], v[48:51], a[208:211], v[64:67]
    ds_read_b128 v[40:43], v13 offset:57344
    v_mfma_f32_16x16x32_bf16 v[68:71], v[48:51], a[212:215], v[68:71]
    v_mfma_f32_16x16x32_bf16 v[72:75], v[52:55], a[208:211], v[72:75]
    ds_read_b128 v[44:47], v13 offset:58368
    s_add_u32 m0, s34, 3968
    v_mfma_f32_16x16x32_bf16 v[76:79], v[52:55], a[212:215], v[76:79]
    buffer_load_dwordx4 v8, s[12:15], s35 offen offset:128 lds
    s_waitcnt lgkmcnt(4)
    v_mfma_f32_16x16x32_bf16 v[64:67], v[56:59], a[216:219], v[64:67]
    ds_read_b128 v[48:51], v12 offset:61440
    v_mfma_f32_16x16x32_bf16 v[68:71], v[56:59], a[220:223], v[68:71]
    v_mfma_f32_16x16x32_bf16 v[72:75], v[60:63], a[216:219], v[72:75]
    ds_read_b128 v[52:55], v12 offset:62464
    v_mfma_f32_16x16x32_bf16 v[76:79], v[60:63], a[220:223], v[76:79]
    s_waitcnt lgkmcnt(4)
    v_mfma_f32_16x16x32_bf16 v[64:67], v[32:35], a[224:227], v[64:67]
    ds_read_b128 v[56:59], v13 offset:61440
    v_mfma_f32_16x16x32_bf16 v[68:71], v[32:35], a[228:231], v[68:71]
    v_mfma_f32_16x16x32_bf16 v[72:75], v[36:39], a[224:227], v[72:75]
    ds_read_b128 v[60:63], v13 offset:62464
    s_add_u32 m0, s34, 7936
    v_mfma_f32_16x16x32_bf16 v[76:79], v[36:39], a[228:231], v[76:79]
    buffer_load_dwordx4 v8, s[12:15], s35 offen offset:256 lds
    s_waitcnt lgkmcnt(4)
    v_mfma_f32_16x16x32_bf16 v[64:67], v[40:43], a[232:235], v[64:67]
    ds_read_b128 v[32:35], v14 offset:0
    v_mfma_f32_16x16x32_bf16 v[68:71], v[40:43], a[236:239], v[68:71]
    v_mfma_f32_16x16x32_bf16 v[72:75], v[44:47], a[232:235], v[72:75]
    ds_read_b128 v[36:39], v14 offset:1024
    v_mfma_f32_16x16x32_bf16 v[76:79], v[44:47], a[236:239], v[76:79]
    s_waitcnt lgkmcnt(4)
    v_mfma_f32_16x16x32_bf16 v[64:67], v[48:51], a[240:243], v[64:67]
    ds_read_b128 v[40:43], v15 offset:0
    v_mfma_f32_16x16x32_bf16 v[68:71], v[48:51], a[244:247], v[68:71]
    v_mfma_f32_16x16x32_bf16 v[72:75], v[52:55], a[240:243], v[72:75]
    ds_read_b128 v[44:47], v15 offset:1024
    s_add_u32 m0, s34, 11904
    v_mfma_f32_16x16x32_bf16 v[76:79], v[52:55], a[244:247], v[76:79]
    buffer_load_dwordx4 v8, s[12:15], s35 offen offset:384 lds
    s_waitcnt lgkmcnt(4)
    v_mfma_f32_16x16x32_bf16 v[64:67], v[56:59], a[248:251], v[64:67]
    ds_read_b128 v[48:51], v14 offset:4096
    v_mfma_f32_16x16x32_bf16 v[68:71], v[56:59], a[252:255], v[68:71]
    v_mfma_f32_16x16x32_bf16 v[72:75], v[60:63], a[248:251], v[72:75]
    ds_read_b128 v[52:55], v14 offset:5120
    v_mfma_f32_16x16x32_bf16 v[76:79], v[60:63], a[252:255], v[76:79]
    s_waitcnt lgkmcnt(4)
    v_mfma_f32_16x16x32_bf16 v[80:83], v[32:35], a[0:3], 0
    ds_read_b128 v[56:59], v15 offset:4096
    v_mfma_f32_16x16x32_bf16 v[84:87], v[32:35], a[4:7], 0
    v_mfma_f32_16x16x32_bf16 v[88:91], v[36:39], a[0:3], 0
    ds_read_b128 v[60:63], v15 offset:5120
    s_add_u32 m0, s34, 15872
    v_mfma_f32_16x16x32_bf16 v[92:95], v[36:39], a[4:7], 0
    buffer_load_dwordx4 v8, s[12:15], s35 offen offset:512 lds
    s_waitcnt lgkmcnt(4)
    v_mfma_f32_16x16x32_bf16 v[80:83], v[40:43], a[8:11], v[80:83]
    ds_read_b128 v[32:35], v14 offset:8192
    v_mfma_f32_16x16x32_bf16 v[84:87], v[40:43], a[12:15], v[84:87]
    v_mfma_f32_16x16x32_bf16 v[88:91], v[44:47], a[8:11], v[88:91]
    ds_read_b128 v[36:39], v14 offset:9216
    v_mfma_f32_16x16x32_bf16 v[92:95], v[44:47], a[12:15], v[92:95]
    s_waitcnt lgkmcnt(4)
    v_mfma_f32_16x16x32_bf16 v[80:83], v[48:51], a[16:19], v[80:83]
    ds_read_b128 v[40:43], v15 offset:8192
    v_mfma_f32_16x16x32_bf16 v[84:87], v[48:51], a[20:23], v[84:87]
    v_cvt_pk_bf16_f32 v96, v64, v65
    v_mfma_f32_16x16x32_bf16 v[88:91], v[52:55], a[16:19], v[88:91]
    ds_read_b128 v[44:47], v15 offset:9216
    s_add_u32 m0, s34, 19840
    v_mfma_f32_16x16x32_bf16 v[92:95], v[52:55], a[20:23], v[92:95]
    buffer_load_dwordx4 v8, s[12:15], s35 offen offset:640 lds
    v_cvt_pk_bf16_f32 v97, v66, v67
    s_waitcnt lgkmcnt(4)
    v_mfma_f32_16x16x32_bf16 v[80:83], v[56:59], a[24:27], v[80:83]
    ds_read_b128 v[48:51], v14 offset:12288
    v_mfma_f32_16x16x32_bf16 v[84:87], v[56:59], a[28:31], v[84:87]
    v_cvt_pk_bf16_f32 v98, v72, v73
    v_mfma_f32_16x16x32_bf16 v[88:91], v[60:63], a[24:27], v[88:91]
    ds_read_b128 v[52:55], v14 offset:13312
    v_mfma_f32_16x16x32_bf16 v[92:95], v[60:63], a[28:31], v[92:95]
    v_cvt_pk_bf16_f32 v99, v74, v75
    s_waitcnt lgkmcnt(4)
    v_mfma_f32_16x16x32_bf16 v[80:83], v[32:35], a[32:35], v[80:83]
    ds_read_b128 v[56:59], v15 offset:12288
    v_mfma_f32_16x16x32_bf16 v[84:87], v[32:35], a[36:39], v[84:87]
    v_cvt_pk_bf16_f32 v100, v68, v69
    v_mfma_f32_16x16x32_bf16 v[88:91], v[36:39], a[32:35], v[88:91]
    ds_read_b128 v[60:63], v15 offset:13312
    s_add_u32 m0, s34, 23808
    v_mfma_f32_16x16x32_bf16 v[92:95], v[36:39], a[36:39], v[92:95]
    buffer_load_dwordx4 v8, s[12:15], s35 offen offset:768 lds
    v_cvt_pk_bf16_f32 v101, v70, v71
    s_waitcnt lgkmcnt(4)
    v_mfma_f32_16x16x32_bf16 v[80:83], v[40:43], a[40:43], v[80:83]
    ds_read_b128 v[32:35], v14 offset:16384
    v_mfma_f32_16x16x32_bf16 v[84:87], v[40:43], a[44:47], v[84:87]
    v_cvt_pk_bf16_f32 v102, v76, v77
    v_mfma_f32_16x16x32_bf16 v[88:91], v[44:47], a[40:43], v[88:91]
    ds_read_b128 v[36:39], v14 offset:17408
    v_mfma_f32_16x16x32_bf16 v[92:95], v[44:47], a[44:47], v[92:95]
    v_cvt_pk_bf16_f32 v103, v78, v79
    buffer_store_dwordx4 v[96:99], v9, s[4:7], s36 offen sc1
    s_waitcnt lgkmcnt(4)
    v_mfma_f32_16x16x32_bf16 v[80:83], v[48:51], a[48:51], v[80:83]
    ds_read_b128 v[40:43], v15 offset:16384
    v_mfma_f32_16x16x32_bf16 v[84:87], v[48:51], a[52:55], v[84:87]
    v_mfma_f32_16x16x32_bf16 v[88:91], v[52:55], a[48:51], v[88:91]
    ds_read_b128 v[44:47], v15 offset:17408
    s_add_u32 m0, s34, 27776
    v_mfma_f32_16x16x32_bf16 v[92:95], v[52:55], a[52:55], v[92:95]
    buffer_load_dwordx4 v8, s[12:15], s35 offen offset:896 lds
    s_waitcnt lgkmcnt(4)
    v_mfma_f32_16x16x32_bf16 v[80:83], v[56:59], a[56:59], v[80:83]
    ds_read_b128 v[48:51], v14 offset:20480
    v_mfma_f32_16x16x32_bf16 v[84:87], v[56:59], a[60:63], v[84:87]
    v_mfma_f32_16x16x32_bf16 v[88:91], v[60:63], a[56:59], v[88:91]
    ds_read_b128 v[52:55], v14 offset:21504
    v_mfma_f32_16x16x32_bf16 v[92:95], v[60:63], a[60:63], v[92:95]
    buffer_store_dwordx4 v[100:103], v9, s[4:7], s36 offen offset:128 sc1
    s_add_u32 s36, s36, s37
    s_waitcnt vmcnt(8)
    s_barrier
    s_waitcnt lgkmcnt(4)
    v_mfma_f32_16x16x32_bf16 v[80:83], v[32:35], a[64:67], v[80:83]
    ds_read_b128 v[56:59], v15 offset:20480
    v_mfma_f32_16x16x32_bf16 v[84:87], v[32:35], a[68:71], v[84:87]
    v_mfma_f32_16x16x32_bf16 v[88:91], v[36:39], a[64:67], v[88:91]
    ds_read_b128 v[60:63], v15 offset:21504
    s_add_u32 m0, s34, 31744
    v_mfma_f32_16x16x32_bf16 v[92:95], v[36:39], a[68:71], v[92:95]
    buffer_load_dwordx4 v8, s[12:15], s35 offen offset:1024 lds
    s_waitcnt lgkmcnt(4)
    v_mfma_f32_16x16x32_bf16 v[80:83], v[40:43], a[72:75], v[80:83]
    ds_read_b128 v[32:35], v14 offset:24576
    v_mfma_f32_16x16x32_bf16 v[84:87], v[40:43], a[76:79], v[84:87]
    v_mfma_f32_16x16x32_bf16 v[88:91], v[44:47], a[72:75], v[88:91]
    ds_read_b128 v[36:39], v14 offset:25600
    v_mfma_f32_16x16x32_bf16 v[92:95], v[44:47], a[76:79], v[92:95]
    s_waitcnt lgkmcnt(4)
    v_mfma_f32_16x16x32_bf16 v[80:83], v[48:51], a[80:83], v[80:83]
    ds_read_b128 v[40:43], v15 offset:24576
    v_mfma_f32_16x16x32_bf16 v[84:87], v[48:51], a[84:87], v[84:87]
    v_mfma_f32_16x16x32_bf16 v[88:91], v[52:55], a[80:83], v[88:91]
    ds_read_b128 v[44:47], v15 offset:25600
    s_add_u32 m0, s34, 35712
    v_mfma_f32_16x16x32_bf16 v[92:95], v[52:55], a[84:87], v[92:95]
    buffer_load_dwordx4 v8, s[12:15], s35 offen offset:1152 lds
    s_waitcnt lgkmcnt(4)
    v_mfma_f32_16x16x32_bf16 v[80:83], v[56:59], a[88:91], v[80:83]
    ds_read_b128 v[48:51], v14 offset:28672
    v_mfma_f32_16x16x32_bf16 v[84:87], v[56:59], a[92:95], v[84:87]
    v_mfma_f32_16x16x32_bf16 v[88:91], v[60:63], a[88:91], v[88:91]
    ds_read_b128 v[52:55], v14 offset:29696
    v_mfma_f32_16x16x32_bf16 v[92:95], v[60:63], a[92:95], v[92:95]
    s_waitcnt lgkmcnt(4)
    v_mfma_f32_16x16x32_bf16 v[80:83], v[32:35], a[96:99], v[80:83]
    ds_read_b128 v[56:59], v15 offset:28672
    v_mfma_f32_16x16x32_bf16 v[84:87], v[32:35], a[100:103], v[84:87]
    v_mfma_f32_16x16x32_bf16 v[88:91], v[36:39], a[96:99], v[88:91]
    ds_read_b128 v[60:63], v15 offset:29696
    s_add_u32 m0, s34, 39680
    v_mfma_f32_16x16x32_bf16 v[92:95], v[36:39], a[100:103], v[92:95]
    buffer_load_dwordx4 v8, s[12:15], s35 offen offset:1280 lds
    s_waitcnt lgkmcnt(4)
    v_mfma_f32_16x16x32_bf16 v[80:83], v[40:43], a[104:107], v[80:83]
    ds_read_b128 v[32:35], v14 offset:32768
    v_mfma_f32_16x16x32_bf16 v[84:87], v[40:43], a[108:111], v[84:87]
    v_mfma_f32_16x16x32_bf16 v[88:91], v[44:47], a[104:107], v[88:91]
    ds_read_b128 v[36:39], v14 offset:33792
    v_mfma_f32_16x16x32_bf16 v[92:95], v[44:47], a[108:111], v[92:95]
    s_waitcnt lgkmcnt(4)
    v_mfma_f32_16x16x32_bf16 v[80:83], v[48:51], a[112:115], v[80:83]
    ds_read_b128 v[40:43], v15 offset:32768
    v_mfma_f32_16x16x32_bf16 v[84:87], v[48:51], a[116:119], v[84:87]
    v_mfma_f32_16x16x32_bf16 v[88:91], v[52:55], a[112:115], v[88:91]
    ds_read_b128 v[44:47], v15 offset:33792
    s_add_u32 m0, s34, 43648
    v_mfma_f32_16x16x32_bf16 v[92:95], v[52:55], a[116:119], v[92:95]
    buffer_load_dwordx4 v8, s[12:15], s35 offen offset:1408 lds
    s_waitcnt lgkmcnt(4)
    v_mfma_f32_16x16x32_bf16 v[80:83], v[56:59], a[120:123], v[80:83]
    ds_read_b128 v[48:51], v14 offset:36864
    v_mfma_f32_16x16x32_bf16 v[84:87], v[56:59], a[124:127], v[84:87]
    v_mfma_f32_16x16x32_bf16 v[88:91], v[60:63], a[120:123], v[88:91]
    ds_read_b128 v[52:55], v14 offset:37888
    v_mfma_f32_16x16x32_bf16 v[92:95], v[60:63], a[124:127], v[92:95]
    s_waitcnt lgkmcnt(4)
    v_mfma_f32_16x16x32_bf16 v[80:83], v[32:35], a[128:131], v[80:83]
    ds_read_b128 v[56:59], v15 offset:36864
    v_mfma_f32_16x16x32_bf16 v[84:87], v[32:35], a[132:135], v[84:87]
    v_mfma_f32_16x16x32_bf16 v[88:91], v[36:39], a[128:131], v[88:91]
    ds_read_b128 v[60:63], v15 offset:37888
    s_add_u32 m0, s34, 47616
    v_mfma_f32_16x16x32_bf16 v[92:95], v[36:39], a[132:135], v[92:95]
    buffer_load_dwordx4 v8, s[12:15], s35 offen offset:1536 lds
    s_waitcnt lgkmcnt(4)
    v_mfma_f32_16x16x32_bf16 v[80:83], v[40:43], a[136:139], v[80:83]
    ds_read_b128 v[32:35], v14 offset:40960
    v_mfma_f32_16x16x32_bf16 v[84:87], v[40:43], a[140:143], v[84:87]
    v_mfma_f32_16x16x32_bf16 v[88:91], v[44:47], a[136:139], v[88:91]
    ds_read_b128 v[36:39], v14 offset:41984
    v_mfma_f32_16x16x32_bf16 v[92:95], v[44:47], a[140:143], v[92:95]
    s_waitcnt lgkmcnt(4)
    v_mfma_f32_16x16x32_bf16 v[80:83], v[48:51], a[144:147], v[80:83]
    ds_read_b128 v[40:43], v15 offset:40960
    v_mfma_f32_16x16x32_bf16 v[84:87], v[48:51], a[148:151], v[84:87]
    v_mfma_f32_16x16x32_bf16 v[88:91], v[52:55], a[144:147], v[88:91]
    ds_read_b128 v[44:47], v15 offset:41984
    s_add_u32 m0, s34, 51584
    v_mfma_f32_16x16x32_bf16 v[92:95], v[52:55], a[148:151], v[92:95]
    buffer_load_dwordx4 v8, s[12:15], s35 offen offset:1664 lds
    s_waitcnt lgkmcnt(4)
    v_mfma_f32_16x16x32_bf16 v[80:83], v[56:59], a[152:155], v[80:83]
    ds_read_b128 v[48:51], v14 offset:45056
    v_mfma_f32_16x16x32_bf16 v[84:87], v[56:59], a[156:159], v[84:87]
    v_mfma_f32_16x16x32_bf16 v[88:91], v[60:63], a[152:155], v[88:91]
    ds_read_b128 v[52:55], v14 offset:46080
    v_mfma_f32_16x16x32_bf16 v[92:95], v[60:63], a[156:159], v[92:95]
    s_waitcnt lgkmcnt(4)
    v_mfma_f32_16x16x32_bf16 v[80:83], v[32:35], a[160:163], v[80:83]
    ds_read_b128 v[56:59], v15 offset:45056
    v_mfma_f32_16x16x32_bf16 v[84:87], v[32:35], a[164:167], v[84:87]
    v_mfma_f32_16x16x32_bf16 v[88:91], v[36:39], a[160:163], v[88:91]
    ds_read_b128 v[60:63], v15 offset:46080
    s_add_u32 m0, s34, 55552
    v_mfma_f32_16x16x32_bf16 v[92:95], v[36:39], a[164:167], v[92:95]
    buffer_load_dwordx4 v8, s[12:15], s35 offen offset:1792 lds
    s_waitcnt lgkmcnt(4)
    v_mfma_f32_16x16x32_bf16 v[80:83], v[40:43], a[168:171], v[80:83]
    ds_read_b128 v[32:35], v14 offset:49152
    v_mfma_f32_16x16x32_bf16 v[84:87], v[40:43], a[172:175], v[84:87]
    v_mfma_f32_16x16x32_bf16 v[88:91], v[44:47], a[168:171], v[88:91]
    ds_read_b128 v[36:39], v14 offset:50176
    v_mfma_f32_16x16x32_bf16 v[92:95], v[44:47], a[172:175], v[92:95]
    s_waitcnt lgkmcnt(4)
    v_mfma_f32_16x16x32_bf16 v[80:83], v[48:51], a[176:179], v[80:83]
    ds_read_b128 v[40:43], v15 offset:49152
    v_mfma_f32_16x16x32_bf16 v[84:87], v[48:51], a[180:183], v[84:87]
    v_mfma_f32_16x16x32_bf16 v[88:91], v[52:55], a[176:179], v[88:91]
    ds_read_b128 v[44:47], v15 offset:50176
    s_add_u32 m0, s34, 59520
    v_mfma_f32_16x16x32_bf16 v[92:95], v[52:55], a[180:183], v[92:95]
    buffer_load_dwordx4 v8, s[12:15], s35 offen offset:1920 lds
    s_add_u32 s35, s35, 65536
    s_min_u32 s35, s35, s52
    s_waitcnt lgkmcnt(4)
    v_mfma_f32_16x16x32_bf16 v[80:83], v[56:59], a[184:187], v[80:83]
    ds_read_b128 v[48:51], v14 offset:53248
    v_mfma_f32_16x16x32_bf16 v[84:87], v[56:59], a[188:191], v[84:87]
    v_mfma_f32_16x16x32_bf16 v[88:91], v[60:63], a[184:187], v[88:91]
    ds_read_b128 v[52:55], v14 offset:54272
    v_mfma_f32_16x16x32_bf16 v[92:95], v[60:63], a[188:191], v[92:95]
    s_waitcnt vmcnt(8)
    s_barrier
    s_waitcnt lgkmcnt(4)
    v_mfma_f32_16x16x32_bf16 v[80:83], v[32:35], a[192:195], v[80:83]
    ds_read_b128 v[56:59], v15 offset:53248
    v_mfma_f32_16x16x32_bf16 v[84:87], v[32:35], a[196:199], v[84:87]
    v_mfma_f32_16x16x32_bf16 v[88:91], v[36:39], a[192:195], v[88:91]
    ds_read_b128 v[60:63], v15 offset:54272
    s_add_u32 m0, s34, 65536
    v_mfma_f32_16x16x32_bf16 v[92:95], v[36:39], a[196:199], v[92:95]
    buffer_load_dwordx4 v8, s[12:15], s35 offen offset:0 lds
    s_waitcnt lgkmcnt(4)
    v_mfma_f32_16x16x32_bf16 v[80:83], v[40:43], a[200:203], v[80:83]
    ds_read_b128 v[32:35], v14 offset:57344
    v_mfma_f32_16x16x32_bf16 v[84:87], v[40:43], a[204:207], v[84:87]
    buffer_store_dword v11, v10, s[4:7], 0 offen sc1
    v_add_u32 v11, 1, v11
    s_cmp_lg_u32 s30, s46
    s_cbranch_scc1 sl_ar_70
    s_mov_b64 exec, 1
    v_mov_b32 v4, 0
    v_mov_b32 v2, 1
    v_mov_b32 v3, s71
    global_atomic_add_x2 v4, v[2:3], s[92:93] offset:0 sc1
    s_mov_b64 exec, -1
sl_ar_70:
    v_mfma_f32_16x16x32_bf16 v[88:91], v[44:47], a[200:203], v[88:91]
    ds_read_b128 v[36:39], v14 offset:58368
    v_mfma_f32_16x16x32_bf16 v[92:95], v[44:47], a[204:207], v[92:95]
    s_waitcnt lgkmcnt(4)
    v_mfma_f32_16x16x32_bf16 v[80:83], v[48:51], a[208:211], v[80:83]
    ds_read_b128 v[40:43], v15 offset:57344
    v_mfma_f32_16x16x32_bf16 v[84:87], v[48:51], a[212:215], v[84:87]
    v_mfma_f32_16x16x32_bf16 v[88:91], v[52:55], a[208:211], v[88:91]
    ds_read_b128 v[44:47], v15 offset:58368
    s_add_u32 m0, s34, 69504
    v_mfma_f32_16x16x32_bf16 v[92:95], v[52:55], a[212:215], v[92:95]
    buffer_load_dwordx4 v8, s[12:15], s35 offen offset:128 lds
    s_waitcnt lgkmcnt(4)
    v_mfma_f32_16x16x32_bf16 v[80:83], v[56:59], a[216:219], v[80:83]
    ds_read_b128 v[48:51], v14 offset:61440
    v_mfma_f32_16x16x32_bf16 v[84:87], v[56:59], a[220:223], v[84:87]
    v_mfma_f32_16x16x32_bf16 v[88:91], v[60:63], a[216:219], v[88:91]
    ds_read_b128 v[52:55], v14 offset:62464
    v_mfma_f32_16x16x32_bf16 v[92:95], v[60:63], a[220:223], v[92:95]
    s_waitcnt lgkmcnt(4)
    v_mfma_f32_16x16x32_bf16 v[80:83], v[32:35], a[224:227], v[80:83]
    ds_read_b128 v[56:59], v15 offset:61440
    v_mfma_f32_16x16x32_bf16 v[84:87], v[32:35], a[228:231], v[84:87]
    v_mfma_f32_16x16x32_bf16 v[88:91], v[36:39], a[224:227], v[88:91]
    ds_read_b128 v[60:63], v15 offset:62464
    s_add_u32 m0, s34, 73472
    v_mfma_f32_16x16x32_bf16 v[92:95], v[36:39], a[228:231], v[92:95]
    buffer_load_dwordx4 v8, s[12:15], s35 offen offset:256 lds
    s_waitcnt lgkmcnt(4)
    v_mfma_f32_16x16x32_bf16 v[80:83], v[40:43], a[232:235], v[80:83]
    ds_read_b128 v[32:35], v12 offset:0
    v_mfma_f32_16x16x32_bf16 v[84:87], v[40:43], a[236:239], v[84:87]
    v_mfma_f32_16x16x32_bf16 v[88:91], v[44:47], a[232:235], v[88:91]
    ds_read_b128 v[36:39], v12 offset:1024
    v_mfma_f32_16x16x32_bf16 v[92:95], v[44:47], a[236:239], v[92:95]
    s_waitcnt lgkmcnt(4)
    v_mfma_f32_16x16x32_bf16 v[80:83], v[48:51], a[240:243], v[80:83]
    ds_read_b128 v[40:43], v13 offset:0
    v_mfma_f32_16x16x32_bf16 v[84:87], v[48:51], a[244:247], v[84:87]
    v_mfma_f32_16x16x32_bf16 v[88:91], v[52:55], a[240:243], v[88:91]
    ds_read_b128 v[44:47], v13 offset:1024
    s_add_u32 m0, s34, 77440
    v_mfma_f32_16x16x32_bf16 v[92:95], v[52:55], a[244:247], v[92:95]
    buffer_load_dwordx4 v8, s[12:15], s35 offen offset:384 lds
    s_waitcnt lgkmcnt(4)
    v_mfma_f32_16x16x32_bf16 v[80:83], v[56:59], a[248:251], v[80:83]
    ds_read_b128 v[48:51], v12 offset:4096
    v_mfma_f32_16x16x32_bf16 v[84:87], v[56:59], a[252:255], v[84:87]
    v_mfma_f32_16x16x32_bf16 v[88:91], v[60:63], a[248:251], v[88:91]
    ds_read_b128 v[52:55], v12 offset:5120
    v_mfma_f32_16x16x32_bf16 v[92:95], v[60:63], a[252:255], v[92:95]
    s_add_u32 s30, s30, 2
    s_cmp_lt_u32 s30, s51
    s_cbranch_scc1 sl_loop_69
    v_cvt_pk_bf16_f32 v96, v80, v81
    v_cvt_pk_bf16_f32 v97, v82, v83
    s_nop 0
    v_cvt_pk_bf16_f32 v98, v88, v89
    v_cvt_pk_bf16_f32 v99, v90, v91
    v_cvt_pk_bf16_f32 v100, v84, v85
    v_cvt_pk_bf16_f32 v101, v86, v87
    v_cvt_pk_bf16_f32 v102, v92, v93
    v_cvt_pk_bf16_f32 v103, v94, v95
    s_branch sl_e_66
sl_e_66:
    buffer_store_dwordx4 v[96:99], v9, s[4:7], s36 offen sc1
    buffer_store_dwordx4 v[100:103], v9, s[4:7], s36 offen offset:128 sc1
    s_add_u32 s36, s36, s37
    s_waitcnt vmcnt(0) lgkmcnt(0)
    s_barrier
    buffer_store_dword v11, v10, s[4:7], 0 offen sc1
    s_branch L_ph2
L_ph2:
    s_cmp_ge_u32 s28, 96
    s_cbranch_scc1 L_ob
L_att:
    s_mov_b32 s42, 0x3e0293ee
    s_mov_b32 s58, 0x3e8293ee
    s_and_b32 s44, s28, 7
    s_lshl_b32 s44, s44, 2
    s_add_u32 s44, s44, s29
    s_lshl_b32 s31, s44, 11
    v_add_u32 v6, s31, v5
    v_lshrrev_b32 v9, 5, v1
    v_lshlrev_b32 v9, 7, v9
    v_and_b32 v4, 7, v1
    v_lshl_add_u32 v9, v4, 4, v9
    v_add_u32 v9, s31, v9
    s_add_u32 s31, s31, 4194304
    v_and_b32 v10, 31, v1
    v_lshlrev_b32 v10, 4, v10
    v_lshrrev_b32 v4, 5, v1
    v_lshl_add_u32 v10, v4, 3, v10
    v_add_u32 v10, s31, v10
    s_lshl_b32 s31, s44, 13
    v_add_u32 v8, s31, v5
    v_mov_b32 v7, v8
    s_lshl_b32 s55, s44, 7
    s_add_u32 s55, s55, 115343360
    s_lshr_b32 s56, s44, 2
    s_lshl_b32 s56, s56, 7
    s_add_u32 s56, s56, 115347456
    s_lshl_b32 s57, s44, 7
    s_add_u32 s57, s57, 115351552
    s_lshl_b32 s31, s44, 7
    s_add_u32 s31, s31, 115343360
    v_mov_b32 v12, s31
    v_lshl_add_u32 v13, v1, 12, s31
    s_mov_b64 vcc, 1
    v_mov_b32 v4, 2130706432
    v_cndmask_b32 v12, v4, v12, vcc
    s_cmp_lt_u32 s28, 120
    s_cbranch_scc1 at_help_71
    s_mov_b32 s53, 0
    s_mov_b32 s54, 0
    s_mov_b32 s37, 1
    s_mov_b32 s38, 6
    s_mov_b32 s39, 32
    v_mov_b32 v2, 0
    s_mov_b32 s31, 16384
    buffer_store_dword v2, v12, s[4:7], s31 offen sc1
    s_mov_b32 s31, 32768
    buffer_store_dword v2, v13, s[4:7], s31 offen sc1
    s_mov_b64 exec, -1
    s_cmp_lt_u32 s28, 96
    s_cbranch_scc1 tw_skip_74
    s_load_dwordx2 s[72:73], s[0:1], 40
    s_and_b32 s31, s28, 31
    s_lshl_b32 s31, s31, 13
    s_lshl_b32 s33, s29, 21
    s_add_u32 s31, s31, s33
    v_lshl_add_u32 v2, v1, 7, s31
    s_waitcnt lgkmcnt(0)
    s_mov_b32 s8, s72
    s_and_b32 s9, s73, 0xffff
    s_mov_b32 s10, 8388608
    s_mov_b32 s11, 0x00020000
    s_mov_b32 s31, 0
    buffer_load_dword v128, v2, s[8:11], s31 offen
    s_mov_b32 s31, 262144
    buffer_load_dword v129, v2, s[8:11], s31 offen
    s_mov_b32 s31, 524288
    buffer_load_dword v130, v2, s[8:11], s31 offen
    s_mov_b32 s31, 786432
    buffer_load_dword v131, v2, s[8:11], s31 offen
    s_mov_b32 s31, 1048576
    buffer_load_dword v132, v2, s[8:11], s31 offen
    s_mov_b32 s31, 1310720
    buffer_load_dword v133, v2, s[8:11], s31 offen
    s_mov_b32 s31, 1572864
    buffer_load_dword v134, v2, s[8:11], s31 offen
    s_mov_b32 s31, 1835008
    buffer_load_dword v135, v2, s[8:11], s31 offen
tw_skip_74:
    s_and_b32 s59, s28, 31
    s_lshl_b32 s59, s59, 2
    s_add_u32 s59, s59, s29
    s_sub_u32 s31, 0, s90
    s_and_b32 s31, s31, 2097151
    s_and_b32 s60, s59, 7
    s_lshl_b32 s60, s60, 21
    s_lshr_b32 s33, s59, 3
    s_and_b32 s33, s33, 1
    s_lshl_b32 s33, s33, 13
    s_add_u32 s60, s60, s33
    s_lshr_b32 s33, s59, 4
    s_and_b32 s33, s33, 7
    s_lshl_b32 s33, s33, 8
    s_add_u32 s60, s60, s33
    s_add_u32 s60, s60, s31
    s_add_u32 s60, s60, 117686272
    s_lshr_b32 s32, s59, 3
    s_and_b32 s32, s32, 1
    s_lshl_b32 s32, s32, 14
    s_sub_u32 s61, s60, s32
    s_add_u32 s61, s61, 8192
    s_load_dword s68, s[90:91], s60 glc
    s_mov_b32 s62, -1
    s_load_dword s69, s[90:91], s61 glc
    s_mov_b32 s63, -1
    s_waitcnt lgkmcnt(0)
    s_memtime s[64:65]
    s_waitcnt lgkmcnt(0)
    s_load_dword s68, s[90:91], s60 glc
    s_waitcnt lgkmcnt(0)
    s_memtime s[66:67]
    s_waitcnt lgkmcnt(0)
    s_sub_u32 s31, s66, s64
    s_min_u32 s62, s62, s31
    s_waitcnt lgkmcnt(0)
    s_memtime s[64:65]
    s_waitcnt lgkmcnt(0)
    s_load_dword s68, s[90:91], s61 glc
    s_waitcnt lgkmcnt(0)
    s_memtime s[66:67]
    s_waitcnt lgkmcnt(0)
    s_sub_u32 s31, s66, s64
    s_min_u32 s63, s63, s31
    s_waitcnt lgkmcnt(0)
    s_memtime s[64:65]
    s_waitcnt lgkmcnt(0)
    s_load_dword s68, s[90:91], s60 glc
    s_waitcnt lgkmcnt(0)
    s_memtime s[66:67]
    s_waitcnt lgkmcnt(0)
    s_sub_u32 s31, s66, s64
    s_min_u32 s62, s62, s31
    s_waitcnt lgkmcnt(0)
    s_memtime s[64:65]
    s_waitcnt lgkmcnt(0)
    s_load_dword s68, s[90:91], s61 glc
    s_waitcnt lgkmcnt(0)
    s_memtime s[66:67]
    s_waitcnt lgkmcnt(0)
    s_sub_u32 s31, s66, s64
    s_min_u32 s63, s63, s31
    s_cmp_gt_u32 s63, s62
    s_cselect_b32 s31, 1, 0
    s_lshr_b32 s32, s59, 3
    s_xor_b32 s31, s31, s32
    s_xor_b32 s31, s31, s59
    s_and_b32 s31, s31, 1
    s_add_u32 s71, s71, s31
    s_waitcnt vmcnt(8)
    s_mov_b64 exec, 1
    v_mov_b32 v4, 0
    v_mov_b32 v2, 1
    v_mov_b32 v3, s71
    global_atomic_add_x2 v4, v[2:3], s[92:93] offset:0 sc1
    s_mov_b64 exec, -1
at_i_73:
    s_load_dwordx2 s[72:73], s[0:1], 0
    s_load_dwordx2 s[74:75], s[0:1], 56
    s_load_dwordx2 s[76:77], s[0:1], 72
    s_waitcnt lgkmcnt(0)
    s_mov_b32 s8, s72
    s_and_b32 s9, s73, 0xffff
    s_mov_b32 s10, 4194304
    s_mov_b32 s11, 0x00020000
    s_mov_b32 s12, s74
    s_and_b32 s13, s75, 0xffff
    s_mov_b32 s14, 4194304
    s_mov_b32 s15, 0x00020000
    s_mov_b32 s16, s76
    s_and_b32 s17, s77, 0xffff
    s_mov_b32 s18, 2097152
    s_mov_b32 s19, 0x00020000
    s_lshl_b32 s31, s44, 13
    v_lshl_add_u32 v11, v1, 7, s31
    buffer_load_dword v144, v11, s[8:11], 0 offen
    s_cmp_lt_u32 s28, 96
    s_cselect_b32 s33, 96, 96
    s_cmp_lg_u32 s29, 0
    s_cbranch_scc1 g_wdd_76
g_wd_75:
    s_load_dword s84, s[92:93], 128 glc
    s_add_u32 s41, s41, 1
    s_cmp_ge_u32 s41, 0x200000
    s_cbranch_scc1 g_wdd_76
    s_waitcnt lgkmcnt(0)
    s_cmp_ge_u32 s84, s33
    s_cbranch_scc1 g_wdd_76
    s_sleep 32
    s_branch g_wd_75
g_wdd_76:
    s_waitcnt lgkmcnt(0)
    s_barrier
    s_mov_b32 s31, 0
    buffer_load_dword v144, v11, s[8:11], s31 offen
    buffer_load_dword v145, v11, s[12:15], s31 offen
    s_waitcnt vmcnt(0)
    s_mov_b32 s31, 262144
    buffer_load_dword v146, v11, s[8:11], s31 offen
    buffer_load_dword v147, v11, s[12:15], s31 offen
    s_waitcnt vmcnt(0)
    s_mov_b32 s31, 524288
    buffer_load_dword v148, v11, s[8:11], s31 offen
    buffer_load_dword v149, v11, s[12:15], s31 offen
    s_waitcnt vmcnt(0)
    s_mov_b32 s31, 786432
    buffer_load_dword v150, v11, s[8:11], s31 offen
    buffer_load_dword v151, v11, s[12:15], s31 offen
    s_waitcnt vmcnt(0)
    s_mov_b32 s31, 1048576
    buffer_load_dword v152, v11, s[8:11], s31 offen
    buffer_load_dword v153, v11, s[12:15], s31 offen
    s_waitcnt vmcnt(0)
    s_mov_b32 s31, 1310720
    buffer_load_dword v154, v11, s[8:11], s31 offen
    buffer_load_dword v155, v11, s[12:15], s31 offen
    s_waitcnt vmcnt(0)
    s_mov_b32 s31, 1572864
    buffer_load_dword v156, v11, s[8:11], s31 offen
    buffer_load_dword v157, v11, s[12:15], s31 offen
    s_waitcnt vmcnt(0)
    s_mov_b32 s31, 1835008
    buffer_load_dword v158, v11, s[8:11], s31 offen
    buffer_load_dword v159, v11, s[12:15], s31 offen
    s_waitcnt vmcnt(0)
    s_mov_b32 s31, 2097152
    buffer_load_dword v160, v11, s[8:11], s31 offen
    buffer_load_dword v161, v11, s[12:15], s31 offen
    s_waitcnt vmcnt(0)
    s_mov_b32 s31, 2359296
    buffer_load_dword v162, v11, s[8:11], s31 offen
    buffer_load_dword v163, v11, s[12:15], s31 offen
    s_waitcnt vmcnt(0)
    s_mov_b32 s31, 2621440
    buffer_load_dword v164, v11, s[8:11], s31 offen
    buffer_load_dword v165, v11, s[12:15], s31 offen
    s_waitcnt vmcnt(0)
    s_mov_b32 s31, 2883584
    buffer_load_dword v166, v11, s[8:11], s31 offen
    buffer_load_dword v167, v11, s[12:15], s31 offen
    s_waitcnt vmcnt(0)
    s_mov_b32 s31, 3145728
    buffer_load_dword v168, v11, s[8:11], s31 offen
    buffer_load_dword v169, v11, s[12:15], s31 offen
    s_waitcnt vmcnt(0)
    s_mov_b32 s31, 3407872
    buffer_load_dword v170, v11, s[8:11], s31 offen
    buffer_load_dword v171, v11, s[12:15], s31 offen
    s_waitcnt vmcnt(0)
    s_mov_b32 s31, 3670016
    buffer_load_dword v172, v11, s[8:11], s31 offen
    buffer_load_dword v173, v11, s[12:15], s31 offen
    s_waitcnt vmcnt(0)
    s_mov_b32 s31, 3932160
    buffer_load_dword v174, v11, s[8:11], s31 offen
    buffer_load_dword v175, v11, s[12:15], s31 offen
    s_waitcnt vmcnt(0)
    s_waitcnt vmcnt(0)
    s_mov_b32 s31, 0
    buffer_load_dword v176, v11, s[16:19], s31 offen
    s_mov_b32 s31, 262144
    buffer_load_dword v177, v11, s[16:19], s31 offen
    s_waitcnt vmcnt(0)
    s_mov_b32 s31, 524288
    buffer_load_dword v178, v11, s[16:19], s31 offen
    s_mov_b32 s31, 786432
    buffer_load_dword v179, v11, s[16:19], s31 offen
    s_waitcnt vmcnt(0)
    s_mov_b32 s31, 1048576
    buffer_load_dword v180, v11, s[16:19], s31 offen
    s_mov_b32 s31, 1310720
    buffer_load_dword v181, v11, s[16:19], s31 offen
    s_waitcnt vmcnt(0)
    s_mov_b32 s31, 1572864
    buffer_load_dword v182, v11, s[16:19], s31 offen
    s_mov_b32 s31, 1835008
    buffer_load_dword v183, v11, s[16:19], s31 offen
    s_branch at_com_72
at_help_71:
    s_lshr_b32 s53, s28, 3
    s_add_u32 s53, s53, 6
    s_mov_b32 s54, 64
    s_mov_b32 s37, 12
    s_mov_b32 s38, 30
    s_lshr_b32 s39, s28, 3
    s_and_b32 s39, s39, 1
    s_add_u32 s39, s39, 30
    s_cmp_lt_u32 s28, 80
    s_cselect_b32 s39, 64, s39
at_com_72:
    v_and_b32 v11, 31, v1
    v_lshrrev_b32 v3, 5, v1
    v_lshlrev_b32 v3, 2, v3
    v_sub_u32 v11, v11, v3
    v_mov_b32 v14, 0xf149f2ca
    v_add_u32 v3, 0, v11
    v_and_b32 v3, 0xfffffff1, v3
    v_cmp_ne_u32 vcc, 0, v3
    s_nop 1
    v_cndmask_b32 v64, 0, v14, vcc
    v_add_u32 v3, -1, v11
    v_and_b32 v3, 0xfffffff1, v3
    v_cmp_ne_u32 vcc, 0, v3
    s_nop 1
    v_cndmask_b32 v65, 0, v14, vcc
    v_add_u32 v3, -2, v11
    v_and_b32 v3, 0xfffffff1, v3
    v_cmp_ne_u32 vcc, 0, v3
    s_nop 1
    v_cndmask_b32 v66, 0, v14, vcc
    v_add_u32 v3, -3, v11
    v_and_b32 v3, 0xfffffff1, v3
    v_cmp_ne_u32 vcc, 0, v3
    s_nop 1
    v_cndmask_b32 v67, 0, v14, vcc
    v_add_u32 v3, -8, v11
    v_and_b32 v3, 0xfffffff1, v3
    v_cmp_ne_u32 vcc, 0, v3
    s_nop 1
    v_cndmask_b32 v68, 0, v14, vcc
    v_add_u32 v3, -9, v11
    v_and_b32 v3, 0xfffffff1, v3
    v_cmp_ne_u32 vcc, 0, v3
    s_nop 1
    v_cndmask_b32 v69, 0, v14, vcc
    v_add_u32 v3, -10, v11
    v_and_b32 v3, 0xfffffff1, v3
    v_cmp_ne_u32 vcc, 0, v3
    s_nop 1
    v_cndmask_b32 v70, 0, v14, vcc
    v_add_u32 v3, -11, v11
    v_and_b32 v3, 0xfffffff1, v3
    v_cmp_ne_u32 vcc, 0, v3
    s_nop 1
    v_cndmask_b32 v71, 0, v14, vcc
    v_add_u32 v3, -16, v11
    v_and_b32 v3, 0xfffffff1, v3
    v_cmp_ne_u32 vcc, 0, v3
    s_nop 1
    v_cndmask_b32 v72, 0, v14, vcc
    v_add_u32 v3, -17, v11
    v_and_b32 v3, 0xfffffff1, v3
    v_cmp_ne_u32 vcc, 0, v3
    s_nop 1
    v_cndmask_b32 v73, 0, v14, vcc
    v_add_u32 v3, -18, v11
    v_and_b32 v3, 0xfffffff1, v3
    v_cmp_ne_u32 vcc, 0, v3
    s_nop 1
    v_cndmask_b32 v74, 0, v14, vcc
    v_add_u32 v3, -19, v11
    v_and_b32 v3, 0xfffffff1, v3
    v_cmp_ne_u32 vcc, 0, v3
    s_nop 1
    v_cndmask_b32 v75, 0, v14, vcc
    v_add_u32 v3, -24, v11
    v_and_b32 v3, 0xfffffff1, v3
    v_cmp_ne_u32 vcc, 0, v3
    s_nop 1
    v_cndmask_b32 v76, 0, v14, vcc
    v_add_u32 v3, -25, v11
    v_and_b32 v3, 0xfffffff1, v3
    v_cmp_ne_u32 vcc, 0, v3
    s_nop 1
    v_cndmask_b32 v77, 0, v14, vcc
    v_add_u32 v3, -26, v11
    v_and_b32 v3, 0xfffffff1, v3
    v_cmp_ne_u32 vcc, 0, v3
    s_nop 1
    v_cndmask_b32 v78, 0, v14, vcc
    v_add_u32 v3, -27, v11
    v_and_b32 v3, 0xfffffff1, v3
    v_cmp_ne_u32 vcc, 0, v3
    s_nop 1
    v_cndmask_b32 v79, 0, v14, vcc
    v_cmp_gt_i32 vcc, 0, v11
    s_nop 1
    v_cndmask_b32 v96, 0, v14, vcc
    v_cmp_gt_i32 vcc, 1, v11
    s_nop 1
    v_cndmask_b32 v97, 0, v14, vcc
    v_cmp_gt_i32 vcc, 2, v11
    s_nop 1
    v_cndmask_b32 v98, 0, v14, vcc
    v_cmp_gt_i32 vcc, 3, v11
    s_nop 1
    v_cndmask_b32 v99, 0, v14, vcc
    v_cmp_gt_i32 vcc, 8, v11
    s_nop 1
    v_cndmask_b32 v100, 0, v14, vcc
    v_cmp_gt_i32 vcc, 9, v11
    s_nop 1
    v_cndmask_b32 v101, 0, v14, vcc
    v_cmp_gt_i32 vcc, 10, v11
    s_nop 1
    v_cndmask_b32 v102, 0, v14, vcc
    v_cmp_gt_i32 vcc, 11, v11
    s_nop 1
    v_cndmask_b32 v103, 0, v14, vcc
    v_cmp_gt_i32 vcc, 16, v11
    s_nop 1
    v_cndmask_b32 v104, 0, v14, vcc
    v_cmp_gt_i32 vcc, 17, v11
    s_nop 1
    v_cndmask_b32 v105, 0, v14, vcc
    v_cmp_gt_i32 vcc, 18, v11
    s_nop 1
    v_cndmask_b32 v106, 0, v14, vcc
    v_cmp_gt_i32 vcc, 19, v11
    s_nop 1
    v_cndmask_b32 v107, 0, v14, vcc
    v_cmp_gt_i32 vcc, 24, v11
    s_nop 1
    v_cndmask_b32 v108, 0, v14, vcc
    v_cmp_gt_i32 vcc, 25, v11
    s_nop 1
    v_cndmask_b32 v109, 0, v14, vcc
    v_cmp_gt_i32 vcc, 26, v11
    s_nop 1
    v_cndmask_b32 v110, 0, v14, vcc
    v_cmp_gt_i32 vcc, 27, v11
    s_nop 1
    v_cndmask_b32 v111, 0, v14, vcc
    v_mov_b32 v80, 0xf149f2ca
    v_mov_b32 v81, 0xf149f2ca
    v_mov_b32 v82, 0xf149f2ca
    v_mov_b32 v83, 0xf149f2ca
    v_mov_b32 v84, 0xf149f2ca
    v_mov_b32 v85, 0xf149f2ca
    v_mov_b32 v86, 0xf149f2ca
    v_mov_b32 v87, 0xf149f2ca
    v_mov_b32 v88, 0xf149f2ca
    v_mov_b32 v89, 0xf149f2ca
    v_mov_b32 v90, 0xf149f2ca
    v_mov_b32 v91, 0xf149f2ca
    v_mov_b32 v92, 0xf149f2ca
    v_mov_b32 v93, 0xf149f2ca
    v_mov_b32 v94, 0xf149f2ca
    v_mov_b32 v95, 0xf149f2ca
    v_accvgpr_write_b32 a184, 0
    v_accvgpr_write_b32 a185, 0
    v_accvgpr_write_b32 a186, 0
    v_accvgpr_write_b32 a187, 0
    v_accvgpr_write_b32 a188, 0
    v_accvgpr_write_b32 a189, 0
    v_accvgpr_write_b32 a190, 0
    v_accvgpr_write_b32 a191, 0
    v_accvgpr_write_b32 a192, 0
    v_accvgpr_write_b32 a193, 0
    v_accvgpr_write_b32 a194, 0
    v_accvgpr_write_b32 a195, 0
    v_accvgpr_write_b32 a128, 0
    v_accvgpr_write_b32 a129, 0
    v_accvgpr_write_b32 a130, 0
    v_accvgpr_write_b32 a131, 0
    v_accvgpr_write_b32 a132, 0
    v_accvgpr_write_b32 a133, 0
    v_accvgpr_write_b32 a134, 0
    v_accvgpr_write_b32 a135, 0
    v_accvgpr_write_b32 a136, 0
    v_accvgpr_write_b32 a137, 0
    v_accvgpr_write_b32 a138, 0
    v_accvgpr_write_b32 a139, 0
    v_accvgpr_write_b32 a140, 0
    v_accvgpr_write_b32 a141, 0
    v_accvgpr_write_b32 a142, 0
    v_accvgpr_write_b32 a143, 0
    v_mov_b32 v40, 0
    v_mov_b32 v41, 0
    v_mov_b32 v42, 0
    v_mov_b32 v43, 0
    s_cmp_lg_u32 s29, 0
    s_cbranch_scc1 g_wdd_78
g_wd_77:
    s_load_dword s72, s[92:93], 0 glc
    s_add_u32 s41, s41, 1
    s_cmp_ge_u32 s41, 0x200000
    s_cbranch_scc1 g_wdd_78
    s_waitcnt lgkmcnt(0)
    s_cmp_ge_u32 s72, 352
    s_cbranch_scc1 g_wdd_78
    s_sleep 32
    s_branch g_wd_77
g_wdd_78:
    s_waitcnt lgkmcnt(0)
    s_barrier
    s_add_u32 s49, s53, s37
    s_cmp_lt_u32 s49, s38
    s_cbranch_scc1 at_nx_86
    s_max_u32 s49, s49, s39
    s_cmp_eq_u32 s38, 255
    s_cselect_b32 s49, s49, s39
    s_mov_b32 s37, 3
    s_mov_b32 s38, 255
at_nx_86:
g_wf_87:
    s_load_dwordx4 s[72:75], s[90:91], s56 glc
    s_add_u32 s41, s41, 1
    s_cmp_ge_u32 s41, 0x200000
    s_cbranch_scc1 g_wfd_88
    s_waitcnt lgkmcnt(0)
    s_min_u32 s76, s72, s73
    s_min_u32 s76, s76, s74
    s_cmp_ge_u32 s76, 1
    s_cbranch_scc1 g_wfd_88
    s_sleep 4
    s_branch g_wf_87
g_wfd_88:
    s_waitcnt lgkmcnt(0)
    s_mov_b32 s35, 0
    s_add_u32 s31, s35, 50331648
    buffer_load_dwordx4 a[160:163], v6, s[4:7], s31 offen offset:0 sc1
    buffer_load_dwordx4 a[164:167], v6, s[4:7], s31 offen offset:1024 sc1
    s_add_u32 s31, s35, 54525952
    buffer_load_dwordx4 a[168:171], v6, s[4:7], s31 offen offset:0 sc1
    buffer_load_dwordx4 a[172:175], v6, s[4:7], s31 offen offset:1024 sc1
    s_add_u32 s31, s35, 58720256
    buffer_load_dwordx4 a[176:179], v6, s[4:7], s31 offen offset:0 sc1
    buffer_load_dwordx4 a[180:183], v6, s[4:7], s31 offen offset:1024 sc1
    s_add_u32 s32, s53, 1
g_wf_89:
    s_load_dwordx4 s[72:75], s[90:91], s55 glc
    s_add_u32 s41, s41, 1
    s_cmp_ge_u32 s41, 0x200000
    s_cbranch_scc1 g_wfd_90
    s_waitcnt lgkmcnt(0)
    s_min_u32 s76, s72, s73
    s_min_u32 s76, s76, s74
    s_cmp_ge_u32 s76, s32
    s_cbranch_scc1 g_wfd_90
    s_sleep 4
    s_branch g_wf_89
g_wfd_90:
    s_waitcnt lgkmcnt(0)
    s_lshl_b32 s36, s53, 18
    s_add_u32 s31, s36, 0
    buffer_load_dwordx4 a[0:3], v7, s[4:7], s31 offen offset:0 sc1
    buffer_load_dwordx4 a[4:7], v7, s[4:7], s31 offen offset:1024 sc1
    buffer_load_dwordx4 a[8:11], v7, s[4:7], s31 offen offset:2048 sc1
    buffer_load_dwordx4 a[12:15], v7, s[4:7], s31 offen offset:3072 sc1
    s_add_u32 s31, s36, 4096
    buffer_load_dwordx4 a[16:19], v7, s[4:7], s31 offen offset:0 sc1
    buffer_load_dwordx4 a[20:23], v7, s[4:7], s31 offen offset:1024 sc1
    buffer_load_dwordx4 a[24:27], v7, s[4:7], s31 offen offset:2048 sc1
    buffer_load_dwordx4 a[28:31], v7, s[4:7], s31 offen offset:3072 sc1
    s_add_u32 s31, s36, 16777216
    buffer_load_dwordx4 a[32:35], v7, s[4:7], s31 offen offset:0 sc1
    buffer_load_dwordx4 a[36:39], v7, s[4:7], s31 offen offset:1024 sc1
    buffer_load_dwordx4 a[40:43], v7, s[4:7], s31 offen offset:2048 sc1
    buffer_load_dwordx4 a[44:47], v7, s[4:7], s31 offen offset:3072 sc1
    s_add_u32 s31, s36, 16781312
    buffer_load_dwordx4 a[48:51], v7, s[4:7], s31 offen offset:0 sc1
    buffer_load_dwordx4 a[52:55], v7, s[4:7], s31 offen offset:1024 sc1
    buffer_load_dwordx4 a[56:59], v7, s[4:7], s31 offen offset:2048 sc1
    buffer_load_dwordx4 a[60:63], v7, s[4:7], s31 offen offset:3072 sc1
    s_add_u32 s31, s36, 33554432
    buffer_load_dwordx4 a[96:99], v7, s[4:7], s31 offen offset:0 sc1
    buffer_load_dwordx4 a[100:103], v7, s[4:7], s31 offen offset:1024 sc1
    buffer_load_dwordx4 a[104:107], v7, s[4:7], s31 offen offset:2048 sc1
    buffer_load_dwordx4 a[108:111], v7, s[4:7], s31 offen offset:3072 sc1
    s_add_u32 s31, s36, 33558528
    buffer_load_dwordx4 a[112:115], v7, s[4:7], s31 offen offset:0 sc1
    buffer_load_dwordx4 a[116:119], v7, s[4:7], s31 offen offset:1024 sc1
    buffer_load_dwordx4 a[120:123], v7, s[4:7], s31 offen offset:2048 sc1
    buffer_load_dwordx4 a[124:127], v7, s[4:7], s31 offen offset:3072 sc1
    s_mov_b32 s43, 20480
    s_mov_b32 s45, 0
    s_mov_b32 s51, 0
    s_waitcnt vmcnt(0)
at_poll_84:
    s_load_dwordx16 s[8:23], s[90:91], s57 glc
    s_load_dwordx4 s[76:79], s[90:91], s55 glc
    s_load_dwordx4 s[80:83], s[90:91], s56 glc
at_top_79:
    s_waitcnt lgkmcnt(0)
    s_min_u32 s72, s8, s12
    s_min_u32 s72, s72, s16
    s_min_u32 s72, s72, s20
    s_min_u32 s76, s76, s77
    s_min_u32 s76, s76, s78
    s_min_u32 s80, s80, s81
    s_min_u32 s80, s80, s82
    s_min_u32 s77, s49, 63
    s_cmp_gt_u32 s76, s77
    s_cselect_b32 s72, s72, 0
    s_min_u32 s72, s72, 64
    s_sub_u32 s81, s80, 1
    s_cmp_ge_u32 s80, 64
    s_cselect_b32 s80, 64, s81
    s_cmp_lt_u32 s54, s80
    s_cbranch_scc1 at_b_81
    s_cmp_lt_u32 s53, s72
    s_cbranch_scc1 at_a_80
    s_cmp_eq_u32 s43, 20480
    s_cbranch_scc1 at_nf_85
    s_waitcnt vmcnt(0)
    v_mov_b32 v2, s45
    buffer_store_dword v2, v12, s[4:7], s43 offen sc1
    s_mov_b32 s43, 20480
at_nf_85:
    s_cmp_ge_u32 s53, 64
    s_cselect_b32 s31, s54, 0
    s_cmp_ge_u32 s31, 64
    s_cbranch_scc1 at_end_82
    s_add_u32 s41, s41, 1
    s_cmp_ge_u32 s41, 0x200000
    s_cbranch_scc1 at_end_82
    s_sleep 1
    s_branch at_poll_84
at_a_80:
    s_lshl_b32 s46, s53, 16
    s_add_u32 s46, s46, 88080384
    s_cmp_lg_u32 s51, 0
    s_cbranch_scc1 at_k1_91
    s_mov_b32 exec_lo, 0xff
    s_mov_b32 exec_hi, 0xff
    buffer_load_dwordx4 a[64:67], v9, s[4:7], s46 offen offset:0 sc1
    buffer_load_dwordx4 a[68:71], v9, s[4:7], s46 offen offset:256 sc1
    buffer_load_dwordx4 a[72:75], v9, s[4:7], s46 offen offset:512 sc1
    buffer_load_dwordx4 a[76:79], v9, s[4:7], s46 offen offset:768 sc1
    buffer_load_dwordx4 a[80:83], v9, s[4:7], s46 offen offset:1024 sc1
    buffer_load_dwordx4 a[84:87], v9, s[4:7], s46 offen offset:1280 sc1
    buffer_load_dwordx4 a[88:91], v9, s[4:7], s46 offen offset:1536 sc1
    buffer_load_dwordx4 a[92:95], v9, s[4:7], s46 offen offset:1792 sc1
    s_mov_b64 exec, -1
    buffer_load_dwordx2 a[128:129], v10, s[4:7], s46 offen offset:0 sc1
    buffer_load_dwordx2 a[132:133], v10, s[4:7], s46 offen offset:512 sc1
    buffer_load_dwordx2 a[136:137], v10, s[4:7], s46 offen offset:1024 sc1
    buffer_load_dwordx2 a[140:141], v10, s[4:7], s46 offen offset:1536 sc1
at_k1_91:
    s_lshl_b32 s47, s53, 18
    s_add_u32 s47, s47, 67108864
    s_cmp_lt_u32 s49, s72
    s_cselect_b32 s52, 1, 0
    s_cmp_lt_u32 s49, 64
    s_cselect_b32 s32, s49, s53
    s_cselect_b32 s31, 0, 2130706432
    v_or_b32 v7, s31, v8
    s_lshl_b32 s36, s32, 18
    s_lshl_b32 s46, s32, 16
    s_add_u32 s46, s46, 88080384
    s_load_dwordx16 s[8:23], s[90:91], s57 glc
    s_load_dwordx4 s[76:79], s[90:91], s55 glc
    s_load_dwordx4 s[80:83], s[90:91], s56 glc
    v_mfma_f32_32x32x16_bf16 v[112:127], a[32:35], a[0:3], v[96:111]
    v_mfma_f32_32x32x16_bf16 v[112:127], a[36:39], a[4:7], v[112:127]
    v_mfma_f32_32x32x16_bf16 v[112:127], a[40:43], a[8:11], v[112:127]
    v_mfma_f32_32x32x16_bf16 v[112:127], a[44:47], a[12:15], v[112:127]
    v_mfma_f32_32x32x16_bf16 v[112:127], a[48:51], a[16:19], v[112:127]
    v_mfma_f32_32x32x16_bf16 v[112:127], a[52:55], a[20:23], v[112:127]
    v_mfma_f32_32x32x16_bf16 v[112:127], a[56:59], a[24:27], v[112:127]
    v_mfma_f32_32x32x16_bf16 v[112:127], a[60:63], a[28:31], v[112:127]
    s_cmp_lg_u32 s51, 0
    s_cbranch_scc1 at_k2_92
    s_waitcnt vmcnt(4)
at_k2_92:
    s_add_u32 s31, s36, 16777216
    buffer_load_dwordx4 a[32:35], v7, s[4:7], s31 offen offset:0 sc1
    buffer_load_dwordx4 a[36:39], v7, s[4:7], s31 offen offset:1024 sc1
    buffer_load_dwordx4 a[40:43], v7, s[4:7], s31 offen offset:2048 sc1
    buffer_load_dwordx4 a[44:47], v7, s[4:7], s31 offen offset:3072 sc1
    s_add_u32 s31, s36, 16781312
    buffer_load_dwordx4 a[48:51], v7, s[4:7], s31 offen offset:0 sc1
    buffer_load_dwordx4 a[52:55], v7, s[4:7], s31 offen offset:1024 sc1
    buffer_load_dwordx4 a[56:59], v7, s[4:7], s31 offen offset:2048 sc1
    buffer_load_dwordx4 a[60:63], v7, s[4:7], s31 offen offset:3072 sc1
    v_mfma_f32_32x32x16_bf16 v[128:143], a[64:67], a[0:3], 0
    v_mfma_f32_32x32x16_bf16 v[128:143], a[68:71], a[4:7], v[128:143]
    v_mfma_f32_32x32x16_bf16 v[128:143], a[72:75], a[8:11], v[128:143]
    v_mfma_f32_32x32x16_bf16 v[128:143], a[76:79], a[12:15], v[128:143]
    v_mfma_f32_32x32x16_bf16 v[128:143], a[80:83], a[16:19], v[128:143]
    v_mfma_f32_32x32x16_bf16 v[128:143], a[84:87], a[20:23], v[128:143]
    v_mfma_f32_32x32x16_bf16 v[128:143], a[88:91], a[24:27], v[128:143]
    v_mfma_f32_32x32x16_bf16 v[128:143], a[92:95], a[28:31], v[128:143]
    s_mov_b32 s51, s52
    s_add_u32 s31, s36, 0
    buffer_load_dwordx4 a[0:3], v7, s[4:7], s31 offen offset:0 sc1
    buffer_load_dwordx4 a[4:7], v7, s[4:7], s31 offen offset:1024 sc1
    buffer_load_dwordx4 a[8:11], v7, s[4:7], s31 offen offset:2048 sc1
    buffer_load_dwordx4 a[12:15], v7, s[4:7], s31 offen offset:3072 sc1
    s_add_u32 s31, s36, 4096
    buffer_load_dwordx4 a[16:19], v7, s[4:7], s31 offen offset:0 sc1
    buffer_load_dwordx4 a[20:23], v7, s[4:7], s31 offen offset:1024 sc1
    buffer_load_dwordx4 a[24:27], v7, s[4:7], s31 offen offset:2048 sc1
    buffer_load_dwordx4 a[28:31], v7, s[4:7], s31 offen offset:3072 sc1
    s_cmp_eq_u32 s51, 0
    s_cbranch_scc1 at_k3_93
    s_mov_b32 exec_lo, 0xff
    s_mov_b32 exec_hi, 0xff
    buffer_load_dwordx4 a[64:67], v9, s[4:7], s46 offen offset:0 sc1
    buffer_load_dwordx4 a[68:71], v9, s[4:7], s46 offen offset:256 sc1
    buffer_load_dwordx4 a[72:75], v9, s[4:7], s46 offen offset:512 sc1
    buffer_load_dwordx4 a[76:79], v9, s[4:7], s46 offen offset:768 sc1
    buffer_load_dwordx4 a[80:83], v9, s[4:7], s46 offen offset:1024 sc1
    buffer_load_dwordx4 a[84:87], v9, s[4:7], s46 offen offset:1280 sc1
    buffer_load_dwordx4 a[88:91], v9, s[4:7], s46 offen offset:1536 sc1
    buffer_load_dwordx4 a[92:95], v9, s[4:7], s46 offen offset:1792 sc1
    s_mov_b64 exec, -1
at_k3_93:
    v_max3_f32 v14, v112, v113, v114
    v_max3_f32 v14, v14, v115, v116
    v_max3_f32 v14, v14, v117, v118
    v_max3_f32 v14, v14, v119, v120
    v_max3_f32 v14, v14, v121, v122
    v_max3_f32 v14, v14, v123, v124
    v_max3_f32 v14, v14, v125, v126
    v_max3_f32 v14, v14, v127, v128
    v_max3_f32 v14, v14, v129, v130
    v_max_f32 v14, v14, v131
    v_mov_b32 v15, v14
    s_nop 1
    v_permlane32_swap_b32 v14, v15
    v_max_f32 v14, v14, v15
    v_mul_f32 v14, s42, v14
    v_fma_f32 v112, v112, s42, -v14
    v_fma_f32 v113, v113, s42, -v14
    v_fma_f32 v114, v114, s42, -v14
    v_fma_f32 v115, v115, s42, -v14
    v_fma_f32 v116, v116, s42, -v14
    v_fma_f32 v117, v117, s42, -v14
    v_fma_f32 v118, v118, s42, -v14
    v_fma_f32 v119, v119, s42, -v14
    v_fma_f32 v120, v120, s42, -v14
    v_fma_f32 v121, v121, s42, -v14
    v_fma_f32 v122, v122, s42, -v14
    v_fma_f32 v123, v123, s42, -v14
    v_fma_f32 v124, v124, s42, -v14
    v_fma_f32 v125, v125, s42, -v14
    v_fma_f32 v126, v126, s42, -v14
    v_fma_f32 v127, v127, s42, -v14
    v_fma_f32 v128, v128, s42, -v14
    v_fma_f32 v129, v129, s42, -v14
    v_fma_f32 v130, v130, s42, -v14
    v_fma_f32 v131, v131, s42, -v14
    v_exp_f32 v112, v112
    v_exp_f32 v113, v113
    v_exp_f32 v114, v114
    v_exp_f32 v115, v115
    v_exp_f32 v116, v116
    v_exp_f32 v117, v117
    v_exp_f32 v118, v118
    v_exp_f32 v119, v119
    v_exp_f32 v120, v120
    v_exp_f32 v121, v121
    v_exp_f32 v122, v122
    v_exp_f32 v123, v123
    v_exp_f32 v124, v124
    v_exp_f32 v125, v125
    v_exp_f32 v126, v126
    v_exp_f32 v127, v127
    v_exp_f32 v128, v128
    v_exp_f32 v129, v129
    v_exp_f32 v130, v130
    v_exp_f32 v131, v131
    v_add_f32 v26, v112, v113
    v_add_f32 v15, v114, v115
    v_add_f32 v26, v26, v116
    v_add_f32 v15, v15, v117
    v_add_f32 v26, v26, v118
    v_add_f32 v15, v15, v119
    v_add_f32 v26, v26, v120
    v_add_f32 v15, v15, v121
    v_add_f32 v26, v26, v122
    v_add_f32 v15, v15, v123
    v_add_f32 v26, v26, v124
    v_add_f32 v15, v15, v125
    v_add_f32 v26, v26, v126
    v_add_f32 v15, v15, v127
    v_add_f32 v26, v26, v128
    v_add_f32 v15, v15, v129
    v_add_f32 v26, v26, v130
    v_add_f32 v15, v15, v131
    v_add_f32 v26, v26, v15
    v_mov_b32 v15, v26
    s_nop 1
    v_permlane32_swap_b32 v26, v15
    v_add_f32 v26, v26, v15
    v_rcp_f32 v26, v26
    v_cvt_pk_bf16_f32 v28, v112, v113
    v_cvt_pk_bf16_f32 v29, v114, v115
    v_cvt_pk_bf16_f32 v30, v116, v117
    v_cvt_pk_bf16_f32 v31, v118, v119
    v_cvt_pk_bf16_f32 v32, v120, v121
    v_cvt_pk_bf16_f32 v33, v122, v123
    v_cvt_pk_bf16_f32 v34, v124, v125
    v_cvt_pk_bf16_f32 v35, v126, v127
    v_cvt_pk_bf16_f32 v40, v128, v129
    v_cvt_pk_bf16_f32 v41, v130, v131
    s_waitcnt vmcnt(16)
    v_mov_b32 v2, s45
    buffer_store_dword v2, v12, s[4:7], s43 offen sc1
    v_mfma_f32_32x32x16_bf16 v[144:159], a[96:99], v[28:31], 0
    v_mfma_f32_32x32x16_bf16 v[144:159], a[100:103], v[32:35], v[144:159]
    v_mfma_f32_32x32x16_bf16 v[144:159], a[128:131], v[40:43], v[144:159]
    v_mfma_f32_32x32x16_bf16 v[160:175], a[104:107], v[28:31], 0
    v_mfma_f32_32x32x16_bf16 v[160:175], a[108:111], v[32:35], v[160:175]
    v_mfma_f32_32x32x16_bf16 v[160:175], a[132:135], v[40:43], v[160:175]
    v_mfma_f32_32x32x16_bf16 v[176:191], a[112:115], v[28:31], 0
    s_nop 7
    v_mul_f32 v144, v144, v26
    v_mul_f32 v145, v145, v26
    v_mul_f32 v146, v146, v26
    v_mul_f32 v147, v147, v26
    v_mul_f32 v148, v148, v26
    v_mul_f32 v149, v149, v26
    v_mfma_f32_32x32x16_bf16 v[176:191], a[116:119], v[32:35], v[176:191]
    v_mul_f32 v150, v150, v26
    v_mul_f32 v151, v151, v26
    v_mul_f32 v152, v152, v26
    v_mul_f32 v153, v153, v26
    v_mul_f32 v154, v154, v26
    v_mul_f32 v155, v155, v26
    v_mfma_f32_32x32x16_bf16 v[176:191], a[136:139], v[40:43], v[176:191]
    v_mul_f32 v156, v156, v26
    v_mul_f32 v157, v157, v26
    v_mul_f32 v158, v158, v26
    v_mul_f32 v159, v159, v26
    v_cvt_pk_bf16_f32 v208, v144, v145
    v_cvt_pk_bf16_f32 v209, v146, v147
    v_mfma_f32_32x32x16_bf16 v[192:207], a[120:123], v[28:31], 0
    v_cvt_pk_bf16_f32 v210, v148, v149
    v_cvt_pk_bf16_f32 v211, v150, v151
    v_cvt_pk_bf16_f32 v212, v152, v153
    v_cvt_pk_bf16_f32 v213, v154, v155
    v_cvt_pk_bf16_f32 v214, v156, v157
    v_cvt_pk_bf16_f32 v215, v158, v159
    v_mfma_f32_32x32x16_bf16 v[192:207], a[124:127], v[32:35], v[192:207]
    v_mul_f32 v160, v160, v26
    v_mul_f32 v161, v161, v26
    v_mul_f32 v162, v162, v26
    v_mul_f32 v163, v163, v26
    v_mul_f32 v164, v164, v26
    v_mul_f32 v165, v165, v26
    v_mfma_f32_32x32x16_bf16 v[192:207], a[140:143], v[40:43], v[192:207]
    v_mul_f32 v166, v166, v26
    v_mul_f32 v167, v167, v26
    v_mul_f32 v168, v168, v26
    v_mul_f32 v169, v169, v26
    v_mul_f32 v170, v170, v26
    v_mul_f32 v171, v171, v26
    s_add_u32 s31, s36, 33554432
    buffer_load_dwordx4 a[96:99], v7, s[4:7], s31 offen offset:0 sc1
    buffer_load_dwordx4 a[100:103], v7, s[4:7], s31 offen offset:1024 sc1
    buffer_load_dwordx4 a[104:107], v7, s[4:7], s31 offen offset:2048 sc1
    buffer_load_dwordx4 a[108:111], v7, s[4:7], s31 offen offset:3072 sc1
    s_add_u32 s31, s36, 33558528
    buffer_load_dwordx4 a[112:115], v7, s[4:7], s31 offen offset:0 sc1
    buffer_load_dwordx4 a[116:119], v7, s[4:7], s31 offen offset:1024 sc1
    buffer_load_dwordx4 a[120:123], v7, s[4:7], s31 offen offset:2048 sc1
    buffer_load_dwordx4 a[124:127], v7, s[4:7], s31 offen offset:3072 sc1
    s_cmp_eq_u32 s51, 0
    s_cbranch_scc1 at_k4_94
    buffer_load_dwordx2 a[128:129], v10, s[4:7], s46 offen offset:0 sc1
    buffer_load_dwordx2 a[132:133], v10, s[4:7], s46 offen offset:512 sc1
    buffer_load_dwordx2 a[136:137], v10, s[4:7], s46 offen offset:1024 sc1
    buffer_load_dwordx2 a[140:141], v10, s[4:7], s46 offen offset:1536 sc1
at_k4_94:
    v_mul_f32 v172, v172, v26
    v_mul_f32 v173, v173, v26
    v_mul_f32 v174, v174, v26
    v_mul_f32 v175, v175, v26
    v_cvt_pk_bf16_f32 v216, v160, v161
    v_cvt_pk_bf16_f32 v217, v162, v163
    v_cvt_pk_bf16_f32 v218, v164, v165
    v_cvt_pk_bf16_f32 v219, v166, v167
    v_cvt_pk_bf16_f32 v220, v168, v169
    v_cvt_pk_bf16_f32 v221, v170, v171
    v_cvt_pk_bf16_f32 v222, v172, v173
    v_cvt_pk_bf16_f32 v223, v174, v175
    v_mul_f32 v176, v176, v26
    v_mul_f32 v177, v177, v26
    v_mul_f32 v178, v178, v26
    v_mul_f32 v179, v179, v26
    v_mul_f32 v180, v180, v26
    v_mul_f32 v181, v181, v26
    v_mul_f32 v182, v182, v26
    v_mul_f32 v183, v183, v26
    v_mul_f32 v184, v184, v26
    v_mul_f32 v185, v185, v26
    v_mul_f32 v186, v186, v26
    v_mul_f32 v187, v187, v26
    v_mul_f32 v188, v188, v26
    v_mul_f32 v189, v189, v26
    v_mul_f32 v190, v190, v26
    v_mul_f32 v191, v191, v26
    v_cvt_pk_bf16_f32 v224, v176, v177
    v_cvt_pk_bf16_f32 v225, v178, v179
    v_cvt_pk_bf16_f32 v226, v180, v181
    v_cvt_pk_bf16_f32 v227, v182, v183
    v_cvt_pk_bf16_f32 v228, v184, v185
    v_cvt_pk_bf16_f32 v229, v186, v187
    v_cvt_pk_bf16_f32 v230, v188, v189
    v_cvt_pk_bf16_f32 v231, v190, v191
    v_mul_f32 v192, v192, v26
    v_mul_f32 v193, v193, v26
    v_mul_f32 v194, v194, v26
    v_mul_f32 v195, v195, v26
    v_mul_f32 v196, v196, v26
    v_mul_f32 v197, v197, v26
    v_mul_f32 v198, v198, v26
    v_mul_f32 v199, v199, v26
    v_mul_f32 v200, v200, v26
    v_mul_f32 v201, v201, v26
    v_mul_f32 v202, v202, v26
    v_mul_f32 v203, v203, v26
    v_mul_f32 v204, v204, v26
    v_mul_f32 v205, v205, v26
    v_mul_f32 v206, v206, v26
    v_mul_f32 v207, v207, v26
    v_cvt_pk_bf16_f32 v232, v192, v193
    v_cvt_pk_bf16_f32 v233, v194, v195
    v_cvt_pk_bf16_f32 v234, v196, v197
    v_cvt_pk_bf16_f32 v235, v198, v199
    v_cvt_pk_bf16_f32 v236, v200, v201
    v_cvt_pk_bf16_f32 v237, v202, v203
    v_cvt_pk_bf16_f32 v238, v204, v205
    v_cvt_pk_bf16_f32 v239, v206, v207
    s_add_u32 s31, s47, 0
    buffer_store_dwordx4 v[208:211], v8, s[4:7], s31 offen offset:0 sc1
    buffer_store_dwordx4 v[212:215], v8, s[4:7], s31 offen offset:1024 sc1
    buffer_store_dwordx4 v[216:219], v8, s[4:7], s31 offen offset:2048 sc1
    buffer_store_dwordx4 v[220:223], v8, s[4:7], s31 offen offset:3072 sc1
    s_add_u32 s31, s47, 4096
    buffer_store_dwordx4 v[224:227], v8, s[4:7], s31 offen offset:0 sc1
    buffer_store_dwordx4 v[228:231], v8, s[4:7], s31 offen offset:1024 sc1
    buffer_store_dwordx4 v[232:235], v8, s[4:7], s31 offen offset:2048 sc1
    buffer_store_dwordx4 v[236:239], v8, s[4:7], s31 offen offset:3072 sc1
    s_mov_b32 s45, 1
    s_lshl_b32 s43, s53, 12
    s_add_u32 s43, s43, 32768
    s_mov_b32 s53, s49
    s_add_u32 s49, s53, s37
    s_cmp_lt_u32 s49, s38
    s_cbranch_scc1 at_nx_95
    s_max_u32 s49, s49, s39
    s_cmp_eq_u32 s38, 255
    s_cselect_b32 s49, s49, s39
    s_mov_b32 s37, 3
    s_mov_b32 s38, 255
at_nx_95:
    s_waitcnt vmcnt(17)
    s_branch at_top_79
at_b_81:
    s_load_dwordx16 s[8:23], s[90:91], s57 glc
    s_load_dwordx4 s[76:79], s[90:91], s55 glc
    s_load_dwordx4 s[80:83], s[90:91], s56 glc
    s_lshl_b32 s48, s54, 16
    s_add_u32 s48, s48, 83886080
    s_add_u32 s32, s54, 1
    s_min_u32 s32, s32, 63
    s_lshl_b32 s35, s32, 16
    v_mfma_f32_32x32x16_bf16 v[128:143], a[184:187], a[160:163], v[80:95]
    v_mfma_f32_32x32x16_bf16 v[128:143], a[188:191], a[164:167], v[128:143]
    v_mfma_f32_32x32x16_bf16 v[112:127], a[168:171], a[160:163], v[64:79]
    v_mfma_f32_32x32x16_bf16 v[112:127], a[172:175], a[164:167], v[112:127]
    v_accvgpr_mov_b32 a184, a168
    v_accvgpr_mov_b32 a185, a169
    v_accvgpr_mov_b32 a186, a170
    v_accvgpr_mov_b32 a187, a171
    v_accvgpr_mov_b32 a188, a172
    v_accvgpr_mov_b32 a189, a173
    v_accvgpr_mov_b32 a190, a174
    v_accvgpr_mov_b32 a191, a175
    v_accvgpr_mov_b32 a196, a176
    v_accvgpr_mov_b32 a197, a177
    v_accvgpr_mov_b32 a198, a178
    v_accvgpr_mov_b32 a199, a179
    v_accvgpr_mov_b32 a200, a180
    v_accvgpr_mov_b32 a201, a181
    v_accvgpr_mov_b32 a202, a182
    v_accvgpr_mov_b32 a203, a183
    s_add_u32 s31, s35, 50331648
    buffer_load_dwordx4 a[160:163], v6, s[4:7], s31 offen offset:0 sc1
    buffer_load_dwordx4 a[164:167], v6, s[4:7], s31 offen offset:1024 sc1
    s_add_u32 s31, s35, 54525952
    buffer_load_dwordx4 a[168:171], v6, s[4:7], s31 offen offset:0 sc1
    buffer_load_dwordx4 a[172:175], v6, s[4:7], s31 offen offset:1024 sc1
    s_add_u32 s31, s35, 58720256
    buffer_load_dwordx4 a[176:179], v6, s[4:7], s31 offen offset:0 sc1
    buffer_load_dwordx4 a[180:183], v6, s[4:7], s31 offen offset:1024 sc1
    v_max3_f32 v14, v136, v137, v138
    v_max3_f32 v14, v14, v139, v140
    v_max3_f32 v14, v14, v141, v142
    v_max3_f32 v14, v14, v143, v112
    v_max3_f32 v14, v14, v113, v114
    v_max3_f32 v14, v14, v115, v116
    v_max3_f32 v14, v14, v117, v118
    v_max3_f32 v14, v14, v119, v120
    v_max3_f32 v14, v14, v121, v122
    v_max3_f32 v14, v14, v123, v124
    v_max3_f32 v14, v14, v125, v126
    v_max_f32 v14, v14, v127
    v_mov_b32 v15, v14
    s_nop 1
    v_permlane32_swap_b32 v14, v15
    v_max_f32 v14, v14, v15
    v_mul_f32 v14, s58, v14
    v_fma_f32 v136, v136, s58, -v14
    v_fma_f32 v137, v137, s58, -v14
    v_fma_f32 v138, v138, s58, -v14
    v_fma_f32 v139, v139, s58, -v14
    v_fma_f32 v140, v140, s58, -v14
    v_fma_f32 v141, v141, s58, -v14
    v_fma_f32 v142, v142, s58, -v14
    v_fma_f32 v143, v143, s58, -v14
    v_fma_f32 v112, v112, s58, -v14
    v_fma_f32 v113, v113, s58, -v14
    v_fma_f32 v114, v114, s58, -v14
    v_fma_f32 v115, v115, s58, -v14
    v_fma_f32 v116, v116, s58, -v14
    v_fma_f32 v117, v117, s58, -v14
    v_fma_f32 v118, v118, s58, -v14
    v_fma_f32 v119, v119, s58, -v14
    v_fma_f32 v120, v120, s58, -v14
    v_fma_f32 v121, v121, s58, -v14
    v_fma_f32 v122, v122, s58, -v14
    v_fma_f32 v123, v123, s58, -v14
    v_fma_f32 v124, v124, s58, -v14
    v_fma_f32 v125, v125, s58, -v14
    v_fma_f32 v126, v126, s58, -v14
    v_fma_f32 v127, v127, s58, -v14
    v_exp_f32 v136, v136
    v_exp_f32 v137, v137
    v_exp_f32 v138, v138
    v_exp_f32 v139, v139
    v_exp_f32 v140, v140
    v_exp_f32 v141, v141
    v_exp_f32 v142, v142
    v_exp_f32 v143, v143
    v_exp_f32 v112, v112
    v_exp_f32 v113, v113
    v_exp_f32 v114, v114
    v_exp_f32 v115, v115
    v_exp_f32 v116, v116
    v_exp_f32 v117, v117
    v_exp_f32 v118, v118
    v_exp_f32 v119, v119
    v_exp_f32 v120, v120
    v_exp_f32 v121, v121
    v_exp_f32 v122, v122
    v_exp_f32 v123, v123
    v_exp_f32 v124, v124
    v_exp_f32 v125, v125
    v_exp_f32 v126, v126
    v_exp_f32 v127, v127
    v_add_f32 v26, v136, v137
    v_add_f32 v15, v138, v139
    v_add_f32 v26, v26, v140
    v_add_f32 v15, v15, v141
    v_add_f32 v26, v26, v142
    v_add_f32 v15, v15, v143
    v_add_f32 v26, v26, v112
    v_add_f32 v15, v15, v113
    v_add_f32 v26, v26, v114
    v_add_f32 v15, v15, v115
    v_add_f32 v26, v26, v116
    v_add_f32 v15, v15, v117
    v_add_f32 v26, v26, v118
    v_add_f32 v15, v15, v119
    v_add_f32 v26, v26, v120
    v_add_f32 v15, v15, v121
    v_add_f32 v26, v26, v122
    v_add_f32 v15, v15, v123
    v_add_f32 v26, v26, v124
    v_add_f32 v15, v15, v125
    v_add_f32 v26, v26, v126
    v_add_f32 v15, v15, v127
    v_add_f32 v26, v26, v15
    v_mov_b32 v15, v26
    s_nop 1
    v_permlane32_swap_b32 v26, v15
    v_add_f32 v26, v26, v15
    v_rcp_f32 v26, v26
    v_cvt_pk_bf16_f32 v28, v112, v113
    v_cvt_pk_bf16_f32 v29, v114, v115
    v_cvt_pk_bf16_f32 v30, v116, v117
    v_cvt_pk_bf16_f32 v31, v118, v119
    v_cvt_pk_bf16_f32 v32, v120, v121
    v_cvt_pk_bf16_f32 v33, v122, v123
    v_cvt_pk_bf16_f32 v34, v124, v125
    v_cvt_pk_bf16_f32 v35, v126, v127
    v_cvt_pk_bf16_f32 v36, v136, v137
    v_cvt_pk_bf16_f32 v37, v138, v139
    v_cvt_pk_bf16_f32 v38, v140, v141
    v_cvt_pk_bf16_f32 v39, v142, v143
    v_mfma_f32_32x32x16_bf16 v[144:159], a[196:199], v[28:31], 0
    v_mfma_f32_32x32x16_bf16 v[144:159], a[200:203], v[32:35], v[144:159]
    v_mfma_f32_32x32x16_bf16 v[144:159], a[192:195], v[36:39], v[144:159]
    v_accvgpr_mov_b32 a192, a200
    v_accvgpr_mov_b32 a193, a201
    v_accvgpr_mov_b32 a194, a202
    v_accvgpr_mov_b32 a195, a203
    s_waitcnt vmcnt(6)
    v_mov_b32 v2, s45
    buffer_store_dword v2, v12, s[4:7], s43 offen sc1
    s_cmp_lg_u32 s54, 0
    s_cbranch_scc1 at_nb_83
    v_mov_b32 v14, 0xf149f2ca
    v_add_u32 v3, 32, v11
    v_and_b32 v3, 0xfffffff1, v3
    v_cmp_ne_u32 vcc, 0, v3
    s_nop 1
    v_cndmask_b32 v80, 0, v14, vcc
    v_add_u32 v3, 31, v11
    v_and_b32 v3, 0xfffffff1, v3
    v_cmp_ne_u32 vcc, 0, v3
    s_nop 1
    v_cndmask_b32 v81, 0, v14, vcc
    v_add_u32 v3, 30, v11
    v_and_b32 v3, 0xfffffff1, v3
    v_cmp_ne_u32 vcc, 0, v3
    s_nop 1
    v_cndmask_b32 v82, 0, v14, vcc
    v_add_u32 v3, 29, v11
    v_and_b32 v3, 0xfffffff1, v3
    v_cmp_ne_u32 vcc, 0, v3
    s_nop 1
    v_cndmask_b32 v83, 0, v14, vcc
    v_add_u32 v3, 24, v11
    v_and_b32 v3, 0xfffffff1, v3
    v_cmp_ne_u32 vcc, 0, v3
    s_nop 1
    v_cndmask_b32 v84, 0, v14, vcc
    v_add_u32 v3, 23, v11
    v_and_b32 v3, 0xfffffff1, v3
    v_cmp_ne_u32 vcc, 0, v3
    s_nop 1
    v_cndmask_b32 v85, 0, v14, vcc
    v_add_u32 v3, 22, v11
    v_and_b32 v3, 0xfffffff1, v3
    v_cmp_ne_u32 vcc, 0, v3
    s_nop 1
    v_cndmask_b32 v86, 0, v14, vcc
    v_add_u32 v3, 21, v11
    v_and_b32 v3, 0xfffffff1, v3
    v_cmp_ne_u32 vcc, 0, v3
    s_nop 1
    v_cndmask_b32 v87, 0, v14, vcc
    v_add_u32 v3, 16, v11
    v_and_b32 v3, 0xfffffff1, v3
    v_cmp_ne_u32 vcc, 0, v3
    s_nop 1
    v_cndmask_b32 v88, 0, v14, vcc
    v_add_u32 v3, 15, v11
    v_and_b32 v3, 0xfffffff1, v3
    v_cmp_ne_u32 vcc, 0, v3
    s_nop 1
    v_cndmask_b32 v89, 0, v14, vcc
    v_add_u32 v3, 14, v11
    v_and_b32 v3, 0xfffffff1, v3
    v_cmp_ne_u32 vcc, 0, v3
    s_nop 1
    v_cndmask_b32 v90, 0, v14, vcc
    v_add_u32 v3, 13, v11
    v_and_b32 v3, 0xfffffff1, v3
    v_cmp_ne_u32 vcc, 0, v3
    s_nop 1
    v_cndmask_b32 v91, 0, v14, vcc
    v_add_u32 v3, 8, v11
    v_and_b32 v3, 0xfffffff1, v3
    v_cmp_ne_u32 vcc, 0, v3
    s_nop 1
    v_cndmask_b32 v92, 0, v14, vcc
    v_add_u32 v3, 7, v11
    v_and_b32 v3, 0xfffffff1, v3
    v_cmp_ne_u32 vcc, 0, v3
    s_nop 1
    v_cndmask_b32 v93, 0, v14, vcc
    v_add_u32 v3, 6, v11
    v_and_b32 v3, 0xfffffff1, v3
    v_cmp_ne_u32 vcc, 0, v3
    s_nop 1
    v_cndmask_b32 v94, 0, v14, vcc
    v_add_u32 v3, 5, v11
    v_and_b32 v3, 0xfffffff1, v3
    v_cmp_ne_u32 vcc, 0, v3
    s_nop 1
    v_cndmask_b32 v95, 0, v14, vcc
at_nb_83:
    s_nop 2
    v_mul_f32 v144, v144, v26
    v_mul_f32 v145, v145, v26
    v_mul_f32 v146, v146, v26
    v_mul_f32 v147, v147, v26
    v_mul_f32 v148, v148, v26
    v_mul_f32 v149, v149, v26
    v_mul_f32 v150, v150, v26
    v_mul_f32 v151, v151, v26
    v_mul_f32 v152, v152, v26
    v_mul_f32 v153, v153, v26
    v_mul_f32 v154, v154, v26
    v_mul_f32 v155, v155, v26
    v_mul_f32 v156, v156, v26
    v_mul_f32 v157, v157, v26
    v_mul_f32 v158, v158, v26
    v_mul_f32 v159, v159, v26
    v_cvt_pk_bf16_f32 v208, v144, v145
    v_cvt_pk_bf16_f32 v209, v146, v147
    v_cvt_pk_bf16_f32 v210, v148, v149
    v_cvt_pk_bf16_f32 v211, v150, v151
    v_cvt_pk_bf16_f32 v212, v152, v153
    v_cvt_pk_bf16_f32 v213, v154, v155
    v_cvt_pk_bf16_f32 v214, v156, v157
    v_cvt_pk_bf16_f32 v215, v158, v159
    v_permlane32_swap_b32 v208, v210
    v_permlane32_swap_b32 v209, v211
    v_permlane32_swap_b32 v212, v214
    v_permlane32_swap_b32 v213, v215
    buffer_store_dwordx4 v[208:211], v6, s[4:7], s48 offen offset:0 sc1
    buffer_store_dwordx4 v[212:215], v6, s[4:7], s48 offen offset:1024 sc1
    s_add_u32 s54, s54, 1
    s_mov_b32 s43, 16384
    s_mov_b32 s45, s54
    s_waitcnt vmcnt(3)
    s_branch at_top_79
at_end_82:
    s_waitcnt vmcnt(0) lgkmcnt(0)
    s_branch L_o64
L_o64:
    s_cmp_ge_u32 s28, 80
    s_cbranch_scc1 L_dump
    s_load_dwordx2 s[72:73], s[0:1], 40
    s_load_dwordx2 s[74:75], s[0:1], 80
    s_mul_i32 s44, s28, 205
    s_lshr_b32 s44, s44, 10
    s_mul_i32 s31, s44, 5
    s_sub_u32 s30, s28, s31
    s_add_u32 s48, s30, 2
    s_sub_u32 s31, s48, 5
    s_min_u32 s48, s48, s31
    s_waitcnt lgkmcnt(0)
    s_mov_b32 s8, s72
    s_and_b32 s9, s73, 0xffff
    s_mov_b32 s10, 8388608
    s_mov_b32 s11, 0x00020000
    s_mov_b32 s20, s74
    s_and_b32 s21, s75, 0xffff
    s_mov_b32 s22, 8388608
    s_mov_b32 s23, 0x00020000
    s_lshl_b32 s31, s29, 21
    s_lshl_b32 s33, s44, 7
    s_add_u32 s31, s31, s33
    v_lshrrev_b32 v6, 3, v1
    v_lshlrev_b32 v6, 11, v6
    v_and_b32 v4, 7, v1
    v_lshl_add_u32 v6, v4, 4, v6
    v_add_u32 v6, s31, v6
    s_lshl_b32 s31, s29, 15
    v_lshrrev_b32 v7, 5, v1
    v_lshlrev_b32 v7, 9, v7
    v_bfe_u32 v4, v1, 2, 2
    v_lshl_add_u32 v7, v4, 7, v7
    v_bfe_u32 v4, v1, 4, 1
    v_lshl_add_u32 v7, v4, 5, v7
    v_and_b32 v4, 3, v1
    v_lshl_add_u32 v7, v4, 3, v7
    v_add_u32 v7, s31, v7
    s_lshl_b32 s32, s29, 15
    s_add_u32 m0, s32, 0
    s_mov_b32 s38, 0
    buffer_load_dwordx4 v6, s[8:11], s38 offen lds
    s_add_u32 m0, s32, 1024
    s_add_u32 s38, s38, 16384
    buffer_load_dwordx4 v6, s[8:11], s38 offen lds
    s_add_u32 m0, s32, 2048
    s_add_u32 s38, s38, 16384
    buffer_load_dwordx4 v6, s[8:11], s38 offen lds
    s_add_u32 m0, s32, 3072
    s_add_u32 s38, s38, 16384
    buffer_load_dwordx4 v6, s[8:11], s38 offen lds
    s_add_u32 m0, s32, 4096
    s_add_u32 s38, s38, 16384
    buffer_load_dwordx4 v6, s[8:11], s38 offen lds
    s_add_u32 m0, s32, 5120
    s_add_u32 s38, s38, 16384
    buffer_load_dwordx4 v6, s[8:11], s38 offen lds
    s_add_u32 m0, s32, 6144
    s_add_u32 s38, s38, 16384
    buffer_load_dwordx4 v6, s[8:11], s38 offen lds
    s_add_u32 m0, s32, 7168
    s_add_u32 s38, s38, 16384
    buffer_load_dwordx4 v6, s[8:11], s38 offen lds
    s_add_u32 m0, s32, 8192
    s_add_u32 s38, s38, 16384
    buffer_load_dwordx4 v6, s[8:11], s38 offen lds
    s_add_u32 m0, s32, 9216
    s_add_u32 s38, s38, 16384
    buffer_load_dwordx4 v6, s[8:11], s38 offen lds
    s_add_u32 m0, s32, 10240
    s_add_u32 s38, s38, 16384
    buffer_load_dwordx4 v6, s[8:11], s38 offen lds
    s_add_u32 m0, s32, 11264
    s_add_u32 s38, s38, 16384
    buffer_load_dwordx4 v6, s[8:11], s38 offen lds
    s_add_u32 m0, s32, 12288
    s_add_u32 s38, s38, 16384
    buffer_load_dwordx4 v6, s[8:11], s38 offen lds
    s_add_u32 m0, s32, 13312
    s_add_u32 s38, s38, 16384
    buffer_load_dwordx4 v6, s[8:11], s38 offen lds
    s_add_u32 m0, s32, 14336
    s_add_u32 s38, s38, 16384
    buffer_load_dwordx4 v6, s[8:11], s38 offen lds
    s_add_u32 m0, s32, 15360
    s_add_u32 s38, s38, 16384
    buffer_load_dwordx4 v6, s[8:11], s38 offen lds
    s_add_u32 m0, s32, 16384
    s_add_u32 s38, s38, 16384
    buffer_load_dwordx4 v6, s[8:11], s38 offen lds
    s_add_u32 m0, s32, 17408
    s_add_u32 s38, s38, 16384
    buffer_load_dwordx4 v6, s[8:11], s38 offen lds
    s_add_u32 m0, s32, 18432
    s_add_u32 s38, s38, 16384
    buffer_load_dwordx4 v6, s[8:11], s38 offen lds
    s_add_u32 m0, s32, 19456
    s_add_u32 s38, s38, 16384
    buffer_load_dwordx4 v6, s[8:11], s38 offen lds
    s_add_u32 m0, s32, 20480
    s_add_u32 s38, s38, 16384
    buffer_load_dwordx4 v6, s[8:11], s38 offen lds
    s_add_u32 m0, s32, 21504
    s_add_u32 s38, s38, 16384
    buffer_load_dwordx4 v6, s[8:11], s38 offen lds
    s_add_u32 m0, s32, 22528
    s_add_u32 s38, s38, 16384
    buffer_load_dwordx4 v6, s[8:11], s38 offen lds
    s_add_u32 m0, s32, 23552
    s_add_u32 s38, s38, 16384
    buffer_load_dwordx4 v6, s[8:11], s38 offen lds
    s_add_u32 m0, s32, 24576
    s_add_u32 s38, s38, 16384
    buffer_load_dwordx4 v6, s[8:11], s38 offen lds
    s_add_u32 m0, s32, 25600
    s_add_u32 s38, s38, 16384
    buffer_load_dwordx4 v6, s[8:11], s38 offen lds
    s_add_u32 m0, s32, 26624
    s_add_u32 s38, s38, 16384
    buffer_load_dwordx4 v6, s[8:11], s38 offen lds
    s_add_u32 m0, s32, 27648
    s_add_u32 s38, s38, 16384
    buffer_load_dwordx4 v6, s[8:11], s38 offen lds
    s_add_u32 m0, s32, 28672
    s_add_u32 s38, s38, 16384
    buffer_load_dwordx4 v6, s[8:11], s38 offen lds
    s_add_u32 m0, s32, 29696
    s_add_u32 s38, s38, 16384
    buffer_load_dwordx4 v6, s[8:11], s38 offen lds
    s_add_u32 m0, s32, 30720
    s_add_u32 s38, s38, 16384
    buffer_load_dwordx4 v6, s[8:11], s38 offen lds
    s_add_u32 m0, s32, 31744
    s_add_u32 s38, s38, 16384
    buffer_load_dwordx4 v6, s[8:11], s38 offen lds
    s_waitcnt vmcnt(30)
    ds_read_b64_tr_b16 a[0:1], v7 offset:0
    ds_read_b64_tr_b16 a[2:3], v7 offset:1024
    ds_read_b64_tr_b16 a[4:5], v7 offset:64
    ds_read_b64_tr_b16 a[6:7], v7 offset:1088
    s_waitcnt vmcnt(28)
    ds_read_b64_tr_b16 a[8:9], v7 offset:2048
    ds_read_b64_tr_b16 a[10:11], v7 offset:3072
    ds_read_b64_tr_b16 a[12:13], v7 offset:2112
    ds_read_b64_tr_b16 a[14:15], v7 offset:3136
    s_waitcnt lgkmcnt(4)
    s_add_u32 m0, s32, 0
    s_add_u32 s38, s38, 16384
    buffer_load_dwordx4 v6, s[8:11], s38 offen lds
    s_add_u32 m0, s32, 1024
    s_add_u32 s38, s38, 16384
    buffer_load_dwordx4 v6, s[8:11], s38 offen lds
    s_waitcnt vmcnt(28)
    ds_read_b64_tr_b16 a[16:17], v7 offset:4096
    ds_read_b64_tr_b16 a[18:19], v7 offset:5120
    ds_read_b64_tr_b16 a[20:21], v7 offset:4160
    ds_read_b64_tr_b16 a[22:23], v7 offset:5184
    s_waitcnt lgkmcnt(4)
    s_add_u32 m0, s32, 2048
    s_add_u32 s38, s38, 16384
    buffer_load_dwordx4 v6, s[8:11], s38 offen lds
    s_add_u32 m0, s32, 3072
    s_add_u32 s38, s38, 16384
    buffer_load_dwordx4 v6, s[8:11], s38 offen lds
    s_waitcnt vmcnt(28)
    ds_read_b64_tr_b16 a[24:25], v7 offset:6144
    ds_read_b64_tr_b16 a[26:27], v7 offset:7168
    ds_read_b64_tr_b16 a[28:29], v7 offset:6208
    ds_read_b64_tr_b16 a[30:31], v7 offset:7232
    s_waitcnt lgkmcnt(4)
    s_add_u32 m0, s32, 4096
    s_add_u32 s38, s38, 16384
    buffer_load_dwordx4 v6, s[8:11], s38 offen lds
    s_add_u32 m0, s32, 5120
    s_add_u32 s38, s38, 16384
    buffer_load_dwordx4 v6, s[8:11], s38 offen lds
    s_waitcnt vmcnt(28)
    ds_read_b64_tr_b16 a[32:33], v7 offset:8192
    ds_read_b64_tr_b16 a[34:35], v7 offset:9216
    ds_read_b64_tr_b16 a[36:37], v7 offset:8256
    ds_read_b64_tr_b16 a[38:39], v7 offset:9280
    s_waitcnt lgkmcnt(4)
    s_add_u32 m0, s32, 6144
    s_add_u32 s38, s38, 16384
    buffer_load_dwordx4 v6, s[8:11], s38 offen lds
    s_add_u32 m0, s32, 7168
    s_add_u32 s38, s38, 16384
    buffer_load_dwordx4 v6, s[8:11], s38 offen lds
    s_waitcnt vmcnt(28)
    ds_read_b64_tr_b16 a[40:41], v7 offset:10240
    ds_read_b64_tr_b16 a[42:43], v7 offset:11264
    ds_read_b64_tr_b16 a[44:45], v7 offset:10304
    ds_read_b64_tr_b16 a[46:47], v7 offset:11328
    s_waitcnt lgkmcnt(4)
    s_add_u32 m0, s32, 8192
    s_add_u32 s38, s38, 16384
    buffer_load_dwordx4 v6, s[8:11], s38 offen lds
    s_add_u32 m0, s32, 9216
    s_add_u32 s38, s38, 16384
    buffer_load_dwordx4 v6, s[8:11], s38 offen lds
    s_waitcnt vmcnt(28)
    ds_read_b64_tr_b16 a[48:49], v7 offset:12288
    ds_read_b64_tr_b16 a[50:51], v7 offset:13312
    ds_read_b64_tr_b16 a[52:53], v7 offset:12352
    ds_read_b64_tr_b16 a[54:55], v7 offset:13376
    s_waitcnt lgkmcnt(4)
    s_add_u32 m0, s32, 10240
    s_add_u32 s38, s38, 16384
    buffer_load_dwordx4 v6, s[8:11], s38 offen lds
    s_add_u32 m0, s32, 11264
    s_add_u32 s38, s38, 16384
    buffer_load_dwordx4 v6, s[8:11], s38 offen lds
    s_waitcnt vmcnt(28)
    ds_read_b64_tr_b16 a[56:57], v7 offset:14336
    ds_read_b64_tr_b16 a[58:59], v7 offset:15360
    ds_read_b64_tr_b16 a[60:61], v7 offset:14400
    ds_read_b64_tr_b16 a[62:63], v7 offset:15424
    s_waitcnt lgkmcnt(4)
    s_add_u32 m0, s32, 12288
    s_add_u32 s38, s38, 16384
    buffer_load_dwordx4 v6, s[8:11], s38 offen lds
    s_add_u32 m0, s32, 13312
    s_add_u32 s38, s38, 16384
    buffer_load_dwordx4 v6, s[8:11], s38 offen lds
    s_waitcnt vmcnt(28)
    ds_read_b64_tr_b16 a[64:65], v7 offset:16384
    ds_read_b64_tr_b16 a[66:67], v7 offset:17408
    ds_read_b64_tr_b16 a[68:69], v7 offset:16448
    ds_read_b64_tr_b16 a[70:71], v7 offset:17472
    s_waitcnt lgkmcnt(4)
    s_add_u32 m0, s32, 14336
    s_add_u32 s38, s38, 16384
    buffer_load_dwordx4 v6, s[8:11], s38 offen lds
    s_add_u32 m0, s32, 15360
    s_add_u32 s38, s38, 16384
    buffer_load_dwordx4 v6, s[8:11], s38 offen lds
    s_waitcnt vmcnt(28)
    ds_read_b64_tr_b16 a[72:73], v7 offset:18432
    ds_read_b64_tr_b16 a[74:75], v7 offset:19456
    ds_read_b64_tr_b16 a[76:77], v7 offset:18496
    ds_read_b64_tr_b16 a[78:79], v7 offset:19520
    s_waitcnt lgkmcnt(4)
    s_add_u32 m0, s32, 16384
    s_add_u32 s38, s38, 16384
    buffer_load_dwordx4 v6, s[8:11], s38 offen lds
    s_add_u32 m0, s32, 17408
    s_add_u32 s38, s38, 16384
    buffer_load_dwordx4 v6, s[8:11], s38 offen lds
    s_waitcnt vmcnt(28)
    ds_read_b64_tr_b16 a[80:81], v7 offset:20480
    ds_read_b64_tr_b16 a[82:83], v7 offset:21504
    ds_read_b64_tr_b16 a[84:85], v7 offset:20544
    ds_read_b64_tr_b16 a[86:87], v7 offset:21568
    s_waitcnt lgkmcnt(4)
    s_add_u32 m0, s32, 18432
    s_add_u32 s38, s38, 16384
    buffer_load_dwordx4 v6, s[8:11], s38 offen lds
    s_add_u32 m0, s32, 19456
    s_add_u32 s38, s38, 16384
    buffer_load_dwordx4 v6, s[8:11], s38 offen lds
    s_waitcnt vmcnt(28)
    ds_read_b64_tr_b16 a[88:89], v7 offset:22528
    ds_read_b64_tr_b16 a[90:91], v7 offset:23552
    ds_read_b64_tr_b16 a[92:93], v7 offset:22592
    ds_read_b64_tr_b16 a[94:95], v7 offset:23616
    s_waitcnt lgkmcnt(4)
    s_add_u32 m0, s32, 20480
    s_add_u32 s38, s38, 16384
    buffer_load_dwordx4 v6, s[8:11], s38 offen lds
    s_add_u32 m0, s32, 21504
    s_add_u32 s38, s38, 16384
    buffer_load_dwordx4 v6, s[8:11], s38 offen lds
    s_waitcnt vmcnt(28)
    ds_read_b64_tr_b16 a[96:97], v7 offset:24576
    ds_read_b64_tr_b16 a[98:99], v7 offset:25600
    ds_read_b64_tr_b16 a[100:101], v7 offset:24640
    ds_read_b64_tr_b16 a[102:103], v7 offset:25664
    s_waitcnt lgkmcnt(4)
    s_add_u32 m0, s32, 22528
    s_add_u32 s38, s38, 16384
    buffer_load_dwordx4 v6, s[8:11], s38 offen lds
    s_add_u32 m0, s32, 23552
    s_add_u32 s38, s38, 16384
    buffer_load_dwordx4 v6, s[8:11], s38 offen lds
    s_waitcnt vmcnt(28)
    ds_read_b64_tr_b16 a[104:105], v7 offset:26624
    ds_read_b64_tr_b16 a[106:107], v7 offset:27648
    ds_read_b64_tr_b16 a[108:109], v7 offset:26688
    ds_read_b64_tr_b16 a[110:111], v7 offset:27712
    s_waitcnt lgkmcnt(4)
    s_add_u32 m0, s32, 24576
    s_add_u32 s38, s38, 16384
    buffer_load_dwordx4 v6, s[8:11], s38 offen lds
    s_add_u32 m0, s32, 25600
    s_add_u32 s38, s38, 16384
    buffer_load_dwordx4 v6, s[8:11], s38 offen lds
    s_waitcnt vmcnt(28)
    ds_read_b64_tr_b16 a[112:113], v7 offset:28672
    ds_read_b64_tr_b16 a[114:115], v7 offset:29696
    ds_read_b64_tr_b16 a[116:117], v7 offset:28736
    ds_read_b64_tr_b16 a[118:119], v7 offset:29760
    s_waitcnt lgkmcnt(4)
    s_add_u32 m0, s32, 26624
    s_add_u32 s38, s38, 16384
    buffer_load_dwordx4 v6, s[8:11], s38 offen lds
    s_add_u32 m0, s32, 27648
    s_add_u32 s38, s38, 16384
    buffer_load_dwordx4 v6, s[8:11], s38 offen lds
    s_waitcnt vmcnt(28)
    ds_read_b64_tr_b16 a[120:121], v7 offset:30720
    ds_read_b64_tr_b16 a[122:123], v7 offset:31744
    ds_read_b64_tr_b16 a[124:125], v7 offset:30784
    ds_read_b64_tr_b16 a[126:127], v7 offset:31808
    s_waitcnt lgkmcnt(4)
    s_add_u32 m0, s32, 28672
    s_add_u32 s38, s38, 16384
    buffer_load_dwordx4 v6, s[8:11], s38 offen lds
    s_add_u32 m0, s32, 29696
    s_add_u32 s38, s38, 16384
    buffer_load_dwordx4 v6, s[8:11], s38 offen lds
    s_waitcnt vmcnt(28)
    ds_read_b64_tr_b16 a[128:129], v7 offset:0
    ds_read_b64_tr_b16 a[130:131], v7 offset:1024
    ds_read_b64_tr_b16 a[132:133], v7 offset:64
    ds_read_b64_tr_b16 a[134:135], v7 offset:1088
    s_waitcnt lgkmcnt(4)
    s_add_u32 m0, s32, 30720
    s_add_u32 s38, s38, 16384
    buffer_load_dwordx4 v6, s[8:11], s38 offen lds
    s_add_u32 m0, s32, 31744
    s_add_u32 s38, s38, 16384
    buffer_load_dwordx4 v6, s[8:11], s38 offen lds
    s_waitcnt vmcnt(28)
    ds_read_b64_tr_b16 a[136:137], v7 offset:2048
    ds_read_b64_tr_b16 a[138:139], v7 offset:3072
    ds_read_b64_tr_b16 a[140:141], v7 offset:2112
    ds_read_b64_tr_b16 a[142:143], v7 offset:3136
    s_waitcnt lgkmcnt(4)
    s_add_u32 m0, s32, 0
    s_add_u32 s38, s38, 16384
    buffer_load_dwordx4 v6, s[8:11], s38 offen lds
    s_add_u32 m0, s32, 1024
    s_add_u32 s38, s38, 16384
    buffer_load_dwordx4 v6, s[8:11], s38 offen lds
    s_waitcnt vmcnt(28)
    ds_read_b64_tr_b16 a[144:145], v7 offset:4096
    ds_read_b64_tr_b16 a[146:147], v7 offset:5120
    ds_read_b64_tr_b16 a[148:149], v7 offset:4160
    ds_read_b64_tr_b16 a[150:151], v7 offset:5184
    s_waitcnt lgkmcnt(4)
    s_add_u32 m0, s32, 2048
    s_add_u32 s38, s38, 16384
    buffer_load_dwordx4 v6, s[8:11], s38 offen lds
    s_add_u32 m0, s32, 3072
    s_add_u32 s38, s38, 16384
    buffer_load_dwordx4 v6, s[8:11], s38 offen lds
    s_waitcnt vmcnt(28)
    ds_read_b64_tr_b16 a[152:153], v7 offset:6144
    ds_read_b64_tr_b16 a[154:155], v7 offset:7168
    ds_read_b64_tr_b16 a[156:157], v7 offset:6208
    ds_read_b64_tr_b16 a[158:159], v7 offset:7232
    s_waitcnt lgkmcnt(4)
    s_add_u32 m0, s32, 4096
    s_add_u32 s38, s38, 16384
    buffer_load_dwordx4 v6, s[8:11], s38 offen lds
    s_add_u32 m0, s32, 5120
    s_add_u32 s38, s38, 16384
    buffer_load_dwordx4 v6, s[8:11], s38 offen lds
    s_waitcnt vmcnt(28)
    ds_read_b64_tr_b16 a[160:161], v7 offset:8192
    ds_read_b64_tr_b16 a[162:163], v7 offset:9216
    ds_read_b64_tr_b16 a[164:165], v7 offset:8256
    ds_read_b64_tr_b16 a[166:167], v7 offset:9280
    s_waitcnt lgkmcnt(4)
    s_add_u32 m0, s32, 6144
    s_add_u32 s38, s38, 16384
    buffer_load_dwordx4 v6, s[8:11], s38 offen lds
    s_add_u32 m0, s32, 7168
    s_add_u32 s38, s38, 16384
    buffer_load_dwordx4 v6, s[8:11], s38 offen lds
    s_waitcnt vmcnt(28)
    ds_read_b64_tr_b16 a[168:169], v7 offset:10240
    ds_read_b64_tr_b16 a[170:171], v7 offset:11264
    ds_read_b64_tr_b16 a[172:173], v7 offset:10304
    ds_read_b64_tr_b16 a[174:175], v7 offset:11328
    s_waitcnt lgkmcnt(4)
    s_add_u32 m0, s32, 8192
    s_add_u32 s38, s38, 16384
    buffer_load_dwordx4 v6, s[8:11], s38 offen lds
    s_add_u32 m0, s32, 9216
    s_add_u32 s38, s38, 16384
    buffer_load_dwordx4 v6, s[8:11], s38 offen lds
    s_waitcnt vmcnt(28)
    ds_read_b64_tr_b16 a[176:177], v7 offset:12288
    ds_read_b64_tr_b16 a[178:179], v7 offset:13312
    ds_read_b64_tr_b16 a[180:181], v7 offset:12352
    ds_read_b64_tr_b16 a[182:183], v7 offset:13376
    s_waitcnt lgkmcnt(4)
    s_add_u32 m0, s32, 10240
    s_add_u32 s38, s38, 16384
    buffer_load_dwordx4 v6, s[8:11], s38 offen lds
    s_add_u32 m0, s32, 11264
    s_add_u32 s38, s38, 16384
    buffer_load_dwordx4 v6, s[8:11], s38 offen lds
    s_waitcnt vmcnt(28)
    ds_read_b64_tr_b16 a[184:185], v7 offset:14336
    ds_read_b64_tr_b16 a[186:187], v7 offset:15360
    ds_read_b64_tr_b16 a[188:189], v7 offset:14400
    ds_read_b64_tr_b16 a[190:191], v7 offset:15424
    s_waitcnt lgkmcnt(4)
    s_add_u32 m0, s32, 12288
    s_add_u32 s38, s38, 16384
    buffer_load_dwordx4 v6, s[8:11], s38 offen lds
    s_add_u32 m0, s32, 13312
    s_add_u32 s38, s38, 16384
    buffer_load_dwordx4 v6, s[8:11], s38 offen lds
    s_waitcnt vmcnt(28)
    ds_read_b64_tr_b16 a[192:193], v7 offset:16384
    ds_read_b64_tr_b16 a[194:195], v7 offset:17408
    ds_read_b64_tr_b16 a[196:197], v7 offset:16448
    ds_read_b64_tr_b16 a[198:199], v7 offset:17472
    s_waitcnt lgkmcnt(4)
    s_add_u32 m0, s32, 14336
    s_add_u32 s38, s38, 16384
    buffer_load_dwordx4 v6, s[8:11], s38 offen lds
    s_add_u32 m0, s32, 15360
    s_add_u32 s38, s38, 16384
    buffer_load_dwordx4 v6, s[8:11], s38 offen lds
    s_waitcnt vmcnt(28)
    ds_read_b64_tr_b16 a[200:201], v7 offset:18432
    ds_read_b64_tr_b16 a[202:203], v7 offset:19456
    ds_read_b64_tr_b16 a[204:205], v7 offset:18496
    ds_read_b64_tr_b16 a[206:207], v7 offset:19520
    s_waitcnt lgkmcnt(4)
    s_add_u32 m0, s32, 16384
    s_add_u32 s38, s38, 16384
    buffer_load_dwordx4 v6, s[8:11], s38 offen lds
    s_add_u32 m0, s32, 17408
    s_add_u32 s38, s38, 16384
    buffer_load_dwordx4 v6, s[8:11], s38 offen lds
    s_waitcnt vmcnt(28)
    ds_read_b64_tr_b16 a[208:209], v7 offset:20480
    ds_read_b64_tr_b16 a[210:211], v7 offset:21504
    ds_read_b64_tr_b16 a[212:213], v7 offset:20544
    ds_read_b64_tr_b16 a[214:215], v7 offset:21568
    s_waitcnt lgkmcnt(4)
    s_add_u32 m0, s32, 18432
    s_add_u32 s38, s38, 16384
    buffer_load_dwordx4 v6, s[8:11], s38 offen lds
    s_add_u32 m0, s32, 19456
    s_add_u32 s38, s38, 16384
    buffer_load_dwordx4 v6, s[8:11], s38 offen lds
    s_waitcnt vmcnt(28)
    ds_read_b64_tr_b16 a[216:217], v7 offset:22528
    ds_read_b64_tr_b16 a[218:219], v7 offset:23552
    ds_read_b64_tr_b16 a[220:221], v7 offset:22592
    ds_read_b64_tr_b16 a[222:223], v7 offset:23616
    s_waitcnt lgkmcnt(4)
    s_add_u32 m0, s32, 20480
    s_add_u32 s38, s38, 16384
    buffer_load_dwordx4 v6, s[8:11], s38 offen lds
    s_add_u32 m0, s32, 21504
    s_add_u32 s38, s38, 16384
    buffer_load_dwordx4 v6, s[8:11], s38 offen lds
    s_waitcnt vmcnt(28)
    ds_read_b64_tr_b16 a[224:225], v7 offset:24576
    ds_read_b64_tr_b16 a[226:227], v7 offset:25600
    ds_read_b64_tr_b16 a[228:229], v7 offset:24640
    ds_read_b64_tr_b16 a[230:231], v7 offset:25664
    s_waitcnt lgkmcnt(4)
    s_add_u32 m0, s32, 22528
    s_add_u32 s38, s38, 16384
    buffer_load_dwordx4 v6, s[8:11], s38 offen lds
    s_add_u32 m0, s32, 23552
    s_add_u32 s38, s38, 16384
    buffer_load_dwordx4 v6, s[8:11], s38 offen lds
    s_waitcnt vmcnt(28)
    ds_read_b64_tr_b16 a[232:233], v7 offset:26624
    ds_read_b64_tr_b16 a[234:235], v7 offset:27648
    ds_read_b64_tr_b16 a[236:237], v7 offset:26688
    ds_read_b64_tr_b16 a[238:239], v7 offset:27712
    s_waitcnt lgkmcnt(4)
    s_add_u32 m0, s32, 24576
    s_add_u32 s38, s38, 16384
    buffer_load_dwordx4 v6, s[8:11], s38 offen lds
    s_add_u32 m0, s32, 25600
    s_add_u32 s38, s38, 16384
    buffer_load_dwordx4 v6, s[8:11], s38 offen lds
    s_waitcnt vmcnt(28)
    ds_read_b64_tr_b16 a[240:241], v7 offset:28672
    ds_read_b64_tr_b16 a[242:243], v7 offset:29696
    ds_read_b64_tr_b16 a[244:245], v7 offset:28736
    ds_read_b64_tr_b16 a[246:247], v7 offset:29760
    s_waitcnt lgkmcnt(4)
    s_add_u32 m0, s32, 26624
    s_add_u32 s38, s38, 16384
    buffer_load_dwordx4 v6, s[8:11], s38 offen lds
    s_add_u32 m0, s32, 27648
    s_add_u32 s38, s38, 16384
    buffer_load_dwordx4 v6, s[8:11], s38 offen lds
    s_waitcnt vmcnt(28)
    ds_read_b64_tr_b16 a[248:249], v7 offset:30720
    ds_read_b64_tr_b16 a[250:251], v7 offset:31744
    ds_read_b64_tr_b16 a[252:253], v7 offset:30784
    ds_read_b64_tr_b16 a[254:255], v7 offset:31808
    s_waitcnt lgkmcnt(4)
    s_add_u32 m0, s32, 28672
    s_add_u32 s38, s38, 16384
    buffer_load_dwordx4 v6, s[8:11], s38 offen lds
    s_add_u32 m0, s32, 29696
    s_add_u32 s38, s38, 16384
    buffer_load_dwordx4 v6, s[8:11], s38 offen lds
    s_waitcnt vmcnt(28)
    ds_read_b64_tr_b16 v[128:129], v7 offset:0
    ds_read_b64_tr_b16 v[130:131], v7 offset:1024
    ds_read_b64_tr_b16 v[132:133], v7 offset:64
    ds_read_b64_tr_b16 v[134:135], v7 offset:1088
    s_waitcnt lgkmcnt(4)
    s_add_u32 m0, s32, 30720
    s_add_u32 s38, s38, 16384
    buffer_load_dwordx4 v6, s[8:11], s38 offen lds
    s_add_u32 m0, s32, 31744
    s_add_u32 s38, s38, 16384
    buffer_load_dwordx4 v6, s[8:11], s38 offen lds
    s_waitcnt vmcnt(28)
    ds_read_b64_tr_b16 v[136:137], v7 offset:2048
    ds_read_b64_tr_b16 v[138:139], v7 offset:3072
    ds_read_b64_tr_b16 v[140:141], v7 offset:2112
    ds_read_b64_tr_b16 v[142:143], v7 offset:3136
    s_waitcnt lgkmcnt(4)
    s_add_u32 m0, s32, 0
    s_add_u32 s38, s38, 16384
    buffer_load_dwordx4 v6, s[8:11], s38 offen lds
    s_add_u32 m0, s32, 1024
    s_add_u32 s38, s38, 16384
    buffer_load_dwordx4 v6, s[8:11], s38 offen lds
    s_waitcnt vmcnt(28)
    ds_read_b64_tr_b16 v[144:145], v7 offset:4096
    ds_read_b64_tr_b16 v[146:147], v7 offset:5120
    ds_read_b64_tr_b16 v[148:149], v7 offset:4160
    ds_read_b64_tr_b16 v[150:151], v7 offset:5184
    s_waitcnt lgkmcnt(4)
    s_add_u32 m0, s32, 2048
    s_add_u32 s38, s38, 16384
    buffer_load_dwordx4 v6, s[8:11], s38 offen lds
    s_add_u32 m0, s32, 3072
    s_add_u32 s38, s38, 16384
    buffer_load_dwordx4 v6, s[8:11], s38 offen lds
    s_waitcnt vmcnt(28)
    ds_read_b64_tr_b16 v[152:153], v7 offset:6144
    ds_read_b64_tr_b16 v[154:155], v7 offset:7168
    ds_read_b64_tr_b16 v[156:157], v7 offset:6208
    ds_read_b64_tr_b16 v[158:159], v7 offset:7232
    s_waitcnt lgkmcnt(4)
    s_add_u32 m0, s32, 4096
    s_add_u32 s38, s38, 16384
    buffer_load_dwordx4 v6, s[8:11], s38 offen lds
    s_add_u32 m0, s32, 5120
    s_add_u32 s38, s38, 16384
    buffer_load_dwordx4 v6, s[8:11], s38 offen lds
    s_waitcnt vmcnt(28)
    ds_read_b64_tr_b16 v[160:161], v7 offset:8192
    ds_read_b64_tr_b16 v[162:163], v7 offset:9216
    ds_read_b64_tr_b16 v[164:165], v7 offset:8256
    ds_read_b64_tr_b16 v[166:167], v7 offset:9280
    s_waitcnt lgkmcnt(4)
    s_add_u32 m0, s32, 6144
    s_add_u32 s38, s38, 16384
    buffer_load_dwordx4 v6, s[8:11], s38 offen lds
    s_add_u32 m0, s32, 7168
    s_add_u32 s38, s38, 16384
    buffer_load_dwordx4 v6, s[8:11], s38 offen lds
    s_waitcnt vmcnt(28)
    ds_read_b64_tr_b16 v[168:169], v7 offset:10240
    ds_read_b64_tr_b16 v[170:171], v7 offset:11264
    ds_read_b64_tr_b16 v[172:173], v7 offset:10304
    ds_read_b64_tr_b16 v[174:175], v7 offset:11328
    s_waitcnt lgkmcnt(4)
    s_add_u32 m0, s32, 8192
    s_add_u32 s38, s38, 16384
    buffer_load_dwordx4 v6, s[8:11], s38 offen lds
    s_add_u32 m0, s32, 9216
    s_add_u32 s38, s38, 16384
    buffer_load_dwordx4 v6, s[8:11], s38 offen lds
    s_waitcnt vmcnt(28)
    ds_read_b64_tr_b16 v[176:177], v7 offset:12288
    ds_read_b64_tr_b16 v[178:179], v7 offset:13312
    ds_read_b64_tr_b16 v[180:181], v7 offset:12352
    ds_read_b64_tr_b16 v[182:183], v7 offset:13376
    s_waitcnt lgkmcnt(4)
    s_add_u32 m0, s32, 10240
    s_add_u32 s38, s38, 16384
    buffer_load_dwordx4 v6, s[8:11], s38 offen lds
    s_add_u32 m0, s32, 11264
    s_add_u32 s38, s38, 16384
    buffer_load_dwordx4 v6, s[8:11], s38 offen lds
    s_waitcnt vmcnt(28)
    ds_read_b64_tr_b16 v[184:185], v7 offset:14336
    ds_read_b64_tr_b16 v[186:187], v7 offset:15360
    ds_read_b64_tr_b16 v[188:189], v7 offset:14400
    ds_read_b64_tr_b16 v[190:191], v7 offset:15424
    s_waitcnt lgkmcnt(4)
    s_add_u32 m0, s32, 12288
    s_add_u32 s38, s38, 16384
    buffer_load_dwordx4 v6, s[8:11], s38 offen lds
    s_add_u32 m0, s32, 13312
    s_add_u32 s38, s38, 16384
    buffer_load_dwordx4 v6, s[8:11], s38 offen lds
    s_waitcnt vmcnt(28)
    ds_read_b64_tr_b16 v[192:193], v7 offset:16384
    ds_read_b64_tr_b16 v[194:195], v7 offset:17408
    ds_read_b64_tr_b16 v[196:197], v7 offset:16448
    ds_read_b64_tr_b16 v[198:199], v7 offset:17472
    s_waitcnt lgkmcnt(4)
    s_add_u32 m0, s32, 14336
    s_add_u32 s38, s38, 16384
    buffer_load_dwordx4 v6, s[8:11], s38 offen lds
    s_add_u32 m0, s32, 15360
    s_add_u32 s38, s38, 16384
    buffer_load_dwordx4 v6, s[8:11], s38 offen lds
    s_waitcnt vmcnt(28)
    ds_read_b64_tr_b16 v[200:201], v7 offset:18432
    ds_read_b64_tr_b16 v[202:203], v7 offset:19456
    ds_read_b64_tr_b16 v[204:205], v7 offset:18496
    ds_read_b64_tr_b16 v[206:207], v7 offset:19520
    s_waitcnt lgkmcnt(4)
    s_add_u32 m0, s32, 16384
    s_add_u32 s38, s38, 16384
    buffer_load_dwordx4 v6, s[8:11], s38 offen lds
    s_add_u32 m0, s32, 17408
    s_add_u32 s38, s38, 16384
    buffer_load_dwordx4 v6, s[8:11], s38 offen lds
    s_waitcnt vmcnt(28)
    ds_read_b64_tr_b16 v[208:209], v7 offset:20480
    ds_read_b64_tr_b16 v[210:211], v7 offset:21504
    ds_read_b64_tr_b16 v[212:213], v7 offset:20544
    ds_read_b64_tr_b16 v[214:215], v7 offset:21568
    s_waitcnt lgkmcnt(4)
    s_add_u32 m0, s32, 18432
    s_add_u32 s38, s38, 16384
    buffer_load_dwordx4 v6, s[8:11], s38 offen lds
    s_add_u32 m0, s32, 19456
    s_add_u32 s38, s38, 16384
    buffer_load_dwordx4 v6, s[8:11], s38 offen lds
    s_waitcnt vmcnt(28)
    ds_read_b64_tr_b16 v[216:217], v7 offset:22528
    ds_read_b64_tr_b16 v[218:219], v7 offset:23552
    ds_read_b64_tr_b16 v[220:221], v7 offset:22592
    ds_read_b64_tr_b16 v[222:223], v7 offset:23616
    s_waitcnt lgkmcnt(4)
    s_add_u32 m0, s32, 20480
    s_add_u32 s38, s38, 16384
    buffer_load_dwordx4 v6, s[8:11], s38 offen lds
    s_add_u32 m0, s32, 21504
    s_add_u32 s38, s38, 16384
    buffer_load_dwordx4 v6, s[8:11], s38 offen lds
    s_waitcnt vmcnt(28)
    ds_read_b64_tr_b16 v[224:225], v7 offset:24576
    ds_read_b64_tr_b16 v[226:227], v7 offset:25600
    ds_read_b64_tr_b16 v[228:229], v7 offset:24640
    ds_read_b64_tr_b16 v[230:231], v7 offset:25664
    s_waitcnt lgkmcnt(4)
    s_add_u32 m0, s32, 22528
    s_add_u32 s38, s38, 16384
    buffer_load_dwordx4 v6, s[8:11], s38 offen lds
    s_add_u32 m0, s32, 23552
    s_add_u32 s38, s38, 16384
    buffer_load_dwordx4 v6, s[8:11], s38 offen lds
    s_waitcnt vmcnt(28)
    ds_read_b64_tr_b16 v[232:233], v7 offset:26624
    ds_read_b64_tr_b16 v[234:235], v7 offset:27648
    ds_read_b64_tr_b16 v[236:237], v7 offset:26688
    ds_read_b64_tr_b16 v[238:239], v7 offset:27712
    s_waitcnt lgkmcnt(4)
    s_add_u32 m0, s32, 24576
    s_add_u32 s38, s38, 16384
    buffer_load_dwordx4 v6, s[8:11], s38 offen lds
    s_add_u32 m0, s32, 25600
    s_add_u32 s38, s38, 16384
    buffer_load_dwordx4 v6, s[8:11], s38 offen lds
    s_waitcnt vmcnt(28)
    ds_read_b64_tr_b16 v[240:241], v7 offset:28672
    ds_read_b64_tr_b16 v[242:243], v7 offset:29696
    ds_read_b64_tr_b16 v[244:245], v7 offset:28736
    ds_read_b64_tr_b16 v[246:247], v7 offset:29760
    s_waitcnt lgkmcnt(4)
    s_add_u32 m0, s32, 26624
    s_add_u32 s38, s38, 16384
    buffer_load_dwordx4 v6, s[8:11], s38 offen lds
    s_add_u32 m0, s32, 27648
    s_add_u32 s38, s38, 16384
    buffer_load_dwordx4 v6, s[8:11], s38 offen lds
    s_waitcnt vmcnt(28)
    ds_read_b64_tr_b16 v[248:249], v7 offset:30720
    ds_read_b64_tr_b16 v[250:251], v7 offset:31744
    ds_read_b64_tr_b16 v[252:253], v7 offset:30784
    ds_read_b64_tr_b16 v[254:255], v7 offset:31808
    s_waitcnt lgkmcnt(4)
    s_add_u32 m0, s32, 28672
    s_add_u32 s38, s38, 16384
    buffer_load_dwordx4 v6, s[8:11], s38 offen lds
    s_add_u32 m0, s32, 29696
    s_add_u32 s38, s38, 16384
    buffer_load_dwordx4 v6, s[8:11], s38 offen lds
    s_waitcnt vmcnt(28)
    s_waitcnt lgkmcnt(0)
    s_add_u32 m0, s32, 30720
    s_add_u32 s38, s38, 16384
    buffer_load_dwordx4 v6, s[8:11], s38 offen lds
    s_add_u32 m0, s32, 31744
    s_add_u32 s38, s38, 16384
    buffer_load_dwordx4 v6, s[8:11], s38 offen lds
    s_waitcnt vmcnt(28)
    s_waitcnt vmcnt(26)
    s_waitcnt vmcnt(24)
    s_waitcnt vmcnt(22)
    s_waitcnt vmcnt(20)
    s_waitcnt vmcnt(18)
    s_waitcnt vmcnt(16)
    s_waitcnt vmcnt(14)
    s_waitcnt vmcnt(12)
    s_waitcnt vmcnt(10)
    s_waitcnt vmcnt(8)
    s_waitcnt vmcnt(6)
    s_waitcnt vmcnt(4)
    s_waitcnt vmcnt(2)
    s_waitcnt vmcnt(0)
    s_waitcnt lgkmcnt(0)
    s_lshl_b32 s31, s29, 16
    v_add_u32 v8, s31, v5
    s_lshl_b32 s31, s29, 13
    s_add_u32 s31, s31, 131072
    v_add_u32 v9, s31, v5
    s_lshl_b32 s31, s29, 7
    s_add_u32 s31, s31, 131072
    v_bfe_u32 v10, v1, 1, 2
    v_lshlrev_b32 v10, 10, v10
    v_and_b32 v4, 1, v1
    v_lshl_add_u32 v10, v4, 9, v10
    v_lshrrev_b32 v4, 3, v1
    v_lshl_add_u32 v10, v4, 4, v10
    v_add_u32 v10, s31, v10
    s_lshl_b32 s31, s29, 15
    s_lshl_b32 s33, s44, 7
    s_add_u32 s31, s31, s33
    v_lshrrev_b32 v11, 3, v1
    v_lshlrev_b32 v11, 12, v11
    v_and_b32 v4, 7, v1
    v_lshl_add_u32 v11, v4, 3, v11
    v_add_u32 v11, s31, v11
    v_and_b32 v12, 31, v1
    v_lshlrev_b32 v12, 7, v12
    v_add_u32 v12, 115343360, v12
    s_lshl_b32 s31, s29, 16
    s_and_b32 s33, s44, 7
    s_lshl_b32 s33, s33, 13
    s_add_u32 s31, s31, s33
    v_lshl_add_u32 v14, v1, 7, s31
    s_cmp_lg_u32 s29, 0
    s_cbranch_scc1 g_wdd_97
g_wd_96:
    s_load_dword s72, s[92:93], 0 glc
    s_add_u32 s41, s41, 1
    s_cmp_ge_u32 s41, 0x200000
    s_cbranch_scc1 g_wdd_97
    s_waitcnt lgkmcnt(0)
    s_cmp_ge_u32 s72, 352
    s_cbranch_scc1 g_wdd_97
    s_sleep 32
    s_branch g_wd_96
g_wdd_97:
    s_waitcnt lgkmcnt(0)
    s_barrier
o6_loop_98:
    s_lshl_b32 s47, s30, 18
    s_add_u32 s47, s47, 67108864
    s_and_b32 s52, s30, 63
    s_lshl_b32 s52, s52, 12
    s_add_u32 s52, s52, 32768
o6_w_102:
    buffer_load_dword v13, v12, s[4:7], s52 offen sc1
    s_add_u32 s41, s41, 1
    s_cmp_ge_u32 s41, 0x200000
    s_cbranch_scc1 o6_wd_103
    s_waitcnt vmcnt(0)
    v_cmp_eq_u32 vcc, 0, v13
    s_cbranch_vccz o6_wd_103
    s_sleep 10
    s_branch o6_w_102
o6_wd_103:
    buffer_load_dword v3, v14, s[4:7], s47 offen sc1
    s_add_u32 s31, s47, 0
    buffer_load_dwordx4 v[64:67], v8, s[4:7], s31 offen sc1
    s_add_u32 s31, s47, 1024
    buffer_load_dwordx4 v[68:71], v8, s[4:7], s31 offen sc1
    s_add_u32 s31, s47, 2048
    buffer_load_dwordx4 v[72:75], v8, s[4:7], s31 offen sc1
    s_add_u32 s31, s47, 49152
    buffer_load_dwordx4 v[76:79], v8, s[4:7], s31 offen sc1
    s_add_u32 s31, s47, 3072
    buffer_load_dwordx4 v[80:83], v8, s[4:7], s31 offen sc1
    s_add_u32 s31, s47, 4096
    buffer_load_dwordx4 v[84:87], v8, s[4:7], s31 offen sc1
    s_add_u32 s31, s47, 5120
    buffer_load_dwordx4 v[88:91], v8, s[4:7], s31 offen sc1
    s_add_u32 s31, s47, 50176
    buffer_load_dwordx4 v[92:95], v8, s[4:7], s31 offen sc1
    s_add_u32 s31, s47, 6144
    buffer_load_dwordx4 v[96:99], v8, s[4:7], s31 offen sc1
    s_add_u32 s31, s47, 7168
    buffer_load_dwordx4 v[100:103], v8, s[4:7], s31 offen sc1
    s_add_u32 s31, s47, 8192
    buffer_load_dwordx4 v[104:107], v8, s[4:7], s31 offen sc1
    s_add_u32 s31, s47, 51200
    buffer_load_dwordx4 v[108:111], v8, s[4:7], s31 offen sc1
    s_add_u32 s31, s47, 9216
    buffer_load_dwordx4 v[112:115], v8, s[4:7], s31 offen sc1
    s_add_u32 s31, s47, 10240
    buffer_load_dwordx4 v[116:119], v8, s[4:7], s31 offen sc1
    s_add_u32 s31, s47, 11264
    buffer_load_dwordx4 v[120:123], v8, s[4:7], s31 offen sc1
o6_go_99:
    s_lshl_b32 s49, s30, 17
    s_add_u32 s35, s30, 5
    s_and_b32 s52, s35, 63
    s_lshl_b32 s52, s52, 12
    s_add_u32 s52, s52, 32768
    ds_read_b64_tr_b16 v[16:17], v7 offset:0
    ds_read_b64_tr_b16 v[18:19], v7 offset:1024
    ds_read_b64_tr_b16 v[20:21], v7 offset:64
    ds_read_b64_tr_b16 v[22:23], v7 offset:1088
    s_waitcnt vmcnt(14)
    v_mfma_f32_32x32x16_bf16 v[32:47], a[0:3], v[64:67], 0
    s_add_u32 s31, s47, 52224
    buffer_load_dwordx4 v[124:127], v8, s[4:7], s31 offen sc1
    v_mfma_f32_32x32x16_bf16 v[48:63], a[4:7], v[64:67], 0
    s_waitcnt vmcnt(14)
    v_mfma_f32_32x32x16_bf16 v[32:47], a[8:11], v[68:71], v[32:47]
    s_add_u32 s31, s47, 12288
    buffer_load_dwordx4 v[64:67], v8, s[4:7], s31 offen sc1
    v_mfma_f32_32x32x16_bf16 v[48:63], a[12:15], v[68:71], v[48:63]
    s_waitcnt vmcnt(14)
    v_mfma_f32_32x32x16_bf16 v[32:47], a[16:19], v[72:75], v[32:47]
    s_add_u32 s31, s47, 13312
    buffer_load_dwordx4 v[68:71], v8, s[4:7], s31 offen sc1
    v_mfma_f32_32x32x16_bf16 v[48:63], a[20:23], v[72:75], v[48:63]
    s_waitcnt vmcnt(14)
    s_waitcnt lgkmcnt(0)
    v_mfma_f32_32x32x16_bf16 v[32:47], v[16:19], v[76:79], v[32:47]
    s_add_u32 s31, s47, 14336
    buffer_load_dwordx4 v[72:75], v8, s[4:7], s31 offen sc1
    v_mfma_f32_32x32x16_bf16 v[48:63], v[20:23], v[76:79], v[48:63]
    ds_read_b64_tr_b16 v[24:25], v7 offset:2048
    ds_read_b64_tr_b16 v[26:27], v7 offset:3072
    ds_read_b64_tr_b16 v[28:29], v7 offset:2112
    ds_read_b64_tr_b16 v[30:31], v7 offset:3136
    s_waitcnt vmcnt(14)
    v_mfma_f32_32x32x16_bf16 v[32:47], a[24:27], v[80:83], v[32:47]
    s_add_u32 s31, s47, 53248
    buffer_load_dwordx4 v[76:79], v8, s[4:7], s31 offen sc1
    v_mfma_f32_32x32x16_bf16 v[48:63], a[28:31], v[80:83], v[48:63]
    s_waitcnt vmcnt(14)
    v_mfma_f32_32x32x16_bf16 v[32:47], a[32:35], v[84:87], v[32:47]
    s_add_u32 s31, s47, 15360
    buffer_load_dwordx4 v[80:83], v8, s[4:7], s31 offen sc1
    v_mfma_f32_32x32x16_bf16 v[48:63], a[36:39], v[84:87], v[48:63]
    s_waitcnt vmcnt(14)
    v_mfma_f32_32x32x16_bf16 v[32:47], a[40:43], v[88:91], v[32:47]
    s_add_u32 s31, s47, 16384
    buffer_load_dwordx4 v[84:87], v8, s[4:7], s31 offen sc1
    v_mfma_f32_32x32x16_bf16 v[48:63], a[44:47], v[88:91], v[48:63]
    s_waitcnt vmcnt(14)
    s_waitcnt lgkmcnt(0)
    v_mfma_f32_32x32x16_bf16 v[32:47], v[24:27], v[92:95], v[32:47]
    s_add_u32 s31, s47, 17408
    buffer_load_dwordx4 v[88:91], v8, s[4:7], s31 offen sc1
    v_mfma_f32_32x32x16_bf16 v[48:63], v[28:31], v[92:95], v[48:63]
    ds_read_b64_tr_b16 v[16:17], v7 offset:4096
    ds_read_b64_tr_b16 v[18:19], v7 offset:5120
    ds_read_b64_tr_b16 v[20:21], v7 offset:4160
    ds_read_b64_tr_b16 v[22:23], v7 offset:5184
    s_waitcnt vmcnt(14)
    v_mfma_f32_32x32x16_bf16 v[32:47], a[48:51], v[96:99], v[32:47]
    s_add_u32 s31, s47, 54272
    buffer_load_dwordx4 v[92:95], v8, s[4:7], s31 offen sc1
    v_mfma_f32_32x32x16_bf16 v[48:63], a[52:55], v[96:99], v[48:63]
    s_waitcnt vmcnt(14)
    v_mfma_f32_32x32x16_bf16 v[32:47], a[56:59], v[100:103], v[32:47]
    s_add_u32 s31, s47, 18432
    buffer_load_dwordx4 v[96:99], v8, s[4:7], s31 offen sc1
    v_mfma_f32_32x32x16_bf16 v[48:63], a[60:63], v[100:103], v[48:63]
    s_waitcnt vmcnt(14)
    v_mfma_f32_32x32x16_bf16 v[32:47], a[64:67], v[104:107], v[32:47]
    s_add_u32 s31, s47, 19456
    buffer_load_dwordx4 v[100:103], v8, s[4:7], s31 offen sc1
    v_mfma_f32_32x32x16_bf16 v[48:63], a[68:71], v[104:107], v[48:63]
    s_waitcnt vmcnt(14)
    s_waitcnt lgkmcnt(0)
    v_mfma_f32_32x32x16_bf16 v[32:47], v[16:19], v[108:111], v[32:47]
    s_add_u32 s31, s47, 20480
    buffer_load_dwordx4 v[104:107], v8, s[4:7], s31 offen sc1
    v_mfma_f32_32x32x16_bf16 v[48:63], v[20:23], v[108:111], v[48:63]
    ds_read_b64_tr_b16 v[24:25], v7 offset:6144
    ds_read_b64_tr_b16 v[26:27], v7 offset:7168
    ds_read_b64_tr_b16 v[28:29], v7 offset:6208
    ds_read_b64_tr_b16 v[30:31], v7 offset:7232
    s_waitcnt vmcnt(14)
    v_mfma_f32_32x32x16_bf16 v[32:47], a[72:75], v[112:115], v[32:47]
    s_add_u32 s31, s47, 55296
    buffer_load_dwordx4 v[108:111], v8, s[4:7], s31 offen sc1
    v_mfma_f32_32x32x16_bf16 v[48:63], a[76:79], v[112:115], v[48:63]
    s_waitcnt vmcnt(14)
    v_mfma_f32_32x32x16_bf16 v[32:47], a[80:83], v[116:119], v[32:47]
    s_add_u32 s31, s47, 21504
    buffer_load_dwordx4 v[112:115], v8, s[4:7], s31 offen sc1
    v_mfma_f32_32x32x16_bf16 v[48:63], a[84:87], v[116:119], v[48:63]
    s_waitcnt vmcnt(14)
    v_mfma_f32_32x32x16_bf16 v[32:47], a[88:91], v[120:123], v[32:47]
    s_add_u32 s31, s47, 22528
    buffer_load_dwordx4 v[116:119], v8, s[4:7], s31 offen sc1
    v_mfma_f32_32x32x16_bf16 v[48:63], a[92:95], v[120:123], v[48:63]
    s_waitcnt vmcnt(14)
    s_waitcnt lgkmcnt(0)
    v_mfma_f32_32x32x16_bf16 v[32:47], v[24:27], v[124:127], v[32:47]
    s_add_u32 s31, s47, 23552
    buffer_load_dwordx4 v[120:123], v8, s[4:7], s31 offen sc1
    v_mfma_f32_32x32x16_bf16 v[48:63], v[28:31], v[124:127], v[48:63]
    ds_read_b64_tr_b16 v[16:17], v7 offset:8192
    ds_read_b64_tr_b16 v[18:19], v7 offset:9216
    ds_read_b64_tr_b16 v[20:21], v7 offset:8256
    ds_read_b64_tr_b16 v[22:23], v7 offset:9280
    s_waitcnt vmcnt(14)
    v_mfma_f32_32x32x16_bf16 v[32:47], a[96:99], v[64:67], v[32:47]
    s_add_u32 s31, s47, 56320
    buffer_load_dwordx4 v[124:127], v8, s[4:7], s31 offen sc1
    v_mfma_f32_32x32x16_bf16 v[48:63], a[100:103], v[64:67], v[48:63]
    s_waitcnt vmcnt(14)
    v_mfma_f32_32x32x16_bf16 v[32:47], a[104:107], v[68:71], v[32:47]
    s_add_u32 s31, s47, 24576
    buffer_load_dwordx4 v[64:67], v8, s[4:7], s31 offen sc1
    v_mfma_f32_32x32x16_bf16 v[48:63], a[108:111], v[68:71], v[48:63]
    s_waitcnt vmcnt(14)
    v_mfma_f32_32x32x16_bf16 v[32:47], a[112:115], v[72:75], v[32:47]
    s_add_u32 s31, s47, 25600
    buffer_load_dwordx4 v[68:71], v8, s[4:7], s31 offen sc1
    v_mfma_f32_32x32x16_bf16 v[48:63], a[116:119], v[72:75], v[48:63]
    s_waitcnt vmcnt(14)
    s_waitcnt lgkmcnt(0)
    v_mfma_f32_32x32x16_bf16 v[32:47], v[16:19], v[76:79], v[32:47]
    s_add_u32 s31, s47, 26624
    buffer_load_dwordx4 v[72:75], v8, s[4:7], s31 offen sc1
    v_mfma_f32_32x32x16_bf16 v[48:63], v[20:23], v[76:79], v[48:63]
    ds_read_b64_tr_b16 v[24:25], v7 offset:10240
    ds_read_b64_tr_b16 v[26:27], v7 offset:11264
    ds_read_b64_tr_b16 v[28:29], v7 offset:10304
    ds_read_b64_tr_b16 v[30:31], v7 offset:11328
    s_waitcnt vmcnt(14)
    v_mfma_f32_32x32x16_bf16 v[32:47], a[120:123], v[80:83], v[32:47]
    s_add_u32 s31, s47, 57344
    buffer_load_dwordx4 v[76:79], v8, s[4:7], s31 offen sc1
    v_mfma_f32_32x32x16_bf16 v[48:63], a[124:127], v[80:83], v[48:63]
    s_waitcnt vmcnt(14)
    v_mfma_f32_32x32x16_bf16 v[32:47], a[128:131], v[84:87], v[32:47]
    s_add_u32 s31, s47, 27648
    buffer_load_dwordx4 v[80:83], v8, s[4:7], s31 offen sc1
    v_mfma_f32_32x32x16_bf16 v[48:63], a[132:135], v[84:87], v[48:63]
    s_waitcnt vmcnt(14)
    v_mfma_f32_32x32x16_bf16 v[32:47], a[136:139], v[88:91], v[32:47]
    s_add_u32 s31, s47, 28672
    buffer_load_dwordx4 v[84:87], v8, s[4:7], s31 offen sc1
    v_mfma_f32_32x32x16_bf16 v[48:63], a[140:143], v[88:91], v[48:63]
    s_waitcnt vmcnt(14)
    s_waitcnt lgkmcnt(0)
    v_mfma_f32_32x32x16_bf16 v[32:47], v[24:27], v[92:95], v[32:47]
    s_add_u32 s31, s47, 29696
    buffer_load_dwordx4 v[88:91], v8, s[4:7], s31 offen sc1
    v_mfma_f32_32x32x16_bf16 v[48:63], v[28:31], v[92:95], v[48:63]
    ds_read_b64_tr_b16 v[16:17], v7 offset:12288
    ds_read_b64_tr_b16 v[18:19], v7 offset:13312
    ds_read_b64_tr_b16 v[20:21], v7 offset:12352
    ds_read_b64_tr_b16 v[22:23], v7 offset:13376
    s_waitcnt vmcnt(14)
    v_mfma_f32_32x32x16_bf16 v[32:47], a[144:147], v[96:99], v[32:47]
    s_add_u32 s31, s47, 58368
    buffer_load_dwordx4 v[92:95], v8, s[4:7], s31 offen sc1
    buffer_load_dword v13, v12, s[4:7], s52 offen sc1
    v_mfma_f32_32x32x16_bf16 v[48:63], a[148:151], v[96:99], v[48:63]
    s_waitcnt vmcnt(15)
    v_mfma_f32_32x32x16_bf16 v[32:47], a[152:155], v[100:103], v[32:47]
    s_add_u32 s31, s47, 30720
    buffer_load_dwordx4 v[96:99], v8, s[4:7], s31 offen sc1
    v_mfma_f32_32x32x16_bf16 v[48:63], a[156:159], v[100:103], v[48:63]
    s_waitcnt vmcnt(15)
    v_mfma_f32_32x32x16_bf16 v[32:47], a[160:163], v[104:107], v[32:47]
    s_add_u32 s31, s47, 31744
    buffer_load_dwordx4 v[100:103], v8, s[4:7], s31 offen sc1
    v_mfma_f32_32x32x16_bf16 v[48:63], a[164:167], v[104:107], v[48:63]
    s_waitcnt vmcnt(15)
    s_waitcnt lgkmcnt(0)
    v_mfma_f32_32x32x16_bf16 v[32:47], v[16:19], v[108:111], v[32:47]
    s_add_u32 s31, s47, 32768
    buffer_load_dwordx4 v[104:107], v8, s[4:7], s31 offen sc1
    v_mfma_f32_32x32x16_bf16 v[48:63], v[20:23], v[108:111], v[48:63]
    ds_read_b64_tr_b16 v[24:25], v7 offset:14336
    ds_read_b64_tr_b16 v[26:27], v7 offset:15360
    ds_read_b64_tr_b16 v[28:29], v7 offset:14400
    ds_read_b64_tr_b16 v[30:31], v7 offset:15424
    s_waitcnt vmcnt(15)
    v_mfma_f32_32x32x16_bf16 v[32:47], a[168:171], v[112:115], v[32:47]
    s_add_u32 s31, s47, 59392
    buffer_load_dwordx4 v[108:111], v8, s[4:7], s31 offen sc1
    v_mfma_f32_32x32x16_bf16 v[48:63], a[172:175], v[112:115], v[48:63]
    s_waitcnt vmcnt(15)
    v_mfma_f32_32x32x16_bf16 v[32:47], a[176:179], v[116:119], v[32:47]
    s_add_u32 s31, s47, 33792
    buffer_load_dwordx4 v[112:115], v8, s[4:7], s31 offen sc1
    v_mfma_f32_32x32x16_bf16 v[48:63], a[180:183], v[116:119], v[48:63]
    s_waitcnt vmcnt(15)
    v_mfma_f32_32x32x16_bf16 v[32:47], a[184:187], v[120:123], v[32:47]
    s_add_u32 s31, s47, 34816
    buffer_load_dwordx4 v[116:119], v8, s[4:7], s31 offen sc1
    v_mfma_f32_32x32x16_bf16 v[48:63], a[188:191], v[120:123], v[48:63]
    s_waitcnt vmcnt(15)
    s_waitcnt lgkmcnt(0)
    v_mfma_f32_32x32x16_bf16 v[32:47], v[24:27], v[124:127], v[32:47]
    s_add_u32 s31, s47, 35840
    buffer_load_dwordx4 v[120:123], v8, s[4:7], s31 offen sc1
    v_mfma_f32_32x32x16_bf16 v[48:63], v[28:31], v[124:127], v[48:63]
    ds_read_b64_tr_b16 v[16:17], v7 offset:16384
    ds_read_b64_tr_b16 v[18:19], v7 offset:17408
    ds_read_b64_tr_b16 v[20:21], v7 offset:16448
    ds_read_b64_tr_b16 v[22:23], v7 offset:17472
    s_waitcnt vmcnt(15)
    v_mfma_f32_32x32x16_bf16 v[32:47], a[192:195], v[64:67], v[32:47]
    s_add_u32 s31, s47, 60416
    buffer_load_dwordx4 v[124:127], v8, s[4:7], s31 offen sc1
    v_mfma_f32_32x32x16_bf16 v[48:63], a[196:199], v[64:67], v[48:63]
    s_waitcnt vmcnt(15)
    v_mfma_f32_32x32x16_bf16 v[32:47], a[200:203], v[68:71], v[32:47]
    s_add_u32 s31, s47, 36864
    buffer_load_dwordx4 v[64:67], v8, s[4:7], s31 offen sc1
    v_mfma_f32_32x32x16_bf16 v[48:63], a[204:207], v[68:71], v[48:63]
    s_waitcnt vmcnt(15)
    v_mfma_f32_32x32x16_bf16 v[32:47], a[208:211], v[72:75], v[32:47]
    s_add_u32 s31, s47, 37888
    buffer_load_dwordx4 v[68:71], v8, s[4:7], s31 offen sc1
    v_mfma_f32_32x32x16_bf16 v[48:63], a[212:215], v[72:75], v[48:63]
    s_waitcnt vmcnt(15)
    s_waitcnt lgkmcnt(0)
    v_mfma_f32_32x32x16_bf16 v[32:47], v[16:19], v[76:79], v[32:47]
    s_add_u32 s31, s47, 38912
    buffer_load_dwordx4 v[72:75], v8, s[4:7], s31 offen sc1
    v_mfma_f32_32x32x16_bf16 v[48:63], v[20:23], v[76:79], v[48:63]
    ds_read_b64_tr_b16 v[24:25], v7 offset:18432
    ds_read_b64_tr_b16 v[26:27], v7 offset:19456
    ds_read_b64_tr_b16 v[28:29], v7 offset:18496
    ds_read_b64_tr_b16 v[30:31], v7 offset:19520
    s_waitcnt vmcnt(15)
    v_mfma_f32_32x32x16_bf16 v[32:47], a[216:219], v[80:83], v[32:47]
    s_add_u32 s31, s47, 61440
    buffer_load_dwordx4 v[76:79], v8, s[4:7], s31 offen sc1
    v_mfma_f32_32x32x16_bf16 v[48:63], a[220:223], v[80:83], v[48:63]
    s_waitcnt vmcnt(15)
    v_mfma_f32_32x32x16_bf16 v[32:47], a[224:227], v[84:87], v[32:47]
    s_add_u32 s31, s47, 39936
    buffer_load_dwordx4 v[80:83], v8, s[4:7], s31 offen sc1
    v_mfma_f32_32x32x16_bf16 v[48:63], a[228:231], v[84:87], v[48:63]
    s_waitcnt vmcnt(15)
    v_mfma_f32_32x32x16_bf16 v[32:47], a[232:235], v[88:91], v[32:47]
    s_add_u32 s31, s47, 40960
    buffer_load_dwordx4 v[84:87], v8, s[4:7], s31 offen sc1
    v_mfma_f32_32x32x16_bf16 v[48:63], a[236:239], v[88:91], v[48:63]
    s_waitcnt vmcnt(15)
    s_waitcnt lgkmcnt(0)
    v_mfma_f32_32x32x16_bf16 v[32:47], v[24:27], v[92:95], v[32:47]
    s_add_u32 s31, s47, 41984
    buffer_load_dwordx4 v[88:91], v8, s[4:7], s31 offen sc1
    v_mfma_f32_32x32x16_bf16 v[48:63], v[28:31], v[92:95], v[48:63]
    ds_read_b64_tr_b16 v[16:17], v7 offset:20480
    ds_read_b64_tr_b16 v[18:19], v7 offset:21504
    ds_read_b64_tr_b16 v[20:21], v7 offset:20544
    ds_read_b64_tr_b16 v[22:23], v7 offset:21568
    s_waitcnt vmcnt(14)
    v_mfma_f32_32x32x16_bf16 v[32:47], a[240:243], v[96:99], v[32:47]
    s_add_u32 s31, s47, 62464
    buffer_load_dwordx4 v[92:95], v8, s[4:7], s31 offen sc1
    v_mfma_f32_32x32x16_bf16 v[48:63], a[244:247], v[96:99], v[48:63]
    s_waitcnt vmcnt(14)
    v_mfma_f32_32x32x16_bf16 v[32:47], a[248:251], v[100:103], v[32:47]
    s_add_u32 s31, s47, 43008
    buffer_load_dwordx4 v[96:99], v8, s[4:7], s31 offen sc1
    v_mfma_f32_32x32x16_bf16 v[48:63], a[252:255], v[100:103], v[48:63]
    s_waitcnt vmcnt(14)
    v_mfma_f32_32x32x16_bf16 v[32:47], v[128:131], v[104:107], v[32:47]
    s_add_u32 s31, s47, 44032
    buffer_load_dwordx4 v[100:103], v8, s[4:7], s31 offen sc1
    v_mfma_f32_32x32x16_bf16 v[48:63], v[132:135], v[104:107], v[48:63]
    s_waitcnt vmcnt(14)
    s_waitcnt lgkmcnt(0)
    v_mfma_f32_32x32x16_bf16 v[32:47], v[16:19], v[108:111], v[32:47]
    s_add_u32 s31, s47, 45056
    buffer_load_dwordx4 v[104:107], v8, s[4:7], s31 offen sc1
    v_mfma_f32_32x32x16_bf16 v[48:63], v[20:23], v[108:111], v[48:63]
    ds_read_b64_tr_b16 v[24:25], v7 offset:22528
    ds_read_b64_tr_b16 v[26:27], v7 offset:23552
    ds_read_b64_tr_b16 v[28:29], v7 offset:22592
    ds_read_b64_tr_b16 v[30:31], v7 offset:23616
    s_waitcnt vmcnt(14)
    v_mfma_f32_32x32x16_bf16 v[32:47], v[136:139], v[112:115], v[32:47]
    s_add_u32 s31, s47, 63488
    buffer_load_dwordx4 v[108:111], v8, s[4:7], s31 offen sc1
    v_mfma_f32_32x32x16_bf16 v[48:63], v[140:143], v[112:115], v[48:63]
    s_waitcnt vmcnt(14)
    v_mfma_f32_32x32x16_bf16 v[32:47], v[144:147], v[116:119], v[32:47]
    s_add_u32 s31, s47, 46080
    buffer_load_dwordx4 v[112:115], v8, s[4:7], s31 offen sc1
    v_mfma_f32_32x32x16_bf16 v[48:63], v[148:151], v[116:119], v[48:63]
    s_waitcnt vmcnt(14)
    v_mfma_f32_32x32x16_bf16 v[32:47], v[152:155], v[120:123], v[32:47]
    s_add_u32 s31, s47, 47104
    buffer_load_dwordx4 v[116:119], v8, s[4:7], s31 offen sc1
    v_mfma_f32_32x32x16_bf16 v[48:63], v[156:159], v[120:123], v[48:63]
    s_waitcnt vmcnt(14)
    s_waitcnt lgkmcnt(0)
    v_mfma_f32_32x32x16_bf16 v[32:47], v[24:27], v[124:127], v[32:47]
    s_add_u32 s31, s47, 48128
    buffer_load_dwordx4 v[120:123], v8, s[4:7], s31 offen sc1
    v_mfma_f32_32x32x16_bf16 v[48:63], v[28:31], v[124:127], v[48:63]
    ds_read_b64_tr_b16 v[16:17], v7 offset:24576
    ds_read_b64_tr_b16 v[18:19], v7 offset:25600
    ds_read_b64_tr_b16 v[20:21], v7 offset:24640
    ds_read_b64_tr_b16 v[22:23], v7 offset:25664
    s_waitcnt vmcnt(14)
    v_mfma_f32_32x32x16_bf16 v[32:47], v[160:163], v[64:67], v[32:47]
    s_add_u32 s31, s47, 64512
    buffer_load_dwordx4 v[124:127], v8, s[4:7], s31 offen sc1
    v_mfma_f32_32x32x16_bf16 v[48:63], v[164:167], v[64:67], v[48:63]
    s_waitcnt vmcnt(14)
    v_mfma_f32_32x32x16_bf16 v[32:47], v[168:171], v[68:71], v[32:47]
    v_cmp_eq_u32 vcc, 0, v13
    s_lshl_b32 s46, s35, 18
    s_add_u32 s46, s46, 67108864
    s_cmp_eq_u64 vcc, 0
    s_cselect_b32 s51, 1, 0
    s_cmp_ge_u32 s35, 64
    s_cselect_b32 s51, 0, s51
    s_cmp_eq_u32 s51, 0
    s_cselect_b32 s46, s47, s46
    s_add_u32 s31, s46, 0
    buffer_load_dwordx4 v[64:67], v8, s[4:7], s31 offen sc1
    v_mfma_f32_32x32x16_bf16 v[48:63], v[172:175], v[68:71], v[48:63]
    s_waitcnt vmcnt(14)
    v_mfma_f32_32x32x16_bf16 v[32:47], v[176:179], v[72:75], v[32:47]
    s_add_u32 s31, s46, 1024
    buffer_load_dwordx4 v[68:71], v8, s[4:7], s31 offen sc1
    v_mfma_f32_32x32x16_bf16 v[48:63], v[180:183], v[72:75], v[48:63]
    s_waitcnt vmcnt(14)
    s_waitcnt lgkmcnt(0)
    v_mfma_f32_32x32x16_bf16 v[32:47], v[16:19], v[76:79], v[32:47]
    s_add_u32 s31, s46, 2048
    buffer_load_dwordx4 v[72:75], v8, s[4:7], s31 offen sc1
    v_mfma_f32_32x32x16_bf16 v[48:63], v[20:23], v[76:79], v[48:63]
    ds_read_b64_tr_b16 v[24:25], v7 offset:26624
    ds_read_b64_tr_b16 v[26:27], v7 offset:27648
    ds_read_b64_tr_b16 v[28:29], v7 offset:26688
    ds_read_b64_tr_b16 v[30:31], v7 offset:27712
    s_waitcnt vmcnt(14)
    v_mfma_f32_32x32x16_bf16 v[32:47], v[184:187], v[80:83], v[32:47]
    s_add_u32 s31, s46, 49152
    buffer_load_dwordx4 v[76:79], v8, s[4:7], s31 offen sc1
    v_mfma_f32_32x32x16_bf16 v[48:63], v[188:191], v[80:83], v[48:63]
    s_waitcnt vmcnt(14)
    v_mfma_f32_32x32x16_bf16 v[32:47], v[192:195], v[84:87], v[32:47]
    s_add_u32 s31, s46, 3072
    buffer_load_dwordx4 v[80:83], v8, s[4:7], s31 offen sc1
    v_mfma_f32_32x32x16_bf16 v[48:63], v[196:199], v[84:87], v[48:63]
    s_waitcnt vmcnt(14)
    v_mfma_f32_32x32x16_bf16 v[32:47], v[200:203], v[88:91], v[32:47]
    s_add_u32 s31, s46, 4096
    buffer_load_dwordx4 v[84:87], v8, s[4:7], s31 offen sc1
    v_mfma_f32_32x32x16_bf16 v[48:63], v[204:207], v[88:91], v[48:63]
    s_waitcnt vmcnt(14)
    s_waitcnt lgkmcnt(0)
    v_mfma_f32_32x32x16_bf16 v[32:47], v[24:27], v[92:95], v[32:47]
    s_add_u32 s31, s46, 5120
    buffer_load_dwordx4 v[88:91], v8, s[4:7], s31 offen sc1
    v_mfma_f32_32x32x16_bf16 v[48:63], v[28:31], v[92:95], v[48:63]
    ds_read_b64_tr_b16 v[16:17], v7 offset:28672
    ds_read_b64_tr_b16 v[18:19], v7 offset:29696
    ds_read_b64_tr_b16 v[20:21], v7 offset:28736
    ds_read_b64_tr_b16 v[22:23], v7 offset:29760
    s_waitcnt vmcnt(14)
    v_mfma_f32_32x32x16_bf16 v[32:47], v[208:211], v[96:99], v[32:47]
    s_add_u32 s31, s46, 50176
    buffer_load_dwordx4 v[92:95], v8, s[4:7], s31 offen sc1
    v_mfma_f32_32x32x16_bf16 v[48:63], v[212:215], v[96:99], v[48:63]
    s_waitcnt vmcnt(14)
    v_mfma_f32_32x32x16_bf16 v[32:47], v[216:219], v[100:103], v[32:47]
    s_add_u32 s31, s46, 6144
    buffer_load_dwordx4 v[96:99], v8, s[4:7], s31 offen sc1
    v_mfma_f32_32x32x16_bf16 v[48:63], v[220:223], v[100:103], v[48:63]
    s_waitcnt vmcnt(14)
    v_mfma_f32_32x32x16_bf16 v[32:47], v[224:227], v[104:107], v[32:47]
    s_add_u32 s31, s46, 7168
    buffer_load_dwordx4 v[100:103], v8, s[4:7], s31 offen sc1
    v_mfma_f32_32x32x16_bf16 v[48:63], v[228:231], v[104:107], v[48:63]
    s_waitcnt vmcnt(14)
    s_waitcnt lgkmcnt(0)
    v_mfma_f32_32x32x16_bf16 v[32:47], v[16:19], v[108:111], v[32:47]
    s_add_u32 s31, s46, 8192
    buffer_load_dwordx4 v[104:107], v8, s[4:7], s31 offen sc1
    v_mfma_f32_32x32x16_bf16 v[48:63], v[20:23], v[108:111], v[48:63]
    ds_read_b64_tr_b16 v[24:25], v7 offset:30720
    ds_read_b64_tr_b16 v[26:27], v7 offset:31744
    ds_read_b64_tr_b16 v[28:29], v7 offset:30784
    ds_read_b64_tr_b16 v[30:31], v7 offset:31808
    s_waitcnt vmcnt(14)
    v_mfma_f32_32x32x16_bf16 v[32:47], v[232:235], v[112:115], v[32:47]
    s_add_u32 s31, s46, 51200
    buffer_load_dwordx4 v[108:111], v8, s[4:7], s31 offen sc1
    v_mfma_f32_32x32x16_bf16 v[48:63], v[236:239], v[112:115], v[48:63]
    s_waitcnt vmcnt(14)
    v_mfma_f32_32x32x16_bf16 v[32:47], v[240:243], v[116:119], v[32:47]
    s_add_u32 s31, s46, 9216
    buffer_load_dwordx4 v[112:115], v8, s[4:7], s31 offen sc1
    v_mfma_f32_32x32x16_bf16 v[48:63], v[244:247], v[116:119], v[48:63]
    s_waitcnt vmcnt(14)
    v_mfma_f32_32x32x16_bf16 v[32:47], v[248:251], v[120:123], v[32:47]
    s_add_u32 s31, s46, 10240
    buffer_load_dwordx4 v[116:119], v8, s[4:7], s31 offen sc1
    v_mfma_f32_32x32x16_bf16 v[48:63], v[252:255], v[120:123], v[48:63]
    s_waitcnt vmcnt(14)
    s_waitcnt lgkmcnt(0)
    v_mfma_f32_32x32x16_bf16 v[32:47], v[24:27], v[124:127], v[32:47]
    s_add_u32 s31, s46, 11264
    buffer_load_dwordx4 v[120:123], v8, s[4:7], s31 offen sc1
    v_mfma_f32_32x32x16_bf16 v[48:63], v[28:31], v[124:127], v[48:63]
    s_barrier
    s_nop 7
    ds_write_b128 v9, v[32:35] offset:0
    ds_write_b128 v9, v[36:39] offset:1024
    ds_write_b128 v9, v[40:43] offset:2048
    ds_write_b128 v9, v[44:47] offset:3072
    ds_write_b128 v9, v[48:51] offset:4096
    ds_write_b128 v9, v[52:55] offset:5120
    ds_write_b128 v9, v[56:59] offset:6144
    ds_write_b128 v9, v[60:63] offset:7168
    s_waitcnt lgkmcnt(0)
    s_barrier
    ds_read_b128 v[32:35], v10 offset:0
    ds_read_b128 v[36:39], v10 offset:8192
    ds_read_b128 v[40:43], v10 offset:16384
    ds_read_b128 v[44:47], v10 offset:24576
    ds_read_b128 v[48:51], v10 offset:4096
    ds_read_b128 v[52:55], v10 offset:12288
    ds_read_b128 v[56:59], v10 offset:20480
    ds_read_b128 v[60:63], v10 offset:28672
    s_waitcnt lgkmcnt(4)
    v_pk_add_f32 v[32:33], v[32:33], v[36:37]
    v_pk_add_f32 v[34:35], v[34:35], v[38:39]
    v_pk_add_f32 v[40:41], v[40:41], v[44:45]
    v_pk_add_f32 v[42:43], v[42:43], v[46:47]
    v_pk_add_f32 v[32:33], v[32:33], v[40:41]
    v_pk_add_f32 v[34:35], v[34:35], v[42:43]
    v_cvt_pk_bf16_f32 v24, v32, v33
    v_cvt_pk_bf16_f32 v25, v34, v35
    buffer_store_dwordx2 v[24:25], v11, s[20:23], s49 offen offset:0
    s_waitcnt lgkmcnt(0)
    v_pk_add_f32 v[48:49], v[48:49], v[52:53]
    v_pk_add_f32 v[50:51], v[50:51], v[54:55]
    v_pk_add_f32 v[56:57], v[56:57], v[60:61]
    v_pk_add_f32 v[58:59], v[58:59], v[62:63]
    v_pk_add_f32 v[48:49], v[48:49], v[56:57]
    v_pk_add_f32 v[50:51], v[50:51], v[58:59]
    v_cvt_pk_bf16_f32 v26, v48, v49
    v_cvt_pk_bf16_f32 v27, v50, v51
    buffer_store_dwordx2 v[26:27], v11, s[20:23], s49 offen offset:64
    s_mov_b32 s30, s35
    s_mov_b32 s47, s46
    s_cmp_lg_u32 s51, 0
    s_cbranch_scc1 o6_go_99
    s_cmp_lt_u32 s30, 64
    s_cbranch_scc1 o6_loop_98
    s_branch L_dump
L_ob:
    s_load_dwordx4 s[72:75], s[0:1], 72
    s_add_u32 s76, s90, 83886080
    s_addc_u32 s77, s91, 0
    s_sub_u32 s32, s28, 96
    s_lshr_b32 s32, s32, 3
    s_mul_i32 s30, s32, 22
    s_add_u32 s51, s30, 22
    s_min_u32 s51, s51, 64
    s_sub_u32 s52, s51, 1
    s_lshl_b32 s52, s52, 16
    s_waitcnt lgkmcnt(0)
    s_mov_b32 s8, s72
    s_and_b32 s9, s73, 0xffff
    s_mov_b32 s10, 2097152
    s_mov_b32 s11, 0x00020000
    s_mov_b32 s20, s74
    s_and_b32 s21, s75, 0xffff
    s_mov_b32 s22, 8388608
    s_mov_b32 s23, 0x00020000
    s_mov_b32 s12, s76
    s_and_b32 s13, s77, 0xffff
    s_mov_b32 s14, 4194304
    s_mov_b32 s15, 0x00020000
    s_and_b32 s31, s28, 7
    s_lshl_b32 s31, s31, 8
    s_lshl_b32 s33, s29, 6
    s_add_u32 s31, s31, s33
    v_lshrrev_b32 v6, 2, v1
    v_lshlrev_b32 v6, 11, v6
    v_and_b32 v4, 3, v1
    v_lshl_add_u32 v6, v4, 4, v6
    v_add_u32 v6, s31, v6
    s_mov_b32 s39, 32768
    s_lshl_b32 s36, s30, 17
    s_and_b32 s33, s28, 7
    s_lshl_b32 s33, s33, 8
    s_add_u32 s36, s36, s33
    s_add_u32 s36, s36, 2048
    s_mov_b32 s37, 131072
    s_lshl_b32 s31, s29, 15
    v_lshrrev_b32 v7, 4, v1
    v_lshlrev_b32 v7, 9, v7
    v_bfe_u32 v4, v1, 2, 2
    v_lshl_add_u32 v7, v4, 6, v7
    v_and_b32 v4, 3, v1
    v_lshl_add_u32 v7, v4, 4, v7
    v_add_u32 v7, s31, v7
    s_lshl_b32 s32, s29, 15
    s_add_u32 m0, s32, 0
    s_mov_b32 s38, 0
    buffer_load_dwordx4 v6, s[8:11], s38 offen lds
    s_add_u32 m0, s32, 1024
    s_add_u32 s38, s38, s39
    buffer_load_dwordx4 v6, s[8:11], s38 offen lds
    s_add_u32 m0, s32, 2048
    s_add_u32 s38, s38, s39
    buffer_load_dwordx4 v6, s[8:11], s38 offen lds
    s_add_u32 m0, s32, 3072
    s_add_u32 s38, s38, s39
    buffer_load_dwordx4 v6, s[8:11], s38 offen lds
    s_add_u32 m0, s32, 4096
    s_add_u32 s38, s38, s39
    buffer_load_dwordx4 v6, s[8:11], s38 offen lds
    s_add_u32 m0, s32, 5120
    s_add_u32 s38, s38, s39
    buffer_load_dwordx4 v6, s[8:11], s38 offen lds
    s_add_u32 m0, s32, 6144
    s_add_u32 s38, s38, s39
    buffer_load_dwordx4 v6, s[8:11], s38 offen lds
    s_add_u32 m0, s32, 7168
    s_add_u32 s38, s38, s39
    buffer_load_dwordx4 v6, s[8:11], s38 offen lds
    s_add_u32 m0, s32, 8192
    s_add_u32 s38, s38, s39
    buffer_load_dwordx4 v6, s[8:11], s38 offen lds
    s_add_u32 m0, s32, 9216
    s_add_u32 s38, s38, s39
    buffer_load_dwordx4 v6, s[8:11], s38 offen lds
    s_add_u32 m0, s32, 10240
    s_add_u32 s38, s38, s39
    buffer_load_dwordx4 v6, s[8:11], s38 offen lds
    s_add_u32 m0, s32, 11264
    s_add_u32 s38, s38, s39
    buffer_load_dwordx4 v6, s[8:11], s38 offen lds
    s_add_u32 m0, s32, 12288
    s_add_u32 s38, s38, s39
    buffer_load_dwordx4 v6, s[8:11], s38 offen lds
    s_add_u32 m0, s32, 13312
    s_add_u32 s38, s38, s39
    buffer_load_dwordx4 v6, s[8:11], s38 offen lds
    s_add_u32 m0, s32, 14336
    s_add_u32 s38, s38, s39
    buffer_load_dwordx4 v6, s[8:11], s38 offen lds
    s_add_u32 m0, s32, 15360
    s_add_u32 s38, s38, s39
    buffer_load_dwordx4 v6, s[8:11], s38 offen lds
    s_add_u32 m0, s32, 16384
    s_add_u32 s38, s38, s39
    buffer_load_dwordx4 v6, s[8:11], s38 offen lds
    s_add_u32 m0, s32, 17408
    s_add_u32 s38, s38, s39
    buffer_load_dwordx4 v6, s[8:11], s38 offen lds
    s_add_u32 m0, s32, 18432
    s_add_u32 s38, s38, s39
    buffer_load_dwordx4 v6, s[8:11], s38 offen lds
    s_add_u32 m0, s32, 19456
    s_add_u32 s38, s38, s39
    buffer_load_dwordx4 v6, s[8:11], s38 offen lds
    s_add_u32 m0, s32, 20480
    s_add_u32 s38, s38, s39
    buffer_load_dwordx4 v6, s[8:11], s38 offen lds
    s_add_u32 m0, s32, 21504
    s_add_u32 s38, s38, s39
    buffer_load_dwordx4 v6, s[8:11], s38 offen lds
    s_add_u32 m0, s32, 22528
    s_add_u32 s38, s38, s39
    buffer_load_dwordx4 v6, s[8:11], s38 offen lds
    s_add_u32 m0, s32, 23552
    s_add_u32 s38, s38, s39
    buffer_load_dwordx4 v6, s[8:11], s38 offen lds
    s_add_u32 m0, s32, 24576
    s_add_u32 s38, s38, s39
    buffer_load_dwordx4 v6, s[8:11], s38 offen lds
    s_add_u32 m0, s32, 25600
    s_add_u32 s38, s38, s39
    buffer_load_dwordx4 v6, s[8:11], s38 offen lds
    s_add_u32 m0, s32, 26624
    s_add_u32 s38, s38, s39
    buffer_load_dwordx4 v6, s[8:11], s38 offen lds
    s_add_u32 m0, s32, 27648
    s_add_u32 s38, s38, s39
    buffer_load_dwordx4 v6, s[8:11], s38 offen lds
    s_add_u32 m0, s32, 28672
    s_add_u32 s38, s38, s39
    buffer_load_dwordx4 v6, s[8:11], s38 offen lds
    s_add_u32 m0, s32, 29696
    s_add_u32 s38, s38, s39
    buffer_load_dwordx4 v6, s[8:11], s38 offen lds
    s_add_u32 m0, s32, 30720
    s_add_u32 s38, s38, s39
    buffer_load_dwordx4 v6, s[8:11], s38 offen lds
    s_add_u32 m0, s32, 31744
    s_add_u32 s38, s38, s39
    buffer_load_dwordx4 v6, s[8:11], s38 offen lds
    s_waitcnt vmcnt(30)
    ds_read_b64_tr_b16 a[0:1], v7 offset:0
    ds_read_b64_tr_b16 a[2:3], v7 offset:256
    ds_read_b64_tr_b16 a[4:5], v7 offset:8
    ds_read_b64_tr_b16 a[6:7], v7 offset:264
    s_waitcnt vmcnt(28)
    ds_read_b64_tr_b16 a[8:9], v7 offset:2048
    ds_read_b64_tr_b16 a[10:11], v7 offset:2304
    ds_read_b64_tr_b16 a[12:13], v7 offset:2056
    ds_read_b64_tr_b16 a[14:15], v7 offset:2312
    s_waitcnt lgkmcnt(4)
    s_add_u32 m0, s32, 0
    s_add_u32 s38, s38, s39
    buffer_load_dwordx4 v6, s[8:11], s38 offen lds
    s_add_u32 m0, s32, 1024
    s_add_u32 s38, s38, s39
    buffer_load_dwordx4 v6, s[8:11], s38 offen lds
    s_waitcnt vmcnt(28)
    ds_read_b64_tr_b16 a[16:17], v7 offset:4096
    ds_read_b64_tr_b16 a[18:19], v7 offset:4352
    ds_read_b64_tr_b16 a[20:21], v7 offset:4104
    ds_read_b64_tr_b16 a[22:23], v7 offset:4360
    s_waitcnt lgkmcnt(4)
    s_add_u32 m0, s32, 2048
    s_add_u32 s38, s38, s39
    buffer_load_dwordx4 v6, s[8:11], s38 offen lds
    s_add_u32 m0, s32, 3072
    s_add_u32 s38, s38, s39
    buffer_load_dwordx4 v6, s[8:11], s38 offen lds
    s_waitcnt vmcnt(28)
    ds_read_b64_tr_b16 a[24:25], v7 offset:6144
    ds_read_b64_tr_b16 a[26:27], v7 offset:6400
    ds_read_b64_tr_b16 a[28:29], v7 offset:6152
    ds_read_b64_tr_b16 a[30:31], v7 offset:6408
    s_waitcnt lgkmcnt(4)
    s_add_u32 m0, s32, 4096
    s_add_u32 s38, s38, s39
    buffer_load_dwordx4 v6, s[8:11], s38 offen lds
    s_add_u32 m0, s32, 5120
    s_add_u32 s38, s38, s39
    buffer_load_dwordx4 v6, s[8:11], s38 offen lds
    s_waitcnt vmcnt(28)
    ds_read_b64_tr_b16 a[32:33], v7 offset:8192
    ds_read_b64_tr_b16 a[34:35], v7 offset:8448
    ds_read_b64_tr_b16 a[36:37], v7 offset:8200
    ds_read_b64_tr_b16 a[38:39], v7 offset:8456
    s_waitcnt lgkmcnt(4)
    s_add_u32 m0, s32, 6144
    s_add_u32 s38, s38, s39
    buffer_load_dwordx4 v6, s[8:11], s38 offen lds
    s_add_u32 m0, s32, 7168
    s_add_u32 s38, s38, s39
    buffer_load_dwordx4 v6, s[8:11], s38 offen lds
    s_waitcnt vmcnt(28)
    ds_read_b64_tr_b16 a[40:41], v7 offset:10240
    ds_read_b64_tr_b16 a[42:43], v7 offset:10496
    ds_read_b64_tr_b16 a[44:45], v7 offset:10248
    ds_read_b64_tr_b16 a[46:47], v7 offset:10504
    s_waitcnt lgkmcnt(4)
    s_add_u32 m0, s32, 8192
    s_add_u32 s38, s38, s39
    buffer_load_dwordx4 v6, s[8:11], s38 offen lds
    s_add_u32 m0, s32, 9216
    s_add_u32 s38, s38, s39
    buffer_load_dwordx4 v6, s[8:11], s38 offen lds
    s_waitcnt vmcnt(28)
    ds_read_b64_tr_b16 a[48:49], v7 offset:12288
    ds_read_b64_tr_b16 a[50:51], v7 offset:12544
    ds_read_b64_tr_b16 a[52:53], v7 offset:12296
    ds_read_b64_tr_b16 a[54:55], v7 offset:12552
    s_waitcnt lgkmcnt(4)
    s_add_u32 m0, s32, 10240
    s_add_u32 s38, s38, s39
    buffer_load_dwordx4 v6, s[8:11], s38 offen lds
    s_add_u32 m0, s32, 11264
    s_add_u32 s38, s38, s39
    buffer_load_dwordx4 v6, s[8:11], s38 offen lds
    s_waitcnt vmcnt(28)
    ds_read_b64_tr_b16 a[56:57], v7 offset:14336
    ds_read_b64_tr_b16 a[58:59], v7 offset:14592
    ds_read_b64_tr_b16 a[60:61], v7 offset:14344
    ds_read_b64_tr_b16 a[62:63], v7 offset:14600
    s_waitcnt lgkmcnt(4)
    s_add_u32 m0, s32, 12288
    s_add_u32 s38, s38, s39
    buffer_load_dwordx4 v6, s[8:11], s38 offen lds
    s_add_u32 m0, s32, 13312
    s_add_u32 s38, s38, s39
    buffer_load_dwordx4 v6, s[8:11], s38 offen lds
    s_waitcnt vmcnt(28)
    ds_read_b64_tr_b16 a[64:65], v7 offset:16384
    ds_read_b64_tr_b16 a[66:67], v7 offset:16640
    ds_read_b64_tr_b16 a[68:69], v7 offset:16392
    ds_read_b64_tr_b16 a[70:71], v7 offset:16648
    s_waitcnt lgkmcnt(4)
    s_add_u32 m0, s32, 14336
    s_add_u32 s38, s38, s39
    buffer_load_dwordx4 v6, s[8:11], s38 offen lds
    s_add_u32 m0, s32, 15360
    s_add_u32 s38, s38, s39
    buffer_load_dwordx4 v6, s[8:11], s38 offen lds
    s_waitcnt vmcnt(28)
    ds_read_b64_tr_b16 a[72:73], v7 offset:18432
    ds_read_b64_tr_b16 a[74:75], v7 offset:18688
    ds_read_b64_tr_b16 a[76:77], v7 offset:18440
    ds_read_b64_tr_b16 a[78:79], v7 offset:18696
    s_waitcnt lgkmcnt(4)
    s_add_u32 m0, s32, 16384
    s_add_u32 s38, s38, s39
    buffer_load_dwordx4 v6, s[8:11], s38 offen lds
    s_add_u32 m0, s32, 17408
    s_add_u32 s38, s38, s39
    buffer_load_dwordx4 v6, s[8:11], s38 offen lds
    s_waitcnt vmcnt(28)
    ds_read_b64_tr_b16 a[80:81], v7 offset:20480
    ds_read_b64_tr_b16 a[82:83], v7 offset:20736
    ds_read_b64_tr_b16 a[84:85], v7 offset:20488
    ds_read_b64_tr_b16 a[86:87], v7 offset:20744
    s_waitcnt lgkmcnt(4)
    s_add_u32 m0, s32, 18432
    s_add_u32 s38, s38, s39
    buffer_load_dwordx4 v6, s[8:11], s38 offen lds
    s_add_u32 m0, s32, 19456
    s_add_u32 s38, s38, s39
    buffer_load_dwordx4 v6, s[8:11], s38 offen lds
    s_waitcnt vmcnt(28)
    ds_read_b64_tr_b16 a[88:89], v7 offset:22528
    ds_read_b64_tr_b16 a[90:91], v7 offset:22784
    ds_read_b64_tr_b16 a[92:93], v7 offset:22536
    ds_read_b64_tr_b16 a[94:95], v7 offset:22792
    s_waitcnt lgkmcnt(4)
    s_add_u32 m0, s32, 20480
    s_add_u32 s38, s38, s39
    buffer_load_dwordx4 v6, s[8:11], s38 offen lds
    s_add_u32 m0, s32, 21504
    s_add_u32 s38, s38, s39
    buffer_load_dwordx4 v6, s[8:11], s38 offen lds
    s_waitcnt vmcnt(28)
    ds_read_b64_tr_b16 a[96:97], v7 offset:24576
    ds_read_b64_tr_b16 a[98:99], v7 offset:24832
    ds_read_b64_tr_b16 a[100:101], v7 offset:24584
    ds_read_b64_tr_b16 a[102:103], v7 offset:24840
    s_waitcnt lgkmcnt(4)
    s_add_u32 m0, s32, 22528
    s_add_u32 s38, s38, s39
    buffer_load_dwordx4 v6, s[8:11], s38 offen lds
    s_add_u32 m0, s32, 23552
    s_add_u32 s38, s38, s39
    buffer_load_dwordx4 v6, s[8:11], s38 offen lds
    s_waitcnt vmcnt(28)
    ds_read_b64_tr_b16 a[104:105], v7 offset:26624
    ds_read_b64_tr_b16 a[106:107], v7 offset:26880
    ds_read_b64_tr_b16 a[108:109], v7 offset:26632
    ds_read_b64_tr_b16 a[110:111], v7 offset:26888
    s_waitcnt lgkmcnt(4)
    s_add_u32 m0, s32, 24576
    s_add_u32 s38, s38, s39
    buffer_load_dwordx4 v6, s[8:11], s38 offen lds
    s_add_u32 m0, s32, 25600
    s_add_u32 s38, s38, s39
    buffer_load_dwordx4 v6, s[8:11], s38 offen lds
    s_waitcnt vmcnt(28)
    ds_read_b64_tr_b16 a[112:113], v7 offset:28672
    ds_read_b64_tr_b16 a[114:115], v7 offset:28928
    ds_read_b64_tr_b16 a[116:117], v7 offset:28680
    ds_read_b64_tr_b16 a[118:119], v7 offset:28936
    s_waitcnt lgkmcnt(4)
    s_add_u32 m0, s32, 26624
    s_add_u32 s38, s38, s39
    buffer_load_dwordx4 v6, s[8:11], s38 offen lds
    s_add_u32 m0, s32, 27648
    s_add_u32 s38, s38, s39
    buffer_load_dwordx4 v6, s[8:11], s38 offen lds
    s_waitcnt vmcnt(28)
    ds_read_b64_tr_b16 a[120:121], v7 offset:30720
    ds_read_b64_tr_b16 a[122:123], v7 offset:30976
    ds_read_b64_tr_b16 a[124:125], v7 offset:30728
    ds_read_b64_tr_b16 a[126:127], v7 offset:30984
    s_waitcnt lgkmcnt(4)
    s_add_u32 m0, s32, 28672
    s_add_u32 s38, s38, s39
    buffer_load_dwordx4 v6, s[8:11], s38 offen lds
    s_add_u32 m0, s32, 29696
    s_add_u32 s38, s38, s39
    buffer_load_dwordx4 v6, s[8:11], s38 offen lds
    s_waitcnt vmcnt(28)
    ds_read_b64_tr_b16 a[128:129], v7 offset:0
    ds_read_b64_tr_b16 a[130:131], v7 offset:256
    ds_read_b64_tr_b16 a[132:133], v7 offset:8
    ds_read_b64_tr_b16 a[134:135], v7 offset:264
    s_waitcnt lgkmcnt(4)
    s_add_u32 m0, s32, 30720
    s_add_u32 s38, s38, s39
    buffer_load_dwordx4 v6, s[8:11], s38 offen lds
    s_add_u32 m0, s32, 31744
    s_add_u32 s38, s38, s39
    buffer_load_dwordx4 v6, s[8:11], s38 offen lds
    s_waitcnt vmcnt(28)
    ds_read_b64_tr_b16 a[136:137], v7 offset:2048
    ds_read_b64_tr_b16 a[138:139], v7 offset:2304
    ds_read_b64_tr_b16 a[140:141], v7 offset:2056
    ds_read_b64_tr_b16 a[142:143], v7 offset:2312
    s_waitcnt vmcnt(26)
    ds_read_b64_tr_b16 a[144:145], v7 offset:4096
    ds_read_b64_tr_b16 a[146:147], v7 offset:4352
    ds_read_b64_tr_b16 a[148:149], v7 offset:4104
    ds_read_b64_tr_b16 a[150:151], v7 offset:4360
    s_waitcnt vmcnt(24)
    ds_read_b64_tr_b16 a[152:153], v7 offset:6144
    ds_read_b64_tr_b16 a[154:155], v7 offset:6400
    ds_read_b64_tr_b16 a[156:157], v7 offset:6152
    ds_read_b64_tr_b16 a[158:159], v7 offset:6408
    s_waitcnt vmcnt(22)
    ds_read_b64_tr_b16 a[160:161], v7 offset:8192
    ds_read_b64_tr_b16 a[162:163], v7 offset:8448
    ds_read_b64_tr_b16 a[164:165], v7 offset:8200
    ds_read_b64_tr_b16 a[166:167], v7 offset:8456
    s_waitcnt vmcnt(20)
    ds_read_b64_tr_b16 a[168:169], v7 offset:10240
    ds_read_b64_tr_b16 a[170:171], v7 offset:10496
    ds_read_b64_tr_b16 a[172:173], v7 offset:10248
    ds_read_b64_tr_b16 a[174:175], v7 offset:10504
    s_waitcnt vmcnt(18)
    ds_read_b64_tr_b16 a[176:177], v7 offset:12288
    ds_read_b64_tr_b16 a[178:179], v7 offset:12544
    ds_read_b64_tr_b16 a[180:181], v7 offset:12296
    ds_read_b64_tr_b16 a[182:183], v7 offset:12552
    s_waitcnt vmcnt(16)
    ds_read_b64_tr_b16 a[184:185], v7 offset:14336
    ds_read_b64_tr_b16 a[186:187], v7 offset:14592
    ds_read_b64_tr_b16 a[188:189], v7 offset:14344
    ds_read_b64_tr_b16 a[190:191], v7 offset:14600
    s_waitcnt vmcnt(14)
    ds_read_b64_tr_b16 a[192:193], v7 offset:16384
    ds_read_b64_tr_b16 a[194:195], v7 offset:16640
    ds_read_b64_tr_b16 a[196:197], v7 offset:16392
    ds_read_b64_tr_b16 a[198:199], v7 offset:16648
    s_waitcnt vmcnt(12)
    ds_read_b64_tr_b16 a[200:201], v7 offset:18432
    ds_read_b64_tr_b16 a[202:203], v7 offset:18688
    ds_read_b64_tr_b16 a[204:205], v7 offset:18440
    ds_read_b64_tr_b16 a[206:207], v7 offset:18696
    s_waitcnt vmcnt(10)
    ds_read_b64_tr_b16 a[208:209], v7 offset:20480
    ds_read_b64_tr_b16 a[210:211], v7 offset:20736
    ds_read_b64_tr_b16 a[212:213], v7 offset:20488
    ds_read_b64_tr_b16 a[214:215], v7 offset:20744
    s_waitcnt vmcnt(8)
    ds_read_b64_tr_b16 a[216:217], v7 offset:22528
    ds_read_b64_tr_b16 a[218:219], v7 offset:22784
    ds_read_b64_tr_b16 a[220:221], v7 offset:22536
    ds_read_b64_tr_b16 a[222:223], v7 offset:22792
    s_waitcnt vmcnt(6)
    ds_read_b64_tr_b16 a[224:225], v7 offset:24576
    ds_read_b64_tr_b16 a[226:227], v7 offset:24832
    ds_read_b64_tr_b16 a[228:229], v7 offset:24584
    ds_read_b64_tr_b16 a[230:231], v7 offset:24840
    s_waitcnt vmcnt(4)
    ds_read_b64_tr_b16 a[232:233], v7 offset:26624
    ds_read_b64_tr_b16 a[234:235], v7 offset:26880
    ds_read_b64_tr_b16 a[236:237], v7 offset:26632
    ds_read_b64_tr_b16 a[238:239], v7 offset:26888
    s_waitcnt vmcnt(2)
    ds_read_b64_tr_b16 a[240:241], v7 offset:28672
    ds_read_b64_tr_b16 a[242:243], v7 offset:28928
    ds_read_b64_tr_b16 a[244:245], v7 offset:28680
    ds_read_b64_tr_b16 a[246:247], v7 offset:28936
    s_waitcnt vmcnt(0)
    ds_read_b64_tr_b16 a[248:249], v7 offset:30720
    ds_read_b64_tr_b16 a[250:251], v7 offset:30976
    ds_read_b64_tr_b16 a[252:253], v7 offset:30728
    ds_read_b64_tr_b16 a[254:255], v7 offset:30984
    s_waitcnt lgkmcnt(0)
    s_lshr_b32 s31, s29, 1
    s_and_b32 s31, s31, 1
    s_lshl_b32 s31, s31, 2
    v_lshrrev_b32 v2, 4, v1
    v_add_u32 v2, s31, v2
    v_and_b32 v3, 7, v1
    v_xor_b32 v2, v2, v3
    s_lshl_b32 s31, s29, 14
    v_lshrrev_b32 v8, 3, v1
    v_lshlrev_b32 v8, 11, v8
    v_add_u32 v8, s31, v8
    v_lshl_add_u32 v8, v2, 4, v8
    v_bfe_u32 v2, v1, 1, 3
    v_lshrrev_b32 v3, 4, v1
    v_xor_b32 v2, v2, v3
    v_bfe_u32 v3, v1, 3, 1
    v_lshlrev_b32 v3, 11, v3
    v_and_b32 v4, 7, v1
    v_lshl_add_u32 v3, v4, 7, v3
    v_xor_b32 v12, 0, v2
    v_lshl_add_u32 v12, v12, 4, v3
    v_add_u32 v14, 65536, v12
    v_xor_b32 v13, 4, v2
    v_lshl_add_u32 v13, v13, 4, v3
    v_add_u32 v15, 65536, v13
    s_lshl_b32 s31, s29, 6
    v_and_b32 v9, 15, v1
    v_lshlrev_b32 v9, 12, v9
    v_lshrrev_b32 v4, 4, v1
    v_lshl_add_u32 v9, v4, 4, v9
    v_add_u32 v9, s31, v9
    v_add_u32 v8, s34, v5
    v_lshrrev_b32 v12, 4, v1
    v_lshlrev_b32 v12, 9, v12
    v_and_b32 v4, 15, v1
    v_lshl_add_u32 v12, v4, 4, v12
    v_add_u32 v14, 65536, v12
    s_cmp_lg_u32 s29, 0
    s_cbranch_scc1 g_wdd_105
g_wd_104:
    s_load_dword s72, s[92:93], 0 glc
    s_add_u32 s41, s41, 1
    s_cmp_ge_u32 s41, 0x200000
    s_cbranch_scc1 g_wdd_105
    s_waitcnt lgkmcnt(0)
    s_cmp_ge_u32 s72, 352
    s_cbranch_scc1 g_wdd_105
    s_sleep 32
    s_branch g_wd_104
g_wdd_105:
    s_waitcnt lgkmcnt(0)
    s_barrier
    v_and_b32 v2, 31, v1
    v_lshlrev_b32 v2, 7, v2
    v_add_u32 v2, 115359744, v2
    s_cmp_lg_u32 s29, 0
    s_cbranch_scc1 g_wld_107
g_wl_106:
    buffer_load_dword v3, v2, s[4:7], 0 offen sc1
    s_add_u32 s41, s41, 1
    s_cmp_ge_u32 s41, 0x200000
    s_cbranch_scc1 g_wld_107
    s_waitcnt vmcnt(0)
    v_cmp_gt_u32 vcc, s51, v3
    s_cbranch_vccz g_wld_107
    s_sleep 8
    s_branch g_wl_106
g_wld_107:
    s_barrier
    s_lshl_b32 s35, s30, 16
    s_sub_u32 s36, s36, s37
    s_barrier
    s_add_u32 m0, s34, 0
    s_add_u32 s32, s35, 0
    buffer_load_dwordx4 v8, s[12:15], s32 offen sc1 lds
    s_add_u32 m0, s34, 4096
    s_add_u32 s32, s35, 4096
    buffer_load_dwordx4 v8, s[12:15], s32 offen sc1 lds
    s_add_u32 m0, s34, 8192
    s_add_u32 s32, s35, 8192
    buffer_load_dwordx4 v8, s[12:15], s32 offen sc1 lds
    s_add_u32 m0, s34, 12288
    s_add_u32 s32, s35, 12288
    buffer_load_dwordx4 v8, s[12:15], s32 offen sc1 lds
    s_add_u32 m0, s34, 16384
    s_add_u32 s32, s35, 16384
    buffer_load_dwordx4 v8, s[12:15], s32 offen sc1 lds
    s_add_u32 m0, s34, 20480
    s_add_u32 s32, s35, 20480
    buffer_load_dwordx4 v8, s[12:15], s32 offen sc1 lds
    s_add_u32 m0, s34, 24576
    s_add_u32 s32, s35, 24576
    buffer_load_dwordx4 v8, s[12:15], s32 offen sc1 lds
    s_add_u32 m0, s34, 28672
    s_add_u32 s32, s35, 28672
    buffer_load_dwordx4 v8, s[12:15], s32 offen sc1 lds
    s_add_u32 m0, s34, 32768
    s_add_u32 s32, s35, 32768
    buffer_load_dwordx4 v8, s[12:15], s32 offen sc1 lds
    s_add_u32 m0, s34, 36864
    s_add_u32 s32, s35, 36864
    buffer_load_dwordx4 v8, s[12:15], s32 offen sc1 lds
    s_add_u32 m0, s34, 40960
    s_add_u32 s32, s35, 40960
    buffer_load_dwordx4 v8, s[12:15], s32 offen sc1 lds
    s_add_u32 m0, s34, 45056
    s_add_u32 s32, s35, 45056
    buffer_load_dwordx4 v8, s[12:15], s32 offen sc1 lds
    s_add_u32 m0, s34, 49152
    s_add_u32 s32, s35, 49152
    buffer_load_dwordx4 v8, s[12:15], s32 offen sc1 lds
    s_add_u32 m0, s34, 53248
    s_add_u32 s32, s35, 53248
    buffer_load_dwordx4 v8, s[12:15], s32 offen sc1 lds
    s_add_u32 m0, s34, 57344
    s_add_u32 s32, s35, 57344
    buffer_load_dwordx4 v8, s[12:15], s32 offen sc1 lds
    s_add_u32 m0, s34, 61440
    s_add_u32 s32, s35, 61440
    buffer_load_dwordx4 v8, s[12:15], s32 offen sc1 lds
    s_add_u32 s35, s35, 65536
    s_add_u32 m0, s34, 65536
    s_add_u32 s32, s35, 0
    buffer_load_dwordx4 v8, s[12:15], s32 offen sc1 lds
    s_add_u32 m0, s34, 69632
    s_add_u32 s32, s35, 4096
    buffer_load_dwordx4 v8, s[12:15], s32 offen sc1 lds
    s_add_u32 m0, s34, 73728
    s_add_u32 s32, s35, 8192
    buffer_load_dwordx4 v8, s[12:15], s32 offen sc1 lds
    s_add_u32 m0, s34, 77824
    s_add_u32 s32, s35, 12288
    buffer_load_dwordx4 v8, s[12:15], s32 offen sc1 lds
    s_waitcnt vmcnt(12)
    s_barrier
    ds_read_b128 v[32:35], v12 offset:0
    ds_read_b128 v[36:39], v12 offset:256
    ds_read_b128 v[40:43], v12 offset:2048
    ds_read_b128 v[44:47], v12 offset:2304
    ds_read_b128 v[48:51], v12 offset:4096
    ds_read_b128 v[52:55], v12 offset:4352
    v_add_u32 v9, 2130706432, v9
sl_loop_110:
    s_waitcnt lgkmcnt(4)
    v_mfma_f32_16x16x32_bf16 v[64:67], a[0:3], v[32:35], 0
    ds_read_b128 v[56:59], v12 offset:6144
    v_mfma_f32_16x16x32_bf16 v[68:71], a[4:7], v[32:35], 0
    v_mfma_f32_16x16x32_bf16 v[72:75], a[0:3], v[36:39], 0
    ds_read_b128 v[60:63], v12 offset:6400
    s_add_u32 m0, s34, 81920
    s_add_u32 s32, s35, 16384
    v_mfma_f32_16x16x32_bf16 v[76:79], a[4:7], v[36:39], 0
    buffer_load_dwordx4 v8, s[12:15], s32 offen sc1 lds
    s_waitcnt lgkmcnt(4)
    v_mfma_f32_16x16x32_bf16 v[64:67], a[8:11], v[40:43], v[64:67]
    ds_read_b128 v[32:35], v12 offset:8192
    v_mfma_f32_16x16x32_bf16 v[68:71], a[12:15], v[40:43], v[68:71]
    v_mfma_f32_16x16x32_bf16 v[72:75], a[8:11], v[44:47], v[72:75]
    ds_read_b128 v[36:39], v12 offset:8448
    v_mfma_f32_16x16x32_bf16 v[76:79], a[12:15], v[44:47], v[76:79]
    s_waitcnt lgkmcnt(4)
    v_mfma_f32_16x16x32_bf16 v[64:67], a[16:19], v[48:51], v[64:67]
    ds_read_b128 v[40:43], v12 offset:10240
    v_mfma_f32_16x16x32_bf16 v[68:71], a[20:23], v[48:51], v[68:71]
    v_cvt_pk_bf16_f32 v96, v80, v81
    v_mfma_f32_16x16x32_bf16 v[72:75], a[16:19], v[52:55], v[72:75]
    ds_read_b128 v[44:47], v12 offset:10496
    s_add_u32 m0, s34, 86016
    s_add_u32 s32, s35, 20480
    v_mfma_f32_16x16x32_bf16 v[76:79], a[20:23], v[52:55], v[76:79]
    buffer_load_dwordx4 v8, s[12:15], s32 offen sc1 lds
    v_cvt_pk_bf16_f32 v97, v82, v83
    s_waitcnt lgkmcnt(4)
    v_mfma_f32_16x16x32_bf16 v[64:67], a[24:27], v[56:59], v[64:67]
    ds_read_b128 v[48:51], v12 offset:12288
    v_mfma_f32_16x16x32_bf16 v[68:71], a[28:31], v[56:59], v[68:71]
    v_cvt_pk_bf16_f32 v98, v84, v85
    v_mfma_f32_16x16x32_bf16 v[72:75], a[24:27], v[60:63], v[72:75]
    ds_read_b128 v[52:55], v12 offset:12544
    v_mfma_f32_16x16x32_bf16 v[76:79], a[28:31], v[60:63], v[76:79]
    v_cvt_pk_bf16_f32 v99, v86, v87
    s_waitcnt lgkmcnt(4)
    v_mfma_f32_16x16x32_bf16 v[64:67], a[32:35], v[32:35], v[64:67]
    ds_read_b128 v[56:59], v12 offset:14336
    v_mfma_f32_16x16x32_bf16 v[68:71], a[36:39], v[32:35], v[68:71]
    v_cvt_pk_bf16_f32 v100, v88, v89
    v_mfma_f32_16x16x32_bf16 v[72:75], a[32:35], v[36:39], v[72:75]
    ds_read_b128 v[60:63], v12 offset:14592
    s_add_u32 m0, s34, 90112
    s_add_u32 s32, s35, 24576
    v_mfma_f32_16x16x32_bf16 v[76:79], a[36:39], v[36:39], v[76:79]
    buffer_load_dwordx4 v8, s[12:15], s32 offen sc1 lds
    v_cvt_pk_bf16_f32 v101, v90, v91
    s_waitcnt lgkmcnt(4)
    v_mfma_f32_16x16x32_bf16 v[64:67], a[40:43], v[40:43], v[64:67]
    ds_read_b128 v[32:35], v12 offset:16384
    v_mfma_f32_16x16x32_bf16 v[68:71], a[44:47], v[40:43], v[68:71]
    v_cvt_pk_bf16_f32 v102, v92, v93
    v_mfma_f32_16x16x32_bf16 v[72:75], a[40:43], v[44:47], v[72:75]
    ds_read_b128 v[36:39], v12 offset:16640
    v_mfma_f32_16x16x32_bf16 v[76:79], a[44:47], v[44:47], v[76:79]
    v_cvt_pk_bf16_f32 v103, v94, v95
    buffer_store_dwordx4 v[96:99], v9, s[20:23], s36 offen
    s_add_u32 s31, s36, 65536
    s_waitcnt lgkmcnt(4)
    v_mfma_f32_16x16x32_bf16 v[64:67], a[48:51], v[48:51], v[64:67]
    ds_read_b128 v[40:43], v12 offset:18432
    v_mfma_f32_16x16x32_bf16 v[68:71], a[52:55], v[48:51], v[68:71]
    v_mfma_f32_16x16x32_bf16 v[72:75], a[48:51], v[52:55], v[72:75]
    ds_read_b128 v[44:47], v12 offset:18688
    s_add_u32 m0, s34, 94208
    s_add_u32 s32, s35, 28672
    v_mfma_f32_16x16x32_bf16 v[76:79], a[52:55], v[52:55], v[76:79]
    buffer_load_dwordx4 v8, s[12:15], s32 offen sc1 lds
    s_waitcnt lgkmcnt(4)
    v_mfma_f32_16x16x32_bf16 v[64:67], a[56:59], v[56:59], v[64:67]
    ds_read_b128 v[48:51], v12 offset:20480
    v_mfma_f32_16x16x32_bf16 v[68:71], a[60:63], v[56:59], v[68:71]
    v_mfma_f32_16x16x32_bf16 v[72:75], a[56:59], v[60:63], v[72:75]
    ds_read_b128 v[52:55], v12 offset:20736
    v_mfma_f32_16x16x32_bf16 v[76:79], a[60:63], v[60:63], v[76:79]
    buffer_store_dwordx4 v[100:103], v9, s[20:23], s31 offen
    s_add_u32 s36, s36, s37
    s_waitcnt vmcnt(8)
    s_barrier
    s_waitcnt lgkmcnt(4)
    v_mfma_f32_16x16x32_bf16 v[64:67], a[64:67], v[32:35], v[64:67]
    ds_read_b128 v[56:59], v12 offset:22528
    v_mfma_f32_16x16x32_bf16 v[68:71], a[68:71], v[32:35], v[68:71]
    v_mfma_f32_16x16x32_bf16 v[72:75], a[64:67], v[36:39], v[72:75]
    ds_read_b128 v[60:63], v12 offset:22784
    s_add_u32 m0, s34, 98304
    s_add_u32 s32, s35, 32768
    v_mfma_f32_16x16x32_bf16 v[76:79], a[68:71], v[36:39], v[76:79]
    buffer_load_dwordx4 v8, s[12:15], s32 offen sc1 lds
    s_waitcnt lgkmcnt(4)
    v_mfma_f32_16x16x32_bf16 v[64:67], a[72:75], v[40:43], v[64:67]
    ds_read_b128 v[32:35], v12 offset:24576
    v_mfma_f32_16x16x32_bf16 v[68:71], a[76:79], v[40:43], v[68:71]
    v_mfma_f32_16x16x32_bf16 v[72:75], a[72:75], v[44:47], v[72:75]
    ds_read_b128 v[36:39], v12 offset:24832
    v_mfma_f32_16x16x32_bf16 v[76:79], a[76:79], v[44:47], v[76:79]
    s_waitcnt lgkmcnt(4)
    v_mfma_f32_16x16x32_bf16 v[64:67], a[80:83], v[48:51], v[64:67]
    ds_read_b128 v[40:43], v12 offset:26624
    v_mfma_f32_16x16x32_bf16 v[68:71], a[84:87], v[48:51], v[68:71]
    v_and_b32 v9, 0xffffff, v9
    v_mfma_f32_16x16x32_bf16 v[72:75], a[80:83], v[52:55], v[72:75]
    ds_read_b128 v[44:47], v12 offset:26880
    s_add_u32 m0, s34, 102400
    s_add_u32 s32, s35, 36864
    v_mfma_f32_16x16x32_bf16 v[76:79], a[84:87], v[52:55], v[76:79]
    buffer_load_dwordx4 v8, s[12:15], s32 offen sc1 lds
    s_waitcnt lgkmcnt(4)
    v_mfma_f32_16x16x32_bf16 v[64:67], a[88:91], v[56:59], v[64:67]
    ds_read_b128 v[48:51], v12 offset:28672
    v_mfma_f32_16x16x32_bf16 v[68:71], a[92:95], v[56:59], v[68:71]
    v_mfma_f32_16x16x32_bf16 v[72:75], a[88:91], v[60:63], v[72:75]
    ds_read_b128 v[52:55], v12 offset:28928
    v_mfma_f32_16x16x32_bf16 v[76:79], a[92:95], v[60:63], v[76:79]
    s_waitcnt lgkmcnt(4)
    v_mfma_f32_16x16x32_bf16 v[64:67], a[96:99], v[32:35], v[64:67]
    ds_read_b128 v[56:59], v12 offset:30720
    v_mfma_f32_16x16x32_bf16 v[68:71], a[100:103], v[32:35], v[68:71]
    v_mfma_f32_16x16x32_bf16 v[72:75], a[96:99], v[36:39], v[72:75]
    ds_read_b128 v[60:63], v12 offset:30976
    s_add_u32 m0, s34, 106496
    s_add_u32 s32, s35, 40960
    v_mfma_f32_16x16x32_bf16 v[76:79], a[100:103], v[36:39], v[76:79]
    buffer_load_dwordx4 v8, s[12:15], s32 offen sc1 lds
    s_waitcnt lgkmcnt(4)
    v_mfma_f32_16x16x32_bf16 v[64:67], a[104:107], v[40:43], v[64:67]
    ds_read_b128 v[32:35], v12 offset:32768
    v_mfma_f32_16x16x32_bf16 v[68:71], a[108:111], v[40:43], v[68:71]
    v_mfma_f32_16x16x32_bf16 v[72:75], a[104:107], v[44:47], v[72:75]
    ds_read_b128 v[36:39], v12 offset:33024
    v_mfma_f32_16x16x32_bf16 v[76:79], a[108:111], v[44:47], v[76:79]
    s_waitcnt lgkmcnt(4)
    v_mfma_f32_16x16x32_bf16 v[64:67], a[112:115], v[48:51], v[64:67]
    ds_read_b128 v[40:43], v12 offset:34816
    v_mfma_f32_16x16x32_bf16 v[68:71], a[116:119], v[48:51], v[68:71]
    v_mfma_f32_16x16x32_bf16 v[72:75], a[112:115], v[52:55], v[72:75]
    ds_read_b128 v[44:47], v12 offset:35072
    s_add_u32 m0, s34, 110592
    s_add_u32 s32, s35, 45056
    v_mfma_f32_16x16x32_bf16 v[76:79], a[116:119], v[52:55], v[76:79]
    buffer_load_dwordx4 v8, s[12:15], s32 offen sc1 lds
    s_waitcnt lgkmcnt(4)
    v_mfma_f32_16x16x32_bf16 v[64:67], a[120:123], v[56:59], v[64:67]
    ds_read_b128 v[48:51], v12 offset:36864
    v_mfma_f32_16x16x32_bf16 v[68:71], a[124:127], v[56:59], v[68:71]
    v_mfma_f32_16x16x32_bf16 v[72:75], a[120:123], v[60:63], v[72:75]
    ds_read_b128 v[52:55], v12 offset:37120
    v_mfma_f32_16x16x32_bf16 v[76:79], a[124:127], v[60:63], v[76:79]
    s_waitcnt lgkmcnt(4)
    v_mfma_f32_16x16x32_bf16 v[64:67], a[128:131], v[32:35], v[64:67]
    ds_read_b128 v[56:59], v12 offset:38912
    v_mfma_f32_16x16x32_bf16 v[68:71], a[132:135], v[32:35], v[68:71]
    v_mfma_f32_16x16x32_bf16 v[72:75], a[128:131], v[36:39], v[72:75]
    ds_read_b128 v[60:63], v12 offset:39168
    s_add_u32 m0, s34, 114688
    s_add_u32 s32, s35, 49152
    v_mfma_f32_16x16x32_bf16 v[76:79], a[132:135], v[36:39], v[76:79]
    buffer_load_dwordx4 v8, s[12:15], s32 offen sc1 lds
    s_waitcnt lgkmcnt(4)
    v_mfma_f32_16x16x32_bf16 v[64:67], a[136:139], v[40:43], v[64:67]
    ds_read_b128 v[32:35], v12 offset:40960
    v_mfma_f32_16x16x32_bf16 v[68:71], a[140:143], v[40:43], v[68:71]
    v_mfma_f32_16x16x32_bf16 v[72:75], a[136:139], v[44:47], v[72:75]
    ds_read_b128 v[36:39], v12 offset:41216
    v_mfma_f32_16x16x32_bf16 v[76:79], a[140:143], v[44:47], v[76:79]
    s_waitcnt lgkmcnt(4)
    v_mfma_f32_16x16x32_bf16 v[64:67], a[144:147], v[48:51], v[64:67]
    ds_read_b128 v[40:43], v12 offset:43008
    v_mfma_f32_16x16x32_bf16 v[68:71], a[148:151], v[48:51], v[68:71]
    v_mfma_f32_16x16x32_bf16 v[72:75], a[144:147], v[52:55], v[72:75]
    ds_read_b128 v[44:47], v12 offset:43264
    s_add_u32 m0, s34, 118784
    s_add_u32 s32, s35, 53248
    v_mfma_f32_16x16x32_bf16 v[76:79], a[148:151], v[52:55], v[76:79]
    buffer_load_dwordx4 v8, s[12:15], s32 offen sc1 lds
    s_waitcnt lgkmcnt(4)
    v_mfma_f32_16x16x32_bf16 v[64:67], a[152:155], v[56:59], v[64:67]
    ds_read_b128 v[48:51], v12 offset:45056
    v_mfma_f32_16x16x32_bf16 v[68:71], a[156:159], v[56:59], v[68:71]
    v_mfma_f32_16x16x32_bf16 v[72:75], a[152:155], v[60:63], v[72:75]
    ds_read_b128 v[52:55], v12 offset:45312
    v_mfma_f32_16x16x32_bf16 v[76:79], a[156:159], v[60:63], v[76:79]
    s_waitcnt lgkmcnt(4)
    v_mfma_f32_16x16x32_bf16 v[64:67], a[160:163], v[32:35], v[64:67]
    ds_read_b128 v[56:59], v12 offset:47104
    v_mfma_f32_16x16x32_bf16 v[68:71], a[164:167], v[32:35], v[68:71]
    v_mfma_f32_16x16x32_bf16 v[72:75], a[160:163], v[36:39], v[72:75]
    ds_read_b128 v[60:63], v12 offset:47360
    s_add_u32 m0, s34, 122880
    s_add_u32 s32, s35, 57344
    v_mfma_f32_16x16x32_bf16 v[76:79], a[164:167], v[36:39], v[76:79]
    buffer_load_dwordx4 v8, s[12:15], s32 offen sc1 lds
    s_waitcnt lgkmcnt(4)
    v_mfma_f32_16x16x32_bf16 v[64:67], a[168:171], v[40:43], v[64:67]
    ds_read_b128 v[32:35], v12 offset:49152
    v_mfma_f32_16x16x32_bf16 v[68:71], a[172:175], v[40:43], v[68:71]
    v_mfma_f32_16x16x32_bf16 v[72:75], a[168:171], v[44:47], v[72:75]
    ds_read_b128 v[36:39], v12 offset:49408
    v_mfma_f32_16x16x32_bf16 v[76:79], a[172:175], v[44:47], v[76:79]
    s_waitcnt lgkmcnt(4)
    v_mfma_f32_16x16x32_bf16 v[64:67], a[176:179], v[48:51], v[64:67]
    ds_read_b128 v[40:43], v12 offset:51200
    v_mfma_f32_16x16x32_bf16 v[68:71], a[180:183], v[48:51], v[68:71]
    v_mfma_f32_16x16x32_bf16 v[72:75], a[176:179], v[52:55], v[72:75]
    ds_read_b128 v[44:47], v12 offset:51456
    s_add_u32 m0, s34, 126976
    s_add_u32 s32, s35, 61440
    v_mfma_f32_16x16x32_bf16 v[76:79], a[180:183], v[52:55], v[76:79]
    buffer_load_dwordx4 v8, s[12:15], s32 offen sc1 lds
    s_add_u32 s35, s35, 65536
    s_min_u32 s35, s35, s52
    s_waitcnt lgkmcnt(4)
    v_mfma_f32_16x16x32_bf16 v[64:67], a[184:187], v[56:59], v[64:67]
    ds_read_b128 v[48:51], v12 offset:53248
    v_mfma_f32_16x16x32_bf16 v[68:71], a[188:191], v[56:59], v[68:71]
    v_mfma_f32_16x16x32_bf16 v[72:75], a[184:187], v[60:63], v[72:75]
    ds_read_b128 v[52:55], v12 offset:53504
    v_mfma_f32_16x16x32_bf16 v[76:79], a[188:191], v[60:63], v[76:79]
    s_waitcnt vmcnt(8)
    s_barrier
    s_waitcnt lgkmcnt(4)
    v_mfma_f32_16x16x32_bf16 v[64:67], a[192:195], v[32:35], v[64:67]
    ds_read_b128 v[56:59], v12 offset:55296
    v_mfma_f32_16x16x32_bf16 v[68:71], a[196:199], v[32:35], v[68:71]
    v_mfma_f32_16x16x32_bf16 v[72:75], a[192:195], v[36:39], v[72:75]
    ds_read_b128 v[60:63], v12 offset:55552
    s_add_u32 m0, s34, 0
    s_add_u32 s32, s35, 0
    v_mfma_f32_16x16x32_bf16 v[76:79], a[196:199], v[36:39], v[76:79]
    buffer_load_dwordx4 v8, s[12:15], s32 offen sc1 lds
    s_waitcnt lgkmcnt(4)
    v_mfma_f32_16x16x32_bf16 v[64:67], a[200:203], v[40:43], v[64:67]
    ds_read_b128 v[32:35], v12 offset:57344
    v_mfma_f32_16x16x32_bf16 v[68:71], a[204:207], v[40:43], v[68:71]
    v_mfma_f32_16x16x32_bf16 v[72:75], a[200:203], v[44:47], v[72:75]
    ds_read_b128 v[36:39], v12 offset:57600
    v_mfma_f32_16x16x32_bf16 v[76:79], a[204:207], v[44:47], v[76:79]
    s_waitcnt lgkmcnt(4)
    v_mfma_f32_16x16x32_bf16 v[64:67], a[208:211], v[48:51], v[64:67]
    ds_read_b128 v[40:43], v12 offset:59392
    v_mfma_f32_16x16x32_bf16 v[68:71], a[212:215], v[48:51], v[68:71]
    v_mfma_f32_16x16x32_bf16 v[72:75], a[208:211], v[52:55], v[72:75]
    ds_read_b128 v[44:47], v12 offset:59648
    s_add_u32 m0, s34, 4096
    s_add_u32 s32, s35, 4096
    v_mfma_f32_16x16x32_bf16 v[76:79], a[212:215], v[52:55], v[76:79]
    buffer_load_dwordx4 v8, s[12:15], s32 offen sc1 lds
    s_waitcnt lgkmcnt(4)
    v_mfma_f32_16x16x32_bf16 v[64:67], a[216:219], v[56:59], v[64:67]
    ds_read_b128 v[48:51], v12 offset:61440
    v_mfma_f32_16x16x32_bf16 v[68:71], a[220:223], v[56:59], v[68:71]
    v_mfma_f32_16x16x32_bf16 v[72:75], a[216:219], v[60:63], v[72:75]
    ds_read_b128 v[52:55], v12 offset:61696
    v_mfma_f32_16x16x32_bf16 v[76:79], a[220:223], v[60:63], v[76:79]
    s_waitcnt lgkmcnt(4)
    v_mfma_f32_16x16x32_bf16 v[64:67], a[224:227], v[32:35], v[64:67]
    ds_read_b128 v[56:59], v12 offset:63488
    v_mfma_f32_16x16x32_bf16 v[68:71], a[228:231], v[32:35], v[68:71]
    v_mfma_f32_16x16x32_bf16 v[72:75], a[224:227], v[36:39], v[72:75]
    ds_read_b128 v[60:63], v12 offset:63744
    s_add_u32 m0, s34, 8192
    s_add_u32 s32, s35, 8192
    v_mfma_f32_16x16x32_bf16 v[76:79], a[228:231], v[36:39], v[76:79]
    buffer_load_dwordx4 v8, s[12:15], s32 offen sc1 lds
    s_waitcnt lgkmcnt(4)
    v_mfma_f32_16x16x32_bf16 v[64:67], a[232:235], v[40:43], v[64:67]
    ds_read_b128 v[32:35], v14 offset:0
    v_mfma_f32_16x16x32_bf16 v[68:71], a[236:239], v[40:43], v[68:71]
    v_mfma_f32_16x16x32_bf16 v[72:75], a[232:235], v[44:47], v[72:75]
    ds_read_b128 v[36:39], v14 offset:256
    v_mfma_f32_16x16x32_bf16 v[76:79], a[236:239], v[44:47], v[76:79]
    s_waitcnt lgkmcnt(4)
    v_mfma_f32_16x16x32_bf16 v[64:67], a[240:243], v[48:51], v[64:67]
    ds_read_b128 v[40:43], v14 offset:2048
    v_mfma_f32_16x16x32_bf16 v[68:71], a[244:247], v[48:51], v[68:71]
    v_mfma_f32_16x16x32_bf16 v[72:75], a[240:243], v[52:55], v[72:75]
    ds_read_b128 v[44:47], v14 offset:2304
    s_add_u32 m0, s34, 12288
    s_add_u32 s32, s35, 12288
    v_mfma_f32_16x16x32_bf16 v[76:79], a[244:247], v[52:55], v[76:79]
    buffer_load_dwordx4 v8, s[12:15], s32 offen sc1 lds
    s_waitcnt lgkmcnt(4)
    v_mfma_f32_16x16x32_bf16 v[64:67], a[248:251], v[56:59], v[64:67]
    ds_read_b128 v[48:51], v14 offset:4096
    v_mfma_f32_16x16x32_bf16 v[68:71], a[252:255], v[56:59], v[68:71]
    v_mfma_f32_16x16x32_bf16 v[72:75], a[248:251], v[60:63], v[72:75]
    ds_read_b128 v[52:55], v14 offset:4352
    v_mfma_f32_16x16x32_bf16 v[76:79], a[252:255], v[60:63], v[76:79]
    s_waitcnt lgkmcnt(4)
    v_mfma_f32_16x16x32_bf16 v[80:83], a[0:3], v[32:35], 0
    ds_read_b128 v[56:59], v14 offset:6144
    v_mfma_f32_16x16x32_bf16 v[84:87], a[4:7], v[32:35], 0
    v_mfma_f32_16x16x32_bf16 v[88:91], a[0:3], v[36:39], 0
    ds_read_b128 v[60:63], v14 offset:6400
    s_add_u32 m0, s34, 16384
    s_add_u32 s32, s35, 16384
    v_mfma_f32_16x16x32_bf16 v[92:95], a[4:7], v[36:39], 0
    buffer_load_dwordx4 v8, s[12:15], s32 offen sc1 lds
    s_waitcnt lgkmcnt(4)
    v_mfma_f32_16x16x32_bf16 v[80:83], a[8:11], v[40:43], v[80:83]
    ds_read_b128 v[32:35], v14 offset:8192
    v_mfma_f32_16x16x32_bf16 v[84:87], a[12:15], v[40:43], v[84:87]
    v_mfma_f32_16x16x32_bf16 v[88:91], a[8:11], v[44:47], v[88:91]
    ds_read_b128 v[36:39], v14 offset:8448
    v_mfma_f32_16x16x32_bf16 v[92:95], a[12:15], v[44:47], v[92:95]
    s_waitcnt lgkmcnt(4)
    v_mfma_f32_16x16x32_bf16 v[80:83], a[16:19], v[48:51], v[80:83]
    ds_read_b128 v[40:43], v14 offset:10240
    v_mfma_f32_16x16x32_bf16 v[84:87], a[20:23], v[48:51], v[84:87]
    v_cvt_pk_bf16_f32 v96, v64, v65
    v_mfma_f32_16x16x32_bf16 v[88:91], a[16:19], v[52:55], v[88:91]
    ds_read_b128 v[44:47], v14 offset:10496
    s_add_u32 m0, s34, 20480
    s_add_u32 s32, s35, 20480
    v_mfma_f32_16x16x32_bf16 v[92:95], a[20:23], v[52:55], v[92:95]
    buffer_load_dwordx4 v8, s[12:15], s32 offen sc1 lds
    v_cvt_pk_bf16_f32 v97, v66, v67
    s_waitcnt lgkmcnt(4)
    v_mfma_f32_16x16x32_bf16 v[80:83], a[24:27], v[56:59], v[80:83]
    ds_read_b128 v[48:51], v14 offset:12288
    v_mfma_f32_16x16x32_bf16 v[84:87], a[28:31], v[56:59], v[84:87]
    v_cvt_pk_bf16_f32 v98, v68, v69
    v_mfma_f32_16x16x32_bf16 v[88:91], a[24:27], v[60:63], v[88:91]
    ds_read_b128 v[52:55], v14 offset:12544
    v_mfma_f32_16x16x32_bf16 v[92:95], a[28:31], v[60:63], v[92:95]
    v_cvt_pk_bf16_f32 v99, v70, v71
    s_waitcnt lgkmcnt(4)
    v_mfma_f32_16x16x32_bf16 v[80:83], a[32:35], v[32:35], v[80:83]
    ds_read_b128 v[56:59], v14 offset:14336
    v_mfma_f32_16x16x32_bf16 v[84:87], a[36:39], v[32:35], v[84:87]
    v_cvt_pk_bf16_f32 v100, v72, v73
    v_mfma_f32_16x16x32_bf16 v[88:91], a[32:35], v[36:39], v[88:91]
    ds_read_b128 v[60:63], v14 offset:14592
    s_add_u32 m0, s34, 24576
    s_add_u32 s32, s35, 24576
    v_mfma_f32_16x16x32_bf16 v[92:95], a[36:39], v[36:39], v[92:95]
    buffer_load_dwordx4 v8, s[12:15], s32 offen sc1 lds
    v_cvt_pk_bf16_f32 v101, v74, v75
    s_waitcnt lgkmcnt(4)
    v_mfma_f32_16x16x32_bf16 v[80:83], a[40:43], v[40:43], v[80:83]
    ds_read_b128 v[32:35], v14 offset:16384
    v_mfma_f32_16x16x32_bf16 v[84:87], a[44:47], v[40:43], v[84:87]
    v_cvt_pk_bf16_f32 v102, v76, v77
    v_mfma_f32_16x16x32_bf16 v[88:91], a[40:43], v[44:47], v[88:91]
    ds_read_b128 v[36:39], v14 offset:16640
    v_mfma_f32_16x16x32_bf16 v[92:95], a[44:47], v[44:47], v[92:95]
    v_cvt_pk_bf16_f32 v103, v78, v79
    buffer_store_dwordx4 v[96:99], v9, s[20:23], s36 offen
    s_add_u32 s31, s36, 65536
    s_waitcnt lgkmcnt(4)
    v_mfma_f32_16x16x32_bf16 v[80:83], a[48:51], v[48:51], v[80:83]
    ds_read_b128 v[40:43], v14 offset:18432
    v_mfma_f32_16x16x32_bf16 v[84:87], a[52:55], v[48:51], v[84:87]
    v_mfma_f32_16x16x32_bf16 v[88:91], a[48:51], v[52:55], v[88:91]
    ds_read_b128 v[44:47], v14 offset:18688
    s_add_u32 m0, s34, 28672
    s_add_u32 s32, s35, 28672
    v_mfma_f32_16x16x32_bf16 v[92:95], a[52:55], v[52:55], v[92:95]
    buffer_load_dwordx4 v8, s[12:15], s32 offen sc1 lds
    s_waitcnt lgkmcnt(4)
    v_mfma_f32_16x16x32_bf16 v[80:83], a[56:59], v[56:59], v[80:83]
    ds_read_b128 v[48:51], v14 offset:20480
    v_mfma_f32_16x16x32_bf16 v[84:87], a[60:63], v[56:59], v[84:87]
    v_mfma_f32_16x16x32_bf16 v[88:91], a[56:59], v[60:63], v[88:91]
    ds_read_b128 v[52:55], v14 offset:20736
    v_mfma_f32_16x16x32_bf16 v[92:95], a[60:63], v[60:63], v[92:95]
    buffer_store_dwordx4 v[100:103], v9, s[20:23], s31 offen
    s_add_u32 s36, s36, s37
    s_waitcnt vmcnt(8)
    s_barrier
    s_waitcnt lgkmcnt(4)
    v_mfma_f32_16x16x32_bf16 v[80:83], a[64:67], v[32:35], v[80:83]
    ds_read_b128 v[56:59], v14 offset:22528
    v_mfma_f32_16x16x32_bf16 v[84:87], a[68:71], v[32:35], v[84:87]
    v_mfma_f32_16x16x32_bf16 v[88:91], a[64:67], v[36:39], v[88:91]
    ds_read_b128 v[60:63], v14 offset:22784
    s_add_u32 m0, s34, 32768
    s_add_u32 s32, s35, 32768
    v_mfma_f32_16x16x32_bf16 v[92:95], a[68:71], v[36:39], v[92:95]
    buffer_load_dwordx4 v8, s[12:15], s32 offen sc1 lds
    s_waitcnt lgkmcnt(4)
    v_mfma_f32_16x16x32_bf16 v[80:83], a[72:75], v[40:43], v[80:83]
    ds_read_b128 v[32:35], v14 offset:24576
    v_mfma_f32_16x16x32_bf16 v[84:87], a[76:79], v[40:43], v[84:87]
    v_mfma_f32_16x16x32_bf16 v[88:91], a[72:75], v[44:47], v[88:91]
    ds_read_b128 v[36:39], v14 offset:24832
    v_mfma_f32_16x16x32_bf16 v[92:95], a[76:79], v[44:47], v[92:95]
    s_waitcnt lgkmcnt(4)
    v_mfma_f32_16x16x32_bf16 v[80:83], a[80:83], v[48:51], v[80:83]
    ds_read_b128 v[40:43], v14 offset:26624
    v_mfma_f32_16x16x32_bf16 v[84:87], a[84:87], v[48:51], v[84:87]
    v_mfma_f32_16x16x32_bf16 v[88:91], a[80:83], v[52:55], v[88:91]
    ds_read_b128 v[44:47], v14 offset:26880
    s_add_u32 m0, s34, 36864
    s_add_u32 s32, s35, 36864
    v_mfma_f32_16x16x32_bf16 v[92:95], a[84:87], v[52:55], v[92:95]
    buffer_load_dwordx4 v8, s[12:15], s32 offen sc1 lds
    s_waitcnt lgkmcnt(4)
    v_mfma_f32_16x16x32_bf16 v[80:83], a[88:91], v[56:59], v[80:83]
    ds_read_b128 v[48:51], v14 offset:28672
    v_mfma_f32_16x16x32_bf16 v[84:87], a[92:95], v[56:59], v[84:87]
    v_mfma_f32_16x16x32_bf16 v[88:91], a[88:91], v[60:63], v[88:91]
    ds_read_b128 v[52:55], v14 offset:28928
    v_mfma_f32_16x16x32_bf16 v[92:95], a[92:95], v[60:63], v[92:95]
    s_waitcnt lgkmcnt(4)
    v_mfma_f32_16x16x32_bf16 v[80:83], a[96:99], v[32:35], v[80:83]
    ds_read_b128 v[56:59], v14 offset:30720
    v_mfma_f32_16x16x32_bf16 v[84:87], a[100:103], v[32:35], v[84:87]
    v_mfma_f32_16x16x32_bf16 v[88:91], a[96:99], v[36:39], v[88:91]
    ds_read_b128 v[60:63], v14 offset:30976
    s_add_u32 m0, s34, 40960
    s_add_u32 s32, s35, 40960
    v_mfma_f32_16x16x32_bf16 v[92:95], a[100:103], v[36:39], v[92:95]
    buffer_load_dwordx4 v8, s[12:15], s32 offen sc1 lds
    s_waitcnt lgkmcnt(4)
    v_mfma_f32_16x16x32_bf16 v[80:83], a[104:107], v[40:43], v[80:83]
    ds_read_b128 v[32:35], v14 offset:32768
    v_mfma_f32_16x16x32_bf16 v[84:87], a[108:111], v[40:43], v[84:87]
    v_mfma_f32_16x16x32_bf16 v[88:91], a[104:107], v[44:47], v[88:91]
    ds_read_b128 v[36:39], v14 offset:33024
    v_mfma_f32_16x16x32_bf16 v[92:95], a[108:111], v[44:47], v[92:95]
    s_waitcnt lgkmcnt(4)
    v_mfma_f32_16x16x32_bf16 v[80:83], a[112:115], v[48:51], v[80:83]
    ds_read_b128 v[40:43], v14 offset:34816
    v_mfma_f32_16x16x32_bf16 v[84:87], a[116:119], v[48:51], v[84:87]
    v_mfma_f32_16x16x32_bf16 v[88:91], a[112:115], v[52:55], v[88:91]
    ds_read_b128 v[44:47], v14 offset:35072
    s_add_u32 m0, s34, 45056
    s_add_u32 s32, s35, 45056
    v_mfma_f32_16x16x32_bf16 v[92:95], a[116:119], v[52:55], v[92:95]
    buffer_load_dwordx4 v8, s[12:15], s32 offen sc1 lds
    s_waitcnt lgkmcnt(4)
    v_mfma_f32_16x16x32_bf16 v[80:83], a[120:123], v[56:59], v[80:83]
    ds_read_b128 v[48:51], v14 offset:36864
    v_mfma_f32_16x16x32_bf16 v[84:87], a[124:127], v[56:59], v[84:87]
    v_mfma_f32_16x16x32_bf16 v[88:91], a[120:123], v[60:63], v[88:91]
    ds_read_b128 v[52:55], v14 offset:37120
    v_mfma_f32_16x16x32_bf16 v[92:95], a[124:127], v[60:63], v[92:95]
    s_waitcnt lgkmcnt(4)
    v_mfma_f32_16x16x32_bf16 v[80:83], a[128:131], v[32:35], v[80:83]
    ds_read_b128 v[56:59], v14 offset:38912
    v_mfma_f32_16x16x32_bf16 v[84:87], a[132:135], v[32:35], v[84:87]
    v_mfma_f32_16x16x32_bf16 v[88:91], a[128:131], v[36:39], v[88:91]
    ds_read_b128 v[60:63], v14 offset:39168
    s_add_u32 m0, s34, 49152
    s_add_u32 s32, s35, 49152
    v_mfma_f32_16x16x32_bf16 v[92:95], a[132:135], v[36:39], v[92:95]
    buffer_load_dwordx4 v8, s[12:15], s32 offen sc1 lds
    s_waitcnt lgkmcnt(4)
    v_mfma_f32_16x16x32_bf16 v[80:83], a[136:139], v[40:43], v[80:83]
    ds_read_b128 v[32:35], v14 offset:40960
    v_mfma_f32_16x16x32_bf16 v[84:87], a[140:143], v[40:43], v[84:87]
    v_mfma_f32_16x16x32_bf16 v[88:91], a[136:139], v[44:47], v[88:91]
    ds_read_b128 v[36:39], v14 offset:41216
    v_mfma_f32_16x16x32_bf16 v[92:95], a[140:143], v[44:47], v[92:95]
    s_waitcnt lgkmcnt(4)
    v_mfma_f32_16x16x32_bf16 v[80:83], a[144:147], v[48:51], v[80:83]
    ds_read_b128 v[40:43], v14 offset:43008
    v_mfma_f32_16x16x32_bf16 v[84:87], a[148:151], v[48:51], v[84:87]
    v_mfma_f32_16x16x32_bf16 v[88:91], a[144:147], v[52:55], v[88:91]
    ds_read_b128 v[44:47], v14 offset:43264
    s_add_u32 m0, s34, 53248
    s_add_u32 s32, s35, 53248
    v_mfma_f32_16x16x32_bf16 v[92:95], a[148:151], v[52:55], v[92:95]
    buffer_load_dwordx4 v8, s[12:15], s32 offen sc1 lds
    s_waitcnt lgkmcnt(4)
    v_mfma_f32_16x16x32_bf16 v[80:83], a[152:155], v[56:59], v[80:83]
    ds_read_b128 v[48:51], v14 offset:45056
    v_mfma_f32_16x16x32_bf16 v[84:87], a[156:159], v[56:59], v[84:87]
    v_mfma_f32_16x16x32_bf16 v[88:91], a[152:155], v[60:63], v[88:91]
    ds_read_b128 v[52:55], v14 offset:45312
    v_mfma_f32_16x16x32_bf16 v[92:95], a[156:159], v[60:63], v[92:95]
    s_waitcnt lgkmcnt(4)
    v_mfma_f32_16x16x32_bf16 v[80:83], a[160:163], v[32:35], v[80:83]
    ds_read_b128 v[56:59], v14 offset:47104
    v_mfma_f32_16x16x32_bf16 v[84:87], a[164:167], v[32:35], v[84:87]
    v_mfma_f32_16x16x32_bf16 v[88:91], a[160:163], v[36:39], v[88:91]
    ds_read_b128 v[60:63], v14 offset:47360
    s_add_u32 m0, s34, 57344
    s_add_u32 s32, s35, 57344
    v_mfma_f32_16x16x32_bf16 v[92:95], a[164:167], v[36:39], v[92:95]
    buffer_load_dwordx4 v8, s[12:15], s32 offen sc1 lds
    s_waitcnt lgkmcnt(4)
    v_mfma_f32_16x16x32_bf16 v[80:83], a[168:171], v[40:43], v[80:83]
    ds_read_b128 v[32:35], v14 offset:49152
    v_mfma_f32_16x16x32_bf16 v[84:87], a[172:175], v[40:43], v[84:87]
    v_mfma_f32_16x16x32_bf16 v[88:91], a[168:171], v[44:47], v[88:91]
    ds_read_b128 v[36:39], v14 offset:49408
    v_mfma_f32_16x16x32_bf16 v[92:95], a[172:175], v[44:47], v[92:95]
    s_waitcnt lgkmcnt(4)
    v_mfma_f32_16x16x32_bf16 v[80:83], a[176:179], v[48:51], v[80:83]
    ds_read_b128 v[40:43], v14 offset:51200
    v_mfma_f32_16x16x32_bf16 v[84:87], a[180:183], v[48:51], v[84:87]
    v_mfma_f32_16x16x32_bf16 v[88:91], a[176:179], v[52:55], v[88:91]
    ds_read_b128 v[44:47], v14 offset:51456
    s_add_u32 m0, s34, 61440
    s_add_u32 s32, s35, 61440
    v_mfma_f32_16x16x32_bf16 v[92:95], a[180:183], v[52:55], v[92:95]
    buffer_load_dwordx4 v8, s[12:15], s32 offen sc1 lds
    s_add_u32 s35, s35, 65536
    s_min_u32 s35, s35, s52
    s_waitcnt lgkmcnt(4)
    v_mfma_f32_16x16x32_bf16 v[80:83], a[184:187], v[56:59], v[80:83]
    ds_read_b128 v[48:51], v14 offset:53248
    v_mfma_f32_16x16x32_bf16 v[84:87], a[188:191], v[56:59], v[84:87]
    v_mfma_f32_16x16x32_bf16 v[88:91], a[184:187], v[60:63], v[88:91]
    ds_read_b128 v[52:55], v14 offset:53504
    v_mfma_f32_16x16x32_bf16 v[92:95], a[188:191], v[60:63], v[92:95]
    s_waitcnt vmcnt(8)
    s_barrier
    s_waitcnt lgkmcnt(4)
    v_mfma_f32_16x16x32_bf16 v[80:83], a[192:195], v[32:35], v[80:83]
    ds_read_b128 v[56:59], v14 offset:55296
    v_mfma_f32_16x16x32_bf16 v[84:87], a[196:199], v[32:35], v[84:87]
    v_mfma_f32_16x16x32_bf16 v[88:91], a[192:195], v[36:39], v[88:91]
    ds_read_b128 v[60:63], v14 offset:55552
    s_add_u32 m0, s34, 65536
    s_add_u32 s32, s35, 0
    v_mfma_f32_16x16x32_bf16 v[92:95], a[196:199], v[36:39], v[92:95]
    buffer_load_dwordx4 v8, s[12:15], s32 offen sc1 lds
    s_waitcnt lgkmcnt(4)
    v_mfma_f32_16x16x32_bf16 v[80:83], a[200:203], v[40:43], v[80:83]
    ds_read_b128 v[32:35], v14 offset:57344
    v_mfma_f32_16x16x32_bf16 v[84:87], a[204:207], v[40:43], v[84:87]
    v_mfma_f32_16x16x32_bf16 v[88:91], a[200:203], v[44:47], v[88:91]
    ds_read_b128 v[36:39], v14 offset:57600
    v_mfma_f32_16x16x32_bf16 v[92:95], a[204:207], v[44:47], v[92:95]
    s_waitcnt lgkmcnt(4)
    v_mfma_f32_16x16x32_bf16 v[80:83], a[208:211], v[48:51], v[80:83]
    ds_read_b128 v[40:43], v14 offset:59392
    v_mfma_f32_16x16x32_bf16 v[84:87], a[212:215], v[48:51], v[84:87]
    v_mfma_f32_16x16x32_bf16 v[88:91], a[208:211], v[52:55], v[88:91]
    ds_read_b128 v[44:47], v14 offset:59648
    s_add_u32 m0, s34, 69632
    s_add_u32 s32, s35, 4096
    v_mfma_f32_16x16x32_bf16 v[92:95], a[212:215], v[52:55], v[92:95]
    buffer_load_dwordx4 v8, s[12:15], s32 offen sc1 lds
    s_waitcnt lgkmcnt(4)
    v_mfma_f32_16x16x32_bf16 v[80:83], a[216:219], v[56:59], v[80:83]
    ds_read_b128 v[48:51], v14 offset:61440
    v_mfma_f32_16x16x32_bf16 v[84:87], a[220:223], v[56:59], v[84:87]
    v_mfma_f32_16x16x32_bf16 v[88:91], a[216:219], v[60:63], v[88:91]
    ds_read_b128 v[52:55], v14 offset:61696
    v_mfma_f32_16x16x32_bf16 v[92:95], a[220:223], v[60:63], v[92:95]
    s_waitcnt lgkmcnt(4)
    v_mfma_f32_16x16x32_bf16 v[80:83], a[224:227], v[32:35], v[80:83]
    ds_read_b128 v[56:59], v14 offset:63488
    v_mfma_f32_16x16x32_bf16 v[84:87], a[228:231], v[32:35], v[84:87]
    v_mfma_f32_16x16x32_bf16 v[88:91], a[224:227], v[36:39], v[88:91]
    ds_read_b128 v[60:63], v14 offset:63744
    s_add_u32 m0, s34, 73728
    s_add_u32 s32, s35, 8192
    v_mfma_f32_16x16x32_bf16 v[92:95], a[228:231], v[36:39], v[92:95]
    buffer_load_dwordx4 v8, s[12:15], s32 offen sc1 lds
    s_waitcnt lgkmcnt(4)
    v_mfma_f32_16x16x32_bf16 v[80:83], a[232:235], v[40:43], v[80:83]
    ds_read_b128 v[32:35], v12 offset:0
    v_mfma_f32_16x16x32_bf16 v[84:87], a[236:239], v[40:43], v[84:87]
    v_mfma_f32_16x16x32_bf16 v[88:91], a[232:235], v[44:47], v[88:91]
    ds_read_b128 v[36:39], v12 offset:256
    v_mfma_f32_16x16x32_bf16 v[92:95], a[236:239], v[44:47], v[92:95]
    s_waitcnt lgkmcnt(4)
    v_mfma_f32_16x16x32_bf16 v[80:83], a[240:243], v[48:51], v[80:83]
    ds_read_b128 v[40:43], v12 offset:2048
    v_mfma_f32_16x16x32_bf16 v[84:87], a[244:247], v[48:51], v[84:87]
    v_mfma_f32_16x16x32_bf16 v[88:91], a[240:243], v[52:55], v[88:91]
    ds_read_b128 v[44:47], v12 offset:2304
    s_add_u32 m0, s34, 77824
    s_add_u32 s32, s35, 12288
    v_mfma_f32_16x16x32_bf16 v[92:95], a[244:247], v[52:55], v[92:95]
    buffer_load_dwordx4 v8, s[12:15], s32 offen sc1 lds
    s_waitcnt lgkmcnt(4)
    v_mfma_f32_16x16x32_bf16 v[80:83], a[248:251], v[56:59], v[80:83]
    ds_read_b128 v[48:51], v12 offset:4096
    v_mfma_f32_16x16x32_bf16 v[84:87], a[252:255], v[56:59], v[84:87]
    v_mfma_f32_16x16x32_bf16 v[88:91], a[248:251], v[60:63], v[88:91]
    ds_read_b128 v[52:55], v12 offset:4352
    v_mfma_f32_16x16x32_bf16 v[92:95], a[252:255], v[60:63], v[92:95]
    s_add_u32 s30, s30, 2
    s_cmp_lt_u32 s30, s51
    s_cbranch_scc1 sl_loop_110
    v_cvt_pk_bf16_f32 v96, v80, v81
    v_cvt_pk_bf16_f32 v97, v82, v83
    v_cvt_pk_bf16_f32 v98, v84, v85
    v_cvt_pk_bf16_f32 v99, v86, v87
    v_cvt_pk_bf16_f32 v100, v88, v89
    v_cvt_pk_bf16_f32 v101, v90, v91
    v_cvt_pk_bf16_f32 v102, v92, v93
    v_cvt_pk_bf16_f32 v103, v94, v95
    s_branch sl_e_109
sl_e_109:
    buffer_store_dwordx4 v[96:99], v9, s[20:23], s36 offen
    s_add_u32 s31, s36, 65536
    buffer_store_dwordx4 v[100:103], v9, s[20:23], s31 offen
    s_add_u32 s36, s36, s37
    s_waitcnt vmcnt(0) lgkmcnt(0)
    s_barrier
    s_branch L_dump
L_dump:
L_end:
    s_endpgm
.section .rodata,"a"
.p2align 6
.amdhsa_kernel concat_heads__memory_aug_recurrent_mem_tr__sliding_local_dilated__prompt_kernel
  .amdhsa_next_free_vgpr 512
  .amdhsa_next_free_sgpr 102
  .amdhsa_accum_offset 256
  .amdhsa_group_segment_fixed_size 0
  .amdhsa_kernarg_size 104
  .amdhsa_user_sgpr_count 2
  .amdhsa_user_sgpr_kernarg_segment_ptr 1
  .amdhsa_system_sgpr_workgroup_id_x 1
.end_amdhsa_kernel
```
